```python
import torch

def _softmax(x, axis=-1):
    return torch.softmax(x, dim=axis)
def _gelu(x):
    return torch.nn.functional.gelu(x, approximate="tanh")
def _silu(x):
    return torch.nn.functional.silu(x)
def _sigmoid(x):
    return torch.sigmoid(x)
def _layernorm(x, axis=-1, eps=1e-5):
    m = x.mean(dim=axis, keepdim=True)
    v = x.var(dim=axis, keepdim=True, unbiased=False)
    return (x - m) / torch.sqrt(v + eps)
def _scatter_add(tgt, idx, src, axis=0):
    return tgt.clone().index_add_(axis, idx, src)
def _segment_sum(src, seg, n):
    out = torch.zeros((n,) + src.shape[1:], dtype=src.dtype)
    return out.index_add_(0, seg, src)
def _pad(x, pw):
    flat = tuple(v for pair in reversed(pw) for v in pair)
    return torch.nn.functional.pad(x, flat)

kernel_name = 'concat_heads__mha_block_cached__mha_block_cached__near_ridge'

def setup_inputs():

    _w = (lambda a: (lambda t: t.to(torch.bfloat16) if t.is_floating_point() else t)(torch.as_tensor(a)))
    def _A_setup():
        B, Sq, D = 8, 144, 576
        H, Sk, Dh = 32, 512, 128
        return {
            "x": _w((lambda *s: torch.randn(*s, dtype=torch.bfloat16) * 0.8)(B, Sq, D)),
            "k_cache": _w((lambda *s: torch.randn(*s, dtype=torch.bfloat16) * 0.8)(B, H, Sk, Dh)),
            "v_cache": _w((lambda *s: torch.randn(*s, dtype=torch.bfloat16) * 0.05)(B, H, Sk, Dh)),
            "wq": _w((lambda *s: torch.randn(*s, dtype=torch.bfloat16) * 0.8)(D, H * Dh) * (D ** -0.5)),
            "wo": _w((lambda *s: torch.randn(*s, dtype=torch.bfloat16) * 0.05)(H * Dh, D) * ((H * Dh) ** -0.5)),
        }
    _A_in = _A_setup()

    def _B_setup():
        B, Sq, D = 8, 144, 576
        H, Sk, Dh = 32, 512, 128
        return {
            "x": _w((lambda *s: torch.randn(*s, dtype=torch.bfloat16) * 0.8)(B, Sq, D)),
            "k_cache": _w((lambda *s: torch.randn(*s, dtype=torch.bfloat16) * 0.8)(B, H, Sk, Dh)),
            "v_cache": _w((lambda *s: torch.randn(*s, dtype=torch.bfloat16) * 0.05)(B, H, Sk, Dh)),
            "wq": _w((lambda *s: torch.randn(*s, dtype=torch.bfloat16) * 0.8)(D, H * Dh) * (D ** -0.5)),
            "wo": _w((lambda *s: torch.randn(*s, dtype=torch.bfloat16) * 0.05)(H * Dh, D) * ((H * Dh) ** -0.5)),
        }
    _B_in = _B_setup()

    return {
        "A_x": _A_in["x"],
        "A_k_cache": _A_in["k_cache"],
        "A_v_cache": _A_in["v_cache"],
        "A_wq": _A_in["wq"],
        "A_wo": _A_in["wo"],
        "B_x": _B_in["x"],
        "B_k_cache": _B_in["k_cache"],
        "B_v_cache": _B_in["v_cache"],
        "B_wq": _B_in["wq"],
        "B_wo": _B_in["wo"],
    }

def reference(A_x, A_k_cache, A_v_cache, A_wq, A_wo, B_x, B_k_cache, B_v_cache, B_wq, B_wo):
    def _A_ref(x, k_cache, v_cache, wq, wo):
        B, Sq, D = x.shape
        H, Dh = 32, 128
        q = (lambda x, *d: x.permute(*d))((x @ wq).reshape(B, Sq, H, Dh), 0, 2, 1, 3)
        scores = torch.einsum("bhqd,bhkd->bhqk", q, k_cache) * (Dh ** -0.5)
        p = _softmax(scores, axis=-1)
        o = torch.einsum("bhqk,bhkd->bhqd", p, v_cache)
        return (lambda x, *d: x.permute(*d))(o, 0, 2, 1, 3).reshape(B, Sq, H * Dh) @ wo

    def _B_ref(x, k_cache, v_cache, wq, wo):
        B, Sq, D = x.shape
        H, Dh = 32, 128
        q = (lambda x, *d: x.permute(*d))((x @ wq).reshape(B, Sq, H, Dh), 0, 2, 1, 3)
        scores = torch.einsum("bhqd,bhkd->bhqk", q, k_cache) * (Dh ** -0.5)
        p = _softmax(scores, axis=-1)
        o = torch.einsum("bhqk,bhkd->bhqd", p, v_cache)
        return (lambda x, *d: x.permute(*d))(o, 0, 2, 1, 3).reshape(B, Sq, H * Dh) @ wo

    a = _A_ref(A_x, A_k_cache, A_v_cache, A_wq, A_wo)
    b = _B_ref(B_x, B_k_cache, B_v_cache, B_wq, B_wo)
    return torch.concatenate([a, b], axis=-1)
```

```asm
; @launch grid=(256,1,1) block=(256,1,1) lds=163840
.amdgcn_target "amdgcn-amd-amdhsa--gfx950"
.text
.globl concat_heads__mha_block_cached__mha_block_cached__near_ridge_kernel
.p2align 8
.type concat_heads__mha_block_cached__mha_block_cached__near_ridge_kernel,@function
concat_heads__mha_block_cached__mha_block_cached__near_ridge_kernel:
s_cmp_ge_u32 s2, 256
s_cbranch_scc1 K_END
s_load_dwordx8 s[68:75], s[0:1], 0
s_load_dwordx8 s[76:83], s[0:1], 40
s_load_dwordx2 s[84:85], s[0:1], 32
s_load_dwordx2 s[86:87], s[0:1], 72
s_load_dwordx2 s[32:33], s[0:1], 80
s_load_dwordx2 s[36:37], s[0:1], 88
s_load_dwordx2 s[24:25], s[0:1], 96
v_and_b32 v242, 63, v0
v_lshrrev_b32 v1, 6, v0
s_and_b32 s3, s2, 7
v_readfirstlane_b32 s38, v1
s_lshr_b32 s4, s2, 3
s_lshr_b32 s48, s3, 2
s_and_b32 s49, s3, 3
s_and_b32 s47, s4, 7
s_lshr_b32 s50, s4, 3
s_lshl_b32 s5, s50, 1
s_lshl_b32 s3, s49, 3
s_add_u32 s3, s3, s5
s_add_u32 s55, s5, s47
s_cmp_ge_u32 s55, 9
s_cselect_b32 s5, 9, 0
s_sub_u32 s55, s55, s5
s_mov_b32 s46, s55
s_lshl_b32 s39, s38, 12
s_mul_i32 s51, s47, 165888
s_lshl_b32 s52, s3, 8
s_lshl_b32 s5, s47, 5
s_add_u32 s5, s5, s3
s_lshl_b32 s41, s5, 17
s_lshl_b32 s6, s48, 8
s_add_u32 s5, s5, s6
s_mul_i32 s53, s5, 36864
s_mov_b32 s10, 1327104
s_mov_b32 s11, 0x20000
s_mov_b32 s14, 33554432
s_mov_b32 s15, 0x20000
s_mov_b32 s18, 33554432
s_mov_b32 s19, 0x20000
s_mov_b32 s22, 4718592
s_mov_b32 s23, 0x20000
s_mov_b32 s26, 31473664
s_mov_b32 s27, 0x20000
s_mov_b32 s30, 4718592
s_mov_b32 s31, 0x20000
s_mov_b32 s34, 2654208
s_mov_b32 s35, 0x20000
v_and_b32 v144, 15, v242
v_lshrrev_b32 v145, 4, v242
v_and_b32 v151, 7, v242
v_lshrrev_b32 v152, 3, v242
v_lshlrev_b32 v178, 2, v145
v_xor_b32 v178, v178, v144
v_lshlrev_b32 v178, 4, v178
s_lshl_b32 s3, s38, 4
v_add_u32 v179, s3, v145
v_lshl_add_u32 v228, v179, 13, v178
v_add_u32 v229, 31744, v228
v_xor_b32 v178, 32, v228
v_add_u32 v230, 63488, v178
v_add_u32 v231, 95232, v178
s_mul_i32 s3, s38, 5
s_andn2_b32 s6, 1, s49
s_mul_i32 s6, s6, s38
s_cmp_eq_u32 s6, 3
s_cselect_b32 s3, 13, s3
s_lshl_b32 s40, s3, 10
v_mul_u32_u24 v179, 1152, v152
s_add_u32 s4, s3, 0
s_lshl_b32 s5, s4, 2
s_mul_i32 s4, s4, 9216
v_add_u32 v178, s5, v145
v_and_b32 v178, 7, v178
v_xor_b32 v178, v178, v151
v_lshlrev_b32 v178, 4, v178
s_sub_u32 s4, s4, 0
v_add3_u32 v232, v178, v179, s4
s_add_u32 s4, s3, 1
s_lshl_b32 s5, s4, 2
s_mul_i32 s4, s4, 9216
v_add_u32 v178, s5, v145
v_and_b32 v178, 7, v178
v_xor_b32 v178, v178, v151
v_lshlrev_b32 v178, 4, v178
s_sub_u32 s4, s4, 1024
v_add3_u32 v233, v178, v179, s4
s_add_u32 s4, s3, 2
s_lshl_b32 s5, s4, 2
s_mul_i32 s4, s4, 9216
v_add_u32 v178, s5, v145
v_and_b32 v178, 7, v178
v_xor_b32 v178, v178, v151
v_lshlrev_b32 v178, 4, v178
s_sub_u32 s4, s4, 2048
v_add3_u32 v234, v178, v179, s4
s_add_u32 s4, s3, 3
s_lshl_b32 s5, s4, 2
s_mul_i32 s4, s4, 9216
v_add_u32 v178, s5, v145
v_and_b32 v178, 7, v178
v_xor_b32 v178, v178, v151
v_lshlrev_b32 v178, 4, v178
s_sub_u32 s4, s4, 3072
v_add3_u32 v235, v178, v179, s4
s_add_u32 s4, s3, 4
s_lshl_b32 s5, s4, 2
s_mul_i32 s4, s4, 9216
v_add_u32 v178, s5, v145
v_and_b32 v178, 7, v178
v_xor_b32 v178, v178, v151
v_lshlrev_b32 v178, 4, v178
s_sub_u32 s4, s4, 0
v_add3_u32 v236, v178, v179, s4
s_cmp_eq_u32 s3, 15
s_cselect_b32 s4, 0x40000000, 0
v_add_u32 v235, s4, v235
v_add_u32 v236, s4, v236
s_lshl_b32 s6, s48, 3
s_add_u32 s6, s6, s47
s_lshl_b32 s3, s6, 10
s_add_u32 s3, s3, 31457280
s_lshl_b32 s5, s49, 7
s_add_u32 s62, s3, s5
s_lshl_b32 s5, s50, 7
s_add_u32 s63, s3, s5
s_add_u32 s63, s63, 512
v_mov_b32 v243, 0
v_lshlrev_b32 v237, 4, v242
s_lshl_b32 s5, s6, 2
s_add_u32 s5, s5, 64
v_mov_b32 v253, s5
s_waitcnt lgkmcnt(0)
s_cmp_eq_u32 s48, 0
s_cselect_b64 s[8:9], s[68:69], s[76:77]
s_cselect_b64 s[12:13], s[70:71], s[78:79]
s_cselect_b64 s[16:17], s[72:73], s[80:81]
s_cselect_b64 s[20:21], s[74:75], s[82:83]
s_cselect_b64 s[28:29], s[84:85], s[86:87]
s_lshl_b32 s5, s49, 2
s_add_u32 s5, s5, s50
s_lshl_b32 s5, s5, 2
s_add_u32 s5, s5, s38
s_cmp_lg_u32 s5, 3
s_cbranch_scc1 NOINIT
v_mov_b32 v10, 0
v_mov_b32 v11, 0
v_mov_b32 v12, 0
v_mov_b32 v13, 0
buffer_store_dwordx4 v[10:13], v237, s[24:27], s3 offen sc1
NOINIT:
s_andn2_b32 s6, 1, s49
s_cmp_eq_u32 s6, 1
s_cbranch_scc1 PROG1J
s_branch PROG0
PROG1J:
s_branch PROG1
K_END:
s_endpgm
CODEB:
PROG0:
s_mul_i32 s44, s46, 524288
s_add_u32 s44, s44, s52
s_lshl_b32 s45, s46, 7
s_add_u32 s45, s45, s51
s_add_u32 m0, s39, 131072
s_add_u32 s46, s46, 1
buffer_load_dwordx4 v228, s[20:23], s44 offen  lds
buffer_load_dwordx4 v229, s[20:23], s44 offen offset:1024  lds
buffer_load_dwordx4 v230, s[20:23], s44 offen offset:2048  lds
buffer_load_dwordx4 v231, s[20:23], s44 offen offset:3072  lds
s_add_u32 m0, s40, 65536
s_cmp_eq_u32 s46, 9
s_cselect_b32 s46, 0, s46
buffer_load_dwordx4 v232, s[8:11], s45 offen  lds
buffer_load_dwordx4 v233, s[8:11], s45 offen offset:1024  lds
buffer_load_dwordx4 v234, s[8:11], s45 offen offset:2048  lds
buffer_load_dwordx4 v235, s[8:11], s45 offen offset:3072  lds
s_add_u32 m0, s40, 69632
s_nop 0
buffer_load_dwordx4 v236, s[8:11], s45 offen  lds
s_mul_i32 s3, s49, 1179648
buffer_load_dword v255, v243, s[28:31], s3 offen
s_add_u32 s3, s3, 1179520
buffer_load_dword v255, v243, s[28:31], s3 offen
s_mul_i32 s3, s47, 331776
buffer_load_dword v255, v243, s[32:35], s3 offen
buffer_load_dword v255, v243, s[24:27], s53 offen
s_lshl_b32 s3, s48, 3
s_add_u32 s3, s3, s47
s_mul_i32 s3, s3, 786432
s_add_u32 s3, s3, 18874368
buffer_load_dword v255, v243, s[24:27], s3 offen
buffer_load_dword v255, v243, s[12:15], s41 offen nt
buffer_load_dword v255, v243, s[16:19], s41 offen nt
v_and_b32 v146, 31, v242
v_lshrrev_b32 v147, 5, v242
v_and_b32 v148, 3, v242
v_bfe_u32 v149, v242, 2, 2
v_and_b32 v150, 1, v145
v_lshl_add_u32 v178, v145, 3, v149
v_and_b32 v179, 1, v148
v_lshlrev_b32 v179, 3, v179
v_lshl_add_u32 v181, v178, 8, v179
v_add_u32 v181, 114688, v181
v_lshlrev_b32 v178, 2, v149
v_lshl_add_u32 v178, v150, 1, v178
v_lshrrev_b32 v179, 1, v148
v_xor_b32 v180, v178, v179
s_lshl_b32 s5, s38, 2
s_add_u32 s3, s5, 0
s_and_b32 s3, s3, 15
v_xor_b32 v178, s3, v180
v_lshl_add_u32 v210, v178, 4, v181
s_add_u32 s3, s5, 2
s_and_b32 s3, s3, 15
v_xor_b32 v178, s3, v180
v_lshl_add_u32 v211, v178, 4, v181
s_add_u32 s3, s5, 4
s_and_b32 s3, s3, 15
v_xor_b32 v178, s3, v180
v_lshl_add_u32 v212, v178, 4, v181
s_add_u32 s3, s5, 6
s_and_b32 s3, s3, 15
v_xor_b32 v178, s3, v180
v_lshl_add_u32 v213, v178, 4, v181
s_add_u32 s3, s5, 8
s_and_b32 s3, s3, 15
v_xor_b32 v178, s3, v180
v_lshl_add_u32 v214, v178, 4, v181
s_add_u32 s3, s5, 10
s_and_b32 s3, s3, 15
v_xor_b32 v178, s3, v180
v_lshl_add_u32 v215, v178, 4, v181
s_add_u32 s3, s5, 12
s_and_b32 s3, s3, 15
v_xor_b32 v178, s3, v180
v_lshl_add_u32 v216, v178, 4, v181
s_add_u32 s3, s5, 14
s_and_b32 s3, s3, 15
v_xor_b32 v178, s3, v180
v_lshl_add_u32 v217, v178, 4, v181
v_lshrrev_b32 v179, 1, v144
v_lshlrev_b32 v181, 7, v144
v_add_u32 v181, 45056, v181
v_add_u32 v178, 0, v145
v_xor_b32 v178, v178, v179
v_lshl_add_u32 v178, v178, 4, v181
v_add_u32 v218, s39, v178
v_add_u32 v220, 16384, v178
v_add_u32 v178, 4, v145
v_xor_b32 v178, v178, v179
v_lshl_add_u32 v178, v178, 4, v181
v_add_u32 v219, s39, v178
v_add_u32 v221, 16384, v178
v_add_u32 v178, 0, v145
v_xor_b32 v178, v178, v144
v_lshlrev_b32 v178, 4, v178
v_lshl_add_u32 v178, v145, 8, v178
v_add_u32 v222, s39, v178
v_add_u32 v178, 4, v145
v_xor_b32 v178, v178, v144
v_lshlrev_b32 v178, 4, v178
v_lshl_add_u32 v178, v145, 8, v178
v_add_u32 v223, s39, v178
v_add_u32 v178, 8, v145
v_xor_b32 v178, v178, v144
v_lshlrev_b32 v178, 4, v178
v_lshl_add_u32 v178, v145, 8, v178
v_add_u32 v224, s39, v178
v_add_u32 v178, 12, v145
v_xor_b32 v178, v178, v144
v_lshlrev_b32 v178, 4, v178
v_lshl_add_u32 v178, v145, 8, v178
v_add_u32 v225, s39, v178
v_lshlrev_b32 v178, 2, v145
v_xor_b32 v178, v178, v144
v_lshlrev_b32 v178, 4, v178
v_lshl_add_u32 v178, v145, 8, v178
v_add_u32 v226, s39, v178
v_xor_b32 v227, 32, v226
v_lshlrev_b32 v181, 8, v144
s_add_u32 s3, s38, 0
s_and_b32 s3, s3, 3
s_lshl_b32 s3, s3, 2
v_add_u32 v178, s3, v145
v_xor_b32 v178, v178, v144
v_lshl_add_u32 v186, v178, 4, v181
v_add_u32 v178, 0, v145
v_xor_b32 v178, v178, v144
v_lshl_add_u32 v178, v178, 4, v181
v_add_u32 v190, s39, v178
s_add_u32 s3, s38, 1
s_and_b32 s3, s3, 3
s_lshl_b32 s3, s3, 2
v_add_u32 v178, s3, v145
v_xor_b32 v178, v178, v144
v_lshl_add_u32 v187, v178, 4, v181
v_add_u32 v178, 4, v145
v_xor_b32 v178, v178, v144
v_lshl_add_u32 v178, v178, 4, v181
v_add_u32 v191, s39, v178
s_add_u32 s3, s38, 2
s_and_b32 s3, s3, 3
s_lshl_b32 s3, s3, 2
v_add_u32 v178, s3, v145
v_xor_b32 v178, v178, v144
v_lshl_add_u32 v188, v178, 4, v181
v_add_u32 v178, 8, v145
v_xor_b32 v178, v178, v144
v_lshl_add_u32 v178, v178, 4, v181
v_add_u32 v192, s39, v178
s_add_u32 s3, s38, 3
s_and_b32 s3, s3, 3
s_lshl_b32 s3, s3, 2
v_add_u32 v178, s3, v145
v_xor_b32 v178, v178, v144
v_lshl_add_u32 v189, v178, 4, v181
v_add_u32 v178, 12, v145
v_xor_b32 v178, v178, v144
v_lshl_add_u32 v178, v178, 4, v181
v_add_u32 v193, s39, v178
v_lshl_add_u32 v178, v145, 2, v149
v_and_b32 v179, 1, v148
v_lshlrev_b32 v179, 3, v179
v_lshl_add_u32 v181, v178, 8, v179
v_add_u32 v181, 65536, v181
v_lshlrev_b32 v178, 2, v149
v_lshl_add_u32 v178, v150, 1, v178
v_lshrrev_b32 v179, 1, v148
v_xor_b32 v180, v178, v179
s_lshl_b32 s5, s38, 2
s_add_u32 s3, s5, 0
s_and_b32 s3, s3, 15
v_xor_b32 v178, s3, v180
v_lshl_add_u32 v194, v178, 4, v181
s_add_u32 s3, s5, 2
s_and_b32 s3, s3, 15
v_xor_b32 v178, s3, v180
v_lshl_add_u32 v195, v178, 4, v181
s_add_u32 s3, s5, 4
s_and_b32 s3, s3, 15
v_xor_b32 v178, s3, v180
v_lshl_add_u32 v196, v178, 4, v181
s_add_u32 s3, s5, 6
s_and_b32 s3, s3, 15
v_xor_b32 v178, s3, v180
v_lshl_add_u32 v197, v178, 4, v181
s_add_u32 s3, s5, 8
s_and_b32 s3, s3, 15
v_xor_b32 v178, s3, v180
v_lshl_add_u32 v198, v178, 4, v181
s_add_u32 s3, s5, 10
s_and_b32 s3, s3, 15
v_xor_b32 v178, s3, v180
v_lshl_add_u32 v199, v178, 4, v181
s_add_u32 s3, s5, 12
s_and_b32 s3, s3, 15
v_xor_b32 v178, s3, v180
v_lshl_add_u32 v200, v178, 4, v181
s_add_u32 s3, s5, 14
s_and_b32 s3, s3, 15
v_xor_b32 v178, s3, v180
v_lshl_add_u32 v201, v178, 4, v181
s_lshl_b32 s3, s38, 2
v_add_u32 v178, s3, v145
v_and_b32 v178, 7, v178
v_xor_b32 v178, v178, v151
v_lshlrev_b32 v178, 4, v178
v_mul_u32_u24 v179, 1152, v152
s_mul_i32 s3, s38, 9216
s_add_u32 s3, s3, 147456
s_cmp_ge_u32 s38, 2
s_cselect_b32 s3, 0x40000000, s3
v_add3_u32 v207, v178, v179, s3
v_lshlrev_b32 v206, 2, v144
v_add_u32 v203, 155648, v237
s_lshr_b32 s3, s38, 1
s_lshl_b32 s3, s3, 10
s_and_b32 s5, s38, 1
s_lshl_b32 s5, s5, 3
s_add_u32 s3, s3, s5
v_add_u32 v202, s3, v203
v_lshl_add_u32 v178, v147, 4, v144
s_lshl_b32 s3, s38, 10
s_add_u32 s3, s3, 106496
v_lshl_add_u32 v239, v178, 4, s3
v_lshl_add_u32 v239, v150, 3, v239
v_lshlrev_b32 v178, 4, v144
v_add_u32 v238, 4096, v237
v_add_u32 v241, 86016, v178
s_lshl_b32 s3, s38, 2
v_add_u32 v240, s3, v241
s_mul_i32 s3, s38, 36864
s_movk_i32 s7, 3641
v_add_u32 v178, 0, v242
v_mul_u32_u24 v179, s7, v178
v_lshrrev_b32 v179, 16, v179
v_mul_u32_u24 v180, 864, v179
v_lshl_add_u32 v178, v178, 4, v180
s_sub_u32 s5, s3, 0
v_add_u32 v244, s5, v178
v_add_u32 v178, 64, v242
v_mul_u32_u24 v179, s7, v178
v_lshrrev_b32 v179, 16, v179
v_mul_u32_u24 v180, 864, v179
v_lshl_add_u32 v178, v178, 4, v180
s_sub_u32 s5, s3, 1024
v_add_u32 v245, s5, v178
v_add_u32 v178, 128, v242
v_mul_u32_u24 v179, s7, v178
v_lshrrev_b32 v179, 16, v179
v_mul_u32_u24 v180, 864, v179
v_lshl_add_u32 v178, v178, 4, v180
s_sub_u32 s5, s3, 2048
v_add_u32 v246, s5, v178
v_add_u32 v178, 192, v242
v_mul_u32_u24 v179, s7, v178
v_lshrrev_b32 v179, 16, v179
v_mul_u32_u24 v180, 864, v179
v_lshl_add_u32 v178, v178, 4, v180
s_sub_u32 s5, s3, 3072
v_add_u32 v247, s5, v178
v_add_u32 v178, 256, v242
v_mul_u32_u24 v179, s7, v178
v_lshrrev_b32 v179, 16, v179
v_mul_u32_u24 v180, 864, v179
v_lshl_add_u32 v178, v178, 4, v180
s_sub_u32 s5, s3, 0
v_add_u32 v248, s5, v178
v_add_u32 v178, 320, v242
v_mul_u32_u24 v179, s7, v178
v_lshrrev_b32 v179, 16, v179
v_mul_u32_u24 v180, 864, v179
v_lshl_add_u32 v178, v178, 4, v180
s_sub_u32 s5, s3, 1024
v_add_u32 v249, s5, v178
v_add_u32 v178, 384, v242
v_mul_u32_u24 v179, s7, v178
v_lshrrev_b32 v179, 16, v179
v_mul_u32_u24 v180, 864, v179
v_lshl_add_u32 v178, v178, 4, v180
s_sub_u32 s5, s3, 2048
v_add_u32 v250, s5, v178
v_add_u32 v178, 448, v242
v_mul_u32_u24 v179, s7, v178
v_lshrrev_b32 v179, 16, v179
v_mul_u32_u24 v180, 864, v179
v_lshl_add_u32 v178, v178, 4, v180
s_sub_u32 s5, s3, 3072
v_add_u32 v251, s5, v178
v_add_u32 v178, 512, v242
v_mul_u32_u24 v179, s7, v178
v_lshrrev_b32 v179, 16, v179
v_mul_u32_u24 v180, 864, v179
v_lshl_add_u32 v178, v178, 4, v180
s_sub_u32 s5, s3, 0
v_add_u32 v252, s5, v178
v_mov_b32 v178, 0x3f803f80
v_accvgpr_write_b32 a228, v178
v_accvgpr_write_b32 a229, v178
v_accvgpr_write_b32 a230, v178
v_accvgpr_write_b32 a231, v178
s_mul_i32 s56, s38, 9216
s_mul_i32 s61, s49, 1179648
s_mul_i32 s3, s50, 288
s_add_u32 s61, s61, s3
s_and_b32 s64, s47, 1
s_lshr_b32 s65, s50, 1
s_lshl_b32 s3, s48, 3
s_add_u32 s3, s3, s47
s_lshl_b32 s3, s3, 2
s_add_u32 s3, s3, s49
s_mul_i32 s60, s3, 294912
s_mov_b32 s4, 0x3e0293ee
s_add_u32 s42, s41, 4294950912
s_mov_b32 s43, s42
s_mul_i32 s44, s46, 524288
s_add_u32 s44, s44, s52
s_lshl_b32 s45, s46, 7
s_add_u32 s45, s45, s51
s_add_u32 m0, s39, 147456
s_add_u32 s46, s46, 1
buffer_load_dwordx4 v228, s[20:23], s44 offen  lds
buffer_load_dwordx4 v229, s[20:23], s44 offen offset:1024  lds
buffer_load_dwordx4 v230, s[20:23], s44 offen offset:2048  lds
buffer_load_dwordx4 v231, s[20:23], s44 offen offset:3072  lds
s_add_u32 m0, s40, 45056
s_cmp_eq_u32 s46, 9
s_cselect_b32 s46, 0, s46
buffer_load_dwordx4 v232, s[8:11], s45 offen  lds
buffer_load_dwordx4 v233, s[8:11], s45 offen offset:1024  lds
buffer_load_dwordx4 v234, s[8:11], s45 offen offset:2048  lds
buffer_load_dwordx4 v235, s[8:11], s45 offen offset:3072  lds
s_add_u32 m0, s40, 49152
s_nop 0
buffer_load_dwordx4 v236, s[8:11], s45 offen  lds
s_getpc_b64 s[66:67]
CODE00:
s_sub_u32 s66, s66, CODE00-CODEB
s_subb_u32 s67, s67, 0
s_lshr_b32 s3, s2, 3
s_lshl_b32 s3, s3, 2
s_add_u32 s3, s3, s38
s_mul_i32 s3, s3, 9
v_add_u32 v178, s3, v242
v_lshlrev_b32 v178, 7, v178
v_min_u32 v178, CODE1-CODEB-4, v178
s_mov_b64 exec, 0x1ff
global_load_dword v255, v178, s[66:67]
s_mov_b64 exec, -1
s_waitcnt vmcnt(17)
s_lshl_b32 s3, s49, 2
s_add_u32 s3, s3, s50
s_lshl_b32 s3, s3, 2
s_add_u32 s3, s3, s38
s_cmp_lg_u32 s3, 3
s_cbranch_scc1 NOPUB1
s_mov_b64 exec, 1
v_mov_b32 v185, 1
global_store_dword v253, v185, s[36:37] sc1
s_mov_b64 exec, -1
NOPUB1:
s_barrier
ds_read_b128 a[48:51], v218 offset:20480
ds_read_b64_tr_b16 a[180:181], v210 offset:16384
ds_read_b64_tr_b16 a[182:183], v210 offset:17408
ds_read_b128 a[52:55], v218 offset:22528
ds_read_b128 a[212:215], v220 offset:20480
ds_read_b64_tr_b16 a[184:185], v211 offset:16384
ds_read_b64_tr_b16 a[186:187], v211 offset:17408
ds_read_b64_tr_b16 a[188:189], v212 offset:16384
ds_read_b64_tr_b16 a[190:191], v212 offset:17408
ds_read_b64_tr_b16 a[192:193], v213 offset:16384
ds_read_b64_tr_b16 a[194:195], v213 offset:17408
ds_read_b64_tr_b16 a[196:197], v214 offset:16384
ds_read_b64_tr_b16 a[198:199], v214 offset:17408
ds_read_b64_tr_b16 a[200:201], v215 offset:16384
ds_read_b64_tr_b16 a[202:203], v215 offset:17408
ds_read_b64_tr_b16 a[204:205], v216 offset:16384
ds_read_b64_tr_b16 a[206:207], v216 offset:17408
s_waitcnt lgkmcnt(10)
v_mfma_f32_16x16x32_bf16 v[0:3], a[180:183], a[48:51], 0
ds_read_b64_tr_b16 a[208:209], v217 offset:16384
s_mul_i32 s44, s46, 524288
v_mfma_f32_16x16x32_bf16 v[4:7], a[180:183], a[52:55], 0
ds_read_b64_tr_b16 a[210:211], v217 offset:17408
s_add_u32 s44, s44, s52
v_mfma_f32_16x16x32_bf16 v[64:67], a[180:183], a[212:215], 0
ds_read_b128 a[56:59], v219 offset:20480
s_lshl_b32 s45, s46, 7
v_mfma_f32_16x16x32_bf16 v[8:11], a[184:187], a[48:51], 0
ds_read_b64_tr_b16 a[180:181], v210 offset:24576
s_add_u32 s45, s45, s51
v_mfma_f32_16x16x32_bf16 v[12:15], a[184:187], a[52:55], 0
ds_read_b64_tr_b16 a[182:183], v210 offset:25600
s_add_u32 m0, s39, 114688
v_mfma_f32_16x16x32_bf16 v[68:71], a[184:187], a[212:215], 0
ds_read_b128 a[60:63], v219 offset:22528
s_waitcnt lgkmcnt(12)
v_mfma_f32_16x16x32_bf16 v[16:19], a[188:191], a[48:51], 0
ds_read_b128 a[216:219], v221 offset:20480
s_add_u32 s46, s46, 1
v_mfma_f32_16x16x32_bf16 v[20:23], a[188:191], a[52:55], 0
ds_read_b64_tr_b16 a[184:185], v211 offset:24576
buffer_load_dwordx4 v228, s[20:23], s44 offen  lds
v_mfma_f32_16x16x32_bf16 v[24:27], a[192:195], a[48:51], 0
ds_read_b64_tr_b16 a[186:187], v211 offset:25600
buffer_load_dwordx4 v229, s[20:23], s44 offen offset:1024  lds
v_mfma_f32_16x16x32_bf16 v[28:31], a[192:195], a[52:55], 0
ds_read_b64_tr_b16 a[188:189], v212 offset:24576
s_waitcnt lgkmcnt(12)
v_mfma_f32_16x16x32_bf16 v[32:35], a[196:199], a[48:51], 0
ds_read_b64_tr_b16 a[190:191], v212 offset:25600
buffer_load_dwordx4 v230, s[20:23], s44 offen offset:2048  lds
v_mfma_f32_16x16x32_bf16 v[36:39], a[196:199], a[52:55], 0
ds_read_b64_tr_b16 a[192:193], v213 offset:24576
buffer_load_dwordx4 v231, s[20:23], s44 offen offset:3072  lds
v_mfma_f32_16x16x32_bf16 v[40:43], a[200:203], a[48:51], 0
ds_read_b64_tr_b16 a[194:195], v213 offset:25600
v_mfma_f32_16x16x32_bf16 v[44:47], a[200:203], a[52:55], 0
ds_read_b64_tr_b16 a[196:197], v214 offset:24576
s_waitcnt lgkmcnt(12)
v_mfma_f32_16x16x32_bf16 v[48:51], a[204:207], a[48:51], 0
ds_read_b64_tr_b16 a[198:199], v214 offset:25600
s_add_u32 m0, s40, 86016
v_mfma_f32_16x16x32_bf16 v[52:55], a[204:207], a[52:55], 0
ds_read_b64_tr_b16 a[200:201], v215 offset:24576
s_cmp_eq_u32 s46, 9
s_cselect_b32 s46, 0, s46
v_mfma_f32_16x16x32_bf16 v[56:59], a[208:211], a[48:51], 0
ds_read_b64_tr_b16 a[202:203], v215 offset:25600
buffer_load_dwordx4 v232, s[8:11], s45 offen  lds
v_mfma_f32_16x16x32_bf16 v[60:63], a[208:211], a[52:55], 0
ds_read_b64_tr_b16 a[204:205], v216 offset:24576
s_waitcnt lgkmcnt(9)
v_mfma_f32_16x16x32_bf16 v[0:3], a[180:183], a[56:59], v[0:3]
ds_read_b64_tr_b16 a[206:207], v216 offset:25600
buffer_load_dwordx4 v233, s[8:11], s45 offen offset:1024  lds
v_mfma_f32_16x16x32_bf16 v[4:7], a[180:183], a[60:63], v[4:7]
ds_read_b64_tr_b16 a[208:209], v217 offset:24576
buffer_load_dwordx4 v234, s[8:11], s45 offen offset:2048  lds
v_mfma_f32_16x16x32_bf16 v[64:67], a[180:183], a[216:219], v[64:67]
ds_read_b64_tr_b16 a[210:211], v217 offset:25600
buffer_load_dwordx4 v235, s[8:11], s45 offen offset:3072  lds
v_mfma_f32_16x16x32_bf16 v[8:11], a[184:187], a[56:59], v[8:11]
v_mfma_f32_16x16x32_bf16 v[12:15], a[184:187], a[60:63], v[12:15]
s_add_u32 m0, s40, 90112
s_nop 0
buffer_load_dwordx4 v236, s[8:11], s45 offen  lds
v_mfma_f32_16x16x32_bf16 v[68:71], a[184:187], a[216:219], v[68:71]
s_waitcnt lgkmcnt(10)
v_mfma_f32_16x16x32_bf16 v[16:19], a[188:191], a[56:59], v[16:19]
v_mfma_f32_16x16x32_bf16 v[20:23], a[188:191], a[60:63], v[20:23]
s_waitcnt vmcnt(10) lgkmcnt(0)
s_barrier
v_mfma_f32_16x16x32_bf16 v[24:27], a[192:195], a[56:59], v[24:27]
ds_read_b128 a[64:67], v218 offset:0
s_mul_i32 s44, s46, 524288
v_mfma_f32_16x16x32_bf16 v[28:31], a[192:195], a[60:63], v[28:31]
ds_read_b64_tr_b16 a[180:181], v210 offset:32768
s_add_u32 s44, s44, s52
v_mfma_f32_16x16x32_bf16 v[32:35], a[196:199], a[56:59], v[32:35]
ds_read_b64_tr_b16 a[182:183], v210 offset:33792
ds_read_b128 a[68:71], v218 offset:2048
ds_read_b128 a[220:223], v220 offset:0
ds_read_b64_tr_b16 a[184:185], v211 offset:32768
ds_read_b64_tr_b16 a[186:187], v211 offset:33792
ds_read_b64_tr_b16 a[188:189], v212 offset:32768
v_mfma_f32_16x16x32_bf16 v[36:39], a[196:199], a[60:63], v[36:39]
ds_read_b64_tr_b16 a[190:191], v212 offset:33792
s_lshl_b32 s45, s46, 7
v_mfma_f32_16x16x32_bf16 v[40:43], a[200:203], a[56:59], v[40:43]
ds_read_b64_tr_b16 a[192:193], v213 offset:32768
s_add_u32 s45, s45, s51
v_mfma_f32_16x16x32_bf16 v[44:47], a[200:203], a[60:63], v[44:47]
ds_read_b64_tr_b16 a[194:195], v213 offset:33792
v_mfma_f32_16x16x32_bf16 v[48:51], a[204:207], a[56:59], v[48:51]
ds_read_b64_tr_b16 a[196:197], v214 offset:32768
s_add_u32 m0, s39, 131072
v_mfma_f32_16x16x32_bf16 v[52:55], a[204:207], a[60:63], v[52:55]
ds_read_b64_tr_b16 a[198:199], v214 offset:33792
s_add_u32 s46, s46, 1
v_mfma_f32_16x16x32_bf16 v[56:59], a[208:211], a[56:59], v[56:59]
ds_read_b64_tr_b16 a[200:201], v215 offset:32768
buffer_load_dwordx4 v228, s[20:23], s44 offen  lds
v_mfma_f32_16x16x32_bf16 v[60:63], a[208:211], a[60:63], v[60:63]
ds_read_b64_tr_b16 a[202:203], v215 offset:33792
s_waitcnt lgkmcnt(8)
v_mfma_f32_16x16x32_bf16 v[0:3], a[180:183], a[64:67], v[0:3]
ds_read_b64_tr_b16 a[204:205], v216 offset:32768
buffer_load_dwordx4 v229, s[20:23], s44 offen offset:1024  lds
v_mfma_f32_16x16x32_bf16 v[4:7], a[180:183], a[68:71], v[4:7]
ds_read_b64_tr_b16 a[206:207], v216 offset:33792
v_mfma_f32_16x16x32_bf16 v[64:67], a[180:183], a[220:223], v[64:67]
ds_read_b64_tr_b16 a[208:209], v217 offset:32768
buffer_load_dwordx4 v230, s[20:23], s44 offen offset:2048  lds
v_mfma_f32_16x16x32_bf16 v[8:11], a[184:187], a[64:67], v[8:11]
ds_read_b64_tr_b16 a[210:211], v217 offset:33792
v_mfma_f32_16x16x32_bf16 v[12:15], a[184:187], a[68:71], v[12:15]
ds_read_b128 a[72:75], v219 offset:0
v_mfma_f32_16x16x32_bf16 v[68:71], a[184:187], a[220:223], v[68:71]
ds_read_b64_tr_b16 a[180:181], v210 offset:40960
s_waitcnt lgkmcnt(10)
v_mfma_f32_16x16x32_bf16 v[16:19], a[188:191], a[64:67], v[16:19]
ds_read_b64_tr_b16 a[182:183], v210 offset:41984
buffer_load_dwordx4 v231, s[20:23], s44 offen offset:3072  lds
v_mfma_f32_16x16x32_bf16 v[20:23], a[188:191], a[68:71], v[20:23]
ds_read_b128 a[76:79], v219 offset:2048
v_mfma_f32_16x16x32_bf16 v[24:27], a[192:195], a[64:67], v[24:27]
ds_read_b128 a[224:227], v221 offset:0
ds_read_b64_tr_b16 a[184:185], v211 offset:40960
v_mfma_f32_16x16x32_bf16 v[28:31], a[192:195], a[68:71], v[28:31]
ds_read_b64_tr_b16 a[186:187], v211 offset:41984
s_waitcnt lgkmcnt(11)
v_mfma_f32_16x16x32_bf16 v[32:35], a[196:199], a[64:67], v[32:35]
ds_read_b64_tr_b16 a[188:189], v212 offset:40960
s_add_u32 m0, s40, 65536
v_mfma_f32_16x16x32_bf16 v[36:39], a[196:199], a[68:71], v[36:39]
ds_read_b64_tr_b16 a[190:191], v212 offset:41984
s_cmp_eq_u32 s46, 9
s_cselect_b32 s46, 0, s46
v_mfma_f32_16x16x32_bf16 v[40:43], a[200:203], a[64:67], v[40:43]
ds_read_b64_tr_b16 a[192:193], v213 offset:40960
buffer_load_dwordx4 v232, s[8:11], s45 offen  lds
v_mfma_f32_16x16x32_bf16 v[44:47], a[200:203], a[68:71], v[44:47]
ds_read_b64_tr_b16 a[194:195], v213 offset:41984
s_waitcnt lgkmcnt(11)
v_mfma_f32_16x16x32_bf16 v[48:51], a[204:207], a[64:67], v[48:51]
ds_read_b64_tr_b16 a[196:197], v214 offset:40960
buffer_load_dwordx4 v233, s[8:11], s45 offen offset:1024  lds
v_mfma_f32_16x16x32_bf16 v[52:55], a[204:207], a[68:71], v[52:55]
ds_read_b64_tr_b16 a[198:199], v214 offset:41984
buffer_load_dwordx4 v234, s[8:11], s45 offen offset:2048  lds
v_mfma_f32_16x16x32_bf16 v[56:59], a[208:211], a[64:67], v[56:59]
ds_read_b64_tr_b16 a[200:201], v215 offset:40960
v_mfma_f32_16x16x32_bf16 v[60:63], a[208:211], a[68:71], v[60:63]
ds_read_b64_tr_b16 a[202:203], v215 offset:41984
s_waitcnt lgkmcnt(8)
v_mfma_f32_16x16x32_bf16 v[0:3], a[180:183], a[72:75], v[0:3]
ds_read_b64_tr_b16 a[204:205], v216 offset:40960
buffer_load_dwordx4 v235, s[8:11], s45 offen offset:3072  lds
v_mfma_f32_16x16x32_bf16 v[4:7], a[180:183], a[76:79], v[4:7]
ds_read_b64_tr_b16 a[206:207], v216 offset:41984
v_mfma_f32_16x16x32_bf16 v[64:67], a[180:183], a[224:227], v[64:67]
ds_read_b64_tr_b16 a[208:209], v217 offset:40960
v_mfma_f32_16x16x32_bf16 v[8:11], a[184:187], a[72:75], v[8:11]
ds_read_b64_tr_b16 a[210:211], v217 offset:41984
s_add_u32 m0, s40, 69632
v_mfma_f32_16x16x32_bf16 v[12:15], a[184:187], a[76:79], v[12:15]
buffer_load_dwordx4 v236, s[8:11], s45 offen  lds
v_mfma_f32_16x16x32_bf16 v[68:71], a[184:187], a[224:227], v[68:71]
s_waitcnt lgkmcnt(10)
v_mfma_f32_16x16x32_bf16 v[16:19], a[188:191], a[72:75], v[16:19]
v_mfma_f32_16x16x32_bf16 v[20:23], a[188:191], a[76:79], v[20:23]
s_waitcnt vmcnt(9) lgkmcnt(0)
s_barrier
v_mfma_f32_16x16x32_bf16 v[24:27], a[192:195], a[72:75], v[24:27]
ds_read_b128 a[80:83], v218 offset:40960
s_mul_i32 s44, s46, 524288
v_mfma_f32_16x16x32_bf16 v[28:31], a[192:195], a[76:79], v[28:31]
ds_read_b64_tr_b16 a[180:181], v210 offset:0
s_add_u32 s44, s44, s52
v_mfma_f32_16x16x32_bf16 v[32:35], a[196:199], a[72:75], v[32:35]
ds_read_b64_tr_b16 a[182:183], v210 offset:1024
ds_read_b128 a[84:87], v218 offset:43008
ds_read_b128 a[212:215], v220 offset:40960
ds_read_b64_tr_b16 a[184:185], v211 offset:0
ds_read_b64_tr_b16 a[186:187], v211 offset:1024
ds_read_b64_tr_b16 a[188:189], v212 offset:0
v_mfma_f32_16x16x32_bf16 v[36:39], a[196:199], a[76:79], v[36:39]
ds_read_b64_tr_b16 a[190:191], v212 offset:1024
s_lshl_b32 s45, s46, 7
v_mfma_f32_16x16x32_bf16 v[40:43], a[200:203], a[72:75], v[40:43]
ds_read_b64_tr_b16 a[192:193], v213 offset:0
s_add_u32 s45, s45, s51
v_mfma_f32_16x16x32_bf16 v[44:47], a[200:203], a[76:79], v[44:47]
ds_read_b64_tr_b16 a[194:195], v213 offset:1024
v_mfma_f32_16x16x32_bf16 v[48:51], a[204:207], a[72:75], v[48:51]
ds_read_b64_tr_b16 a[196:197], v214 offset:0
s_add_u32 m0, s39, 147456
v_mfma_f32_16x16x32_bf16 v[52:55], a[204:207], a[76:79], v[52:55]
ds_read_b64_tr_b16 a[198:199], v214 offset:1024
s_add_u32 s46, s46, 1
v_mfma_f32_16x16x32_bf16 v[56:59], a[208:211], a[72:75], v[56:59]
ds_read_b64_tr_b16 a[200:201], v215 offset:0
buffer_load_dwordx4 v228, s[20:23], s44 offen  lds
v_mfma_f32_16x16x32_bf16 v[60:63], a[208:211], a[76:79], v[60:63]
ds_read_b64_tr_b16 a[202:203], v215 offset:1024
s_waitcnt lgkmcnt(8)
v_mfma_f32_16x16x32_bf16 v[0:3], a[180:183], a[80:83], v[0:3]
ds_read_b64_tr_b16 a[204:205], v216 offset:0
buffer_load_dwordx4 v229, s[20:23], s44 offen offset:1024  lds
v_mfma_f32_16x16x32_bf16 v[4:7], a[180:183], a[84:87], v[4:7]
ds_read_b64_tr_b16 a[206:207], v216 offset:1024
v_mfma_f32_16x16x32_bf16 v[64:67], a[180:183], a[212:215], v[64:67]
ds_read_b64_tr_b16 a[208:209], v217 offset:0
buffer_load_dwordx4 v230, s[20:23], s44 offen offset:2048  lds
v_mfma_f32_16x16x32_bf16 v[8:11], a[184:187], a[80:83], v[8:11]
ds_read_b64_tr_b16 a[210:211], v217 offset:1024
v_mfma_f32_16x16x32_bf16 v[12:15], a[184:187], a[84:87], v[12:15]
ds_read_b128 a[88:91], v219 offset:40960
v_mfma_f32_16x16x32_bf16 v[68:71], a[184:187], a[212:215], v[68:71]
ds_read_b64_tr_b16 a[180:181], v210 offset:8192
s_waitcnt lgkmcnt(10)
v_mfma_f32_16x16x32_bf16 v[16:19], a[188:191], a[80:83], v[16:19]
ds_read_b64_tr_b16 a[182:183], v210 offset:9216
buffer_load_dwordx4 v231, s[20:23], s44 offen offset:3072  lds
v_mfma_f32_16x16x32_bf16 v[20:23], a[188:191], a[84:87], v[20:23]
ds_read_b128 a[92:95], v219 offset:43008
v_mfma_f32_16x16x32_bf16 v[24:27], a[192:195], a[80:83], v[24:27]
ds_read_b128 a[216:219], v221 offset:40960
ds_read_b64_tr_b16 a[184:185], v211 offset:8192
v_mfma_f32_16x16x32_bf16 v[28:31], a[192:195], a[84:87], v[28:31]
ds_read_b64_tr_b16 a[186:187], v211 offset:9216
s_waitcnt lgkmcnt(11)
v_mfma_f32_16x16x32_bf16 v[32:35], a[196:199], a[80:83], v[32:35]
ds_read_b64_tr_b16 a[188:189], v212 offset:8192
s_add_u32 m0, s40, 45056
v_mfma_f32_16x16x32_bf16 v[36:39], a[196:199], a[84:87], v[36:39]
ds_read_b64_tr_b16 a[190:191], v212 offset:9216
s_cmp_eq_u32 s46, 9
s_cselect_b32 s46, 0, s46
v_mfma_f32_16x16x32_bf16 v[40:43], a[200:203], a[80:83], v[40:43]
ds_read_b64_tr_b16 a[192:193], v213 offset:8192
buffer_load_dwordx4 v232, s[8:11], s45 offen  lds
v_mfma_f32_16x16x32_bf16 v[44:47], a[200:203], a[84:87], v[44:47]
ds_read_b64_tr_b16 a[194:195], v213 offset:9216
s_waitcnt lgkmcnt(11)
v_mfma_f32_16x16x32_bf16 v[48:51], a[204:207], a[80:83], v[48:51]
ds_read_b64_tr_b16 a[196:197], v214 offset:8192
buffer_load_dwordx4 v233, s[8:11], s45 offen offset:1024  lds
v_mfma_f32_16x16x32_bf16 v[52:55], a[204:207], a[84:87], v[52:55]
ds_read_b64_tr_b16 a[198:199], v214 offset:9216
buffer_load_dwordx4 v234, s[8:11], s45 offen offset:2048  lds
v_mfma_f32_16x16x32_bf16 v[56:59], a[208:211], a[80:83], v[56:59]
ds_read_b64_tr_b16 a[200:201], v215 offset:8192
v_mfma_f32_16x16x32_bf16 v[60:63], a[208:211], a[84:87], v[60:63]
ds_read_b64_tr_b16 a[202:203], v215 offset:9216
s_waitcnt lgkmcnt(8)
v_mfma_f32_16x16x32_bf16 v[0:3], a[180:183], a[88:91], v[0:3]
ds_read_b64_tr_b16 a[204:205], v216 offset:8192
buffer_load_dwordx4 v235, s[8:11], s45 offen offset:3072  lds
v_mfma_f32_16x16x32_bf16 v[4:7], a[180:183], a[92:95], v[4:7]
ds_read_b64_tr_b16 a[206:207], v216 offset:9216
v_mfma_f32_16x16x32_bf16 v[64:67], a[180:183], a[216:219], v[64:67]
ds_read_b64_tr_b16 a[208:209], v217 offset:8192
v_mfma_f32_16x16x32_bf16 v[8:11], a[184:187], a[88:91], v[8:11]
ds_read_b64_tr_b16 a[210:211], v217 offset:9216
s_add_u32 m0, s40, 49152
v_mfma_f32_16x16x32_bf16 v[12:15], a[184:187], a[92:95], v[12:15]
buffer_load_dwordx4 v236, s[8:11], s45 offen  lds
v_mfma_f32_16x16x32_bf16 v[68:71], a[184:187], a[216:219], v[68:71]
s_waitcnt lgkmcnt(10)
v_mfma_f32_16x16x32_bf16 v[16:19], a[188:191], a[88:91], v[16:19]
v_mfma_f32_16x16x32_bf16 v[20:23], a[188:191], a[92:95], v[20:23]
s_waitcnt vmcnt(9) lgkmcnt(0)
s_barrier
v_mfma_f32_16x16x32_bf16 v[24:27], a[192:195], a[88:91], v[24:27]
ds_read_b128 a[96:99], v218 offset:20480
s_mul_i32 s44, s46, 524288
v_mfma_f32_16x16x32_bf16 v[28:31], a[192:195], a[92:95], v[28:31]
ds_read_b64_tr_b16 a[180:181], v210 offset:16384
s_add_u32 s44, s44, s52
v_mfma_f32_16x16x32_bf16 v[32:35], a[196:199], a[88:91], v[32:35]
ds_read_b64_tr_b16 a[182:183], v210 offset:17408
ds_read_b128 a[100:103], v218 offset:22528
ds_read_b128 a[220:223], v220 offset:20480
ds_read_b64_tr_b16 a[184:185], v211 offset:16384
ds_read_b64_tr_b16 a[186:187], v211 offset:17408
ds_read_b64_tr_b16 a[188:189], v212 offset:16384
v_mfma_f32_16x16x32_bf16 v[36:39], a[196:199], a[92:95], v[36:39]
ds_read_b64_tr_b16 a[190:191], v212 offset:17408
s_lshl_b32 s45, s46, 7
v_mfma_f32_16x16x32_bf16 v[40:43], a[200:203], a[88:91], v[40:43]
ds_read_b64_tr_b16 a[192:193], v213 offset:16384
s_add_u32 s45, s45, s51
v_mfma_f32_16x16x32_bf16 v[44:47], a[200:203], a[92:95], v[44:47]
ds_read_b64_tr_b16 a[194:195], v213 offset:17408
v_mfma_f32_16x16x32_bf16 v[48:51], a[204:207], a[88:91], v[48:51]
ds_read_b64_tr_b16 a[196:197], v214 offset:16384
s_add_u32 m0, s39, 114688
v_mfma_f32_16x16x32_bf16 v[52:55], a[204:207], a[92:95], v[52:55]
ds_read_b64_tr_b16 a[198:199], v214 offset:17408
s_add_u32 s46, s46, 1
v_mfma_f32_16x16x32_bf16 v[56:59], a[208:211], a[88:91], v[56:59]
ds_read_b64_tr_b16 a[200:201], v215 offset:16384
buffer_load_dwordx4 v228, s[20:23], s44 offen  lds
v_mfma_f32_16x16x32_bf16 v[60:63], a[208:211], a[92:95], v[60:63]
ds_read_b64_tr_b16 a[202:203], v215 offset:17408
s_waitcnt lgkmcnt(8)
v_mfma_f32_16x16x32_bf16 v[0:3], a[180:183], a[96:99], v[0:3]
ds_read_b64_tr_b16 a[204:205], v216 offset:16384
buffer_load_dwordx4 v229, s[20:23], s44 offen offset:1024  lds
v_mfma_f32_16x16x32_bf16 v[4:7], a[180:183], a[100:103], v[4:7]
ds_read_b64_tr_b16 a[206:207], v216 offset:17408
v_mfma_f32_16x16x32_bf16 v[64:67], a[180:183], a[220:223], v[64:67]
ds_read_b64_tr_b16 a[208:209], v217 offset:16384
buffer_load_dwordx4 v230, s[20:23], s44 offen offset:2048  lds
v_mfma_f32_16x16x32_bf16 v[8:11], a[184:187], a[96:99], v[8:11]
ds_read_b64_tr_b16 a[210:211], v217 offset:17408
v_mfma_f32_16x16x32_bf16 v[12:15], a[184:187], a[100:103], v[12:15]
ds_read_b128 a[104:107], v219 offset:20480
v_mfma_f32_16x16x32_bf16 v[68:71], a[184:187], a[220:223], v[68:71]
ds_read_b64_tr_b16 a[180:181], v210 offset:24576
s_waitcnt lgkmcnt(10)
v_mfma_f32_16x16x32_bf16 v[16:19], a[188:191], a[96:99], v[16:19]
ds_read_b64_tr_b16 a[182:183], v210 offset:25600
buffer_load_dwordx4 v231, s[20:23], s44 offen offset:3072  lds
v_mfma_f32_16x16x32_bf16 v[20:23], a[188:191], a[100:103], v[20:23]
ds_read_b128 a[108:111], v219 offset:22528
v_mfma_f32_16x16x32_bf16 v[24:27], a[192:195], a[96:99], v[24:27]
ds_read_b128 a[224:227], v221 offset:20480
ds_read_b64_tr_b16 a[184:185], v211 offset:24576
v_mfma_f32_16x16x32_bf16 v[28:31], a[192:195], a[100:103], v[28:31]
ds_read_b64_tr_b16 a[186:187], v211 offset:25600
s_waitcnt lgkmcnt(11)
v_mfma_f32_16x16x32_bf16 v[32:35], a[196:199], a[96:99], v[32:35]
ds_read_b64_tr_b16 a[188:189], v212 offset:24576
s_add_u32 m0, s40, 86016
v_mfma_f32_16x16x32_bf16 v[36:39], a[196:199], a[100:103], v[36:39]
ds_read_b64_tr_b16 a[190:191], v212 offset:25600
s_cmp_eq_u32 s46, 9
s_cselect_b32 s46, 0, s46
v_mfma_f32_16x16x32_bf16 v[40:43], a[200:203], a[96:99], v[40:43]
ds_read_b64_tr_b16 a[192:193], v213 offset:24576
buffer_load_dwordx4 v232, s[8:11], s45 offen  lds
v_mfma_f32_16x16x32_bf16 v[44:47], a[200:203], a[100:103], v[44:47]
ds_read_b64_tr_b16 a[194:195], v213 offset:25600
s_waitcnt lgkmcnt(11)
v_mfma_f32_16x16x32_bf16 v[48:51], a[204:207], a[96:99], v[48:51]
ds_read_b64_tr_b16 a[196:197], v214 offset:24576
buffer_load_dwordx4 v233, s[8:11], s45 offen offset:1024  lds
v_mfma_f32_16x16x32_bf16 v[52:55], a[204:207], a[100:103], v[52:55]
ds_read_b64_tr_b16 a[198:199], v214 offset:25600
buffer_load_dwordx4 v234, s[8:11], s45 offen offset:2048  lds
v_mfma_f32_16x16x32_bf16 v[56:59], a[208:211], a[96:99], v[56:59]
ds_read_b64_tr_b16 a[200:201], v215 offset:24576
v_mfma_f32_16x16x32_bf16 v[60:63], a[208:211], a[100:103], v[60:63]
ds_read_b64_tr_b16 a[202:203], v215 offset:25600
s_waitcnt lgkmcnt(8)
v_mfma_f32_16x16x32_bf16 v[0:3], a[180:183], a[104:107], v[0:3]
ds_read_b64_tr_b16 a[204:205], v216 offset:24576
buffer_load_dwordx4 v235, s[8:11], s45 offen offset:3072  lds
v_mfma_f32_16x16x32_bf16 v[4:7], a[180:183], a[108:111], v[4:7]
ds_read_b64_tr_b16 a[206:207], v216 offset:25600
v_mfma_f32_16x16x32_bf16 v[64:67], a[180:183], a[224:227], v[64:67]
ds_read_b64_tr_b16 a[208:209], v217 offset:24576
v_mfma_f32_16x16x32_bf16 v[8:11], a[184:187], a[104:107], v[8:11]
ds_read_b64_tr_b16 a[210:211], v217 offset:25600
s_add_u32 m0, s40, 90112
v_mfma_f32_16x16x32_bf16 v[12:15], a[184:187], a[108:111], v[12:15]
buffer_load_dwordx4 v236, s[8:11], s45 offen  lds
v_mfma_f32_16x16x32_bf16 v[68:71], a[184:187], a[224:227], v[68:71]
s_waitcnt lgkmcnt(10)
v_mfma_f32_16x16x32_bf16 v[16:19], a[188:191], a[104:107], v[16:19]
v_mfma_f32_16x16x32_bf16 v[20:23], a[188:191], a[108:111], v[20:23]
s_waitcnt vmcnt(9) lgkmcnt(0)
s_barrier
v_mfma_f32_16x16x32_bf16 v[24:27], a[192:195], a[104:107], v[24:27]
ds_read_b128 a[112:115], v218 offset:0
s_mul_i32 s44, s46, 524288
v_mfma_f32_16x16x32_bf16 v[28:31], a[192:195], a[108:111], v[28:31]
ds_read_b64_tr_b16 a[180:181], v210 offset:32768
s_add_u32 s44, s44, s52
v_mfma_f32_16x16x32_bf16 v[32:35], a[196:199], a[104:107], v[32:35]
ds_read_b64_tr_b16 a[182:183], v210 offset:33792
ds_read_b128 a[116:119], v218 offset:2048
ds_read_b128 a[212:215], v220 offset:0
ds_read_b64_tr_b16 a[184:185], v211 offset:32768
ds_read_b64_tr_b16 a[186:187], v211 offset:33792
ds_read_b64_tr_b16 a[188:189], v212 offset:32768
v_mfma_f32_16x16x32_bf16 v[36:39], a[196:199], a[108:111], v[36:39]
ds_read_b64_tr_b16 a[190:191], v212 offset:33792
s_lshl_b32 s45, s46, 7
v_mfma_f32_16x16x32_bf16 v[40:43], a[200:203], a[104:107], v[40:43]
ds_read_b64_tr_b16 a[192:193], v213 offset:32768
s_add_u32 s45, s45, s51
v_mfma_f32_16x16x32_bf16 v[44:47], a[200:203], a[108:111], v[44:47]
ds_read_b64_tr_b16 a[194:195], v213 offset:33792
v_mfma_f32_16x16x32_bf16 v[48:51], a[204:207], a[104:107], v[48:51]
ds_read_b64_tr_b16 a[196:197], v214 offset:32768
s_add_u32 m0, s39, 131072
v_mfma_f32_16x16x32_bf16 v[52:55], a[204:207], a[108:111], v[52:55]
ds_read_b64_tr_b16 a[198:199], v214 offset:33792
s_add_u32 s46, s46, 1
v_mfma_f32_16x16x32_bf16 v[56:59], a[208:211], a[104:107], v[56:59]
ds_read_b64_tr_b16 a[200:201], v215 offset:32768
buffer_load_dwordx4 v228, s[20:23], s44 offen  lds
v_mfma_f32_16x16x32_bf16 v[60:63], a[208:211], a[108:111], v[60:63]
ds_read_b64_tr_b16 a[202:203], v215 offset:33792
s_waitcnt lgkmcnt(8)
v_mfma_f32_16x16x32_bf16 v[0:3], a[180:183], a[112:115], v[0:3]
ds_read_b64_tr_b16 a[204:205], v216 offset:32768
buffer_load_dwordx4 v229, s[20:23], s44 offen offset:1024  lds
v_mfma_f32_16x16x32_bf16 v[4:7], a[180:183], a[116:119], v[4:7]
ds_read_b64_tr_b16 a[206:207], v216 offset:33792
v_mfma_f32_16x16x32_bf16 v[64:67], a[180:183], a[212:215], v[64:67]
ds_read_b64_tr_b16 a[208:209], v217 offset:32768
buffer_load_dwordx4 v230, s[20:23], s44 offen offset:2048  lds
v_mfma_f32_16x16x32_bf16 v[8:11], a[184:187], a[112:115], v[8:11]
ds_read_b64_tr_b16 a[210:211], v217 offset:33792
v_mfma_f32_16x16x32_bf16 v[12:15], a[184:187], a[116:119], v[12:15]
ds_read_b128 a[120:123], v219 offset:0
v_mfma_f32_16x16x32_bf16 v[68:71], a[184:187], a[212:215], v[68:71]
ds_read_b64_tr_b16 a[180:181], v210 offset:40960
s_waitcnt lgkmcnt(10)
v_mfma_f32_16x16x32_bf16 v[16:19], a[188:191], a[112:115], v[16:19]
ds_read_b64_tr_b16 a[182:183], v210 offset:41984
buffer_load_dwordx4 v231, s[20:23], s44 offen offset:3072  lds
v_mfma_f32_16x16x32_bf16 v[20:23], a[188:191], a[116:119], v[20:23]
ds_read_b128 a[124:127], v219 offset:2048
v_mfma_f32_16x16x32_bf16 v[24:27], a[192:195], a[112:115], v[24:27]
ds_read_b128 a[216:219], v221 offset:0
ds_read_b64_tr_b16 a[184:185], v211 offset:40960
v_mfma_f32_16x16x32_bf16 v[28:31], a[192:195], a[116:119], v[28:31]
ds_read_b64_tr_b16 a[186:187], v211 offset:41984
s_waitcnt lgkmcnt(11)
v_mfma_f32_16x16x32_bf16 v[32:35], a[196:199], a[112:115], v[32:35]
ds_read_b64_tr_b16 a[188:189], v212 offset:40960
s_add_u32 m0, s40, 65536
v_mfma_f32_16x16x32_bf16 v[36:39], a[196:199], a[116:119], v[36:39]
ds_read_b64_tr_b16 a[190:191], v212 offset:41984
s_cmp_eq_u32 s46, 9
s_cselect_b32 s46, 0, s46
v_mfma_f32_16x16x32_bf16 v[40:43], a[200:203], a[112:115], v[40:43]
ds_read_b64_tr_b16 a[192:193], v213 offset:40960
buffer_load_dwordx4 v232, s[8:11], s45 offen  lds
v_mfma_f32_16x16x32_bf16 v[44:47], a[200:203], a[116:119], v[44:47]
ds_read_b64_tr_b16 a[194:195], v213 offset:41984
s_waitcnt lgkmcnt(11)
v_mfma_f32_16x16x32_bf16 v[48:51], a[204:207], a[112:115], v[48:51]
ds_read_b64_tr_b16 a[196:197], v214 offset:40960
buffer_load_dwordx4 v233, s[8:11], s45 offen offset:1024  lds
v_mfma_f32_16x16x32_bf16 v[52:55], a[204:207], a[116:119], v[52:55]
ds_read_b64_tr_b16 a[198:199], v214 offset:41984
buffer_load_dwordx4 v234, s[8:11], s45 offen offset:2048  lds
v_mfma_f32_16x16x32_bf16 v[56:59], a[208:211], a[112:115], v[56:59]
ds_read_b64_tr_b16 a[200:201], v215 offset:40960
v_mfma_f32_16x16x32_bf16 v[60:63], a[208:211], a[116:119], v[60:63]
ds_read_b64_tr_b16 a[202:203], v215 offset:41984
s_waitcnt lgkmcnt(8)
v_mfma_f32_16x16x32_bf16 v[0:3], a[180:183], a[120:123], v[0:3]
ds_read_b64_tr_b16 a[204:205], v216 offset:40960
buffer_load_dwordx4 v235, s[8:11], s45 offen offset:3072  lds
v_mfma_f32_16x16x32_bf16 v[4:7], a[180:183], a[124:127], v[4:7]
ds_read_b64_tr_b16 a[206:207], v216 offset:41984
v_mfma_f32_16x16x32_bf16 v[64:67], a[180:183], a[216:219], v[64:67]
ds_read_b64_tr_b16 a[208:209], v217 offset:40960
v_mfma_f32_16x16x32_bf16 v[8:11], a[184:187], a[120:123], v[8:11]
ds_read_b64_tr_b16 a[210:211], v217 offset:41984
s_add_u32 m0, s40, 69632
v_mfma_f32_16x16x32_bf16 v[12:15], a[184:187], a[124:127], v[12:15]
buffer_load_dwordx4 v236, s[8:11], s45 offen  lds
v_mfma_f32_16x16x32_bf16 v[68:71], a[184:187], a[216:219], v[68:71]
s_waitcnt lgkmcnt(10)
v_mfma_f32_16x16x32_bf16 v[16:19], a[188:191], a[120:123], v[16:19]
v_mfma_f32_16x16x32_bf16 v[20:23], a[188:191], a[124:127], v[20:23]
s_waitcnt vmcnt(9) lgkmcnt(0)
s_barrier
v_mfma_f32_16x16x32_bf16 v[24:27], a[192:195], a[120:123], v[24:27]
ds_read_b128 a[128:131], v218 offset:40960
s_mul_i32 s44, s46, 524288
v_mfma_f32_16x16x32_bf16 v[28:31], a[192:195], a[124:127], v[28:31]
ds_read_b64_tr_b16 a[180:181], v210 offset:0
s_add_u32 s44, s44, s52
v_mfma_f32_16x16x32_bf16 v[32:35], a[196:199], a[120:123], v[32:35]
ds_read_b64_tr_b16 a[182:183], v210 offset:1024
ds_read_b128 a[132:135], v218 offset:43008
ds_read_b128 a[220:223], v220 offset:40960
ds_read_b64_tr_b16 a[184:185], v211 offset:0
ds_read_b64_tr_b16 a[186:187], v211 offset:1024
ds_read_b64_tr_b16 a[188:189], v212 offset:0
v_mfma_f32_16x16x32_bf16 v[36:39], a[196:199], a[124:127], v[36:39]
ds_read_b64_tr_b16 a[190:191], v212 offset:1024
s_lshl_b32 s45, s46, 7
v_mfma_f32_16x16x32_bf16 v[40:43], a[200:203], a[120:123], v[40:43]
ds_read_b64_tr_b16 a[192:193], v213 offset:0
s_add_u32 s45, s45, s51
v_mfma_f32_16x16x32_bf16 v[44:47], a[200:203], a[124:127], v[44:47]
ds_read_b64_tr_b16 a[194:195], v213 offset:1024
v_mfma_f32_16x16x32_bf16 v[48:51], a[204:207], a[120:123], v[48:51]
ds_read_b64_tr_b16 a[196:197], v214 offset:0
s_add_u32 m0, s39, 147456
v_mfma_f32_16x16x32_bf16 v[52:55], a[204:207], a[124:127], v[52:55]
ds_read_b64_tr_b16 a[198:199], v214 offset:1024
s_add_u32 s46, s46, 1
v_mfma_f32_16x16x32_bf16 v[56:59], a[208:211], a[120:123], v[56:59]
ds_read_b64_tr_b16 a[200:201], v215 offset:0
buffer_load_dwordx4 v228, s[20:23], s44 offen  lds
v_mfma_f32_16x16x32_bf16 v[60:63], a[208:211], a[124:127], v[60:63]
ds_read_b64_tr_b16 a[202:203], v215 offset:1024
s_waitcnt lgkmcnt(8)
v_mfma_f32_16x16x32_bf16 v[0:3], a[180:183], a[128:131], v[0:3]
ds_read_b64_tr_b16 a[204:205], v216 offset:0
buffer_load_dwordx4 v229, s[20:23], s44 offen offset:1024  lds
v_mfma_f32_16x16x32_bf16 v[4:7], a[180:183], a[132:135], v[4:7]
ds_read_b64_tr_b16 a[206:207], v216 offset:1024
v_mfma_f32_16x16x32_bf16 v[64:67], a[180:183], a[220:223], v[64:67]
ds_read_b64_tr_b16 a[208:209], v217 offset:0
buffer_load_dwordx4 v230, s[20:23], s44 offen offset:2048  lds
v_mfma_f32_16x16x32_bf16 v[8:11], a[184:187], a[128:131], v[8:11]
ds_read_b64_tr_b16 a[210:211], v217 offset:1024
v_mfma_f32_16x16x32_bf16 v[12:15], a[184:187], a[132:135], v[12:15]
ds_read_b128 a[136:139], v219 offset:40960
v_mfma_f32_16x16x32_bf16 v[68:71], a[184:187], a[220:223], v[68:71]
ds_read_b64_tr_b16 a[180:181], v210 offset:8192
s_waitcnt lgkmcnt(10)
v_mfma_f32_16x16x32_bf16 v[16:19], a[188:191], a[128:131], v[16:19]
ds_read_b64_tr_b16 a[182:183], v210 offset:9216
buffer_load_dwordx4 v231, s[20:23], s44 offen offset:3072  lds
v_mfma_f32_16x16x32_bf16 v[20:23], a[188:191], a[132:135], v[20:23]
ds_read_b128 a[140:143], v219 offset:43008
v_mfma_f32_16x16x32_bf16 v[24:27], a[192:195], a[128:131], v[24:27]
ds_read_b128 a[224:227], v221 offset:40960
ds_read_b64_tr_b16 a[184:185], v211 offset:8192
v_mfma_f32_16x16x32_bf16 v[28:31], a[192:195], a[132:135], v[28:31]
ds_read_b64_tr_b16 a[186:187], v211 offset:9216
s_waitcnt lgkmcnt(11)
v_mfma_f32_16x16x32_bf16 v[32:35], a[196:199], a[128:131], v[32:35]
ds_read_b64_tr_b16 a[188:189], v212 offset:8192
s_add_u32 m0, s40, 45056
v_mfma_f32_16x16x32_bf16 v[36:39], a[196:199], a[132:135], v[36:39]
ds_read_b64_tr_b16 a[190:191], v212 offset:9216
s_cmp_eq_u32 s46, 9
s_cselect_b32 s46, 0, s46
v_mfma_f32_16x16x32_bf16 v[40:43], a[200:203], a[128:131], v[40:43]
ds_read_b64_tr_b16 a[192:193], v213 offset:8192
buffer_load_dwordx4 v232, s[8:11], s45 offen  lds
v_mfma_f32_16x16x32_bf16 v[44:47], a[200:203], a[132:135], v[44:47]
ds_read_b64_tr_b16 a[194:195], v213 offset:9216
s_waitcnt lgkmcnt(11)
v_mfma_f32_16x16x32_bf16 v[48:51], a[204:207], a[128:131], v[48:51]
ds_read_b64_tr_b16 a[196:197], v214 offset:8192
buffer_load_dwordx4 v233, s[8:11], s45 offen offset:1024  lds
v_mfma_f32_16x16x32_bf16 v[52:55], a[204:207], a[132:135], v[52:55]
ds_read_b64_tr_b16 a[198:199], v214 offset:9216
buffer_load_dwordx4 v234, s[8:11], s45 offen offset:2048  lds
v_mfma_f32_16x16x32_bf16 v[56:59], a[208:211], a[128:131], v[56:59]
ds_read_b64_tr_b16 a[200:201], v215 offset:8192
v_mfma_f32_16x16x32_bf16 v[60:63], a[208:211], a[132:135], v[60:63]
ds_read_b64_tr_b16 a[202:203], v215 offset:9216
s_waitcnt lgkmcnt(8)
v_mfma_f32_16x16x32_bf16 v[0:3], a[180:183], a[136:139], v[0:3]
ds_read_b64_tr_b16 a[204:205], v216 offset:8192
buffer_load_dwordx4 v235, s[8:11], s45 offen offset:3072  lds
v_mfma_f32_16x16x32_bf16 v[4:7], a[180:183], a[140:143], v[4:7]
ds_read_b64_tr_b16 a[206:207], v216 offset:9216
v_mfma_f32_16x16x32_bf16 v[64:67], a[180:183], a[224:227], v[64:67]
ds_read_b64_tr_b16 a[208:209], v217 offset:8192
v_mfma_f32_16x16x32_bf16 v[8:11], a[184:187], a[136:139], v[8:11]
ds_read_b64_tr_b16 a[210:211], v217 offset:9216
s_add_u32 m0, s40, 49152
v_mfma_f32_16x16x32_bf16 v[12:15], a[184:187], a[140:143], v[12:15]
buffer_load_dwordx4 v236, s[8:11], s45 offen  lds
v_mfma_f32_16x16x32_bf16 v[68:71], a[184:187], a[224:227], v[68:71]
s_waitcnt lgkmcnt(10)
v_mfma_f32_16x16x32_bf16 v[16:19], a[188:191], a[136:139], v[16:19]
v_mfma_f32_16x16x32_bf16 v[20:23], a[188:191], a[140:143], v[20:23]
s_waitcnt vmcnt(9) lgkmcnt(0)
s_barrier
v_mfma_f32_16x16x32_bf16 v[24:27], a[192:195], a[136:139], v[24:27]
ds_read_b128 a[144:147], v218 offset:20480
s_mul_i32 s44, s46, 524288
v_mfma_f32_16x16x32_bf16 v[28:31], a[192:195], a[140:143], v[28:31]
ds_read_b64_tr_b16 a[180:181], v210 offset:16384
s_add_u32 s44, s44, s52
v_mfma_f32_16x16x32_bf16 v[32:35], a[196:199], a[136:139], v[32:35]
ds_read_b64_tr_b16 a[182:183], v210 offset:17408
ds_read_b128 a[148:151], v218 offset:22528
ds_read_b128 a[212:215], v220 offset:20480
ds_read_b64_tr_b16 a[184:185], v211 offset:16384
ds_read_b64_tr_b16 a[186:187], v211 offset:17408
ds_read_b64_tr_b16 a[188:189], v212 offset:16384
v_mfma_f32_16x16x32_bf16 v[36:39], a[196:199], a[140:143], v[36:39]
ds_read_b64_tr_b16 a[190:191], v212 offset:17408
s_lshl_b32 s45, s46, 7
v_mfma_f32_16x16x32_bf16 v[40:43], a[200:203], a[136:139], v[40:43]
ds_read_b64_tr_b16 a[192:193], v213 offset:16384
s_add_u32 s45, s45, s51
v_mfma_f32_16x16x32_bf16 v[44:47], a[200:203], a[140:143], v[44:47]
ds_read_b64_tr_b16 a[194:195], v213 offset:17408
v_mfma_f32_16x16x32_bf16 v[48:51], a[204:207], a[136:139], v[48:51]
ds_read_b64_tr_b16 a[196:197], v214 offset:16384
s_add_u32 m0, s39, 114688
v_mfma_f32_16x16x32_bf16 v[52:55], a[204:207], a[140:143], v[52:55]
ds_read_b64_tr_b16 a[198:199], v214 offset:17408
s_add_u32 s46, s46, 1
v_mfma_f32_16x16x32_bf16 v[56:59], a[208:211], a[136:139], v[56:59]
ds_read_b64_tr_b16 a[200:201], v215 offset:16384
buffer_load_dwordx4 v228, s[20:23], s44 offen  lds
v_mfma_f32_16x16x32_bf16 v[60:63], a[208:211], a[140:143], v[60:63]
ds_read_b64_tr_b16 a[202:203], v215 offset:17408
s_waitcnt lgkmcnt(8)
v_mfma_f32_16x16x32_bf16 v[0:3], a[180:183], a[144:147], v[0:3]
ds_read_b64_tr_b16 a[204:205], v216 offset:16384
buffer_load_dwordx4 v229, s[20:23], s44 offen offset:1024  lds
v_mfma_f32_16x16x32_bf16 v[4:7], a[180:183], a[148:151], v[4:7]
ds_read_b64_tr_b16 a[206:207], v216 offset:17408
v_mfma_f32_16x16x32_bf16 v[64:67], a[180:183], a[212:215], v[64:67]
ds_read_b64_tr_b16 a[208:209], v217 offset:16384
buffer_load_dwordx4 v230, s[20:23], s44 offen offset:2048  lds
v_mfma_f32_16x16x32_bf16 v[8:11], a[184:187], a[144:147], v[8:11]
ds_read_b64_tr_b16 a[210:211], v217 offset:17408
v_mfma_f32_16x16x32_bf16 v[12:15], a[184:187], a[148:151], v[12:15]
ds_read_b128 a[152:155], v219 offset:20480
v_mfma_f32_16x16x32_bf16 v[68:71], a[184:187], a[212:215], v[68:71]
ds_read_b64_tr_b16 a[180:181], v210 offset:24576
s_waitcnt lgkmcnt(10)
v_mfma_f32_16x16x32_bf16 v[16:19], a[188:191], a[144:147], v[16:19]
ds_read_b64_tr_b16 a[182:183], v210 offset:25600
buffer_load_dwordx4 v231, s[20:23], s44 offen offset:3072  lds
v_mfma_f32_16x16x32_bf16 v[20:23], a[188:191], a[148:151], v[20:23]
ds_read_b128 a[156:159], v219 offset:22528
v_mfma_f32_16x16x32_bf16 v[24:27], a[192:195], a[144:147], v[24:27]
ds_read_b128 a[216:219], v221 offset:20480
ds_read_b64_tr_b16 a[184:185], v211 offset:24576
v_mfma_f32_16x16x32_bf16 v[28:31], a[192:195], a[148:151], v[28:31]
ds_read_b64_tr_b16 a[186:187], v211 offset:25600
s_waitcnt lgkmcnt(11)
v_mfma_f32_16x16x32_bf16 v[32:35], a[196:199], a[144:147], v[32:35]
ds_read_b64_tr_b16 a[188:189], v212 offset:24576
s_add_u32 m0, s40, 86016
v_mfma_f32_16x16x32_bf16 v[36:39], a[196:199], a[148:151], v[36:39]
ds_read_b64_tr_b16 a[190:191], v212 offset:25600
s_cmp_eq_u32 s46, 9
s_cselect_b32 s46, 0, s46
v_mfma_f32_16x16x32_bf16 v[40:43], a[200:203], a[144:147], v[40:43]
ds_read_b64_tr_b16 a[192:193], v213 offset:24576
buffer_load_dwordx4 v232, s[8:11], s45 offen  lds
v_mfma_f32_16x16x32_bf16 v[44:47], a[200:203], a[148:151], v[44:47]
ds_read_b64_tr_b16 a[194:195], v213 offset:25600
s_waitcnt lgkmcnt(11)
v_mfma_f32_16x16x32_bf16 v[48:51], a[204:207], a[144:147], v[48:51]
ds_read_b64_tr_b16 a[196:197], v214 offset:24576
buffer_load_dwordx4 v233, s[8:11], s45 offen offset:1024  lds
v_mfma_f32_16x16x32_bf16 v[52:55], a[204:207], a[148:151], v[52:55]
ds_read_b64_tr_b16 a[198:199], v214 offset:25600
buffer_load_dwordx4 v234, s[8:11], s45 offen offset:2048  lds
v_mfma_f32_16x16x32_bf16 v[56:59], a[208:211], a[144:147], v[56:59]
ds_read_b64_tr_b16 a[200:201], v215 offset:24576
v_mfma_f32_16x16x32_bf16 v[60:63], a[208:211], a[148:151], v[60:63]
ds_read_b64_tr_b16 a[202:203], v215 offset:25600
s_waitcnt lgkmcnt(8)
v_mfma_f32_16x16x32_bf16 v[0:3], a[180:183], a[152:155], v[0:3]
ds_read_b64_tr_b16 a[204:205], v216 offset:24576
buffer_load_dwordx4 v235, s[8:11], s45 offen offset:3072  lds
v_mfma_f32_16x16x32_bf16 v[4:7], a[180:183], a[156:159], v[4:7]
ds_read_b64_tr_b16 a[206:207], v216 offset:25600
v_mfma_f32_16x16x32_bf16 v[64:67], a[180:183], a[216:219], v[64:67]
ds_read_b64_tr_b16 a[208:209], v217 offset:24576
v_mfma_f32_16x16x32_bf16 v[8:11], a[184:187], a[152:155], v[8:11]
ds_read_b64_tr_b16 a[210:211], v217 offset:25600
s_add_u32 m0, s40, 90112
v_mfma_f32_16x16x32_bf16 v[12:15], a[184:187], a[156:159], v[12:15]
buffer_load_dwordx4 v236, s[8:11], s45 offen  lds
v_mfma_f32_16x16x32_bf16 v[68:71], a[184:187], a[216:219], v[68:71]
s_waitcnt lgkmcnt(10)
v_mfma_f32_16x16x32_bf16 v[16:19], a[188:191], a[152:155], v[16:19]
v_mfma_f32_16x16x32_bf16 v[20:23], a[188:191], a[156:159], v[20:23]
s_waitcnt vmcnt(9) lgkmcnt(0)
s_barrier
v_mfma_f32_16x16x32_bf16 v[24:27], a[192:195], a[152:155], v[24:27]
ds_read_b128 a[160:163], v218 offset:0
s_add_u32 s52, s52, 256
v_mfma_f32_16x16x32_bf16 v[28:31], a[192:195], a[156:159], v[28:31]
ds_read_b64_tr_b16 a[180:181], v210 offset:32768
v_mfma_f32_16x16x32_bf16 v[32:35], a[196:199], a[152:155], v[32:35]
ds_read_b64_tr_b16 a[182:183], v210 offset:33792
ds_read_b128 a[164:167], v218 offset:2048
ds_read_b128 a[220:223], v220 offset:0
ds_read_b64_tr_b16 a[184:185], v211 offset:32768
ds_read_b64_tr_b16 a[186:187], v211 offset:33792
ds_read_b64_tr_b16 a[188:189], v212 offset:32768
v_mfma_f32_16x16x32_bf16 v[36:39], a[196:199], a[156:159], v[36:39]
ds_read_b64_tr_b16 a[190:191], v212 offset:33792
v_mfma_f32_16x16x32_bf16 v[40:43], a[200:203], a[152:155], v[40:43]
ds_read_b64_tr_b16 a[192:193], v213 offset:32768
v_mfma_f32_16x16x32_bf16 v[44:47], a[200:203], a[156:159], v[44:47]
ds_read_b64_tr_b16 a[194:195], v213 offset:33792
v_mfma_f32_16x16x32_bf16 v[48:51], a[204:207], a[152:155], v[48:51]
ds_read_b64_tr_b16 a[196:197], v214 offset:32768
v_mfma_f32_16x16x32_bf16 v[52:55], a[204:207], a[156:159], v[52:55]
ds_read_b64_tr_b16 a[198:199], v214 offset:33792
s_add_u32 m0, s39, 0
v_mfma_f32_16x16x32_bf16 v[56:59], a[208:211], a[152:155], v[56:59]
ds_read_b64_tr_b16 a[200:201], v215 offset:32768
s_add_u32 s42, s42, 16384
v_mfma_f32_16x16x32_bf16 v[60:63], a[208:211], a[156:159], v[60:63]
ds_read_b64_tr_b16 a[202:203], v215 offset:33792
s_waitcnt lgkmcnt(8)
v_mfma_f32_16x16x32_bf16 v[0:3], a[180:183], a[160:163], v[0:3]
ds_read_b64_tr_b16 a[204:205], v216 offset:32768
buffer_load_dwordx4 v222, s[12:15], s42 offen nt lds
v_mfma_f32_16x16x32_bf16 v[4:7], a[180:183], a[164:167], v[4:7]
ds_read_b64_tr_b16 a[206:207], v216 offset:33792
v_mfma_f32_16x16x32_bf16 v[64:67], a[180:183], a[220:223], v[64:67]
ds_read_b64_tr_b16 a[208:209], v217 offset:32768
v_mfma_f32_16x16x32_bf16 v[8:11], a[184:187], a[160:163], v[8:11]
ds_read_b64_tr_b16 a[210:211], v217 offset:33792
v_mfma_f32_16x16x32_bf16 v[12:15], a[184:187], a[164:167], v[12:15]
ds_read_b128 a[168:171], v219 offset:0
buffer_load_dwordx4 v223, s[12:15], s42 offen offset:1024 nt lds
v_mfma_f32_16x16x32_bf16 v[68:71], a[184:187], a[220:223], v[68:71]
ds_read_b64_tr_b16 a[180:181], v210 offset:40960
s_waitcnt lgkmcnt(10)
v_mfma_f32_16x16x32_bf16 v[16:19], a[188:191], a[160:163], v[16:19]
ds_read_b64_tr_b16 a[182:183], v210 offset:41984
v_mfma_f32_16x16x32_bf16 v[20:23], a[188:191], a[164:167], v[20:23]
ds_read_b128 a[172:175], v219 offset:2048
v_mfma_f32_16x16x32_bf16 v[24:27], a[192:195], a[160:163], v[24:27]
ds_read_b128 a[224:227], v221 offset:0
ds_read_b64_tr_b16 a[184:185], v211 offset:40960
v_mfma_f32_16x16x32_bf16 v[28:31], a[192:195], a[164:167], v[28:31]
ds_read_b64_tr_b16 a[186:187], v211 offset:41984
s_waitcnt lgkmcnt(11)
v_mfma_f32_16x16x32_bf16 v[32:35], a[196:199], a[160:163], v[32:35]
ds_read_b64_tr_b16 a[188:189], v212 offset:40960
v_mfma_f32_16x16x32_bf16 v[36:39], a[196:199], a[164:167], v[36:39]
ds_read_b64_tr_b16 a[190:191], v212 offset:41984
buffer_load_dwordx4 v224, s[12:15], s42 offen offset:2048 nt lds
v_mfma_f32_16x16x32_bf16 v[40:43], a[200:203], a[160:163], v[40:43]
ds_read_b64_tr_b16 a[192:193], v213 offset:40960
v_mfma_f32_16x16x32_bf16 v[44:47], a[200:203], a[164:167], v[44:47]
ds_read_b64_tr_b16 a[194:195], v213 offset:41984
s_waitcnt lgkmcnt(11)
v_mfma_f32_16x16x32_bf16 v[48:51], a[204:207], a[160:163], v[48:51]
ds_read_b64_tr_b16 a[196:197], v214 offset:40960
v_mfma_f32_16x16x32_bf16 v[52:55], a[204:207], a[164:167], v[52:55]
ds_read_b64_tr_b16 a[198:199], v214 offset:41984
v_mfma_f32_16x16x32_bf16 v[56:59], a[208:211], a[160:163], v[56:59]
ds_read_b64_tr_b16 a[200:201], v215 offset:40960
v_mfma_f32_16x16x32_bf16 v[60:63], a[208:211], a[164:167], v[60:63]
ds_read_b64_tr_b16 a[202:203], v215 offset:41984
s_waitcnt lgkmcnt(8)
v_mfma_f32_16x16x32_bf16 v[0:3], a[180:183], a[168:171], v[0:3]
ds_read_b64_tr_b16 a[204:205], v216 offset:40960
buffer_load_dwordx4 v225, s[12:15], s42 offen offset:3072 nt lds
v_mfma_f32_16x16x32_bf16 v[4:7], a[180:183], a[172:175], v[4:7]
ds_read_b64_tr_b16 a[206:207], v216 offset:41984
v_mfma_f32_16x16x32_bf16 v[64:67], a[180:183], a[224:227], v[64:67]
ds_read_b64_tr_b16 a[208:209], v217 offset:40960
v_mfma_f32_16x16x32_bf16 v[8:11], a[184:187], a[168:171], v[8:11]
ds_read_b64_tr_b16 a[210:211], v217 offset:41984
v_mfma_f32_16x16x32_bf16 v[12:15], a[184:187], a[172:175], v[12:15]
v_mfma_f32_16x16x32_bf16 v[68:71], a[184:187], a[224:227], v[68:71]
s_waitcnt lgkmcnt(10)
v_mfma_f32_16x16x32_bf16 v[16:19], a[188:191], a[168:171], v[16:19]
v_mfma_f32_16x16x32_bf16 v[20:23], a[188:191], a[172:175], v[20:23]
s_waitcnt vmcnt(4) lgkmcnt(0)
s_barrier
v_mfma_f32_16x16x32_bf16 v[24:27], a[192:195], a[168:171], v[24:27]
ds_read_b128 a[176:179], v218 offset:40960
s_add_u32 m0, s39, 16384
v_mfma_f32_16x16x32_bf16 v[28:31], a[192:195], a[172:175], v[28:31]
ds_read_b64_tr_b16 a[180:181], v210 offset:0
s_add_u32 s42, s42, 16384
v_mfma_f32_16x16x32_bf16 v[32:35], a[196:199], a[168:171], v[32:35]
ds_read_b64_tr_b16 a[182:183], v210 offset:1024
ds_read_b128 a[240:243], v218 offset:43008
ds_read_b128 a[212:215], v220 offset:40960
ds_read_b128 a[244:247], v219 offset:40960
ds_read_b64_tr_b16 a[184:185], v210 offset:8192
ds_read_b64_tr_b16 a[186:187], v210 offset:9216
ds_read_b128 a[248:251], v219 offset:43008
v_mfma_f32_16x16x32_bf16 v[36:39], a[196:199], a[172:175], v[36:39]
ds_read_b128 a[216:219], v221 offset:40960
ds_read_b64_tr_b16 a[188:189], v211 offset:0
ds_read_b64_tr_b16 a[190:191], v211 offset:1024
v_mfma_f32_16x16x32_bf16 v[40:43], a[200:203], a[168:171], v[40:43]
ds_read_b64_tr_b16 a[192:193], v211 offset:8192
buffer_load_dwordx4 v222, s[12:15], s42 offen nt lds
v_mfma_f32_16x16x32_bf16 v[44:47], a[200:203], a[172:175], v[44:47]
ds_read_b64_tr_b16 a[194:195], v211 offset:9216
buffer_load_dwordx4 v223, s[12:15], s42 offen offset:1024 nt lds
v_mfma_f32_16x16x32_bf16 v[48:51], a[204:207], a[168:171], v[48:51]
ds_read_b64_tr_b16 a[196:197], v212 offset:0
v_mfma_f32_16x16x32_bf16 v[52:55], a[204:207], a[172:175], v[52:55]
ds_read_b64_tr_b16 a[198:199], v212 offset:1024
v_mfma_f32_16x16x32_bf16 v[56:59], a[208:211], a[168:171], v[56:59]
ds_read_b64_tr_b16 a[200:201], v212 offset:8192
v_mfma_f32_16x16x32_bf16 v[60:63], a[208:211], a[172:175], v[60:63]
ds_read_b64_tr_b16 a[202:203], v212 offset:9216
s_waitcnt lgkmcnt(10)
v_mfma_f32_16x16x32_bf16 v[0:3], a[180:183], a[176:179], v[0:3]
ds_read_b64_tr_b16 a[204:205], v213 offset:0
v_mfma_f32_16x16x32_bf16 v[4:7], a[180:183], a[240:243], v[4:7]
ds_read_b64_tr_b16 a[206:207], v213 offset:1024
buffer_load_dwordx4 v224, s[12:15], s42 offen offset:2048 nt lds
v_mfma_f32_16x16x32_bf16 v[64:67], a[180:183], a[212:215], v[64:67]
ds_read_b64_tr_b16 a[208:209], v213 offset:8192
v_mfma_f32_16x16x32_bf16 v[0:3], a[184:187], a[244:247], v[0:3]
ds_read_b64_tr_b16 a[210:211], v213 offset:9216
s_waitcnt lgkmcnt(10)
v_mfma_f32_16x16x32_bf16 v[4:7], a[184:187], a[248:251], v[4:7]
ds_read_b64_tr_b16 a[180:181], v214 offset:0
v_mfma_f32_16x16x32_bf16 v[64:67], a[184:187], a[216:219], v[64:67]
ds_read_b64_tr_b16 a[182:183], v214 offset:1024
v_mfma_f32_16x16x32_bf16 v[8:11], a[188:191], a[176:179], v[8:11]
ds_read_b64_tr_b16 a[184:185], v214 offset:8192
v_mfma_f32_16x16x32_bf16 v[12:15], a[188:191], a[240:243], v[12:15]
ds_read_b64_tr_b16 a[186:187], v214 offset:9216
buffer_load_dwordx4 v225, s[12:15], s42 offen offset:3072 nt lds
v_mfma_f32_16x16x32_bf16 v[68:71], a[188:191], a[212:215], v[68:71]
s_waitcnt lgkmcnt(10)
v_mfma_f32_16x16x32_bf16 v[8:11], a[192:195], a[244:247], v[8:11]
ds_read_b64_tr_b16 a[188:189], v215 offset:0
v_mfma_f32_16x16x32_bf16 v[12:15], a[192:195], a[248:251], v[12:15]
ds_read_b64_tr_b16 a[190:191], v215 offset:1024
v_mfma_f32_16x16x32_bf16 v[68:71], a[192:195], a[216:219], v[68:71]
v_mfma_f32_16x16x32_bf16 v[16:19], a[196:199], a[176:179], v[16:19]
ds_read_b64_tr_b16 a[192:193], v215 offset:8192
v_mfma_f32_16x16x32_bf16 v[20:23], a[196:199], a[240:243], v[20:23]
ds_read_b64_tr_b16 a[194:195], v215 offset:9216
s_waitcnt lgkmcnt(10)
v_mfma_f32_16x16x32_bf16 v[16:19], a[200:203], a[244:247], v[16:19]
ds_read_b64_tr_b16 a[196:197], v216 offset:0
s_add_u32 m0, s39, 65536
v_mfma_f32_16x16x32_bf16 v[20:23], a[200:203], a[248:251], v[20:23]
ds_read_b64_tr_b16 a[198:199], v216 offset:1024
s_add_u32 s43, s43, 16384
v_mfma_f32_16x16x32_bf16 v[24:27], a[204:207], a[176:179], v[24:27]
ds_read_b64_tr_b16 a[200:201], v216 offset:8192
buffer_load_dwordx4 v226, s[16:19], s43 offen nt lds
v_mfma_f32_16x16x32_bf16 v[28:31], a[204:207], a[240:243], v[28:31]
ds_read_b64_tr_b16 a[202:203], v216 offset:9216
s_waitcnt lgkmcnt(10)
v_mfma_f32_16x16x32_bf16 v[24:27], a[208:211], a[244:247], v[24:27]
ds_read_b64_tr_b16 a[204:205], v217 offset:0
buffer_load_dwordx4 v227, s[16:19], s43 offen offset:1024 nt lds
v_mfma_f32_16x16x32_bf16 v[28:31], a[208:211], a[248:251], v[28:31]
ds_read_b64_tr_b16 a[206:207], v217 offset:1024
v_mul_f32 v64, s4, v64
v_mfma_f32_16x16x32_bf16 v[32:35], a[180:183], a[176:179], v[32:35]
ds_read_b64_tr_b16 a[208:209], v217 offset:8192
v_mul_f32 v65, s4, v65
v_mfma_f32_16x16x32_bf16 v[36:39], a[180:183], a[240:243], v[36:39]
ds_read_b64_tr_b16 a[210:211], v217 offset:9216
s_waitcnt lgkmcnt(10)
v_mfma_f32_16x16x32_bf16 v[32:35], a[184:187], a[244:247], v[32:35]
v_cvt_pk_bf16_f32 v80, v64, v65
v_mul_f32 v66, s4, v66
v_mfma_f32_16x16x32_bf16 v[36:39], a[184:187], a[248:251], v[36:39]
v_mul_f32 v67, s4, v67
v_cvt_pk_bf16_f32 v81, v66, v67
v_mfma_f32_16x16x32_bf16 v[40:43], a[188:191], a[176:179], v[40:43]
buffer_load_dwordx4 v226, s[16:19], s43 offen offset:2048 nt lds
v_mfma_f32_16x16x32_bf16 v[44:47], a[188:191], a[240:243], v[44:47]
v_mul_f32 v68, s4, v68
s_waitcnt lgkmcnt(6)
v_mfma_f32_16x16x32_bf16 v[40:43], a[192:195], a[244:247], v[40:43]
v_mul_f32 v69, s4, v69
v_cvt_pk_bf16_f32 v82, v68, v69
v_mfma_f32_16x16x32_bf16 v[44:47], a[192:195], a[248:251], v[44:47]
v_mul_f32 v70, s4, v70
v_mul_f32 v71, s4, v71
v_mfma_f32_16x16x32_bf16 v[48:51], a[196:199], a[176:179], v[48:51]
v_cvt_pk_bf16_f32 v83, v70, v71
v_mul_f32 v0, s4, v0
v_mfma_f32_16x16x32_bf16 v[52:55], a[196:199], a[240:243], v[52:55]
v_mul_f32 v1, s4, v1
s_waitcnt lgkmcnt(2)
v_mfma_f32_16x16x32_bf16 v[48:51], a[200:203], a[244:247], v[48:51]
buffer_load_dwordx4 v227, s[16:19], s43 offen offset:3072 nt lds
v_mfma_f32_16x16x32_bf16 v[52:55], a[200:203], a[248:251], v[52:55]
v_cvt_pk_bf16_f32 v112, v0, v1
v_mul_f32 v2, s4, v2
v_mfma_f32_16x16x32_bf16 v[56:59], a[204:207], a[176:179], v[56:59]
v_mul_f32 v3, s4, v3
v_cvt_pk_bf16_f32 v113, v2, v3
v_mfma_f32_16x16x32_bf16 v[60:63], a[204:207], a[240:243], v[60:63]
v_mul_f32 v4, s4, v4
s_waitcnt lgkmcnt(0)
v_mfma_f32_16x16x32_bf16 v[56:59], a[208:211], a[244:247], v[56:59]
v_mul_f32 v5, s4, v5
v_cvt_pk_bf16_f32 v128, v4, v5
v_mfma_f32_16x16x32_bf16 v[60:63], a[208:211], a[248:251], v[60:63]
v_mul_f32 v6, s4, v6
v_mul_f32 v7, s4, v7
s_nop 3
ds_write_b64 v239, v[80:81]
ds_write_b64 v239, v[82:83] offset:512
s_cmp_lg_u32 s38, 0
s_cbranch_scc1 NORD2
global_load_dword v254, v253, s[36:37] sc1
NORD2:
v_add_u32 v178, 106496, v237
v_cvt_pk_bf16_f32 v129, v6, v7
v_pk_mul_f32 v[8:9], v[8:9], s[4:5] op_sel_hi:[1,0]
v_cvt_pk_bf16_f32 v114, v8, v9
v_pk_mul_f32 v[10:11], v[10:11], s[4:5] op_sel_hi:[1,0]
v_cvt_pk_bf16_f32 v115, v10, v11
v_pk_mul_f32 v[12:13], v[12:13], s[4:5] op_sel_hi:[1,0]
v_cvt_pk_bf16_f32 v130, v12, v13
v_pk_mul_f32 v[14:15], v[14:15], s[4:5] op_sel_hi:[1,0]
v_cvt_pk_bf16_f32 v131, v14, v15
v_pk_mul_f32 v[16:17], v[16:17], s[4:5] op_sel_hi:[1,0]
v_cvt_pk_bf16_f32 v116, v16, v17
v_pk_mul_f32 v[18:19], v[18:19], s[4:5] op_sel_hi:[1,0]
v_cvt_pk_bf16_f32 v117, v18, v19
v_pk_mul_f32 v[20:21], v[20:21], s[4:5] op_sel_hi:[1,0]
v_cvt_pk_bf16_f32 v132, v20, v21
v_pk_mul_f32 v[22:23], v[22:23], s[4:5] op_sel_hi:[1,0]
s_waitcnt vmcnt(8) lgkmcnt(0)
s_barrier
ds_read_b128 a[0:3], v178 offset:0
ds_read_b128 a[4:7], v178 offset:1024
ds_read_b128 a[8:11], v178 offset:2048
ds_read_b128 a[12:15], v178 offset:3072
ds_read_b128 a[180:183], v186 offset:0
ds_read_b128 a[184:187], v187 offset:0
ds_read_b128 a[188:191], v190 offset:0
ds_read_b128 a[192:195], v188 offset:0
ds_read_b128 a[196:199], v191 offset:0
ds_read_b128 a[200:203], v189 offset:0
ds_read_b128 a[204:207], v192 offset:0
v_cvt_pk_bf16_f32 v133, v22, v23
v_pk_mul_f32 v[24:25], v[24:25], s[4:5] op_sel_hi:[1,0]
v_cvt_pk_bf16_f32 v118, v24, v25
v_pk_mul_f32 v[26:27], v[26:27], s[4:5] op_sel_hi:[1,0]
v_cvt_pk_bf16_f32 v119, v26, v27
v_pk_mul_f32 v[28:29], v[28:29], s[4:5] op_sel_hi:[1,0]
v_cvt_pk_bf16_f32 v134, v28, v29
v_pk_mul_f32 v[30:31], v[30:31], s[4:5] op_sel_hi:[1,0]
v_cvt_pk_bf16_f32 v135, v30, v31
v_pk_mul_f32 v[32:33], v[32:33], s[4:5] op_sel_hi:[1,0]
v_cvt_pk_bf16_f32 v120, v32, v33
v_pk_mul_f32 v[34:35], v[34:35], s[4:5] op_sel_hi:[1,0]
v_cvt_pk_bf16_f32 v121, v34, v35
v_pk_mul_f32 v[36:37], v[36:37], s[4:5] op_sel_hi:[1,0]
v_cvt_pk_bf16_f32 v136, v36, v37
v_pk_mul_f32 v[38:39], v[38:39], s[4:5] op_sel_hi:[1,0]
v_cvt_pk_bf16_f32 v137, v38, v39
v_pk_mul_f32 v[40:41], v[40:41], s[4:5] op_sel_hi:[1,0]
v_cvt_pk_bf16_f32 v122, v40, v41
v_pk_mul_f32 v[42:43], v[42:43], s[4:5] op_sel_hi:[1,0]
v_cvt_pk_bf16_f32 v123, v42, v43
v_pk_mul_f32 v[44:45], v[44:45], s[4:5] op_sel_hi:[1,0]
v_cvt_pk_bf16_f32 v138, v44, v45
v_pk_mul_f32 v[46:47], v[46:47], s[4:5] op_sel_hi:[1,0]
v_cvt_pk_bf16_f32 v139, v46, v47
v_pk_mul_f32 v[48:49], v[48:49], s[4:5] op_sel_hi:[1,0]
v_cvt_pk_bf16_f32 v124, v48, v49
v_pk_mul_f32 v[50:51], v[50:51], s[4:5] op_sel_hi:[1,0]
v_cvt_pk_bf16_f32 v125, v50, v51
v_pk_mul_f32 v[52:53], v[52:53], s[4:5] op_sel_hi:[1,0]
v_cvt_pk_bf16_f32 v140, v52, v53
v_pk_mul_f32 v[54:55], v[54:55], s[4:5] op_sel_hi:[1,0]
v_cvt_pk_bf16_f32 v141, v54, v55
v_pk_mul_f32 v[56:57], v[56:57], s[4:5] op_sel_hi:[1,0]
v_cvt_pk_bf16_f32 v126, v56, v57
v_pk_mul_f32 v[58:59], v[58:59], s[4:5] op_sel_hi:[1,0]
v_cvt_pk_bf16_f32 v127, v58, v59
v_pk_mul_f32 v[60:61], v[60:61], s[4:5] op_sel_hi:[1,0]
v_cvt_pk_bf16_f32 v142, v60, v61
v_pk_mul_f32 v[62:63], v[62:63], s[4:5] op_sel_hi:[1,0]
v_cvt_pk_bf16_f32 v143, v62, v63
v_mov_b32 v156, 0
v_mov_b32 v157, 0
v_mov_b32 v158, 0
v_mov_b32 v159, 0
v_mov_b32 v160, 0
v_mov_b32 v161, 0
v_mov_b32 v162, 0
v_mov_b32 v163, 0
v_mov_b32 v164, 0
v_mov_b32 v165, 0
v_mov_b32 v166, 0
v_mov_b32 v167, 0
v_permlane32_swap_b32 v112, v114
v_permlane32_swap_b32 v113, v115
v_permlane32_swap_b32 v116, v118
v_permlane32_swap_b32 v117, v119
v_permlane32_swap_b32 v120, v122
v_permlane32_swap_b32 v121, v123
v_permlane32_swap_b32 v124, v126
v_permlane32_swap_b32 v125, v127
v_permlane32_swap_b32 v128, v130
v_permlane32_swap_b32 v129, v131
v_permlane32_swap_b32 v132, v134
v_permlane32_swap_b32 v133, v135
v_permlane32_swap_b32 v136, v138
v_permlane32_swap_b32 v137, v139
v_permlane32_swap_b32 v140, v142
v_permlane32_swap_b32 v141, v143
v_permlane16_swap_b32 v112, v114
v_permlane16_swap_b32 v113, v115
v_permlane16_swap_b32 v116, v118
v_permlane16_swap_b32 v117, v119
v_permlane16_swap_b32 v120, v122
v_permlane16_swap_b32 v121, v123
v_permlane16_swap_b32 v124, v126
v_permlane16_swap_b32 v125, v127
v_permlane16_swap_b32 v128, v130
v_permlane16_swap_b32 v129, v131
v_permlane16_swap_b32 v132, v134
v_permlane16_swap_b32 v133, v135
v_permlane16_swap_b32 v136, v138
v_permlane16_swap_b32 v137, v139
v_permlane16_swap_b32 v140, v142
v_permlane16_swap_b32 v141, v143
s_mov_b32 s54, 0
ATT00:
s_mov_b32 s46, s55
v_mov_b32 v177, 0
s_waitcnt lgkmcnt(3)
v_mfma_f32_16x16x32_bf16 v[64:67], a[180:183], v[112:115], v[156:159]
ds_read_b128 a[208:211], v186 offset:4096
s_add_u32 m0, s39, 32768
v_mfma_f32_16x16x32_bf16 v[72:75], a[180:183], v[128:131], v[160:163]
s_add_u32 s42, s42, 16384
buffer_load_dwordx4 v222, s[12:15], s42 offen nt lds
v_mfma_f32_16x16x32_bf16 v[64:67], a[184:187], v[116:119], v[64:67]
ds_read_b128 a[212:215], v193 offset:0
v_mfma_f32_16x16x32_bf16 v[72:75], a[184:187], v[132:135], v[72:75]
buffer_load_dwordx4 v223, s[12:15], s42 offen offset:1024 nt lds
v_mfma_f32_16x16x32_bf16 v[144:147], a[188:191], a[0:3], v[164:167]
ds_read_b128 a[216:219], v187 offset:4096
v_mfma_f32_16x16x32_bf16 v[64:67], a[192:195], v[120:123], v[64:67]
ds_read_b128 a[220:223], v188 offset:4096
v_mfma_f32_16x16x32_bf16 v[72:75], a[192:195], v[136:139], v[72:75]
buffer_load_dwordx4 v224, s[12:15], s42 offen offset:2048 nt lds
s_waitcnt lgkmcnt(3)
v_mfma_f32_16x16x32_bf16 v[144:147], a[196:199], a[4:7], v[144:147]
ds_read_b128 a[224:227], v189 offset:4096
v_mfma_f32_16x16x32_bf16 v[64:67], a[200:203], v[124:127], v[64:67]
ds_read_b128 a[180:183], v186 offset:8192
v_mfma_f32_16x16x32_bf16 v[72:75], a[200:203], v[140:143], v[72:75]
buffer_load_dwordx4 v225, s[12:15], s42 offen offset:3072 nt lds
v_mfma_f32_16x16x32_bf16 v[144:147], a[204:207], a[8:11], v[144:147]
ds_read_b128 a[184:187], v187 offset:8192
v_mfma_f32_16x16x32_bf16 v[68:71], a[208:211], v[112:115], v[156:159]
ds_read_b128 a[188:191], v188 offset:8192
v_mfma_f32_16x16x32_bf16 v[76:79], a[208:211], v[128:131], v[160:163]
s_add_u32 m0, s39, 81920
s_waitcnt lgkmcnt(3)
v_mfma_f32_16x16x32_bf16 v[144:147], a[212:215], a[12:15], v[144:147]
ds_read_b128 a[192:195], v189 offset:8192
s_add_u32 s43, s43, 16384
v_mfma_f32_16x16x32_bf16 v[68:71], a[216:219], v[116:119], v[68:71]
ds_read_b128 a[196:199], v186 offset:12288
buffer_load_dwordx4 v226, s[16:19], s43 offen nt lds
v_mfma_f32_16x16x32_bf16 v[76:79], a[216:219], v[132:135], v[76:79]
buffer_load_dwordx4 v227, s[16:19], s43 offen offset:1024 nt lds
v_mfma_f32_16x16x32_bf16 v[68:71], a[220:223], v[120:123], v[68:71]
ds_read_b128 a[200:203], v187 offset:12288
v_mfma_f32_16x16x32_bf16 v[76:79], a[220:223], v[136:139], v[76:79]
v_mfma_f32_16x16x32_bf16 v[68:71], a[224:227], v[124:127], v[68:71]
ds_read_b128 a[204:207], v188 offset:12288
buffer_load_dwordx4 v226, s[16:19], s43 offen offset:2048 nt lds
v_mfma_f32_16x16x32_bf16 v[76:79], a[224:227], v[140:143], v[76:79]
v_exp_f32 v144, v144
s_waitcnt lgkmcnt(4)
v_mfma_f32_16x16x32_bf16 v[80:83], a[180:183], v[112:115], v[156:159]
ds_read_b128 a[208:211], v189 offset:12288
v_add_f32 v177, v177, v144
v_exp_f32 v145, v145
v_exp_f32 v146, v146
v_cvt_pk_bf16_f32 v152, v144, v145
v_exp_f32 v147, v147
v_add_f32 v177, v177, v145
v_cvt_pk_bf16_f32 v153, v146, v147
v_mfma_f32_16x16x32_bf16 v[88:91], a[180:183], v[128:131], v[160:163]
buffer_load_dwordx4 v227, s[16:19], s43 offen offset:3072 nt lds
ds_write_b64 v202, v[152:153] offset:0
v_mfma_f32_16x16x32_bf16 v[80:83], a[184:187], v[116:119], v[80:83]
v_add_f32 v177, v177, v146
v_add_f32 v177, v177, v147
v_mfma_f32_16x16x32_bf16 v[88:91], a[184:187], v[132:135], v[88:91]
v_mfma_f32_16x16x32_bf16 v[80:83], a[188:191], v[120:123], v[80:83]
s_waitcnt vmcnt(8) lgkmcnt(0)
s_barrier
v_mfma_f32_16x16x32_bf16 v[88:91], a[188:191], v[136:139], v[88:91]
ds_read_b128 a[212:215], v186 offset:16384
s_waitcnt lgkmcnt(3)
v_mfma_f32_16x16x32_bf16 v[80:83], a[192:195], v[124:127], v[80:83]
ds_read_b128 a[216:219], v187 offset:16384
s_add_u32 m0, s39, 49152
v_mfma_f32_16x16x32_bf16 v[88:91], a[192:195], v[140:143], v[88:91]
ds_read_b128 a[220:223], v190 offset:16384
s_add_u32 s42, s42, 16384
v_mfma_f32_16x16x32_bf16 v[84:87], a[196:199], v[112:115], v[156:159]
ds_read_b64_tr_b16 a[224:225], v196 offset:0
buffer_load_dwordx4 v222, s[12:15], s42 offen nt lds
v_mfma_f32_16x16x32_bf16 v[92:95], a[196:199], v[128:131], v[160:163]
ds_read_b64_tr_b16 a[226:227], v196 offset:4096
v_exp_f32 v64, v64
v_mfma_f32_16x16x32_bf16 v[84:87], a[200:203], v[116:119], v[84:87]
ds_read_b128 a[180:183], v191 offset:16384
v_exp_f32 v65, v65
v_mfma_f32_16x16x32_bf16 v[92:95], a[200:203], v[132:135], v[92:95]
v_cvt_pk_bf16_f32 v96, v64, v65
s_waitcnt lgkmcnt(5)
v_mfma_f32_16x16x32_bf16 v[84:87], a[204:207], v[120:123], v[84:87]
ds_read_b128 a[184:187], v188 offset:16384
v_exp_f32 v66, v66
v_mfma_f32_16x16x32_bf16 v[92:95], a[204:207], v[136:139], v[92:95]
buffer_load_dwordx4 v223, s[12:15], s42 offen offset:1024 nt lds
v_mfma_f32_16x16x32_bf16 v[84:87], a[208:211], v[124:127], v[84:87]
ds_read_b128 a[188:191], v192 offset:16384
v_exp_f32 v67, v67
v_mfma_f32_16x16x32_bf16 v[92:95], a[208:211], v[140:143], v[92:95]
v_exp_f32 v68, v68
v_cvt_pk_bf16_f32 v97, v66, v67
v_exp_f32 v69, v69
v_exp_f32 v70, v70
v_cvt_pk_bf16_f32 v98, v68, v69
v_exp_f32 v71, v71
v_exp_f32 v72, v72
v_cvt_pk_bf16_f32 v99, v70, v71
v_exp_f32 v73, v73
v_exp_f32 v74, v74
v_cvt_pk_bf16_f32 v100, v72, v73
v_exp_f32 v75, v75
v_exp_f32 v76, v76
v_cvt_pk_bf16_f32 v101, v74, v75
v_exp_f32 v77, v77
v_exp_f32 v78, v78
v_cvt_pk_bf16_f32 v102, v76, v77
v_exp_f32 v79, v79
s_nop 0
v_cvt_pk_bf16_f32 v103, v78, v79
v_mfma_f32_16x16x32_bf16 v[64:67], a[212:215], v[112:115], v[156:159]
ds_read_b64_tr_b16 a[192:193], v197 offset:0
v_exp_f32 v80, v80
v_mfma_f32_16x16x32_bf16 v[72:75], a[212:215], v[128:131], v[160:163]
ds_read_b64_tr_b16 a[194:195], v197 offset:4096
s_waitcnt lgkmcnt(4)
v_mfma_f32_16x16x32_bf16 v[64:67], a[216:219], v[116:119], v[64:67]
ds_read_b128 a[196:199], v193 offset:16384
v_exp_f32 v81, v81
v_mfma_f32_16x16x32_bf16 v[72:75], a[216:219], v[132:135], v[72:75]
ds_read_b128 a[24:27], v203 offset:0
v_cvt_pk_bf16_f32 v104, v80, v81
v_mfma_f32_16x16x32_bf16 v[144:147], a[220:223], a[0:3], v[164:167]
ds_read_b128 a[200:203], v189 offset:16384
v_exp_f32 v82, v82
v_mfma_f32_16x16x32_bf16 v[16:19], a[224:227], v[96:99], 0
ds_read_b64_tr_b16 a[204:205], v198 offset:0
v_exp_f32 v83, v83
v_mfma_f32_16x16x32_bf16 v[20:23], a[224:227], v[100:103], 0
ds_read_b64_tr_b16 a[206:207], v198 offset:4096
buffer_load_dwordx4 v224, s[12:15], s42 offen offset:2048 nt lds
v_mfma_f32_16x16x32_bf16 v[144:147], a[180:183], a[4:7], v[144:147]
ds_read_b128 a[208:211], v186 offset:20480
s_waitcnt lgkmcnt(5)
v_mfma_f32_16x16x32_bf16 v[64:67], a[184:187], v[120:123], v[64:67]
ds_read_b64_tr_b16 a[212:213], v199 offset:0
v_cvt_pk_bf16_f32 v105, v82, v83
v_mfma_f32_16x16x32_bf16 v[72:75], a[184:187], v[136:139], v[72:75]
ds_read_b64_tr_b16 a[214:215], v199 offset:4096
v_exp_f32 v84, v84
v_mfma_f32_16x16x32_bf16 v[144:147], a[188:191], a[8:11], v[144:147]
ds_read_b128 a[216:219], v187 offset:20480
v_exp_f32 v85, v85
v_mfma_f32_16x16x32_bf16 v[24:27], a[192:195], v[96:99], 0
ds_read_b64_tr_b16 a[220:221], v200 offset:0
v_cvt_pk_bf16_f32 v106, v84, v85
v_mfma_f32_16x16x32_bf16 v[28:31], a[192:195], v[100:103], 0
ds_read_b64_tr_b16 a[222:223], v200 offset:4096
v_exp_f32 v86, v86
v_mfma_f32_16x16x32_bf16 v[144:147], a[196:199], a[12:15], v[144:147]
ds_read_b128 a[224:227], v188 offset:20480
s_waitcnt lgkmcnt(6)
v_mfma_f32_16x16x32_bf16 v[64:67], a[200:203], v[124:127], v[64:67]
ds_read_b64_tr_b16 a[180:181], v201 offset:0
v_exp_f32 v87, v87
v_mfma_f32_16x16x32_bf16 v[72:75], a[200:203], v[140:143], v[72:75]
ds_read_b64_tr_b16 a[182:183], v201 offset:4096
buffer_load_dwordx4 v225, s[12:15], s42 offen offset:3072 nt lds
v_mfma_f32_16x16x32_bf16 v[32:35], a[204:207], v[96:99], 0
ds_read_b128 a[28:31], v203 offset:1024
v_cvt_pk_bf16_f32 v107, v86, v87
v_mfma_f32_16x16x32_bf16 v[36:39], a[204:207], v[100:103], 0
ds_read_b128 a[184:187], v189 offset:20480
v_exp_f32 v88, v88
v_mfma_f32_16x16x32_bf16 v[68:71], a[208:211], v[112:115], v[156:159]
ds_read_b64_tr_b16 a[188:189], v194 offset:0
v_exp_f32 v89, v89
v_mfma_f32_16x16x32_bf16 v[76:79], a[208:211], v[128:131], v[160:163]
ds_read_b64_tr_b16 a[190:191], v194 offset:4096
s_waitcnt lgkmcnt(7)
v_mfma_f32_16x16x32_bf16 v[40:43], a[212:215], v[96:99], 0
ds_read_b64_tr_b16 a[192:193], v195 offset:0
v_cvt_pk_bf16_f32 v108, v88, v89
v_mfma_f32_16x16x32_bf16 v[44:47], a[212:215], v[100:103], 0
ds_read_b64_tr_b16 a[194:195], v195 offset:4096
v_exp_f32 v90, v90
v_mfma_f32_16x16x32_bf16 v[68:71], a[216:219], v[116:119], v[68:71]
ds_read_b128 a[196:199], v186 offset:24576
v_exp_f32 v91, v91
v_mfma_f32_16x16x32_bf16 v[76:79], a[216:219], v[132:135], v[76:79]
v_exp_f32 v92, v92
v_mfma_f32_16x16x32_bf16 v[48:51], a[220:223], v[96:99], 0
ds_read_b128 a[200:203], v187 offset:24576
s_add_u32 m0, s39, 98304
v_mfma_f32_16x16x32_bf16 v[52:55], a[220:223], v[100:103], 0
s_add_u32 s43, s43, 16384
s_waitcnt lgkmcnt(6)
v_mfma_f32_16x16x32_bf16 v[68:71], a[224:227], v[120:123], v[68:71]
ds_read_b64_tr_b16 a[204:205], v196 offset:8192
buffer_load_dwordx4 v226, s[16:19], s43 offen nt lds
v_mfma_f32_16x16x32_bf16 v[76:79], a[224:227], v[136:139], v[76:79]
ds_read_b64_tr_b16 a[206:207], v196 offset:12288
v_cvt_pk_bf16_f32 v109, v90, v91
v_mfma_f32_16x16x32_bf16 v[56:59], a[180:183], v[96:99], 0
ds_read_b128 a[208:211], v188 offset:24576
v_exp_f32 v93, v93
v_mfma_f32_16x16x32_bf16 v[60:63], a[180:183], v[100:103], 0
v_exp_f32 v94, v94
v_mfma_f32_16x16x32_bf16 a[232:235], a[228:231], v[96:99], 0
v_cvt_pk_bf16_f32 v110, v92, v93
v_exp_f32 v95, v95
v_mfma_f32_16x16x32_bf16 v[68:71], a[184:187], v[124:127], v[68:71]
ds_read_b64_tr_b16 a[212:213], v197 offset:8192
v_cvt_pk_bf16_f32 v111, v94, v95
v_mfma_f32_16x16x32_bf16 v[76:79], a[184:187], v[140:143], v[76:79]
ds_read_b64_tr_b16 a[214:215], v197 offset:12288
s_waitcnt lgkmcnt(7)
v_mfma_f32_16x16x32_bf16 v[0:3], a[188:191], v[96:99], 0
ds_read_b128 a[216:219], v189 offset:24576
buffer_load_dwordx4 v227, s[16:19], s43 offen offset:1024 nt lds
v_mfma_f32_16x16x32_bf16 v[4:7], a[188:191], v[100:103], 0
v_exp_f32 v144, v144
v_mfma_f32_16x16x32_bf16 a[16:19], a[188:191], a[24:27], 0
v_exp_f32 v145, v145
v_mfma_f32_16x16x32_bf16 a[236:239], a[228:231], v[100:103], 0
v_exp_f32 v146, v146
v_mfma_f32_16x16x32_bf16 v[8:11], a[192:195], v[96:99], 0
ds_read_b64_tr_b16 a[220:221], v198 offset:8192
v_cvt_pk_bf16_f32 v152, v144, v145
v_mfma_f32_16x16x32_bf16 v[12:15], a[192:195], v[100:103], 0
ds_read_b64_tr_b16 a[222:223], v198 offset:12288
v_add_f32 v177, v177, v144
v_mfma_f32_16x16x32_bf16 a[20:23], a[192:195], a[24:27], 0
v_add_f32 v177, v177, v145
s_waitcnt lgkmcnt(6)
v_mfma_f32_16x16x32_bf16 v[80:83], a[196:199], v[112:115], v[156:159]
ds_read_b128 a[224:227], v186 offset:28672
v_add_f32 v177, v177, v146
v_mfma_f32_16x16x32_bf16 v[88:91], a[196:199], v[128:131], v[160:163]
v_exp_f32 v147, v147
v_mfma_f32_16x16x32_bf16 v[80:83], a[200:203], v[116:119], v[80:83]
ds_read_b64_tr_b16 a[180:181], v199 offset:8192
buffer_load_dwordx4 v226, s[16:19], s43 offen offset:2048 nt lds
v_mfma_f32_16x16x32_bf16 v[88:91], a[200:203], v[132:135], v[88:91]
ds_read_b64_tr_b16 a[182:183], v199 offset:12288
v_cvt_pk_bf16_f32 v153, v146, v147
v_mfma_f32_16x16x32_bf16 v[16:19], a[204:207], v[104:107], v[16:19]
ds_read_b128 a[184:187], v187 offset:28672
ds_write_b64 v202, v[152:153] offset:2048
v_mfma_f32_16x16x32_bf16 v[20:23], a[204:207], v[108:111], v[20:23]
v_add_f32 v177, v177, v147
s_waitcnt lgkmcnt(6)
v_mfma_f32_16x16x32_bf16 v[80:83], a[208:211], v[120:123], v[80:83]
ds_read_b64_tr_b16 a[188:189], v200 offset:8192
v_exp_f32 v64, v64
v_mfma_f32_16x16x32_bf16 v[88:91], a[208:211], v[136:139], v[88:91]
ds_read_b64_tr_b16 a[190:191], v200 offset:12288
v_exp_f32 v65, v65
v_mfma_f32_16x16x32_bf16 v[24:27], a[212:215], v[104:107], v[24:27]
ds_read_b128 a[192:195], v188 offset:28672
v_cvt_pk_bf16_f32 v96, v64, v65
v_mfma_f32_16x16x32_bf16 v[28:31], a[212:215], v[108:111], v[28:31]
v_exp_f32 v66, v66
v_mfma_f32_16x16x32_bf16 v[80:83], a[216:219], v[124:127], v[80:83]
ds_read_b64_tr_b16 a[196:197], v201 offset:8192
v_exp_f32 v67, v67
v_mfma_f32_16x16x32_bf16 v[88:91], a[216:219], v[140:143], v[88:91]
ds_read_b64_tr_b16 a[198:199], v201 offset:12288
s_waitcnt lgkmcnt(6)
v_mfma_f32_16x16x32_bf16 v[32:35], a[220:223], v[104:107], v[32:35]
ds_read_b128 a[200:203], v189 offset:28672
buffer_load_dwordx4 v227, s[16:19], s43 offen offset:3072 nt lds
v_mfma_f32_16x16x32_bf16 v[36:39], a[220:223], v[108:111], v[36:39]
v_exp_f32 v68, v68
v_mfma_f32_16x16x32_bf16 v[84:87], a[224:227], v[112:115], v[156:159]
ds_read_b64_tr_b16 a[204:205], v194 offset:8192
v_cvt_pk_bf16_f32 v97, v66, v67
v_mfma_f32_16x16x32_bf16 v[92:95], a[224:227], v[128:131], v[160:163]
ds_read_b64_tr_b16 a[206:207], v194 offset:12288
v_exp_f32 v69, v69
v_mfma_f32_16x16x32_bf16 v[40:43], a[180:183], v[104:107], v[40:43]
ds_read_b64_tr_b16 a[208:209], v195 offset:8192
v_cvt_pk_bf16_f32 v98, v68, v69
v_mfma_f32_16x16x32_bf16 v[44:47], a[180:183], v[108:111], v[44:47]
ds_read_b64_tr_b16 a[210:211], v195 offset:12288
s_waitcnt lgkmcnt(8)
v_mfma_f32_16x16x32_bf16 v[84:87], a[184:187], v[116:119], v[84:87]
v_exp_f32 v70, v70
v_mfma_f32_16x16x32_bf16 v[92:95], a[184:187], v[132:135], v[92:95]
v_exp_f32 v71, v71
v_mfma_f32_16x16x32_bf16 v[48:51], a[188:191], v[104:107], v[48:51]
s_waitcnt vmcnt(8)
s_barrier
v_mfma_f32_16x16x32_bf16 v[52:55], a[188:191], v[108:111], v[52:55]
ds_read_b128 a[212:215], v186 offset:32768
s_waitcnt lgkmcnt(5)
v_mfma_f32_16x16x32_bf16 v[84:87], a[192:195], v[120:123], v[84:87]
ds_read_b128 a[216:219], v187 offset:32768
s_add_u32 m0, s39, 0
v_mfma_f32_16x16x32_bf16 v[92:95], a[192:195], v[136:139], v[92:95]
ds_read_b128 a[220:223], v190 offset:32768
s_add_u32 s42, s42, 16384
v_mfma_f32_16x16x32_bf16 v[56:59], a[196:199], v[104:107], v[56:59]
ds_read_b64_tr_b16 a[224:225], v196 offset:16384
buffer_load_dwordx4 v222, s[12:15], s42 offen nt lds
v_mfma_f32_16x16x32_bf16 v[60:63], a[196:199], v[108:111], v[60:63]
ds_read_b64_tr_b16 a[226:227], v196 offset:20480
v_cvt_pk_bf16_f32 v99, v70, v71
v_mfma_f32_16x16x32_bf16 a[232:235], a[228:231], v[104:107], a[232:235]
v_exp_f32 v72, v72
v_mfma_f32_16x16x32_bf16 v[84:87], a[200:203], v[124:127], v[84:87]
ds_read_b128 a[180:183], v191 offset:32768
v_exp_f32 v73, v73
v_mfma_f32_16x16x32_bf16 v[92:95], a[200:203], v[140:143], v[92:95]
v_cvt_pk_bf16_f32 v100, v72, v73
s_waitcnt lgkmcnt(6)
v_mfma_f32_16x16x32_bf16 v[0:3], a[204:207], v[104:107], v[0:3]
ds_read_b128 a[184:187], v188 offset:32768
v_exp_f32 v74, v74
v_mfma_f32_16x16x32_bf16 v[4:7], a[204:207], v[108:111], v[4:7]
buffer_load_dwordx4 v223, s[12:15], s42 offen offset:1024 nt lds
v_mfma_f32_16x16x32_bf16 a[16:19], a[204:207], a[28:31], a[16:19]
v_exp_f32 v75, v75
v_mfma_f32_16x16x32_bf16 a[236:239], a[228:231], v[108:111], a[236:239]
v_exp_f32 v76, v76
v_mfma_f32_16x16x32_bf16 v[8:11], a[208:211], v[104:107], v[8:11]
ds_read_b128 a[188:191], v192 offset:32768
v_cvt_pk_bf16_f32 v101, v74, v75
v_mfma_f32_16x16x32_bf16 v[12:15], a[208:211], v[108:111], v[12:15]
v_exp_f32 v77, v77
v_mfma_f32_16x16x32_bf16 a[20:23], a[208:211], a[28:31], a[20:23]
v_cvt_pk_bf16_f32 v102, v76, v77
v_exp_f32 v78, v78
v_exp_f32 v79, v79
s_nop 0
v_cvt_pk_bf16_f32 v103, v78, v79
s_waitcnt lgkmcnt(3)
v_mfma_f32_16x16x32_bf16 v[64:67], a[212:215], v[112:115], v[156:159]
ds_read_b64_tr_b16 a[192:193], v197 offset:16384
v_exp_f32 v80, v80
v_mfma_f32_16x16x32_bf16 v[72:75], a[212:215], v[128:131], v[160:163]
ds_read_b64_tr_b16 a[194:195], v197 offset:20480
v_exp_f32 v81, v81
v_mfma_f32_16x16x32_bf16 v[64:67], a[216:219], v[116:119], v[64:67]
ds_read_b128 a[196:199], v193 offset:32768
v_cvt_pk_bf16_f32 v104, v80, v81
v_mfma_f32_16x16x32_bf16 v[72:75], a[216:219], v[132:135], v[72:75]
ds_read_b128 a[24:27], v203 offset:2048
buffer_load_dwordx4 v224, s[12:15], s42 offen offset:2048 nt lds
v_mfma_f32_16x16x32_bf16 v[144:147], a[220:223], a[0:3], v[164:167]
ds_read_b128 a[200:203], v189 offset:32768
v_exp_f32 v82, v82
v_mfma_f32_16x16x32_bf16 v[16:19], a[224:227], v[96:99], v[16:19]
ds_read_b64_tr_b16 a[204:205], v198 offset:16384
v_exp_f32 v83, v83
v_mfma_f32_16x16x32_bf16 v[20:23], a[224:227], v[100:103], v[20:23]
ds_read_b64_tr_b16 a[206:207], v198 offset:20480
s_waitcnt lgkmcnt(5)
v_mfma_f32_16x16x32_bf16 v[144:147], a[180:183], a[4:7], v[144:147]
ds_read_b128 a[208:211], v186 offset:36864
v_cvt_pk_bf16_f32 v105, v82, v83
v_mfma_f32_16x16x32_bf16 v[64:67], a[184:187], v[120:123], v[64:67]
ds_read_b64_tr_b16 a[212:213], v199 offset:16384
v_exp_f32 v84, v84
v_mfma_f32_16x16x32_bf16 v[72:75], a[184:187], v[136:139], v[72:75]
ds_read_b64_tr_b16 a[214:215], v199 offset:20480
v_exp_f32 v85, v85
v_mfma_f32_16x16x32_bf16 v[144:147], a[188:191], a[8:11], v[144:147]
ds_read_b128 a[216:219], v187 offset:36864
v_cvt_pk_bf16_f32 v106, v84, v85
v_mfma_f32_16x16x32_bf16 v[24:27], a[192:195], v[96:99], v[24:27]
ds_read_b64_tr_b16 a[220:221], v200 offset:16384
v_exp_f32 v86, v86
v_mfma_f32_16x16x32_bf16 v[28:31], a[192:195], v[100:103], v[28:31]
ds_read_b64_tr_b16 a[222:223], v200 offset:20480
s_waitcnt lgkmcnt(5)
v_mfma_f32_16x16x32_bf16 v[144:147], a[196:199], a[12:15], v[144:147]
ds_read_b128 a[224:227], v188 offset:36864
buffer_load_dwordx4 v225, s[12:15], s42 offen offset:3072 nt lds
v_mfma_f32_16x16x32_bf16 v[64:67], a[200:203], v[124:127], v[64:67]
ds_read_b64_tr_b16 a[180:181], v201 offset:16384
v_exp_f32 v87, v87
v_mfma_f32_16x16x32_bf16 v[72:75], a[200:203], v[140:143], v[72:75]
ds_read_b64_tr_b16 a[182:183], v201 offset:20480
v_cvt_pk_bf16_f32 v107, v86, v87
v_mfma_f32_16x16x32_bf16 v[32:35], a[204:207], v[96:99], v[32:35]
ds_read_b128 a[28:31], v203 offset:3072
v_exp_f32 v88, v88
v_mfma_f32_16x16x32_bf16 v[36:39], a[204:207], v[100:103], v[36:39]
ds_read_b128 a[184:187], v189 offset:36864
v_exp_f32 v89, v89
v_mfma_f32_16x16x32_bf16 v[68:71], a[208:211], v[112:115], v[156:159]
ds_read_b64_tr_b16 a[188:189], v194 offset:16384
v_cvt_pk_bf16_f32 v108, v88, v89
v_mfma_f32_16x16x32_bf16 v[76:79], a[208:211], v[128:131], v[160:163]
ds_read_b64_tr_b16 a[190:191], v194 offset:20480
s_waitcnt lgkmcnt(7)
v_mfma_f32_16x16x32_bf16 v[40:43], a[212:215], v[96:99], v[40:43]
ds_read_b64_tr_b16 a[192:193], v195 offset:16384
v_exp_f32 v90, v90
v_mfma_f32_16x16x32_bf16 v[44:47], a[212:215], v[100:103], v[44:47]
ds_read_b64_tr_b16 a[194:195], v195 offset:20480
v_exp_f32 v91, v91
v_mfma_f32_16x16x32_bf16 v[68:71], a[216:219], v[116:119], v[68:71]
ds_read_b128 a[196:199], v186 offset:40960
s_add_u32 m0, s39, 114688
v_mfma_f32_16x16x32_bf16 v[76:79], a[216:219], v[132:135], v[76:79]
s_add_u32 s43, s43, 16384
buffer_load_dwordx4 v226, s[16:19], s43 offen nt lds
v_mfma_f32_16x16x32_bf16 v[48:51], a[220:223], v[96:99], v[48:51]
ds_read_b128 a[200:203], v187 offset:40960
v_cvt_pk_bf16_f32 v109, v90, v91
v_mfma_f32_16x16x32_bf16 v[52:55], a[220:223], v[100:103], v[52:55]
v_exp_f32 v92, v92
s_waitcnt lgkmcnt(6)
v_mfma_f32_16x16x32_bf16 v[68:71], a[224:227], v[120:123], v[68:71]
ds_read_b64_tr_b16 a[204:205], v196 offset:24576
v_exp_f32 v93, v93
v_mfma_f32_16x16x32_bf16 v[76:79], a[224:227], v[136:139], v[76:79]
ds_read_b64_tr_b16 a[206:207], v196 offset:28672
v_cvt_pk_bf16_f32 v110, v92, v93
v_mfma_f32_16x16x32_bf16 v[56:59], a[180:183], v[96:99], v[56:59]
ds_read_b128 a[208:211], v188 offset:40960
v_exp_f32 v94, v94
v_mfma_f32_16x16x32_bf16 v[60:63], a[180:183], v[100:103], v[60:63]
v_exp_f32 v95, v95
v_mfma_f32_16x16x32_bf16 a[232:235], a[228:231], v[96:99], a[232:235]
v_cvt_pk_bf16_f32 v111, v94, v95
v_exp_f32 v144, v144
v_mfma_f32_16x16x32_bf16 v[68:71], a[184:187], v[124:127], v[68:71]
ds_read_b64_tr_b16 a[212:213], v197 offset:24576
buffer_load_dwordx4 v227, s[16:19], s43 offen offset:1024 nt lds
v_mfma_f32_16x16x32_bf16 v[76:79], a[184:187], v[140:143], v[76:79]
ds_read_b64_tr_b16 a[214:215], v197 offset:28672
s_waitcnt lgkmcnt(7)
v_mfma_f32_16x16x32_bf16 v[0:3], a[188:191], v[96:99], v[0:3]
ds_read_b128 a[216:219], v189 offset:40960
v_add_f32 v177, v177, v144
v_mfma_f32_16x16x32_bf16 v[4:7], a[188:191], v[100:103], v[4:7]
v_exp_f32 v145, v145
v_mfma_f32_16x16x32_bf16 a[16:19], a[188:191], a[24:27], a[16:19]
v_exp_f32 v146, v146
v_mfma_f32_16x16x32_bf16 a[236:239], a[228:231], v[100:103], a[236:239]
v_cvt_pk_bf16_f32 v152, v144, v145
v_add_f32 v177, v177, v145
v_mfma_f32_16x16x32_bf16 v[8:11], a[192:195], v[96:99], v[8:11]
ds_read_b64_tr_b16 a[220:221], v198 offset:24576
v_add_f32 v177, v177, v146
v_mfma_f32_16x16x32_bf16 v[12:15], a[192:195], v[100:103], v[12:15]
ds_read_b64_tr_b16 a[222:223], v198 offset:28672
v_exp_f32 v147, v147
v_mfma_f32_16x16x32_bf16 a[20:23], a[192:195], a[24:27], a[20:23]
v_cvt_pk_bf16_f32 v153, v146, v147
s_waitcnt lgkmcnt(6)
v_mfma_f32_16x16x32_bf16 v[80:83], a[196:199], v[112:115], v[156:159]
ds_read_b128 a[224:227], v186 offset:45056
ds_write_b64 v202, v[152:153] offset:0
v_mfma_f32_16x16x32_bf16 v[88:91], a[196:199], v[128:131], v[160:163]
buffer_load_dwordx4 v226, s[16:19], s43 offen offset:2048 nt lds
v_mfma_f32_16x16x32_bf16 v[80:83], a[200:203], v[116:119], v[80:83]
ds_read_b64_tr_b16 a[180:181], v199 offset:24576
v_add_f32 v177, v177, v147
v_mfma_f32_16x16x32_bf16 v[88:91], a[200:203], v[132:135], v[88:91]
ds_read_b64_tr_b16 a[182:183], v199 offset:28672
v_exp_f32 v64, v64
v_mfma_f32_16x16x32_bf16 v[16:19], a[204:207], v[104:107], v[16:19]
ds_read_b128 a[184:187], v187 offset:45056
v_exp_f32 v65, v65
v_mfma_f32_16x16x32_bf16 v[20:23], a[204:207], v[108:111], v[20:23]
v_cvt_pk_bf16_f32 v96, v64, v65
s_waitcnt lgkmcnt(6)
v_mfma_f32_16x16x32_bf16 v[80:83], a[208:211], v[120:123], v[80:83]
ds_read_b64_tr_b16 a[188:189], v200 offset:24576
v_exp_f32 v66, v66
v_mfma_f32_16x16x32_bf16 v[88:91], a[208:211], v[136:139], v[88:91]
ds_read_b64_tr_b16 a[190:191], v200 offset:28672
v_exp_f32 v67, v67
v_mfma_f32_16x16x32_bf16 v[24:27], a[212:215], v[104:107], v[24:27]
ds_read_b128 a[192:195], v188 offset:45056
v_cvt_pk_bf16_f32 v97, v66, v67
v_mfma_f32_16x16x32_bf16 v[28:31], a[212:215], v[108:111], v[28:31]
v_exp_f32 v68, v68
v_mfma_f32_16x16x32_bf16 v[80:83], a[216:219], v[124:127], v[80:83]
ds_read_b64_tr_b16 a[196:197], v201 offset:24576
buffer_load_dwordx4 v227, s[16:19], s43 offen offset:3072 nt lds
v_mfma_f32_16x16x32_bf16 v[88:91], a[216:219], v[140:143], v[88:91]
ds_read_b64_tr_b16 a[198:199], v201 offset:28672
s_waitcnt lgkmcnt(6)
v_mfma_f32_16x16x32_bf16 v[32:35], a[220:223], v[104:107], v[32:35]
ds_read_b128 a[200:203], v189 offset:45056
v_exp_f32 v69, v69
v_mfma_f32_16x16x32_bf16 v[36:39], a[220:223], v[108:111], v[36:39]
v_exp_f32 v70, v70
v_mfma_f32_16x16x32_bf16 v[84:87], a[224:227], v[112:115], v[156:159]
ds_read_b64_tr_b16 a[204:205], v194 offset:24576
v_cvt_pk_bf16_f32 v98, v68, v69
v_mfma_f32_16x16x32_bf16 v[92:95], a[224:227], v[128:131], v[160:163]
ds_read_b64_tr_b16 a[206:207], v194 offset:28672
v_exp_f32 v71, v71
v_mfma_f32_16x16x32_bf16 v[40:43], a[180:183], v[104:107], v[40:43]
ds_read_b64_tr_b16 a[208:209], v195 offset:24576
v_cvt_pk_bf16_f32 v99, v70, v71
v_mfma_f32_16x16x32_bf16 v[44:47], a[180:183], v[108:111], v[44:47]
ds_read_b64_tr_b16 a[210:211], v195 offset:28672
s_waitcnt lgkmcnt(8)
v_mfma_f32_16x16x32_bf16 v[84:87], a[184:187], v[116:119], v[84:87]
v_exp_f32 v72, v72
v_mfma_f32_16x16x32_bf16 v[92:95], a[184:187], v[132:135], v[92:95]
v_exp_f32 v73, v73
v_mfma_f32_16x16x32_bf16 v[48:51], a[188:191], v[104:107], v[48:51]
s_waitcnt vmcnt(8)
s_barrier
v_mfma_f32_16x16x32_bf16 v[52:55], a[188:191], v[108:111], v[52:55]
ds_read_b128 a[212:215], v186 offset:49152
s_waitcnt lgkmcnt(5)
v_mfma_f32_16x16x32_bf16 v[84:87], a[192:195], v[120:123], v[84:87]
ds_read_b128 a[216:219], v187 offset:49152
s_add_u32 m0, s39, 16384
v_mfma_f32_16x16x32_bf16 v[92:95], a[192:195], v[136:139], v[92:95]
ds_read_b128 a[220:223], v190 offset:49152
s_add_u32 s42, s42, 16384
v_mfma_f32_16x16x32_bf16 v[56:59], a[196:199], v[104:107], v[56:59]
ds_read_b64_tr_b16 a[224:225], v196 offset:32768
buffer_load_dwordx4 v222, s[12:15], s42 offen nt lds
v_mfma_f32_16x16x32_bf16 v[60:63], a[196:199], v[108:111], v[60:63]
ds_read_b64_tr_b16 a[226:227], v196 offset:36864
v_cvt_pk_bf16_f32 v100, v72, v73
v_mfma_f32_16x16x32_bf16 a[232:235], a[228:231], v[104:107], a[232:235]
v_exp_f32 v74, v74
v_mfma_f32_16x16x32_bf16 v[84:87], a[200:203], v[124:127], v[84:87]
ds_read_b128 a[180:183], v191 offset:49152
v_exp_f32 v75, v75
v_mfma_f32_16x16x32_bf16 v[92:95], a[200:203], v[140:143], v[92:95]
v_cvt_pk_bf16_f32 v101, v74, v75
s_waitcnt lgkmcnt(6)
v_mfma_f32_16x16x32_bf16 v[0:3], a[204:207], v[104:107], v[0:3]
ds_read_b128 a[184:187], v188 offset:49152
v_exp_f32 v76, v76
v_mfma_f32_16x16x32_bf16 v[4:7], a[204:207], v[108:111], v[4:7]
buffer_load_dwordx4 v223, s[12:15], s42 offen offset:1024 nt lds
v_mfma_f32_16x16x32_bf16 a[16:19], a[204:207], a[28:31], a[16:19]
v_exp_f32 v77, v77
v_mfma_f32_16x16x32_bf16 a[236:239], a[228:231], v[108:111], a[236:239]
v_exp_f32 v78, v78
v_mfma_f32_16x16x32_bf16 v[8:11], a[208:211], v[104:107], v[8:11]
ds_read_b128 a[188:191], v192 offset:49152
v_cvt_pk_bf16_f32 v102, v76, v77
v_mfma_f32_16x16x32_bf16 v[12:15], a[208:211], v[108:111], v[12:15]
v_exp_f32 v79, v79
v_mfma_f32_16x16x32_bf16 a[20:23], a[208:211], a[28:31], a[20:23]
v_cvt_pk_bf16_f32 v103, v78, v79
s_waitcnt lgkmcnt(3)
v_mfma_f32_16x16x32_bf16 v[64:67], a[212:215], v[112:115], v[156:159]
ds_read_b64_tr_b16 a[192:193], v197 offset:32768
v_exp_f32 v80, v80
v_mfma_f32_16x16x32_bf16 v[72:75], a[212:215], v[128:131], v[160:163]
ds_read_b64_tr_b16 a[194:195], v197 offset:36864
v_exp_f32 v81, v81
v_mfma_f32_16x16x32_bf16 v[64:67], a[216:219], v[116:119], v[64:67]
ds_read_b128 a[196:199], v193 offset:49152
v_cvt_pk_bf16_f32 v104, v80, v81
v_mfma_f32_16x16x32_bf16 v[72:75], a[216:219], v[132:135], v[72:75]
ds_read_b128 a[24:27], v203 offset:0
buffer_load_dwordx4 v224, s[12:15], s42 offen offset:2048 nt lds
v_mfma_f32_16x16x32_bf16 v[144:147], a[220:223], a[0:3], v[164:167]
ds_read_b128 a[200:203], v189 offset:49152
v_exp_f32 v82, v82
v_mfma_f32_16x16x32_bf16 v[16:19], a[224:227], v[96:99], v[16:19]
ds_read_b64_tr_b16 a[204:205], v198 offset:32768
v_exp_f32 v83, v83
v_mfma_f32_16x16x32_bf16 v[20:23], a[224:227], v[100:103], v[20:23]
ds_read_b64_tr_b16 a[206:207], v198 offset:36864
s_waitcnt lgkmcnt(5)
v_mfma_f32_16x16x32_bf16 v[144:147], a[180:183], a[4:7], v[144:147]
ds_read_b128 a[208:211], v186 offset:53248
v_cvt_pk_bf16_f32 v105, v82, v83
v_mfma_f32_16x16x32_bf16 v[64:67], a[184:187], v[120:123], v[64:67]
ds_read_b64_tr_b16 a[212:213], v199 offset:32768
v_exp_f32 v84, v84
v_mfma_f32_16x16x32_bf16 v[72:75], a[184:187], v[136:139], v[72:75]
ds_read_b64_tr_b16 a[214:215], v199 offset:36864
v_exp_f32 v85, v85
v_mfma_f32_16x16x32_bf16 v[144:147], a[188:191], a[8:11], v[144:147]
ds_read_b128 a[216:219], v187 offset:53248
v_cvt_pk_bf16_f32 v106, v84, v85
v_mfma_f32_16x16x32_bf16 v[24:27], a[192:195], v[96:99], v[24:27]
ds_read_b64_tr_b16 a[220:221], v200 offset:32768
v_exp_f32 v86, v86
v_mfma_f32_16x16x32_bf16 v[28:31], a[192:195], v[100:103], v[28:31]
ds_read_b64_tr_b16 a[222:223], v200 offset:36864
s_waitcnt lgkmcnt(5)
v_mfma_f32_16x16x32_bf16 v[144:147], a[196:199], a[12:15], v[144:147]
ds_read_b128 a[224:227], v188 offset:53248
buffer_load_dwordx4 v225, s[12:15], s42 offen offset:3072 nt lds
v_mfma_f32_16x16x32_bf16 v[64:67], a[200:203], v[124:127], v[64:67]
ds_read_b64_tr_b16 a[180:181], v201 offset:32768
v_exp_f32 v87, v87
v_mfma_f32_16x16x32_bf16 v[72:75], a[200:203], v[140:143], v[72:75]
ds_read_b64_tr_b16 a[182:183], v201 offset:36864
v_cvt_pk_bf16_f32 v107, v86, v87
v_mfma_f32_16x16x32_bf16 v[32:35], a[204:207], v[96:99], v[32:35]
ds_read_b128 a[28:31], v203 offset:1024
v_exp_f32 v88, v88
v_mfma_f32_16x16x32_bf16 v[36:39], a[204:207], v[100:103], v[36:39]
ds_read_b128 a[184:187], v189 offset:53248
v_exp_f32 v89, v89
v_mfma_f32_16x16x32_bf16 v[68:71], a[208:211], v[112:115], v[156:159]
ds_read_b64_tr_b16 a[188:189], v194 offset:32768
v_cvt_pk_bf16_f32 v108, v88, v89
v_mfma_f32_16x16x32_bf16 v[76:79], a[208:211], v[128:131], v[160:163]
ds_read_b64_tr_b16 a[190:191], v194 offset:36864
s_waitcnt lgkmcnt(7)
v_mfma_f32_16x16x32_bf16 v[40:43], a[212:215], v[96:99], v[40:43]
ds_read_b64_tr_b16 a[192:193], v195 offset:32768
v_exp_f32 v90, v90
v_mfma_f32_16x16x32_bf16 v[44:47], a[212:215], v[100:103], v[44:47]
ds_read_b64_tr_b16 a[194:195], v195 offset:36864
v_exp_f32 v91, v91
v_mfma_f32_16x16x32_bf16 v[68:71], a[216:219], v[116:119], v[68:71]
ds_read_b128 a[196:199], v186 offset:57344
s_add_u32 m0, s39, 65536
v_mfma_f32_16x16x32_bf16 v[76:79], a[216:219], v[132:135], v[76:79]
s_add_u32 s43, s43, 16384
buffer_load_dwordx4 v226, s[16:19], s43 offen nt lds
v_mfma_f32_16x16x32_bf16 v[48:51], a[220:223], v[96:99], v[48:51]
ds_read_b128 a[200:203], v187 offset:57344
v_cvt_pk_bf16_f32 v109, v90, v91
v_mfma_f32_16x16x32_bf16 v[52:55], a[220:223], v[100:103], v[52:55]
v_exp_f32 v92, v92
s_waitcnt lgkmcnt(6)
v_mfma_f32_16x16x32_bf16 v[68:71], a[224:227], v[120:123], v[68:71]
ds_read_b64_tr_b16 a[204:205], v196 offset:40960
v_exp_f32 v93, v93
v_mfma_f32_16x16x32_bf16 v[76:79], a[224:227], v[136:139], v[76:79]
ds_read_b64_tr_b16 a[206:207], v196 offset:45056
v_cvt_pk_bf16_f32 v110, v92, v93
v_mfma_f32_16x16x32_bf16 v[56:59], a[180:183], v[96:99], v[56:59]
ds_read_b128 a[208:211], v188 offset:57344
v_exp_f32 v94, v94
v_mfma_f32_16x16x32_bf16 v[60:63], a[180:183], v[100:103], v[60:63]
v_exp_f32 v95, v95
v_mfma_f32_16x16x32_bf16 a[232:235], a[228:231], v[96:99], a[232:235]
v_cvt_pk_bf16_f32 v111, v94, v95
v_exp_f32 v144, v144
v_mfma_f32_16x16x32_bf16 v[68:71], a[184:187], v[124:127], v[68:71]
ds_read_b64_tr_b16 a[212:213], v197 offset:40960
buffer_load_dwordx4 v227, s[16:19], s43 offen offset:1024 nt lds
v_mfma_f32_16x16x32_bf16 v[76:79], a[184:187], v[140:143], v[76:79]
ds_read_b64_tr_b16 a[214:215], v197 offset:45056
s_waitcnt lgkmcnt(7)
v_mfma_f32_16x16x32_bf16 v[0:3], a[188:191], v[96:99], v[0:3]
ds_read_b128 a[216:219], v189 offset:57344
v_add_f32 v177, v177, v144
v_mfma_f32_16x16x32_bf16 v[4:7], a[188:191], v[100:103], v[4:7]
v_exp_f32 v145, v145
v_mfma_f32_16x16x32_bf16 a[16:19], a[188:191], a[24:27], a[16:19]
v_exp_f32 v146, v146
v_mfma_f32_16x16x32_bf16 a[236:239], a[228:231], v[100:103], a[236:239]
v_cvt_pk_bf16_f32 v152, v144, v145
v_add_f32 v177, v177, v145
v_mfma_f32_16x16x32_bf16 v[8:11], a[192:195], v[96:99], v[8:11]
ds_read_b64_tr_b16 a[220:221], v198 offset:40960
v_add_f32 v177, v177, v146
v_mfma_f32_16x16x32_bf16 v[12:15], a[192:195], v[100:103], v[12:15]
ds_read_b64_tr_b16 a[222:223], v198 offset:45056
v_exp_f32 v147, v147
v_mfma_f32_16x16x32_bf16 a[20:23], a[192:195], a[24:27], a[20:23]
v_cvt_pk_bf16_f32 v153, v146, v147
s_waitcnt lgkmcnt(6)
v_mfma_f32_16x16x32_bf16 v[80:83], a[196:199], v[112:115], v[156:159]
ds_read_b128 a[224:227], v186 offset:61440
ds_write_b64 v202, v[152:153] offset:2048
v_mfma_f32_16x16x32_bf16 v[88:91], a[196:199], v[128:131], v[160:163]
buffer_load_dwordx4 v226, s[16:19], s43 offen offset:2048 nt lds
v_mfma_f32_16x16x32_bf16 v[80:83], a[200:203], v[116:119], v[80:83]
ds_read_b64_tr_b16 a[180:181], v199 offset:40960
v_add_f32 v177, v177, v147
v_mfma_f32_16x16x32_bf16 v[88:91], a[200:203], v[132:135], v[88:91]
ds_read_b64_tr_b16 a[182:183], v199 offset:45056
v_exp_f32 v64, v64
v_mfma_f32_16x16x32_bf16 v[16:19], a[204:207], v[104:107], v[16:19]
ds_read_b128 a[184:187], v187 offset:61440
v_exp_f32 v65, v65
v_mfma_f32_16x16x32_bf16 v[20:23], a[204:207], v[108:111], v[20:23]
v_cvt_pk_bf16_f32 v96, v64, v65
s_waitcnt lgkmcnt(6)
v_mfma_f32_16x16x32_bf16 v[80:83], a[208:211], v[120:123], v[80:83]
ds_read_b64_tr_b16 a[188:189], v200 offset:40960
v_exp_f32 v66, v66
v_mfma_f32_16x16x32_bf16 v[88:91], a[208:211], v[136:139], v[88:91]
ds_read_b64_tr_b16 a[190:191], v200 offset:45056
v_exp_f32 v67, v67
v_mfma_f32_16x16x32_bf16 v[24:27], a[212:215], v[104:107], v[24:27]
ds_read_b128 a[192:195], v188 offset:61440
v_cvt_pk_bf16_f32 v97, v66, v67
v_mfma_f32_16x16x32_bf16 v[28:31], a[212:215], v[108:111], v[28:31]
v_exp_f32 v68, v68
v_mfma_f32_16x16x32_bf16 v[80:83], a[216:219], v[124:127], v[80:83]
ds_read_b64_tr_b16 a[196:197], v201 offset:40960
buffer_load_dwordx4 v227, s[16:19], s43 offen offset:3072 nt lds
v_mfma_f32_16x16x32_bf16 v[88:91], a[216:219], v[140:143], v[88:91]
ds_read_b64_tr_b16 a[198:199], v201 offset:45056
s_waitcnt lgkmcnt(6)
v_mfma_f32_16x16x32_bf16 v[32:35], a[220:223], v[104:107], v[32:35]
ds_read_b128 a[200:203], v189 offset:61440
v_exp_f32 v69, v69
v_mfma_f32_16x16x32_bf16 v[36:39], a[220:223], v[108:111], v[36:39]
v_exp_f32 v70, v70
v_mfma_f32_16x16x32_bf16 v[84:87], a[224:227], v[112:115], v[156:159]
ds_read_b64_tr_b16 a[204:205], v194 offset:40960
v_cvt_pk_bf16_f32 v98, v68, v69
v_mfma_f32_16x16x32_bf16 v[92:95], a[224:227], v[128:131], v[160:163]
ds_read_b64_tr_b16 a[206:207], v194 offset:45056
v_exp_f32 v71, v71
v_mfma_f32_16x16x32_bf16 v[40:43], a[180:183], v[104:107], v[40:43]
ds_read_b64_tr_b16 a[208:209], v195 offset:40960
v_cvt_pk_bf16_f32 v99, v70, v71
v_mfma_f32_16x16x32_bf16 v[44:47], a[180:183], v[108:111], v[44:47]
ds_read_b64_tr_b16 a[210:211], v195 offset:45056
s_waitcnt lgkmcnt(8)
v_mfma_f32_16x16x32_bf16 v[84:87], a[184:187], v[116:119], v[84:87]
v_exp_f32 v72, v72
v_mfma_f32_16x16x32_bf16 v[92:95], a[184:187], v[132:135], v[92:95]
v_exp_f32 v73, v73
v_mfma_f32_16x16x32_bf16 v[48:51], a[188:191], v[104:107], v[48:51]
s_waitcnt vmcnt(8)
s_barrier
v_mfma_f32_16x16x32_bf16 v[52:55], a[188:191], v[108:111], v[52:55]
ds_read_b128 a[212:215], v186 offset:0
s_waitcnt lgkmcnt(5)
v_mfma_f32_16x16x32_bf16 v[84:87], a[192:195], v[120:123], v[84:87]
ds_read_b128 a[216:219], v187 offset:0
s_add_u32 m0, s39, 32768
v_mfma_f32_16x16x32_bf16 v[92:95], a[192:195], v[136:139], v[92:95]
ds_read_b128 a[220:223], v190 offset:0
s_add_u32 s42, s42, 16384
v_mfma_f32_16x16x32_bf16 v[56:59], a[196:199], v[104:107], v[56:59]
ds_read_b64_tr_b16 a[224:225], v196 offset:49152
buffer_load_dwordx4 v222, s[12:15], s42 offen nt lds
v_mfma_f32_16x16x32_bf16 v[60:63], a[196:199], v[108:111], v[60:63]
ds_read_b64_tr_b16 a[226:227], v196 offset:53248
v_cvt_pk_bf16_f32 v100, v72, v73
v_mfma_f32_16x16x32_bf16 a[232:235], a[228:231], v[104:107], a[232:235]
v_exp_f32 v74, v74
v_mfma_f32_16x16x32_bf16 v[84:87], a[200:203], v[124:127], v[84:87]
ds_read_b128 a[180:183], v191 offset:0
v_exp_f32 v75, v75
v_mfma_f32_16x16x32_bf16 v[92:95], a[200:203], v[140:143], v[92:95]
v_cvt_pk_bf16_f32 v101, v74, v75
s_waitcnt lgkmcnt(6)
v_mfma_f32_16x16x32_bf16 v[0:3], a[204:207], v[104:107], v[0:3]
ds_read_b128 a[184:187], v188 offset:0
v_exp_f32 v76, v76
v_mfma_f32_16x16x32_bf16 v[4:7], a[204:207], v[108:111], v[4:7]
buffer_load_dwordx4 v223, s[12:15], s42 offen offset:1024 nt lds
v_mfma_f32_16x16x32_bf16 a[16:19], a[204:207], a[28:31], a[16:19]
v_exp_f32 v77, v77
v_mfma_f32_16x16x32_bf16 a[236:239], a[228:231], v[108:111], a[236:239]
v_exp_f32 v78, v78
v_mfma_f32_16x16x32_bf16 v[8:11], a[208:211], v[104:107], v[8:11]
ds_read_b128 a[188:191], v192 offset:0
v_cvt_pk_bf16_f32 v102, v76, v77
v_mfma_f32_16x16x32_bf16 v[12:15], a[208:211], v[108:111], v[12:15]
v_exp_f32 v79, v79
v_mfma_f32_16x16x32_bf16 a[20:23], a[208:211], a[28:31], a[20:23]
v_cvt_pk_bf16_f32 v103, v78, v79
s_waitcnt lgkmcnt(3)
v_mfma_f32_16x16x32_bf16 v[64:67], a[212:215], v[112:115], v[156:159]
ds_read_b64_tr_b16 a[192:193], v197 offset:49152
v_exp_f32 v80, v80
v_mfma_f32_16x16x32_bf16 v[72:75], a[212:215], v[128:131], v[160:163]
ds_read_b64_tr_b16 a[194:195], v197 offset:53248
v_exp_f32 v81, v81
v_mfma_f32_16x16x32_bf16 v[64:67], a[216:219], v[116:119], v[64:67]
ds_read_b128 a[196:199], v193 offset:0
v_cvt_pk_bf16_f32 v104, v80, v81
v_mfma_f32_16x16x32_bf16 v[72:75], a[216:219], v[132:135], v[72:75]
ds_read_b128 a[24:27], v203 offset:2048
buffer_load_dwordx4 v224, s[12:15], s42 offen offset:2048 nt lds
v_mfma_f32_16x16x32_bf16 v[144:147], a[220:223], a[0:3], v[164:167]
ds_read_b128 a[200:203], v189 offset:0
v_exp_f32 v82, v82
v_mfma_f32_16x16x32_bf16 v[16:19], a[224:227], v[96:99], v[16:19]
ds_read_b64_tr_b16 a[204:205], v198 offset:49152
v_exp_f32 v83, v83
v_mfma_f32_16x16x32_bf16 v[20:23], a[224:227], v[100:103], v[20:23]
ds_read_b64_tr_b16 a[206:207], v198 offset:53248
s_waitcnt lgkmcnt(5)
v_mfma_f32_16x16x32_bf16 v[144:147], a[180:183], a[4:7], v[144:147]
ds_read_b128 a[208:211], v186 offset:4096
v_cvt_pk_bf16_f32 v105, v82, v83
v_mfma_f32_16x16x32_bf16 v[64:67], a[184:187], v[120:123], v[64:67]
ds_read_b64_tr_b16 a[212:213], v199 offset:49152
v_exp_f32 v84, v84
v_mfma_f32_16x16x32_bf16 v[72:75], a[184:187], v[136:139], v[72:75]
ds_read_b64_tr_b16 a[214:215], v199 offset:53248
v_exp_f32 v85, v85
v_mfma_f32_16x16x32_bf16 v[144:147], a[188:191], a[8:11], v[144:147]
ds_read_b128 a[216:219], v187 offset:4096
v_cvt_pk_bf16_f32 v106, v84, v85
v_mfma_f32_16x16x32_bf16 v[24:27], a[192:195], v[96:99], v[24:27]
ds_read_b64_tr_b16 a[220:221], v200 offset:49152
v_exp_f32 v86, v86
v_mfma_f32_16x16x32_bf16 v[28:31], a[192:195], v[100:103], v[28:31]
ds_read_b64_tr_b16 a[222:223], v200 offset:53248
s_waitcnt lgkmcnt(5)
v_mfma_f32_16x16x32_bf16 v[144:147], a[196:199], a[12:15], v[144:147]
ds_read_b128 a[224:227], v188 offset:4096
buffer_load_dwordx4 v225, s[12:15], s42 offen offset:3072 nt lds
v_mfma_f32_16x16x32_bf16 v[64:67], a[200:203], v[124:127], v[64:67]
ds_read_b64_tr_b16 a[180:181], v201 offset:49152
v_exp_f32 v87, v87
v_mfma_f32_16x16x32_bf16 v[72:75], a[200:203], v[140:143], v[72:75]
ds_read_b64_tr_b16 a[182:183], v201 offset:53248
v_cvt_pk_bf16_f32 v107, v86, v87
v_mfma_f32_16x16x32_bf16 v[32:35], a[204:207], v[96:99], v[32:35]
ds_read_b128 a[28:31], v203 offset:3072
v_exp_f32 v88, v88
v_mfma_f32_16x16x32_bf16 v[36:39], a[204:207], v[100:103], v[36:39]
ds_read_b128 a[184:187], v189 offset:4096
v_exp_f32 v89, v89
v_mfma_f32_16x16x32_bf16 v[68:71], a[208:211], v[112:115], v[156:159]
ds_read_b64_tr_b16 a[188:189], v194 offset:49152
v_cvt_pk_bf16_f32 v108, v88, v89
v_mfma_f32_16x16x32_bf16 v[76:79], a[208:211], v[128:131], v[160:163]
ds_read_b64_tr_b16 a[190:191], v194 offset:53248
s_waitcnt lgkmcnt(7)
v_mfma_f32_16x16x32_bf16 v[40:43], a[212:215], v[96:99], v[40:43]
ds_read_b64_tr_b16 a[192:193], v195 offset:49152
v_exp_f32 v90, v90
v_mfma_f32_16x16x32_bf16 v[44:47], a[212:215], v[100:103], v[44:47]
ds_read_b64_tr_b16 a[194:195], v195 offset:53248
v_exp_f32 v91, v91
v_mfma_f32_16x16x32_bf16 v[68:71], a[216:219], v[116:119], v[68:71]
ds_read_b128 a[196:199], v186 offset:8192
s_add_u32 m0, s39, 81920
v_mfma_f32_16x16x32_bf16 v[76:79], a[216:219], v[132:135], v[76:79]
s_add_u32 s43, s43, 16384
buffer_load_dwordx4 v226, s[16:19], s43 offen nt lds
v_mfma_f32_16x16x32_bf16 v[48:51], a[220:223], v[96:99], v[48:51]
ds_read_b128 a[200:203], v187 offset:8192
v_cvt_pk_bf16_f32 v109, v90, v91
v_mfma_f32_16x16x32_bf16 v[52:55], a[220:223], v[100:103], v[52:55]
v_exp_f32 v92, v92
s_waitcnt lgkmcnt(6)
v_mfma_f32_16x16x32_bf16 v[68:71], a[224:227], v[120:123], v[68:71]
ds_read_b64_tr_b16 a[204:205], v196 offset:57344
v_exp_f32 v93, v93
v_mfma_f32_16x16x32_bf16 v[76:79], a[224:227], v[136:139], v[76:79]
ds_read_b64_tr_b16 a[206:207], v196 offset:61440
v_cvt_pk_bf16_f32 v110, v92, v93
v_mfma_f32_16x16x32_bf16 v[56:59], a[180:183], v[96:99], v[56:59]
ds_read_b128 a[208:211], v188 offset:8192
v_exp_f32 v94, v94
v_mfma_f32_16x16x32_bf16 v[60:63], a[180:183], v[100:103], v[60:63]
v_exp_f32 v95, v95
v_mfma_f32_16x16x32_bf16 a[232:235], a[228:231], v[96:99], a[232:235]
v_cvt_pk_bf16_f32 v111, v94, v95
v_exp_f32 v144, v144
v_mfma_f32_16x16x32_bf16 v[68:71], a[184:187], v[124:127], v[68:71]
ds_read_b64_tr_b16 a[212:213], v197 offset:57344
buffer_load_dwordx4 v227, s[16:19], s43 offen offset:1024 nt lds
v_mfma_f32_16x16x32_bf16 v[76:79], a[184:187], v[140:143], v[76:79]
ds_read_b64_tr_b16 a[214:215], v197 offset:61440
s_waitcnt lgkmcnt(7)
v_mfma_f32_16x16x32_bf16 v[0:3], a[188:191], v[96:99], v[0:3]
ds_read_b128 a[216:219], v189 offset:8192
v_add_f32 v177, v177, v144
v_mfma_f32_16x16x32_bf16 v[4:7], a[188:191], v[100:103], v[4:7]
v_exp_f32 v145, v145
v_mfma_f32_16x16x32_bf16 a[16:19], a[188:191], a[24:27], a[16:19]
v_exp_f32 v146, v146
v_mfma_f32_16x16x32_bf16 a[236:239], a[228:231], v[100:103], a[236:239]
v_cvt_pk_bf16_f32 v152, v144, v145
v_add_f32 v177, v177, v145
v_mfma_f32_16x16x32_bf16 v[8:11], a[192:195], v[96:99], v[8:11]
ds_read_b64_tr_b16 a[220:221], v198 offset:57344
v_add_f32 v177, v177, v146
v_mfma_f32_16x16x32_bf16 v[12:15], a[192:195], v[100:103], v[12:15]
ds_read_b64_tr_b16 a[222:223], v198 offset:61440
v_exp_f32 v147, v147
v_mfma_f32_16x16x32_bf16 a[20:23], a[192:195], a[24:27], a[20:23]
v_cvt_pk_bf16_f32 v153, v146, v147
s_waitcnt lgkmcnt(6)
v_mfma_f32_16x16x32_bf16 v[80:83], a[196:199], v[112:115], v[156:159]
ds_read_b128 a[224:227], v186 offset:12288
ds_write_b64 v202, v[152:153] offset:0
v_mfma_f32_16x16x32_bf16 v[88:91], a[196:199], v[128:131], v[160:163]
buffer_load_dwordx4 v226, s[16:19], s43 offen offset:2048 nt lds
v_mfma_f32_16x16x32_bf16 v[80:83], a[200:203], v[116:119], v[80:83]
ds_read_b64_tr_b16 a[180:181], v199 offset:57344
v_add_f32 v177, v177, v147
v_mfma_f32_16x16x32_bf16 v[88:91], a[200:203], v[132:135], v[88:91]
ds_read_b64_tr_b16 a[182:183], v199 offset:61440
v_exp_f32 v64, v64
v_mfma_f32_16x16x32_bf16 v[16:19], a[204:207], v[104:107], v[16:19]
ds_read_b128 a[184:187], v187 offset:12288
v_exp_f32 v65, v65
v_mfma_f32_16x16x32_bf16 v[20:23], a[204:207], v[108:111], v[20:23]
v_cvt_pk_bf16_f32 v96, v64, v65
s_waitcnt lgkmcnt(6)
v_mfma_f32_16x16x32_bf16 v[80:83], a[208:211], v[120:123], v[80:83]
ds_read_b64_tr_b16 a[188:189], v200 offset:57344
v_exp_f32 v66, v66
v_mfma_f32_16x16x32_bf16 v[88:91], a[208:211], v[136:139], v[88:91]
ds_read_b64_tr_b16 a[190:191], v200 offset:61440
v_exp_f32 v67, v67
v_mfma_f32_16x16x32_bf16 v[24:27], a[212:215], v[104:107], v[24:27]
ds_read_b128 a[192:195], v188 offset:12288
v_cvt_pk_bf16_f32 v97, v66, v67
v_mfma_f32_16x16x32_bf16 v[28:31], a[212:215], v[108:111], v[28:31]
v_exp_f32 v68, v68
v_mfma_f32_16x16x32_bf16 v[80:83], a[216:219], v[124:127], v[80:83]
ds_read_b64_tr_b16 a[196:197], v201 offset:57344
buffer_load_dwordx4 v227, s[16:19], s43 offen offset:3072 nt lds
v_mfma_f32_16x16x32_bf16 v[88:91], a[216:219], v[140:143], v[88:91]
ds_read_b64_tr_b16 a[198:199], v201 offset:61440
s_waitcnt lgkmcnt(6)
v_mfma_f32_16x16x32_bf16 v[32:35], a[220:223], v[104:107], v[32:35]
ds_read_b128 a[200:203], v189 offset:12288
v_exp_f32 v69, v69
v_mfma_f32_16x16x32_bf16 v[36:39], a[220:223], v[108:111], v[36:39]
v_exp_f32 v70, v70
v_mfma_f32_16x16x32_bf16 v[84:87], a[224:227], v[112:115], v[156:159]
ds_read_b64_tr_b16 a[204:205], v194 offset:57344
v_cvt_pk_bf16_f32 v98, v68, v69
v_mfma_f32_16x16x32_bf16 v[92:95], a[224:227], v[128:131], v[160:163]
ds_read_b64_tr_b16 a[206:207], v194 offset:61440
v_exp_f32 v71, v71
v_mfma_f32_16x16x32_bf16 v[40:43], a[180:183], v[104:107], v[40:43]
ds_read_b64_tr_b16 a[208:209], v195 offset:57344
v_cvt_pk_bf16_f32 v99, v70, v71
v_mfma_f32_16x16x32_bf16 v[44:47], a[180:183], v[108:111], v[44:47]
ds_read_b64_tr_b16 a[210:211], v195 offset:61440
s_waitcnt lgkmcnt(8)
v_mfma_f32_16x16x32_bf16 v[84:87], a[184:187], v[116:119], v[84:87]
v_exp_f32 v72, v72
v_mfma_f32_16x16x32_bf16 v[92:95], a[184:187], v[132:135], v[92:95]
v_exp_f32 v73, v73
v_mfma_f32_16x16x32_bf16 v[48:51], a[188:191], v[104:107], v[48:51]
s_waitcnt vmcnt(8)
s_barrier
v_mfma_f32_16x16x32_bf16 v[52:55], a[188:191], v[108:111], v[52:55]
ds_read_b128 a[212:215], v186 offset:16384
s_waitcnt lgkmcnt(5)
v_mfma_f32_16x16x32_bf16 v[84:87], a[192:195], v[120:123], v[84:87]
ds_read_b128 a[216:219], v187 offset:16384
s_add_u32 m0, s39, 49152
v_mfma_f32_16x16x32_bf16 v[92:95], a[192:195], v[136:139], v[92:95]
ds_read_b128 a[220:223], v190 offset:16384
s_add_u32 s42, s42, 16384
v_mfma_f32_16x16x32_bf16 v[56:59], a[196:199], v[104:107], v[56:59]
ds_read_b64_tr_b16 a[224:225], v196 offset:0
buffer_load_dwordx4 v222, s[12:15], s42 offen nt lds
v_mfma_f32_16x16x32_bf16 v[60:63], a[196:199], v[108:111], v[60:63]
ds_read_b64_tr_b16 a[226:227], v196 offset:4096
v_cvt_pk_bf16_f32 v100, v72, v73
v_mfma_f32_16x16x32_bf16 a[232:235], a[228:231], v[104:107], a[232:235]
v_exp_f32 v74, v74
v_mfma_f32_16x16x32_bf16 v[84:87], a[200:203], v[124:127], v[84:87]
ds_read_b128 a[180:183], v191 offset:16384
v_exp_f32 v75, v75
v_mfma_f32_16x16x32_bf16 v[92:95], a[200:203], v[140:143], v[92:95]
v_cvt_pk_bf16_f32 v101, v74, v75
s_waitcnt lgkmcnt(6)
v_mfma_f32_16x16x32_bf16 v[0:3], a[204:207], v[104:107], v[0:3]
ds_read_b128 a[184:187], v188 offset:16384
v_exp_f32 v76, v76
v_mfma_f32_16x16x32_bf16 v[4:7], a[204:207], v[108:111], v[4:7]
buffer_load_dwordx4 v223, s[12:15], s42 offen offset:1024 nt lds
v_mfma_f32_16x16x32_bf16 a[16:19], a[204:207], a[28:31], a[16:19]
v_exp_f32 v77, v77
v_mfma_f32_16x16x32_bf16 a[236:239], a[228:231], v[108:111], a[236:239]
v_exp_f32 v78, v78
v_mfma_f32_16x16x32_bf16 v[8:11], a[208:211], v[104:107], v[8:11]
ds_read_b128 a[188:191], v192 offset:16384
v_cvt_pk_bf16_f32 v102, v76, v77
v_mfma_f32_16x16x32_bf16 v[12:15], a[208:211], v[108:111], v[12:15]
v_exp_f32 v79, v79
v_mfma_f32_16x16x32_bf16 a[20:23], a[208:211], a[28:31], a[20:23]
v_cvt_pk_bf16_f32 v103, v78, v79
s_waitcnt lgkmcnt(3)
v_mfma_f32_16x16x32_bf16 v[64:67], a[212:215], v[112:115], v[156:159]
ds_read_b64_tr_b16 a[192:193], v197 offset:0
v_exp_f32 v80, v80
v_mfma_f32_16x16x32_bf16 v[72:75], a[212:215], v[128:131], v[160:163]
ds_read_b64_tr_b16 a[194:195], v197 offset:4096
v_exp_f32 v81, v81
v_mfma_f32_16x16x32_bf16 v[64:67], a[216:219], v[116:119], v[64:67]
ds_read_b128 a[196:199], v193 offset:16384
v_cvt_pk_bf16_f32 v104, v80, v81
v_mfma_f32_16x16x32_bf16 v[72:75], a[216:219], v[132:135], v[72:75]
ds_read_b128 a[24:27], v203 offset:0
buffer_load_dwordx4 v224, s[12:15], s42 offen offset:2048 nt lds
v_mfma_f32_16x16x32_bf16 v[144:147], a[220:223], a[0:3], v[164:167]
ds_read_b128 a[200:203], v189 offset:16384
v_exp_f32 v82, v82
v_mfma_f32_16x16x32_bf16 v[16:19], a[224:227], v[96:99], v[16:19]
ds_read_b64_tr_b16 a[204:205], v198 offset:0
v_exp_f32 v83, v83
v_mfma_f32_16x16x32_bf16 v[20:23], a[224:227], v[100:103], v[20:23]
ds_read_b64_tr_b16 a[206:207], v198 offset:4096
s_waitcnt lgkmcnt(5)
v_mfma_f32_16x16x32_bf16 v[144:147], a[180:183], a[4:7], v[144:147]
ds_read_b128 a[208:211], v186 offset:20480
v_cvt_pk_bf16_f32 v105, v82, v83
v_mfma_f32_16x16x32_bf16 v[64:67], a[184:187], v[120:123], v[64:67]
ds_read_b64_tr_b16 a[212:213], v199 offset:0
v_exp_f32 v84, v84
v_mfma_f32_16x16x32_bf16 v[72:75], a[184:187], v[136:139], v[72:75]
ds_read_b64_tr_b16 a[214:215], v199 offset:4096
v_exp_f32 v85, v85
v_mfma_f32_16x16x32_bf16 v[144:147], a[188:191], a[8:11], v[144:147]
ds_read_b128 a[216:219], v187 offset:20480
v_cvt_pk_bf16_f32 v106, v84, v85
v_mfma_f32_16x16x32_bf16 v[24:27], a[192:195], v[96:99], v[24:27]
ds_read_b64_tr_b16 a[220:221], v200 offset:0
v_exp_f32 v86, v86
v_mfma_f32_16x16x32_bf16 v[28:31], a[192:195], v[100:103], v[28:31]
ds_read_b64_tr_b16 a[222:223], v200 offset:4096
s_waitcnt lgkmcnt(5)
v_mfma_f32_16x16x32_bf16 v[144:147], a[196:199], a[12:15], v[144:147]
ds_read_b128 a[224:227], v188 offset:20480
buffer_load_dwordx4 v225, s[12:15], s42 offen offset:3072 nt lds
v_mfma_f32_16x16x32_bf16 v[64:67], a[200:203], v[124:127], v[64:67]
ds_read_b64_tr_b16 a[180:181], v201 offset:0
v_exp_f32 v87, v87
v_mfma_f32_16x16x32_bf16 v[72:75], a[200:203], v[140:143], v[72:75]
ds_read_b64_tr_b16 a[182:183], v201 offset:4096
v_cvt_pk_bf16_f32 v107, v86, v87
v_mfma_f32_16x16x32_bf16 v[32:35], a[204:207], v[96:99], v[32:35]
ds_read_b128 a[28:31], v203 offset:1024
v_exp_f32 v88, v88
v_mfma_f32_16x16x32_bf16 v[36:39], a[204:207], v[100:103], v[36:39]
ds_read_b128 a[184:187], v189 offset:20480
v_exp_f32 v89, v89
v_mfma_f32_16x16x32_bf16 v[68:71], a[208:211], v[112:115], v[156:159]
ds_read_b64_tr_b16 a[188:189], v194 offset:0
v_cvt_pk_bf16_f32 v108, v88, v89
v_mfma_f32_16x16x32_bf16 v[76:79], a[208:211], v[128:131], v[160:163]
ds_read_b64_tr_b16 a[190:191], v194 offset:4096
s_waitcnt lgkmcnt(7)
v_mfma_f32_16x16x32_bf16 v[40:43], a[212:215], v[96:99], v[40:43]
ds_read_b64_tr_b16 a[192:193], v195 offset:0
v_exp_f32 v90, v90
v_mfma_f32_16x16x32_bf16 v[44:47], a[212:215], v[100:103], v[44:47]
ds_read_b64_tr_b16 a[194:195], v195 offset:4096
v_exp_f32 v91, v91
v_mfma_f32_16x16x32_bf16 v[68:71], a[216:219], v[116:119], v[68:71]
ds_read_b128 a[196:199], v186 offset:24576
s_add_u32 m0, s39, 98304
v_mfma_f32_16x16x32_bf16 v[76:79], a[216:219], v[132:135], v[76:79]
s_add_u32 s43, s43, 16384
buffer_load_dwordx4 v226, s[16:19], s43 offen nt lds
v_mfma_f32_16x16x32_bf16 v[48:51], a[220:223], v[96:99], v[48:51]
ds_read_b128 a[200:203], v187 offset:24576
v_cvt_pk_bf16_f32 v109, v90, v91
v_mfma_f32_16x16x32_bf16 v[52:55], a[220:223], v[100:103], v[52:55]
v_exp_f32 v92, v92
s_waitcnt lgkmcnt(6)
v_mfma_f32_16x16x32_bf16 v[68:71], a[224:227], v[120:123], v[68:71]
ds_read_b64_tr_b16 a[204:205], v196 offset:8192
v_exp_f32 v93, v93
v_mfma_f32_16x16x32_bf16 v[76:79], a[224:227], v[136:139], v[76:79]
ds_read_b64_tr_b16 a[206:207], v196 offset:12288
v_cvt_pk_bf16_f32 v110, v92, v93
v_mfma_f32_16x16x32_bf16 v[56:59], a[180:183], v[96:99], v[56:59]
ds_read_b128 a[208:211], v188 offset:24576
v_exp_f32 v94, v94
v_mfma_f32_16x16x32_bf16 v[60:63], a[180:183], v[100:103], v[60:63]
v_exp_f32 v95, v95
v_mfma_f32_16x16x32_bf16 a[232:235], a[228:231], v[96:99], a[232:235]
v_cvt_pk_bf16_f32 v111, v94, v95
v_exp_f32 v144, v144
v_mfma_f32_16x16x32_bf16 v[68:71], a[184:187], v[124:127], v[68:71]
ds_read_b64_tr_b16 a[212:213], v197 offset:8192
buffer_load_dwordx4 v227, s[16:19], s43 offen offset:1024 nt lds
v_mfma_f32_16x16x32_bf16 v[76:79], a[184:187], v[140:143], v[76:79]
ds_read_b64_tr_b16 a[214:215], v197 offset:12288
s_waitcnt lgkmcnt(7)
v_mfma_f32_16x16x32_bf16 v[0:3], a[188:191], v[96:99], v[0:3]
ds_read_b128 a[216:219], v189 offset:24576
v_add_f32 v177, v177, v144
v_mfma_f32_16x16x32_bf16 v[4:7], a[188:191], v[100:103], v[4:7]
v_exp_f32 v145, v145
v_mfma_f32_16x16x32_bf16 a[16:19], a[188:191], a[24:27], a[16:19]
v_exp_f32 v146, v146
v_mfma_f32_16x16x32_bf16 a[236:239], a[228:231], v[100:103], a[236:239]
v_cvt_pk_bf16_f32 v152, v144, v145
v_add_f32 v177, v177, v145
v_mfma_f32_16x16x32_bf16 v[8:11], a[192:195], v[96:99], v[8:11]
ds_read_b64_tr_b16 a[220:221], v198 offset:8192
v_add_f32 v177, v177, v146
v_mfma_f32_16x16x32_bf16 v[12:15], a[192:195], v[100:103], v[12:15]
ds_read_b64_tr_b16 a[222:223], v198 offset:12288
v_exp_f32 v147, v147
v_mfma_f32_16x16x32_bf16 a[20:23], a[192:195], a[24:27], a[20:23]
v_cvt_pk_bf16_f32 v153, v146, v147
s_waitcnt lgkmcnt(6)
v_mfma_f32_16x16x32_bf16 v[80:83], a[196:199], v[112:115], v[156:159]
ds_read_b128 a[224:227], v186 offset:28672
ds_write_b64 v202, v[152:153] offset:2048
v_mfma_f32_16x16x32_bf16 v[88:91], a[196:199], v[128:131], v[160:163]
buffer_load_dwordx4 v226, s[16:19], s43 offen offset:2048 nt lds
v_mfma_f32_16x16x32_bf16 v[80:83], a[200:203], v[116:119], v[80:83]
ds_read_b64_tr_b16 a[180:181], v199 offset:8192
v_add_f32 v177, v177, v147
v_mfma_f32_16x16x32_bf16 v[88:91], a[200:203], v[132:135], v[88:91]
ds_read_b64_tr_b16 a[182:183], v199 offset:12288
v_exp_f32 v64, v64
v_mfma_f32_16x16x32_bf16 v[16:19], a[204:207], v[104:107], v[16:19]
ds_read_b128 a[184:187], v187 offset:28672
v_exp_f32 v65, v65
v_mfma_f32_16x16x32_bf16 v[20:23], a[204:207], v[108:111], v[20:23]
v_cvt_pk_bf16_f32 v96, v64, v65
s_waitcnt lgkmcnt(6)
v_mfma_f32_16x16x32_bf16 v[80:83], a[208:211], v[120:123], v[80:83]
ds_read_b64_tr_b16 a[188:189], v200 offset:8192
v_exp_f32 v66, v66
v_mfma_f32_16x16x32_bf16 v[88:91], a[208:211], v[136:139], v[88:91]
ds_read_b64_tr_b16 a[190:191], v200 offset:12288
v_exp_f32 v67, v67
v_mfma_f32_16x16x32_bf16 v[24:27], a[212:215], v[104:107], v[24:27]
ds_read_b128 a[192:195], v188 offset:28672
v_cvt_pk_bf16_f32 v97, v66, v67
v_mfma_f32_16x16x32_bf16 v[28:31], a[212:215], v[108:111], v[28:31]
v_exp_f32 v68, v68
v_mfma_f32_16x16x32_bf16 v[80:83], a[216:219], v[124:127], v[80:83]
ds_read_b64_tr_b16 a[196:197], v201 offset:8192
buffer_load_dwordx4 v227, s[16:19], s43 offen offset:3072 nt lds
v_mfma_f32_16x16x32_bf16 v[88:91], a[216:219], v[140:143], v[88:91]
ds_read_b64_tr_b16 a[198:199], v201 offset:12288
s_waitcnt lgkmcnt(6)
v_mfma_f32_16x16x32_bf16 v[32:35], a[220:223], v[104:107], v[32:35]
ds_read_b128 a[200:203], v189 offset:28672
v_exp_f32 v69, v69
v_mfma_f32_16x16x32_bf16 v[36:39], a[220:223], v[108:111], v[36:39]
v_exp_f32 v70, v70
v_mfma_f32_16x16x32_bf16 v[84:87], a[224:227], v[112:115], v[156:159]
ds_read_b64_tr_b16 a[204:205], v194 offset:8192
v_cvt_pk_bf16_f32 v98, v68, v69
v_mfma_f32_16x16x32_bf16 v[92:95], a[224:227], v[128:131], v[160:163]
ds_read_b64_tr_b16 a[206:207], v194 offset:12288
v_exp_f32 v71, v71
v_mfma_f32_16x16x32_bf16 v[40:43], a[180:183], v[104:107], v[40:43]
ds_read_b64_tr_b16 a[208:209], v195 offset:8192
v_cvt_pk_bf16_f32 v99, v70, v71
v_mfma_f32_16x16x32_bf16 v[44:47], a[180:183], v[108:111], v[44:47]
ds_read_b64_tr_b16 a[210:211], v195 offset:12288
s_waitcnt lgkmcnt(8)
v_mfma_f32_16x16x32_bf16 v[84:87], a[184:187], v[116:119], v[84:87]
v_exp_f32 v72, v72
v_mfma_f32_16x16x32_bf16 v[92:95], a[184:187], v[132:135], v[92:95]
v_exp_f32 v73, v73
v_mfma_f32_16x16x32_bf16 v[48:51], a[188:191], v[104:107], v[48:51]
s_waitcnt vmcnt(8)
s_barrier
v_mfma_f32_16x16x32_bf16 v[52:55], a[188:191], v[108:111], v[52:55]
ds_read_b128 a[212:215], v186 offset:32768
s_waitcnt lgkmcnt(5)
v_mfma_f32_16x16x32_bf16 v[84:87], a[192:195], v[120:123], v[84:87]
ds_read_b128 a[216:219], v187 offset:32768
s_add_u32 m0, s39, 114688
v_mfma_f32_16x16x32_bf16 v[92:95], a[192:195], v[136:139], v[92:95]
ds_read_b128 a[220:223], v190 offset:32768
s_add_u32 s43, s43, 16384
v_mfma_f32_16x16x32_bf16 v[56:59], a[196:199], v[104:107], v[56:59]
ds_read_b64_tr_b16 a[224:225], v196 offset:16384
buffer_load_dwordx4 v226, s[16:19], s43 offen nt lds
v_mfma_f32_16x16x32_bf16 v[60:63], a[196:199], v[108:111], v[60:63]
ds_read_b64_tr_b16 a[226:227], v196 offset:20480
v_cvt_pk_bf16_f32 v100, v72, v73
v_mfma_f32_16x16x32_bf16 a[232:235], a[228:231], v[104:107], a[232:235]
v_exp_f32 v74, v74
v_mfma_f32_16x16x32_bf16 v[84:87], a[200:203], v[124:127], v[84:87]
ds_read_b128 a[180:183], v191 offset:32768
v_exp_f32 v75, v75
v_mfma_f32_16x16x32_bf16 v[92:95], a[200:203], v[140:143], v[92:95]
v_cvt_pk_bf16_f32 v101, v74, v75
s_waitcnt lgkmcnt(6)
v_mfma_f32_16x16x32_bf16 v[0:3], a[204:207], v[104:107], v[0:3]
ds_read_b128 a[184:187], v188 offset:32768
v_exp_f32 v76, v76
v_mfma_f32_16x16x32_bf16 v[4:7], a[204:207], v[108:111], v[4:7]
v_exp_f32 v77, v77
v_mfma_f32_16x16x32_bf16 a[16:19], a[204:207], a[28:31], a[16:19]
v_exp_f32 v78, v78
v_mfma_f32_16x16x32_bf16 a[236:239], a[228:231], v[108:111], a[236:239]
v_cvt_pk_bf16_f32 v102, v76, v77
v_exp_f32 v79, v79
v_mfma_f32_16x16x32_bf16 v[8:11], a[208:211], v[104:107], v[8:11]
ds_read_b128 a[188:191], v192 offset:32768
v_cvt_pk_bf16_f32 v103, v78, v79
v_mfma_f32_16x16x32_bf16 v[12:15], a[208:211], v[108:111], v[12:15]
v_mfma_f32_16x16x32_bf16 a[20:23], a[208:211], a[28:31], a[20:23]
s_waitcnt lgkmcnt(3)
v_mfma_f32_16x16x32_bf16 v[64:67], a[212:215], v[112:115], v[156:159]
ds_read_b64_tr_b16 a[192:193], v197 offset:16384
buffer_load_dwordx4 v227, s[16:19], s43 offen offset:1024 nt lds
v_mfma_f32_16x16x32_bf16 v[72:75], a[212:215], v[128:131], v[160:163]
ds_read_b64_tr_b16 a[194:195], v197 offset:20480
v_exp_f32 v80, v80
v_mfma_f32_16x16x32_bf16 v[64:67], a[216:219], v[116:119], v[64:67]
ds_read_b128 a[196:199], v193 offset:32768
v_exp_f32 v81, v81
v_mfma_f32_16x16x32_bf16 v[72:75], a[216:219], v[132:135], v[72:75]
ds_read_b128 a[24:27], v203 offset:2048
v_cvt_pk_bf16_f32 v104, v80, v81
v_mfma_f32_16x16x32_bf16 v[144:147], a[220:223], a[0:3], v[164:167]
ds_read_b128 a[200:203], v189 offset:32768
v_exp_f32 v82, v82
v_mfma_f32_16x16x32_bf16 v[16:19], a[224:227], v[96:99], v[16:19]
ds_read_b64_tr_b16 a[204:205], v198 offset:16384
v_exp_f32 v83, v83
v_mfma_f32_16x16x32_bf16 v[20:23], a[224:227], v[100:103], v[20:23]
ds_read_b64_tr_b16 a[206:207], v198 offset:20480
s_waitcnt lgkmcnt(5)
v_mfma_f32_16x16x32_bf16 v[144:147], a[180:183], a[4:7], v[144:147]
ds_read_b128 a[208:211], v186 offset:36864
v_cvt_pk_bf16_f32 v105, v82, v83
v_mfma_f32_16x16x32_bf16 v[64:67], a[184:187], v[120:123], v[64:67]
ds_read_b64_tr_b16 a[212:213], v199 offset:16384
v_exp_f32 v84, v84
v_mfma_f32_16x16x32_bf16 v[72:75], a[184:187], v[136:139], v[72:75]
ds_read_b64_tr_b16 a[214:215], v199 offset:20480
v_exp_f32 v85, v85
v_mfma_f32_16x16x32_bf16 v[144:147], a[188:191], a[8:11], v[144:147]
ds_read_b128 a[216:219], v187 offset:36864
v_cvt_pk_bf16_f32 v106, v84, v85
v_mfma_f32_16x16x32_bf16 v[24:27], a[192:195], v[96:99], v[24:27]
ds_read_b64_tr_b16 a[220:221], v200 offset:16384
v_exp_f32 v86, v86
v_mfma_f32_16x16x32_bf16 v[28:31], a[192:195], v[100:103], v[28:31]
ds_read_b64_tr_b16 a[222:223], v200 offset:20480
s_waitcnt lgkmcnt(5)
v_mfma_f32_16x16x32_bf16 v[144:147], a[196:199], a[12:15], v[144:147]
ds_read_b128 a[224:227], v188 offset:36864
v_exp_f32 v87, v87
v_mfma_f32_16x16x32_bf16 v[64:67], a[200:203], v[124:127], v[64:67]
ds_read_b64_tr_b16 a[180:181], v201 offset:16384
v_cvt_pk_bf16_f32 v107, v86, v87
v_mfma_f32_16x16x32_bf16 v[72:75], a[200:203], v[140:143], v[72:75]
ds_read_b64_tr_b16 a[182:183], v201 offset:20480
buffer_load_dwordx4 v226, s[16:19], s43 offen offset:2048 nt lds
v_mfma_f32_16x16x32_bf16 v[32:35], a[204:207], v[96:99], v[32:35]
ds_read_b128 a[28:31], v203 offset:3072
v_exp_f32 v88, v88
v_mfma_f32_16x16x32_bf16 v[36:39], a[204:207], v[100:103], v[36:39]
ds_read_b128 a[184:187], v189 offset:36864
v_exp_f32 v89, v89
v_mfma_f32_16x16x32_bf16 v[68:71], a[208:211], v[112:115], v[156:159]
ds_read_b64_tr_b16 a[188:189], v194 offset:16384
v_cvt_pk_bf16_f32 v108, v88, v89
v_mfma_f32_16x16x32_bf16 v[76:79], a[208:211], v[128:131], v[160:163]
ds_read_b64_tr_b16 a[190:191], v194 offset:20480
s_waitcnt lgkmcnt(7)
v_mfma_f32_16x16x32_bf16 v[40:43], a[212:215], v[96:99], v[40:43]
ds_read_b64_tr_b16 a[192:193], v195 offset:16384
v_exp_f32 v90, v90
v_mfma_f32_16x16x32_bf16 v[44:47], a[212:215], v[100:103], v[44:47]
ds_read_b64_tr_b16 a[194:195], v195 offset:20480
v_exp_f32 v91, v91
v_mfma_f32_16x16x32_bf16 v[68:71], a[216:219], v[116:119], v[68:71]
ds_read_b128 a[196:199], v186 offset:40960
v_cvt_pk_bf16_f32 v109, v90, v91
v_mfma_f32_16x16x32_bf16 v[76:79], a[216:219], v[132:135], v[76:79]
v_exp_f32 v92, v92
v_mfma_f32_16x16x32_bf16 v[48:51], a[220:223], v[96:99], v[48:51]
ds_read_b128 a[200:203], v187 offset:40960
v_exp_f32 v93, v93
v_mfma_f32_16x16x32_bf16 v[52:55], a[220:223], v[100:103], v[52:55]
v_cvt_pk_bf16_f32 v110, v92, v93
s_waitcnt lgkmcnt(6)
v_mfma_f32_16x16x32_bf16 v[68:71], a[224:227], v[120:123], v[68:71]
ds_read_b64_tr_b16 a[204:205], v196 offset:24576
v_exp_f32 v94, v94
v_mfma_f32_16x16x32_bf16 v[76:79], a[224:227], v[136:139], v[76:79]
ds_read_b64_tr_b16 a[206:207], v196 offset:28672
v_exp_f32 v95, v95
v_mfma_f32_16x16x32_bf16 v[56:59], a[180:183], v[96:99], v[56:59]
ds_read_b128 a[208:211], v188 offset:40960
v_cvt_pk_bf16_f32 v111, v94, v95
v_mfma_f32_16x16x32_bf16 v[60:63], a[180:183], v[100:103], v[60:63]
v_exp_f32 v144, v144
v_mfma_f32_16x16x32_bf16 a[232:235], a[228:231], v[96:99], a[232:235]
buffer_load_dwordx4 v227, s[16:19], s43 offen offset:3072 nt lds
v_mfma_f32_16x16x32_bf16 v[68:71], a[184:187], v[124:127], v[68:71]
ds_read_b64_tr_b16 a[212:213], v197 offset:24576
v_add_f32 v177, v177, v144
v_mfma_f32_16x16x32_bf16 v[76:79], a[184:187], v[140:143], v[76:79]
ds_read_b64_tr_b16 a[214:215], v197 offset:28672
s_waitcnt lgkmcnt(7)
v_mfma_f32_16x16x32_bf16 v[0:3], a[188:191], v[96:99], v[0:3]
ds_read_b128 a[216:219], v189 offset:40960
v_exp_f32 v145, v145
v_mfma_f32_16x16x32_bf16 v[4:7], a[188:191], v[100:103], v[4:7]
v_exp_f32 v146, v146
v_mfma_f32_16x16x32_bf16 a[16:19], a[188:191], a[24:27], a[16:19]
v_cvt_pk_bf16_f32 v152, v144, v145
v_add_f32 v177, v177, v145
v_mfma_f32_16x16x32_bf16 a[236:239], a[228:231], v[100:103], a[236:239]
v_exp_f32 v147, v147
v_mfma_f32_16x16x32_bf16 v[8:11], a[192:195], v[96:99], v[8:11]
ds_read_b64_tr_b16 a[220:221], v198 offset:24576
v_cvt_pk_bf16_f32 v153, v146, v147
v_mfma_f32_16x16x32_bf16 v[12:15], a[192:195], v[100:103], v[12:15]
ds_read_b64_tr_b16 a[222:223], v198 offset:28672
ds_write_b64 v202, v[152:153] offset:0
v_mfma_f32_16x16x32_bf16 a[20:23], a[192:195], a[24:27], a[20:23]
v_add_f32 v177, v177, v146
s_waitcnt lgkmcnt(6)
v_mfma_f32_16x16x32_bf16 v[80:83], a[196:199], v[112:115], v[156:159]
ds_read_b128 a[224:227], v186 offset:45056
v_add_f32 v177, v177, v147
v_mfma_f32_16x16x32_bf16 v[88:91], a[196:199], v[128:131], v[160:163]
v_exp_f32 v64, v64
v_mfma_f32_16x16x32_bf16 v[80:83], a[200:203], v[116:119], v[80:83]
ds_read_b64_tr_b16 a[180:181], v199 offset:24576
v_exp_f32 v65, v65
v_mfma_f32_16x16x32_bf16 v[88:91], a[200:203], v[132:135], v[88:91]
ds_read_b64_tr_b16 a[182:183], v199 offset:28672
v_cvt_pk_bf16_f32 v96, v64, v65
v_mfma_f32_16x16x32_bf16 v[16:19], a[204:207], v[104:107], v[16:19]
ds_read_b128 a[184:187], v187 offset:45056
v_exp_f32 v66, v66
v_mfma_f32_16x16x32_bf16 v[20:23], a[204:207], v[108:111], v[20:23]
v_subrev_u32 v178, 155648, v202
s_waitcnt lgkmcnt(6)
v_mfma_f32_16x16x32_bf16 v[80:83], a[208:211], v[120:123], v[80:83]
ds_read_b64_tr_b16 a[188:189], v200 offset:24576
v_subrev_u32 v179, 155648, v203
v_mfma_f32_16x16x32_bf16 v[88:91], a[208:211], v[136:139], v[88:91]
ds_read_b64_tr_b16 a[190:191], v200 offset:28672
v_exp_f32 v67, v67
v_mfma_f32_16x16x32_bf16 v[24:27], a[212:215], v[104:107], v[24:27]
ds_read_b128 a[192:195], v188 offset:45056
v_cvt_pk_bf16_f32 v97, v66, v67
v_mfma_f32_16x16x32_bf16 v[28:31], a[212:215], v[108:111], v[28:31]
v_exp_f32 v68, v68
v_mfma_f32_16x16x32_bf16 v[80:83], a[216:219], v[124:127], v[80:83]
ds_read_b64_tr_b16 a[196:197], v201 offset:24576
v_exp_f32 v69, v69
v_mfma_f32_16x16x32_bf16 v[88:91], a[216:219], v[140:143], v[88:91]
ds_read_b64_tr_b16 a[198:199], v201 offset:28672
s_waitcnt lgkmcnt(6)
v_mfma_f32_16x16x32_bf16 v[32:35], a[220:223], v[104:107], v[32:35]
ds_read_b128 a[200:203], v189 offset:45056
v_cvt_pk_bf16_f32 v98, v68, v69
v_mfma_f32_16x16x32_bf16 v[36:39], a[220:223], v[108:111], v[36:39]
v_exp_f32 v70, v70
v_mfma_f32_16x16x32_bf16 v[84:87], a[224:227], v[112:115], v[156:159]
ds_read_b64_tr_b16 a[204:205], v194 offset:24576
v_exp_f32 v71, v71
v_mfma_f32_16x16x32_bf16 v[92:95], a[224:227], v[128:131], v[160:163]
ds_read_b64_tr_b16 a[206:207], v194 offset:28672
v_cvt_pk_bf16_f32 v99, v70, v71
v_mfma_f32_16x16x32_bf16 v[40:43], a[180:183], v[104:107], v[40:43]
ds_read_b64_tr_b16 a[208:209], v195 offset:24576
v_exp_f32 v72, v72
v_mfma_f32_16x16x32_bf16 v[44:47], a[180:183], v[108:111], v[44:47]
ds_read_b64_tr_b16 a[210:211], v195 offset:28672
s_waitcnt lgkmcnt(8)
v_mfma_f32_16x16x32_bf16 v[84:87], a[184:187], v[116:119], v[84:87]
v_exp_f32 v73, v73
v_mfma_f32_16x16x32_bf16 v[92:95], a[184:187], v[132:135], v[92:95]
v_exp_f32 v74, v74
v_mfma_f32_16x16x32_bf16 v[48:51], a[188:191], v[104:107], v[48:51]
s_waitcnt vmcnt(4)
s_barrier
v_mfma_f32_16x16x32_bf16 v[52:55], a[188:191], v[108:111], v[52:55]
ds_read_b128 a[212:215], v186 offset:49152
s_waitcnt lgkmcnt(5)
v_mfma_f32_16x16x32_bf16 v[84:87], a[192:195], v[120:123], v[84:87]
ds_read_b128 a[216:219], v187 offset:49152
s_mul_i32 s44, s46, 524288
v_mfma_f32_16x16x32_bf16 v[92:95], a[192:195], v[136:139], v[92:95]
ds_read_b128 a[220:223], v190 offset:49152
s_add_u32 s44, s44, s52
v_mfma_f32_16x16x32_bf16 v[56:59], a[196:199], v[104:107], v[56:59]
ds_read_b64_tr_b16 a[224:225], v196 offset:32768
v_cvt_pk_bf16_f32 v100, v72, v73
v_mfma_f32_16x16x32_bf16 v[60:63], a[196:199], v[108:111], v[60:63]
ds_read_b64_tr_b16 a[226:227], v196 offset:36864
v_exp_f32 v75, v75
v_mfma_f32_16x16x32_bf16 a[232:235], a[228:231], v[104:107], a[232:235]
v_exp_f32 v76, v76
v_mfma_f32_16x16x32_bf16 v[84:87], a[200:203], v[124:127], v[84:87]
ds_read_b128 a[180:183], v191 offset:49152
v_cvt_pk_bf16_f32 v101, v74, v75
v_mfma_f32_16x16x32_bf16 v[92:95], a[200:203], v[140:143], v[92:95]
v_exp_f32 v77, v77
s_waitcnt lgkmcnt(6)
v_mfma_f32_16x16x32_bf16 v[0:3], a[204:207], v[104:107], v[0:3]
ds_read_b128 a[184:187], v188 offset:49152
v_cvt_pk_bf16_f32 v102, v76, v77
v_mfma_f32_16x16x32_bf16 v[4:7], a[204:207], v[108:111], v[4:7]
s_lshl_b32 s45, s46, 7
s_add_u32 s45, s45, s51
v_mfma_f32_16x16x32_bf16 a[16:19], a[204:207], a[28:31], a[16:19]
v_exp_f32 v78, v78
v_mfma_f32_16x16x32_bf16 a[236:239], a[228:231], v[108:111], a[236:239]
v_exp_f32 v79, v79
v_mfma_f32_16x16x32_bf16 v[8:11], a[208:211], v[104:107], v[8:11]
ds_read_b128 a[188:191], v192 offset:49152
v_cvt_pk_bf16_f32 v103, v78, v79
v_mfma_f32_16x16x32_bf16 v[12:15], a[208:211], v[108:111], v[12:15]
v_mfma_f32_16x16x32_bf16 a[20:23], a[208:211], a[28:31], a[20:23]
s_waitcnt lgkmcnt(3)
v_mfma_f32_16x16x32_bf16 v[64:67], a[212:215], v[112:115], v[156:159]
ds_read_b64_tr_b16 a[192:193], v197 offset:32768
v_exp_f32 v80, v80
v_mfma_f32_16x16x32_bf16 v[72:75], a[212:215], v[128:131], v[160:163]
ds_read_b64_tr_b16 a[194:195], v197 offset:36864
v_exp_f32 v81, v81
v_mfma_f32_16x16x32_bf16 v[64:67], a[216:219], v[116:119], v[64:67]
ds_read_b128 a[196:199], v193 offset:49152
v_cvt_pk_bf16_f32 v104, v80, v81
v_mfma_f32_16x16x32_bf16 v[72:75], a[216:219], v[132:135], v[72:75]
ds_read_b128 a[24:27], v203 offset:0
s_add_u32 m0, s39, 131072
v_mfma_f32_16x16x32_bf16 v[144:147], a[220:223], a[0:3], v[164:167]
ds_read_b128 a[200:203], v189 offset:49152
s_add_u32 s46, s46, 1
v_mfma_f32_16x16x32_bf16 v[16:19], a[224:227], v[96:99], v[16:19]
ds_read_b64_tr_b16 a[204:205], v198 offset:32768
buffer_load_dwordx4 v228, s[20:23], s44 offen  lds
v_mfma_f32_16x16x32_bf16 v[20:23], a[224:227], v[100:103], v[20:23]
ds_read_b64_tr_b16 a[206:207], v198 offset:36864
s_waitcnt lgkmcnt(5)
v_mfma_f32_16x16x32_bf16 v[144:147], a[180:183], a[4:7], v[144:147]
ds_read_b128 a[208:211], v186 offset:53248
v_exp_f32 v82, v82
v_mfma_f32_16x16x32_bf16 v[64:67], a[184:187], v[120:123], v[64:67]
ds_read_b64_tr_b16 a[212:213], v199 offset:32768
v_exp_f32 v83, v83
v_mfma_f32_16x16x32_bf16 v[72:75], a[184:187], v[136:139], v[72:75]
ds_read_b64_tr_b16 a[214:215], v199 offset:36864
v_cvt_pk_bf16_f32 v105, v82, v83
v_mfma_f32_16x16x32_bf16 v[144:147], a[188:191], a[8:11], v[144:147]
ds_read_b128 a[216:219], v187 offset:53248
v_exp_f32 v84, v84
v_mfma_f32_16x16x32_bf16 v[24:27], a[192:195], v[96:99], v[24:27]
ds_read_b64_tr_b16 a[220:221], v200 offset:32768
v_exp_f32 v85, v85
v_mfma_f32_16x16x32_bf16 v[28:31], a[192:195], v[100:103], v[28:31]
ds_read_b64_tr_b16 a[222:223], v200 offset:36864
s_waitcnt lgkmcnt(5)
v_mfma_f32_16x16x32_bf16 v[144:147], a[196:199], a[12:15], v[144:147]
ds_read_b128 a[224:227], v188 offset:53248
buffer_load_dwordx4 v229, s[20:23], s44 offen offset:1024  lds
v_mfma_f32_16x16x32_bf16 v[64:67], a[200:203], v[124:127], v[64:67]
ds_read_b64_tr_b16 a[180:181], v201 offset:32768
v_cvt_pk_bf16_f32 v106, v84, v85
v_mfma_f32_16x16x32_bf16 v[72:75], a[200:203], v[140:143], v[72:75]
ds_read_b64_tr_b16 a[182:183], v201 offset:36864
v_exp_f32 v86, v86
v_mfma_f32_16x16x32_bf16 v[32:35], a[204:207], v[96:99], v[32:35]
ds_read_b128 a[28:31], v203 offset:1024
v_exp_f32 v87, v87
v_mfma_f32_16x16x32_bf16 v[36:39], a[204:207], v[100:103], v[36:39]
ds_read_b128 a[184:187], v189 offset:53248
v_cvt_pk_bf16_f32 v107, v86, v87
v_mfma_f32_16x16x32_bf16 v[68:71], a[208:211], v[112:115], v[156:159]
ds_read_b64_tr_b16 a[188:189], v194 offset:32768
v_exp_f32 v88, v88
v_mfma_f32_16x16x32_bf16 v[76:79], a[208:211], v[128:131], v[160:163]
ds_read_b64_tr_b16 a[190:191], v194 offset:36864
s_waitcnt lgkmcnt(7)
v_mfma_f32_16x16x32_bf16 v[40:43], a[212:215], v[96:99], v[40:43]
ds_read_b64_tr_b16 a[192:193], v195 offset:32768
v_exp_f32 v89, v89
v_mfma_f32_16x16x32_bf16 v[44:47], a[212:215], v[100:103], v[44:47]
ds_read_b64_tr_b16 a[194:195], v195 offset:36864
v_cvt_pk_bf16_f32 v108, v88, v89
v_mfma_f32_16x16x32_bf16 v[68:71], a[216:219], v[116:119], v[68:71]
ds_read_b128 a[196:199], v186 offset:57344
buffer_load_dwordx4 v230, s[20:23], s44 offen offset:2048  lds
v_mfma_f32_16x16x32_bf16 v[76:79], a[216:219], v[132:135], v[76:79]
v_exp_f32 v90, v90
v_mfma_f32_16x16x32_bf16 v[48:51], a[220:223], v[96:99], v[48:51]
ds_read_b128 a[200:203], v187 offset:57344
v_exp_f32 v91, v91
v_mfma_f32_16x16x32_bf16 v[52:55], a[220:223], v[100:103], v[52:55]
v_cvt_pk_bf16_f32 v109, v90, v91
s_waitcnt lgkmcnt(6)
v_mfma_f32_16x16x32_bf16 v[68:71], a[224:227], v[120:123], v[68:71]
ds_read_b64_tr_b16 a[204:205], v196 offset:40960
v_exp_f32 v92, v92
v_mfma_f32_16x16x32_bf16 v[76:79], a[224:227], v[136:139], v[76:79]
ds_read_b64_tr_b16 a[206:207], v196 offset:45056
v_exp_f32 v93, v93
v_mfma_f32_16x16x32_bf16 v[56:59], a[180:183], v[96:99], v[56:59]
ds_read_b128 a[208:211], v188 offset:57344
v_cvt_pk_bf16_f32 v110, v92, v93
v_mfma_f32_16x16x32_bf16 v[60:63], a[180:183], v[100:103], v[60:63]
v_exp_f32 v94, v94
v_mfma_f32_16x16x32_bf16 a[232:235], a[228:231], v[96:99], a[232:235]
v_exp_f32 v95, v95
v_mfma_f32_16x16x32_bf16 v[68:71], a[184:187], v[124:127], v[68:71]
ds_read_b64_tr_b16 a[212:213], v197 offset:40960
buffer_load_dwordx4 v231, s[20:23], s44 offen offset:3072  lds
v_mfma_f32_16x16x32_bf16 v[76:79], a[184:187], v[140:143], v[76:79]
ds_read_b64_tr_b16 a[214:215], v197 offset:45056
s_waitcnt lgkmcnt(7)
v_mfma_f32_16x16x32_bf16 v[0:3], a[188:191], v[96:99], v[0:3]
ds_read_b128 a[216:219], v189 offset:57344
v_cvt_pk_bf16_f32 v111, v94, v95
v_mfma_f32_16x16x32_bf16 v[4:7], a[188:191], v[100:103], v[4:7]
v_exp_f32 v144, v144
v_mfma_f32_16x16x32_bf16 a[16:19], a[188:191], a[24:27], a[16:19]
v_exp_f32 v145, v145
v_mfma_f32_16x16x32_bf16 a[236:239], a[228:231], v[100:103], a[236:239]
v_exp_f32 v146, v146
v_mfma_f32_16x16x32_bf16 v[8:11], a[192:195], v[96:99], v[8:11]
ds_read_b64_tr_b16 a[220:221], v198 offset:40960
v_cvt_pk_bf16_f32 v152, v144, v145
v_mfma_f32_16x16x32_bf16 v[12:15], a[192:195], v[100:103], v[12:15]
ds_read_b64_tr_b16 a[222:223], v198 offset:45056
v_add_f32 v177, v177, v144
v_mfma_f32_16x16x32_bf16 a[20:23], a[192:195], a[24:27], a[20:23]
v_add_f32 v177, v177, v145
s_waitcnt lgkmcnt(6)
v_mfma_f32_16x16x32_bf16 v[80:83], a[196:199], v[112:115], v[156:159]
ds_read_b128 a[224:227], v186 offset:61440
v_add_f32 v177, v177, v146
v_mfma_f32_16x16x32_bf16 v[88:91], a[196:199], v[128:131], v[160:163]
s_lshr_b32 s6, s39, 2
s_add_u32 m0, s6, 81920
v_mfma_f32_16x16x32_bf16 v[80:83], a[200:203], v[116:119], v[80:83]
ds_read_b64_tr_b16 a[180:181], v199 offset:40960
s_cmp_eq_u32 s46, 9
s_cselect_b32 s46, 0, s46
v_mfma_f32_16x16x32_bf16 v[88:91], a[200:203], v[132:135], v[88:91]
ds_read_b64_tr_b16 a[182:183], v199 offset:45056
buffer_load_dwordx4 v207, s[8:11], s45 offen  lds
v_mfma_f32_16x16x32_bf16 v[16:19], a[204:207], v[104:107], v[16:19]
ds_read_b128 a[184:187], v187 offset:61440
v_exp_f32 v147, v147
v_mfma_f32_16x16x32_bf16 v[20:23], a[204:207], v[108:111], v[20:23]
v_cvt_pk_bf16_f32 v153, v146, v147
s_waitcnt lgkmcnt(6)
v_mfma_f32_16x16x32_bf16 v[80:83], a[208:211], v[120:123], v[80:83]
ds_read_b64_tr_b16 a[188:189], v200 offset:40960
ds_write_b64 v178, v[152:153] offset:2048
v_mfma_f32_16x16x32_bf16 v[88:91], a[208:211], v[136:139], v[88:91]
ds_read_b64_tr_b16 a[190:191], v200 offset:45056
v_add_f32 v177, v177, v147
v_mfma_f32_16x16x32_bf16 v[24:27], a[212:215], v[104:107], v[24:27]
ds_read_b128 a[192:195], v188 offset:61440
v_exp_f32 v64, v64
v_mfma_f32_16x16x32_bf16 v[28:31], a[212:215], v[108:111], v[28:31]
v_exp_f32 v65, v65
v_mfma_f32_16x16x32_bf16 v[80:83], a[216:219], v[124:127], v[80:83]
ds_read_b64_tr_b16 a[196:197], v201 offset:40960
s_lshl_b32 s57, s39, 1
v_mfma_f32_16x16x32_bf16 v[88:91], a[216:219], v[140:143], v[88:91]
ds_read_b64_tr_b16 a[198:199], v201 offset:45056
s_waitcnt lgkmcnt(6)
v_mfma_f32_16x16x32_bf16 v[32:35], a[220:223], v[104:107], v[32:35]
ds_read_b128 a[200:203], v189 offset:61440
s_add_u32 s57, s57, s53
v_mfma_f32_16x16x32_bf16 v[36:39], a[220:223], v[108:111], v[36:39]
v_exp_f32 v66, v66
v_mfma_f32_16x16x32_bf16 v[84:87], a[224:227], v[112:115], v[156:159]
ds_read_b64_tr_b16 a[204:205], v194 offset:40960
v_cvt_pk_bf16_f32 v96, v64, v65
v_mfma_f32_16x16x32_bf16 v[92:95], a[224:227], v[128:131], v[160:163]
ds_read_b64_tr_b16 a[206:207], v194 offset:45056
v_exp_f32 v67, v67
v_mfma_f32_16x16x32_bf16 v[40:43], a[180:183], v[104:107], v[40:43]
ds_read_b64_tr_b16 a[208:209], v195 offset:40960
v_cvt_pk_bf16_f32 v97, v66, v67
v_mfma_f32_16x16x32_bf16 v[44:47], a[180:183], v[108:111], v[44:47]
ds_read_b64_tr_b16 a[210:211], v195 offset:45056
s_waitcnt lgkmcnt(8)
v_mfma_f32_16x16x32_bf16 v[84:87], a[184:187], v[116:119], v[84:87]
v_exp_f32 v68, v68
v_mfma_f32_16x16x32_bf16 v[92:95], a[184:187], v[132:135], v[92:95]
v_exp_f32 v69, v69
v_mfma_f32_16x16x32_bf16 v[48:51], a[188:191], v[104:107], v[48:51]
s_waitcnt vmcnt(5) lgkmcnt(0)
s_barrier
v_mfma_f32_16x16x32_bf16 v[52:55], a[188:191], v[108:111], v[52:55]
ds_read_b64_tr_b16 a[212:213], v196 offset:49152
s_mul_i32 s44, s46, 524288
v_mfma_f32_16x16x32_bf16 v[84:87], a[192:195], v[120:123], v[84:87]
ds_read_b64_tr_b16 a[216:217], v197 offset:49152
s_add_u32 s44, s44, s52
v_mfma_f32_16x16x32_bf16 v[92:95], a[192:195], v[136:139], v[92:95]
ds_read_b64_tr_b16 a[214:215], v196 offset:53248
v_cvt_pk_bf16_f32 v98, v68, v69
v_mfma_f32_16x16x32_bf16 v[56:59], a[196:199], v[104:107], v[56:59]
ds_read_b64_tr_b16 a[218:219], v197 offset:53248
ds_read_b64_tr_b16 a[220:221], v198 offset:49152
v_mfma_f32_16x16x32_bf16 v[60:63], a[196:199], v[108:111], v[60:63]
ds_read_b64_tr_b16 a[222:223], v198 offset:53248
v_exp_f32 v70, v70
v_mfma_f32_16x16x32_bf16 a[232:235], a[228:231], v[104:107], a[232:235]
ds_read_b64_tr_b16 a[224:225], v199 offset:49152
v_exp_f32 v71, v71
v_mfma_f32_16x16x32_bf16 v[84:87], a[200:203], v[124:127], v[84:87]
ds_read_b64_tr_b16 a[226:227], v199 offset:53248
v_cvt_pk_bf16_f32 v99, v70, v71
v_mfma_f32_16x16x32_bf16 v[92:95], a[200:203], v[140:143], v[92:95]
ds_read_b64_tr_b16 a[180:181], v200 offset:49152
s_lshl_b32 s45, s46, 7
v_mfma_f32_16x16x32_bf16 v[0:3], a[204:207], v[104:107], v[0:3]
ds_read_b64_tr_b16 a[182:183], v200 offset:53248
s_add_u32 s45, s45, s51
v_mfma_f32_16x16x32_bf16 v[4:7], a[204:207], v[108:111], v[4:7]
ds_read_b64_tr_b16 a[184:185], v201 offset:49152
v_exp_f32 v72, v72
v_mfma_f32_16x16x32_bf16 a[16:19], a[204:207], a[28:31], a[16:19]
ds_read_b64_tr_b16 a[186:187], v201 offset:53248
v_exp_f32 v73, v73
v_mfma_f32_16x16x32_bf16 a[236:239], a[228:231], v[108:111], a[236:239]
v_exp_f32 v74, v74
v_mfma_f32_16x16x32_bf16 v[8:11], a[208:211], v[104:107], v[8:11]
ds_read_b64_tr_b16 a[188:189], v194 offset:49152
v_cvt_pk_bf16_f32 v100, v72, v73
v_mfma_f32_16x16x32_bf16 v[12:15], a[208:211], v[108:111], v[12:15]
ds_read_b64_tr_b16 a[190:191], v194 offset:53248
v_exp_f32 v75, v75
v_mfma_f32_16x16x32_bf16 a[20:23], a[208:211], a[28:31], a[20:23]
v_cvt_pk_bf16_f32 v101, v74, v75
v_exp_f32 v76, v76
v_exp_f32 v77, v77
v_exp_f32 v78, v78
v_cvt_pk_bf16_f32 v102, v76, v77
v_exp_f32 v79, v79
s_nop 0
v_cvt_pk_bf16_f32 v103, v78, v79
s_waitcnt lgkmcnt(8)
v_mfma_f32_16x16x32_bf16 v[16:19], a[212:215], v[96:99], v[16:19]
ds_read_b64_tr_b16 a[192:193], v195 offset:49152
s_add_u32 m0, s39, 147456
v_mfma_f32_16x16x32_bf16 v[20:23], a[212:215], v[100:103], v[20:23]
ds_read_b64_tr_b16 a[194:195], v195 offset:53248
s_add_u32 s46, s46, 1
v_mfma_f32_16x16x32_bf16 v[24:27], a[216:219], v[96:99], v[24:27]
ds_read_b64_tr_b16 a[196:197], v196 offset:57344
buffer_load_dwordx4 v228, s[20:23], s44 offen  lds
v_mfma_f32_16x16x32_bf16 v[28:31], a[216:219], v[100:103], v[28:31]
ds_read_b64_tr_b16 a[198:199], v196 offset:61440
v_exp_f32 v80, v80
v_mfma_f32_16x16x32_bf16 v[32:35], a[220:223], v[96:99], v[32:35]
ds_read_b128 a[24:27], v179 offset:2048
v_exp_f32 v81, v81
v_mfma_f32_16x16x32_bf16 v[36:39], a[220:223], v[100:103], v[36:39]
ds_read_b64_tr_b16 a[200:201], v197 offset:57344
s_waitcnt lgkmcnt(8)
v_mfma_f32_16x16x32_bf16 v[40:43], a[224:227], v[96:99], v[40:43]
ds_read_b64_tr_b16 a[202:203], v197 offset:61440
v_cvt_pk_bf16_f32 v104, v80, v81
v_mfma_f32_16x16x32_bf16 v[44:47], a[224:227], v[100:103], v[44:47]
ds_read_b64_tr_b16 a[204:205], v198 offset:57344
v_exp_f32 v82, v82
v_mfma_f32_16x16x32_bf16 v[48:51], a[180:183], v[96:99], v[48:51]
ds_read_b64_tr_b16 a[206:207], v198 offset:61440
buffer_load_dwordx4 v229, s[20:23], s44 offen offset:1024  lds
v_mfma_f32_16x16x32_bf16 v[52:55], a[180:183], v[100:103], v[52:55]
ds_read_b64_tr_b16 a[208:209], v199 offset:57344
v_exp_f32 v83, v83
v_mfma_f32_16x16x32_bf16 a[232:235], a[228:231], v[96:99], a[232:235]
ds_read_b64_tr_b16 a[210:211], v199 offset:61440
v_cvt_pk_bf16_f32 v105, v82, v83
v_mfma_f32_16x16x32_bf16 v[56:59], a[184:187], v[96:99], v[56:59]
ds_read_b64_tr_b16 a[212:213], v200 offset:57344
v_exp_f32 v84, v84
v_mfma_f32_16x16x32_bf16 v[60:63], a[184:187], v[100:103], v[60:63]
ds_read_b64_tr_b16 a[214:215], v200 offset:61440
s_waitcnt lgkmcnt(8)
v_mfma_f32_16x16x32_bf16 v[0:3], a[188:191], v[96:99], v[0:3]
ds_read_b64_tr_b16 a[216:217], v201 offset:57344
v_exp_f32 v85, v85
v_mfma_f32_16x16x32_bf16 v[4:7], a[188:191], v[100:103], v[4:7]
ds_read_b64_tr_b16 a[218:219], v201 offset:61440
v_cvt_pk_bf16_f32 v106, v84, v85
v_mfma_f32_16x16x32_bf16 a[16:19], a[188:191], a[24:27], a[16:19]
ds_read_b128 a[28:31], v179 offset:3072
buffer_load_dwordx4 v230, s[20:23], s44 offen offset:2048  lds
v_mfma_f32_16x16x32_bf16 a[236:239], a[228:231], v[100:103], a[236:239]
v_exp_f32 v86, v86
v_mfma_f32_16x16x32_bf16 v[8:11], a[192:195], v[96:99], v[8:11]
ds_read_b64_tr_b16 a[220:221], v194 offset:57344
v_exp_f32 v87, v87
v_mfma_f32_16x16x32_bf16 v[12:15], a[192:195], v[100:103], v[12:15]
ds_read_b64_tr_b16 a[222:223], v194 offset:61440
v_cvt_pk_bf16_f32 v107, v86, v87
v_exp_f32 v88, v88
v_exp_f32 v89, v89
v_exp_f32 v90, v90
v_cvt_pk_bf16_f32 v108, v88, v89
v_exp_f32 v91, v91
v_exp_f32 v92, v92
v_cvt_pk_bf16_f32 v109, v90, v91
v_exp_f32 v93, v93
v_exp_f32 v94, v94
v_cvt_pk_bf16_f32 v110, v92, v93
v_exp_f32 v95, v95
s_nop 0
v_cvt_pk_bf16_f32 v111, v94, v95
v_mfma_f32_16x16x32_bf16 a[20:23], a[192:195], a[24:27], a[20:23]
v_mfma_f32_16x16x32_bf16 v[16:19], a[196:199], v[104:107], v[16:19]
ds_read_b64_tr_b16 a[224:225], v195 offset:57344
v_mfma_f32_16x16x32_bf16 v[20:23], a[196:199], v[108:111], v[20:23]
ds_read_b64_tr_b16 a[226:227], v195 offset:61440
v_mfma_f32_16x16x32_bf16 a[232:235], a[228:231], v[104:107], a[232:235]
v_mfma_f32_16x16x32_bf16 a[236:239], a[228:231], v[108:111], a[236:239]
buffer_load_dwordx4 v231, s[20:23], s44 offen offset:3072  lds
s_waitcnt lgkmcnt(9)
v_mfma_f32_16x16x32_bf16 v[24:27], a[200:203], v[104:107], v[24:27]
v_mfma_f32_16x16x32_bf16 v[28:31], a[200:203], v[108:111], v[28:31]
v_mfma_f32_16x16x32_bf16 v[32:35], a[204:207], v[104:107], v[32:35]
v_mfma_f32_16x16x32_bf16 v[36:39], a[204:207], v[108:111], v[36:39]
v_mfma_f32_16x16x32_bf16 v[40:43], a[208:211], v[104:107], v[40:43]
v_mfma_f32_16x16x32_bf16 v[44:47], a[208:211], v[108:111], v[44:47]
v_accvgpr_read_b32 v176, a232
s_waitcnt lgkmcnt(2)
v_mfma_f32_16x16x32_bf16 v[48:51], a[212:215], v[104:107], v[48:51]
v_accvgpr_read_b32 v144, a236
v_rcp_f32 v180, v176
v_mfma_f32_16x16x32_bf16 v[52:55], a[212:215], v[108:111], v[52:55]
s_lshr_b32 s6, s39, 2
s_add_u32 m0, s6, 61440
v_mfma_f32_16x16x32_bf16 v[56:59], a[216:219], v[104:107], v[56:59]
s_cmp_eq_u32 s46, 9
s_cselect_b32 s46, 0, s46
v_mfma_f32_16x16x32_bf16 v[60:63], a[216:219], v[108:111], v[60:63]
buffer_load_dwordx4 v207, s[8:11], s45 offen  lds
v_mfma_f32_16x16x32_bf16 v[0:3], a[220:223], v[104:107], v[0:3]
v_rcp_f32 v182, v144
v_mfma_f32_16x16x32_bf16 v[4:7], a[220:223], v[108:111], v[4:7]
v_mfma_f32_16x16x32_bf16 a[16:19], a[220:223], a[28:31], a[16:19]
s_waitcnt lgkmcnt(0)
v_mfma_f32_16x16x32_bf16 v[8:11], a[224:227], v[104:107], v[8:11]
v_mfma_f32_16x16x32_bf16 v[12:15], a[224:227], v[108:111], v[12:15]
v_mfma_f32_16x16x32_bf16 a[20:23], a[224:227], a[28:31], a[20:23]
v_mov_b32 v184, v177
s_mov_b32 s3, 0x4e800000
s_mov_b32 s7, 0x30800000
v_permlane16_swap_b32 v177, v184
v_add_f32 v177, v177, v184
v_max_f32 v145, v176, v144
v_mov_b32 v184, v177
v_cmp_nle_f32 s[66:67], s7, v176
v_cmp_nle_f32 vcc, s7, v144
v_permlane32_swap_b32 v177, v184
v_add_f32 v177, v177, v184
s_or_b64 s[66:67], vcc, s[66:67]
v_max_f32 v145, v145, v177
v_cmp_nge_f32 vcc, s3, v145
ds_write_b32 v240, v177 offset:0
s_or_b64 vcc, vcc, s[66:67]
s_cselect_b32 s3, 1, 0
v_mov_b32 v184, s3
ds_write_b32 v240, v184 offset:256
s_add_u32 s6, s38, 1
s_and_b32 s6, s6, 3
s_lshl_b32 s6, s6, 10
s_add_u32 s6, s6, s57
v_pk_mul_f32 v[16:17], v[16:17], v[180:181] op_sel_hi:[1,0]
v_pk_mul_f32 v[18:19], v[18:19], v[180:181] op_sel_hi:[1,0]
v_pk_mul_f32 v[24:25], v[24:25], v[180:181] op_sel_hi:[1,0]
v_pk_mul_f32 v[26:27], v[26:27], v[180:181] op_sel_hi:[1,0]
v_cvt_pk_bf16_f32 v72, v16, v17
v_cvt_pk_bf16_f32 v73, v18, v19
v_cvt_pk_bf16_f32 v74, v24, v25
v_cvt_pk_bf16_f32 v75, v26, v27
buffer_store_dwordx4 v[72:75], v237, s[24:27], s6 offen sc1
v_pk_mul_f32 v[20:21], v[20:21], v[182:183] op_sel_hi:[1,0]
v_pk_mul_f32 v[22:23], v[22:23], v[182:183] op_sel_hi:[1,0]
v_pk_mul_f32 v[28:29], v[28:29], v[182:183] op_sel_hi:[1,0]
v_pk_mul_f32 v[30:31], v[30:31], v[182:183] op_sel_hi:[1,0]
v_cvt_pk_bf16_f32 v76, v20, v21
v_cvt_pk_bf16_f32 v77, v22, v23
v_cvt_pk_bf16_f32 v78, v28, v29
v_cvt_pk_bf16_f32 v79, v30, v31
buffer_store_dwordx4 v[76:79], v238, s[24:27], s6 offen sc1
s_add_u32 s6, s38, 2
s_and_b32 s6, s6, 3
s_lshl_b32 s6, s6, 10
s_add_u32 s6, s6, s57
v_pk_mul_f32 v[32:33], v[32:33], v[180:181] op_sel_hi:[1,0]
v_pk_mul_f32 v[34:35], v[34:35], v[180:181] op_sel_hi:[1,0]
v_pk_mul_f32 v[40:41], v[40:41], v[180:181] op_sel_hi:[1,0]
v_pk_mul_f32 v[42:43], v[42:43], v[180:181] op_sel_hi:[1,0]
v_cvt_pk_bf16_f32 v80, v32, v33
v_cvt_pk_bf16_f32 v81, v34, v35
v_cvt_pk_bf16_f32 v82, v40, v41
v_cvt_pk_bf16_f32 v83, v42, v43
buffer_store_dwordx4 v[80:83], v237, s[24:27], s6 offen sc1
v_pk_mul_f32 v[36:37], v[36:37], v[182:183] op_sel_hi:[1,0]
v_pk_mul_f32 v[38:39], v[38:39], v[182:183] op_sel_hi:[1,0]
v_pk_mul_f32 v[44:45], v[44:45], v[182:183] op_sel_hi:[1,0]
v_pk_mul_f32 v[46:47], v[46:47], v[182:183] op_sel_hi:[1,0]
v_cvt_pk_bf16_f32 v84, v36, v37
v_cvt_pk_bf16_f32 v85, v38, v39
v_cvt_pk_bf16_f32 v86, v44, v45
v_cvt_pk_bf16_f32 v87, v46, v47
buffer_store_dwordx4 v[84:87], v238, s[24:27], s6 offen sc1
s_cmp_lg_u32 s38, 0
s_cbranch_scc1 INITE3
s_mov_b32 s6, 0x20000
INITL3:
v_readfirstlane_b32 s3, v254
s_nop 0
s_cmp_lg_u32 s3, 0
s_cbranch_scc1 INITE3
global_load_dword v254, v253, s[36:37] sc1
s_waitcnt vmcnt(0)
s_sub_u32 s6, s6, 1
s_cbranch_scc0 INITL3
INITE3:
s_waitcnt lgkmcnt(0)
s_barrier
ds_read_b128 v[96:99], v241 offset:0
ds_read_b128 v[100:103], v241 offset:256
s_add_u32 s6, s38, 3
s_and_b32 s6, s6, 3
s_lshl_b32 s6, s6, 10
s_add_u32 s6, s6, s57
v_pk_mul_f32 v[48:49], v[48:49], v[180:181] op_sel_hi:[1,0]
v_pk_mul_f32 v[50:51], v[50:51], v[180:181] op_sel_hi:[1,0]
v_pk_mul_f32 v[56:57], v[56:57], v[180:181] op_sel_hi:[1,0]
v_pk_mul_f32 v[58:59], v[58:59], v[180:181] op_sel_hi:[1,0]
v_cvt_pk_bf16_f32 v88, v48, v49
v_cvt_pk_bf16_f32 v89, v50, v51
v_cvt_pk_bf16_f32 v90, v56, v57
v_cvt_pk_bf16_f32 v91, v58, v59
buffer_store_dwordx4 v[88:91], v237, s[24:27], s6 offen sc1
v_pk_mul_f32 v[52:53], v[52:53], v[182:183] op_sel_hi:[1,0]
v_pk_mul_f32 v[54:55], v[54:55], v[182:183] op_sel_hi:[1,0]
v_pk_mul_f32 v[60:61], v[60:61], v[182:183] op_sel_hi:[1,0]
v_pk_mul_f32 v[62:63], v[62:63], v[182:183] op_sel_hi:[1,0]
v_cvt_pk_bf16_f32 v92, v52, v53
v_cvt_pk_bf16_f32 v93, v54, v55
v_cvt_pk_bf16_f32 v94, v60, v61
v_cvt_pk_bf16_f32 v95, v62, v63
buffer_store_dwordx4 v[92:95], v238, s[24:27], s6 offen sc1
s_add_u32 s6, s38, 0
s_and_b32 s6, s6, 3
s_lshl_b32 s6, s6, 10
s_add_u32 s6, s6, s57
v_pk_mul_f32 v[0:1], v[0:1], v[180:181] op_sel_hi:[1,0]
v_pk_mul_f32 v[2:3], v[2:3], v[180:181] op_sel_hi:[1,0]
v_pk_mul_f32 v[8:9], v[8:9], v[180:181] op_sel_hi:[1,0]
v_pk_mul_f32 v[10:11], v[10:11], v[180:181] op_sel_hi:[1,0]
v_cvt_pk_bf16_f32 v64, v0, v1
v_cvt_pk_bf16_f32 v65, v2, v3
v_cvt_pk_bf16_f32 v66, v8, v9
v_cvt_pk_bf16_f32 v67, v10, v11
buffer_store_dwordx4 v[64:67], v237, s[24:27], s6 offen sc1
v_pk_mul_f32 v[4:5], v[4:5], v[182:183] op_sel_hi:[1,0]
v_pk_mul_f32 v[6:7], v[6:7], v[182:183] op_sel_hi:[1,0]
v_pk_mul_f32 v[12:13], v[12:13], v[182:183] op_sel_hi:[1,0]
v_pk_mul_f32 v[14:15], v[14:15], v[182:183] op_sel_hi:[1,0]
v_cvt_pk_bf16_f32 v68, v4, v5
v_cvt_pk_bf16_f32 v69, v6, v7
v_cvt_pk_bf16_f32 v70, v12, v13
v_cvt_pk_bf16_f32 v71, v14, v15
buffer_store_dwordx4 v[68:71], v238, s[24:27], s6 offen sc1
v_accvgpr_read_b32 v16, a16
v_accvgpr_read_b32 v17, a17
v_accvgpr_read_b32 v18, a18
v_accvgpr_read_b32 v19, a19
v_accvgpr_read_b32 v20, a20
v_accvgpr_read_b32 v21, a21
v_accvgpr_read_b32 v22, a22
v_accvgpr_read_b32 v23, a23
s_waitcnt lgkmcnt(1)
v_add_f32 v96, v96, v97
v_add_f32 v98, v98, v99
s_waitcnt lgkmcnt(0)
v_or_b32 v100, v100, v101
v_add_f32 v96, v96, v98
v_or3_b32 v100, v100, v102, v103
v_cmp_nle_f32 vcc, s7, v96
v_cmp_ne_u32 s[66:67], 0, v100
v_rcp_f32 v98, v96
s_lshr_b32 s6, s39, 2
s_add_u32 s6, s6, s53
s_or_b64 vcc, vcc, s[66:67]
s_cselect_b32 s3, 1, 0
s_cmp_gt_u32 s3, s54
s_cbranch_scc1 SLOW00
v_mul_f32 v16, v16, v98
v_mul_f32 v17, v17, v98
v_mul_f32 v18, v18, v98
v_mul_f32 v19, v19, v98
v_mul_f32 v20, v20, v98
v_mul_f32 v21, v21, v98
v_mul_f32 v22, v22, v98
v_mul_f32 v23, v23, v98
v_cvt_pk_bf16_f32 v16, v16, v17
v_cvt_pk_bf16_f32 v17, v18, v19
v_cvt_pk_bf16_f32 v18, v20, v21
v_cvt_pk_bf16_f32 v19, v22, v23
s_add_u32 s6, s6, 32768
buffer_store_dwordx4 v[16:19], v237, s[24:27], s6 offen sc1
s_add_u32 s41, s41, 131072
s_add_u32 s53, s53, 36864
s_add_u32 s42, s41, 4294950912
s_mov_b32 s43, s42
s_waitcnt vmcnt(14)
s_barrier
ds_read_b64_tr_b16 a[180:181], v210 offset:16384
ds_read_b64_tr_b16 a[182:183], v210 offset:17408
ds_read_b128 a[212:215], v220 offset:20480
ds_read_b64_tr_b16 a[184:185], v211 offset:16384
ds_read_b64_tr_b16 a[186:187], v211 offset:17408
ds_read_b64_tr_b16 a[188:189], v212 offset:16384
ds_read_b64_tr_b16 a[190:191], v212 offset:17408
ds_read_b64_tr_b16 a[192:193], v213 offset:16384
ds_read_b64_tr_b16 a[194:195], v213 offset:17408
ds_read_b64_tr_b16 a[196:197], v214 offset:16384
ds_read_b64_tr_b16 a[198:199], v214 offset:17408
ds_read_b64_tr_b16 a[200:201], v215 offset:16384
ds_read_b64_tr_b16 a[202:203], v215 offset:17408
ds_read_b64_tr_b16 a[204:205], v216 offset:16384
ds_read_b64_tr_b16 a[206:207], v216 offset:17408
s_waitcnt lgkmcnt(10)
v_mfma_f32_16x16x32_bf16 v[0:3], a[180:183], a[48:51], 0
ds_read_b64_tr_b16 a[208:209], v217 offset:16384
s_mul_i32 s44, s46, 524288
v_mfma_f32_16x16x32_bf16 v[4:7], a[180:183], a[52:55], 0
ds_read_b64_tr_b16 a[210:211], v217 offset:17408
s_add_u32 s44, s44, s52
v_mfma_f32_16x16x32_bf16 v[64:67], a[180:183], a[212:215], 0
ds_read_b64_tr_b16 a[180:181], v210 offset:24576
v_mfma_f32_16x16x32_bf16 v[8:11], a[184:187], a[48:51], 0
ds_read_b64_tr_b16 a[182:183], v210 offset:25600
s_lshl_b32 s45, s46, 7
v_mfma_f32_16x16x32_bf16 v[12:15], a[184:187], a[52:55], 0
ds_read_b128 a[216:219], v221 offset:20480
s_add_u32 s45, s45, s51
v_mfma_f32_16x16x32_bf16 v[68:71], a[184:187], a[212:215], 0
s_waitcnt lgkmcnt(11)
v_mfma_f32_16x16x32_bf16 v[16:19], a[188:191], a[48:51], 0
ds_read_b64_tr_b16 a[184:185], v211 offset:24576
s_add_u32 m0, s39, 114688
v_mfma_f32_16x16x32_bf16 v[20:23], a[188:191], a[52:55], 0
ds_read_b64_tr_b16 a[186:187], v211 offset:25600
s_add_u32 s46, s46, 1
v_mfma_f32_16x16x32_bf16 v[24:27], a[192:195], a[48:51], 0
ds_read_b64_tr_b16 a[188:189], v212 offset:24576
buffer_load_dwordx4 v228, s[20:23], s44 offen  lds
v_mfma_f32_16x16x32_bf16 v[28:31], a[192:195], a[52:55], 0
ds_read_b64_tr_b16 a[190:191], v212 offset:25600
s_waitcnt lgkmcnt(11)
v_mfma_f32_16x16x32_bf16 v[32:35], a[196:199], a[48:51], 0
ds_read_b64_tr_b16 a[192:193], v213 offset:24576
buffer_load_dwordx4 v229, s[20:23], s44 offen offset:1024  lds
v_mfma_f32_16x16x32_bf16 v[36:39], a[196:199], a[52:55], 0
ds_read_b64_tr_b16 a[194:195], v213 offset:25600
v_mfma_f32_16x16x32_bf16 v[40:43], a[200:203], a[48:51], 0
ds_read_b64_tr_b16 a[196:197], v214 offset:24576
v_mfma_f32_16x16x32_bf16 v[44:47], a[200:203], a[52:55], 0
ds_read_b64_tr_b16 a[198:199], v214 offset:25600
s_waitcnt lgkmcnt(11)
v_mfma_f32_16x16x32_bf16 v[48:51], a[204:207], a[48:51], 0
ds_read_b64_tr_b16 a[200:201], v215 offset:24576
buffer_load_dwordx4 v230, s[20:23], s44 offen offset:2048  lds
v_mfma_f32_16x16x32_bf16 v[52:55], a[204:207], a[52:55], 0
ds_read_b64_tr_b16 a[202:203], v215 offset:25600
v_mfma_f32_16x16x32_bf16 v[56:59], a[208:211], a[48:51], 0
ds_read_b64_tr_b16 a[204:205], v216 offset:24576
buffer_load_dwordx4 v231, s[20:23], s44 offen offset:3072  lds
v_mfma_f32_16x16x32_bf16 v[60:63], a[208:211], a[52:55], 0
ds_read_b64_tr_b16 a[206:207], v216 offset:25600
s_waitcnt lgkmcnt(10)
v_mfma_f32_16x16x32_bf16 v[0:3], a[180:183], a[56:59], v[0:3]
ds_read_b64_tr_b16 a[208:209], v217 offset:24576
v_mfma_f32_16x16x32_bf16 v[4:7], a[180:183], a[60:63], v[4:7]
ds_read_b64_tr_b16 a[210:211], v217 offset:25600
s_lshr_b32 s6, s39, 2
v_mfma_f32_16x16x32_bf16 v[64:67], a[180:183], a[216:219], v[64:67]
s_add_u32 m0, s6, 102400
s_cmp_eq_u32 s46, 9
s_cselect_b32 s46, 0, s46
v_mfma_f32_16x16x32_bf16 v[8:11], a[184:187], a[56:59], v[8:11]
buffer_load_dwordx4 v207, s[8:11], s45 offen  lds
v_mfma_f32_16x16x32_bf16 v[12:15], a[184:187], a[60:63], v[12:15]
v_mfma_f32_16x16x32_bf16 v[68:71], a[184:187], a[216:219], v[68:71]
s_waitcnt vmcnt(14) lgkmcnt(0)
s_barrier
v_mfma_f32_16x16x32_bf16 v[16:19], a[188:191], a[56:59], v[16:19]
ds_read_b64_tr_b16 a[180:181], v210 offset:32768
s_waitcnt vmcnt(5)
s_lshl_b32 s66, s50, 2
s_add_u32 s66, s66, s38
s_lshl_b32 s66, s66, 2
s_add_u32 s66, s66, s62
v_mov_b32 v185, 1
s_mov_b64 exec, 1
buffer_store_dword v185, v243, s[24:27], s66 offen sc1
s_mov_b64 exec, -1
v_mfma_f32_16x16x32_bf16 v[20:23], a[188:191], a[60:63], v[20:23]
ds_read_b64_tr_b16 a[182:183], v210 offset:33792
s_mul_i32 s44, s46, 524288
v_mfma_f32_16x16x32_bf16 v[24:27], a[192:195], a[56:59], v[24:27]
ds_read_b128 a[220:223], v220 offset:0
ds_read_b64_tr_b16 a[184:185], v211 offset:32768
v_mfma_f32_16x16x32_bf16 v[28:31], a[192:195], a[60:63], v[28:31]
ds_read_b64_tr_b16 a[186:187], v211 offset:33792
s_add_u32 s44, s44, s52
v_mfma_f32_16x16x32_bf16 v[32:35], a[196:199], a[56:59], v[32:35]
ds_read_b64_tr_b16 a[188:189], v212 offset:32768
v_mfma_f32_16x16x32_bf16 v[36:39], a[196:199], a[60:63], v[36:39]
ds_read_b64_tr_b16 a[190:191], v212 offset:33792
s_lshl_b32 s45, s46, 7
v_mfma_f32_16x16x32_bf16 v[40:43], a[200:203], a[56:59], v[40:43]
ds_read_b64_tr_b16 a[192:193], v213 offset:32768
s_add_u32 s45, s45, s51
v_mfma_f32_16x16x32_bf16 v[44:47], a[200:203], a[60:63], v[44:47]
ds_read_b64_tr_b16 a[194:195], v213 offset:33792
v_mfma_f32_16x16x32_bf16 v[48:51], a[204:207], a[56:59], v[48:51]
ds_read_b64_tr_b16 a[196:197], v214 offset:32768
v_mfma_f32_16x16x32_bf16 v[52:55], a[204:207], a[60:63], v[52:55]
ds_read_b64_tr_b16 a[198:199], v214 offset:33792
v_mfma_f32_16x16x32_bf16 v[56:59], a[208:211], a[56:59], v[56:59]
ds_read_b64_tr_b16 a[200:201], v215 offset:32768
s_add_u32 m0, s39, 131072
v_mfma_f32_16x16x32_bf16 v[60:63], a[208:211], a[60:63], v[60:63]
ds_read_b64_tr_b16 a[202:203], v215 offset:33792
s_waitcnt lgkmcnt(8)
v_mfma_f32_16x16x32_bf16 v[0:3], a[180:183], a[64:67], v[0:3]
ds_read_b64_tr_b16 a[204:205], v216 offset:32768
s_add_u32 s46, s46, 1
v_mfma_f32_16x16x32_bf16 v[4:7], a[180:183], a[68:71], v[4:7]
ds_read_b64_tr_b16 a[206:207], v216 offset:33792
buffer_load_dwordx4 v228, s[20:23], s44 offen  lds
v_mfma_f32_16x16x32_bf16 v[64:67], a[180:183], a[220:223], v[64:67]
ds_read_b64_tr_b16 a[208:209], v217 offset:32768
v_mfma_f32_16x16x32_bf16 v[8:11], a[184:187], a[64:67], v[8:11]
ds_read_b64_tr_b16 a[210:211], v217 offset:33792
buffer_load_dwordx4 v229, s[20:23], s44 offen offset:1024  lds
v_mfma_f32_16x16x32_bf16 v[12:15], a[184:187], a[68:71], v[12:15]
ds_read_b64_tr_b16 a[180:181], v210 offset:40960
v_mfma_f32_16x16x32_bf16 v[68:71], a[184:187], a[220:223], v[68:71]
ds_read_b64_tr_b16 a[182:183], v210 offset:41984
s_waitcnt lgkmcnt(10)
v_mfma_f32_16x16x32_bf16 v[16:19], a[188:191], a[64:67], v[16:19]
ds_read_b128 a[224:227], v221 offset:0
v_mfma_f32_16x16x32_bf16 v[20:23], a[188:191], a[68:71], v[20:23]
ds_read_b64_tr_b16 a[184:185], v211 offset:40960
v_mfma_f32_16x16x32_bf16 v[24:27], a[192:195], a[64:67], v[24:27]
ds_read_b64_tr_b16 a[186:187], v211 offset:41984
buffer_load_dwordx4 v230, s[20:23], s44 offen offset:2048  lds
v_mfma_f32_16x16x32_bf16 v[28:31], a[192:195], a[68:71], v[28:31]
ds_read_b64_tr_b16 a[188:189], v212 offset:40960
s_waitcnt lgkmcnt(10)
v_mfma_f32_16x16x32_bf16 v[32:35], a[196:199], a[64:67], v[32:35]
ds_read_b64_tr_b16 a[190:191], v212 offset:41984
v_mfma_f32_16x16x32_bf16 v[36:39], a[196:199], a[68:71], v[36:39]
ds_read_b64_tr_b16 a[192:193], v213 offset:40960
v_mfma_f32_16x16x32_bf16 v[40:43], a[200:203], a[64:67], v[40:43]
ds_read_b64_tr_b16 a[194:195], v213 offset:41984
v_mfma_f32_16x16x32_bf16 v[44:47], a[200:203], a[68:71], v[44:47]
ds_read_b64_tr_b16 a[196:197], v214 offset:40960
s_waitcnt lgkmcnt(10)
v_mfma_f32_16x16x32_bf16 v[48:51], a[204:207], a[64:67], v[48:51]
ds_read_b64_tr_b16 a[198:199], v214 offset:41984
buffer_load_dwordx4 v231, s[20:23], s44 offen offset:3072  lds
v_mfma_f32_16x16x32_bf16 v[52:55], a[204:207], a[68:71], v[52:55]
ds_read_b64_tr_b16 a[200:201], v215 offset:40960
v_mfma_f32_16x16x32_bf16 v[56:59], a[208:211], a[64:67], v[56:59]
ds_read_b64_tr_b16 a[202:203], v215 offset:41984
v_mfma_f32_16x16x32_bf16 v[60:63], a[208:211], a[68:71], v[60:63]
ds_read_b64_tr_b16 a[204:205], v216 offset:40960
s_waitcnt lgkmcnt(9)
v_mfma_f32_16x16x32_bf16 v[0:3], a[180:183], a[72:75], v[0:3]
ds_read_b64_tr_b16 a[206:207], v216 offset:41984
s_lshr_b32 s6, s39, 2
v_mfma_f32_16x16x32_bf16 v[4:7], a[180:183], a[76:79], v[4:7]
ds_read_b64_tr_b16 a[208:209], v217 offset:40960
s_add_u32 m0, s6, 81920
v_mfma_f32_16x16x32_bf16 v[64:67], a[180:183], a[224:227], v[64:67]
ds_read_b64_tr_b16 a[210:211], v217 offset:41984
s_cmp_eq_u32 s46, 9
s_cselect_b32 s46, 0, s46
v_mfma_f32_16x16x32_bf16 v[8:11], a[184:187], a[72:75], v[8:11]
buffer_load_dwordx4 v207, s[8:11], s45 offen  lds
v_mfma_f32_16x16x32_bf16 v[12:15], a[184:187], a[76:79], v[12:15]
v_mfma_f32_16x16x32_bf16 v[68:71], a[184:187], a[224:227], v[68:71]
s_waitcnt vmcnt(6) lgkmcnt(0)
s_barrier
v_mfma_f32_16x16x32_bf16 v[16:19], a[188:191], a[72:75], v[16:19]
ds_read_b64_tr_b16 a[180:181], v210 offset:0
s_mul_i32 s44, s46, 524288
v_mfma_f32_16x16x32_bf16 v[20:23], a[188:191], a[76:79], v[20:23]
ds_read_b64_tr_b16 a[182:183], v210 offset:1024
s_add_u32 s44, s44, s52
v_mfma_f32_16x16x32_bf16 v[24:27], a[192:195], a[72:75], v[24:27]
ds_read_b128 a[212:215], v220 offset:40960
ds_read_b64_tr_b16 a[184:185], v211 offset:0
v_mfma_f32_16x16x32_bf16 v[28:31], a[192:195], a[76:79], v[28:31]
ds_read_b64_tr_b16 a[186:187], v211 offset:1024
v_mfma_f32_16x16x32_bf16 v[32:35], a[196:199], a[72:75], v[32:35]
ds_read_b64_tr_b16 a[188:189], v212 offset:0
v_mfma_f32_16x16x32_bf16 v[36:39], a[196:199], a[76:79], v[36:39]
ds_read_b64_tr_b16 a[190:191], v212 offset:1024
s_lshl_b32 s45, s46, 7
v_mfma_f32_16x16x32_bf16 v[40:43], a[200:203], a[72:75], v[40:43]
ds_read_b64_tr_b16 a[192:193], v213 offset:0
s_add_u32 s45, s45, s51
v_mfma_f32_16x16x32_bf16 v[44:47], a[200:203], a[76:79], v[44:47]
ds_read_b64_tr_b16 a[194:195], v213 offset:1024
v_mfma_f32_16x16x32_bf16 v[48:51], a[204:207], a[72:75], v[48:51]
ds_read_b64_tr_b16 a[196:197], v214 offset:0
v_mfma_f32_16x16x32_bf16 v[52:55], a[204:207], a[76:79], v[52:55]
ds_read_b64_tr_b16 a[198:199], v214 offset:1024
v_mfma_f32_16x16x32_bf16 v[56:59], a[208:211], a[72:75], v[56:59]
ds_read_b64_tr_b16 a[200:201], v215 offset:0
s_add_u32 m0, s39, 147456
v_mfma_f32_16x16x32_bf16 v[60:63], a[208:211], a[76:79], v[60:63]
ds_read_b64_tr_b16 a[202:203], v215 offset:1024
s_waitcnt lgkmcnt(8)
v_mfma_f32_16x16x32_bf16 v[0:3], a[180:183], a[80:83], v[0:3]
ds_read_b64_tr_b16 a[204:205], v216 offset:0
s_add_u32 s46, s46, 1
v_mfma_f32_16x16x32_bf16 v[4:7], a[180:183], a[84:87], v[4:7]
ds_read_b64_tr_b16 a[206:207], v216 offset:1024
buffer_load_dwordx4 v228, s[20:23], s44 offen  lds
v_mfma_f32_16x16x32_bf16 v[64:67], a[180:183], a[212:215], v[64:67]
ds_read_b64_tr_b16 a[208:209], v217 offset:0
v_mfma_f32_16x16x32_bf16 v[8:11], a[184:187], a[80:83], v[8:11]
ds_read_b64_tr_b16 a[210:211], v217 offset:1024
buffer_load_dwordx4 v229, s[20:23], s44 offen offset:1024  lds
v_mfma_f32_16x16x32_bf16 v[12:15], a[184:187], a[84:87], v[12:15]
ds_read_b64_tr_b16 a[180:181], v210 offset:8192
v_mfma_f32_16x16x32_bf16 v[68:71], a[184:187], a[212:215], v[68:71]
ds_read_b64_tr_b16 a[182:183], v210 offset:9216
s_waitcnt lgkmcnt(10)
v_mfma_f32_16x16x32_bf16 v[16:19], a[188:191], a[80:83], v[16:19]
ds_read_b128 a[216:219], v221 offset:40960
v_mfma_f32_16x16x32_bf16 v[20:23], a[188:191], a[84:87], v[20:23]
ds_read_b64_tr_b16 a[184:185], v211 offset:8192
v_mfma_f32_16x16x32_bf16 v[24:27], a[192:195], a[80:83], v[24:27]
ds_read_b64_tr_b16 a[186:187], v211 offset:9216
buffer_load_dwordx4 v230, s[20:23], s44 offen offset:2048  lds
v_mfma_f32_16x16x32_bf16 v[28:31], a[192:195], a[84:87], v[28:31]
ds_read_b64_tr_b16 a[188:189], v212 offset:8192
s_waitcnt lgkmcnt(10)
v_mfma_f32_16x16x32_bf16 v[32:35], a[196:199], a[80:83], v[32:35]
ds_read_b64_tr_b16 a[190:191], v212 offset:9216
v_mfma_f32_16x16x32_bf16 v[36:39], a[196:199], a[84:87], v[36:39]
ds_read_b64_tr_b16 a[192:193], v213 offset:8192
v_mfma_f32_16x16x32_bf16 v[40:43], a[200:203], a[80:83], v[40:43]
ds_read_b64_tr_b16 a[194:195], v213 offset:9216
v_mfma_f32_16x16x32_bf16 v[44:47], a[200:203], a[84:87], v[44:47]
ds_read_b64_tr_b16 a[196:197], v214 offset:8192
s_waitcnt lgkmcnt(10)
v_mfma_f32_16x16x32_bf16 v[48:51], a[204:207], a[80:83], v[48:51]
ds_read_b64_tr_b16 a[198:199], v214 offset:9216
buffer_load_dwordx4 v231, s[20:23], s44 offen offset:3072  lds
v_mfma_f32_16x16x32_bf16 v[52:55], a[204:207], a[84:87], v[52:55]
ds_read_b64_tr_b16 a[200:201], v215 offset:8192
v_mfma_f32_16x16x32_bf16 v[56:59], a[208:211], a[80:83], v[56:59]
ds_read_b64_tr_b16 a[202:203], v215 offset:9216
v_mfma_f32_16x16x32_bf16 v[60:63], a[208:211], a[84:87], v[60:63]
ds_read_b64_tr_b16 a[204:205], v216 offset:8192
s_waitcnt lgkmcnt(9)
v_mfma_f32_16x16x32_bf16 v[0:3], a[180:183], a[88:91], v[0:3]
ds_read_b64_tr_b16 a[206:207], v216 offset:9216
s_lshr_b32 s6, s39, 2
v_mfma_f32_16x16x32_bf16 v[4:7], a[180:183], a[92:95], v[4:7]
ds_read_b64_tr_b16 a[208:209], v217 offset:8192
s_add_u32 m0, s6, 61440
v_mfma_f32_16x16x32_bf16 v[64:67], a[180:183], a[216:219], v[64:67]
ds_read_b64_tr_b16 a[210:211], v217 offset:9216
s_cmp_eq_u32 s46, 9
s_cselect_b32 s46, 0, s46
v_mfma_f32_16x16x32_bf16 v[8:11], a[184:187], a[88:91], v[8:11]
buffer_load_dwordx4 v207, s[8:11], s45 offen  lds
v_mfma_f32_16x16x32_bf16 v[12:15], a[184:187], a[92:95], v[12:15]
v_mfma_f32_16x16x32_bf16 v[68:71], a[184:187], a[216:219], v[68:71]
s_waitcnt vmcnt(5) lgkmcnt(0)
s_barrier
v_mfma_f32_16x16x32_bf16 v[16:19], a[188:191], a[88:91], v[16:19]
ds_read_b64_tr_b16 a[180:181], v210 offset:16384
s_mul_i32 s44, s46, 524288
v_mfma_f32_16x16x32_bf16 v[20:23], a[188:191], a[92:95], v[20:23]
ds_read_b64_tr_b16 a[182:183], v210 offset:17408
s_add_u32 s44, s44, s52
v_mfma_f32_16x16x32_bf16 v[24:27], a[192:195], a[88:91], v[24:27]
ds_read_b128 a[220:223], v220 offset:20480
ds_read_b64_tr_b16 a[184:185], v211 offset:16384
v_mfma_f32_16x16x32_bf16 v[28:31], a[192:195], a[92:95], v[28:31]
ds_read_b64_tr_b16 a[186:187], v211 offset:17408
v_mfma_f32_16x16x32_bf16 v[32:35], a[196:199], a[88:91], v[32:35]
ds_read_b64_tr_b16 a[188:189], v212 offset:16384
v_mfma_f32_16x16x32_bf16 v[36:39], a[196:199], a[92:95], v[36:39]
ds_read_b64_tr_b16 a[190:191], v212 offset:17408
s_lshl_b32 s45, s46, 7
v_mfma_f32_16x16x32_bf16 v[40:43], a[200:203], a[88:91], v[40:43]
ds_read_b64_tr_b16 a[192:193], v213 offset:16384
s_add_u32 s45, s45, s51
v_mfma_f32_16x16x32_bf16 v[44:47], a[200:203], a[92:95], v[44:47]
ds_read_b64_tr_b16 a[194:195], v213 offset:17408
v_mfma_f32_16x16x32_bf16 v[48:51], a[204:207], a[88:91], v[48:51]
ds_read_b64_tr_b16 a[196:197], v214 offset:16384
v_mfma_f32_16x16x32_bf16 v[52:55], a[204:207], a[92:95], v[52:55]
ds_read_b64_tr_b16 a[198:199], v214 offset:17408
v_mfma_f32_16x16x32_bf16 v[56:59], a[208:211], a[88:91], v[56:59]
ds_read_b64_tr_b16 a[200:201], v215 offset:16384
s_add_u32 m0, s39, 114688
v_mfma_f32_16x16x32_bf16 v[60:63], a[208:211], a[92:95], v[60:63]
ds_read_b64_tr_b16 a[202:203], v215 offset:17408
s_waitcnt lgkmcnt(8)
v_mfma_f32_16x16x32_bf16 v[0:3], a[180:183], a[96:99], v[0:3]
ds_read_b64_tr_b16 a[204:205], v216 offset:16384
s_add_u32 s46, s46, 1
v_mfma_f32_16x16x32_bf16 v[4:7], a[180:183], a[100:103], v[4:7]
ds_read_b64_tr_b16 a[206:207], v216 offset:17408
buffer_load_dwordx4 v228, s[20:23], s44 offen  lds
v_mfma_f32_16x16x32_bf16 v[64:67], a[180:183], a[220:223], v[64:67]
ds_read_b64_tr_b16 a[208:209], v217 offset:16384
v_mfma_f32_16x16x32_bf16 v[8:11], a[184:187], a[96:99], v[8:11]
ds_read_b64_tr_b16 a[210:211], v217 offset:17408
buffer_load_dwordx4 v229, s[20:23], s44 offen offset:1024  lds
v_mfma_f32_16x16x32_bf16 v[12:15], a[184:187], a[100:103], v[12:15]
ds_read_b64_tr_b16 a[180:181], v210 offset:24576
v_mfma_f32_16x16x32_bf16 v[68:71], a[184:187], a[220:223], v[68:71]
ds_read_b64_tr_b16 a[182:183], v210 offset:25600
s_waitcnt lgkmcnt(10)
v_mfma_f32_16x16x32_bf16 v[16:19], a[188:191], a[96:99], v[16:19]
ds_read_b128 a[224:227], v221 offset:20480
v_mfma_f32_16x16x32_bf16 v[20:23], a[188:191], a[100:103], v[20:23]
ds_read_b64_tr_b16 a[184:185], v211 offset:24576
v_mfma_f32_16x16x32_bf16 v[24:27], a[192:195], a[96:99], v[24:27]
ds_read_b64_tr_b16 a[186:187], v211 offset:25600
buffer_load_dwordx4 v230, s[20:23], s44 offen offset:2048  lds
v_mfma_f32_16x16x32_bf16 v[28:31], a[192:195], a[100:103], v[28:31]
ds_read_b64_tr_b16 a[188:189], v212 offset:24576
s_waitcnt lgkmcnt(10)
v_mfma_f32_16x16x32_bf16 v[32:35], a[196:199], a[96:99], v[32:35]
ds_read_b64_tr_b16 a[190:191], v212 offset:25600
v_mfma_f32_16x16x32_bf16 v[36:39], a[196:199], a[100:103], v[36:39]
ds_read_b64_tr_b16 a[192:193], v213 offset:24576
v_mfma_f32_16x16x32_bf16 v[40:43], a[200:203], a[96:99], v[40:43]
ds_read_b64_tr_b16 a[194:195], v213 offset:25600
v_mfma_f32_16x16x32_bf16 v[44:47], a[200:203], a[100:103], v[44:47]
ds_read_b64_tr_b16 a[196:197], v214 offset:24576
s_waitcnt lgkmcnt(10)
v_mfma_f32_16x16x32_bf16 v[48:51], a[204:207], a[96:99], v[48:51]
ds_read_b64_tr_b16 a[198:199], v214 offset:25600
buffer_load_dwordx4 v231, s[20:23], s44 offen offset:3072  lds
v_mfma_f32_16x16x32_bf16 v[52:55], a[204:207], a[100:103], v[52:55]
ds_read_b64_tr_b16 a[200:201], v215 offset:24576
v_mfma_f32_16x16x32_bf16 v[56:59], a[208:211], a[96:99], v[56:59]
ds_read_b64_tr_b16 a[202:203], v215 offset:25600
v_mfma_f32_16x16x32_bf16 v[60:63], a[208:211], a[100:103], v[60:63]
ds_read_b64_tr_b16 a[204:205], v216 offset:24576
s_waitcnt lgkmcnt(9)
v_mfma_f32_16x16x32_bf16 v[0:3], a[180:183], a[104:107], v[0:3]
ds_read_b64_tr_b16 a[206:207], v216 offset:25600
s_lshr_b32 s6, s39, 2
v_mfma_f32_16x16x32_bf16 v[4:7], a[180:183], a[108:111], v[4:7]
ds_read_b64_tr_b16 a[208:209], v217 offset:24576
s_add_u32 m0, s6, 102400
v_mfma_f32_16x16x32_bf16 v[64:67], a[180:183], a[224:227], v[64:67]
ds_read_b64_tr_b16 a[210:211], v217 offset:25600
s_cmp_eq_u32 s46, 9
s_cselect_b32 s46, 0, s46
v_mfma_f32_16x16x32_bf16 v[8:11], a[184:187], a[104:107], v[8:11]
buffer_load_dwordx4 v207, s[8:11], s45 offen  lds
v_mfma_f32_16x16x32_bf16 v[12:15], a[184:187], a[108:111], v[12:15]
v_mfma_f32_16x16x32_bf16 v[68:71], a[184:187], a[224:227], v[68:71]
s_waitcnt vmcnt(5) lgkmcnt(0)
s_barrier
v_mfma_f32_16x16x32_bf16 v[16:19], a[188:191], a[104:107], v[16:19]
ds_read_b64_tr_b16 a[180:181], v210 offset:32768
s_mul_i32 s44, s46, 524288
v_mfma_f32_16x16x32_bf16 v[20:23], a[188:191], a[108:111], v[20:23]
ds_read_b64_tr_b16 a[182:183], v210 offset:33792
s_add_u32 s44, s44, s52
v_mfma_f32_16x16x32_bf16 v[24:27], a[192:195], a[104:107], v[24:27]
ds_read_b128 a[212:215], v220 offset:0
ds_read_b64_tr_b16 a[184:185], v211 offset:32768
v_mfma_f32_16x16x32_bf16 v[28:31], a[192:195], a[108:111], v[28:31]
ds_read_b64_tr_b16 a[186:187], v211 offset:33792
v_mfma_f32_16x16x32_bf16 v[32:35], a[196:199], a[104:107], v[32:35]
ds_read_b64_tr_b16 a[188:189], v212 offset:32768
v_mfma_f32_16x16x32_bf16 v[36:39], a[196:199], a[108:111], v[36:39]
ds_read_b64_tr_b16 a[190:191], v212 offset:33792
s_lshl_b32 s45, s46, 7
v_mfma_f32_16x16x32_bf16 v[40:43], a[200:203], a[104:107], v[40:43]
ds_read_b64_tr_b16 a[192:193], v213 offset:32768
s_add_u32 s45, s45, s51
v_mfma_f32_16x16x32_bf16 v[44:47], a[200:203], a[108:111], v[44:47]
ds_read_b64_tr_b16 a[194:195], v213 offset:33792
v_mfma_f32_16x16x32_bf16 v[48:51], a[204:207], a[104:107], v[48:51]
ds_read_b64_tr_b16 a[196:197], v214 offset:32768
v_mfma_f32_16x16x32_bf16 v[52:55], a[204:207], a[108:111], v[52:55]
ds_read_b64_tr_b16 a[198:199], v214 offset:33792
v_mfma_f32_16x16x32_bf16 v[56:59], a[208:211], a[104:107], v[56:59]
ds_read_b64_tr_b16 a[200:201], v215 offset:32768
s_add_u32 m0, s39, 131072
v_mfma_f32_16x16x32_bf16 v[60:63], a[208:211], a[108:111], v[60:63]
ds_read_b64_tr_b16 a[202:203], v215 offset:33792
s_waitcnt lgkmcnt(8)
v_mfma_f32_16x16x32_bf16 v[0:3], a[180:183], a[112:115], v[0:3]
ds_read_b64_tr_b16 a[204:205], v216 offset:32768
s_add_u32 s46, s46, 1
v_mfma_f32_16x16x32_bf16 v[4:7], a[180:183], a[116:119], v[4:7]
ds_read_b64_tr_b16 a[206:207], v216 offset:33792
buffer_load_dwordx4 v228, s[20:23], s44 offen  lds
v_mfma_f32_16x16x32_bf16 v[64:67], a[180:183], a[212:215], v[64:67]
ds_read_b64_tr_b16 a[208:209], v217 offset:32768
v_mfma_f32_16x16x32_bf16 v[8:11], a[184:187], a[112:115], v[8:11]
ds_read_b64_tr_b16 a[210:211], v217 offset:33792
buffer_load_dwordx4 v229, s[20:23], s44 offen offset:1024  lds
v_mfma_f32_16x16x32_bf16 v[12:15], a[184:187], a[116:119], v[12:15]
ds_read_b64_tr_b16 a[180:181], v210 offset:40960
v_mfma_f32_16x16x32_bf16 v[68:71], a[184:187], a[212:215], v[68:71]
ds_read_b64_tr_b16 a[182:183], v210 offset:41984
s_waitcnt lgkmcnt(10)
v_mfma_f32_16x16x32_bf16 v[16:19], a[188:191], a[112:115], v[16:19]
ds_read_b128 a[216:219], v221 offset:0
v_mfma_f32_16x16x32_bf16 v[20:23], a[188:191], a[116:119], v[20:23]
ds_read_b64_tr_b16 a[184:185], v211 offset:40960
v_mfma_f32_16x16x32_bf16 v[24:27], a[192:195], a[112:115], v[24:27]
ds_read_b64_tr_b16 a[186:187], v211 offset:41984
buffer_load_dwordx4 v230, s[20:23], s44 offen offset:2048  lds
v_mfma_f32_16x16x32_bf16 v[28:31], a[192:195], a[116:119], v[28:31]
ds_read_b64_tr_b16 a[188:189], v212 offset:40960
s_waitcnt lgkmcnt(10)
v_mfma_f32_16x16x32_bf16 v[32:35], a[196:199], a[112:115], v[32:35]
ds_read_b64_tr_b16 a[190:191], v212 offset:41984
v_mfma_f32_16x16x32_bf16 v[36:39], a[196:199], a[116:119], v[36:39]
ds_read_b64_tr_b16 a[192:193], v213 offset:40960
v_mfma_f32_16x16x32_bf16 v[40:43], a[200:203], a[112:115], v[40:43]
ds_read_b64_tr_b16 a[194:195], v213 offset:41984
v_mfma_f32_16x16x32_bf16 v[44:47], a[200:203], a[116:119], v[44:47]
ds_read_b64_tr_b16 a[196:197], v214 offset:40960
s_waitcnt lgkmcnt(10)
v_mfma_f32_16x16x32_bf16 v[48:51], a[204:207], a[112:115], v[48:51]
ds_read_b64_tr_b16 a[198:199], v214 offset:41984
buffer_load_dwordx4 v231, s[20:23], s44 offen offset:3072  lds
v_mfma_f32_16x16x32_bf16 v[52:55], a[204:207], a[116:119], v[52:55]
ds_read_b64_tr_b16 a[200:201], v215 offset:40960
v_mfma_f32_16x16x32_bf16 v[56:59], a[208:211], a[112:115], v[56:59]
ds_read_b64_tr_b16 a[202:203], v215 offset:41984
v_mfma_f32_16x16x32_bf16 v[60:63], a[208:211], a[116:119], v[60:63]
ds_read_b64_tr_b16 a[204:205], v216 offset:40960
s_waitcnt lgkmcnt(9)
v_mfma_f32_16x16x32_bf16 v[0:3], a[180:183], a[120:123], v[0:3]
ds_read_b64_tr_b16 a[206:207], v216 offset:41984
s_lshr_b32 s6, s39, 2
v_mfma_f32_16x16x32_bf16 v[4:7], a[180:183], a[124:127], v[4:7]
ds_read_b64_tr_b16 a[208:209], v217 offset:40960
s_add_u32 m0, s6, 81920
v_mfma_f32_16x16x32_bf16 v[64:67], a[180:183], a[216:219], v[64:67]
ds_read_b64_tr_b16 a[210:211], v217 offset:41984
s_cmp_eq_u32 s46, 9
s_cselect_b32 s46, 0, s46
v_mfma_f32_16x16x32_bf16 v[8:11], a[184:187], a[120:123], v[8:11]
buffer_load_dwordx4 v207, s[8:11], s45 offen  lds
v_mfma_f32_16x16x32_bf16 v[12:15], a[184:187], a[124:127], v[12:15]
v_mfma_f32_16x16x32_bf16 v[68:71], a[184:187], a[216:219], v[68:71]
s_waitcnt vmcnt(5) lgkmcnt(0)
s_barrier
v_mfma_f32_16x16x32_bf16 v[16:19], a[188:191], a[120:123], v[16:19]
ds_read_b64_tr_b16 a[180:181], v210 offset:0
s_mul_i32 s44, s46, 524288
v_mfma_f32_16x16x32_bf16 v[20:23], a[188:191], a[124:127], v[20:23]
ds_read_b64_tr_b16 a[182:183], v210 offset:1024
s_add_u32 s44, s44, s52
v_mfma_f32_16x16x32_bf16 v[24:27], a[192:195], a[120:123], v[24:27]
ds_read_b128 a[220:223], v220 offset:40960
ds_read_b64_tr_b16 a[184:185], v211 offset:0
v_mfma_f32_16x16x32_bf16 v[28:31], a[192:195], a[124:127], v[28:31]
ds_read_b64_tr_b16 a[186:187], v211 offset:1024
v_mfma_f32_16x16x32_bf16 v[32:35], a[196:199], a[120:123], v[32:35]
ds_read_b64_tr_b16 a[188:189], v212 offset:0
v_mfma_f32_16x16x32_bf16 v[36:39], a[196:199], a[124:127], v[36:39]
ds_read_b64_tr_b16 a[190:191], v212 offset:1024
s_lshl_b32 s45, s46, 7
v_mfma_f32_16x16x32_bf16 v[40:43], a[200:203], a[120:123], v[40:43]
ds_read_b64_tr_b16 a[192:193], v213 offset:0
s_add_u32 s45, s45, s51
v_mfma_f32_16x16x32_bf16 v[44:47], a[200:203], a[124:127], v[44:47]
ds_read_b64_tr_b16 a[194:195], v213 offset:1024
v_mfma_f32_16x16x32_bf16 v[48:51], a[204:207], a[120:123], v[48:51]
ds_read_b64_tr_b16 a[196:197], v214 offset:0
v_mfma_f32_16x16x32_bf16 v[52:55], a[204:207], a[124:127], v[52:55]
ds_read_b64_tr_b16 a[198:199], v214 offset:1024
v_mfma_f32_16x16x32_bf16 v[56:59], a[208:211], a[120:123], v[56:59]
ds_read_b64_tr_b16 a[200:201], v215 offset:0
s_add_u32 m0, s39, 147456
v_mfma_f32_16x16x32_bf16 v[60:63], a[208:211], a[124:127], v[60:63]
ds_read_b64_tr_b16 a[202:203], v215 offset:1024
s_waitcnt lgkmcnt(8)
v_mfma_f32_16x16x32_bf16 v[0:3], a[180:183], a[128:131], v[0:3]
ds_read_b64_tr_b16 a[204:205], v216 offset:0
s_add_u32 s46, s46, 1
v_mfma_f32_16x16x32_bf16 v[4:7], a[180:183], a[132:135], v[4:7]
ds_read_b64_tr_b16 a[206:207], v216 offset:1024
buffer_load_dwordx4 v228, s[20:23], s44 offen  lds
v_mfma_f32_16x16x32_bf16 v[64:67], a[180:183], a[220:223], v[64:67]
ds_read_b64_tr_b16 a[208:209], v217 offset:0
v_mfma_f32_16x16x32_bf16 v[8:11], a[184:187], a[128:131], v[8:11]
ds_read_b64_tr_b16 a[210:211], v217 offset:1024
buffer_load_dwordx4 v229, s[20:23], s44 offen offset:1024  lds
v_mfma_f32_16x16x32_bf16 v[12:15], a[184:187], a[132:135], v[12:15]
ds_read_b64_tr_b16 a[180:181], v210 offset:8192
v_mfma_f32_16x16x32_bf16 v[68:71], a[184:187], a[220:223], v[68:71]
ds_read_b64_tr_b16 a[182:183], v210 offset:9216
s_waitcnt lgkmcnt(10)
v_mfma_f32_16x16x32_bf16 v[16:19], a[188:191], a[128:131], v[16:19]
ds_read_b128 a[224:227], v221 offset:40960
v_mfma_f32_16x16x32_bf16 v[20:23], a[188:191], a[132:135], v[20:23]
ds_read_b64_tr_b16 a[184:185], v211 offset:8192
v_mfma_f32_16x16x32_bf16 v[24:27], a[192:195], a[128:131], v[24:27]
ds_read_b64_tr_b16 a[186:187], v211 offset:9216
buffer_load_dwordx4 v230, s[20:23], s44 offen offset:2048  lds
v_mfma_f32_16x16x32_bf16 v[28:31], a[192:195], a[132:135], v[28:31]
ds_read_b64_tr_b16 a[188:189], v212 offset:8192
s_waitcnt lgkmcnt(10)
v_mfma_f32_16x16x32_bf16 v[32:35], a[196:199], a[128:131], v[32:35]
ds_read_b64_tr_b16 a[190:191], v212 offset:9216
v_mfma_f32_16x16x32_bf16 v[36:39], a[196:199], a[132:135], v[36:39]
ds_read_b64_tr_b16 a[192:193], v213 offset:8192
v_mfma_f32_16x16x32_bf16 v[40:43], a[200:203], a[128:131], v[40:43]
ds_read_b64_tr_b16 a[194:195], v213 offset:9216
v_mfma_f32_16x16x32_bf16 v[44:47], a[200:203], a[132:135], v[44:47]
ds_read_b64_tr_b16 a[196:197], v214 offset:8192
s_waitcnt lgkmcnt(10)
v_mfma_f32_16x16x32_bf16 v[48:51], a[204:207], a[128:131], v[48:51]
ds_read_b64_tr_b16 a[198:199], v214 offset:9216
buffer_load_dwordx4 v231, s[20:23], s44 offen offset:3072  lds
v_mfma_f32_16x16x32_bf16 v[52:55], a[204:207], a[132:135], v[52:55]
ds_read_b64_tr_b16 a[200:201], v215 offset:8192
v_mfma_f32_16x16x32_bf16 v[56:59], a[208:211], a[128:131], v[56:59]
ds_read_b64_tr_b16 a[202:203], v215 offset:9216
v_mfma_f32_16x16x32_bf16 v[60:63], a[208:211], a[132:135], v[60:63]
ds_read_b64_tr_b16 a[204:205], v216 offset:8192
s_waitcnt lgkmcnt(9)
v_mfma_f32_16x16x32_bf16 v[0:3], a[180:183], a[136:139], v[0:3]
ds_read_b64_tr_b16 a[206:207], v216 offset:9216
s_lshr_b32 s6, s39, 2
v_mfma_f32_16x16x32_bf16 v[4:7], a[180:183], a[140:143], v[4:7]
ds_read_b64_tr_b16 a[208:209], v217 offset:8192
s_add_u32 m0, s6, 61440
v_mfma_f32_16x16x32_bf16 v[64:67], a[180:183], a[224:227], v[64:67]
ds_read_b64_tr_b16 a[210:211], v217 offset:9216
s_cmp_eq_u32 s46, 9
s_cselect_b32 s46, 0, s46
v_mfma_f32_16x16x32_bf16 v[8:11], a[184:187], a[136:139], v[8:11]
buffer_load_dwordx4 v207, s[8:11], s45 offen  lds
v_mfma_f32_16x16x32_bf16 v[12:15], a[184:187], a[140:143], v[12:15]
v_mfma_f32_16x16x32_bf16 v[68:71], a[184:187], a[224:227], v[68:71]
s_waitcnt vmcnt(5) lgkmcnt(0)
s_barrier
v_mfma_f32_16x16x32_bf16 v[16:19], a[188:191], a[136:139], v[16:19]
ds_read_b64_tr_b16 a[180:181], v210 offset:16384
s_mul_i32 s44, s46, 524288
v_mfma_f32_16x16x32_bf16 v[20:23], a[188:191], a[140:143], v[20:23]
ds_read_b64_tr_b16 a[182:183], v210 offset:17408
s_add_u32 s44, s44, s52
v_mfma_f32_16x16x32_bf16 v[24:27], a[192:195], a[136:139], v[24:27]
ds_read_b128 a[212:215], v220 offset:20480
ds_read_b64_tr_b16 a[184:185], v211 offset:16384
v_mfma_f32_16x16x32_bf16 v[28:31], a[192:195], a[140:143], v[28:31]
ds_read_b64_tr_b16 a[186:187], v211 offset:17408
v_mfma_f32_16x16x32_bf16 v[32:35], a[196:199], a[136:139], v[32:35]
ds_read_b64_tr_b16 a[188:189], v212 offset:16384
v_mfma_f32_16x16x32_bf16 v[36:39], a[196:199], a[140:143], v[36:39]
ds_read_b64_tr_b16 a[190:191], v212 offset:17408
s_lshl_b32 s45, s46, 7
v_mfma_f32_16x16x32_bf16 v[40:43], a[200:203], a[136:139], v[40:43]
ds_read_b64_tr_b16 a[192:193], v213 offset:16384
s_add_u32 s45, s45, s51
v_mfma_f32_16x16x32_bf16 v[44:47], a[200:203], a[140:143], v[44:47]
ds_read_b64_tr_b16 a[194:195], v213 offset:17408
v_mfma_f32_16x16x32_bf16 v[48:51], a[204:207], a[136:139], v[48:51]
ds_read_b64_tr_b16 a[196:197], v214 offset:16384
v_mfma_f32_16x16x32_bf16 v[52:55], a[204:207], a[140:143], v[52:55]
ds_read_b64_tr_b16 a[198:199], v214 offset:17408
v_mfma_f32_16x16x32_bf16 v[56:59], a[208:211], a[136:139], v[56:59]
ds_read_b64_tr_b16 a[200:201], v215 offset:16384
s_add_u32 m0, s39, 114688
v_mfma_f32_16x16x32_bf16 v[60:63], a[208:211], a[140:143], v[60:63]
ds_read_b64_tr_b16 a[202:203], v215 offset:17408
s_waitcnt lgkmcnt(8)
v_mfma_f32_16x16x32_bf16 v[0:3], a[180:183], a[144:147], v[0:3]
ds_read_b64_tr_b16 a[204:205], v216 offset:16384
s_add_u32 s46, s46, 1
v_mfma_f32_16x16x32_bf16 v[4:7], a[180:183], a[148:151], v[4:7]
ds_read_b64_tr_b16 a[206:207], v216 offset:17408
buffer_load_dwordx4 v228, s[20:23], s44 offen  lds
v_mfma_f32_16x16x32_bf16 v[64:67], a[180:183], a[212:215], v[64:67]
ds_read_b64_tr_b16 a[208:209], v217 offset:16384
v_mfma_f32_16x16x32_bf16 v[8:11], a[184:187], a[144:147], v[8:11]
ds_read_b64_tr_b16 a[210:211], v217 offset:17408
buffer_load_dwordx4 v229, s[20:23], s44 offen offset:1024  lds
v_mfma_f32_16x16x32_bf16 v[12:15], a[184:187], a[148:151], v[12:15]
ds_read_b64_tr_b16 a[180:181], v210 offset:24576
v_mfma_f32_16x16x32_bf16 v[68:71], a[184:187], a[212:215], v[68:71]
ds_read_b64_tr_b16 a[182:183], v210 offset:25600
s_waitcnt lgkmcnt(10)
v_mfma_f32_16x16x32_bf16 v[16:19], a[188:191], a[144:147], v[16:19]
ds_read_b128 a[216:219], v221 offset:20480
v_mfma_f32_16x16x32_bf16 v[20:23], a[188:191], a[148:151], v[20:23]
ds_read_b64_tr_b16 a[184:185], v211 offset:24576
v_mfma_f32_16x16x32_bf16 v[24:27], a[192:195], a[144:147], v[24:27]
ds_read_b64_tr_b16 a[186:187], v211 offset:25600
buffer_load_dwordx4 v230, s[20:23], s44 offen offset:2048  lds
v_mfma_f32_16x16x32_bf16 v[28:31], a[192:195], a[148:151], v[28:31]
ds_read_b64_tr_b16 a[188:189], v212 offset:24576
s_waitcnt lgkmcnt(10)
v_mfma_f32_16x16x32_bf16 v[32:35], a[196:199], a[144:147], v[32:35]
ds_read_b64_tr_b16 a[190:191], v212 offset:25600
v_mfma_f32_16x16x32_bf16 v[36:39], a[196:199], a[148:151], v[36:39]
ds_read_b64_tr_b16 a[192:193], v213 offset:24576
v_mfma_f32_16x16x32_bf16 v[40:43], a[200:203], a[144:147], v[40:43]
ds_read_b64_tr_b16 a[194:195], v213 offset:25600
v_mfma_f32_16x16x32_bf16 v[44:47], a[200:203], a[148:151], v[44:47]
ds_read_b64_tr_b16 a[196:197], v214 offset:24576
s_waitcnt lgkmcnt(10)
v_mfma_f32_16x16x32_bf16 v[48:51], a[204:207], a[144:147], v[48:51]
ds_read_b64_tr_b16 a[198:199], v214 offset:25600
buffer_load_dwordx4 v231, s[20:23], s44 offen offset:3072  lds
v_mfma_f32_16x16x32_bf16 v[52:55], a[204:207], a[148:151], v[52:55]
ds_read_b64_tr_b16 a[200:201], v215 offset:24576
v_mfma_f32_16x16x32_bf16 v[56:59], a[208:211], a[144:147], v[56:59]
ds_read_b64_tr_b16 a[202:203], v215 offset:25600
v_mfma_f32_16x16x32_bf16 v[60:63], a[208:211], a[148:151], v[60:63]
ds_read_b64_tr_b16 a[204:205], v216 offset:24576
s_waitcnt lgkmcnt(9)
v_mfma_f32_16x16x32_bf16 v[0:3], a[180:183], a[152:155], v[0:3]
ds_read_b64_tr_b16 a[206:207], v216 offset:25600
s_lshr_b32 s6, s39, 2
v_mfma_f32_16x16x32_bf16 v[4:7], a[180:183], a[156:159], v[4:7]
ds_read_b64_tr_b16 a[208:209], v217 offset:24576
s_add_u32 m0, s6, 102400
v_mfma_f32_16x16x32_bf16 v[64:67], a[180:183], a[216:219], v[64:67]
ds_read_b64_tr_b16 a[210:211], v217 offset:25600
s_cmp_eq_u32 s46, 9
s_cselect_b32 s46, 0, s46
v_mfma_f32_16x16x32_bf16 v[8:11], a[184:187], a[152:155], v[8:11]
buffer_load_dwordx4 v207, s[8:11], s45 offen  lds
v_mfma_f32_16x16x32_bf16 v[12:15], a[184:187], a[156:159], v[12:15]
v_mfma_f32_16x16x32_bf16 v[68:71], a[184:187], a[216:219], v[68:71]
s_waitcnt vmcnt(5) lgkmcnt(0)
s_barrier
v_mfma_f32_16x16x32_bf16 v[16:19], a[188:191], a[152:155], v[16:19]
ds_read_b64_tr_b16 a[180:181], v210 offset:32768
s_add_u32 s52, s52, 0
v_mfma_f32_16x16x32_bf16 v[20:23], a[188:191], a[156:159], v[20:23]
ds_read_b64_tr_b16 a[182:183], v210 offset:33792
v_mfma_f32_16x16x32_bf16 v[24:27], a[192:195], a[152:155], v[24:27]
ds_read_b128 a[220:223], v220 offset:0
ds_read_b64_tr_b16 a[184:185], v211 offset:32768
v_mfma_f32_16x16x32_bf16 v[28:31], a[192:195], a[156:159], v[28:31]
ds_read_b64_tr_b16 a[186:187], v211 offset:33792
v_mfma_f32_16x16x32_bf16 v[32:35], a[196:199], a[152:155], v[32:35]
ds_read_b64_tr_b16 a[188:189], v212 offset:32768
v_mfma_f32_16x16x32_bf16 v[36:39], a[196:199], a[156:159], v[36:39]
ds_read_b64_tr_b16 a[190:191], v212 offset:33792
v_mfma_f32_16x16x32_bf16 v[40:43], a[200:203], a[152:155], v[40:43]
ds_read_b64_tr_b16 a[192:193], v213 offset:32768
v_mfma_f32_16x16x32_bf16 v[44:47], a[200:203], a[156:159], v[44:47]
ds_read_b64_tr_b16 a[194:195], v213 offset:33792
s_add_u32 m0, s39, 0
v_mfma_f32_16x16x32_bf16 v[48:51], a[204:207], a[152:155], v[48:51]
ds_read_b64_tr_b16 a[196:197], v214 offset:32768
s_add_u32 s42, s42, 16384
v_mfma_f32_16x16x32_bf16 v[52:55], a[204:207], a[156:159], v[52:55]
ds_read_b64_tr_b16 a[198:199], v214 offset:33792
buffer_load_dwordx4 v222, s[12:15], s42 offen nt lds
v_mfma_f32_16x16x32_bf16 v[56:59], a[208:211], a[152:155], v[56:59]
ds_read_b64_tr_b16 a[200:201], v215 offset:32768
v_mfma_f32_16x16x32_bf16 v[60:63], a[208:211], a[156:159], v[60:63]
ds_read_b64_tr_b16 a[202:203], v215 offset:33792
s_waitcnt lgkmcnt(8)
v_mfma_f32_16x16x32_bf16 v[0:3], a[180:183], a[160:163], v[0:3]
ds_read_b64_tr_b16 a[204:205], v216 offset:32768
v_mfma_f32_16x16x32_bf16 v[4:7], a[180:183], a[164:167], v[4:7]
ds_read_b64_tr_b16 a[206:207], v216 offset:33792
v_mfma_f32_16x16x32_bf16 v[64:67], a[180:183], a[220:223], v[64:67]
ds_read_b64_tr_b16 a[208:209], v217 offset:32768
buffer_load_dwordx4 v223, s[12:15], s42 offen offset:1024 nt lds
v_mfma_f32_16x16x32_bf16 v[8:11], a[184:187], a[160:163], v[8:11]
ds_read_b64_tr_b16 a[210:211], v217 offset:33792
v_mfma_f32_16x16x32_bf16 v[12:15], a[184:187], a[164:167], v[12:15]
ds_read_b64_tr_b16 a[180:181], v210 offset:40960
v_mfma_f32_16x16x32_bf16 v[68:71], a[184:187], a[220:223], v[68:71]
ds_read_b64_tr_b16 a[182:183], v210 offset:41984
s_waitcnt lgkmcnt(10)
v_mfma_f32_16x16x32_bf16 v[16:19], a[188:191], a[160:163], v[16:19]
ds_read_b128 a[224:227], v221 offset:0
v_mfma_f32_16x16x32_bf16 v[20:23], a[188:191], a[164:167], v[20:23]
ds_read_b64_tr_b16 a[184:185], v211 offset:40960
v_mfma_f32_16x16x32_bf16 v[24:27], a[192:195], a[160:163], v[24:27]
ds_read_b64_tr_b16 a[186:187], v211 offset:41984
v_mfma_f32_16x16x32_bf16 v[28:31], a[192:195], a[164:167], v[28:31]
ds_read_b64_tr_b16 a[188:189], v212 offset:40960
s_waitcnt lgkmcnt(10)
v_mfma_f32_16x16x32_bf16 v[32:35], a[196:199], a[160:163], v[32:35]
ds_read_b64_tr_b16 a[190:191], v212 offset:41984
buffer_load_dwordx4 v224, s[12:15], s42 offen offset:2048 nt lds
v_mfma_f32_16x16x32_bf16 v[36:39], a[196:199], a[164:167], v[36:39]
ds_read_b64_tr_b16 a[192:193], v213 offset:40960
v_mfma_f32_16x16x32_bf16 v[40:43], a[200:203], a[160:163], v[40:43]
ds_read_b64_tr_b16 a[194:195], v213 offset:41984
v_mfma_f32_16x16x32_bf16 v[44:47], a[200:203], a[164:167], v[44:47]
ds_read_b64_tr_b16 a[196:197], v214 offset:40960
s_waitcnt lgkmcnt(10)
v_mfma_f32_16x16x32_bf16 v[48:51], a[204:207], a[160:163], v[48:51]
ds_read_b64_tr_b16 a[198:199], v214 offset:41984
v_mfma_f32_16x16x32_bf16 v[52:55], a[204:207], a[164:167], v[52:55]
ds_read_b64_tr_b16 a[200:201], v215 offset:40960
v_mfma_f32_16x16x32_bf16 v[56:59], a[208:211], a[160:163], v[56:59]
ds_read_b64_tr_b16 a[202:203], v215 offset:41984
buffer_load_dwordx4 v225, s[12:15], s42 offen offset:3072 nt lds
v_mfma_f32_16x16x32_bf16 v[60:63], a[208:211], a[164:167], v[60:63]
ds_read_b64_tr_b16 a[204:205], v216 offset:40960
s_waitcnt lgkmcnt(9)
v_mfma_f32_16x16x32_bf16 v[0:3], a[180:183], a[168:171], v[0:3]
ds_read_b64_tr_b16 a[206:207], v216 offset:41984
v_mfma_f32_16x16x32_bf16 v[4:7], a[180:183], a[172:175], v[4:7]
ds_read_b64_tr_b16 a[208:209], v217 offset:40960
v_mfma_f32_16x16x32_bf16 v[64:67], a[180:183], a[224:227], v[64:67]
ds_read_b64_tr_b16 a[210:211], v217 offset:41984
v_mfma_f32_16x16x32_bf16 v[8:11], a[184:187], a[168:171], v[8:11]
v_mfma_f32_16x16x32_bf16 v[12:15], a[184:187], a[172:175], v[12:15]
v_mfma_f32_16x16x32_bf16 v[68:71], a[184:187], a[224:227], v[68:71]
s_waitcnt vmcnt(4) lgkmcnt(0)
s_barrier
v_mfma_f32_16x16x32_bf16 v[16:19], a[188:191], a[168:171], v[16:19]
ds_read_b64_tr_b16 a[180:181], v210 offset:0
s_add_u32 m0, s39, 16384
v_mfma_f32_16x16x32_bf16 v[20:23], a[188:191], a[172:175], v[20:23]
ds_read_b64_tr_b16 a[182:183], v210 offset:1024
s_add_u32 s42, s42, 16384
v_mfma_f32_16x16x32_bf16 v[24:27], a[192:195], a[168:171], v[24:27]
ds_read_b128 a[212:215], v220 offset:40960
ds_read_b64_tr_b16 a[184:185], v210 offset:8192
ds_read_b64_tr_b16 a[186:187], v210 offset:9216
v_mfma_f32_16x16x32_bf16 v[28:31], a[192:195], a[172:175], v[28:31]
ds_read_b128 a[216:219], v221 offset:40960
buffer_load_dwordx4 v222, s[12:15], s42 offen nt lds
v_mfma_f32_16x16x32_bf16 v[32:35], a[196:199], a[168:171], v[32:35]
ds_read_b64_tr_b16 a[188:189], v211 offset:0
v_mfma_f32_16x16x32_bf16 v[36:39], a[196:199], a[172:175], v[36:39]
ds_read_b64_tr_b16 a[190:191], v211 offset:1024
v_mfma_f32_16x16x32_bf16 v[40:43], a[200:203], a[168:171], v[40:43]
ds_read_b64_tr_b16 a[192:193], v211 offset:8192
buffer_load_dwordx4 v223, s[12:15], s42 offen offset:1024 nt lds
v_mfma_f32_16x16x32_bf16 v[44:47], a[200:203], a[172:175], v[44:47]
ds_read_b64_tr_b16 a[194:195], v211 offset:9216
v_mfma_f32_16x16x32_bf16 v[48:51], a[204:207], a[168:171], v[48:51]
ds_read_b64_tr_b16 a[196:197], v212 offset:0
v_mfma_f32_16x16x32_bf16 v[52:55], a[204:207], a[172:175], v[52:55]
ds_read_b64_tr_b16 a[198:199], v212 offset:1024
v_mfma_f32_16x16x32_bf16 v[56:59], a[208:211], a[168:171], v[56:59]
ds_read_b64_tr_b16 a[200:201], v212 offset:8192
v_mfma_f32_16x16x32_bf16 v[60:63], a[208:211], a[172:175], v[60:63]
ds_read_b64_tr_b16 a[202:203], v212 offset:9216
s_waitcnt lgkmcnt(9)
v_mfma_f32_16x16x32_bf16 v[0:3], a[180:183], a[176:179], v[0:3]
ds_read_b64_tr_b16 a[204:205], v213 offset:0
buffer_load_dwordx4 v224, s[12:15], s42 offen offset:2048 nt lds
v_mfma_f32_16x16x32_bf16 v[4:7], a[180:183], a[240:243], v[4:7]
ds_read_b64_tr_b16 a[206:207], v213 offset:1024
v_mfma_f32_16x16x32_bf16 v[64:67], a[180:183], a[212:215], v[64:67]
ds_read_b64_tr_b16 a[208:209], v213 offset:8192
v_mfma_f32_16x16x32_bf16 v[0:3], a[184:187], a[244:247], v[0:3]
ds_read_b64_tr_b16 a[210:211], v213 offset:9216
v_mfma_f32_16x16x32_bf16 v[4:7], a[184:187], a[248:251], v[4:7]
ds_read_b64_tr_b16 a[180:181], v214 offset:0
s_waitcnt lgkmcnt(11)
v_mfma_f32_16x16x32_bf16 v[64:67], a[184:187], a[216:219], v[64:67]
ds_read_b64_tr_b16 a[182:183], v214 offset:1024
v_mfma_f32_16x16x32_bf16 v[8:11], a[188:191], a[176:179], v[8:11]
ds_read_b64_tr_b16 a[184:185], v214 offset:8192
buffer_load_dwordx4 v225, s[12:15], s42 offen offset:3072 nt lds
v_mfma_f32_16x16x32_bf16 v[12:15], a[188:191], a[240:243], v[12:15]
ds_read_b64_tr_b16 a[186:187], v214 offset:9216
v_mfma_f32_16x16x32_bf16 v[68:71], a[188:191], a[212:215], v[68:71]
s_waitcnt lgkmcnt(10)
v_mfma_f32_16x16x32_bf16 v[8:11], a[192:195], a[244:247], v[8:11]
ds_read_b64_tr_b16 a[188:189], v215 offset:0
v_mfma_f32_16x16x32_bf16 v[12:15], a[192:195], a[248:251], v[12:15]
ds_read_b64_tr_b16 a[190:191], v215 offset:1024
v_mfma_f32_16x16x32_bf16 v[68:71], a[192:195], a[216:219], v[68:71]
v_mfma_f32_16x16x32_bf16 v[16:19], a[196:199], a[176:179], v[16:19]
ds_read_b64_tr_b16 a[192:193], v215 offset:8192
s_add_u32 m0, s39, 65536
v_mfma_f32_16x16x32_bf16 v[20:23], a[196:199], a[240:243], v[20:23]
ds_read_b64_tr_b16 a[194:195], v215 offset:9216
s_waitcnt lgkmcnt(10)
v_mfma_f32_16x16x32_bf16 v[16:19], a[200:203], a[244:247], v[16:19]
ds_read_b64_tr_b16 a[196:197], v216 offset:0
s_add_u32 s43, s43, 16384
v_mfma_f32_16x16x32_bf16 v[20:23], a[200:203], a[248:251], v[20:23]
ds_read_b64_tr_b16 a[198:199], v216 offset:1024
buffer_load_dwordx4 v226, s[16:19], s43 offen nt lds
v_mfma_f32_16x16x32_bf16 v[24:27], a[204:207], a[176:179], v[24:27]
ds_read_b64_tr_b16 a[200:201], v216 offset:8192
v_mul_f32 v64, s4, v64
v_mfma_f32_16x16x32_bf16 v[28:31], a[204:207], a[240:243], v[28:31]
ds_read_b64_tr_b16 a[202:203], v216 offset:9216
s_waitcnt lgkmcnt(10)
v_mfma_f32_16x16x32_bf16 v[24:27], a[208:211], a[244:247], v[24:27]
ds_read_b64_tr_b16 a[204:205], v217 offset:0
buffer_load_dwordx4 v227, s[16:19], s43 offen offset:1024 nt lds
v_mfma_f32_16x16x32_bf16 v[28:31], a[208:211], a[248:251], v[28:31]
ds_read_b64_tr_b16 a[206:207], v217 offset:1024
v_mul_f32 v65, s4, v65
v_mfma_f32_16x16x32_bf16 v[32:35], a[180:183], a[176:179], v[32:35]
ds_read_b64_tr_b16 a[208:209], v217 offset:8192
v_cvt_pk_bf16_f32 v80, v64, v65
v_mfma_f32_16x16x32_bf16 v[36:39], a[180:183], a[240:243], v[36:39]
ds_read_b64_tr_b16 a[210:211], v217 offset:9216
s_waitcnt lgkmcnt(10)
v_mfma_f32_16x16x32_bf16 v[32:35], a[184:187], a[244:247], v[32:35]
v_mul_f32 v66, s4, v66
v_mul_f32 v67, s4, v67
v_mfma_f32_16x16x32_bf16 v[36:39], a[184:187], a[248:251], v[36:39]
v_cvt_pk_bf16_f32 v81, v66, v67
v_mul_f32 v68, s4, v68
v_mfma_f32_16x16x32_bf16 v[40:43], a[188:191], a[176:179], v[40:43]
buffer_load_dwordx4 v226, s[16:19], s43 offen offset:2048 nt lds
v_mfma_f32_16x16x32_bf16 v[44:47], a[188:191], a[240:243], v[44:47]
v_mul_f32 v69, s4, v69
s_waitcnt lgkmcnt(6)
v_mfma_f32_16x16x32_bf16 v[40:43], a[192:195], a[244:247], v[40:43]
v_cvt_pk_bf16_f32 v82, v68, v69
v_mul_f32 v70, s4, v70
v_mfma_f32_16x16x32_bf16 v[44:47], a[192:195], a[248:251], v[44:47]
v_mul_f32 v71, s4, v71
v_cvt_pk_bf16_f32 v83, v70, v71
v_mfma_f32_16x16x32_bf16 v[48:51], a[196:199], a[176:179], v[48:51]
v_mul_f32 v0, s4, v0
v_mul_f32 v1, s4, v1
v_mfma_f32_16x16x32_bf16 v[52:55], a[196:199], a[240:243], v[52:55]
v_cvt_pk_bf16_f32 v112, v0, v1
s_waitcnt lgkmcnt(2)
v_mfma_f32_16x16x32_bf16 v[48:51], a[200:203], a[244:247], v[48:51]
buffer_load_dwordx4 v227, s[16:19], s43 offen offset:3072 nt lds
v_mfma_f32_16x16x32_bf16 v[52:55], a[200:203], a[248:251], v[52:55]
v_mul_f32 v2, s4, v2
v_mul_f32 v3, s4, v3
v_mfma_f32_16x16x32_bf16 v[56:59], a[204:207], a[176:179], v[56:59]
v_cvt_pk_bf16_f32 v113, v2, v3
v_mul_f32 v4, s4, v4
v_mfma_f32_16x16x32_bf16 v[60:63], a[204:207], a[240:243], v[60:63]
v_mul_f32 v5, s4, v5
s_waitcnt lgkmcnt(0)
v_mfma_f32_16x16x32_bf16 v[56:59], a[208:211], a[244:247], v[56:59]
v_cvt_pk_bf16_f32 v128, v4, v5
v_mul_f32 v6, s4, v6
v_mfma_f32_16x16x32_bf16 v[60:63], a[208:211], a[248:251], v[60:63]
v_mul_f32 v7, s4, v7
v_cvt_pk_bf16_f32 v129, v6, v7
s_nop 3
ds_write_b64 v239, v[80:81]
ds_write_b64 v239, v[82:83] offset:512
v_add_u32 v178, 106496, v237
v_pk_mul_f32 v[8:9], v[8:9], s[4:5] op_sel_hi:[1,0]
v_cvt_pk_bf16_f32 v114, v8, v9
v_pk_mul_f32 v[10:11], v[10:11], s[4:5] op_sel_hi:[1,0]
v_cvt_pk_bf16_f32 v115, v10, v11
v_pk_mul_f32 v[12:13], v[12:13], s[4:5] op_sel_hi:[1,0]
v_cvt_pk_bf16_f32 v130, v12, v13
v_pk_mul_f32 v[14:15], v[14:15], s[4:5] op_sel_hi:[1,0]
v_cvt_pk_bf16_f32 v131, v14, v15
v_pk_mul_f32 v[16:17], v[16:17], s[4:5] op_sel_hi:[1,0]
v_cvt_pk_bf16_f32 v116, v16, v17
v_pk_mul_f32 v[18:19], v[18:19], s[4:5] op_sel_hi:[1,0]
v_cvt_pk_bf16_f32 v117, v18, v19
v_pk_mul_f32 v[20:21], v[20:21], s[4:5] op_sel_hi:[1,0]
v_cvt_pk_bf16_f32 v132, v20, v21
v_pk_mul_f32 v[22:23], v[22:23], s[4:5] op_sel_hi:[1,0]
v_cvt_pk_bf16_f32 v133, v22, v23
s_waitcnt vmcnt(8) lgkmcnt(0)
s_barrier
ds_read_b128 a[0:3], v178 offset:0
ds_read_b128 a[4:7], v178 offset:1024
ds_read_b128 a[8:11], v178 offset:2048
ds_read_b128 a[12:15], v178 offset:3072
ds_read_b128 a[180:183], v186 offset:0
ds_read_b128 a[184:187], v187 offset:0
ds_read_b128 a[188:191], v190 offset:0
ds_read_b128 a[192:195], v188 offset:0
ds_read_b128 a[196:199], v191 offset:0
ds_read_b128 a[200:203], v189 offset:0
ds_read_b128 a[204:207], v192 offset:0
v_pk_mul_f32 v[24:25], v[24:25], s[4:5] op_sel_hi:[1,0]
v_cvt_pk_bf16_f32 v118, v24, v25
v_pk_mul_f32 v[26:27], v[26:27], s[4:5] op_sel_hi:[1,0]
v_cvt_pk_bf16_f32 v119, v26, v27
v_pk_mul_f32 v[28:29], v[28:29], s[4:5] op_sel_hi:[1,0]
v_cvt_pk_bf16_f32 v134, v28, v29
v_pk_mul_f32 v[30:31], v[30:31], s[4:5] op_sel_hi:[1,0]
v_cvt_pk_bf16_f32 v135, v30, v31
v_pk_mul_f32 v[32:33], v[32:33], s[4:5] op_sel_hi:[1,0]
v_cvt_pk_bf16_f32 v120, v32, v33
v_pk_mul_f32 v[34:35], v[34:35], s[4:5] op_sel_hi:[1,0]
v_cvt_pk_bf16_f32 v121, v34, v35
v_pk_mul_f32 v[36:37], v[36:37], s[4:5] op_sel_hi:[1,0]
v_cvt_pk_bf16_f32 v136, v36, v37
v_pk_mul_f32 v[38:39], v[38:39], s[4:5] op_sel_hi:[1,0]
v_cvt_pk_bf16_f32 v137, v38, v39
v_pk_mul_f32 v[40:41], v[40:41], s[4:5] op_sel_hi:[1,0]
v_cvt_pk_bf16_f32 v122, v40, v41
v_pk_mul_f32 v[42:43], v[42:43], s[4:5] op_sel_hi:[1,0]
v_cvt_pk_bf16_f32 v123, v42, v43
v_pk_mul_f32 v[44:45], v[44:45], s[4:5] op_sel_hi:[1,0]
v_cvt_pk_bf16_f32 v138, v44, v45
v_pk_mul_f32 v[46:47], v[46:47], s[4:5] op_sel_hi:[1,0]
v_cvt_pk_bf16_f32 v139, v46, v47
v_pk_mul_f32 v[48:49], v[48:49], s[4:5] op_sel_hi:[1,0]
v_cvt_pk_bf16_f32 v124, v48, v49
v_pk_mul_f32 v[50:51], v[50:51], s[4:5] op_sel_hi:[1,0]
v_cvt_pk_bf16_f32 v125, v50, v51
v_pk_mul_f32 v[52:53], v[52:53], s[4:5] op_sel_hi:[1,0]
v_cvt_pk_bf16_f32 v140, v52, v53
v_pk_mul_f32 v[54:55], v[54:55], s[4:5] op_sel_hi:[1,0]
v_cvt_pk_bf16_f32 v141, v54, v55
v_pk_mul_f32 v[56:57], v[56:57], s[4:5] op_sel_hi:[1,0]
v_cvt_pk_bf16_f32 v126, v56, v57
v_pk_mul_f32 v[58:59], v[58:59], s[4:5] op_sel_hi:[1,0]
v_cvt_pk_bf16_f32 v127, v58, v59
v_pk_mul_f32 v[60:61], v[60:61], s[4:5] op_sel_hi:[1,0]
v_cvt_pk_bf16_f32 v142, v60, v61
v_pk_mul_f32 v[62:63], v[62:63], s[4:5] op_sel_hi:[1,0]
v_cvt_pk_bf16_f32 v143, v62, v63
v_mov_b32 v156, 0
v_mov_b32 v157, 0
v_mov_b32 v158, 0
v_mov_b32 v159, 0
v_mov_b32 v160, 0
v_mov_b32 v161, 0
v_mov_b32 v162, 0
v_mov_b32 v163, 0
v_mov_b32 v164, 0
v_mov_b32 v165, 0
v_mov_b32 v166, 0
v_mov_b32 v167, 0
v_permlane32_swap_b32 v112, v114
v_permlane32_swap_b32 v113, v115
v_permlane32_swap_b32 v116, v118
v_permlane32_swap_b32 v117, v119
v_permlane32_swap_b32 v120, v122
v_permlane32_swap_b32 v121, v123
v_permlane32_swap_b32 v124, v126
v_permlane32_swap_b32 v125, v127
v_permlane32_swap_b32 v128, v130
v_permlane32_swap_b32 v129, v131
v_permlane32_swap_b32 v132, v134
v_permlane32_swap_b32 v133, v135
v_permlane32_swap_b32 v136, v138
v_permlane32_swap_b32 v137, v139
v_permlane32_swap_b32 v140, v142
v_permlane32_swap_b32 v141, v143
v_permlane16_swap_b32 v112, v114
v_permlane16_swap_b32 v113, v115
v_permlane16_swap_b32 v116, v118
v_permlane16_swap_b32 v117, v119
v_permlane16_swap_b32 v120, v122
v_permlane16_swap_b32 v121, v123
v_permlane16_swap_b32 v124, v126
v_permlane16_swap_b32 v125, v127
v_permlane16_swap_b32 v128, v130
v_permlane16_swap_b32 v129, v131
v_permlane16_swap_b32 v132, v134
v_permlane16_swap_b32 v133, v135
v_permlane16_swap_b32 v136, v138
v_permlane16_swap_b32 v137, v139
v_permlane16_swap_b32 v140, v142
v_permlane16_swap_b32 v141, v143
s_mov_b32 s54, 0
ATT01:
s_add_u32 s55, s47, s50
v_mov_b32 v177, 0
s_waitcnt lgkmcnt(3)
v_mfma_f32_16x16x32_bf16 v[64:67], a[180:183], v[112:115], v[156:159]
ds_read_b128 a[208:211], v186 offset:4096
s_add_u32 m0, s39, 32768
v_mfma_f32_16x16x32_bf16 v[72:75], a[180:183], v[128:131], v[160:163]
s_add_u32 s42, s42, 16384
buffer_load_dwordx4 v222, s[12:15], s42 offen nt lds
v_mfma_f32_16x16x32_bf16 v[64:67], a[184:187], v[116:119], v[64:67]
ds_read_b128 a[212:215], v193 offset:0
v_mfma_f32_16x16x32_bf16 v[72:75], a[184:187], v[132:135], v[72:75]
buffer_load_dwordx4 v223, s[12:15], s42 offen offset:1024 nt lds
v_mfma_f32_16x16x32_bf16 v[144:147], a[188:191], a[0:3], v[164:167]
ds_read_b128 a[216:219], v187 offset:4096
v_mfma_f32_16x16x32_bf16 v[64:67], a[192:195], v[120:123], v[64:67]
ds_read_b128 a[220:223], v188 offset:4096
v_mfma_f32_16x16x32_bf16 v[72:75], a[192:195], v[136:139], v[72:75]
buffer_load_dwordx4 v224, s[12:15], s42 offen offset:2048 nt lds
s_waitcnt lgkmcnt(3)
v_mfma_f32_16x16x32_bf16 v[144:147], a[196:199], a[4:7], v[144:147]
ds_read_b128 a[224:227], v189 offset:4096
v_mfma_f32_16x16x32_bf16 v[64:67], a[200:203], v[124:127], v[64:67]
ds_read_b128 a[180:183], v186 offset:8192
v_mfma_f32_16x16x32_bf16 v[72:75], a[200:203], v[140:143], v[72:75]
buffer_load_dwordx4 v225, s[12:15], s42 offen offset:3072 nt lds
v_mfma_f32_16x16x32_bf16 v[144:147], a[204:207], a[8:11], v[144:147]
ds_read_b128 a[184:187], v187 offset:8192
v_mfma_f32_16x16x32_bf16 v[68:71], a[208:211], v[112:115], v[156:159]
ds_read_b128 a[188:191], v188 offset:8192
v_mfma_f32_16x16x32_bf16 v[76:79], a[208:211], v[128:131], v[160:163]
s_add_u32 m0, s39, 81920
s_waitcnt lgkmcnt(3)
v_mfma_f32_16x16x32_bf16 v[144:147], a[212:215], a[12:15], v[144:147]
ds_read_b128 a[192:195], v189 offset:8192
s_add_u32 s43, s43, 16384
v_mfma_f32_16x16x32_bf16 v[68:71], a[216:219], v[116:119], v[68:71]
ds_read_b128 a[196:199], v186 offset:12288
buffer_load_dwordx4 v226, s[16:19], s43 offen nt lds
v_mfma_f32_16x16x32_bf16 v[76:79], a[216:219], v[132:135], v[76:79]
buffer_load_dwordx4 v227, s[16:19], s43 offen offset:1024 nt lds
v_mfma_f32_16x16x32_bf16 v[68:71], a[220:223], v[120:123], v[68:71]
ds_read_b128 a[200:203], v187 offset:12288
v_mfma_f32_16x16x32_bf16 v[76:79], a[220:223], v[136:139], v[76:79]
v_mfma_f32_16x16x32_bf16 v[68:71], a[224:227], v[124:127], v[68:71]
ds_read_b128 a[204:207], v188 offset:12288
buffer_load_dwordx4 v226, s[16:19], s43 offen offset:2048 nt lds
v_mfma_f32_16x16x32_bf16 v[76:79], a[224:227], v[140:143], v[76:79]
v_exp_f32 v144, v144
s_waitcnt lgkmcnt(4)
v_mfma_f32_16x16x32_bf16 v[80:83], a[180:183], v[112:115], v[156:159]
ds_read_b128 a[208:211], v189 offset:12288
v_add_f32 v177, v177, v144
v_exp_f32 v145, v145
v_exp_f32 v146, v146
v_cvt_pk_bf16_f32 v152, v144, v145
v_exp_f32 v147, v147
v_add_f32 v177, v177, v145
v_cvt_pk_bf16_f32 v153, v146, v147
v_mfma_f32_16x16x32_bf16 v[88:91], a[180:183], v[128:131], v[160:163]
buffer_load_dwordx4 v227, s[16:19], s43 offen offset:3072 nt lds
ds_write_b64 v202, v[152:153] offset:0
v_mfma_f32_16x16x32_bf16 v[80:83], a[184:187], v[116:119], v[80:83]
v_add_f32 v177, v177, v146
v_add_f32 v177, v177, v147
v_mfma_f32_16x16x32_bf16 v[88:91], a[184:187], v[132:135], v[88:91]
v_mfma_f32_16x16x32_bf16 v[80:83], a[188:191], v[120:123], v[80:83]
s_waitcnt vmcnt(8) lgkmcnt(0)
s_barrier
v_mfma_f32_16x16x32_bf16 v[88:91], a[188:191], v[136:139], v[88:91]
ds_read_b128 a[212:215], v186 offset:16384
s_waitcnt lgkmcnt(3)
v_mfma_f32_16x16x32_bf16 v[80:83], a[192:195], v[124:127], v[80:83]
ds_read_b128 a[216:219], v187 offset:16384
s_add_u32 m0, s39, 49152
v_mfma_f32_16x16x32_bf16 v[88:91], a[192:195], v[140:143], v[88:91]
ds_read_b128 a[220:223], v190 offset:16384
s_add_u32 s42, s42, 16384
v_mfma_f32_16x16x32_bf16 v[84:87], a[196:199], v[112:115], v[156:159]
ds_read_b64_tr_b16 a[224:225], v196 offset:0
buffer_load_dwordx4 v222, s[12:15], s42 offen nt lds
v_mfma_f32_16x16x32_bf16 v[92:95], a[196:199], v[128:131], v[160:163]
ds_read_b64_tr_b16 a[226:227], v196 offset:4096
v_exp_f32 v64, v64
v_mfma_f32_16x16x32_bf16 v[84:87], a[200:203], v[116:119], v[84:87]
ds_read_b128 a[180:183], v191 offset:16384
v_exp_f32 v65, v65
v_mfma_f32_16x16x32_bf16 v[92:95], a[200:203], v[132:135], v[92:95]
v_cvt_pk_bf16_f32 v96, v64, v65
s_waitcnt lgkmcnt(5)
v_mfma_f32_16x16x32_bf16 v[84:87], a[204:207], v[120:123], v[84:87]
ds_read_b128 a[184:187], v188 offset:16384
v_exp_f32 v66, v66
v_mfma_f32_16x16x32_bf16 v[92:95], a[204:207], v[136:139], v[92:95]
buffer_load_dwordx4 v223, s[12:15], s42 offen offset:1024 nt lds
v_mfma_f32_16x16x32_bf16 v[84:87], a[208:211], v[124:127], v[84:87]
ds_read_b128 a[188:191], v192 offset:16384
v_exp_f32 v67, v67
v_mfma_f32_16x16x32_bf16 v[92:95], a[208:211], v[140:143], v[92:95]
v_exp_f32 v68, v68
v_cvt_pk_bf16_f32 v97, v66, v67
v_exp_f32 v69, v69
v_exp_f32 v70, v70
v_cvt_pk_bf16_f32 v98, v68, v69
v_exp_f32 v71, v71
v_exp_f32 v72, v72
v_cvt_pk_bf16_f32 v99, v70, v71
v_exp_f32 v73, v73
v_exp_f32 v74, v74
v_cvt_pk_bf16_f32 v100, v72, v73
v_exp_f32 v75, v75
v_exp_f32 v76, v76
v_cvt_pk_bf16_f32 v101, v74, v75
v_exp_f32 v77, v77
v_exp_f32 v78, v78
v_cvt_pk_bf16_f32 v102, v76, v77
v_exp_f32 v79, v79
s_nop 0
v_cvt_pk_bf16_f32 v103, v78, v79
v_mfma_f32_16x16x32_bf16 v[64:67], a[212:215], v[112:115], v[156:159]
ds_read_b64_tr_b16 a[192:193], v197 offset:0
v_exp_f32 v80, v80
v_mfma_f32_16x16x32_bf16 v[72:75], a[212:215], v[128:131], v[160:163]
ds_read_b64_tr_b16 a[194:195], v197 offset:4096
s_waitcnt lgkmcnt(4)
v_mfma_f32_16x16x32_bf16 v[64:67], a[216:219], v[116:119], v[64:67]
ds_read_b128 a[196:199], v193 offset:16384
v_exp_f32 v81, v81
v_mfma_f32_16x16x32_bf16 v[72:75], a[216:219], v[132:135], v[72:75]
ds_read_b128 a[24:27], v203 offset:0
v_cvt_pk_bf16_f32 v104, v80, v81
v_mfma_f32_16x16x32_bf16 v[144:147], a[220:223], a[0:3], v[164:167]
ds_read_b128 a[200:203], v189 offset:16384
v_exp_f32 v82, v82
v_mfma_f32_16x16x32_bf16 v[16:19], a[224:227], v[96:99], 0
ds_read_b64_tr_b16 a[204:205], v198 offset:0
v_exp_f32 v83, v83
v_mfma_f32_16x16x32_bf16 v[20:23], a[224:227], v[100:103], 0
ds_read_b64_tr_b16 a[206:207], v198 offset:4096
buffer_load_dwordx4 v224, s[12:15], s42 offen offset:2048 nt lds
v_mfma_f32_16x16x32_bf16 v[144:147], a[180:183], a[4:7], v[144:147]
ds_read_b128 a[208:211], v186 offset:20480
s_waitcnt lgkmcnt(5)
v_mfma_f32_16x16x32_bf16 v[64:67], a[184:187], v[120:123], v[64:67]
ds_read_b64_tr_b16 a[212:213], v199 offset:0
v_cvt_pk_bf16_f32 v105, v82, v83
v_mfma_f32_16x16x32_bf16 v[72:75], a[184:187], v[136:139], v[72:75]
ds_read_b64_tr_b16 a[214:215], v199 offset:4096
v_exp_f32 v84, v84
v_mfma_f32_16x16x32_bf16 v[144:147], a[188:191], a[8:11], v[144:147]
ds_read_b128 a[216:219], v187 offset:20480
v_exp_f32 v85, v85
v_mfma_f32_16x16x32_bf16 v[24:27], a[192:195], v[96:99], 0
ds_read_b64_tr_b16 a[220:221], v200 offset:0
v_cvt_pk_bf16_f32 v106, v84, v85
v_mfma_f32_16x16x32_bf16 v[28:31], a[192:195], v[100:103], 0
ds_read_b64_tr_b16 a[222:223], v200 offset:4096
v_exp_f32 v86, v86
v_mfma_f32_16x16x32_bf16 v[144:147], a[196:199], a[12:15], v[144:147]
ds_read_b128 a[224:227], v188 offset:20480
s_waitcnt lgkmcnt(6)
v_mfma_f32_16x16x32_bf16 v[64:67], a[200:203], v[124:127], v[64:67]
ds_read_b64_tr_b16 a[180:181], v201 offset:0
v_exp_f32 v87, v87
v_mfma_f32_16x16x32_bf16 v[72:75], a[200:203], v[140:143], v[72:75]
ds_read_b64_tr_b16 a[182:183], v201 offset:4096
buffer_load_dwordx4 v225, s[12:15], s42 offen offset:3072 nt lds
v_mfma_f32_16x16x32_bf16 v[32:35], a[204:207], v[96:99], 0
ds_read_b128 a[28:31], v203 offset:1024
v_cvt_pk_bf16_f32 v107, v86, v87
v_mfma_f32_16x16x32_bf16 v[36:39], a[204:207], v[100:103], 0
ds_read_b128 a[184:187], v189 offset:20480
v_exp_f32 v88, v88
v_mfma_f32_16x16x32_bf16 v[68:71], a[208:211], v[112:115], v[156:159]
ds_read_b64_tr_b16 a[188:189], v194 offset:0
v_exp_f32 v89, v89
v_mfma_f32_16x16x32_bf16 v[76:79], a[208:211], v[128:131], v[160:163]
ds_read_b64_tr_b16 a[190:191], v194 offset:4096
s_waitcnt lgkmcnt(7)
v_mfma_f32_16x16x32_bf16 v[40:43], a[212:215], v[96:99], 0
ds_read_b64_tr_b16 a[192:193], v195 offset:0
v_cvt_pk_bf16_f32 v108, v88, v89
v_mfma_f32_16x16x32_bf16 v[44:47], a[212:215], v[100:103], 0
ds_read_b64_tr_b16 a[194:195], v195 offset:4096
v_exp_f32 v90, v90
v_mfma_f32_16x16x32_bf16 v[68:71], a[216:219], v[116:119], v[68:71]
ds_read_b128 a[196:199], v186 offset:24576
v_exp_f32 v91, v91
v_mfma_f32_16x16x32_bf16 v[76:79], a[216:219], v[132:135], v[76:79]
v_exp_f32 v92, v92
v_mfma_f32_16x16x32_bf16 v[48:51], a[220:223], v[96:99], 0
ds_read_b128 a[200:203], v187 offset:24576
s_add_u32 m0, s39, 98304
v_mfma_f32_16x16x32_bf16 v[52:55], a[220:223], v[100:103], 0
s_add_u32 s43, s43, 16384
s_waitcnt lgkmcnt(6)
v_mfma_f32_16x16x32_bf16 v[68:71], a[224:227], v[120:123], v[68:71]
ds_read_b64_tr_b16 a[204:205], v196 offset:8192
buffer_load_dwordx4 v226, s[16:19], s43 offen nt lds
v_mfma_f32_16x16x32_bf16 v[76:79], a[224:227], v[136:139], v[76:79]
ds_read_b64_tr_b16 a[206:207], v196 offset:12288
v_cvt_pk_bf16_f32 v109, v90, v91
v_mfma_f32_16x16x32_bf16 v[56:59], a[180:183], v[96:99], 0
ds_read_b128 a[208:211], v188 offset:24576
v_exp_f32 v93, v93
v_mfma_f32_16x16x32_bf16 v[60:63], a[180:183], v[100:103], 0
v_exp_f32 v94, v94
v_mfma_f32_16x16x32_bf16 a[232:235], a[228:231], v[96:99], 0
v_cvt_pk_bf16_f32 v110, v92, v93
v_exp_f32 v95, v95
v_mfma_f32_16x16x32_bf16 v[68:71], a[184:187], v[124:127], v[68:71]
ds_read_b64_tr_b16 a[212:213], v197 offset:8192
v_cvt_pk_bf16_f32 v111, v94, v95
v_mfma_f32_16x16x32_bf16 v[76:79], a[184:187], v[140:143], v[76:79]
ds_read_b64_tr_b16 a[214:215], v197 offset:12288
s_waitcnt lgkmcnt(7)
v_mfma_f32_16x16x32_bf16 v[0:3], a[188:191], v[96:99], 0
ds_read_b128 a[216:219], v189 offset:24576
buffer_load_dwordx4 v227, s[16:19], s43 offen offset:1024 nt lds
v_mfma_f32_16x16x32_bf16 v[4:7], a[188:191], v[100:103], 0
v_exp_f32 v144, v144
v_mfma_f32_16x16x32_bf16 a[16:19], a[188:191], a[24:27], 0
v_exp_f32 v145, v145
v_mfma_f32_16x16x32_bf16 a[236:239], a[228:231], v[100:103], 0
v_exp_f32 v146, v146
v_mfma_f32_16x16x32_bf16 v[8:11], a[192:195], v[96:99], 0
ds_read_b64_tr_b16 a[220:221], v198 offset:8192
v_cvt_pk_bf16_f32 v152, v144, v145
v_mfma_f32_16x16x32_bf16 v[12:15], a[192:195], v[100:103], 0
ds_read_b64_tr_b16 a[222:223], v198 offset:12288
v_add_f32 v177, v177, v144
v_mfma_f32_16x16x32_bf16 a[20:23], a[192:195], a[24:27], 0
v_add_f32 v177, v177, v145
s_waitcnt lgkmcnt(6)
v_mfma_f32_16x16x32_bf16 v[80:83], a[196:199], v[112:115], v[156:159]
ds_read_b128 a[224:227], v186 offset:28672
v_add_f32 v177, v177, v146
v_mfma_f32_16x16x32_bf16 v[88:91], a[196:199], v[128:131], v[160:163]
v_exp_f32 v147, v147
v_mfma_f32_16x16x32_bf16 v[80:83], a[200:203], v[116:119], v[80:83]
ds_read_b64_tr_b16 a[180:181], v199 offset:8192
buffer_load_dwordx4 v226, s[16:19], s43 offen offset:2048 nt lds
v_mfma_f32_16x16x32_bf16 v[88:91], a[200:203], v[132:135], v[88:91]
ds_read_b64_tr_b16 a[182:183], v199 offset:12288
v_cvt_pk_bf16_f32 v153, v146, v147
v_mfma_f32_16x16x32_bf16 v[16:19], a[204:207], v[104:107], v[16:19]
ds_read_b128 a[184:187], v187 offset:28672
ds_write_b64 v202, v[152:153] offset:2048
v_mfma_f32_16x16x32_bf16 v[20:23], a[204:207], v[108:111], v[20:23]
v_add_f32 v177, v177, v147
s_waitcnt lgkmcnt(6)
v_mfma_f32_16x16x32_bf16 v[80:83], a[208:211], v[120:123], v[80:83]
ds_read_b64_tr_b16 a[188:189], v200 offset:8192
v_exp_f32 v64, v64
v_mfma_f32_16x16x32_bf16 v[88:91], a[208:211], v[136:139], v[88:91]
ds_read_b64_tr_b16 a[190:191], v200 offset:12288
v_exp_f32 v65, v65
v_mfma_f32_16x16x32_bf16 v[24:27], a[212:215], v[104:107], v[24:27]
ds_read_b128 a[192:195], v188 offset:28672
v_cvt_pk_bf16_f32 v96, v64, v65
v_mfma_f32_16x16x32_bf16 v[28:31], a[212:215], v[108:111], v[28:31]
v_exp_f32 v66, v66
v_mfma_f32_16x16x32_bf16 v[80:83], a[216:219], v[124:127], v[80:83]
ds_read_b64_tr_b16 a[196:197], v201 offset:8192
v_exp_f32 v67, v67
v_mfma_f32_16x16x32_bf16 v[88:91], a[216:219], v[140:143], v[88:91]
ds_read_b64_tr_b16 a[198:199], v201 offset:12288
s_waitcnt lgkmcnt(6)
v_mfma_f32_16x16x32_bf16 v[32:35], a[220:223], v[104:107], v[32:35]
ds_read_b128 a[200:203], v189 offset:28672
buffer_load_dwordx4 v227, s[16:19], s43 offen offset:3072 nt lds
v_mfma_f32_16x16x32_bf16 v[36:39], a[220:223], v[108:111], v[36:39]
v_exp_f32 v68, v68
v_mfma_f32_16x16x32_bf16 v[84:87], a[224:227], v[112:115], v[156:159]
ds_read_b64_tr_b16 a[204:205], v194 offset:8192
v_cvt_pk_bf16_f32 v97, v66, v67
v_mfma_f32_16x16x32_bf16 v[92:95], a[224:227], v[128:131], v[160:163]
ds_read_b64_tr_b16 a[206:207], v194 offset:12288
v_exp_f32 v69, v69
v_mfma_f32_16x16x32_bf16 v[40:43], a[180:183], v[104:107], v[40:43]
ds_read_b64_tr_b16 a[208:209], v195 offset:8192
v_cvt_pk_bf16_f32 v98, v68, v69
v_mfma_f32_16x16x32_bf16 v[44:47], a[180:183], v[108:111], v[44:47]
ds_read_b64_tr_b16 a[210:211], v195 offset:12288
s_waitcnt lgkmcnt(8)
v_mfma_f32_16x16x32_bf16 v[84:87], a[184:187], v[116:119], v[84:87]
v_exp_f32 v70, v70
v_mfma_f32_16x16x32_bf16 v[92:95], a[184:187], v[132:135], v[92:95]
v_exp_f32 v71, v71
v_mfma_f32_16x16x32_bf16 v[48:51], a[188:191], v[104:107], v[48:51]
s_waitcnt vmcnt(8)
s_barrier
v_mfma_f32_16x16x32_bf16 v[52:55], a[188:191], v[108:111], v[52:55]
ds_read_b128 a[212:215], v186 offset:32768
s_waitcnt lgkmcnt(5)
v_mfma_f32_16x16x32_bf16 v[84:87], a[192:195], v[120:123], v[84:87]
ds_read_b128 a[216:219], v187 offset:32768
s_add_u32 m0, s39, 0
v_mfma_f32_16x16x32_bf16 v[92:95], a[192:195], v[136:139], v[92:95]
ds_read_b128 a[220:223], v190 offset:32768
s_add_u32 s42, s42, 16384
v_mfma_f32_16x16x32_bf16 v[56:59], a[196:199], v[104:107], v[56:59]
ds_read_b64_tr_b16 a[224:225], v196 offset:16384
buffer_load_dwordx4 v222, s[12:15], s42 offen nt lds
v_mfma_f32_16x16x32_bf16 v[60:63], a[196:199], v[108:111], v[60:63]
ds_read_b64_tr_b16 a[226:227], v196 offset:20480
v_cvt_pk_bf16_f32 v99, v70, v71
v_mfma_f32_16x16x32_bf16 a[232:235], a[228:231], v[104:107], a[232:235]
v_exp_f32 v72, v72
v_mfma_f32_16x16x32_bf16 v[84:87], a[200:203], v[124:127], v[84:87]
ds_read_b128 a[180:183], v191 offset:32768
v_exp_f32 v73, v73
v_mfma_f32_16x16x32_bf16 v[92:95], a[200:203], v[140:143], v[92:95]
v_cvt_pk_bf16_f32 v100, v72, v73
s_waitcnt lgkmcnt(6)
v_mfma_f32_16x16x32_bf16 v[0:3], a[204:207], v[104:107], v[0:3]
ds_read_b128 a[184:187], v188 offset:32768
v_exp_f32 v74, v74
v_mfma_f32_16x16x32_bf16 v[4:7], a[204:207], v[108:111], v[4:7]
buffer_load_dwordx4 v223, s[12:15], s42 offen offset:1024 nt lds
v_mfma_f32_16x16x32_bf16 a[16:19], a[204:207], a[28:31], a[16:19]
v_exp_f32 v75, v75
v_mfma_f32_16x16x32_bf16 a[236:239], a[228:231], v[108:111], a[236:239]
v_exp_f32 v76, v76
v_mfma_f32_16x16x32_bf16 v[8:11], a[208:211], v[104:107], v[8:11]
ds_read_b128 a[188:191], v192 offset:32768
v_cvt_pk_bf16_f32 v101, v74, v75
v_mfma_f32_16x16x32_bf16 v[12:15], a[208:211], v[108:111], v[12:15]
v_exp_f32 v77, v77
v_mfma_f32_16x16x32_bf16 a[20:23], a[208:211], a[28:31], a[20:23]
v_cvt_pk_bf16_f32 v102, v76, v77
v_exp_f32 v78, v78
v_exp_f32 v79, v79
s_nop 0
v_cvt_pk_bf16_f32 v103, v78, v79
s_waitcnt lgkmcnt(3)
v_mfma_f32_16x16x32_bf16 v[64:67], a[212:215], v[112:115], v[156:159]
ds_read_b64_tr_b16 a[192:193], v197 offset:16384
v_exp_f32 v80, v80
v_mfma_f32_16x16x32_bf16 v[72:75], a[212:215], v[128:131], v[160:163]
ds_read_b64_tr_b16 a[194:195], v197 offset:20480
v_exp_f32 v81, v81
v_mfma_f32_16x16x32_bf16 v[64:67], a[216:219], v[116:119], v[64:67]
ds_read_b128 a[196:199], v193 offset:32768
v_cvt_pk_bf16_f32 v104, v80, v81
v_mfma_f32_16x16x32_bf16 v[72:75], a[216:219], v[132:135], v[72:75]
ds_read_b128 a[24:27], v203 offset:2048
buffer_load_dwordx4 v224, s[12:15], s42 offen offset:2048 nt lds
v_mfma_f32_16x16x32_bf16 v[144:147], a[220:223], a[0:3], v[164:167]
ds_read_b128 a[200:203], v189 offset:32768
v_exp_f32 v82, v82
v_mfma_f32_16x16x32_bf16 v[16:19], a[224:227], v[96:99], v[16:19]
ds_read_b64_tr_b16 a[204:205], v198 offset:16384
v_exp_f32 v83, v83
v_mfma_f32_16x16x32_bf16 v[20:23], a[224:227], v[100:103], v[20:23]
ds_read_b64_tr_b16 a[206:207], v198 offset:20480
s_waitcnt lgkmcnt(5)
v_mfma_f32_16x16x32_bf16 v[144:147], a[180:183], a[4:7], v[144:147]
ds_read_b128 a[208:211], v186 offset:36864
v_cvt_pk_bf16_f32 v105, v82, v83
v_mfma_f32_16x16x32_bf16 v[64:67], a[184:187], v[120:123], v[64:67]
ds_read_b64_tr_b16 a[212:213], v199 offset:16384
v_exp_f32 v84, v84
v_mfma_f32_16x16x32_bf16 v[72:75], a[184:187], v[136:139], v[72:75]
ds_read_b64_tr_b16 a[214:215], v199 offset:20480
v_exp_f32 v85, v85
v_mfma_f32_16x16x32_bf16 v[144:147], a[188:191], a[8:11], v[144:147]
ds_read_b128 a[216:219], v187 offset:36864
v_cvt_pk_bf16_f32 v106, v84, v85
v_mfma_f32_16x16x32_bf16 v[24:27], a[192:195], v[96:99], v[24:27]
ds_read_b64_tr_b16 a[220:221], v200 offset:16384
v_exp_f32 v86, v86
v_mfma_f32_16x16x32_bf16 v[28:31], a[192:195], v[100:103], v[28:31]
ds_read_b64_tr_b16 a[222:223], v200 offset:20480
s_waitcnt lgkmcnt(5)
v_mfma_f32_16x16x32_bf16 v[144:147], a[196:199], a[12:15], v[144:147]
ds_read_b128 a[224:227], v188 offset:36864
buffer_load_dwordx4 v225, s[12:15], s42 offen offset:3072 nt lds
v_mfma_f32_16x16x32_bf16 v[64:67], a[200:203], v[124:127], v[64:67]
ds_read_b64_tr_b16 a[180:181], v201 offset:16384
v_exp_f32 v87, v87
v_mfma_f32_16x16x32_bf16 v[72:75], a[200:203], v[140:143], v[72:75]
ds_read_b64_tr_b16 a[182:183], v201 offset:20480
v_cvt_pk_bf16_f32 v107, v86, v87
v_mfma_f32_16x16x32_bf16 v[32:35], a[204:207], v[96:99], v[32:35]
ds_read_b128 a[28:31], v203 offset:3072
v_exp_f32 v88, v88
v_mfma_f32_16x16x32_bf16 v[36:39], a[204:207], v[100:103], v[36:39]
ds_read_b128 a[184:187], v189 offset:36864
v_exp_f32 v89, v89
v_mfma_f32_16x16x32_bf16 v[68:71], a[208:211], v[112:115], v[156:159]
ds_read_b64_tr_b16 a[188:189], v194 offset:16384
v_cvt_pk_bf16_f32 v108, v88, v89
v_mfma_f32_16x16x32_bf16 v[76:79], a[208:211], v[128:131], v[160:163]
ds_read_b64_tr_b16 a[190:191], v194 offset:20480
s_waitcnt lgkmcnt(7)
v_mfma_f32_16x16x32_bf16 v[40:43], a[212:215], v[96:99], v[40:43]
ds_read_b64_tr_b16 a[192:193], v195 offset:16384
v_exp_f32 v90, v90
v_mfma_f32_16x16x32_bf16 v[44:47], a[212:215], v[100:103], v[44:47]
ds_read_b64_tr_b16 a[194:195], v195 offset:20480
v_exp_f32 v91, v91
v_mfma_f32_16x16x32_bf16 v[68:71], a[216:219], v[116:119], v[68:71]
ds_read_b128 a[196:199], v186 offset:40960
s_add_u32 m0, s39, 114688
v_mfma_f32_16x16x32_bf16 v[76:79], a[216:219], v[132:135], v[76:79]
s_add_u32 s43, s43, 16384
buffer_load_dwordx4 v226, s[16:19], s43 offen nt lds
v_mfma_f32_16x16x32_bf16 v[48:51], a[220:223], v[96:99], v[48:51]
ds_read_b128 a[200:203], v187 offset:40960
v_cvt_pk_bf16_f32 v109, v90, v91
v_mfma_f32_16x16x32_bf16 v[52:55], a[220:223], v[100:103], v[52:55]
v_exp_f32 v92, v92
s_waitcnt lgkmcnt(6)
v_mfma_f32_16x16x32_bf16 v[68:71], a[224:227], v[120:123], v[68:71]
ds_read_b64_tr_b16 a[204:205], v196 offset:24576
v_exp_f32 v93, v93
v_mfma_f32_16x16x32_bf16 v[76:79], a[224:227], v[136:139], v[76:79]
ds_read_b64_tr_b16 a[206:207], v196 offset:28672
v_cvt_pk_bf16_f32 v110, v92, v93
v_mfma_f32_16x16x32_bf16 v[56:59], a[180:183], v[96:99], v[56:59]
ds_read_b128 a[208:211], v188 offset:40960
v_exp_f32 v94, v94
v_mfma_f32_16x16x32_bf16 v[60:63], a[180:183], v[100:103], v[60:63]
v_exp_f32 v95, v95
v_mfma_f32_16x16x32_bf16 a[232:235], a[228:231], v[96:99], a[232:235]
v_cvt_pk_bf16_f32 v111, v94, v95
v_exp_f32 v144, v144
v_mfma_f32_16x16x32_bf16 v[68:71], a[184:187], v[124:127], v[68:71]
ds_read_b64_tr_b16 a[212:213], v197 offset:24576
buffer_load_dwordx4 v227, s[16:19], s43 offen offset:1024 nt lds
v_mfma_f32_16x16x32_bf16 v[76:79], a[184:187], v[140:143], v[76:79]
ds_read_b64_tr_b16 a[214:215], v197 offset:28672
s_waitcnt lgkmcnt(7)
v_mfma_f32_16x16x32_bf16 v[0:3], a[188:191], v[96:99], v[0:3]
ds_read_b128 a[216:219], v189 offset:40960
v_add_f32 v177, v177, v144
v_mfma_f32_16x16x32_bf16 v[4:7], a[188:191], v[100:103], v[4:7]
v_exp_f32 v145, v145
v_mfma_f32_16x16x32_bf16 a[16:19], a[188:191], a[24:27], a[16:19]
v_exp_f32 v146, v146
v_mfma_f32_16x16x32_bf16 a[236:239], a[228:231], v[100:103], a[236:239]
v_cvt_pk_bf16_f32 v152, v144, v145
v_add_f32 v177, v177, v145
v_mfma_f32_16x16x32_bf16 v[8:11], a[192:195], v[96:99], v[8:11]
ds_read_b64_tr_b16 a[220:221], v198 offset:24576
v_add_f32 v177, v177, v146
v_mfma_f32_16x16x32_bf16 v[12:15], a[192:195], v[100:103], v[12:15]
ds_read_b64_tr_b16 a[222:223], v198 offset:28672
v_exp_f32 v147, v147
v_mfma_f32_16x16x32_bf16 a[20:23], a[192:195], a[24:27], a[20:23]
v_cvt_pk_bf16_f32 v153, v146, v147
s_waitcnt lgkmcnt(6)
v_mfma_f32_16x16x32_bf16 v[80:83], a[196:199], v[112:115], v[156:159]
ds_read_b128 a[224:227], v186 offset:45056
ds_write_b64 v202, v[152:153] offset:0
v_mfma_f32_16x16x32_bf16 v[88:91], a[196:199], v[128:131], v[160:163]
buffer_load_dwordx4 v226, s[16:19], s43 offen offset:2048 nt lds
v_mfma_f32_16x16x32_bf16 v[80:83], a[200:203], v[116:119], v[80:83]
ds_read_b64_tr_b16 a[180:181], v199 offset:24576
v_add_f32 v177, v177, v147
v_mfma_f32_16x16x32_bf16 v[88:91], a[200:203], v[132:135], v[88:91]
ds_read_b64_tr_b16 a[182:183], v199 offset:28672
v_exp_f32 v64, v64
v_mfma_f32_16x16x32_bf16 v[16:19], a[204:207], v[104:107], v[16:19]
ds_read_b128 a[184:187], v187 offset:45056
v_exp_f32 v65, v65
v_mfma_f32_16x16x32_bf16 v[20:23], a[204:207], v[108:111], v[20:23]
v_cvt_pk_bf16_f32 v96, v64, v65
s_waitcnt lgkmcnt(6)
v_mfma_f32_16x16x32_bf16 v[80:83], a[208:211], v[120:123], v[80:83]
ds_read_b64_tr_b16 a[188:189], v200 offset:24576
v_exp_f32 v66, v66
v_mfma_f32_16x16x32_bf16 v[88:91], a[208:211], v[136:139], v[88:91]
ds_read_b64_tr_b16 a[190:191], v200 offset:28672
v_exp_f32 v67, v67
v_mfma_f32_16x16x32_bf16 v[24:27], a[212:215], v[104:107], v[24:27]
ds_read_b128 a[192:195], v188 offset:45056
v_cvt_pk_bf16_f32 v97, v66, v67
v_mfma_f32_16x16x32_bf16 v[28:31], a[212:215], v[108:111], v[28:31]
v_exp_f32 v68, v68
v_mfma_f32_16x16x32_bf16 v[80:83], a[216:219], v[124:127], v[80:83]
ds_read_b64_tr_b16 a[196:197], v201 offset:24576
buffer_load_dwordx4 v227, s[16:19], s43 offen offset:3072 nt lds
v_mfma_f32_16x16x32_bf16 v[88:91], a[216:219], v[140:143], v[88:91]
ds_read_b64_tr_b16 a[198:199], v201 offset:28672
s_waitcnt lgkmcnt(6)
v_mfma_f32_16x16x32_bf16 v[32:35], a[220:223], v[104:107], v[32:35]
ds_read_b128 a[200:203], v189 offset:45056
v_exp_f32 v69, v69
v_mfma_f32_16x16x32_bf16 v[36:39], a[220:223], v[108:111], v[36:39]
v_exp_f32 v70, v70
v_mfma_f32_16x16x32_bf16 v[84:87], a[224:227], v[112:115], v[156:159]
ds_read_b64_tr_b16 a[204:205], v194 offset:24576
v_cvt_pk_bf16_f32 v98, v68, v69
v_mfma_f32_16x16x32_bf16 v[92:95], a[224:227], v[128:131], v[160:163]
ds_read_b64_tr_b16 a[206:207], v194 offset:28672
v_exp_f32 v71, v71
v_mfma_f32_16x16x32_bf16 v[40:43], a[180:183], v[104:107], v[40:43]
ds_read_b64_tr_b16 a[208:209], v195 offset:24576
v_cvt_pk_bf16_f32 v99, v70, v71
v_mfma_f32_16x16x32_bf16 v[44:47], a[180:183], v[108:111], v[44:47]
ds_read_b64_tr_b16 a[210:211], v195 offset:28672
s_waitcnt lgkmcnt(8)
v_mfma_f32_16x16x32_bf16 v[84:87], a[184:187], v[116:119], v[84:87]
v_exp_f32 v72, v72
v_mfma_f32_16x16x32_bf16 v[92:95], a[184:187], v[132:135], v[92:95]
v_exp_f32 v73, v73
v_mfma_f32_16x16x32_bf16 v[48:51], a[188:191], v[104:107], v[48:51]
s_waitcnt vmcnt(8)
s_barrier
v_mfma_f32_16x16x32_bf16 v[52:55], a[188:191], v[108:111], v[52:55]
ds_read_b128 a[212:215], v186 offset:49152
s_waitcnt lgkmcnt(5)
v_mfma_f32_16x16x32_bf16 v[84:87], a[192:195], v[120:123], v[84:87]
ds_read_b128 a[216:219], v187 offset:49152
s_add_u32 m0, s39, 16384
v_mfma_f32_16x16x32_bf16 v[92:95], a[192:195], v[136:139], v[92:95]
ds_read_b128 a[220:223], v190 offset:49152
s_add_u32 s42, s42, 16384
v_mfma_f32_16x16x32_bf16 v[56:59], a[196:199], v[104:107], v[56:59]
ds_read_b64_tr_b16 a[224:225], v196 offset:32768
buffer_load_dwordx4 v222, s[12:15], s42 offen nt lds
v_mfma_f32_16x16x32_bf16 v[60:63], a[196:199], v[108:111], v[60:63]
ds_read_b64_tr_b16 a[226:227], v196 offset:36864
v_cvt_pk_bf16_f32 v100, v72, v73
v_mfma_f32_16x16x32_bf16 a[232:235], a[228:231], v[104:107], a[232:235]
v_exp_f32 v74, v74
v_mfma_f32_16x16x32_bf16 v[84:87], a[200:203], v[124:127], v[84:87]
ds_read_b128 a[180:183], v191 offset:49152
v_exp_f32 v75, v75
v_mfma_f32_16x16x32_bf16 v[92:95], a[200:203], v[140:143], v[92:95]
v_cvt_pk_bf16_f32 v101, v74, v75
s_waitcnt lgkmcnt(6)
v_mfma_f32_16x16x32_bf16 v[0:3], a[204:207], v[104:107], v[0:3]
ds_read_b128 a[184:187], v188 offset:49152
v_exp_f32 v76, v76
v_mfma_f32_16x16x32_bf16 v[4:7], a[204:207], v[108:111], v[4:7]
buffer_load_dwordx4 v223, s[12:15], s42 offen offset:1024 nt lds
v_mfma_f32_16x16x32_bf16 a[16:19], a[204:207], a[28:31], a[16:19]
v_exp_f32 v77, v77
v_mfma_f32_16x16x32_bf16 a[236:239], a[228:231], v[108:111], a[236:239]
v_exp_f32 v78, v78
v_mfma_f32_16x16x32_bf16 v[8:11], a[208:211], v[104:107], v[8:11]
ds_read_b128 a[188:191], v192 offset:49152
v_cvt_pk_bf16_f32 v102, v76, v77
v_mfma_f32_16x16x32_bf16 v[12:15], a[208:211], v[108:111], v[12:15]
v_exp_f32 v79, v79
v_mfma_f32_16x16x32_bf16 a[20:23], a[208:211], a[28:31], a[20:23]
v_cvt_pk_bf16_f32 v103, v78, v79
s_waitcnt lgkmcnt(3)
v_mfma_f32_16x16x32_bf16 v[64:67], a[212:215], v[112:115], v[156:159]
ds_read_b64_tr_b16 a[192:193], v197 offset:32768
v_exp_f32 v80, v80
v_mfma_f32_16x16x32_bf16 v[72:75], a[212:215], v[128:131], v[160:163]
ds_read_b64_tr_b16 a[194:195], v197 offset:36864
v_exp_f32 v81, v81
v_mfma_f32_16x16x32_bf16 v[64:67], a[216:219], v[116:119], v[64:67]
ds_read_b128 a[196:199], v193 offset:49152
v_cvt_pk_bf16_f32 v104, v80, v81
v_mfma_f32_16x16x32_bf16 v[72:75], a[216:219], v[132:135], v[72:75]
ds_read_b128 a[24:27], v203 offset:0
buffer_load_dwordx4 v224, s[12:15], s42 offen offset:2048 nt lds
v_mfma_f32_16x16x32_bf16 v[144:147], a[220:223], a[0:3], v[164:167]
ds_read_b128 a[200:203], v189 offset:49152
v_exp_f32 v82, v82
v_mfma_f32_16x16x32_bf16 v[16:19], a[224:227], v[96:99], v[16:19]
ds_read_b64_tr_b16 a[204:205], v198 offset:32768
v_exp_f32 v83, v83
v_mfma_f32_16x16x32_bf16 v[20:23], a[224:227], v[100:103], v[20:23]
ds_read_b64_tr_b16 a[206:207], v198 offset:36864
s_waitcnt lgkmcnt(5)
v_mfma_f32_16x16x32_bf16 v[144:147], a[180:183], a[4:7], v[144:147]
ds_read_b128 a[208:211], v186 offset:53248
v_cvt_pk_bf16_f32 v105, v82, v83
v_mfma_f32_16x16x32_bf16 v[64:67], a[184:187], v[120:123], v[64:67]
ds_read_b64_tr_b16 a[212:213], v199 offset:32768
v_exp_f32 v84, v84
v_mfma_f32_16x16x32_bf16 v[72:75], a[184:187], v[136:139], v[72:75]
ds_read_b64_tr_b16 a[214:215], v199 offset:36864
v_exp_f32 v85, v85
v_mfma_f32_16x16x32_bf16 v[144:147], a[188:191], a[8:11], v[144:147]
ds_read_b128 a[216:219], v187 offset:53248
v_cvt_pk_bf16_f32 v106, v84, v85
v_mfma_f32_16x16x32_bf16 v[24:27], a[192:195], v[96:99], v[24:27]
ds_read_b64_tr_b16 a[220:221], v200 offset:32768
v_exp_f32 v86, v86
v_mfma_f32_16x16x32_bf16 v[28:31], a[192:195], v[100:103], v[28:31]
ds_read_b64_tr_b16 a[222:223], v200 offset:36864
s_waitcnt lgkmcnt(5)
v_mfma_f32_16x16x32_bf16 v[144:147], a[196:199], a[12:15], v[144:147]
ds_read_b128 a[224:227], v188 offset:53248
buffer_load_dwordx4 v225, s[12:15], s42 offen offset:3072 nt lds
v_mfma_f32_16x16x32_bf16 v[64:67], a[200:203], v[124:127], v[64:67]
ds_read_b64_tr_b16 a[180:181], v201 offset:32768
v_exp_f32 v87, v87
v_mfma_f32_16x16x32_bf16 v[72:75], a[200:203], v[140:143], v[72:75]
ds_read_b64_tr_b16 a[182:183], v201 offset:36864
v_cvt_pk_bf16_f32 v107, v86, v87
v_mfma_f32_16x16x32_bf16 v[32:35], a[204:207], v[96:99], v[32:35]
ds_read_b128 a[28:31], v203 offset:1024
v_exp_f32 v88, v88
v_mfma_f32_16x16x32_bf16 v[36:39], a[204:207], v[100:103], v[36:39]
ds_read_b128 a[184:187], v189 offset:53248
v_exp_f32 v89, v89
v_mfma_f32_16x16x32_bf16 v[68:71], a[208:211], v[112:115], v[156:159]
ds_read_b64_tr_b16 a[188:189], v194 offset:32768
v_cvt_pk_bf16_f32 v108, v88, v89
v_mfma_f32_16x16x32_bf16 v[76:79], a[208:211], v[128:131], v[160:163]
ds_read_b64_tr_b16 a[190:191], v194 offset:36864
s_waitcnt lgkmcnt(7)
v_mfma_f32_16x16x32_bf16 v[40:43], a[212:215], v[96:99], v[40:43]
ds_read_b64_tr_b16 a[192:193], v195 offset:32768
v_exp_f32 v90, v90
v_mfma_f32_16x16x32_bf16 v[44:47], a[212:215], v[100:103], v[44:47]
ds_read_b64_tr_b16 a[194:195], v195 offset:36864
v_exp_f32 v91, v91
v_mfma_f32_16x16x32_bf16 v[68:71], a[216:219], v[116:119], v[68:71]
ds_read_b128 a[196:199], v186 offset:57344
s_add_u32 m0, s39, 65536
v_mfma_f32_16x16x32_bf16 v[76:79], a[216:219], v[132:135], v[76:79]
s_add_u32 s43, s43, 16384
buffer_load_dwordx4 v226, s[16:19], s43 offen nt lds
v_mfma_f32_16x16x32_bf16 v[48:51], a[220:223], v[96:99], v[48:51]
ds_read_b128 a[200:203], v187 offset:57344
v_cvt_pk_bf16_f32 v109, v90, v91
v_mfma_f32_16x16x32_bf16 v[52:55], a[220:223], v[100:103], v[52:55]
v_exp_f32 v92, v92
s_waitcnt lgkmcnt(6)
v_mfma_f32_16x16x32_bf16 v[68:71], a[224:227], v[120:123], v[68:71]
ds_read_b64_tr_b16 a[204:205], v196 offset:40960
v_exp_f32 v93, v93
v_mfma_f32_16x16x32_bf16 v[76:79], a[224:227], v[136:139], v[76:79]
ds_read_b64_tr_b16 a[206:207], v196 offset:45056
v_cvt_pk_bf16_f32 v110, v92, v93
v_mfma_f32_16x16x32_bf16 v[56:59], a[180:183], v[96:99], v[56:59]
ds_read_b128 a[208:211], v188 offset:57344
v_exp_f32 v94, v94
v_mfma_f32_16x16x32_bf16 v[60:63], a[180:183], v[100:103], v[60:63]
v_exp_f32 v95, v95
v_mfma_f32_16x16x32_bf16 a[232:235], a[228:231], v[96:99], a[232:235]
v_cvt_pk_bf16_f32 v111, v94, v95
v_exp_f32 v144, v144
v_mfma_f32_16x16x32_bf16 v[68:71], a[184:187], v[124:127], v[68:71]
ds_read_b64_tr_b16 a[212:213], v197 offset:40960
buffer_load_dwordx4 v227, s[16:19], s43 offen offset:1024 nt lds
v_mfma_f32_16x16x32_bf16 v[76:79], a[184:187], v[140:143], v[76:79]
ds_read_b64_tr_b16 a[214:215], v197 offset:45056
s_waitcnt lgkmcnt(7)
v_mfma_f32_16x16x32_bf16 v[0:3], a[188:191], v[96:99], v[0:3]
ds_read_b128 a[216:219], v189 offset:57344
v_add_f32 v177, v177, v144
v_mfma_f32_16x16x32_bf16 v[4:7], a[188:191], v[100:103], v[4:7]
v_exp_f32 v145, v145
v_mfma_f32_16x16x32_bf16 a[16:19], a[188:191], a[24:27], a[16:19]
v_exp_f32 v146, v146
v_mfma_f32_16x16x32_bf16 a[236:239], a[228:231], v[100:103], a[236:239]
v_cvt_pk_bf16_f32 v152, v144, v145
v_add_f32 v177, v177, v145
v_mfma_f32_16x16x32_bf16 v[8:11], a[192:195], v[96:99], v[8:11]
ds_read_b64_tr_b16 a[220:221], v198 offset:40960
v_add_f32 v177, v177, v146
v_mfma_f32_16x16x32_bf16 v[12:15], a[192:195], v[100:103], v[12:15]
ds_read_b64_tr_b16 a[222:223], v198 offset:45056
v_exp_f32 v147, v147
v_mfma_f32_16x16x32_bf16 a[20:23], a[192:195], a[24:27], a[20:23]
v_cvt_pk_bf16_f32 v153, v146, v147
s_waitcnt lgkmcnt(6)
v_mfma_f32_16x16x32_bf16 v[80:83], a[196:199], v[112:115], v[156:159]
ds_read_b128 a[224:227], v186 offset:61440
ds_write_b64 v202, v[152:153] offset:2048
v_mfma_f32_16x16x32_bf16 v[88:91], a[196:199], v[128:131], v[160:163]
buffer_load_dwordx4 v226, s[16:19], s43 offen offset:2048 nt lds
v_mfma_f32_16x16x32_bf16 v[80:83], a[200:203], v[116:119], v[80:83]
ds_read_b64_tr_b16 a[180:181], v199 offset:40960
v_add_f32 v177, v177, v147
v_mfma_f32_16x16x32_bf16 v[88:91], a[200:203], v[132:135], v[88:91]
ds_read_b64_tr_b16 a[182:183], v199 offset:45056
v_exp_f32 v64, v64
v_mfma_f32_16x16x32_bf16 v[16:19], a[204:207], v[104:107], v[16:19]
ds_read_b128 a[184:187], v187 offset:61440
v_exp_f32 v65, v65
v_mfma_f32_16x16x32_bf16 v[20:23], a[204:207], v[108:111], v[20:23]
v_cvt_pk_bf16_f32 v96, v64, v65
s_waitcnt lgkmcnt(6)
v_mfma_f32_16x16x32_bf16 v[80:83], a[208:211], v[120:123], v[80:83]
ds_read_b64_tr_b16 a[188:189], v200 offset:40960
v_exp_f32 v66, v66
v_mfma_f32_16x16x32_bf16 v[88:91], a[208:211], v[136:139], v[88:91]
ds_read_b64_tr_b16 a[190:191], v200 offset:45056
v_exp_f32 v67, v67
v_mfma_f32_16x16x32_bf16 v[24:27], a[212:215], v[104:107], v[24:27]
ds_read_b128 a[192:195], v188 offset:61440
v_cvt_pk_bf16_f32 v97, v66, v67
v_mfma_f32_16x16x32_bf16 v[28:31], a[212:215], v[108:111], v[28:31]
v_exp_f32 v68, v68
v_mfma_f32_16x16x32_bf16 v[80:83], a[216:219], v[124:127], v[80:83]
ds_read_b64_tr_b16 a[196:197], v201 offset:40960
buffer_load_dwordx4 v227, s[16:19], s43 offen offset:3072 nt lds
v_mfma_f32_16x16x32_bf16 v[88:91], a[216:219], v[140:143], v[88:91]
ds_read_b64_tr_b16 a[198:199], v201 offset:45056
s_waitcnt lgkmcnt(6)
v_mfma_f32_16x16x32_bf16 v[32:35], a[220:223], v[104:107], v[32:35]
ds_read_b128 a[200:203], v189 offset:61440
v_exp_f32 v69, v69
v_mfma_f32_16x16x32_bf16 v[36:39], a[220:223], v[108:111], v[36:39]
v_exp_f32 v70, v70
v_mfma_f32_16x16x32_bf16 v[84:87], a[224:227], v[112:115], v[156:159]
ds_read_b64_tr_b16 a[204:205], v194 offset:40960
v_cvt_pk_bf16_f32 v98, v68, v69
v_mfma_f32_16x16x32_bf16 v[92:95], a[224:227], v[128:131], v[160:163]
ds_read_b64_tr_b16 a[206:207], v194 offset:45056
v_exp_f32 v71, v71
v_mfma_f32_16x16x32_bf16 v[40:43], a[180:183], v[104:107], v[40:43]
ds_read_b64_tr_b16 a[208:209], v195 offset:40960
v_cvt_pk_bf16_f32 v99, v70, v71
v_mfma_f32_16x16x32_bf16 v[44:47], a[180:183], v[108:111], v[44:47]
ds_read_b64_tr_b16 a[210:211], v195 offset:45056
s_waitcnt lgkmcnt(8)
v_mfma_f32_16x16x32_bf16 v[84:87], a[184:187], v[116:119], v[84:87]
v_exp_f32 v72, v72
v_mfma_f32_16x16x32_bf16 v[92:95], a[184:187], v[132:135], v[92:95]
v_exp_f32 v73, v73
v_mfma_f32_16x16x32_bf16 v[48:51], a[188:191], v[104:107], v[48:51]
s_waitcnt vmcnt(8)
s_barrier
v_mfma_f32_16x16x32_bf16 v[52:55], a[188:191], v[108:111], v[52:55]
ds_read_b128 a[212:215], v186 offset:0
s_waitcnt lgkmcnt(5)
v_mfma_f32_16x16x32_bf16 v[84:87], a[192:195], v[120:123], v[84:87]
ds_read_b128 a[216:219], v187 offset:0
s_add_u32 m0, s39, 32768
v_mfma_f32_16x16x32_bf16 v[92:95], a[192:195], v[136:139], v[92:95]
ds_read_b128 a[220:223], v190 offset:0
s_add_u32 s42, s42, 16384
v_mfma_f32_16x16x32_bf16 v[56:59], a[196:199], v[104:107], v[56:59]
ds_read_b64_tr_b16 a[224:225], v196 offset:49152
buffer_load_dwordx4 v222, s[12:15], s42 offen nt lds
v_mfma_f32_16x16x32_bf16 v[60:63], a[196:199], v[108:111], v[60:63]
ds_read_b64_tr_b16 a[226:227], v196 offset:53248
v_cvt_pk_bf16_f32 v100, v72, v73
v_mfma_f32_16x16x32_bf16 a[232:235], a[228:231], v[104:107], a[232:235]
v_exp_f32 v74, v74
v_mfma_f32_16x16x32_bf16 v[84:87], a[200:203], v[124:127], v[84:87]
ds_read_b128 a[180:183], v191 offset:0
v_exp_f32 v75, v75
v_mfma_f32_16x16x32_bf16 v[92:95], a[200:203], v[140:143], v[92:95]
v_cvt_pk_bf16_f32 v101, v74, v75
s_waitcnt lgkmcnt(6)
v_mfma_f32_16x16x32_bf16 v[0:3], a[204:207], v[104:107], v[0:3]
ds_read_b128 a[184:187], v188 offset:0
v_exp_f32 v76, v76
v_mfma_f32_16x16x32_bf16 v[4:7], a[204:207], v[108:111], v[4:7]
buffer_load_dwordx4 v223, s[12:15], s42 offen offset:1024 nt lds
v_mfma_f32_16x16x32_bf16 a[16:19], a[204:207], a[28:31], a[16:19]
v_exp_f32 v77, v77
v_mfma_f32_16x16x32_bf16 a[236:239], a[228:231], v[108:111], a[236:239]
v_exp_f32 v78, v78
v_mfma_f32_16x16x32_bf16 v[8:11], a[208:211], v[104:107], v[8:11]
ds_read_b128 a[188:191], v192 offset:0
v_cvt_pk_bf16_f32 v102, v76, v77
v_mfma_f32_16x16x32_bf16 v[12:15], a[208:211], v[108:111], v[12:15]
v_exp_f32 v79, v79
v_mfma_f32_16x16x32_bf16 a[20:23], a[208:211], a[28:31], a[20:23]
v_cvt_pk_bf16_f32 v103, v78, v79
s_waitcnt lgkmcnt(3)
v_mfma_f32_16x16x32_bf16 v[64:67], a[212:215], v[112:115], v[156:159]
ds_read_b64_tr_b16 a[192:193], v197 offset:49152
v_exp_f32 v80, v80
v_mfma_f32_16x16x32_bf16 v[72:75], a[212:215], v[128:131], v[160:163]
ds_read_b64_tr_b16 a[194:195], v197 offset:53248
v_exp_f32 v81, v81
v_mfma_f32_16x16x32_bf16 v[64:67], a[216:219], v[116:119], v[64:67]
ds_read_b128 a[196:199], v193 offset:0
v_cvt_pk_bf16_f32 v104, v80, v81
v_mfma_f32_16x16x32_bf16 v[72:75], a[216:219], v[132:135], v[72:75]
ds_read_b128 a[24:27], v203 offset:2048
buffer_load_dwordx4 v224, s[12:15], s42 offen offset:2048 nt lds
v_mfma_f32_16x16x32_bf16 v[144:147], a[220:223], a[0:3], v[164:167]
ds_read_b128 a[200:203], v189 offset:0
v_exp_f32 v82, v82
v_mfma_f32_16x16x32_bf16 v[16:19], a[224:227], v[96:99], v[16:19]
ds_read_b64_tr_b16 a[204:205], v198 offset:49152
v_exp_f32 v83, v83
v_mfma_f32_16x16x32_bf16 v[20:23], a[224:227], v[100:103], v[20:23]
ds_read_b64_tr_b16 a[206:207], v198 offset:53248
s_waitcnt lgkmcnt(5)
v_mfma_f32_16x16x32_bf16 v[144:147], a[180:183], a[4:7], v[144:147]
ds_read_b128 a[208:211], v186 offset:4096
v_cvt_pk_bf16_f32 v105, v82, v83
v_mfma_f32_16x16x32_bf16 v[64:67], a[184:187], v[120:123], v[64:67]
ds_read_b64_tr_b16 a[212:213], v199 offset:49152
v_exp_f32 v84, v84
v_mfma_f32_16x16x32_bf16 v[72:75], a[184:187], v[136:139], v[72:75]
ds_read_b64_tr_b16 a[214:215], v199 offset:53248
v_exp_f32 v85, v85
v_mfma_f32_16x16x32_bf16 v[144:147], a[188:191], a[8:11], v[144:147]
ds_read_b128 a[216:219], v187 offset:4096
v_cvt_pk_bf16_f32 v106, v84, v85
v_mfma_f32_16x16x32_bf16 v[24:27], a[192:195], v[96:99], v[24:27]
ds_read_b64_tr_b16 a[220:221], v200 offset:49152
v_exp_f32 v86, v86
v_mfma_f32_16x16x32_bf16 v[28:31], a[192:195], v[100:103], v[28:31]
ds_read_b64_tr_b16 a[222:223], v200 offset:53248
s_waitcnt lgkmcnt(5)
v_mfma_f32_16x16x32_bf16 v[144:147], a[196:199], a[12:15], v[144:147]
ds_read_b128 a[224:227], v188 offset:4096
buffer_load_dwordx4 v225, s[12:15], s42 offen offset:3072 nt lds
v_mfma_f32_16x16x32_bf16 v[64:67], a[200:203], v[124:127], v[64:67]
ds_read_b64_tr_b16 a[180:181], v201 offset:49152
v_exp_f32 v87, v87
v_mfma_f32_16x16x32_bf16 v[72:75], a[200:203], v[140:143], v[72:75]
ds_read_b64_tr_b16 a[182:183], v201 offset:53248
v_cvt_pk_bf16_f32 v107, v86, v87
v_mfma_f32_16x16x32_bf16 v[32:35], a[204:207], v[96:99], v[32:35]
ds_read_b128 a[28:31], v203 offset:3072
v_exp_f32 v88, v88
v_mfma_f32_16x16x32_bf16 v[36:39], a[204:207], v[100:103], v[36:39]
ds_read_b128 a[184:187], v189 offset:4096
v_exp_f32 v89, v89
v_mfma_f32_16x16x32_bf16 v[68:71], a[208:211], v[112:115], v[156:159]
ds_read_b64_tr_b16 a[188:189], v194 offset:49152
v_cvt_pk_bf16_f32 v108, v88, v89
v_mfma_f32_16x16x32_bf16 v[76:79], a[208:211], v[128:131], v[160:163]
ds_read_b64_tr_b16 a[190:191], v194 offset:53248
s_waitcnt lgkmcnt(7)
v_mfma_f32_16x16x32_bf16 v[40:43], a[212:215], v[96:99], v[40:43]
ds_read_b64_tr_b16 a[192:193], v195 offset:49152
v_exp_f32 v90, v90
v_mfma_f32_16x16x32_bf16 v[44:47], a[212:215], v[100:103], v[44:47]
ds_read_b64_tr_b16 a[194:195], v195 offset:53248
v_exp_f32 v91, v91
v_mfma_f32_16x16x32_bf16 v[68:71], a[216:219], v[116:119], v[68:71]
ds_read_b128 a[196:199], v186 offset:8192
s_add_u32 m0, s39, 81920
v_mfma_f32_16x16x32_bf16 v[76:79], a[216:219], v[132:135], v[76:79]
s_add_u32 s43, s43, 16384
buffer_load_dwordx4 v226, s[16:19], s43 offen nt lds
v_mfma_f32_16x16x32_bf16 v[48:51], a[220:223], v[96:99], v[48:51]
ds_read_b128 a[200:203], v187 offset:8192
v_cvt_pk_bf16_f32 v109, v90, v91
v_mfma_f32_16x16x32_bf16 v[52:55], a[220:223], v[100:103], v[52:55]
v_exp_f32 v92, v92
s_waitcnt lgkmcnt(6)
v_mfma_f32_16x16x32_bf16 v[68:71], a[224:227], v[120:123], v[68:71]
ds_read_b64_tr_b16 a[204:205], v196 offset:57344
v_exp_f32 v93, v93
v_mfma_f32_16x16x32_bf16 v[76:79], a[224:227], v[136:139], v[76:79]
ds_read_b64_tr_b16 a[206:207], v196 offset:61440
v_cvt_pk_bf16_f32 v110, v92, v93
v_mfma_f32_16x16x32_bf16 v[56:59], a[180:183], v[96:99], v[56:59]
ds_read_b128 a[208:211], v188 offset:8192
v_exp_f32 v94, v94
v_mfma_f32_16x16x32_bf16 v[60:63], a[180:183], v[100:103], v[60:63]
v_exp_f32 v95, v95
v_mfma_f32_16x16x32_bf16 a[232:235], a[228:231], v[96:99], a[232:235]
v_cvt_pk_bf16_f32 v111, v94, v95
v_exp_f32 v144, v144
v_mfma_f32_16x16x32_bf16 v[68:71], a[184:187], v[124:127], v[68:71]
ds_read_b64_tr_b16 a[212:213], v197 offset:57344
buffer_load_dwordx4 v227, s[16:19], s43 offen offset:1024 nt lds
v_mfma_f32_16x16x32_bf16 v[76:79], a[184:187], v[140:143], v[76:79]
ds_read_b64_tr_b16 a[214:215], v197 offset:61440
s_waitcnt lgkmcnt(7)
v_mfma_f32_16x16x32_bf16 v[0:3], a[188:191], v[96:99], v[0:3]
ds_read_b128 a[216:219], v189 offset:8192
v_add_f32 v177, v177, v144
v_mfma_f32_16x16x32_bf16 v[4:7], a[188:191], v[100:103], v[4:7]
v_exp_f32 v145, v145
v_mfma_f32_16x16x32_bf16 a[16:19], a[188:191], a[24:27], a[16:19]
v_exp_f32 v146, v146
v_mfma_f32_16x16x32_bf16 a[236:239], a[228:231], v[100:103], a[236:239]
v_cvt_pk_bf16_f32 v152, v144, v145
v_add_f32 v177, v177, v145
v_mfma_f32_16x16x32_bf16 v[8:11], a[192:195], v[96:99], v[8:11]
ds_read_b64_tr_b16 a[220:221], v198 offset:57344
v_add_f32 v177, v177, v146
v_mfma_f32_16x16x32_bf16 v[12:15], a[192:195], v[100:103], v[12:15]
ds_read_b64_tr_b16 a[222:223], v198 offset:61440
v_exp_f32 v147, v147
v_mfma_f32_16x16x32_bf16 a[20:23], a[192:195], a[24:27], a[20:23]
v_cvt_pk_bf16_f32 v153, v146, v147
s_waitcnt lgkmcnt(6)
v_mfma_f32_16x16x32_bf16 v[80:83], a[196:199], v[112:115], v[156:159]
ds_read_b128 a[224:227], v186 offset:12288
ds_write_b64 v202, v[152:153] offset:0
v_mfma_f32_16x16x32_bf16 v[88:91], a[196:199], v[128:131], v[160:163]
buffer_load_dwordx4 v226, s[16:19], s43 offen offset:2048 nt lds
v_mfma_f32_16x16x32_bf16 v[80:83], a[200:203], v[116:119], v[80:83]
ds_read_b64_tr_b16 a[180:181], v199 offset:57344
v_add_f32 v177, v177, v147
v_mfma_f32_16x16x32_bf16 v[88:91], a[200:203], v[132:135], v[88:91]
ds_read_b64_tr_b16 a[182:183], v199 offset:61440
v_exp_f32 v64, v64
v_mfma_f32_16x16x32_bf16 v[16:19], a[204:207], v[104:107], v[16:19]
ds_read_b128 a[184:187], v187 offset:12288
v_exp_f32 v65, v65
v_mfma_f32_16x16x32_bf16 v[20:23], a[204:207], v[108:111], v[20:23]
v_cvt_pk_bf16_f32 v96, v64, v65
s_waitcnt lgkmcnt(6)
v_mfma_f32_16x16x32_bf16 v[80:83], a[208:211], v[120:123], v[80:83]
ds_read_b64_tr_b16 a[188:189], v200 offset:57344
v_exp_f32 v66, v66
v_mfma_f32_16x16x32_bf16 v[88:91], a[208:211], v[136:139], v[88:91]
ds_read_b64_tr_b16 a[190:191], v200 offset:61440
v_exp_f32 v67, v67
v_mfma_f32_16x16x32_bf16 v[24:27], a[212:215], v[104:107], v[24:27]
ds_read_b128 a[192:195], v188 offset:12288
v_cvt_pk_bf16_f32 v97, v66, v67
v_mfma_f32_16x16x32_bf16 v[28:31], a[212:215], v[108:111], v[28:31]
v_exp_f32 v68, v68
v_mfma_f32_16x16x32_bf16 v[80:83], a[216:219], v[124:127], v[80:83]
ds_read_b64_tr_b16 a[196:197], v201 offset:57344
buffer_load_dwordx4 v227, s[16:19], s43 offen offset:3072 nt lds
v_mfma_f32_16x16x32_bf16 v[88:91], a[216:219], v[140:143], v[88:91]
ds_read_b64_tr_b16 a[198:199], v201 offset:61440
s_waitcnt lgkmcnt(6)
v_mfma_f32_16x16x32_bf16 v[32:35], a[220:223], v[104:107], v[32:35]
ds_read_b128 a[200:203], v189 offset:12288
v_exp_f32 v69, v69
v_mfma_f32_16x16x32_bf16 v[36:39], a[220:223], v[108:111], v[36:39]
v_exp_f32 v70, v70
v_mfma_f32_16x16x32_bf16 v[84:87], a[224:227], v[112:115], v[156:159]
ds_read_b64_tr_b16 a[204:205], v194 offset:57344
v_cvt_pk_bf16_f32 v98, v68, v69
v_mfma_f32_16x16x32_bf16 v[92:95], a[224:227], v[128:131], v[160:163]
ds_read_b64_tr_b16 a[206:207], v194 offset:61440
v_exp_f32 v71, v71
v_mfma_f32_16x16x32_bf16 v[40:43], a[180:183], v[104:107], v[40:43]
ds_read_b64_tr_b16 a[208:209], v195 offset:57344
v_cvt_pk_bf16_f32 v99, v70, v71
v_mfma_f32_16x16x32_bf16 v[44:47], a[180:183], v[108:111], v[44:47]
ds_read_b64_tr_b16 a[210:211], v195 offset:61440
s_waitcnt lgkmcnt(8)
v_mfma_f32_16x16x32_bf16 v[84:87], a[184:187], v[116:119], v[84:87]
v_exp_f32 v72, v72
v_mfma_f32_16x16x32_bf16 v[92:95], a[184:187], v[132:135], v[92:95]
v_exp_f32 v73, v73
v_mfma_f32_16x16x32_bf16 v[48:51], a[188:191], v[104:107], v[48:51]
s_waitcnt vmcnt(8)
s_barrier
v_mfma_f32_16x16x32_bf16 v[52:55], a[188:191], v[108:111], v[52:55]
ds_read_b128 a[212:215], v186 offset:16384
s_waitcnt lgkmcnt(5)
v_mfma_f32_16x16x32_bf16 v[84:87], a[192:195], v[120:123], v[84:87]
ds_read_b128 a[216:219], v187 offset:16384
s_add_u32 m0, s39, 49152
v_mfma_f32_16x16x32_bf16 v[92:95], a[192:195], v[136:139], v[92:95]
ds_read_b128 a[220:223], v190 offset:16384
s_add_u32 s42, s42, 16384
v_mfma_f32_16x16x32_bf16 v[56:59], a[196:199], v[104:107], v[56:59]
ds_read_b64_tr_b16 a[224:225], v196 offset:0
buffer_load_dwordx4 v222, s[12:15], s42 offen nt lds
v_mfma_f32_16x16x32_bf16 v[60:63], a[196:199], v[108:111], v[60:63]
ds_read_b64_tr_b16 a[226:227], v196 offset:4096
v_cvt_pk_bf16_f32 v100, v72, v73
v_mfma_f32_16x16x32_bf16 a[232:235], a[228:231], v[104:107], a[232:235]
buffer_load_dwordx4 v223, s[12:15], s42 offen offset:1024 nt lds
v_mfma_f32_16x16x32_bf16 v[84:87], a[200:203], v[124:127], v[84:87]
ds_read_b128 a[180:183], v191 offset:16384
v_exp_f32 v74, v74
v_mfma_f32_16x16x32_bf16 v[92:95], a[200:203], v[140:143], v[92:95]
v_exp_f32 v75, v75
s_waitcnt lgkmcnt(6)
v_mfma_f32_16x16x32_bf16 v[0:3], a[204:207], v[104:107], v[0:3]
ds_read_b128 a[184:187], v188 offset:16384
v_cvt_pk_bf16_f32 v101, v74, v75
v_mfma_f32_16x16x32_bf16 v[4:7], a[204:207], v[108:111], v[4:7]
v_exp_f32 v76, v76
v_mfma_f32_16x16x32_bf16 a[16:19], a[204:207], a[28:31], a[16:19]
buffer_load_dwordx4 v224, s[12:15], s42 offen offset:2048 nt lds
v_mfma_f32_16x16x32_bf16 a[236:239], a[228:231], v[108:111], a[236:239]
v_exp_f32 v77, v77
v_mfma_f32_16x16x32_bf16 v[8:11], a[208:211], v[104:107], v[8:11]
ds_read_b128 a[188:191], v192 offset:16384
v_cvt_pk_bf16_f32 v102, v76, v77
v_mfma_f32_16x16x32_bf16 v[12:15], a[208:211], v[108:111], v[12:15]
v_exp_f32 v78, v78
v_mfma_f32_16x16x32_bf16 a[20:23], a[208:211], a[28:31], a[20:23]
v_exp_f32 v79, v79
s_nop 0
v_cvt_pk_bf16_f32 v103, v78, v79
s_waitcnt lgkmcnt(3)
v_mfma_f32_16x16x32_bf16 v[64:67], a[212:215], v[112:115], v[156:159]
ds_read_b64_tr_b16 a[192:193], v197 offset:0
buffer_load_dwordx4 v225, s[12:15], s42 offen offset:3072 nt lds
v_mfma_f32_16x16x32_bf16 v[72:75], a[212:215], v[128:131], v[160:163]
ds_read_b64_tr_b16 a[194:195], v197 offset:4096
v_exp_f32 v80, v80
v_mfma_f32_16x16x32_bf16 v[64:67], a[216:219], v[116:119], v[64:67]
ds_read_b128 a[196:199], v193 offset:16384
v_exp_f32 v81, v81
v_mfma_f32_16x16x32_bf16 v[72:75], a[216:219], v[132:135], v[72:75]
ds_read_b128 a[24:27], v203 offset:0
v_cvt_pk_bf16_f32 v104, v80, v81
v_mfma_f32_16x16x32_bf16 v[144:147], a[220:223], a[0:3], v[164:167]
ds_read_b128 a[200:203], v189 offset:16384
v_exp_f32 v82, v82
v_mfma_f32_16x16x32_bf16 v[16:19], a[224:227], v[96:99], v[16:19]
ds_read_b64_tr_b16 a[204:205], v198 offset:0
s_add_u32 m0, s39, 98304
v_mfma_f32_16x16x32_bf16 v[20:23], a[224:227], v[100:103], v[20:23]
ds_read_b64_tr_b16 a[206:207], v198 offset:4096
s_waitcnt lgkmcnt(5)
v_mfma_f32_16x16x32_bf16 v[144:147], a[180:183], a[4:7], v[144:147]
ds_read_b128 a[208:211], v186 offset:20480
s_add_u32 s43, s43, 16384
v_mfma_f32_16x16x32_bf16 v[64:67], a[184:187], v[120:123], v[64:67]
ds_read_b64_tr_b16 a[212:213], v199 offset:0
buffer_load_dwordx4 v226, s[16:19], s43 offen nt lds
v_mfma_f32_16x16x32_bf16 v[72:75], a[184:187], v[136:139], v[72:75]
ds_read_b64_tr_b16 a[214:215], v199 offset:4096
v_exp_f32 v83, v83
v_mfma_f32_16x16x32_bf16 v[144:147], a[188:191], a[8:11], v[144:147]
ds_read_b128 a[216:219], v187 offset:20480
buffer_load_dwordx4 v227, s[16:19], s43 offen offset:1024 nt lds
v_mfma_f32_16x16x32_bf16 v[24:27], a[192:195], v[96:99], v[24:27]
ds_read_b64_tr_b16 a[220:221], v200 offset:0
v_cvt_pk_bf16_f32 v105, v82, v83
v_mfma_f32_16x16x32_bf16 v[28:31], a[192:195], v[100:103], v[28:31]
ds_read_b64_tr_b16 a[222:223], v200 offset:4096
s_waitcnt lgkmcnt(5)
v_mfma_f32_16x16x32_bf16 v[144:147], a[196:199], a[12:15], v[144:147]
ds_read_b128 a[224:227], v188 offset:20480
v_exp_f32 v84, v84
v_mfma_f32_16x16x32_bf16 v[64:67], a[200:203], v[124:127], v[64:67]
ds_read_b64_tr_b16 a[180:181], v201 offset:0
v_exp_f32 v85, v85
v_mfma_f32_16x16x32_bf16 v[72:75], a[200:203], v[140:143], v[72:75]
ds_read_b64_tr_b16 a[182:183], v201 offset:4096
buffer_load_dwordx4 v226, s[16:19], s43 offen offset:2048 nt lds
v_mfma_f32_16x16x32_bf16 v[32:35], a[204:207], v[96:99], v[32:35]
ds_read_b128 a[28:31], v203 offset:1024
v_cvt_pk_bf16_f32 v106, v84, v85
v_mfma_f32_16x16x32_bf16 v[36:39], a[204:207], v[100:103], v[36:39]
ds_read_b128 a[184:187], v189 offset:20480
v_exp_f32 v86, v86
v_mfma_f32_16x16x32_bf16 v[68:71], a[208:211], v[112:115], v[156:159]
ds_read_b64_tr_b16 a[188:189], v194 offset:0
v_exp_f32 v87, v87
v_mfma_f32_16x16x32_bf16 v[76:79], a[208:211], v[128:131], v[160:163]
ds_read_b64_tr_b16 a[190:191], v194 offset:4096
s_waitcnt lgkmcnt(7)
v_mfma_f32_16x16x32_bf16 v[40:43], a[212:215], v[96:99], v[40:43]
ds_read_b64_tr_b16 a[192:193], v195 offset:0
buffer_load_dwordx4 v227, s[16:19], s43 offen offset:3072 nt lds
v_mfma_f32_16x16x32_bf16 v[44:47], a[212:215], v[100:103], v[44:47]
ds_read_b64_tr_b16 a[194:195], v195 offset:4096
v_cvt_pk_bf16_f32 v107, v86, v87
v_mfma_f32_16x16x32_bf16 v[68:71], a[216:219], v[116:119], v[68:71]
ds_read_b128 a[196:199], v186 offset:24576
v_exp_f32 v88, v88
v_mfma_f32_16x16x32_bf16 v[76:79], a[216:219], v[132:135], v[76:79]
v_exp_f32 v89, v89
v_mfma_f32_16x16x32_bf16 v[48:51], a[220:223], v[96:99], v[48:51]
ds_read_b128 a[200:203], v187 offset:24576
v_cvt_pk_bf16_f32 v108, v88, v89
v_mfma_f32_16x16x32_bf16 v[52:55], a[220:223], v[100:103], v[52:55]
s_lshl_b32 s3, s49, 3
s_waitcnt lgkmcnt(6)
v_mfma_f32_16x16x32_bf16 v[68:71], a[224:227], v[120:123], v[68:71]
ds_read_b64_tr_b16 a[204:205], v196 offset:8192
s_add_u32 s3, s3, s47
v_mfma_f32_16x16x32_bf16 v[76:79], a[224:227], v[136:139], v[76:79]
ds_read_b64_tr_b16 a[206:207], v196 offset:12288
v_exp_f32 v90, v90
v_mfma_f32_16x16x32_bf16 v[56:59], a[180:183], v[96:99], v[56:59]
ds_read_b128 a[208:211], v188 offset:24576
v_exp_f32 v91, v91
v_mfma_f32_16x16x32_bf16 v[60:63], a[180:183], v[100:103], v[60:63]
v_exp_f32 v92, v92
v_mfma_f32_16x16x32_bf16 a[232:235], a[228:231], v[96:99], a[232:235]
s_lshl_b32 s3, s3, 2
s_add_u32 s3, s3, s50
v_mfma_f32_16x16x32_bf16 v[68:71], a[184:187], v[124:127], v[68:71]
ds_read_b64_tr_b16 a[212:213], v197 offset:8192
v_cvt_pk_bf16_f32 v109, v90, v91
v_mfma_f32_16x16x32_bf16 v[76:79], a[184:187], v[140:143], v[76:79]
ds_read_b64_tr_b16 a[214:215], v197 offset:12288
s_waitcnt lgkmcnt(7)
v_mfma_f32_16x16x32_bf16 v[0:3], a[188:191], v[96:99], v[0:3]
ds_read_b128 a[216:219], v189 offset:24576
v_exp_f32 v93, v93
v_mfma_f32_16x16x32_bf16 v[4:7], a[188:191], v[100:103], v[4:7]
v_exp_f32 v94, v94
v_mfma_f32_16x16x32_bf16 a[16:19], a[188:191], a[24:27], a[16:19]
s_lshl_b32 s3, s3, 2
s_add_u32 s3, s3, s38
v_mfma_f32_16x16x32_bf16 a[236:239], a[228:231], v[100:103], a[236:239]
v_cvt_pk_bf16_f32 v110, v92, v93
v_exp_f32 v95, v95
v_mfma_f32_16x16x32_bf16 v[8:11], a[192:195], v[96:99], v[8:11]
ds_read_b64_tr_b16 a[220:221], v198 offset:8192
v_cvt_pk_bf16_f32 v111, v94, v95
v_mfma_f32_16x16x32_bf16 v[12:15], a[192:195], v[100:103], v[12:15]
ds_read_b64_tr_b16 a[222:223], v198 offset:12288
v_exp_f32 v144, v144
v_mfma_f32_16x16x32_bf16 a[20:23], a[192:195], a[24:27], a[20:23]
v_add_f32 v177, v177, v144
s_waitcnt lgkmcnt(6)
v_mfma_f32_16x16x32_bf16 v[80:83], a[196:199], v[112:115], v[156:159]
ds_read_b128 a[224:227], v186 offset:28672
s_mul_i32 s3, s3, 9216
v_mfma_f32_16x16x32_bf16 v[88:91], a[196:199], v[128:131], v[160:163]
v_lshlrev_b32 v178, 7, v242
v_exp_f32 v145, v145
v_mfma_f32_16x16x32_bf16 v[80:83], a[200:203], v[116:119], v[80:83]
ds_read_b64_tr_b16 a[180:181], v199 offset:8192
v_cvt_pk_bf16_f32 v152, v144, v145
v_mfma_f32_16x16x32_bf16 v[88:91], a[200:203], v[132:135], v[88:91]
ds_read_b64_tr_b16 a[182:183], v199 offset:12288
v_add_f32 v177, v177, v145
v_mfma_f32_16x16x32_bf16 v[16:19], a[204:207], v[104:107], v[16:19]
ds_read_b128 a[184:187], v187 offset:28672
v_exp_f32 v146, v146
v_mfma_f32_16x16x32_bf16 v[20:23], a[204:207], v[108:111], v[20:23]
v_and_b32 v179, 0x3ff, v178
s_waitcnt lgkmcnt(6)
v_mfma_f32_16x16x32_bf16 v[80:83], a[208:211], v[120:123], v[80:83]
ds_read_b64_tr_b16 a[188:189], v200 offset:8192
v_add_f32 v177, v177, v146
v_mfma_f32_16x16x32_bf16 v[88:91], a[208:211], v[136:139], v[88:91]
ds_read_b64_tr_b16 a[190:191], v200 offset:12288
v_exp_f32 v147, v147
v_mfma_f32_16x16x32_bf16 v[24:27], a[212:215], v[104:107], v[24:27]
ds_read_b128 a[192:195], v188 offset:28672
v_cvt_pk_bf16_f32 v153, v146, v147
v_mfma_f32_16x16x32_bf16 v[28:31], a[212:215], v[108:111], v[28:31]
ds_write_b64 v202, v[152:153] offset:2048
v_add_f32 v177, v177, v147
v_mfma_f32_16x16x32_bf16 v[80:83], a[216:219], v[124:127], v[80:83]
ds_read_b64_tr_b16 a[196:197], v201 offset:8192
buffer_load_dword v255, v178, s[28:31], s3 offen
v_mfma_f32_16x16x32_bf16 v[88:91], a[216:219], v[140:143], v[88:91]
ds_read_b64_tr_b16 a[198:199], v201 offset:12288
s_waitcnt lgkmcnt(6)
v_mfma_f32_16x16x32_bf16 v[32:35], a[220:223], v[104:107], v[32:35]
ds_read_b128 a[200:203], v189 offset:28672
s_add_u32 s3, s3, 8192
v_mfma_f32_16x16x32_bf16 v[36:39], a[220:223], v[108:111], v[36:39]
v_exp_f32 v64, v64
v_mfma_f32_16x16x32_bf16 v[84:87], a[224:227], v[112:115], v[156:159]
ds_read_b64_tr_b16 a[204:205], v194 offset:8192
v_exp_f32 v65, v65
v_mfma_f32_16x16x32_bf16 v[92:95], a[224:227], v[128:131], v[160:163]
ds_read_b64_tr_b16 a[206:207], v194 offset:12288
buffer_load_dword v255, v179, s[28:31], s3 offen
v_mfma_f32_16x16x32_bf16 v[40:43], a[180:183], v[104:107], v[40:43]
ds_read_b64_tr_b16 a[208:209], v195 offset:8192
v_cvt_pk_bf16_f32 v96, v64, v65
v_mfma_f32_16x16x32_bf16 v[44:47], a[180:183], v[108:111], v[44:47]
ds_read_b64_tr_b16 a[210:211], v195 offset:12288
s_waitcnt lgkmcnt(8)
v_mfma_f32_16x16x32_bf16 v[84:87], a[184:187], v[116:119], v[84:87]
v_exp_f32 v66, v66
v_mfma_f32_16x16x32_bf16 v[92:95], a[184:187], v[132:135], v[92:95]
v_exp_f32 v67, v67
v_mfma_f32_16x16x32_bf16 v[48:51], a[188:191], v[104:107], v[48:51]
s_waitcnt vmcnt(10) lgkmcnt(7)
s_barrier
v_mfma_f32_16x16x32_bf16 v[52:55], a[188:191], v[108:111], v[52:55]
ds_read_b128 a[212:215], v186 offset:32768
s_waitcnt lgkmcnt(5)
v_mfma_f32_16x16x32_bf16 v[84:87], a[192:195], v[120:123], v[84:87]
ds_read_b128 a[216:219], v187 offset:32768
s_add_u32 m0, s39, 114688
v_mfma_f32_16x16x32_bf16 v[92:95], a[192:195], v[136:139], v[92:95]
ds_read_b128 a[220:223], v190 offset:32768
s_add_u32 s43, s43, 16384
v_mfma_f32_16x16x32_bf16 v[56:59], a[196:199], v[104:107], v[56:59]
ds_read_b64_tr_b16 a[224:225], v196 offset:16384
buffer_load_dwordx4 v226, s[16:19], s43 offen nt lds
v_mfma_f32_16x16x32_bf16 v[60:63], a[196:199], v[108:111], v[60:63]
ds_read_b64_tr_b16 a[226:227], v196 offset:20480
v_cvt_pk_bf16_f32 v97, v66, v67
v_mfma_f32_16x16x32_bf16 a[232:235], a[228:231], v[104:107], a[232:235]
v_exp_f32 v68, v68
v_mfma_f32_16x16x32_bf16 v[84:87], a[200:203], v[124:127], v[84:87]
ds_read_b128 a[180:183], v191 offset:32768
v_exp_f32 v69, v69
v_mfma_f32_16x16x32_bf16 v[92:95], a[200:203], v[140:143], v[92:95]
v_cvt_pk_bf16_f32 v98, v68, v69
s_waitcnt lgkmcnt(6)
v_mfma_f32_16x16x32_bf16 v[0:3], a[204:207], v[104:107], v[0:3]
ds_read_b128 a[184:187], v188 offset:32768
v_exp_f32 v70, v70
v_mfma_f32_16x16x32_bf16 v[4:7], a[204:207], v[108:111], v[4:7]
v_exp_f32 v71, v71
v_mfma_f32_16x16x32_bf16 a[16:19], a[204:207], a[28:31], a[16:19]
v_exp_f32 v72, v72
v_mfma_f32_16x16x32_bf16 a[236:239], a[228:231], v[108:111], a[236:239]
v_cvt_pk_bf16_f32 v99, v70, v71
v_exp_f32 v73, v73
v_mfma_f32_16x16x32_bf16 v[8:11], a[208:211], v[104:107], v[8:11]
ds_read_b128 a[188:191], v192 offset:32768
v_cvt_pk_bf16_f32 v100, v72, v73
v_mfma_f32_16x16x32_bf16 v[12:15], a[208:211], v[108:111], v[12:15]
v_exp_f32 v74, v74
v_mfma_f32_16x16x32_bf16 a[20:23], a[208:211], a[28:31], a[20:23]
v_exp_f32 v75, v75
v_exp_f32 v76, v76
v_cvt_pk_bf16_f32 v101, v74, v75
v_exp_f32 v77, v77
v_exp_f32 v78, v78
v_cvt_pk_bf16_f32 v102, v76, v77
v_exp_f32 v79, v79
s_nop 0
v_cvt_pk_bf16_f32 v103, v78, v79
s_waitcnt lgkmcnt(3)
v_mfma_f32_16x16x32_bf16 v[64:67], a[212:215], v[112:115], v[156:159]
ds_read_b64_tr_b16 a[192:193], v197 offset:16384
v_exp_f32 v80, v80
v_mfma_f32_16x16x32_bf16 v[72:75], a[212:215], v[128:131], v[160:163]
ds_read_b64_tr_b16 a[194:195], v197 offset:20480
v_exp_f32 v81, v81
v_mfma_f32_16x16x32_bf16 v[64:67], a[216:219], v[116:119], v[64:67]
ds_read_b128 a[196:199], v193 offset:32768
v_cvt_pk_bf16_f32 v104, v80, v81
v_mfma_f32_16x16x32_bf16 v[72:75], a[216:219], v[132:135], v[72:75]
ds_read_b128 a[24:27], v203 offset:2048
buffer_load_dwordx4 v227, s[16:19], s43 offen offset:1024 nt lds
v_mfma_f32_16x16x32_bf16 v[144:147], a[220:223], a[0:3], v[164:167]
ds_read_b128 a[200:203], v189 offset:32768
v_exp_f32 v82, v82
v_mfma_f32_16x16x32_bf16 v[16:19], a[224:227], v[96:99], v[16:19]
ds_read_b64_tr_b16 a[204:205], v198 offset:16384
v_exp_f32 v83, v83
v_mfma_f32_16x16x32_bf16 v[20:23], a[224:227], v[100:103], v[20:23]
ds_read_b64_tr_b16 a[206:207], v198 offset:20480
s_waitcnt lgkmcnt(5)
v_mfma_f32_16x16x32_bf16 v[144:147], a[180:183], a[4:7], v[144:147]
ds_read_b128 a[208:211], v186 offset:36864
v_cvt_pk_bf16_f32 v105, v82, v83
v_mfma_f32_16x16x32_bf16 v[64:67], a[184:187], v[120:123], v[64:67]
ds_read_b64_tr_b16 a[212:213], v199 offset:16384
v_exp_f32 v84, v84
v_mfma_f32_16x16x32_bf16 v[72:75], a[184:187], v[136:139], v[72:75]
ds_read_b64_tr_b16 a[214:215], v199 offset:20480
v_exp_f32 v85, v85
v_mfma_f32_16x16x32_bf16 v[144:147], a[188:191], a[8:11], v[144:147]
ds_read_b128 a[216:219], v187 offset:36864
v_cvt_pk_bf16_f32 v106, v84, v85
v_mfma_f32_16x16x32_bf16 v[24:27], a[192:195], v[96:99], v[24:27]
ds_read_b64_tr_b16 a[220:221], v200 offset:16384
v_exp_f32 v86, v86
v_mfma_f32_16x16x32_bf16 v[28:31], a[192:195], v[100:103], v[28:31]
ds_read_b64_tr_b16 a[222:223], v200 offset:20480
s_waitcnt lgkmcnt(5)
v_mfma_f32_16x16x32_bf16 v[144:147], a[196:199], a[12:15], v[144:147]
ds_read_b128 a[224:227], v188 offset:36864
v_exp_f32 v87, v87
v_mfma_f32_16x16x32_bf16 v[64:67], a[200:203], v[124:127], v[64:67]
ds_read_b64_tr_b16 a[180:181], v201 offset:16384
v_cvt_pk_bf16_f32 v107, v86, v87
v_mfma_f32_16x16x32_bf16 v[72:75], a[200:203], v[140:143], v[72:75]
ds_read_b64_tr_b16 a[182:183], v201 offset:20480
v_exp_f32 v88, v88
v_mfma_f32_16x16x32_bf16 v[32:35], a[204:207], v[96:99], v[32:35]
ds_read_b128 a[28:31], v203 offset:3072
v_exp_f32 v89, v89
v_mfma_f32_16x16x32_bf16 v[36:39], a[204:207], v[100:103], v[36:39]
ds_read_b128 a[184:187], v189 offset:36864
v_cvt_pk_bf16_f32 v108, v88, v89
v_mfma_f32_16x16x32_bf16 v[68:71], a[208:211], v[112:115], v[156:159]
ds_read_b64_tr_b16 a[188:189], v194 offset:16384
v_exp_f32 v90, v90
v_mfma_f32_16x16x32_bf16 v[76:79], a[208:211], v[128:131], v[160:163]
ds_read_b64_tr_b16 a[190:191], v194 offset:20480
s_waitcnt lgkmcnt(7)
v_mfma_f32_16x16x32_bf16 v[40:43], a[212:215], v[96:99], v[40:43]
ds_read_b64_tr_b16 a[192:193], v195 offset:16384
v_exp_f32 v91, v91
v_mfma_f32_16x16x32_bf16 v[44:47], a[212:215], v[100:103], v[44:47]
ds_read_b64_tr_b16 a[194:195], v195 offset:20480
v_cvt_pk_bf16_f32 v109, v90, v91
v_mfma_f32_16x16x32_bf16 v[68:71], a[216:219], v[116:119], v[68:71]
ds_read_b128 a[196:199], v186 offset:40960
buffer_load_dwordx4 v226, s[16:19], s43 offen offset:2048 nt lds
v_mfma_f32_16x16x32_bf16 v[76:79], a[216:219], v[132:135], v[76:79]
v_exp_f32 v92, v92
v_mfma_f32_16x16x32_bf16 v[48:51], a[220:223], v[96:99], v[48:51]
ds_read_b128 a[200:203], v187 offset:40960
v_exp_f32 v93, v93
v_mfma_f32_16x16x32_bf16 v[52:55], a[220:223], v[100:103], v[52:55]
v_cvt_pk_bf16_f32 v110, v92, v93
s_waitcnt lgkmcnt(6)
v_mfma_f32_16x16x32_bf16 v[68:71], a[224:227], v[120:123], v[68:71]
ds_read_b64_tr_b16 a[204:205], v196 offset:24576
v_exp_f32 v94, v94
v_mfma_f32_16x16x32_bf16 v[76:79], a[224:227], v[136:139], v[76:79]
ds_read_b64_tr_b16 a[206:207], v196 offset:28672
v_exp_f32 v95, v95
v_mfma_f32_16x16x32_bf16 v[56:59], a[180:183], v[96:99], v[56:59]
ds_read_b128 a[208:211], v188 offset:40960
v_cvt_pk_bf16_f32 v111, v94, v95
v_mfma_f32_16x16x32_bf16 v[60:63], a[180:183], v[100:103], v[60:63]
v_exp_f32 v144, v144
v_mfma_f32_16x16x32_bf16 a[232:235], a[228:231], v[96:99], a[232:235]
v_exp_f32 v145, v145
v_mfma_f32_16x16x32_bf16 v[68:71], a[184:187], v[124:127], v[68:71]
ds_read_b64_tr_b16 a[212:213], v197 offset:24576
v_cvt_pk_bf16_f32 v152, v144, v145
v_mfma_f32_16x16x32_bf16 v[76:79], a[184:187], v[140:143], v[76:79]
ds_read_b64_tr_b16 a[214:215], v197 offset:28672
s_waitcnt lgkmcnt(7)
v_mfma_f32_16x16x32_bf16 v[0:3], a[188:191], v[96:99], v[0:3]
ds_read_b128 a[216:219], v189 offset:40960
v_add_f32 v177, v177, v144
v_mfma_f32_16x16x32_bf16 v[4:7], a[188:191], v[100:103], v[4:7]
v_exp_f32 v146, v146
v_mfma_f32_16x16x32_bf16 a[16:19], a[188:191], a[24:27], a[16:19]
v_exp_f32 v147, v147
v_mfma_f32_16x16x32_bf16 a[236:239], a[228:231], v[100:103], a[236:239]
v_cvt_pk_bf16_f32 v153, v146, v147
ds_write_b64 v202, v[152:153] offset:0
v_mfma_f32_16x16x32_bf16 v[8:11], a[192:195], v[96:99], v[8:11]
ds_read_b64_tr_b16 a[220:221], v198 offset:24576
v_add_f32 v177, v177, v145
v_mfma_f32_16x16x32_bf16 v[12:15], a[192:195], v[100:103], v[12:15]
ds_read_b64_tr_b16 a[222:223], v198 offset:28672
v_add_f32 v177, v177, v146
v_mfma_f32_16x16x32_bf16 a[20:23], a[192:195], a[24:27], a[20:23]
v_add_f32 v177, v177, v147
s_waitcnt lgkmcnt(6)
v_mfma_f32_16x16x32_bf16 v[80:83], a[196:199], v[112:115], v[156:159]
ds_read_b128 a[224:227], v186 offset:45056
v_exp_f32 v64, v64
v_mfma_f32_16x16x32_bf16 v[88:91], a[196:199], v[128:131], v[160:163]
buffer_load_dwordx4 v227, s[16:19], s43 offen offset:3072 nt lds
v_mfma_f32_16x16x32_bf16 v[80:83], a[200:203], v[116:119], v[80:83]
ds_read_b64_tr_b16 a[180:181], v199 offset:24576
v_exp_f32 v65, v65
v_mfma_f32_16x16x32_bf16 v[88:91], a[200:203], v[132:135], v[88:91]
ds_read_b64_tr_b16 a[182:183], v199 offset:28672
v_cvt_pk_bf16_f32 v96, v64, v65
v_mfma_f32_16x16x32_bf16 v[16:19], a[204:207], v[104:107], v[16:19]
ds_read_b128 a[184:187], v187 offset:45056
v_exp_f32 v66, v66
v_mfma_f32_16x16x32_bf16 v[20:23], a[204:207], v[108:111], v[20:23]
v_exp_f32 v67, v67
s_waitcnt lgkmcnt(6)
v_mfma_f32_16x16x32_bf16 v[80:83], a[208:211], v[120:123], v[80:83]
ds_read_b64_tr_b16 a[188:189], v200 offset:24576
v_cvt_pk_bf16_f32 v97, v66, v67
v_mfma_f32_16x16x32_bf16 v[88:91], a[208:211], v[136:139], v[88:91]
ds_read_b64_tr_b16 a[190:191], v200 offset:28672
v_exp_f32 v68, v68
v_mfma_f32_16x16x32_bf16 v[24:27], a[212:215], v[104:107], v[24:27]
ds_read_b128 a[192:195], v188 offset:45056
v_exp_f32 v69, v69
v_mfma_f32_16x16x32_bf16 v[28:31], a[212:215], v[108:111], v[28:31]
v_exp_f32 v70, v70
v_mfma_f32_16x16x32_bf16 v[80:83], a[216:219], v[124:127], v[80:83]
ds_read_b64_tr_b16 a[196:197], v201 offset:24576
v_cvt_pk_bf16_f32 v98, v68, v69
v_mfma_f32_16x16x32_bf16 v[88:91], a[216:219], v[140:143], v[88:91]
ds_read_b64_tr_b16 a[198:199], v201 offset:28672
s_waitcnt lgkmcnt(6)
v_mfma_f32_16x16x32_bf16 v[32:35], a[220:223], v[104:107], v[32:35]
ds_read_b128 a[200:203], v189 offset:45056
v_exp_f32 v71, v71
v_mfma_f32_16x16x32_bf16 v[36:39], a[220:223], v[108:111], v[36:39]
v_exp_f32 v72, v72
v_mfma_f32_16x16x32_bf16 v[84:87], a[224:227], v[112:115], v[156:159]
ds_read_b64_tr_b16 a[204:205], v194 offset:24576
v_cvt_pk_bf16_f32 v99, v70, v71
v_mfma_f32_16x16x32_bf16 v[92:95], a[224:227], v[128:131], v[160:163]
ds_read_b64_tr_b16 a[206:207], v194 offset:28672
v_exp_f32 v73, v73
v_mfma_f32_16x16x32_bf16 v[40:43], a[180:183], v[104:107], v[40:43]
ds_read_b64_tr_b16 a[208:209], v195 offset:24576
v_cvt_pk_bf16_f32 v100, v72, v73
v_mfma_f32_16x16x32_bf16 v[44:47], a[180:183], v[108:111], v[44:47]
ds_read_b64_tr_b16 a[210:211], v195 offset:28672
s_waitcnt lgkmcnt(8)
v_mfma_f32_16x16x32_bf16 v[84:87], a[184:187], v[116:119], v[84:87]
v_exp_f32 v74, v74
v_mfma_f32_16x16x32_bf16 v[92:95], a[184:187], v[132:135], v[92:95]
v_exp_f32 v75, v75
v_mfma_f32_16x16x32_bf16 v[48:51], a[188:191], v[104:107], v[48:51]
s_waitcnt vmcnt(6)
s_barrier
v_mfma_f32_16x16x32_bf16 v[52:55], a[188:191], v[108:111], v[52:55]
ds_read_b128 a[212:215], v186 offset:49152
s_waitcnt lgkmcnt(5)
v_mfma_f32_16x16x32_bf16 v[84:87], a[192:195], v[120:123], v[84:87]
ds_read_b128 a[216:219], v187 offset:49152
s_cmp_lg_u32 s38, 0
s_cbranch_scc1 FL4
buffer_load_dword v180, v206, s[24:27], s62 offen sc1
FL4:
v_mfma_f32_16x16x32_bf16 v[92:95], a[192:195], v[136:139], v[92:95]
ds_read_b128 a[220:223], v190 offset:49152
v_cvt_pk_bf16_f32 v101, v74, v75
v_mfma_f32_16x16x32_bf16 v[56:59], a[196:199], v[104:107], v[56:59]
ds_read_b64_tr_b16 a[224:225], v196 offset:32768
v_exp_f32 v76, v76
v_mfma_f32_16x16x32_bf16 v[60:63], a[196:199], v[108:111], v[60:63]
ds_read_b64_tr_b16 a[226:227], v196 offset:36864
v_exp_f32 v77, v77
v_mfma_f32_16x16x32_bf16 a[232:235], a[228:231], v[104:107], a[232:235]
v_exp_f32 v78, v78
v_mfma_f32_16x16x32_bf16 v[84:87], a[200:203], v[124:127], v[84:87]
ds_read_b128 a[180:183], v191 offset:49152
v_cvt_pk_bf16_f32 v102, v76, v77
v_mfma_f32_16x16x32_bf16 v[92:95], a[200:203], v[140:143], v[92:95]
v_exp_f32 v79, v79
s_waitcnt lgkmcnt(6)
v_mfma_f32_16x16x32_bf16 v[0:3], a[204:207], v[104:107], v[0:3]
ds_read_b128 a[184:187], v188 offset:49152
s_add_u32 s57, s55, 0
v_mfma_f32_16x16x32_bf16 v[4:7], a[204:207], v[108:111], v[4:7]
s_and_b32 s57, s57, 3
v_cvt_pk_bf16_f32 v103, v78, v79
v_mfma_f32_16x16x32_bf16 a[16:19], a[204:207], a[28:31], a[16:19]
v_mfma_f32_16x16x32_bf16 a[236:239], a[228:231], v[108:111], a[236:239]
v_mfma_f32_16x16x32_bf16 v[8:11], a[208:211], v[104:107], v[8:11]
ds_read_b128 a[188:191], v192 offset:49152
v_mfma_f32_16x16x32_bf16 v[12:15], a[208:211], v[108:111], v[12:15]
v_mfma_f32_16x16x32_bf16 a[20:23], a[208:211], a[28:31], a[20:23]
s_waitcnt lgkmcnt(3)
v_mfma_f32_16x16x32_bf16 v[64:67], a[212:215], v[112:115], v[156:159]
ds_read_b64_tr_b16 a[192:193], v197 offset:32768
v_exp_f32 v80, v80
v_mfma_f32_16x16x32_bf16 v[72:75], a[212:215], v[128:131], v[160:163]
ds_read_b64_tr_b16 a[194:195], v197 offset:36864
s_mul_i32 s57, s57, 294912
v_mfma_f32_16x16x32_bf16 v[64:67], a[216:219], v[116:119], v[64:67]
ds_read_b128 a[196:199], v193 offset:49152
s_add_u32 s57, s57, s61
v_mfma_f32_16x16x32_bf16 v[72:75], a[216:219], v[132:135], v[72:75]
ds_read_b128 a[24:27], v203 offset:0
v_exp_f32 v81, v81
v_mfma_f32_16x16x32_bf16 v[144:147], a[220:223], a[0:3], v[164:167]
ds_read_b128 a[200:203], v189 offset:49152
v_cvt_pk_bf16_f32 v104, v80, v81
v_mfma_f32_16x16x32_bf16 v[16:19], a[224:227], v[96:99], v[16:19]
ds_read_b64_tr_b16 a[204:205], v198 offset:32768
v_exp_f32 v82, v82
v_mfma_f32_16x16x32_bf16 v[20:23], a[224:227], v[100:103], v[20:23]
ds_read_b64_tr_b16 a[206:207], v198 offset:36864
s_waitcnt lgkmcnt(5)
v_mfma_f32_16x16x32_bf16 v[144:147], a[180:183], a[4:7], v[144:147]
ds_read_b128 a[208:211], v186 offset:53248
v_exp_f32 v83, v83
v_mfma_f32_16x16x32_bf16 v[64:67], a[184:187], v[120:123], v[64:67]
ds_read_b64_tr_b16 a[212:213], v199 offset:32768
v_cvt_pk_bf16_f32 v105, v82, v83
v_mfma_f32_16x16x32_bf16 v[72:75], a[184:187], v[136:139], v[72:75]
ds_read_b64_tr_b16 a[214:215], v199 offset:36864
v_exp_f32 v84, v84
v_mfma_f32_16x16x32_bf16 v[144:147], a[188:191], a[8:11], v[144:147]
ds_read_b128 a[216:219], v187 offset:53248
s_add_u32 m0, s56, 0
v_mfma_f32_16x16x32_bf16 v[24:27], a[192:195], v[96:99], v[24:27]
ds_read_b64_tr_b16 a[220:221], v200 offset:32768
buffer_load_dwordx4 v244, s[28:31], s57 offen  lds
v_mfma_f32_16x16x32_bf16 v[28:31], a[192:195], v[100:103], v[28:31]
ds_read_b64_tr_b16 a[222:223], v200 offset:36864
s_waitcnt lgkmcnt(5)
v_mfma_f32_16x16x32_bf16 v[144:147], a[196:199], a[12:15], v[144:147]
ds_read_b128 a[224:227], v188 offset:53248
v_exp_f32 v85, v85
v_mfma_f32_16x16x32_bf16 v[64:67], a[200:203], v[124:127], v[64:67]
ds_read_b64_tr_b16 a[180:181], v201 offset:32768
v_cvt_pk_bf16_f32 v106, v84, v85
v_mfma_f32_16x16x32_bf16 v[72:75], a[200:203], v[140:143], v[72:75]
ds_read_b64_tr_b16 a[182:183], v201 offset:36864
v_exp_f32 v86, v86
v_mfma_f32_16x16x32_bf16 v[32:35], a[204:207], v[96:99], v[32:35]
ds_read_b128 a[28:31], v203 offset:1024
v_exp_f32 v87, v87
v_mfma_f32_16x16x32_bf16 v[36:39], a[204:207], v[100:103], v[36:39]
ds_read_b128 a[184:187], v189 offset:53248
v_cvt_pk_bf16_f32 v107, v86, v87
v_mfma_f32_16x16x32_bf16 v[68:71], a[208:211], v[112:115], v[156:159]
ds_read_b64_tr_b16 a[188:189], v194 offset:32768
buffer_load_dwordx4 v245, s[28:31], s57 offen offset:1024  lds
v_mfma_f32_16x16x32_bf16 v[76:79], a[208:211], v[128:131], v[160:163]
ds_read_b64_tr_b16 a[190:191], v194 offset:36864
s_waitcnt lgkmcnt(7)
v_mfma_f32_16x16x32_bf16 v[40:43], a[212:215], v[96:99], v[40:43]
ds_read_b64_tr_b16 a[192:193], v195 offset:32768
v_exp_f32 v88, v88
v_mfma_f32_16x16x32_bf16 v[44:47], a[212:215], v[100:103], v[44:47]
ds_read_b64_tr_b16 a[194:195], v195 offset:36864
v_exp_f32 v89, v89
v_mfma_f32_16x16x32_bf16 v[68:71], a[216:219], v[116:119], v[68:71]
ds_read_b128 a[196:199], v186 offset:57344
v_cvt_pk_bf16_f32 v108, v88, v89
v_mfma_f32_16x16x32_bf16 v[76:79], a[216:219], v[132:135], v[76:79]
v_exp_f32 v90, v90
v_mfma_f32_16x16x32_bf16 v[48:51], a[220:223], v[96:99], v[48:51]
ds_read_b128 a[200:203], v187 offset:57344
v_exp_f32 v91, v91
v_mfma_f32_16x16x32_bf16 v[52:55], a[220:223], v[100:103], v[52:55]
v_cvt_pk_bf16_f32 v109, v90, v91
s_waitcnt lgkmcnt(6)
v_mfma_f32_16x16x32_bf16 v[68:71], a[224:227], v[120:123], v[68:71]
ds_read_b64_tr_b16 a[204:205], v196 offset:40960
buffer_load_dwordx4 v246, s[28:31], s57 offen offset:2048  lds
v_mfma_f32_16x16x32_bf16 v[76:79], a[224:227], v[136:139], v[76:79]
ds_read_b64_tr_b16 a[206:207], v196 offset:45056
v_exp_f32 v92, v92
v_mfma_f32_16x16x32_bf16 v[56:59], a[180:183], v[96:99], v[56:59]
ds_read_b128 a[208:211], v188 offset:57344
v_exp_f32 v93, v93
v_mfma_f32_16x16x32_bf16 v[60:63], a[180:183], v[100:103], v[60:63]
v_exp_f32 v94, v94
v_mfma_f32_16x16x32_bf16 a[232:235], a[228:231], v[96:99], a[232:235]
v_cvt_pk_bf16_f32 v110, v92, v93
v_exp_f32 v95, v95
v_mfma_f32_16x16x32_bf16 v[68:71], a[184:187], v[124:127], v[68:71]
ds_read_b64_tr_b16 a[212:213], v197 offset:40960
v_cvt_pk_bf16_f32 v111, v94, v95
v_mfma_f32_16x16x32_bf16 v[76:79], a[184:187], v[140:143], v[76:79]
ds_read_b64_tr_b16 a[214:215], v197 offset:45056
s_waitcnt lgkmcnt(7)
v_mfma_f32_16x16x32_bf16 v[0:3], a[188:191], v[96:99], v[0:3]
ds_read_b128 a[216:219], v189 offset:57344
v_exp_f32 v144, v144
v_mfma_f32_16x16x32_bf16 v[4:7], a[188:191], v[100:103], v[4:7]
v_exp_f32 v145, v145
v_mfma_f32_16x16x32_bf16 a[16:19], a[188:191], a[24:27], a[16:19]
buffer_load_dwordx4 v247, s[28:31], s57 offen offset:3072  lds
v_mfma_f32_16x16x32_bf16 a[236:239], a[228:231], v[100:103], a[236:239]
v_exp_f32 v146, v146
v_mfma_f32_16x16x32_bf16 v[8:11], a[192:195], v[96:99], v[8:11]
ds_read_b64_tr_b16 a[220:221], v198 offset:40960
v_cvt_pk_bf16_f32 v152, v144, v145
v_mfma_f32_16x16x32_bf16 v[12:15], a[192:195], v[100:103], v[12:15]
ds_read_b64_tr_b16 a[222:223], v198 offset:45056
v_add_f32 v177, v177, v144
v_mfma_f32_16x16x32_bf16 a[20:23], a[192:195], a[24:27], a[20:23]
v_add_f32 v177, v177, v145
s_waitcnt lgkmcnt(6)
v_mfma_f32_16x16x32_bf16 v[80:83], a[196:199], v[112:115], v[156:159]
ds_read_b128 a[224:227], v186 offset:61440
v_add_f32 v177, v177, v146
v_mfma_f32_16x16x32_bf16 v[88:91], a[196:199], v[128:131], v[160:163]
v_exp_f32 v147, v147
v_mfma_f32_16x16x32_bf16 v[80:83], a[200:203], v[116:119], v[80:83]
ds_read_b64_tr_b16 a[180:181], v199 offset:40960
v_cvt_pk_bf16_f32 v153, v146, v147
v_mfma_f32_16x16x32_bf16 v[88:91], a[200:203], v[132:135], v[88:91]
ds_read_b64_tr_b16 a[182:183], v199 offset:45056
s_add_u32 m0, s56, 4096
v_mfma_f32_16x16x32_bf16 v[16:19], a[204:207], v[104:107], v[16:19]
ds_read_b128 a[184:187], v187 offset:61440
buffer_load_dwordx4 v248, s[28:31], s57 offen  lds
v_mfma_f32_16x16x32_bf16 v[20:23], a[204:207], v[108:111], v[20:23]
ds_write_b64 v202, v[152:153] offset:2048
s_waitcnt lgkmcnt(6)
v_mfma_f32_16x16x32_bf16 v[80:83], a[208:211], v[120:123], v[80:83]
ds_read_b64_tr_b16 a[188:189], v200 offset:40960
v_add_f32 v177, v177, v147
v_mfma_f32_16x16x32_bf16 v[88:91], a[208:211], v[136:139], v[88:91]
ds_read_b64_tr_b16 a[190:191], v200 offset:45056
v_exp_f32 v64, v64
v_mfma_f32_16x16x32_bf16 v[24:27], a[212:215], v[104:107], v[24:27]
ds_read_b128 a[192:195], v188 offset:61440
v_exp_f32 v65, v65
v_mfma_f32_16x16x32_bf16 v[28:31], a[212:215], v[108:111], v[28:31]
v_exp_f32 v66, v66
v_mfma_f32_16x16x32_bf16 v[80:83], a[216:219], v[124:127], v[80:83]
ds_read_b64_tr_b16 a[196:197], v201 offset:40960
v_cvt_pk_bf16_f32 v96, v64, v65
v_mfma_f32_16x16x32_bf16 v[88:91], a[216:219], v[140:143], v[88:91]
ds_read_b64_tr_b16 a[198:199], v201 offset:45056
s_waitcnt lgkmcnt(6)
v_mfma_f32_16x16x32_bf16 v[32:35], a[220:223], v[104:107], v[32:35]
ds_read_b128 a[200:203], v189 offset:61440
s_lshl_b32 s44, s39, 1
v_mfma_f32_16x16x32_bf16 v[36:39], a[220:223], v[108:111], v[36:39]
s_add_u32 s44, s44, s53
v_exp_f32 v67, v67
v_mfma_f32_16x16x32_bf16 v[84:87], a[224:227], v[112:115], v[156:159]
ds_read_b64_tr_b16 a[204:205], v194 offset:40960
v_cvt_pk_bf16_f32 v97, v66, v67
v_mfma_f32_16x16x32_bf16 v[92:95], a[224:227], v[128:131], v[160:163]
ds_read_b64_tr_b16 a[206:207], v194 offset:45056
v_exp_f32 v68, v68
v_mfma_f32_16x16x32_bf16 v[40:43], a[180:183], v[104:107], v[40:43]
ds_read_b64_tr_b16 a[208:209], v195 offset:40960
v_exp_f32 v69, v69
v_mfma_f32_16x16x32_bf16 v[44:47], a[180:183], v[108:111], v[44:47]
ds_read_b64_tr_b16 a[210:211], v195 offset:45056
s_waitcnt lgkmcnt(8)
v_mfma_f32_16x16x32_bf16 v[84:87], a[184:187], v[116:119], v[84:87]
v_exp_f32 v70, v70
v_mfma_f32_16x16x32_bf16 v[92:95], a[184:187], v[132:135], v[92:95]
v_cvt_pk_bf16_f32 v98, v68, v69
v_exp_f32 v71, v71
v_mfma_f32_16x16x32_bf16 v[48:51], a[188:191], v[104:107], v[48:51]
s_cmp_lg_u32 s38, 0
s_cbranch_scc1 CE5
s_mov_b32 s5, 0x20000
s_waitcnt vmcnt(5)
CL5:
v_cmp_le_u32 s[66:67], 1, v180
s_nop 1
s_and_b32 s66, s66, 65535
s_cmp_eq_u32 s66, 65535
s_cbranch_scc1 CE5
s_sleep 4
buffer_load_dword v180, v206, s[24:27], s62 offen sc1
s_waitcnt vmcnt(0)
s_sub_u32 s5, s5, 1
s_cbranch_scc0 CL5
CE5:
s_waitcnt vmcnt(5) lgkmcnt(0)
s_barrier
v_mfma_f32_16x16x32_bf16 v[52:55], a[188:191], v[108:111], v[52:55]
ds_read_b64_tr_b16 a[212:213], v196 offset:49152
buffer_load_dwordx4 v249, s[28:31], s57 offen offset:1024  lds
v_mfma_f32_16x16x32_bf16 v[84:87], a[192:195], v[120:123], v[84:87]
ds_read_b64_tr_b16 a[216:217], v197 offset:49152
buffer_load_dwordx4 v250, s[28:31], s57 offen offset:2048  lds
v_mfma_f32_16x16x32_bf16 v[92:95], a[192:195], v[136:139], v[92:95]
ds_read_b64_tr_b16 a[214:215], v196 offset:53248
v_cvt_pk_bf16_f32 v99, v70, v71
v_mfma_f32_16x16x32_bf16 v[56:59], a[196:199], v[104:107], v[56:59]
ds_read_b64_tr_b16 a[218:219], v197 offset:53248
ds_read_b64_tr_b16 a[220:221], v198 offset:49152
v_mfma_f32_16x16x32_bf16 v[60:63], a[196:199], v[108:111], v[60:63]
ds_read_b64_tr_b16 a[222:223], v198 offset:53248
buffer_load_dwordx4 v251, s[28:31], s57 offen offset:3072  lds
v_mfma_f32_16x16x32_bf16 a[232:235], a[228:231], v[104:107], a[232:235]
ds_read_b64_tr_b16 a[224:225], v199 offset:49152
s_add_u32 m0, s56, 8192
v_mfma_f32_16x16x32_bf16 v[84:87], a[200:203], v[124:127], v[84:87]
ds_read_b64_tr_b16 a[226:227], v199 offset:53248
buffer_load_dwordx4 v252, s[28:31], s57 offen  lds
v_mfma_f32_16x16x32_bf16 v[92:95], a[200:203], v[140:143], v[92:95]
ds_read_b64_tr_b16 a[180:181], v200 offset:49152
s_add_u32 s57, s55, 0
v_mfma_f32_16x16x32_bf16 v[0:3], a[204:207], v[104:107], v[0:3]
ds_read_b64_tr_b16 a[182:183], v200 offset:53248
s_and_b32 s57, s57, 3
v_mfma_f32_16x16x32_bf16 v[4:7], a[204:207], v[108:111], v[4:7]
ds_read_b64_tr_b16 a[184:185], v201 offset:49152
s_mul_i32 s57, s57, 73728
v_mfma_f32_16x16x32_bf16 a[16:19], a[204:207], a[28:31], a[16:19]
ds_read_b64_tr_b16 a[186:187], v201 offset:53248
s_add_u32 s57, s57, s60
v_mfma_f32_16x16x32_bf16 a[236:239], a[228:231], v[108:111], a[236:239]
s_lshr_b32 s6, s39, 2
s_add_u32 s57, s57, s6
v_mfma_f32_16x16x32_bf16 v[8:11], a[208:211], v[104:107], v[8:11]
ds_read_b64_tr_b16 a[188:189], v194 offset:49152
s_add_u32 m0, s6, 147456
v_mfma_f32_16x16x32_bf16 v[12:15], a[208:211], v[108:111], v[12:15]
ds_read_b64_tr_b16 a[190:191], v194 offset:53248
s_add_u32 s57, s57, 32768
v_mfma_f32_16x16x32_bf16 a[20:23], a[208:211], a[28:31], a[20:23]
buffer_load_dwordx4 v237, s[24:27], s57 offen sc1 lds
v_exp_f32 v72, v72
v_exp_f32 v73, v73
v_exp_f32 v74, v74
v_cvt_pk_bf16_f32 v100, v72, v73
v_exp_f32 v75, v75
v_exp_f32 v76, v76
v_cvt_pk_bf16_f32 v101, v74, v75
v_exp_f32 v77, v77
v_exp_f32 v78, v78
v_cvt_pk_bf16_f32 v102, v76, v77
v_exp_f32 v79, v79
s_nop 0
v_cvt_pk_bf16_f32 v103, v78, v79
s_waitcnt lgkmcnt(8)
v_mfma_f32_16x16x32_bf16 v[16:19], a[212:215], v[96:99], v[16:19]
ds_read_b64_tr_b16 a[192:193], v195 offset:49152
s_add_u32 s58, s55, 0
v_mfma_f32_16x16x32_bf16 v[20:23], a[212:215], v[100:103], v[20:23]
ds_read_b64_tr_b16 a[194:195], v195 offset:53248
s_and_b32 s58, s58, 3
v_mfma_f32_16x16x32_bf16 v[24:27], a[216:219], v[96:99], v[24:27]
ds_read_b64_tr_b16 a[196:197], v196 offset:57344
s_mul_i32 s58, s58, 73728
v_mfma_f32_16x16x32_bf16 v[28:31], a[216:219], v[100:103], v[28:31]
ds_read_b64_tr_b16 a[198:199], v196 offset:61440
s_add_u32 s58, s58, s60
v_mfma_f32_16x16x32_bf16 v[32:35], a[220:223], v[96:99], v[32:35]
ds_read_b128 a[24:27], v203 offset:2048
s_lshl_b32 s59, s39, 1
v_mfma_f32_16x16x32_bf16 v[36:39], a[220:223], v[100:103], v[36:39]
ds_read_b64_tr_b16 a[200:201], v197 offset:57344
s_waitcnt lgkmcnt(8)
v_mfma_f32_16x16x32_bf16 v[40:43], a[224:227], v[96:99], v[40:43]
ds_read_b64_tr_b16 a[202:203], v197 offset:61440
s_add_u32 s58, s58, s59
v_mfma_f32_16x16x32_bf16 v[44:47], a[224:227], v[100:103], v[44:47]
ds_read_b64_tr_b16 a[204:205], v198 offset:57344
s_add_u32 s59, s58, 4096
v_mfma_f32_16x16x32_bf16 v[48:51], a[180:183], v[96:99], v[48:51]
ds_read_b64_tr_b16 a[206:207], v198 offset:61440
buffer_load_dwordx4 a[48:51], v237, s[24:27], s58 offen offset:0 sc1
v_mfma_f32_16x16x32_bf16 v[52:55], a[180:183], v[100:103], v[52:55]
ds_read_b64_tr_b16 a[208:209], v199 offset:57344
buffer_load_dwordx4 a[52:55], v237, s[24:27], s59 offen offset:0 sc1
v_mfma_f32_16x16x32_bf16 a[232:235], a[228:231], v[96:99], a[232:235]
ds_read_b64_tr_b16 a[210:211], v199 offset:61440
buffer_load_dwordx4 a[56:59], v237, s[24:27], s58 offen offset:1024 sc1
v_mfma_f32_16x16x32_bf16 v[56:59], a[184:187], v[96:99], v[56:59]
ds_read_b64_tr_b16 a[212:213], v200 offset:57344
buffer_load_dwordx4 a[60:63], v237, s[24:27], s59 offen offset:1024 sc1
v_mfma_f32_16x16x32_bf16 v[60:63], a[184:187], v[100:103], v[60:63]
ds_read_b64_tr_b16 a[214:215], v200 offset:61440
s_waitcnt lgkmcnt(8)
v_mfma_f32_16x16x32_bf16 v[0:3], a[188:191], v[96:99], v[0:3]
ds_read_b64_tr_b16 a[216:217], v201 offset:57344
buffer_load_dwordx4 a[64:67], v237, s[24:27], s58 offen offset:2048 sc1
v_mfma_f32_16x16x32_bf16 v[4:7], a[188:191], v[100:103], v[4:7]
ds_read_b64_tr_b16 a[218:219], v201 offset:61440
buffer_load_dwordx4 a[68:71], v237, s[24:27], s59 offen offset:2048 sc1
v_mfma_f32_16x16x32_bf16 a[16:19], a[188:191], a[24:27], a[16:19]
ds_read_b128 a[28:31], v203 offset:3072
buffer_load_dwordx4 a[72:75], v237, s[24:27], s58 offen offset:3072 sc1
v_mfma_f32_16x16x32_bf16 a[236:239], a[228:231], v[100:103], a[236:239]
v_exp_f32 v80, v80
v_mfma_f32_16x16x32_bf16 v[8:11], a[192:195], v[96:99], v[8:11]
ds_read_b64_tr_b16 a[220:221], v194 offset:57344
buffer_load_dwordx4 a[76:79], v237, s[24:27], s59 offen offset:3072 sc1
v_mfma_f32_16x16x32_bf16 v[12:15], a[192:195], v[100:103], v[12:15]
ds_read_b64_tr_b16 a[222:223], v194 offset:61440
v_exp_f32 v81, v81
v_exp_f32 v82, v82
v_cvt_pk_bf16_f32 v104, v80, v81
v_exp_f32 v83, v83
v_exp_f32 v84, v84
v_cvt_pk_bf16_f32 v105, v82, v83
v_exp_f32 v85, v85
v_exp_f32 v86, v86
v_cvt_pk_bf16_f32 v106, v84, v85
v_exp_f32 v87, v87
v_exp_f32 v88, v88
v_cvt_pk_bf16_f32 v107, v86, v87
v_exp_f32 v89, v89
v_exp_f32 v90, v90
v_cvt_pk_bf16_f32 v108, v88, v89
v_exp_f32 v91, v91
v_exp_f32 v92, v92
v_cvt_pk_bf16_f32 v109, v90, v91
v_exp_f32 v93, v93
v_exp_f32 v94, v94
v_cvt_pk_bf16_f32 v110, v92, v93
v_exp_f32 v95, v95
s_nop 0
v_cvt_pk_bf16_f32 v111, v94, v95
v_mfma_f32_16x16x32_bf16 a[20:23], a[192:195], a[24:27], a[20:23]
s_add_u32 s57, s55, 1
s_and_b32 s57, s57, 3
v_mfma_f32_16x16x32_bf16 v[16:19], a[196:199], v[104:107], v[16:19]
ds_read_b64_tr_b16 a[224:225], v195 offset:57344
v_mfma_f32_16x16x32_bf16 v[20:23], a[196:199], v[108:111], v[20:23]
ds_read_b64_tr_b16 a[226:227], v195 offset:61440
s_mul_i32 s57, s57, 294912
v_mfma_f32_16x16x32_bf16 a[232:235], a[228:231], v[104:107], a[232:235]
s_add_u32 s57, s57, s61
s_add_u32 m0, s56, 36864
v_mfma_f32_16x16x32_bf16 a[236:239], a[228:231], v[108:111], a[236:239]
buffer_load_dwordx4 v244, s[28:31], s57 offen  lds
s_waitcnt lgkmcnt(9)
v_mfma_f32_16x16x32_bf16 v[24:27], a[200:203], v[104:107], v[24:27]
buffer_load_dwordx4 v245, s[28:31], s57 offen offset:1024  lds
v_mfma_f32_16x16x32_bf16 v[28:31], a[200:203], v[108:111], v[28:31]
v_mfma_f32_16x16x32_bf16 v[32:35], a[204:207], v[104:107], v[32:35]
buffer_load_dwordx4 v246, s[28:31], s57 offen offset:2048  lds
v_mfma_f32_16x16x32_bf16 v[36:39], a[204:207], v[108:111], v[36:39]
v_mfma_f32_16x16x32_bf16 v[40:43], a[208:211], v[104:107], v[40:43]
buffer_load_dwordx4 v247, s[28:31], s57 offen offset:3072  lds
v_mfma_f32_16x16x32_bf16 v[44:47], a[208:211], v[108:111], v[44:47]
v_accvgpr_read_b32 v176, a232
s_waitcnt lgkmcnt(2)
v_mfma_f32_16x16x32_bf16 v[48:51], a[212:215], v[104:107], v[48:51]
s_add_u32 m0, s56, 40960
s_nop 0
buffer_load_dwordx4 v248, s[28:31], s57 offen  lds
v_mfma_f32_16x16x32_bf16 v[52:55], a[212:215], v[108:111], v[52:55]
buffer_load_dwordx4 v249, s[28:31], s57 offen offset:1024  lds
v_mfma_f32_16x16x32_bf16 v[56:59], a[216:219], v[104:107], v[56:59]
v_accvgpr_read_b32 v144, a236
v_rcp_f32 v180, v176
v_mfma_f32_16x16x32_bf16 v[60:63], a[216:219], v[108:111], v[60:63]
buffer_load_dwordx4 v250, s[28:31], s57 offen offset:2048  lds
v_mfma_f32_16x16x32_bf16 v[0:3], a[220:223], v[104:107], v[0:3]
v_rcp_f32 v182, v144
v_mfma_f32_16x16x32_bf16 v[4:7], a[220:223], v[108:111], v[4:7]
buffer_load_dwordx4 v251, s[28:31], s57 offen offset:3072  lds
v_mfma_f32_16x16x32_bf16 a[16:19], a[220:223], a[28:31], a[16:19]
s_waitcnt lgkmcnt(0)
v_mfma_f32_16x16x32_bf16 v[8:11], a[224:227], v[104:107], v[8:11]
s_add_u32 m0, s56, 45056
s_nop 0
buffer_load_dwordx4 v252, s[28:31], s57 offen  lds
v_mfma_f32_16x16x32_bf16 v[12:15], a[224:227], v[108:111], v[12:15]
v_mfma_f32_16x16x32_bf16 a[20:23], a[224:227], a[28:31], a[20:23]
v_mov_b32 v184, v177
s_mov_b32 s3, 0x4e800000
s_mov_b32 s7, 0x30800000
v_permlane16_swap_b32 v177, v184
v_add_f32 v177, v177, v184
v_max_f32 v145, v176, v144
v_mov_b32 v184, v177
v_cmp_nle_f32 s[66:67], s7, v176
v_cmp_nle_f32 vcc, s7, v144
v_permlane32_swap_b32 v177, v184
v_add_f32 v177, v177, v184
s_or_b64 s[66:67], vcc, s[66:67]
v_max_f32 v145, v145, v177
v_cmp_nge_f32 vcc, s3, v145
ds_write_b32 v240, v177 offset:0
s_or_b64 vcc, vcc, s[66:67]
s_cselect_b32 s3, 1, 0
v_mov_b32 v184, s3
ds_write_b32 v240, v184 offset:256
s_add_u32 s6, s38, 1
s_and_b32 s6, s6, 3
s_lshl_b32 s6, s6, 10
s_add_u32 s6, s6, s44
v_pk_mul_f32 v[16:17], v[16:17], v[180:181] op_sel_hi:[1,0]
v_pk_mul_f32 v[18:19], v[18:19], v[180:181] op_sel_hi:[1,0]
v_pk_mul_f32 v[24:25], v[24:25], v[180:181] op_sel_hi:[1,0]
v_pk_mul_f32 v[26:27], v[26:27], v[180:181] op_sel_hi:[1,0]
v_cvt_pk_bf16_f32 v72, v16, v17
v_cvt_pk_bf16_f32 v73, v18, v19
v_cvt_pk_bf16_f32 v74, v24, v25
v_cvt_pk_bf16_f32 v75, v26, v27
v_accvgpr_write_b32 a188, v72
v_accvgpr_write_b32 a189, v73
v_accvgpr_write_b32 a190, v74
v_accvgpr_write_b32 a191, v75
v_pk_mul_f32 v[20:21], v[20:21], v[182:183] op_sel_hi:[1,0]
v_pk_mul_f32 v[22:23], v[22:23], v[182:183] op_sel_hi:[1,0]
v_pk_mul_f32 v[28:29], v[28:29], v[182:183] op_sel_hi:[1,0]
v_pk_mul_f32 v[30:31], v[30:31], v[182:183] op_sel_hi:[1,0]
v_cvt_pk_bf16_f32 v76, v20, v21
v_cvt_pk_bf16_f32 v77, v22, v23
v_cvt_pk_bf16_f32 v78, v28, v29
v_cvt_pk_bf16_f32 v79, v30, v31
v_accvgpr_write_b32 a192, v76
v_accvgpr_write_b32 a193, v77
v_accvgpr_write_b32 a194, v78
v_accvgpr_write_b32 a195, v79
s_add_u32 s6, s38, 2
s_and_b32 s6, s6, 3
s_lshl_b32 s6, s6, 10
s_add_u32 s6, s6, s44
v_pk_mul_f32 v[32:33], v[32:33], v[180:181] op_sel_hi:[1,0]
v_pk_mul_f32 v[34:35], v[34:35], v[180:181] op_sel_hi:[1,0]
v_pk_mul_f32 v[40:41], v[40:41], v[180:181] op_sel_hi:[1,0]
v_pk_mul_f32 v[42:43], v[42:43], v[180:181] op_sel_hi:[1,0]
v_cvt_pk_bf16_f32 v80, v32, v33
v_cvt_pk_bf16_f32 v81, v34, v35
v_cvt_pk_bf16_f32 v82, v40, v41
v_cvt_pk_bf16_f32 v83, v42, v43
v_accvgpr_write_b32 a196, v80
v_accvgpr_write_b32 a197, v81
v_accvgpr_write_b32 a198, v82
v_accvgpr_write_b32 a199, v83
v_pk_mul_f32 v[36:37], v[36:37], v[182:183] op_sel_hi:[1,0]
v_pk_mul_f32 v[38:39], v[38:39], v[182:183] op_sel_hi:[1,0]
v_pk_mul_f32 v[44:45], v[44:45], v[182:183] op_sel_hi:[1,0]
v_pk_mul_f32 v[46:47], v[46:47], v[182:183] op_sel_hi:[1,0]
v_cvt_pk_bf16_f32 v84, v36, v37
v_cvt_pk_bf16_f32 v85, v38, v39
v_cvt_pk_bf16_f32 v86, v44, v45
v_cvt_pk_bf16_f32 v87, v46, v47
v_accvgpr_write_b32 a200, v84
v_accvgpr_write_b32 a201, v85
v_accvgpr_write_b32 a202, v86
v_accvgpr_write_b32 a203, v87
s_waitcnt lgkmcnt(0)
s_barrier
ds_read_b128 v[96:99], v241 offset:0
ds_read_b128 v[100:103], v241 offset:256
s_add_u32 s6, s38, 3
s_and_b32 s6, s6, 3
s_lshl_b32 s6, s6, 10
s_add_u32 s6, s6, s44
v_pk_mul_f32 v[48:49], v[48:49], v[180:181] op_sel_hi:[1,0]
v_pk_mul_f32 v[50:51], v[50:51], v[180:181] op_sel_hi:[1,0]
v_pk_mul_f32 v[56:57], v[56:57], v[180:181] op_sel_hi:[1,0]
v_pk_mul_f32 v[58:59], v[58:59], v[180:181] op_sel_hi:[1,0]
v_cvt_pk_bf16_f32 v88, v48, v49
v_cvt_pk_bf16_f32 v89, v50, v51
v_cvt_pk_bf16_f32 v90, v56, v57
v_cvt_pk_bf16_f32 v91, v58, v59
v_accvgpr_write_b32 a204, v88
v_accvgpr_write_b32 a205, v89
v_accvgpr_write_b32 a206, v90
v_accvgpr_write_b32 a207, v91
v_pk_mul_f32 v[52:53], v[52:53], v[182:183] op_sel_hi:[1,0]
v_pk_mul_f32 v[54:55], v[54:55], v[182:183] op_sel_hi:[1,0]
v_pk_mul_f32 v[60:61], v[60:61], v[182:183] op_sel_hi:[1,0]
v_pk_mul_f32 v[62:63], v[62:63], v[182:183] op_sel_hi:[1,0]
v_cvt_pk_bf16_f32 v92, v52, v53
v_cvt_pk_bf16_f32 v93, v54, v55
v_cvt_pk_bf16_f32 v94, v60, v61
v_cvt_pk_bf16_f32 v95, v62, v63
v_accvgpr_write_b32 a208, v92
v_accvgpr_write_b32 a209, v93
v_accvgpr_write_b32 a210, v94
v_accvgpr_write_b32 a211, v95
s_add_u32 s6, s38, 0
s_and_b32 s6, s6, 3
s_lshl_b32 s6, s6, 10
s_add_u32 s6, s6, s44
v_pk_mul_f32 v[0:1], v[0:1], v[180:181] op_sel_hi:[1,0]
v_pk_mul_f32 v[2:3], v[2:3], v[180:181] op_sel_hi:[1,0]
v_pk_mul_f32 v[8:9], v[8:9], v[180:181] op_sel_hi:[1,0]
v_pk_mul_f32 v[10:11], v[10:11], v[180:181] op_sel_hi:[1,0]
v_cvt_pk_bf16_f32 v64, v0, v1
v_cvt_pk_bf16_f32 v65, v2, v3
v_cvt_pk_bf16_f32 v66, v8, v9
v_cvt_pk_bf16_f32 v67, v10, v11
v_accvgpr_write_b32 a180, v64
v_accvgpr_write_b32 a181, v65
v_accvgpr_write_b32 a182, v66
v_accvgpr_write_b32 a183, v67
v_pk_mul_f32 v[4:5], v[4:5], v[182:183] op_sel_hi:[1,0]
v_pk_mul_f32 v[6:7], v[6:7], v[182:183] op_sel_hi:[1,0]
v_pk_mul_f32 v[12:13], v[12:13], v[182:183] op_sel_hi:[1,0]
v_pk_mul_f32 v[14:15], v[14:15], v[182:183] op_sel_hi:[1,0]
v_cvt_pk_bf16_f32 v68, v4, v5
v_cvt_pk_bf16_f32 v69, v6, v7
v_cvt_pk_bf16_f32 v70, v12, v13
v_cvt_pk_bf16_f32 v71, v14, v15
v_accvgpr_write_b32 a184, v68
v_accvgpr_write_b32 a185, v69
v_accvgpr_write_b32 a186, v70
v_accvgpr_write_b32 a187, v71
v_accvgpr_read_b32 v16, a16
v_accvgpr_read_b32 v17, a17
v_accvgpr_read_b32 v18, a18
v_accvgpr_read_b32 v19, a19
v_accvgpr_read_b32 v20, a20
v_accvgpr_read_b32 v21, a21
v_accvgpr_read_b32 v22, a22
v_accvgpr_read_b32 v23, a23
s_waitcnt lgkmcnt(1)
v_add_f32 v96, v96, v97
v_add_f32 v98, v98, v99
s_waitcnt lgkmcnt(0)
v_or_b32 v100, v100, v101
v_add_f32 v96, v96, v98
v_or3_b32 v100, v100, v102, v103
v_cmp_nle_f32 vcc, s7, v96
v_cmp_ne_u32 s[66:67], 0, v100
v_rcp_f32 v98, v96
s_lshr_b32 s6, s39, 2
s_add_u32 s6, s6, s53
s_or_b64 vcc, vcc, s[66:67]
s_cselect_b32 s3, 1, 0
s_cmp_gt_u32 s3, s54
s_cbranch_scc1 SLOW01
v_mul_f32 v16, v16, v98
v_mul_f32 v17, v17, v98
v_mul_f32 v18, v18, v98
v_mul_f32 v19, v19, v98
v_mul_f32 v20, v20, v98
v_mul_f32 v21, v21, v98
v_mul_f32 v22, v22, v98
v_mul_f32 v23, v23, v98
v_cvt_pk_bf16_f32 v16, v16, v17
v_cvt_pk_bf16_f32 v17, v18, v19
v_cvt_pk_bf16_f32 v18, v20, v21
v_cvt_pk_bf16_f32 v19, v22, v23
v_accvgpr_write_b32 a212, v16
v_accvgpr_write_b32 a213, v17
v_accvgpr_write_b32 a214, v18
v_accvgpr_write_b32 a215, v19
s_add_u32 s45, s6, 32768
s_add_u32 s41, s41, 131072
s_add_u32 s53, s53, 36864
s_add_u32 s42, s41, 4294950912
s_mov_b32 s43, s42
v_lshrrev_b32 v178, 2, v242
v_mul_u32_u24 v178, 288, v178
v_and_b32 v179, 3, v242
v_lshl_add_u32 v178, v179, 3, v178
s_lshl_b32 s6, s38, 6
v_add_u32 v178, s6, v178
v_add_u32 v73, 147456, v237
v_add_u32 v64, 0, v178
v_add_u32 v65, 32, v178
v_add_u32 v66, 64, v178
s_cmp_ge_u32 s38, 3
s_cselect_b32 s3, 4294967008, 0
s_add_u32 s3, s3, 96
v_add_u32 v67, s3, v178
s_cmp_ge_u32 s38, 3
s_cselect_b32 s3, 4294967008, 0
s_add_u32 s3, s3, 128
v_add_u32 v68, s3, v178
s_cmp_ge_u32 s38, 2
s_cselect_b32 s3, 4294967008, 0
s_add_u32 s3, s3, 160
v_add_u32 v69, s3, v178
s_cmp_ge_u32 s38, 2
s_cselect_b32 s3, 4294967008, 0
s_add_u32 s3, s3, 192
v_add_u32 v70, s3, v178
s_cmp_ge_u32 s38, 1
s_cselect_b32 s3, 4294967008, 0
s_add_u32 s3, s3, 224
v_add_u32 v71, s3, v178
s_cmp_ge_u32 s38, 1
s_cselect_b32 s3, 4294967008, 0
s_add_u32 s3, s3, 256
v_add_u32 v72, s3, v178
s_cmp_eq_u32 s38, 3
s_cselect_b64 vcc, -1, 0
s_waitcnt vmcnt(17) lgkmcnt(0)
s_barrier
s_waitcnt vmcnt(15)
ds_read_b64_tr_b16 v[0:1], v64 offset:0
ds_read_b64_tr_b16 v[2:3], v64 offset:4608
ds_read_b128 v[76:79], v73 offset:0
ds_read_b64_tr_b16 v[4:5], v65 offset:0
ds_read_b64_tr_b16 v[6:7], v65 offset:4608
ds_read_b64_tr_b16 v[8:9], v66 offset:0
ds_read_b64_tr_b16 v[10:11], v66 offset:4608
ds_read_b64_tr_b16 v[12:13], v67 offset:0
ds_read_b64_tr_b16 v[14:15], v67 offset:4608
ds_read_b64_tr_b16 v[16:17], v68 offset:0
ds_read_b64_tr_b16 v[18:19], v68 offset:4608
ds_read_b64_tr_b16 v[20:21], v69 offset:0
ds_read_b64_tr_b16 v[22:23], v69 offset:4608
ds_read_b64_tr_b16 v[24:25], v70 offset:0
ds_read_b64_tr_b16 v[26:27], v70 offset:4608
s_waitcnt lgkmcnt(10)
v_mfma_f32_16x16x32_bf16 v[96:99], v[0:3], a[48:51], 0
ds_read_b64_tr_b16 v[28:29], v71 offset:0
s_add_u32 s57, s55, 1
v_mfma_f32_16x16x32_bf16 v[100:103], v[0:3], a[52:55], 0
ds_read_b64_tr_b16 v[30:31], v71 offset:4608
s_and_b32 s57, s57, 3
v_mfma_f32_16x16x32_bf16 v[168:171], v[0:3], v[76:79], 0
s_mul_i32 s57, s57, 73728
s_add_u32 s57, s57, s60
v_mfma_f32_16x16x32_bf16 v[104:107], v[4:7], a[48:51], 0
ds_read_b64_tr_b16 v[0:1], v72 offset:0
s_lshr_b32 s6, s39, 2
v_mfma_f32_16x16x32_bf16 v[108:111], v[4:7], a[52:55], 0
ds_read_b64_tr_b16 v[2:3], v72 offset:4608
s_add_u32 s57, s57, s6
s_add_u32 m0, s6, 151552
s_add_u32 s57, s57, 32768
buffer_load_dwordx4 v237, s[24:27], s57 offen sc1 lds
v_mfma_f32_16x16x32_bf16 v[172:175], v[4:7], v[76:79], 0
s_add_u32 s58, s55, 1
s_waitcnt lgkmcnt(10)
v_mfma_f32_16x16x32_bf16 v[112:115], v[8:11], a[48:51], 0
ds_read_b64_tr_b16 v[4:5], v64 offset:9216
s_and_b32 s58, s58, 3
v_mfma_f32_16x16x32_bf16 v[116:119], v[8:11], a[52:55], 0
ds_read_b64_tr_b16 v[6:7], v64 offset:13824
s_mul_i32 s58, s58, 73728
s_add_u32 s58, s58, s60
s_lshl_b32 s59, s39, 1
s_add_u32 s58, s58, s59
s_add_u32 s59, s58, 4096
buffer_load_dwordx4 a[80:83], v237, s[24:27], s58 offen offset:0 sc1
v_mfma_f32_16x16x32_bf16 v[60:63], v[8:11], v[76:79], 0
ds_read_b128 v[80:83], v73 offset:1024
v_mfma_f32_16x16x32_bf16 v[120:123], v[12:15], a[48:51], 0
ds_read_b64_tr_b16 v[8:9], v65 offset:9216
buffer_load_dwordx4 a[84:87], v237, s[24:27], s59 offen offset:0 sc1
v_mfma_f32_16x16x32_bf16 v[124:127], v[12:15], a[52:55], 0
ds_read_b64_tr_b16 v[10:11], v65 offset:13824
s_waitcnt lgkmcnt(9)
v_mfma_f32_16x16x32_bf16 v[128:131], v[16:19], a[48:51], 0
ds_read_b64_tr_b16 v[12:13], v66 offset:9216
v_mfma_f32_16x16x32_bf16 v[132:135], v[16:19], a[52:55], 0
ds_read_b64_tr_b16 v[14:15], v66 offset:13824
buffer_load_dwordx4 a[88:91], v237, s[24:27], s58 offen offset:1024 sc1
v_mfma_f32_16x16x32_bf16 v[136:139], v[20:23], a[48:51], 0
ds_read_b64_tr_b16 v[16:17], v67 offset:9216
v_mfma_f32_16x16x32_bf16 v[140:143], v[20:23], a[52:55], 0
ds_read_b64_tr_b16 v[18:19], v67 offset:13824
v_mfma_f32_16x16x32_bf16 v[144:147], v[24:27], a[48:51], 0
ds_read_b64_tr_b16 v[20:21], v68 offset:9216
v_mfma_f32_16x16x32_bf16 v[148:151], v[24:27], a[52:55], 0
ds_read_b64_tr_b16 v[22:23], v68 offset:13824
s_waitcnt lgkmcnt(9)
v_mfma_f32_16x16x32_bf16 v[152:155], v[28:31], a[48:51], 0
ds_read_b64_tr_b16 v[24:25], v69 offset:9216
buffer_load_dwordx4 a[92:95], v237, s[24:27], s59 offen offset:1024 sc1
v_mfma_f32_16x16x32_bf16 v[156:159], v[28:31], a[52:55], 0
ds_read_b64_tr_b16 v[26:27], v69 offset:13824
v_mfma_f32_16x16x32_bf16 v[160:163], v[0:3], a[48:51], 0
ds_read_b64_tr_b16 v[28:29], v70 offset:9216
v_mfma_f32_16x16x32_bf16 v[164:167], v[0:3], a[52:55], 0
ds_read_b64_tr_b16 v[30:31], v70 offset:13824
s_waitcnt vmcnt(18)
v_mfma_f32_16x16x32_bf16 v[96:99], v[4:7], a[56:59], v[96:99]
ds_read_b64_tr_b16 v[0:1], v71 offset:9216
buffer_load_dwordx4 a[96:99], v237, s[24:27], s58 offen offset:2048 sc1
v_mfma_f32_16x16x32_bf16 v[100:103], v[4:7], a[60:63], v[100:103]
ds_read_b64_tr_b16 v[2:3], v71 offset:13824
s_waitcnt lgkmcnt(10)
v_mfma_f32_16x16x32_bf16 v[168:171], v[4:7], v[80:83], v[168:171]
buffer_load_dwordx4 a[100:103], v237, s[24:27], s59 offen offset:2048 sc1
v_mfma_f32_16x16x32_bf16 v[104:107], v[8:11], a[56:59], v[104:107]
ds_read_b64_tr_b16 v[4:5], v72 offset:9216
v_mfma_f32_16x16x32_bf16 v[108:111], v[8:11], a[60:63], v[108:111]
ds_read_b64_tr_b16 v[6:7], v72 offset:13824
v_mfma_f32_16x16x32_bf16 v[172:175], v[8:11], v[80:83], v[172:175]
v_mfma_f32_16x16x32_bf16 v[112:115], v[12:15], a[56:59], v[112:115]
ds_read_b64_tr_b16 v[8:9], v64 offset:18432
buffer_load_dwordx4 a[104:107], v237, s[24:27], s58 offen offset:3072 sc1
v_mfma_f32_16x16x32_bf16 v[116:119], v[12:15], a[60:63], v[116:119]
ds_read_b64_tr_b16 v[10:11], v64 offset:23040
v_mfma_f32_16x16x32_bf16 v[60:63], v[12:15], v[80:83], v[60:63]
ds_read_b128 v[76:79], v73 offset:2048
s_waitcnt lgkmcnt(9)
v_mfma_f32_16x16x32_bf16 v[120:123], v[16:19], a[56:59], v[120:123]
ds_read_b64_tr_b16 v[12:13], v65 offset:18432
v_mfma_f32_16x16x32_bf16 v[124:127], v[16:19], a[60:63], v[124:127]
ds_read_b64_tr_b16 v[14:15], v65 offset:23040
buffer_load_dwordx4 a[108:111], v237, s[24:27], s59 offen offset:3072 sc1
v_mfma_f32_16x16x32_bf16 v[128:131], v[20:23], a[56:59], v[128:131]
ds_read_b64_tr_b16 v[16:17], v66 offset:18432
s_add_u32 s57, s55, 2
v_mfma_f32_16x16x32_bf16 v[132:135], v[20:23], a[60:63], v[132:135]
ds_read_b64_tr_b16 v[18:19], v66 offset:23040
s_and_b32 s57, s57, 3
v_mfma_f32_16x16x32_bf16 v[136:139], v[24:27], a[56:59], v[136:139]
ds_read_b64_tr_b16 v[20:21], v67 offset:18432
s_mul_i32 s57, s57, 294912
v_mfma_f32_16x16x32_bf16 v[140:143], v[24:27], a[60:63], v[140:143]
ds_read_b64_tr_b16 v[22:23], v67 offset:23040
s_waitcnt lgkmcnt(9)
v_mfma_f32_16x16x32_bf16 v[144:147], v[28:31], a[56:59], v[144:147]
ds_read_b64_tr_b16 v[24:25], v68 offset:18432
s_add_u32 s57, s57, s61
s_add_u32 m0, s56, 73728
s_nop 0
buffer_load_dwordx4 v244, s[28:31], s57 offen  lds
v_mfma_f32_16x16x32_bf16 v[148:151], v[28:31], a[60:63], v[148:151]
ds_read_b64_tr_b16 v[26:27], v68 offset:23040
v_mfma_f32_16x16x32_bf16 v[152:155], v[0:3], a[56:59], v[152:155]
ds_read_b64_tr_b16 v[28:29], v69 offset:18432
buffer_load_dwordx4 v245, s[28:31], s57 offen offset:1024  lds
v_mfma_f32_16x16x32_bf16 v[156:159], v[0:3], a[60:63], v[156:159]
ds_read_b64_tr_b16 v[30:31], v69 offset:23040
v_mfma_f32_16x16x32_bf16 v[160:163], v[4:7], a[56:59], v[160:163]
ds_read_b64_tr_b16 v[0:1], v70 offset:18432
v_mfma_f32_16x16x32_bf16 v[164:167], v[4:7], a[60:63], v[164:167]
ds_read_b64_tr_b16 v[2:3], v70 offset:23040
s_waitcnt vmcnt(22) lgkmcnt(10)
v_mfma_f32_16x16x32_bf16 v[96:99], v[8:11], a[64:67], v[96:99]
ds_read_b64_tr_b16 v[4:5], v71 offset:18432
buffer_load_dwordx4 v246, s[28:31], s57 offen offset:2048  lds
v_mfma_f32_16x16x32_bf16 v[100:103], v[8:11], a[68:71], v[100:103]
ds_read_b64_tr_b16 v[6:7], v71 offset:23040
v_mfma_f32_16x16x32_bf16 v[168:171], v[8:11], v[76:79], v[168:171]
v_mfma_f32_16x16x32_bf16 v[104:107], v[12:15], a[64:67], v[104:107]
ds_read_b64_tr_b16 v[8:9], v72 offset:18432
buffer_load_dwordx4 v247, s[28:31], s57 offen offset:3072  lds
v_mfma_f32_16x16x32_bf16 v[108:111], v[12:15], a[68:71], v[108:111]
ds_read_b64_tr_b16 v[10:11], v72 offset:23040
v_mfma_f32_16x16x32_bf16 v[172:175], v[12:15], v[76:79], v[172:175]
s_waitcnt lgkmcnt(10)
v_mfma_f32_16x16x32_bf16 v[112:115], v[16:19], a[64:67], v[112:115]
ds_read_b64_tr_b16 v[12:13], v64 offset:27648
s_add_u32 m0, s56, 77824
v_mfma_f32_16x16x32_bf16 v[116:119], v[16:19], a[68:71], v[116:119]
ds_read_b64_tr_b16 v[14:15], v64 offset:32256
buffer_load_dwordx4 v248, s[28:31], s57 offen  lds
v_mfma_f32_16x16x32_bf16 v[60:63], v[16:19], v[76:79], v[60:63]
ds_read_b128 v[80:83], v73 offset:3072
v_mfma_f32_16x16x32_bf16 v[120:123], v[20:23], a[64:67], v[120:123]
ds_read_b64_tr_b16 v[16:17], v65 offset:27648
v_mfma_f32_16x16x32_bf16 v[124:127], v[20:23], a[68:71], v[124:127]
ds_read_b64_tr_b16 v[18:19], v65 offset:32256
s_waitcnt lgkmcnt(9)
v_mfma_f32_16x16x32_bf16 v[128:131], v[24:27], a[64:67], v[128:131]
ds_read_b64_tr_b16 v[20:21], v66 offset:27648
buffer_load_dwordx4 v249, s[28:31], s57 offen offset:1024  lds
v_mfma_f32_16x16x32_bf16 v[132:135], v[24:27], a[68:71], v[132:135]
ds_read_b64_tr_b16 v[22:23], v66 offset:32256
v_mfma_f32_16x16x32_bf16 v[136:139], v[28:31], a[64:67], v[136:139]
ds_read_b64_tr_b16 v[24:25], v67 offset:27648
v_mfma_f32_16x16x32_bf16 v[140:143], v[28:31], a[68:71], v[140:143]
ds_read_b64_tr_b16 v[26:27], v67 offset:32256
buffer_load_dwordx4 v250, s[28:31], s57 offen offset:2048  lds
v_mfma_f32_16x16x32_bf16 v[144:147], v[0:3], a[64:67], v[144:147]
ds_read_b64_tr_b16 v[28:29], v68 offset:27648
v_mfma_f32_16x16x32_bf16 v[148:151], v[0:3], a[68:71], v[148:151]
ds_read_b64_tr_b16 v[30:31], v68 offset:32256
s_waitcnt lgkmcnt(9)
v_mfma_f32_16x16x32_bf16 v[152:155], v[4:7], a[64:67], v[152:155]
ds_read_b64_tr_b16 v[0:1], v69 offset:27648
v_mfma_f32_16x16x32_bf16 v[156:159], v[4:7], a[68:71], v[156:159]
ds_read_b64_tr_b16 v[2:3], v69 offset:32256
buffer_load_dwordx4 v251, s[28:31], s57 offen offset:3072  lds
v_mfma_f32_16x16x32_bf16 v[160:163], v[8:11], a[64:67], v[160:163]
ds_read_b64_tr_b16 v[4:5], v70 offset:27648
v_mfma_f32_16x16x32_bf16 v[164:167], v[8:11], a[68:71], v[164:167]
ds_read_b64_tr_b16 v[6:7], v70 offset:32256
s_waitcnt vmcnt(26)
v_mfma_f32_16x16x32_bf16 v[96:99], v[12:15], a[72:75], v[96:99]
ds_read_b64_tr_b16 v[8:9], v71 offset:27648
s_add_u32 m0, s56, 81920
v_mfma_f32_16x16x32_bf16 v[100:103], v[12:15], a[76:79], v[100:103]
ds_read_b64_tr_b16 v[10:11], v71 offset:32256
s_waitcnt lgkmcnt(10)
v_mfma_f32_16x16x32_bf16 v[168:171], v[12:15], v[80:83], v[168:171]
buffer_load_dwordx4 v252, s[28:31], s57 offen  lds
v_mfma_f32_16x16x32_bf16 v[104:107], v[16:19], a[72:75], v[104:107]
ds_read_b64_tr_b16 v[12:13], v72 offset:27648
s_add_u32 s57, s55, 2
v_mfma_f32_16x16x32_bf16 v[108:111], v[16:19], a[76:79], v[108:111]
ds_read_b64_tr_b16 v[14:15], v72 offset:32256
s_and_b32 s57, s57, 3
v_mfma_f32_16x16x32_bf16 v[172:175], v[16:19], v[80:83], v[172:175]
s_mul_i32 s57, s57, 73728
s_add_u32 s57, s57, s60
s_lshr_b32 s6, s39, 2
s_add_u32 s57, s57, s6
s_add_u32 m0, s6, 155648
s_add_u32 s57, s57, 32768
buffer_load_dwordx4 v237, s[24:27], s57 offen sc1 lds
v_mfma_f32_16x16x32_bf16 v[112:115], v[20:23], a[72:75], v[112:115]
s_waitcnt vmcnt(18)
s_barrier
v_mfma_f32_16x16x32_bf16 v[116:119], v[20:23], a[76:79], v[116:119]
ds_read_b64_tr_b16 v[16:17], v64 offset:36864
s_add_u32 s58, s55, 2
v_mfma_f32_16x16x32_bf16 v[60:63], v[20:23], v[80:83], v[60:63]
ds_read_b64_tr_b16 v[18:19], v64 offset:41472
ds_read_b128 v[76:79], v73 offset:4096
s_waitcnt lgkmcnt(9)
v_mfma_f32_16x16x32_bf16 v[120:123], v[24:27], a[72:75], v[120:123]
ds_read_b64_tr_b16 v[20:21], v65 offset:36864
s_and_b32 s58, s58, 3
v_mfma_f32_16x16x32_bf16 v[124:127], v[24:27], a[76:79], v[124:127]
ds_read_b64_tr_b16 v[22:23], v65 offset:41472
s_mul_i32 s58, s58, 73728
s_add_u32 s58, s58, s60
s_lshl_b32 s59, s39, 1
s_add_u32 s58, s58, s59
s_add_u32 s59, s58, 4096
buffer_load_dwordx4 a[112:115], v237, s[24:27], s58 offen offset:0 sc1
v_mfma_f32_16x16x32_bf16 v[128:131], v[28:31], a[72:75], v[128:131]
ds_read_b64_tr_b16 v[24:25], v66 offset:36864
buffer_load_dwordx4 a[116:119], v237, s[24:27], s59 offen offset:0 sc1
v_mfma_f32_16x16x32_bf16 v[132:135], v[28:31], a[76:79], v[132:135]
ds_read_b64_tr_b16 v[26:27], v66 offset:41472
v_mfma_f32_16x16x32_bf16 v[136:139], v[0:3], a[72:75], v[136:139]
ds_read_b64_tr_b16 v[28:29], v67 offset:36864
v_mfma_f32_16x16x32_bf16 v[140:143], v[0:3], a[76:79], v[140:143]
ds_read_b64_tr_b16 v[30:31], v67 offset:41472
s_waitcnt lgkmcnt(9)
v_mfma_f32_16x16x32_bf16 v[144:147], v[4:7], a[72:75], v[144:147]
ds_read_b64_tr_b16 v[0:1], v68 offset:36864
buffer_load_dwordx4 a[120:123], v237, s[24:27], s58 offen offset:1024 sc1
v_mfma_f32_16x16x32_bf16 v[148:151], v[4:7], a[76:79], v[148:151]
ds_read_b64_tr_b16 v[2:3], v68 offset:41472
v_mfma_f32_16x16x32_bf16 v[152:155], v[8:11], a[72:75], v[152:155]
ds_read_b64_tr_b16 v[4:5], v69 offset:36864
v_mfma_f32_16x16x32_bf16 v[156:159], v[8:11], a[76:79], v[156:159]
ds_read_b64_tr_b16 v[6:7], v69 offset:41472
v_mfma_f32_16x16x32_bf16 v[160:163], v[12:15], a[72:75], v[160:163]
ds_read_b64_tr_b16 v[8:9], v70 offset:36864
buffer_load_dwordx4 a[124:127], v237, s[24:27], s59 offen offset:1024 sc1
v_mfma_f32_16x16x32_bf16 v[164:167], v[12:15], a[76:79], v[164:167]
ds_read_b64_tr_b16 v[10:11], v70 offset:41472
s_waitcnt vmcnt(20) lgkmcnt(10)
v_mfma_f32_16x16x32_bf16 v[96:99], v[16:19], a[80:83], v[96:99]
ds_read_b64_tr_b16 v[12:13], v71 offset:36864
v_mfma_f32_16x16x32_bf16 v[100:103], v[16:19], a[84:87], v[100:103]
ds_read_b64_tr_b16 v[14:15], v71 offset:41472
buffer_load_dwordx4 a[128:131], v237, s[24:27], s58 offen offset:2048 sc1
v_mfma_f32_16x16x32_bf16 v[168:171], v[16:19], v[76:79], v[168:171]
v_mfma_f32_16x16x32_bf16 v[104:107], v[20:23], a[80:83], v[104:107]
ds_read_b64_tr_b16 v[16:17], v72 offset:36864
v_mfma_f32_16x16x32_bf16 v[108:111], v[20:23], a[84:87], v[108:111]
ds_read_b64_tr_b16 v[18:19], v72 offset:41472
v_mfma_f32_16x16x32_bf16 v[172:175], v[20:23], v[76:79], v[172:175]
buffer_load_dwordx4 a[132:135], v237, s[24:27], s59 offen offset:2048 sc1
s_waitcnt lgkmcnt(10)
v_mfma_f32_16x16x32_bf16 v[112:115], v[24:27], a[80:83], v[112:115]
ds_read_b64_tr_b16 v[20:21], v64 offset:46080
v_mfma_f32_16x16x32_bf16 v[116:119], v[24:27], a[84:87], v[116:119]
ds_read_b64_tr_b16 v[22:23], v64 offset:50688
v_mfma_f32_16x16x32_bf16 v[60:63], v[24:27], v[76:79], v[60:63]
ds_read_b128 v[80:83], v73 offset:5120
v_mfma_f32_16x16x32_bf16 v[120:123], v[28:31], a[80:83], v[120:123]
ds_read_b64_tr_b16 v[24:25], v65 offset:46080
buffer_load_dwordx4 a[136:139], v237, s[24:27], s58 offen offset:3072 sc1
v_mfma_f32_16x16x32_bf16 v[124:127], v[28:31], a[84:87], v[124:127]
ds_read_b64_tr_b16 v[26:27], v65 offset:50688
s_waitcnt lgkmcnt(9)
v_mfma_f32_16x16x32_bf16 v[128:131], v[0:3], a[80:83], v[128:131]
ds_read_b64_tr_b16 v[28:29], v66 offset:46080
v_mfma_f32_16x16x32_bf16 v[132:135], v[0:3], a[84:87], v[132:135]
ds_read_b64_tr_b16 v[30:31], v66 offset:50688
buffer_load_dwordx4 a[140:143], v237, s[24:27], s59 offen offset:3072 sc1
v_mfma_f32_16x16x32_bf16 v[136:139], v[4:7], a[80:83], v[136:139]
ds_read_b64_tr_b16 v[0:1], v67 offset:46080
s_add_u32 s46, s38, 0
v_mfma_f32_16x16x32_bf16 v[140:143], v[4:7], a[84:87], v[140:143]
ds_read_b64_tr_b16 v[2:3], v67 offset:50688
s_and_b32 s46, s46, 3
v_mfma_f32_16x16x32_bf16 v[144:147], v[8:11], a[80:83], v[144:147]
ds_read_b64_tr_b16 v[4:5], v68 offset:46080
s_lshl_b32 s46, s46, 10
v_mfma_f32_16x16x32_bf16 v[148:151], v[8:11], a[84:87], v[148:151]
ds_read_b64_tr_b16 v[6:7], v68 offset:50688
s_waitcnt lgkmcnt(9)
v_mfma_f32_16x16x32_bf16 v[152:155], v[12:15], a[80:83], v[152:155]
ds_read_b64_tr_b16 v[8:9], v69 offset:46080
s_add_u32 s46, s46, s44
v_mfma_f32_16x16x32_bf16 v[156:159], v[12:15], a[84:87], v[156:159]
ds_read_b64_tr_b16 v[10:11], v69 offset:50688
buffer_store_dwordx4 a[180:183], v237, s[24:27], s46 offen sc1
v_mfma_f32_16x16x32_bf16 v[160:163], v[16:19], a[80:83], v[160:163]
ds_read_b64_tr_b16 v[12:13], v70 offset:46080
v_mfma_f32_16x16x32_bf16 v[164:167], v[16:19], a[84:87], v[164:167]
ds_read_b64_tr_b16 v[14:15], v70 offset:50688
s_waitcnt vmcnt(23)
v_mfma_f32_16x16x32_bf16 v[96:99], v[20:23], a[88:91], v[96:99]
ds_read_b64_tr_b16 v[16:17], v71 offset:46080
buffer_store_dwordx4 a[184:187], v238, s[24:27], s46 offen sc1
v_mfma_f32_16x16x32_bf16 v[100:103], v[20:23], a[92:95], v[100:103]
ds_read_b64_tr_b16 v[18:19], v71 offset:50688
s_waitcnt lgkmcnt(10)
v_mfma_f32_16x16x32_bf16 v[168:171], v[20:23], v[80:83], v[168:171]
s_add_u32 s46, s38, 1
s_and_b32 s46, s46, 3
v_mfma_f32_16x16x32_bf16 v[104:107], v[24:27], a[88:91], v[104:107]
ds_read_b64_tr_b16 v[20:21], v72 offset:46080
s_lshl_b32 s46, s46, 10
v_mfma_f32_16x16x32_bf16 v[108:111], v[24:27], a[92:95], v[108:111]
ds_read_b64_tr_b16 v[22:23], v72 offset:50688
s_add_u32 s46, s46, s44
buffer_store_dwordx4 a[188:191], v237, s[24:27], s46 offen sc1
v_mfma_f32_16x16x32_bf16 v[172:175], v[24:27], v[80:83], v[172:175]
v_mfma_f32_16x16x32_bf16 v[112:115], v[28:31], a[88:91], v[112:115]
ds_read_b64_tr_b16 v[24:25], v64 offset:55296
buffer_store_dwordx4 a[192:195], v238, s[24:27], s46 offen sc1
v_mfma_f32_16x16x32_bf16 v[116:119], v[28:31], a[92:95], v[116:119]
ds_read_b64_tr_b16 v[26:27], v64 offset:59904
s_add_u32 s46, s38, 2
v_mfma_f32_16x16x32_bf16 v[60:63], v[28:31], v[80:83], v[60:63]
ds_read_b128 v[76:79], v73 offset:6144
s_waitcnt lgkmcnt(9)
v_mfma_f32_16x16x32_bf16 v[120:123], v[0:3], a[88:91], v[120:123]
ds_read_b64_tr_b16 v[28:29], v65 offset:55296
s_and_b32 s46, s46, 3
v_mfma_f32_16x16x32_bf16 v[124:127], v[0:3], a[92:95], v[124:127]
ds_read_b64_tr_b16 v[30:31], v65 offset:59904
s_lshl_b32 s46, s46, 10
v_mfma_f32_16x16x32_bf16 v[128:131], v[4:7], a[88:91], v[128:131]
ds_read_b64_tr_b16 v[0:1], v66 offset:55296
s_add_u32 s46, s46, s44
buffer_store_dwordx4 a[196:199], v237, s[24:27], s46 offen sc1
v_mfma_f32_16x16x32_bf16 v[132:135], v[4:7], a[92:95], v[132:135]
ds_read_b64_tr_b16 v[2:3], v66 offset:59904
v_add_u32 v64, 64512, v64
v_mfma_f32_16x16x32_bf16 v[136:139], v[8:11], a[88:91], v[136:139]
ds_read_b64_tr_b16 v[4:5], v67 offset:55296
buffer_store_dwordx4 a[200:203], v238, s[24:27], s46 offen sc1
v_mfma_f32_16x16x32_bf16 v[140:143], v[8:11], a[92:95], v[140:143]
ds_read_b64_tr_b16 v[6:7], v67 offset:59904
s_waitcnt lgkmcnt(9)
v_mfma_f32_16x16x32_bf16 v[144:147], v[12:15], a[88:91], v[144:147]
ds_read_b64_tr_b16 v[8:9], v68 offset:55296
s_add_u32 s46, s38, 3
v_mfma_f32_16x16x32_bf16 v[148:151], v[12:15], a[92:95], v[148:151]
ds_read_b64_tr_b16 v[10:11], v68 offset:59904
s_and_b32 s46, s46, 3
v_mfma_f32_16x16x32_bf16 v[152:155], v[16:19], a[88:91], v[152:155]
ds_read_b64_tr_b16 v[12:13], v69 offset:55296
s_lshl_b32 s46, s46, 10
v_mfma_f32_16x16x32_bf16 v[156:159], v[16:19], a[92:95], v[156:159]
ds_read_b64_tr_b16 v[14:15], v69 offset:59904
s_add_u32 s46, s46, s44
v_mfma_f32_16x16x32_bf16 v[160:163], v[20:23], a[88:91], v[160:163]
ds_read_b64_tr_b16 v[16:17], v70 offset:55296
buffer_store_dwordx4 a[204:207], v237, s[24:27], s46 offen sc1
v_add_u32 v65, 64512, v65
v_mfma_f32_16x16x32_bf16 v[164:167], v[20:23], a[92:95], v[164:167]
ds_read_b64_tr_b16 v[18:19], v70 offset:59904
s_waitcnt vmcnt(27) lgkmcnt(10)
v_mfma_f32_16x16x32_bf16 v[96:99], v[24:27], a[96:99], v[96:99]
ds_read_b64_tr_b16 v[20:21], v71 offset:55296
buffer_store_dwordx4 a[208:211], v238, s[24:27], s46 offen sc1
v_add_u32 v66, 64512, v66
v_mfma_f32_16x16x32_bf16 v[100:103], v[24:27], a[100:103], v[100:103]
ds_read_b64_tr_b16 v[22:23], v71 offset:59904
v_add_u32 v67, 64512, v67
v_mfma_f32_16x16x32_bf16 v[168:171], v[24:27], v[76:79], v[168:171]
v_add_u32 v68, 64512, v68
v_add_u32 v69, 64512, v69
v_mfma_f32_16x16x32_bf16 v[104:107], v[28:31], a[96:99], v[104:107]
ds_read_b64_tr_b16 v[24:25], v72 offset:55296
buffer_store_dwordx4 a[212:215], v237, s[24:27], s45 offen sc1
v_mfma_f32_16x16x32_bf16 v[108:111], v[28:31], a[100:103], v[108:111]
ds_read_b64_tr_b16 v[26:27], v72 offset:59904
s_add_u32 s57, s55, 3
v_mfma_f32_16x16x32_bf16 v[172:175], v[28:31], v[76:79], v[172:175]
s_and_b32 s57, s57, 3
s_waitcnt lgkmcnt(10)
v_mfma_f32_16x16x32_bf16 v[112:115], v[0:3], a[96:99], v[112:115]
ds_read_b64_tr_b16 v[28:29], v64 offset:0
s_mul_i32 s57, s57, 294912
v_mfma_f32_16x16x32_bf16 v[116:119], v[0:3], a[100:103], v[116:119]
ds_read_b64_tr_b16 v[30:31], v64 offset:4608
s_add_u32 s57, s57, s61
v_mfma_f32_16x16x32_bf16 v[60:63], v[0:3], v[76:79], v[60:63]
ds_read_b128 v[80:83], v73 offset:7168
s_add_u32 m0, s56, 110592
v_add_u32 v70, 64512, v70
v_mfma_f32_16x16x32_bf16 v[120:123], v[4:7], a[96:99], v[120:123]
ds_read_b64_tr_b16 v[0:1], v65 offset:0
buffer_load_dwordx4 v244, s[28:31], s57 offen  lds
v_mfma_f32_16x16x32_bf16 v[124:127], v[4:7], a[100:103], v[124:127]
ds_read_b64_tr_b16 v[2:3], v65 offset:4608
v_add_u32 v71, 64512, v71
s_waitcnt lgkmcnt(9)
v_mfma_f32_16x16x32_bf16 v[128:131], v[8:11], a[96:99], v[128:131]
ds_read_b64_tr_b16 v[4:5], v66 offset:0
buffer_load_dwordx4 v245, s[28:31], s57 offen offset:1024  lds
v_mfma_f32_16x16x32_bf16 v[132:135], v[8:11], a[100:103], v[132:135]
ds_read_b64_tr_b16 v[6:7], v66 offset:4608
v_add_u32 v72, 64512, v72
v_mfma_f32_16x16x32_bf16 v[136:139], v[12:15], a[96:99], v[136:139]
ds_read_b64_tr_b16 v[8:9], v67 offset:0
v_mfma_f32_16x16x32_bf16 v[140:143], v[12:15], a[100:103], v[140:143]
ds_read_b64_tr_b16 v[10:11], v67 offset:4608
buffer_load_dwordx4 v246, s[28:31], s57 offen offset:2048  lds
v_mfma_f32_16x16x32_bf16 v[144:147], v[16:19], a[96:99], v[144:147]
ds_read_b64_tr_b16 v[12:13], v68 offset:0
v_mfma_f32_16x16x32_bf16 v[148:151], v[16:19], a[100:103], v[148:151]
ds_read_b64_tr_b16 v[14:15], v68 offset:4608
s_waitcnt lgkmcnt(9)
v_mfma_f32_16x16x32_bf16 v[152:155], v[20:23], a[96:99], v[152:155]
ds_read_b64_tr_b16 v[16:17], v69 offset:0
v_mfma_f32_16x16x32_bf16 v[156:159], v[20:23], a[100:103], v[156:159]
ds_read_b64_tr_b16 v[18:19], v69 offset:4608
buffer_load_dwordx4 v247, s[28:31], s57 offen offset:3072  lds
v_mfma_f32_16x16x32_bf16 v[160:163], v[24:27], a[96:99], v[160:163]
ds_read_b64_tr_b16 v[20:21], v70 offset:0
v_mfma_f32_16x16x32_bf16 v[164:167], v[24:27], a[100:103], v[164:167]
ds_read_b64_tr_b16 v[22:23], v70 offset:4608
s_waitcnt vmcnt(31)
v_mfma_f32_16x16x32_bf16 v[96:99], v[28:31], a[104:107], v[96:99]
ds_read_b64_tr_b16 v[24:25], v71 offset:0
s_add_u32 m0, s56, 114688
v_mfma_f32_16x16x32_bf16 v[100:103], v[28:31], a[108:111], v[100:103]
ds_read_b64_tr_b16 v[26:27], v71 offset:4608
s_waitcnt lgkmcnt(10)
v_mfma_f32_16x16x32_bf16 v[168:171], v[28:31], v[80:83], v[168:171]
buffer_load_dwordx4 v248, s[28:31], s57 offen  lds
v_mfma_f32_16x16x32_bf16 v[104:107], v[0:3], a[104:107], v[104:107]
ds_read_b64_tr_b16 v[28:29], v72 offset:0
v_mfma_f32_16x16x32_bf16 v[108:111], v[0:3], a[108:111], v[108:111]
ds_read_b64_tr_b16 v[30:31], v72 offset:4608
buffer_load_dwordx4 v249, s[28:31], s57 offen offset:1024  lds
v_mfma_f32_16x16x32_bf16 v[172:175], v[0:3], v[80:83], v[172:175]
v_mfma_f32_16x16x32_bf16 v[112:115], v[4:7], a[104:107], v[112:115]
s_waitcnt vmcnt(23)
s_barrier
v_mfma_f32_16x16x32_bf16 v[116:119], v[4:7], a[108:111], v[116:119]
ds_read_b64_tr_b16 v[0:1], v64 offset:9216
v_mfma_f32_16x16x32_bf16 v[60:63], v[4:7], v[80:83], v[60:63]
ds_read_b64_tr_b16 v[2:3], v64 offset:13824
ds_read_b128 v[76:79], v73 offset:8192
s_waitcnt lgkmcnt(9)
v_mfma_f32_16x16x32_bf16 v[120:123], v[8:11], a[104:107], v[120:123]
ds_read_b64_tr_b16 v[4:5], v65 offset:9216
buffer_load_dwordx4 v250, s[28:31], s57 offen offset:2048  lds
v_mfma_f32_16x16x32_bf16 v[124:127], v[8:11], a[108:111], v[124:127]
ds_read_b64_tr_b16 v[6:7], v65 offset:13824
v_mfma_f32_16x16x32_bf16 v[128:131], v[12:15], a[104:107], v[128:131]
ds_read_b64_tr_b16 v[8:9], v66 offset:9216
buffer_load_dwordx4 v251, s[28:31], s57 offen offset:3072  lds
v_mfma_f32_16x16x32_bf16 v[132:135], v[12:15], a[108:111], v[132:135]
ds_read_b64_tr_b16 v[10:11], v66 offset:13824
v_mfma_f32_16x16x32_bf16 v[136:139], v[16:19], a[104:107], v[136:139]
ds_read_b64_tr_b16 v[12:13], v67 offset:9216
v_mfma_f32_16x16x32_bf16 v[140:143], v[16:19], a[108:111], v[140:143]
ds_read_b64_tr_b16 v[14:15], v67 offset:13824
s_waitcnt lgkmcnt(9)
v_mfma_f32_16x16x32_bf16 v[144:147], v[20:23], a[104:107], v[144:147]
ds_read_b64_tr_b16 v[16:17], v68 offset:9216
s_add_u32 m0, s56, 118784
v_mfma_f32_16x16x32_bf16 v[148:151], v[20:23], a[108:111], v[148:151]
ds_read_b64_tr_b16 v[18:19], v68 offset:13824
buffer_load_dwordx4 v252, s[28:31], s57 offen  lds
v_mfma_f32_16x16x32_bf16 v[152:155], v[24:27], a[104:107], v[152:155]
ds_read_b64_tr_b16 v[20:21], v69 offset:9216
v_mfma_f32_16x16x32_bf16 v[156:159], v[24:27], a[108:111], v[156:159]
ds_read_b64_tr_b16 v[22:23], v69 offset:13824
v_mfma_f32_16x16x32_bf16 v[160:163], v[28:31], a[104:107], v[160:163]
ds_read_b64_tr_b16 v[24:25], v70 offset:9216
v_mfma_f32_16x16x32_bf16 v[164:167], v[28:31], a[108:111], v[164:167]
ds_read_b64_tr_b16 v[26:27], v70 offset:13824
s_waitcnt vmcnt(24) lgkmcnt(10)
v_mfma_f32_16x16x32_bf16 v[96:99], v[0:3], a[112:115], v[96:99]
ds_read_b64_tr_b16 v[28:29], v71 offset:9216
s_add_u32 s58, s55, 3
v_mfma_f32_16x16x32_bf16 v[100:103], v[0:3], a[116:119], v[100:103]
ds_read_b64_tr_b16 v[30:31], v71 offset:13824
s_and_b32 s58, s58, 3
v_mfma_f32_16x16x32_bf16 v[168:171], v[0:3], v[76:79], v[168:171]
s_mul_i32 s58, s58, 73728
s_add_u32 s58, s58, s60
v_mfma_f32_16x16x32_bf16 v[104:107], v[4:7], a[112:115], v[104:107]
ds_read_b64_tr_b16 v[0:1], v72 offset:9216
s_lshl_b32 s59, s39, 1
v_mfma_f32_16x16x32_bf16 v[108:111], v[4:7], a[116:119], v[108:111]
ds_read_b64_tr_b16 v[2:3], v72 offset:13824
s_add_u32 s58, s58, s59
v_mfma_f32_16x16x32_bf16 v[172:175], v[4:7], v[76:79], v[172:175]
s_add_u32 s57, s55, 3
s_waitcnt lgkmcnt(10)
v_mfma_f32_16x16x32_bf16 v[112:115], v[8:11], a[112:115], v[112:115]
ds_read_b64_tr_b16 v[4:5], v64 offset:18432
s_and_b32 s57, s57, 3
v_mfma_f32_16x16x32_bf16 v[116:119], v[8:11], a[116:119], v[116:119]
ds_read_b64_tr_b16 v[6:7], v64 offset:23040
s_mul_i32 s57, s57, 73728
s_waitcnt vmcnt(9)
s_lshl_b32 s66, s50, 2
s_add_u32 s66, s66, s38
s_lshl_b32 s66, s66, 2
s_add_u32 s66, s66, s62
v_mov_b32 v185, 2
s_mov_b64 exec, 1
buffer_store_dword v185, v243, s[24:27], s66 offen sc1
s_mov_b64 exec, -1
s_add_u32 s59, s58, 4096
v_mfma_f32_16x16x32_bf16 v[60:63], v[8:11], v[76:79], v[60:63]
ds_read_b128 v[80:83], v73 offset:9216
s_add_u32 s57, s57, s60
buffer_load_dwordx4 a[48:51], v237, s[24:27], s58 offen offset:0 sc1
s_lshr_b32 s6, s39, 2
s_add_u32 s57, s57, s6
s_add_u32 m0, s6, 159744
s_add_u32 s57, s57, 32768
buffer_load_dwordx4 v237, s[24:27], s57 offen sc1 lds
v_mfma_f32_16x16x32_bf16 v[120:123], v[12:15], a[112:115], v[120:123]
ds_read_b64_tr_b16 v[8:9], v65 offset:18432
v_mfma_f32_16x16x32_bf16 v[124:127], v[12:15], a[116:119], v[124:127]
ds_read_b64_tr_b16 v[10:11], v65 offset:23040
s_waitcnt lgkmcnt(9)
v_mfma_f32_16x16x32_bf16 v[128:131], v[16:19], a[112:115], v[128:131]
ds_read_b64_tr_b16 v[12:13], v66 offset:18432
s_add_u32 s57, s50, 0
v_mfma_f32_16x16x32_bf16 v[132:135], v[16:19], a[116:119], v[132:135]
ds_read_b64_tr_b16 v[14:15], v66 offset:23040
buffer_load_dwordx4 a[52:55], v237, s[24:27], s59 offen offset:0 sc1
v_mfma_f32_16x16x32_bf16 v[136:139], v[20:23], a[112:115], v[136:139]
ds_read_b64_tr_b16 v[16:17], v67 offset:18432
s_and_b32 s57, s57, 3
v_mfma_f32_16x16x32_bf16 v[140:143], v[20:23], a[116:119], v[140:143]
ds_read_b64_tr_b16 v[18:19], v67 offset:23040
s_mul_i32 s57, s57, 294912
v_mfma_f32_16x16x32_bf16 v[144:147], v[24:27], a[112:115], v[144:147]
ds_read_b64_tr_b16 v[20:21], v68 offset:18432
s_add_u32 s57, s57, s61
v_mfma_f32_16x16x32_bf16 v[148:151], v[24:27], a[116:119], v[148:151]
ds_read_b64_tr_b16 v[22:23], v68 offset:23040
s_waitcnt lgkmcnt(9)
v_mfma_f32_16x16x32_bf16 v[152:155], v[28:31], a[112:115], v[152:155]
ds_read_b64_tr_b16 v[24:25], v69 offset:18432
s_add_u32 s57, s57, 147456
v_mfma_f32_16x16x32_bf16 v[156:159], v[28:31], a[116:119], v[156:159]
ds_read_b64_tr_b16 v[26:27], v69 offset:23040
s_add_u32 m0, s56, 0
s_nop 0
buffer_load_dwordx4 v244, s[28:31], s57 offen  lds
v_mfma_f32_16x16x32_bf16 v[160:163], v[0:3], a[112:115], v[160:163]
ds_read_b64_tr_b16 v[28:29], v70 offset:18432
v_mfma_f32_16x16x32_bf16 v[164:167], v[0:3], a[116:119], v[164:167]
ds_read_b64_tr_b16 v[30:31], v70 offset:23040
v_mfma_f32_16x16x32_bf16 v[96:99], v[4:7], a[120:123], v[96:99]
ds_read_b64_tr_b16 v[0:1], v71 offset:18432
v_mfma_f32_16x16x32_bf16 v[100:103], v[4:7], a[124:127], v[100:103]
ds_read_b64_tr_b16 v[2:3], v71 offset:23040
s_waitcnt lgkmcnt(10)
v_mfma_f32_16x16x32_bf16 v[168:171], v[4:7], v[80:83], v[168:171]
buffer_load_dwordx4 a[56:59], v237, s[24:27], s58 offen offset:1024 sc1
v_mfma_f32_16x16x32_bf16 v[104:107], v[8:11], a[120:123], v[104:107]
ds_read_b64_tr_b16 v[4:5], v72 offset:18432
v_mfma_f32_16x16x32_bf16 v[108:111], v[8:11], a[124:127], v[108:111]
ds_read_b64_tr_b16 v[6:7], v72 offset:23040
buffer_load_dwordx4 v245, s[28:31], s57 offen offset:1024  lds
v_mfma_f32_16x16x32_bf16 v[172:175], v[8:11], v[80:83], v[172:175]
v_mfma_f32_16x16x32_bf16 v[112:115], v[12:15], a[120:123], v[112:115]
ds_read_b64_tr_b16 v[8:9], v64 offset:27648
v_mfma_f32_16x16x32_bf16 v[116:119], v[12:15], a[124:127], v[116:119]
ds_read_b64_tr_b16 v[10:11], v64 offset:32256
v_mfma_f32_16x16x32_bf16 v[60:63], v[12:15], v[80:83], v[60:63]
ds_read_b128 v[76:79], v73 offset:10240
s_waitcnt lgkmcnt(9)
v_mfma_f32_16x16x32_bf16 v[120:123], v[16:19], a[120:123], v[120:123]
ds_read_b64_tr_b16 v[12:13], v65 offset:27648
buffer_load_dwordx4 a[60:63], v237, s[24:27], s59 offen offset:1024 sc1
v_mfma_f32_16x16x32_bf16 v[124:127], v[16:19], a[124:127], v[124:127]
ds_read_b64_tr_b16 v[14:15], v65 offset:32256
v_mfma_f32_16x16x32_bf16 v[128:131], v[20:23], a[120:123], v[128:131]
ds_read_b64_tr_b16 v[16:17], v66 offset:27648
v_mfma_f32_16x16x32_bf16 v[132:135], v[20:23], a[124:127], v[132:135]
ds_read_b64_tr_b16 v[18:19], v66 offset:32256
v_mfma_f32_16x16x32_bf16 v[136:139], v[24:27], a[120:123], v[136:139]
ds_read_b64_tr_b16 v[20:21], v67 offset:27648
buffer_load_dwordx4 v246, s[28:31], s57 offen offset:2048  lds
v_mfma_f32_16x16x32_bf16 v[140:143], v[24:27], a[124:127], v[140:143]
ds_read_b64_tr_b16 v[22:23], v67 offset:32256
s_waitcnt lgkmcnt(9)
v_mfma_f32_16x16x32_bf16 v[144:147], v[28:31], a[120:123], v[144:147]
ds_read_b64_tr_b16 v[24:25], v68 offset:27648
v_mfma_f32_16x16x32_bf16 v[148:151], v[28:31], a[124:127], v[148:151]
ds_read_b64_tr_b16 v[26:27], v68 offset:32256
v_mfma_f32_16x16x32_bf16 v[152:155], v[0:3], a[120:123], v[152:155]
ds_read_b64_tr_b16 v[28:29], v69 offset:27648
v_mfma_f32_16x16x32_bf16 v[156:159], v[0:3], a[124:127], v[156:159]
ds_read_b64_tr_b16 v[30:31], v69 offset:32256
buffer_load_dwordx4 v247, s[28:31], s57 offen offset:3072  lds
v_mfma_f32_16x16x32_bf16 v[160:163], v[4:7], a[120:123], v[160:163]
ds_read_b64_tr_b16 v[0:1], v70 offset:27648
v_mfma_f32_16x16x32_bf16 v[164:167], v[4:7], a[124:127], v[164:167]
ds_read_b64_tr_b16 v[2:3], v70 offset:32256
s_waitcnt lgkmcnt(10)
v_mfma_f32_16x16x32_bf16 v[96:99], v[8:11], a[128:131], v[96:99]
ds_read_b64_tr_b16 v[4:5], v71 offset:27648
v_mfma_f32_16x16x32_bf16 v[100:103], v[8:11], a[132:135], v[100:103]
ds_read_b64_tr_b16 v[6:7], v71 offset:32256
v_mfma_f32_16x16x32_bf16 v[168:171], v[8:11], v[76:79], v[168:171]
buffer_load_dwordx4 a[64:67], v237, s[24:27], s58 offen offset:2048 sc1
v_mfma_f32_16x16x32_bf16 v[104:107], v[12:15], a[128:131], v[104:107]
ds_read_b64_tr_b16 v[8:9], v72 offset:27648
v_mfma_f32_16x16x32_bf16 v[108:111], v[12:15], a[132:135], v[108:111]
ds_read_b64_tr_b16 v[10:11], v72 offset:32256
v_mfma_f32_16x16x32_bf16 v[172:175], v[12:15], v[76:79], v[172:175]
s_add_u32 m0, s56, 4096
s_waitcnt lgkmcnt(10)
v_mfma_f32_16x16x32_bf16 v[112:115], v[16:19], a[128:131], v[112:115]
ds_read_b64_tr_b16 v[12:13], v64 offset:36864
buffer_load_dwordx4 v248, s[28:31], s57 offen  lds
v_mfma_f32_16x16x32_bf16 v[116:119], v[16:19], a[132:135], v[116:119]
ds_read_b64_tr_b16 v[14:15], v64 offset:41472
v_mfma_f32_16x16x32_bf16 v[60:63], v[16:19], v[76:79], v[60:63]
ds_read_b128 v[80:83], v73 offset:11264
v_mfma_f32_16x16x32_bf16 v[120:123], v[20:23], a[128:131], v[120:123]
ds_read_b64_tr_b16 v[16:17], v65 offset:36864
v_mfma_f32_16x16x32_bf16 v[124:127], v[20:23], a[132:135], v[124:127]
ds_read_b64_tr_b16 v[18:19], v65 offset:41472
s_waitcnt lgkmcnt(9)
v_mfma_f32_16x16x32_bf16 v[128:131], v[24:27], a[128:131], v[128:131]
ds_read_b64_tr_b16 v[20:21], v66 offset:36864
buffer_load_dwordx4 a[68:71], v237, s[24:27], s59 offen offset:2048 sc1
v_mfma_f32_16x16x32_bf16 v[132:135], v[24:27], a[132:135], v[132:135]
ds_read_b64_tr_b16 v[22:23], v66 offset:41472
v_mfma_f32_16x16x32_bf16 v[136:139], v[28:31], a[128:131], v[136:139]
ds_read_b64_tr_b16 v[24:25], v67 offset:36864
v_mfma_f32_16x16x32_bf16 v[140:143], v[28:31], a[132:135], v[140:143]
ds_read_b64_tr_b16 v[26:27], v67 offset:41472
v_mfma_f32_16x16x32_bf16 v[144:147], v[0:3], a[128:131], v[144:147]
ds_read_b64_tr_b16 v[28:29], v68 offset:36864
v_mfma_f32_16x16x32_bf16 v[148:151], v[0:3], a[132:135], v[148:151]
ds_read_b64_tr_b16 v[30:31], v68 offset:41472
s_waitcnt lgkmcnt(9)
v_mfma_f32_16x16x32_bf16 v[152:155], v[4:7], a[128:131], v[152:155]
ds_read_b64_tr_b16 v[0:1], v69 offset:36864
buffer_load_dwordx4 v249, s[28:31], s57 offen offset:1024  lds
v_mfma_f32_16x16x32_bf16 v[156:159], v[4:7], a[132:135], v[156:159]
ds_read_b64_tr_b16 v[2:3], v69 offset:41472
v_mfma_f32_16x16x32_bf16 v[160:163], v[8:11], a[128:131], v[160:163]
ds_read_b64_tr_b16 v[4:5], v70 offset:36864
v_mfma_f32_16x16x32_bf16 v[164:167], v[8:11], a[132:135], v[164:167]
ds_read_b64_tr_b16 v[6:7], v70 offset:41472
v_mfma_f32_16x16x32_bf16 v[96:99], v[12:15], a[136:139], v[96:99]
ds_read_b64_tr_b16 v[8:9], v71 offset:36864
v_mfma_f32_16x16x32_bf16 v[100:103], v[12:15], a[140:143], v[100:103]
ds_read_b64_tr_b16 v[10:11], v71 offset:41472
s_waitcnt lgkmcnt(10)
v_mfma_f32_16x16x32_bf16 v[168:171], v[12:15], v[80:83], v[168:171]
buffer_load_dwordx4 a[72:75], v237, s[24:27], s58 offen offset:3072 sc1
v_mfma_f32_16x16x32_bf16 v[104:107], v[16:19], a[136:139], v[104:107]
ds_read_b64_tr_b16 v[12:13], v72 offset:36864
v_mfma_f32_16x16x32_bf16 v[108:111], v[16:19], a[140:143], v[108:111]
ds_read_b64_tr_b16 v[14:15], v72 offset:41472
buffer_load_dwordx4 v250, s[28:31], s57 offen offset:2048  lds
v_mfma_f32_16x16x32_bf16 v[172:175], v[16:19], v[80:83], v[172:175]
v_mfma_f32_16x16x32_bf16 v[112:115], v[20:23], a[136:139], v[112:115]
s_waitcnt vmcnt(13)
s_barrier
v_mfma_f32_16x16x32_bf16 v[116:119], v[20:23], a[140:143], v[116:119]
ds_read_b64_tr_b16 v[16:17], v64 offset:46080
v_mfma_f32_16x16x32_bf16 v[60:63], v[20:23], v[80:83], v[60:63]
ds_read_b64_tr_b16 v[18:19], v64 offset:50688
ds_read_b128 v[76:79], v73 offset:12288
s_waitcnt lgkmcnt(9)
v_mfma_f32_16x16x32_bf16 v[120:123], v[24:27], a[136:139], v[120:123]
ds_read_b64_tr_b16 v[20:21], v65 offset:46080
buffer_load_dwordx4 a[76:79], v237, s[24:27], s59 offen offset:3072 sc1
v_mfma_f32_16x16x32_bf16 v[124:127], v[24:27], a[140:143], v[124:127]
ds_read_b64_tr_b16 v[22:23], v65 offset:50688
v_mfma_f32_16x16x32_bf16 v[128:131], v[28:31], a[136:139], v[128:131]
ds_read_b64_tr_b16 v[24:25], v66 offset:46080
v_mfma_f32_16x16x32_bf16 v[132:135], v[28:31], a[140:143], v[132:135]
ds_read_b64_tr_b16 v[26:27], v66 offset:50688
v_mfma_f32_16x16x32_bf16 v[136:139], v[0:3], a[136:139], v[136:139]
ds_read_b64_tr_b16 v[28:29], v67 offset:46080
buffer_load_dwordx4 v251, s[28:31], s57 offen offset:3072  lds
v_mfma_f32_16x16x32_bf16 v[140:143], v[0:3], a[140:143], v[140:143]
ds_read_b64_tr_b16 v[30:31], v67 offset:50688
s_waitcnt lgkmcnt(9)
v_mfma_f32_16x16x32_bf16 v[144:147], v[4:7], a[136:139], v[144:147]
ds_read_b64_tr_b16 v[0:1], v68 offset:46080
v_mfma_f32_16x16x32_bf16 v[148:151], v[4:7], a[140:143], v[148:151]
ds_read_b64_tr_b16 v[2:3], v68 offset:50688
v_mfma_f32_16x16x32_bf16 v[152:155], v[8:11], a[136:139], v[152:155]
ds_read_b64_tr_b16 v[4:5], v69 offset:46080
s_add_u32 m0, s56, 8192
v_mfma_f32_16x16x32_bf16 v[156:159], v[8:11], a[140:143], v[156:159]
ds_read_b64_tr_b16 v[6:7], v69 offset:50688
buffer_load_dwordx4 v252, s[28:31], s57 offen  lds
v_mfma_f32_16x16x32_bf16 v[160:163], v[12:15], a[136:139], v[160:163]
ds_read_b64_tr_b16 v[8:9], v70 offset:46080
v_mfma_f32_16x16x32_bf16 v[164:167], v[12:15], a[140:143], v[164:167]
ds_read_b64_tr_b16 v[10:11], v70 offset:50688
s_waitcnt vmcnt(15) lgkmcnt(10)
v_mfma_f32_16x16x32_bf16 v[96:99], v[16:19], a[48:51], v[96:99]
ds_read_b64_tr_b16 v[12:13], v71 offset:46080
s_add_u32 s58, s50, 0
v_mfma_f32_16x16x32_bf16 v[100:103], v[16:19], a[52:55], v[100:103]
ds_read_b64_tr_b16 v[14:15], v71 offset:50688
s_and_b32 s58, s58, 3
v_mfma_f32_16x16x32_bf16 v[168:171], v[16:19], v[76:79], v[168:171]
s_mul_i32 s58, s58, 73728
s_add_u32 s58, s58, s60
v_mfma_f32_16x16x32_bf16 v[104:107], v[20:23], a[48:51], v[104:107]
ds_read_b64_tr_b16 v[16:17], v72 offset:46080
s_add_u32 s58, s58, 36864
v_mfma_f32_16x16x32_bf16 v[108:111], v[20:23], a[52:55], v[108:111]
ds_read_b64_tr_b16 v[18:19], v72 offset:50688
s_lshl_b32 s59, s39, 1
s_add_u32 s58, s58, s59
s_add_u32 s59, s58, 4096
buffer_load_dwordx4 a[80:83], v237, s[24:27], s58 offen offset:0 sc1
v_mfma_f32_16x16x32_bf16 v[172:175], v[20:23], v[76:79], v[172:175]
s_add_u32 s57, s50, 0
s_waitcnt lgkmcnt(10)
v_mfma_f32_16x16x32_bf16 v[112:115], v[24:27], a[48:51], v[112:115]
ds_read_b64_tr_b16 v[20:21], v64 offset:55296
s_and_b32 s57, s57, 3
v_mfma_f32_16x16x32_bf16 v[116:119], v[24:27], a[52:55], v[116:119]
ds_read_b64_tr_b16 v[22:23], v64 offset:59904
s_mul_i32 s57, s57, 73728
v_mfma_f32_16x16x32_bf16 v[60:63], v[24:27], v[76:79], v[60:63]
ds_read_b128 v[80:83], v73 offset:13312
s_add_u32 s57, s57, s60
s_add_u32 s57, s57, 36864
s_lshr_b32 s6, s39, 2
s_add_u32 s57, s57, s6
s_add_u32 m0, s6, 147456
s_add_u32 s57, s57, 32768
buffer_load_dwordx4 v237, s[24:27], s57 offen sc1 lds
v_mfma_f32_16x16x32_bf16 v[120:123], v[28:31], a[48:51], v[120:123]
ds_read_b64_tr_b16 v[24:25], v65 offset:55296
v_add_u32 v64, 64512, v64
v_mfma_f32_16x16x32_bf16 v[124:127], v[28:31], a[52:55], v[124:127]
ds_read_b64_tr_b16 v[26:27], v65 offset:59904
s_waitcnt lgkmcnt(9)
v_mfma_f32_16x16x32_bf16 v[128:131], v[0:3], a[48:51], v[128:131]
ds_read_b64_tr_b16 v[28:29], v66 offset:55296
buffer_load_dwordx4 a[84:87], v237, s[24:27], s59 offen offset:0 sc1
v_mfma_f32_16x16x32_bf16 v[132:135], v[0:3], a[52:55], v[132:135]
ds_read_b64_tr_b16 v[30:31], v66 offset:59904
s_add_u32 s57, s50, 1
v_mfma_f32_16x16x32_bf16 v[136:139], v[4:7], a[48:51], v[136:139]
ds_read_b64_tr_b16 v[0:1], v67 offset:55296
s_and_b32 s57, s57, 3
v_mfma_f32_16x16x32_bf16 v[140:143], v[4:7], a[52:55], v[140:143]
ds_read_b64_tr_b16 v[2:3], v67 offset:59904
s_mul_i32 s57, s57, 294912
v_mfma_f32_16x16x32_bf16 v[144:147], v[8:11], a[48:51], v[144:147]
ds_read_b64_tr_b16 v[4:5], v68 offset:55296
s_add_u32 s57, s57, s61
v_mfma_f32_16x16x32_bf16 v[148:151], v[8:11], a[52:55], v[148:151]
ds_read_b64_tr_b16 v[6:7], v68 offset:59904
s_waitcnt lgkmcnt(9)
v_mfma_f32_16x16x32_bf16 v[152:155], v[12:15], a[48:51], v[152:155]
ds_read_b64_tr_b16 v[8:9], v69 offset:55296
s_add_u32 s57, s57, 147456
s_add_u32 m0, s56, 36864
s_nop 0
buffer_load_dwordx4 v244, s[28:31], s57 offen  lds
v_mfma_f32_16x16x32_bf16 v[156:159], v[12:15], a[52:55], v[156:159]
ds_read_b64_tr_b16 v[10:11], v69 offset:59904
v_add_u32 v65, 64512, v65
v_mfma_f32_16x16x32_bf16 v[160:163], v[16:19], a[48:51], v[160:163]
ds_read_b64_tr_b16 v[12:13], v70 offset:55296
v_add_u32 v66, 64512, v66
v_mfma_f32_16x16x32_bf16 v[164:167], v[16:19], a[52:55], v[164:167]
ds_read_b64_tr_b16 v[14:15], v70 offset:59904
s_waitcnt vmcnt(15)
v_mfma_f32_16x16x32_bf16 v[96:99], v[20:23], a[56:59], v[96:99]
ds_read_b64_tr_b16 v[16:17], v71 offset:55296
v_add_u32 v67, 64512, v67
v_mfma_f32_16x16x32_bf16 v[100:103], v[20:23], a[60:63], v[100:103]
ds_read_b64_tr_b16 v[18:19], v71 offset:59904
s_waitcnt lgkmcnt(10)
v_mfma_f32_16x16x32_bf16 v[168:171], v[20:23], v[80:83], v[168:171]
s_cmp_lg_u32 s38, 0
s_cbranch_scc1 FL6
buffer_load_dword v180, v206, s[24:27], s62 offen sc1
FL6:
v_mfma_f32_16x16x32_bf16 v[104:107], v[24:27], a[56:59], v[104:107]
ds_read_b64_tr_b16 v[20:21], v72 offset:55296
buffer_load_dwordx4 v245, s[28:31], s57 offen offset:1024  lds
v_mfma_f32_16x16x32_bf16 v[108:111], v[24:27], a[60:63], v[108:111]
ds_read_b64_tr_b16 v[22:23], v72 offset:59904
v_add_u32 v68, 64512, v68
v_mfma_f32_16x16x32_bf16 v[172:175], v[24:27], v[80:83], v[172:175]
v_add_u32 v69, 64512, v69
v_add_u32 v70, 64512, v70
v_mfma_f32_16x16x32_bf16 v[112:115], v[28:31], a[56:59], v[112:115]
ds_read_b64_tr_b16 v[24:25], v64 offset:0
v_add_u32 v71, 64512, v71
v_mfma_f32_16x16x32_bf16 v[116:119], v[28:31], a[60:63], v[116:119]
ds_read_b64_tr_b16 v[26:27], v64 offset:4608
buffer_load_dwordx4 a[88:91], v237, s[24:27], s58 offen offset:1024 sc1
v_mfma_f32_16x16x32_bf16 v[60:63], v[28:31], v[80:83], v[60:63]
ds_read_b128 v[76:79], v73 offset:14336
s_waitcnt lgkmcnt(9)
v_mfma_f32_16x16x32_bf16 v[120:123], v[0:3], a[56:59], v[120:123]
ds_read_b64_tr_b16 v[28:29], v65 offset:0
v_add_u32 v72, 64512, v72
v_mfma_f32_16x16x32_bf16 v[124:127], v[0:3], a[60:63], v[124:127]
ds_read_b64_tr_b16 v[30:31], v65 offset:4608
v_mfma_f32_16x16x32_bf16 v[128:131], v[4:7], a[56:59], v[128:131]
ds_read_b64_tr_b16 v[0:1], v66 offset:0
buffer_load_dwordx4 v246, s[28:31], s57 offen offset:2048  lds
v_mfma_f32_16x16x32_bf16 v[132:135], v[4:7], a[60:63], v[132:135]
ds_read_b64_tr_b16 v[2:3], v66 offset:4608
v_mfma_f32_16x16x32_bf16 v[136:139], v[8:11], a[56:59], v[136:139]
ds_read_b64_tr_b16 v[4:5], v67 offset:0
v_mfma_f32_16x16x32_bf16 v[140:143], v[8:11], a[60:63], v[140:143]
ds_read_b64_tr_b16 v[6:7], v67 offset:4608
s_waitcnt lgkmcnt(9)
v_mfma_f32_16x16x32_bf16 v[144:147], v[12:15], a[56:59], v[144:147]
ds_read_b64_tr_b16 v[8:9], v68 offset:0
v_mfma_f32_16x16x32_bf16 v[148:151], v[12:15], a[60:63], v[148:151]
ds_read_b64_tr_b16 v[10:11], v68 offset:4608
buffer_load_dwordx4 a[92:95], v237, s[24:27], s59 offen offset:1024 sc1
v_mfma_f32_16x16x32_bf16 v[152:155], v[16:19], a[56:59], v[152:155]
ds_read_b64_tr_b16 v[12:13], v69 offset:0
v_mfma_f32_16x16x32_bf16 v[156:159], v[16:19], a[60:63], v[156:159]
ds_read_b64_tr_b16 v[14:15], v69 offset:4608
v_mfma_f32_16x16x32_bf16 v[160:163], v[20:23], a[56:59], v[160:163]
ds_read_b64_tr_b16 v[16:17], v70 offset:0
v_mfma_f32_16x16x32_bf16 v[164:167], v[20:23], a[60:63], v[164:167]
ds_read_b64_tr_b16 v[18:19], v70 offset:4608
s_waitcnt vmcnt(14) lgkmcnt(10)
v_mfma_f32_16x16x32_bf16 v[96:99], v[24:27], a[64:67], v[96:99]
ds_read_b64_tr_b16 v[20:21], v71 offset:0
buffer_load_dwordx4 v247, s[28:31], s57 offen offset:3072  lds
v_mfma_f32_16x16x32_bf16 v[100:103], v[24:27], a[68:71], v[100:103]
ds_read_b64_tr_b16 v[22:23], v71 offset:4608
v_mfma_f32_16x16x32_bf16 v[168:171], v[24:27], v[76:79], v[168:171]
v_mfma_f32_16x16x32_bf16 v[104:107], v[28:31], a[64:67], v[104:107]
ds_read_b64_tr_b16 v[24:25], v72 offset:0
v_mfma_f32_16x16x32_bf16 v[108:111], v[28:31], a[68:71], v[108:111]
ds_read_b64_tr_b16 v[26:27], v72 offset:4608
buffer_load_dwordx4 a[96:99], v237, s[24:27], s58 offen offset:2048 sc1
v_mfma_f32_16x16x32_bf16 v[172:175], v[28:31], v[76:79], v[172:175]
s_waitcnt lgkmcnt(10)
v_mfma_f32_16x16x32_bf16 v[112:115], v[0:3], a[64:67], v[112:115]
ds_read_b64_tr_b16 v[28:29], v64 offset:9216
v_mfma_f32_16x16x32_bf16 v[116:119], v[0:3], a[68:71], v[116:119]
ds_read_b64_tr_b16 v[30:31], v64 offset:13824
s_add_u32 m0, s56, 40960
v_mfma_f32_16x16x32_bf16 v[60:63], v[0:3], v[76:79], v[60:63]
ds_read_b128 v[80:83], v73 offset:15360
buffer_load_dwordx4 v248, s[28:31], s57 offen  lds
v_mfma_f32_16x16x32_bf16 v[120:123], v[4:7], a[64:67], v[120:123]
ds_read_b64_tr_b16 v[0:1], v65 offset:9216
v_subrev_u32 v64, 129024, v64
v_mfma_f32_16x16x32_bf16 v[124:127], v[4:7], a[68:71], v[124:127]
ds_read_b64_tr_b16 v[2:3], v65 offset:13824
s_waitcnt lgkmcnt(9)
v_mfma_f32_16x16x32_bf16 v[128:131], v[8:11], a[64:67], v[128:131]
ds_read_b64_tr_b16 v[4:5], v66 offset:9216
v_mfma_f32_16x16x32_bf16 v[132:135], v[8:11], a[68:71], v[132:135]
ds_read_b64_tr_b16 v[6:7], v66 offset:13824
v_subrev_u32 v65, 129024, v65
v_mfma_f32_16x16x32_bf16 v[136:139], v[12:15], a[64:67], v[136:139]
ds_read_b64_tr_b16 v[8:9], v67 offset:9216
buffer_load_dwordx4 a[100:103], v237, s[24:27], s59 offen offset:2048 sc1
v_mfma_f32_16x16x32_bf16 v[140:143], v[12:15], a[68:71], v[140:143]
ds_read_b64_tr_b16 v[10:11], v67 offset:13824
v_subrev_u32 v66, 129024, v66
v_mfma_f32_16x16x32_bf16 v[144:147], v[16:19], a[64:67], v[144:147]
ds_read_b64_tr_b16 v[12:13], v68 offset:9216
v_mfma_f32_16x16x32_bf16 v[148:151], v[16:19], a[68:71], v[148:151]
ds_read_b64_tr_b16 v[14:15], v68 offset:13824
s_waitcnt lgkmcnt(9)
v_mfma_f32_16x16x32_bf16 v[152:155], v[20:23], a[64:67], v[152:155]
ds_read_b64_tr_b16 v[16:17], v69 offset:9216
buffer_load_dwordx4 v249, s[28:31], s57 offen offset:1024  lds
v_mfma_f32_16x16x32_bf16 v[156:159], v[20:23], a[68:71], v[156:159]
ds_read_b64_tr_b16 v[18:19], v69 offset:13824
v_subrev_u32 v67, 129024, v67
v_mfma_f32_16x16x32_bf16 v[160:163], v[24:27], a[64:67], v[160:163]
ds_read_b64_tr_b16 v[20:21], v70 offset:9216
v_subrev_u32 v68, 129024, v68
v_mfma_f32_16x16x32_bf16 v[164:167], v[24:27], a[68:71], v[164:167]
ds_read_b64_tr_b16 v[22:23], v70 offset:13824
s_waitcnt vmcnt(15)
v_mfma_f32_16x16x32_bf16 v[96:99], v[28:31], a[72:75], v[96:99]
ds_read_b64_tr_b16 v[24:25], v71 offset:9216
v_subrev_u32 v69, 129024, v69
v_mfma_f32_16x16x32_bf16 v[100:103], v[28:31], a[76:79], v[100:103]
ds_read_b64_tr_b16 v[26:27], v71 offset:13824
s_waitcnt lgkmcnt(10)
v_mfma_f32_16x16x32_bf16 v[168:171], v[28:31], v[80:83], v[168:171]
buffer_load_dwordx4 a[104:107], v237, s[24:27], s58 offen offset:3072 sc1
v_mfma_f32_16x16x32_bf16 v[104:107], v[0:3], a[72:75], v[104:107]
ds_read_b64_tr_b16 v[28:29], v72 offset:9216
v_subrev_u32 v70, 129024, v70
v_mfma_f32_16x16x32_bf16 v[108:111], v[0:3], a[76:79], v[108:111]
ds_read_b64_tr_b16 v[30:31], v72 offset:13824
v_subrev_u32 v71, 129024, v71
v_mfma_f32_16x16x32_bf16 v[172:175], v[0:3], v[80:83], v[172:175]
buffer_load_dwordx4 v250, s[28:31], s57 offen offset:2048  lds
v_mfma_f32_16x16x32_bf16 v[112:115], v[4:7], a[72:75], v[112:115]
s_cmp_lg_u32 s38, 0
s_cbranch_scc1 CE7
s_mov_b32 s5, 0x20000
s_waitcnt vmcnt(11)
CL7:
v_cmp_le_u32 s[66:67], 2, v180
s_nop 1
s_and_b32 s66, s66, 65535
s_cmp_eq_u32 s66, 65535
s_cbranch_scc1 CE7
s_sleep 4
buffer_load_dword v180, v206, s[24:27], s62 offen sc1
s_waitcnt vmcnt(0)
s_sub_u32 s5, s5, 1
s_cbranch_scc0 CL7
CE7:
s_waitcnt vmcnt(13)
s_barrier
v_mfma_f32_16x16x32_bf16 v[116:119], v[4:7], a[76:79], v[116:119]
ds_read_b64_tr_b16 v[0:1], v64 offset:0
v_subrev_u32 v72, 129024, v72
v_mfma_f32_16x16x32_bf16 v[60:63], v[4:7], v[80:83], v[60:63]
ds_read_b64_tr_b16 v[2:3], v64 offset:4608
ds_read_b128 v[76:79], v73 offset:0
s_waitcnt lgkmcnt(9)
v_mfma_f32_16x16x32_bf16 v[120:123], v[8:11], a[72:75], v[120:123]
ds_read_b64_tr_b16 v[4:5], v65 offset:0
buffer_load_dwordx4 a[108:111], v237, s[24:27], s59 offen offset:3072 sc1
v_mfma_f32_16x16x32_bf16 v[124:127], v[8:11], a[76:79], v[124:127]
ds_read_b64_tr_b16 v[6:7], v65 offset:4608
v_mfma_f32_16x16x32_bf16 v[128:131], v[12:15], a[72:75], v[128:131]
ds_read_b64_tr_b16 v[8:9], v66 offset:0
v_mfma_f32_16x16x32_bf16 v[132:135], v[12:15], a[76:79], v[132:135]
ds_read_b64_tr_b16 v[10:11], v66 offset:4608
v_mfma_f32_16x16x32_bf16 v[136:139], v[16:19], a[72:75], v[136:139]
ds_read_b64_tr_b16 v[12:13], v67 offset:0
v_mfma_f32_16x16x32_bf16 v[140:143], v[16:19], a[76:79], v[140:143]
ds_read_b64_tr_b16 v[14:15], v67 offset:4608
s_waitcnt lgkmcnt(9)
v_mfma_f32_16x16x32_bf16 v[144:147], v[20:23], a[72:75], v[144:147]
ds_read_b64_tr_b16 v[16:17], v68 offset:0
buffer_load_dwordx4 v251, s[28:31], s57 offen offset:3072  lds
v_mfma_f32_16x16x32_bf16 v[148:151], v[20:23], a[76:79], v[148:151]
ds_read_b64_tr_b16 v[18:19], v68 offset:4608
v_mfma_f32_16x16x32_bf16 v[152:155], v[24:27], a[72:75], v[152:155]
ds_read_b64_tr_b16 v[20:21], v69 offset:0
s_add_u32 m0, s56, 45056
v_mfma_f32_16x16x32_bf16 v[156:159], v[24:27], a[76:79], v[156:159]
ds_read_b64_tr_b16 v[22:23], v69 offset:4608
buffer_load_dwordx4 v252, s[28:31], s57 offen  lds
v_mfma_f32_16x16x32_bf16 v[160:163], v[28:31], a[72:75], v[160:163]
ds_read_b64_tr_b16 v[24:25], v70 offset:0
v_mfma_f32_16x16x32_bf16 v[164:167], v[28:31], a[76:79], v[164:167]
ds_read_b64_tr_b16 v[26:27], v70 offset:4608
s_waitcnt vmcnt(15) lgkmcnt(10)
v_mfma_f32_16x16x32_bf16 v[96:99], v[0:3], a[80:83], v[96:99]
ds_read_b64_tr_b16 v[28:29], v71 offset:0
s_add_u32 s58, s50, 1
v_mfma_f32_16x16x32_bf16 v[100:103], v[0:3], a[84:87], v[100:103]
ds_read_b64_tr_b16 v[30:31], v71 offset:4608
s_and_b32 s58, s58, 3
v_mfma_f32_16x16x32_bf16 v[168:171], v[0:3], v[76:79], v[168:171]
s_mul_i32 s58, s58, 73728
s_add_u32 s58, s58, s60
v_mfma_f32_16x16x32_bf16 v[104:107], v[4:7], a[80:83], v[104:107]
ds_read_b64_tr_b16 v[0:1], v72 offset:0
s_add_u32 s58, s58, 36864
v_mfma_f32_16x16x32_bf16 v[108:111], v[4:7], a[84:87], v[108:111]
ds_read_b64_tr_b16 v[2:3], v72 offset:4608
s_lshl_b32 s59, s39, 1
s_add_u32 s58, s58, s59
s_add_u32 s59, s58, 4096
buffer_load_dwordx4 a[112:115], v237, s[24:27], s58 offen offset:0 sc1
v_mfma_f32_16x16x32_bf16 v[172:175], v[4:7], v[76:79], v[172:175]
s_add_u32 s57, s50, 1
s_waitcnt lgkmcnt(10)
v_mfma_f32_16x16x32_bf16 v[112:115], v[8:11], a[80:83], v[112:115]
ds_read_b64_tr_b16 v[4:5], v64 offset:9216
s_and_b32 s57, s57, 3
v_mfma_f32_16x16x32_bf16 v[116:119], v[8:11], a[84:87], v[116:119]
ds_read_b64_tr_b16 v[6:7], v64 offset:13824
s_mul_i32 s57, s57, 73728
v_mfma_f32_16x16x32_bf16 v[60:63], v[8:11], v[76:79], v[60:63]
ds_read_b128 v[80:83], v73 offset:1024
s_add_u32 s57, s57, s60
s_add_u32 s57, s57, 36864
s_lshr_b32 s6, s39, 2
s_add_u32 s57, s57, s6
s_add_u32 m0, s6, 151552
s_add_u32 s57, s57, 32768
buffer_load_dwordx4 v237, s[24:27], s57 offen sc1 lds
v_mfma_f32_16x16x32_bf16 v[120:123], v[12:15], a[80:83], v[120:123]
ds_read_b64_tr_b16 v[8:9], v65 offset:9216
v_mfma_f32_16x16x32_bf16 v[124:127], v[12:15], a[84:87], v[124:127]
ds_read_b64_tr_b16 v[10:11], v65 offset:13824
s_waitcnt lgkmcnt(9)
v_mfma_f32_16x16x32_bf16 v[128:131], v[16:19], a[80:83], v[128:131]
ds_read_b64_tr_b16 v[12:13], v66 offset:9216
buffer_load_dwordx4 a[116:119], v237, s[24:27], s59 offen offset:0 sc1
v_mfma_f32_16x16x32_bf16 v[132:135], v[16:19], a[84:87], v[132:135]
ds_read_b64_tr_b16 v[14:15], v66 offset:13824
s_add_u32 s57, s50, 2
v_mfma_f32_16x16x32_bf16 v[136:139], v[20:23], a[80:83], v[136:139]
ds_read_b64_tr_b16 v[16:17], v67 offset:9216
s_and_b32 s57, s57, 3
v_mfma_f32_16x16x32_bf16 v[140:143], v[20:23], a[84:87], v[140:143]
ds_read_b64_tr_b16 v[18:19], v67 offset:13824
s_mul_i32 s57, s57, 294912
v_mfma_f32_16x16x32_bf16 v[144:147], v[24:27], a[80:83], v[144:147]
ds_read_b64_tr_b16 v[20:21], v68 offset:9216
s_add_u32 s57, s57, s61
v_mfma_f32_16x16x32_bf16 v[148:151], v[24:27], a[84:87], v[148:151]
ds_read_b64_tr_b16 v[22:23], v68 offset:13824
s_waitcnt lgkmcnt(9)
v_mfma_f32_16x16x32_bf16 v[152:155], v[28:31], a[80:83], v[152:155]
ds_read_b64_tr_b16 v[24:25], v69 offset:9216
s_add_u32 s57, s57, 147456
v_mfma_f32_16x16x32_bf16 v[156:159], v[28:31], a[84:87], v[156:159]
ds_read_b64_tr_b16 v[26:27], v69 offset:13824
s_add_u32 m0, s56, 73728
s_nop 0
buffer_load_dwordx4 v244, s[28:31], s57 offen  lds
v_mfma_f32_16x16x32_bf16 v[160:163], v[0:3], a[80:83], v[160:163]
ds_read_b64_tr_b16 v[28:29], v70 offset:9216
v_mfma_f32_16x16x32_bf16 v[164:167], v[0:3], a[84:87], v[164:167]
ds_read_b64_tr_b16 v[30:31], v70 offset:13824
s_waitcnt vmcnt(14)
v_mfma_f32_16x16x32_bf16 v[96:99], v[4:7], a[88:91], v[96:99]
ds_read_b64_tr_b16 v[0:1], v71 offset:9216
v_mfma_f32_16x16x32_bf16 v[100:103], v[4:7], a[92:95], v[100:103]
ds_read_b64_tr_b16 v[2:3], v71 offset:13824
s_waitcnt lgkmcnt(10)
v_mfma_f32_16x16x32_bf16 v[168:171], v[4:7], v[80:83], v[168:171]
buffer_load_dwordx4 a[120:123], v237, s[24:27], s58 offen offset:1024 sc1
v_mfma_f32_16x16x32_bf16 v[104:107], v[8:11], a[88:91], v[104:107]
ds_read_b64_tr_b16 v[4:5], v72 offset:9216
v_mfma_f32_16x16x32_bf16 v[108:111], v[8:11], a[92:95], v[108:111]
ds_read_b64_tr_b16 v[6:7], v72 offset:13824
buffer_load_dwordx4 v245, s[28:31], s57 offen offset:1024  lds
v_mfma_f32_16x16x32_bf16 v[172:175], v[8:11], v[80:83], v[172:175]
v_mfma_f32_16x16x32_bf16 v[112:115], v[12:15], a[88:91], v[112:115]
ds_read_b64_tr_b16 v[8:9], v64 offset:18432
v_mfma_f32_16x16x32_bf16 v[116:119], v[12:15], a[92:95], v[116:119]
ds_read_b64_tr_b16 v[10:11], v64 offset:23040
v_mfma_f32_16x16x32_bf16 v[60:63], v[12:15], v[80:83], v[60:63]
ds_read_b128 v[76:79], v73 offset:2048
s_waitcnt lgkmcnt(9)
v_mfma_f32_16x16x32_bf16 v[120:123], v[16:19], a[88:91], v[120:123]
ds_read_b64_tr_b16 v[12:13], v65 offset:18432
buffer_load_dwordx4 a[124:127], v237, s[24:27], s59 offen offset:1024 sc1
v_mfma_f32_16x16x32_bf16 v[124:127], v[16:19], a[92:95], v[124:127]
ds_read_b64_tr_b16 v[14:15], v65 offset:23040
v_mfma_f32_16x16x32_bf16 v[128:131], v[20:23], a[88:91], v[128:131]
ds_read_b64_tr_b16 v[16:17], v66 offset:18432
v_mfma_f32_16x16x32_bf16 v[132:135], v[20:23], a[92:95], v[132:135]
ds_read_b64_tr_b16 v[18:19], v66 offset:23040
v_mfma_f32_16x16x32_bf16 v[136:139], v[24:27], a[88:91], v[136:139]
ds_read_b64_tr_b16 v[20:21], v67 offset:18432
buffer_load_dwordx4 v246, s[28:31], s57 offen offset:2048  lds
v_mfma_f32_16x16x32_bf16 v[140:143], v[24:27], a[92:95], v[140:143]
ds_read_b64_tr_b16 v[22:23], v67 offset:23040
s_waitcnt lgkmcnt(9)
v_mfma_f32_16x16x32_bf16 v[144:147], v[28:31], a[88:91], v[144:147]
ds_read_b64_tr_b16 v[24:25], v68 offset:18432
v_mfma_f32_16x16x32_bf16 v[148:151], v[28:31], a[92:95], v[148:151]
ds_read_b64_tr_b16 v[26:27], v68 offset:23040
v_mfma_f32_16x16x32_bf16 v[152:155], v[0:3], a[88:91], v[152:155]
ds_read_b64_tr_b16 v[28:29], v69 offset:18432
v_mfma_f32_16x16x32_bf16 v[156:159], v[0:3], a[92:95], v[156:159]
ds_read_b64_tr_b16 v[30:31], v69 offset:23040
buffer_load_dwordx4 v247, s[28:31], s57 offen offset:3072  lds
v_mfma_f32_16x16x32_bf16 v[160:163], v[4:7], a[88:91], v[160:163]
ds_read_b64_tr_b16 v[0:1], v70 offset:18432
v_mfma_f32_16x16x32_bf16 v[164:167], v[4:7], a[92:95], v[164:167]
ds_read_b64_tr_b16 v[2:3], v70 offset:23040
s_waitcnt vmcnt(15) lgkmcnt(10)
v_mfma_f32_16x16x32_bf16 v[96:99], v[8:11], a[96:99], v[96:99]
ds_read_b64_tr_b16 v[4:5], v71 offset:18432
v_mfma_f32_16x16x32_bf16 v[100:103], v[8:11], a[100:103], v[100:103]
ds_read_b64_tr_b16 v[6:7], v71 offset:23040
v_mfma_f32_16x16x32_bf16 v[168:171], v[8:11], v[76:79], v[168:171]
buffer_load_dwordx4 a[128:131], v237, s[24:27], s58 offen offset:2048 sc1
v_mfma_f32_16x16x32_bf16 v[104:107], v[12:15], a[96:99], v[104:107]
ds_read_b64_tr_b16 v[8:9], v72 offset:18432
v_mfma_f32_16x16x32_bf16 v[108:111], v[12:15], a[100:103], v[108:111]
ds_read_b64_tr_b16 v[10:11], v72 offset:23040
v_mfma_f32_16x16x32_bf16 v[172:175], v[12:15], v[76:79], v[172:175]
s_add_u32 m0, s56, 77824
s_waitcnt lgkmcnt(10)
v_mfma_f32_16x16x32_bf16 v[112:115], v[16:19], a[96:99], v[112:115]
ds_read_b64_tr_b16 v[12:13], v64 offset:27648
buffer_load_dwordx4 v248, s[28:31], s57 offen  lds
v_mfma_f32_16x16x32_bf16 v[116:119], v[16:19], a[100:103], v[116:119]
ds_read_b64_tr_b16 v[14:15], v64 offset:32256
v_mfma_f32_16x16x32_bf16 v[60:63], v[16:19], v[76:79], v[60:63]
ds_read_b128 v[80:83], v73 offset:3072
v_mfma_f32_16x16x32_bf16 v[120:123], v[20:23], a[96:99], v[120:123]
ds_read_b64_tr_b16 v[16:17], v65 offset:27648
v_mfma_f32_16x16x32_bf16 v[124:127], v[20:23], a[100:103], v[124:127]
ds_read_b64_tr_b16 v[18:19], v65 offset:32256
s_waitcnt lgkmcnt(9)
v_mfma_f32_16x16x32_bf16 v[128:131], v[24:27], a[96:99], v[128:131]
ds_read_b64_tr_b16 v[20:21], v66 offset:27648
buffer_load_dwordx4 a[132:135], v237, s[24:27], s59 offen offset:2048 sc1
v_mfma_f32_16x16x32_bf16 v[132:135], v[24:27], a[100:103], v[132:135]
ds_read_b64_tr_b16 v[22:23], v66 offset:32256
v_mfma_f32_16x16x32_bf16 v[136:139], v[28:31], a[96:99], v[136:139]
ds_read_b64_tr_b16 v[24:25], v67 offset:27648
v_mfma_f32_16x16x32_bf16 v[140:143], v[28:31], a[100:103], v[140:143]
ds_read_b64_tr_b16 v[26:27], v67 offset:32256
v_mfma_f32_16x16x32_bf16 v[144:147], v[0:3], a[96:99], v[144:147]
ds_read_b64_tr_b16 v[28:29], v68 offset:27648
v_mfma_f32_16x16x32_bf16 v[148:151], v[0:3], a[100:103], v[148:151]
ds_read_b64_tr_b16 v[30:31], v68 offset:32256
s_waitcnt lgkmcnt(9)
v_mfma_f32_16x16x32_bf16 v[152:155], v[4:7], a[96:99], v[152:155]
ds_read_b64_tr_b16 v[0:1], v69 offset:27648
buffer_load_dwordx4 v249, s[28:31], s57 offen offset:1024  lds
v_mfma_f32_16x16x32_bf16 v[156:159], v[4:7], a[100:103], v[156:159]
ds_read_b64_tr_b16 v[2:3], v69 offset:32256
v_mfma_f32_16x16x32_bf16 v[160:163], v[8:11], a[96:99], v[160:163]
ds_read_b64_tr_b16 v[4:5], v70 offset:27648
v_mfma_f32_16x16x32_bf16 v[164:167], v[8:11], a[100:103], v[164:167]
ds_read_b64_tr_b16 v[6:7], v70 offset:32256
s_waitcnt vmcnt(15)
v_mfma_f32_16x16x32_bf16 v[96:99], v[12:15], a[104:107], v[96:99]
ds_read_b64_tr_b16 v[8:9], v71 offset:27648
v_mfma_f32_16x16x32_bf16 v[100:103], v[12:15], a[108:111], v[100:103]
ds_read_b64_tr_b16 v[10:11], v71 offset:32256
s_waitcnt lgkmcnt(10)
v_mfma_f32_16x16x32_bf16 v[168:171], v[12:15], v[80:83], v[168:171]
buffer_load_dwordx4 a[136:139], v237, s[24:27], s58 offen offset:3072 sc1
v_mfma_f32_16x16x32_bf16 v[104:107], v[16:19], a[104:107], v[104:107]
ds_read_b64_tr_b16 v[12:13], v72 offset:27648
v_mfma_f32_16x16x32_bf16 v[108:111], v[16:19], a[108:111], v[108:111]
ds_read_b64_tr_b16 v[14:15], v72 offset:32256
buffer_load_dwordx4 v250, s[28:31], s57 offen offset:2048  lds
v_mfma_f32_16x16x32_bf16 v[172:175], v[16:19], v[80:83], v[172:175]
v_mfma_f32_16x16x32_bf16 v[112:115], v[20:23], a[104:107], v[112:115]
s_waitcnt vmcnt(13)
s_barrier
v_mfma_f32_16x16x32_bf16 v[116:119], v[20:23], a[108:111], v[116:119]
ds_read_b64_tr_b16 v[16:17], v64 offset:36864
v_mfma_f32_16x16x32_bf16 v[60:63], v[20:23], v[80:83], v[60:63]
ds_read_b64_tr_b16 v[18:19], v64 offset:41472
ds_read_b128 v[76:79], v73 offset:4096
s_waitcnt lgkmcnt(9)
v_mfma_f32_16x16x32_bf16 v[120:123], v[24:27], a[104:107], v[120:123]
ds_read_b64_tr_b16 v[20:21], v65 offset:36864
buffer_load_dwordx4 a[140:143], v237, s[24:27], s59 offen offset:3072 sc1
v_mfma_f32_16x16x32_bf16 v[124:127], v[24:27], a[108:111], v[124:127]
ds_read_b64_tr_b16 v[22:23], v65 offset:41472
v_mfma_f32_16x16x32_bf16 v[128:131], v[28:31], a[104:107], v[128:131]
ds_read_b64_tr_b16 v[24:25], v66 offset:36864
v_mfma_f32_16x16x32_bf16 v[132:135], v[28:31], a[108:111], v[132:135]
ds_read_b64_tr_b16 v[26:27], v66 offset:41472
v_mfma_f32_16x16x32_bf16 v[136:139], v[0:3], a[104:107], v[136:139]
ds_read_b64_tr_b16 v[28:29], v67 offset:36864
buffer_load_dwordx4 v251, s[28:31], s57 offen offset:3072  lds
v_mfma_f32_16x16x32_bf16 v[140:143], v[0:3], a[108:111], v[140:143]
ds_read_b64_tr_b16 v[30:31], v67 offset:41472
s_waitcnt lgkmcnt(9)
v_mfma_f32_16x16x32_bf16 v[144:147], v[4:7], a[104:107], v[144:147]
ds_read_b64_tr_b16 v[0:1], v68 offset:36864
v_mfma_f32_16x16x32_bf16 v[148:151], v[4:7], a[108:111], v[148:151]
ds_read_b64_tr_b16 v[2:3], v68 offset:41472
v_mfma_f32_16x16x32_bf16 v[152:155], v[8:11], a[104:107], v[152:155]
ds_read_b64_tr_b16 v[4:5], v69 offset:36864
s_add_u32 m0, s56, 81920
v_mfma_f32_16x16x32_bf16 v[156:159], v[8:11], a[108:111], v[156:159]
ds_read_b64_tr_b16 v[6:7], v69 offset:41472
buffer_load_dwordx4 v252, s[28:31], s57 offen  lds
v_mfma_f32_16x16x32_bf16 v[160:163], v[12:15], a[104:107], v[160:163]
ds_read_b64_tr_b16 v[8:9], v70 offset:36864
v_mfma_f32_16x16x32_bf16 v[164:167], v[12:15], a[108:111], v[164:167]
ds_read_b64_tr_b16 v[10:11], v70 offset:41472
s_waitcnt vmcnt(15) lgkmcnt(10)
v_mfma_f32_16x16x32_bf16 v[96:99], v[16:19], a[112:115], v[96:99]
ds_read_b64_tr_b16 v[12:13], v71 offset:36864
s_add_u32 s58, s50, 2
v_mfma_f32_16x16x32_bf16 v[100:103], v[16:19], a[116:119], v[100:103]
ds_read_b64_tr_b16 v[14:15], v71 offset:41472
s_and_b32 s58, s58, 3
v_mfma_f32_16x16x32_bf16 v[168:171], v[16:19], v[76:79], v[168:171]
s_mul_i32 s58, s58, 73728
s_add_u32 s58, s58, s60
v_mfma_f32_16x16x32_bf16 v[104:107], v[20:23], a[112:115], v[104:107]
ds_read_b64_tr_b16 v[16:17], v72 offset:36864
s_add_u32 s58, s58, 36864
v_mfma_f32_16x16x32_bf16 v[108:111], v[20:23], a[116:119], v[108:111]
ds_read_b64_tr_b16 v[18:19], v72 offset:41472
s_lshl_b32 s59, s39, 1
s_add_u32 s58, s58, s59
s_add_u32 s59, s58, 4096
buffer_load_dwordx4 a[48:51], v237, s[24:27], s58 offen offset:0 sc1
v_mfma_f32_16x16x32_bf16 v[172:175], v[20:23], v[76:79], v[172:175]
s_add_u32 s57, s50, 2
s_waitcnt lgkmcnt(10)
v_mfma_f32_16x16x32_bf16 v[112:115], v[24:27], a[112:115], v[112:115]
ds_read_b64_tr_b16 v[20:21], v64 offset:46080
s_and_b32 s57, s57, 3
v_mfma_f32_16x16x32_bf16 v[116:119], v[24:27], a[116:119], v[116:119]
ds_read_b64_tr_b16 v[22:23], v64 offset:50688
s_mul_i32 s57, s57, 73728
v_mfma_f32_16x16x32_bf16 v[60:63], v[24:27], v[76:79], v[60:63]
ds_read_b128 v[80:83], v73 offset:5120
s_add_u32 s57, s57, s60
s_add_u32 s57, s57, 36864
s_lshr_b32 s6, s39, 2
s_add_u32 s57, s57, s6
s_add_u32 m0, s6, 155648
s_add_u32 s57, s57, 32768
buffer_load_dwordx4 v237, s[24:27], s57 offen sc1 lds
v_mfma_f32_16x16x32_bf16 v[120:123], v[28:31], a[112:115], v[120:123]
ds_read_b64_tr_b16 v[24:25], v65 offset:46080
v_mfma_f32_16x16x32_bf16 v[124:127], v[28:31], a[116:119], v[124:127]
ds_read_b64_tr_b16 v[26:27], v65 offset:50688
s_waitcnt lgkmcnt(9)
v_mfma_f32_16x16x32_bf16 v[128:131], v[0:3], a[112:115], v[128:131]
ds_read_b64_tr_b16 v[28:29], v66 offset:46080
buffer_load_dwordx4 a[52:55], v237, s[24:27], s59 offen offset:0 sc1
v_mfma_f32_16x16x32_bf16 v[132:135], v[0:3], a[116:119], v[132:135]
ds_read_b64_tr_b16 v[30:31], v66 offset:50688
s_add_u32 s57, s50, 3
v_mfma_f32_16x16x32_bf16 v[136:139], v[4:7], a[112:115], v[136:139]
ds_read_b64_tr_b16 v[0:1], v67 offset:46080
s_and_b32 s57, s57, 3
v_mfma_f32_16x16x32_bf16 v[140:143], v[4:7], a[116:119], v[140:143]
ds_read_b64_tr_b16 v[2:3], v67 offset:50688
s_mul_i32 s57, s57, 294912
v_mfma_f32_16x16x32_bf16 v[144:147], v[8:11], a[112:115], v[144:147]
ds_read_b64_tr_b16 v[4:5], v68 offset:46080
s_add_u32 s57, s57, s61
v_mfma_f32_16x16x32_bf16 v[148:151], v[8:11], a[116:119], v[148:151]
ds_read_b64_tr_b16 v[6:7], v68 offset:50688
s_waitcnt lgkmcnt(9)
v_mfma_f32_16x16x32_bf16 v[152:155], v[12:15], a[112:115], v[152:155]
ds_read_b64_tr_b16 v[8:9], v69 offset:46080
s_add_u32 s57, s57, 147456
v_mfma_f32_16x16x32_bf16 v[156:159], v[12:15], a[116:119], v[156:159]
ds_read_b64_tr_b16 v[10:11], v69 offset:50688
s_add_u32 m0, s56, 110592
s_nop 0
buffer_load_dwordx4 v244, s[28:31], s57 offen  lds
v_mfma_f32_16x16x32_bf16 v[160:163], v[16:19], a[112:115], v[160:163]
ds_read_b64_tr_b16 v[12:13], v70 offset:46080
v_mfma_f32_16x16x32_bf16 v[164:167], v[16:19], a[116:119], v[164:167]
ds_read_b64_tr_b16 v[14:15], v70 offset:50688
s_waitcnt vmcnt(15)
v_mfma_f32_16x16x32_bf16 v[96:99], v[20:23], a[120:123], v[96:99]
ds_read_b64_tr_b16 v[16:17], v71 offset:46080
v_mfma_f32_16x16x32_bf16 v[100:103], v[20:23], a[124:127], v[100:103]
ds_read_b64_tr_b16 v[18:19], v71 offset:50688
s_waitcnt lgkmcnt(10)
v_mfma_f32_16x16x32_bf16 v[168:171], v[20:23], v[80:83], v[168:171]
buffer_load_dwordx4 a[56:59], v237, s[24:27], s58 offen offset:1024 sc1
v_mfma_f32_16x16x32_bf16 v[104:107], v[24:27], a[120:123], v[104:107]
ds_read_b64_tr_b16 v[20:21], v72 offset:46080
v_mfma_f32_16x16x32_bf16 v[108:111], v[24:27], a[124:127], v[108:111]
ds_read_b64_tr_b16 v[22:23], v72 offset:50688
buffer_load_dwordx4 v245, s[28:31], s57 offen offset:1024  lds
v_mfma_f32_16x16x32_bf16 v[172:175], v[24:27], v[80:83], v[172:175]
v_mfma_f32_16x16x32_bf16 v[112:115], v[28:31], a[120:123], v[112:115]
ds_read_b64_tr_b16 v[24:25], v64 offset:55296
v_mfma_f32_16x16x32_bf16 v[116:119], v[28:31], a[124:127], v[116:119]
ds_read_b64_tr_b16 v[26:27], v64 offset:59904
v_mfma_f32_16x16x32_bf16 v[60:63], v[28:31], v[80:83], v[60:63]
ds_read_b128 v[76:79], v73 offset:6144
s_waitcnt lgkmcnt(9)
v_mfma_f32_16x16x32_bf16 v[120:123], v[0:3], a[120:123], v[120:123]
ds_read_b64_tr_b16 v[28:29], v65 offset:55296
buffer_load_dwordx4 a[60:63], v237, s[24:27], s59 offen offset:1024 sc1
v_mfma_f32_16x16x32_bf16 v[124:127], v[0:3], a[124:127], v[124:127]
ds_read_b64_tr_b16 v[30:31], v65 offset:59904
v_add_u32 v64, 64512, v64
v_mfma_f32_16x16x32_bf16 v[128:131], v[4:7], a[120:123], v[128:131]
ds_read_b64_tr_b16 v[0:1], v66 offset:55296
v_mfma_f32_16x16x32_bf16 v[132:135], v[4:7], a[124:127], v[132:135]
ds_read_b64_tr_b16 v[2:3], v66 offset:59904
v_add_u32 v65, 64512, v65
v_mfma_f32_16x16x32_bf16 v[136:139], v[8:11], a[120:123], v[136:139]
ds_read_b64_tr_b16 v[4:5], v67 offset:55296
buffer_load_dwordx4 v246, s[28:31], s57 offen offset:2048  lds
v_mfma_f32_16x16x32_bf16 v[140:143], v[8:11], a[124:127], v[140:143]
ds_read_b64_tr_b16 v[6:7], v67 offset:59904
s_waitcnt lgkmcnt(9)
v_mfma_f32_16x16x32_bf16 v[144:147], v[12:15], a[120:123], v[144:147]
ds_read_b64_tr_b16 v[8:9], v68 offset:55296
v_add_u32 v66, 64512, v66
v_mfma_f32_16x16x32_bf16 v[148:151], v[12:15], a[124:127], v[148:151]
ds_read_b64_tr_b16 v[10:11], v68 offset:59904
v_add_u32 v67, 64512, v67
v_mfma_f32_16x16x32_bf16 v[152:155], v[16:19], a[120:123], v[152:155]
ds_read_b64_tr_b16 v[12:13], v69 offset:55296
v_mfma_f32_16x16x32_bf16 v[156:159], v[16:19], a[124:127], v[156:159]
ds_read_b64_tr_b16 v[14:15], v69 offset:59904
buffer_load_dwordx4 v247, s[28:31], s57 offen offset:3072  lds
v_mfma_f32_16x16x32_bf16 v[160:163], v[20:23], a[120:123], v[160:163]
ds_read_b64_tr_b16 v[16:17], v70 offset:55296
v_add_u32 v68, 64512, v68
v_mfma_f32_16x16x32_bf16 v[164:167], v[20:23], a[124:127], v[164:167]
ds_read_b64_tr_b16 v[18:19], v70 offset:59904
s_waitcnt vmcnt(15) lgkmcnt(10)
v_mfma_f32_16x16x32_bf16 v[96:99], v[24:27], a[128:131], v[96:99]
ds_read_b64_tr_b16 v[20:21], v71 offset:55296
v_add_u32 v69, 64512, v69
v_mfma_f32_16x16x32_bf16 v[100:103], v[24:27], a[132:135], v[100:103]
ds_read_b64_tr_b16 v[22:23], v71 offset:59904
v_add_u32 v70, 64512, v70
v_mfma_f32_16x16x32_bf16 v[168:171], v[24:27], v[76:79], v[168:171]
buffer_load_dwordx4 a[64:67], v237, s[24:27], s58 offen offset:2048 sc1
v_mfma_f32_16x16x32_bf16 v[104:107], v[28:31], a[128:131], v[104:107]
ds_read_b64_tr_b16 v[24:25], v72 offset:55296
v_add_u32 v71, 64512, v71
v_mfma_f32_16x16x32_bf16 v[108:111], v[28:31], a[132:135], v[108:111]
ds_read_b64_tr_b16 v[26:27], v72 offset:59904
v_mfma_f32_16x16x32_bf16 v[172:175], v[28:31], v[76:79], v[172:175]
s_add_u32 m0, s56, 114688
s_waitcnt lgkmcnt(10)
v_mfma_f32_16x16x32_bf16 v[112:115], v[0:3], a[128:131], v[112:115]
ds_read_b64_tr_b16 v[28:29], v64 offset:0
buffer_load_dwordx4 v248, s[28:31], s57 offen  lds
v_mfma_f32_16x16x32_bf16 v[116:119], v[0:3], a[132:135], v[116:119]
ds_read_b64_tr_b16 v[30:31], v64 offset:4608
v_add_u32 v72, 64512, v72
v_mfma_f32_16x16x32_bf16 v[60:63], v[0:3], v[76:79], v[60:63]
ds_read_b128 v[80:83], v73 offset:7168
v_mfma_f32_16x16x32_bf16 v[120:123], v[4:7], a[128:131], v[120:123]
ds_read_b64_tr_b16 v[0:1], v65 offset:0
v_mfma_f32_16x16x32_bf16 v[124:127], v[4:7], a[132:135], v[124:127]
ds_read_b64_tr_b16 v[2:3], v65 offset:4608
s_waitcnt lgkmcnt(9)
v_mfma_f32_16x16x32_bf16 v[128:131], v[8:11], a[128:131], v[128:131]
ds_read_b64_tr_b16 v[4:5], v66 offset:0
buffer_load_dwordx4 a[68:71], v237, s[24:27], s59 offen offset:2048 sc1
v_mfma_f32_16x16x32_bf16 v[132:135], v[8:11], a[132:135], v[132:135]
ds_read_b64_tr_b16 v[6:7], v66 offset:4608
v_mfma_f32_16x16x32_bf16 v[136:139], v[12:15], a[128:131], v[136:139]
ds_read_b64_tr_b16 v[8:9], v67 offset:0
v_mfma_f32_16x16x32_bf16 v[140:143], v[12:15], a[132:135], v[140:143]
ds_read_b64_tr_b16 v[10:11], v67 offset:4608
v_mfma_f32_16x16x32_bf16 v[144:147], v[16:19], a[128:131], v[144:147]
ds_read_b64_tr_b16 v[12:13], v68 offset:0
v_mfma_f32_16x16x32_bf16 v[148:151], v[16:19], a[132:135], v[148:151]
ds_read_b64_tr_b16 v[14:15], v68 offset:4608
s_waitcnt lgkmcnt(9)
v_mfma_f32_16x16x32_bf16 v[152:155], v[20:23], a[128:131], v[152:155]
ds_read_b64_tr_b16 v[16:17], v69 offset:0
buffer_load_dwordx4 v249, s[28:31], s57 offen offset:1024  lds
v_mfma_f32_16x16x32_bf16 v[156:159], v[20:23], a[132:135], v[156:159]
ds_read_b64_tr_b16 v[18:19], v69 offset:4608
v_mfma_f32_16x16x32_bf16 v[160:163], v[24:27], a[128:131], v[160:163]
ds_read_b64_tr_b16 v[20:21], v70 offset:0
v_mfma_f32_16x16x32_bf16 v[164:167], v[24:27], a[132:135], v[164:167]
ds_read_b64_tr_b16 v[22:23], v70 offset:4608
s_waitcnt vmcnt(15)
v_mfma_f32_16x16x32_bf16 v[96:99], v[28:31], a[136:139], v[96:99]
ds_read_b64_tr_b16 v[24:25], v71 offset:0
v_mfma_f32_16x16x32_bf16 v[100:103], v[28:31], a[140:143], v[100:103]
ds_read_b64_tr_b16 v[26:27], v71 offset:4608
s_waitcnt lgkmcnt(10)
v_mfma_f32_16x16x32_bf16 v[168:171], v[28:31], v[80:83], v[168:171]
buffer_load_dwordx4 a[72:75], v237, s[24:27], s58 offen offset:3072 sc1
v_mfma_f32_16x16x32_bf16 v[104:107], v[0:3], a[136:139], v[104:107]
ds_read_b64_tr_b16 v[28:29], v72 offset:0
v_mfma_f32_16x16x32_bf16 v[108:111], v[0:3], a[140:143], v[108:111]
ds_read_b64_tr_b16 v[30:31], v72 offset:4608
buffer_load_dwordx4 v250, s[28:31], s57 offen offset:2048  lds
v_mfma_f32_16x16x32_bf16 v[172:175], v[0:3], v[80:83], v[172:175]
v_mfma_f32_16x16x32_bf16 v[112:115], v[4:7], a[136:139], v[112:115]
s_waitcnt vmcnt(13)
s_barrier
v_mfma_f32_16x16x32_bf16 v[116:119], v[4:7], a[140:143], v[116:119]
ds_read_b64_tr_b16 v[0:1], v64 offset:9216
v_mfma_f32_16x16x32_bf16 v[60:63], v[4:7], v[80:83], v[60:63]
ds_read_b64_tr_b16 v[2:3], v64 offset:13824
ds_read_b128 v[76:79], v73 offset:8192
s_waitcnt lgkmcnt(9)
v_mfma_f32_16x16x32_bf16 v[120:123], v[8:11], a[136:139], v[120:123]
ds_read_b64_tr_b16 v[4:5], v65 offset:9216
buffer_load_dwordx4 a[76:79], v237, s[24:27], s59 offen offset:3072 sc1
v_mfma_f32_16x16x32_bf16 v[124:127], v[8:11], a[140:143], v[124:127]
ds_read_b64_tr_b16 v[6:7], v65 offset:13824
v_mfma_f32_16x16x32_bf16 v[128:131], v[12:15], a[136:139], v[128:131]
ds_read_b64_tr_b16 v[8:9], v66 offset:9216
v_mfma_f32_16x16x32_bf16 v[132:135], v[12:15], a[140:143], v[132:135]
ds_read_b64_tr_b16 v[10:11], v66 offset:13824
v_mfma_f32_16x16x32_bf16 v[136:139], v[16:19], a[136:139], v[136:139]
ds_read_b64_tr_b16 v[12:13], v67 offset:9216
buffer_load_dwordx4 v251, s[28:31], s57 offen offset:3072  lds
v_mfma_f32_16x16x32_bf16 v[140:143], v[16:19], a[140:143], v[140:143]
ds_read_b64_tr_b16 v[14:15], v67 offset:13824
s_waitcnt lgkmcnt(9)
v_mfma_f32_16x16x32_bf16 v[144:147], v[20:23], a[136:139], v[144:147]
ds_read_b64_tr_b16 v[16:17], v68 offset:9216
v_mfma_f32_16x16x32_bf16 v[148:151], v[20:23], a[140:143], v[148:151]
ds_read_b64_tr_b16 v[18:19], v68 offset:13824
v_mfma_f32_16x16x32_bf16 v[152:155], v[24:27], a[136:139], v[152:155]
ds_read_b64_tr_b16 v[20:21], v69 offset:9216
s_add_u32 m0, s56, 118784
v_mfma_f32_16x16x32_bf16 v[156:159], v[24:27], a[140:143], v[156:159]
ds_read_b64_tr_b16 v[22:23], v69 offset:13824
buffer_load_dwordx4 v252, s[28:31], s57 offen  lds
v_mfma_f32_16x16x32_bf16 v[160:163], v[28:31], a[136:139], v[160:163]
ds_read_b64_tr_b16 v[24:25], v70 offset:9216
v_mfma_f32_16x16x32_bf16 v[164:167], v[28:31], a[140:143], v[164:167]
ds_read_b64_tr_b16 v[26:27], v70 offset:13824
s_waitcnt vmcnt(15) lgkmcnt(10)
v_mfma_f32_16x16x32_bf16 v[96:99], v[0:3], a[48:51], v[96:99]
ds_read_b64_tr_b16 v[28:29], v71 offset:9216
s_add_u32 s58, s50, 3
v_mfma_f32_16x16x32_bf16 v[100:103], v[0:3], a[52:55], v[100:103]
ds_read_b64_tr_b16 v[30:31], v71 offset:13824
s_and_b32 s58, s58, 3
v_mfma_f32_16x16x32_bf16 v[168:171], v[0:3], v[76:79], v[168:171]
s_mul_i32 s58, s58, 73728
s_add_u32 s58, s58, s60
v_mfma_f32_16x16x32_bf16 v[104:107], v[4:7], a[48:51], v[104:107]
ds_read_b64_tr_b16 v[0:1], v72 offset:9216
s_add_u32 s58, s58, 36864
v_mfma_f32_16x16x32_bf16 v[108:111], v[4:7], a[52:55], v[108:111]
ds_read_b64_tr_b16 v[2:3], v72 offset:13824
s_lshl_b32 s59, s39, 1
s_add_u32 s58, s58, s59
s_add_u32 s59, s58, 4096
buffer_load_dwordx4 a[16:19], v237, s[24:27], s58 offen offset:0 sc1
v_mfma_f32_16x16x32_bf16 v[172:175], v[4:7], v[76:79], v[172:175]
s_waitcnt lgkmcnt(10)
v_mfma_f32_16x16x32_bf16 v[112:115], v[8:11], a[48:51], v[112:115]
ds_read_b64_tr_b16 v[4:5], v64 offset:18432
v_mfma_f32_16x16x32_bf16 v[116:119], v[8:11], a[52:55], v[116:119]
ds_read_b64_tr_b16 v[6:7], v64 offset:23040
v_mfma_f32_16x16x32_bf16 v[60:63], v[8:11], v[76:79], v[60:63]
ds_read_b128 v[80:83], v73 offset:9216
v_mfma_f32_16x16x32_bf16 v[120:123], v[12:15], a[48:51], v[120:123]
ds_read_b64_tr_b16 v[8:9], v65 offset:18432
v_mfma_f32_16x16x32_bf16 v[124:127], v[12:15], a[52:55], v[124:127]
ds_read_b64_tr_b16 v[10:11], v65 offset:23040
s_waitcnt lgkmcnt(9)
v_mfma_f32_16x16x32_bf16 v[128:131], v[16:19], a[48:51], v[128:131]
ds_read_b64_tr_b16 v[12:13], v66 offset:18432
buffer_load_dwordx4 a[20:23], v237, s[24:27], s59 offen offset:0 sc1
v_mfma_f32_16x16x32_bf16 v[132:135], v[16:19], a[52:55], v[132:135]
ds_read_b64_tr_b16 v[14:15], v66 offset:23040
v_mfma_f32_16x16x32_bf16 v[136:139], v[20:23], a[48:51], v[136:139]
ds_read_b64_tr_b16 v[16:17], v67 offset:18432
v_mfma_f32_16x16x32_bf16 v[140:143], v[20:23], a[52:55], v[140:143]
ds_read_b64_tr_b16 v[18:19], v67 offset:23040
v_mfma_f32_16x16x32_bf16 v[144:147], v[24:27], a[48:51], v[144:147]
ds_read_b64_tr_b16 v[20:21], v68 offset:18432
v_mfma_f32_16x16x32_bf16 v[148:151], v[24:27], a[52:55], v[148:151]
ds_read_b64_tr_b16 v[22:23], v68 offset:23040
s_waitcnt lgkmcnt(9)
v_mfma_f32_16x16x32_bf16 v[152:155], v[28:31], a[48:51], v[152:155]
ds_read_b64_tr_b16 v[24:25], v69 offset:18432
v_mfma_f32_16x16x32_bf16 v[156:159], v[28:31], a[52:55], v[156:159]
ds_read_b64_tr_b16 v[26:27], v69 offset:23040
v_mfma_f32_16x16x32_bf16 v[160:163], v[0:3], a[48:51], v[160:163]
ds_read_b64_tr_b16 v[28:29], v70 offset:18432
v_mfma_f32_16x16x32_bf16 v[164:167], v[0:3], a[52:55], v[164:167]
ds_read_b64_tr_b16 v[30:31], v70 offset:23040
s_waitcnt vmcnt(13)
v_mfma_f32_16x16x32_bf16 v[96:99], v[4:7], a[56:59], v[96:99]
ds_read_b64_tr_b16 v[0:1], v71 offset:18432
v_mfma_f32_16x16x32_bf16 v[100:103], v[4:7], a[60:63], v[100:103]
ds_read_b64_tr_b16 v[2:3], v71 offset:23040
s_waitcnt lgkmcnt(10)
v_mfma_f32_16x16x32_bf16 v[168:171], v[4:7], v[80:83], v[168:171]
buffer_load_dwordx4 a[24:27], v237, s[24:27], s58 offen offset:1024 sc1
v_mfma_f32_16x16x32_bf16 v[104:107], v[8:11], a[56:59], v[104:107]
ds_read_b64_tr_b16 v[4:5], v72 offset:18432
v_mfma_f32_16x16x32_bf16 v[108:111], v[8:11], a[60:63], v[108:111]
ds_read_b64_tr_b16 v[6:7], v72 offset:23040
v_mfma_f32_16x16x32_bf16 v[172:175], v[8:11], v[80:83], v[172:175]
v_mfma_f32_16x16x32_bf16 v[112:115], v[12:15], a[56:59], v[112:115]
ds_read_b64_tr_b16 v[8:9], v64 offset:27648
v_mfma_f32_16x16x32_bf16 v[116:119], v[12:15], a[60:63], v[116:119]
ds_read_b64_tr_b16 v[10:11], v64 offset:32256
v_mfma_f32_16x16x32_bf16 v[60:63], v[12:15], v[80:83], v[60:63]
ds_read_b128 v[76:79], v73 offset:10240
s_waitcnt lgkmcnt(9)
v_mfma_f32_16x16x32_bf16 v[120:123], v[16:19], a[56:59], v[120:123]
ds_read_b64_tr_b16 v[12:13], v65 offset:27648
buffer_load_dwordx4 a[28:31], v237, s[24:27], s59 offen offset:1024 sc1
v_mfma_f32_16x16x32_bf16 v[124:127], v[16:19], a[60:63], v[124:127]
ds_read_b64_tr_b16 v[14:15], v65 offset:32256
v_mfma_f32_16x16x32_bf16 v[128:131], v[20:23], a[56:59], v[128:131]
ds_read_b64_tr_b16 v[16:17], v66 offset:27648
v_mfma_f32_16x16x32_bf16 v[132:135], v[20:23], a[60:63], v[132:135]
ds_read_b64_tr_b16 v[18:19], v66 offset:32256
v_mfma_f32_16x16x32_bf16 v[136:139], v[24:27], a[56:59], v[136:139]
ds_read_b64_tr_b16 v[20:21], v67 offset:27648
v_mfma_f32_16x16x32_bf16 v[140:143], v[24:27], a[60:63], v[140:143]
ds_read_b64_tr_b16 v[22:23], v67 offset:32256
s_waitcnt lgkmcnt(9)
v_mfma_f32_16x16x32_bf16 v[144:147], v[28:31], a[56:59], v[144:147]
ds_read_b64_tr_b16 v[24:25], v68 offset:27648
v_mfma_f32_16x16x32_bf16 v[148:151], v[28:31], a[60:63], v[148:151]
ds_read_b64_tr_b16 v[26:27], v68 offset:32256
v_mfma_f32_16x16x32_bf16 v[152:155], v[0:3], a[56:59], v[152:155]
ds_read_b64_tr_b16 v[28:29], v69 offset:27648
v_mfma_f32_16x16x32_bf16 v[156:159], v[0:3], a[60:63], v[156:159]
ds_read_b64_tr_b16 v[30:31], v69 offset:32256
buffer_load_dwordx4 a[32:35], v237, s[24:27], s58 offen offset:2048 sc1
v_mfma_f32_16x16x32_bf16 v[160:163], v[4:7], a[56:59], v[160:163]
ds_read_b64_tr_b16 v[0:1], v70 offset:27648
v_mfma_f32_16x16x32_bf16 v[164:167], v[4:7], a[60:63], v[164:167]
ds_read_b64_tr_b16 v[2:3], v70 offset:32256
s_waitcnt vmcnt(11) lgkmcnt(10)
v_mfma_f32_16x16x32_bf16 v[96:99], v[8:11], a[64:67], v[96:99]
ds_read_b64_tr_b16 v[4:5], v71 offset:27648
v_mfma_f32_16x16x32_bf16 v[100:103], v[8:11], a[68:71], v[100:103]
ds_read_b64_tr_b16 v[6:7], v71 offset:32256
v_mfma_f32_16x16x32_bf16 v[168:171], v[8:11], v[76:79], v[168:171]
buffer_load_dwordx4 a[36:39], v237, s[24:27], s59 offen offset:2048 sc1
v_mfma_f32_16x16x32_bf16 v[104:107], v[12:15], a[64:67], v[104:107]
ds_read_b64_tr_b16 v[8:9], v72 offset:27648
v_mfma_f32_16x16x32_bf16 v[108:111], v[12:15], a[68:71], v[108:111]
ds_read_b64_tr_b16 v[10:11], v72 offset:32256
v_mfma_f32_16x16x32_bf16 v[172:175], v[12:15], v[76:79], v[172:175]
s_waitcnt lgkmcnt(10)
v_mfma_f32_16x16x32_bf16 v[112:115], v[16:19], a[64:67], v[112:115]
ds_read_b64_tr_b16 v[12:13], v64 offset:36864
v_mfma_f32_16x16x32_bf16 v[116:119], v[16:19], a[68:71], v[116:119]
ds_read_b64_tr_b16 v[14:15], v64 offset:41472
v_mfma_f32_16x16x32_bf16 v[60:63], v[16:19], v[76:79], v[60:63]
ds_read_b128 v[80:83], v73 offset:11264
v_mfma_f32_16x16x32_bf16 v[120:123], v[20:23], a[64:67], v[120:123]
ds_read_b64_tr_b16 v[16:17], v65 offset:36864
v_add_u32 v64, 46080, v64
v_mfma_f32_16x16x32_bf16 v[124:127], v[20:23], a[68:71], v[124:127]
ds_read_b64_tr_b16 v[18:19], v65 offset:41472
s_waitcnt lgkmcnt(9)
v_mfma_f32_16x16x32_bf16 v[128:131], v[24:27], a[64:67], v[128:131]
ds_read_b64_tr_b16 v[20:21], v66 offset:36864
v_mfma_f32_16x16x32_bf16 v[132:135], v[24:27], a[68:71], v[132:135]
ds_read_b64_tr_b16 v[22:23], v66 offset:41472
v_add_u32 v65, 46080, v65
v_mfma_f32_16x16x32_bf16 v[136:139], v[28:31], a[64:67], v[136:139]
ds_read_b64_tr_b16 v[24:25], v67 offset:36864
v_mfma_f32_16x16x32_bf16 v[140:143], v[28:31], a[68:71], v[140:143]
ds_read_b64_tr_b16 v[26:27], v67 offset:41472
v_add_u32 v66, 46080, v66
v_mfma_f32_16x16x32_bf16 v[144:147], v[0:3], a[64:67], v[144:147]
ds_read_b64_tr_b16 v[28:29], v68 offset:36864
v_mfma_f32_16x16x32_bf16 v[148:151], v[0:3], a[68:71], v[148:151]
ds_read_b64_tr_b16 v[30:31], v68 offset:41472
s_waitcnt lgkmcnt(9)
v_mfma_f32_16x16x32_bf16 v[152:155], v[4:7], a[64:67], v[152:155]
ds_read_b64_tr_b16 v[0:1], v69 offset:36864
buffer_load_dwordx4 a[40:43], v237, s[24:27], s58 offen offset:3072 sc1
v_mfma_f32_16x16x32_bf16 v[156:159], v[4:7], a[68:71], v[156:159]
ds_read_b64_tr_b16 v[2:3], v69 offset:41472
v_add_u32 v67, 46080, v67
v_mfma_f32_16x16x32_bf16 v[160:163], v[8:11], a[64:67], v[160:163]
ds_read_b64_tr_b16 v[4:5], v70 offset:36864
v_add_u32 v68, 46080, v68
v_mfma_f32_16x16x32_bf16 v[164:167], v[8:11], a[68:71], v[164:167]
ds_read_b64_tr_b16 v[6:7], v70 offset:41472
s_waitcnt vmcnt(9)
v_mfma_f32_16x16x32_bf16 v[96:99], v[12:15], a[72:75], v[96:99]
ds_read_b64_tr_b16 v[8:9], v71 offset:36864
v_add_u32 v69, 46080, v69
v_mfma_f32_16x16x32_bf16 v[100:103], v[12:15], a[76:79], v[100:103]
ds_read_b64_tr_b16 v[10:11], v71 offset:41472
s_waitcnt lgkmcnt(10)
v_mfma_f32_16x16x32_bf16 v[168:171], v[12:15], v[80:83], v[168:171]
buffer_load_dwordx4 a[44:47], v237, s[24:27], s59 offen offset:3072 sc1
v_mfma_f32_16x16x32_bf16 v[104:107], v[16:19], a[72:75], v[104:107]
ds_read_b64_tr_b16 v[12:13], v72 offset:36864
v_add_u32 v70, 46080, v70
v_mfma_f32_16x16x32_bf16 v[108:111], v[16:19], a[76:79], v[108:111]
ds_read_b64_tr_b16 v[14:15], v72 offset:41472
s_add_u32 s57, s50, 3
v_mfma_f32_16x16x32_bf16 v[172:175], v[16:19], v[80:83], v[172:175]
s_and_b32 s57, s57, 3
v_add_u32 v71, 46080, v71
v_mfma_f32_16x16x32_bf16 v[112:115], v[20:23], a[72:75], v[112:115]
s_mul_i32 s57, s57, 73728
v_add_u32 v72, 46080, v72
v_mfma_f32_16x16x32_bf16 v[116:119], v[20:23], a[76:79], v[116:119]
s_add_u32 s57, s57, s60
v_mfma_f32_16x16x32_bf16 v[60:63], v[20:23], v[80:83], v[60:63]
s_add_u32 s57, s57, 36864
s_waitcnt lgkmcnt(6)
v_mfma_f32_16x16x32_bf16 v[120:123], v[24:27], a[72:75], v[120:123]
s_lshr_b32 s6, s39, 2
v_mfma_f32_16x16x32_bf16 v[124:127], v[24:27], a[76:79], v[124:127]
s_add_u32 s57, s57, s6
v_mfma_f32_16x16x32_bf16 v[128:131], v[28:31], a[72:75], v[128:131]
s_add_u32 m0, s6, 159744
v_mfma_f32_16x16x32_bf16 v[132:135], v[28:31], a[76:79], v[132:135]
s_add_u32 s57, s57, 32768
v_mfma_f32_16x16x32_bf16 v[136:139], v[0:3], a[72:75], v[136:139]
buffer_load_dwordx4 v237, s[24:27], s57 offen sc1 lds
v_mfma_f32_16x16x32_bf16 v[140:143], v[0:3], a[76:79], v[140:143]
s_waitcnt lgkmcnt(0)
v_mfma_f32_16x16x32_bf16 v[144:147], v[4:7], a[72:75], v[144:147]
v_mfma_f32_16x16x32_bf16 v[148:151], v[4:7], a[76:79], v[148:151]
v_mfma_f32_16x16x32_bf16 v[152:155], v[8:11], a[72:75], v[152:155]
v_mfma_f32_16x16x32_bf16 v[156:159], v[8:11], a[76:79], v[156:159]
v_mfma_f32_16x16x32_bf16 v[160:163], v[12:15], a[72:75], v[160:163]
v_mfma_f32_16x16x32_bf16 v[164:167], v[12:15], a[76:79], v[164:167]
s_waitcnt vmcnt(0)
s_barrier
s_cmp_eq_u32 s49, 0
s_cbranch_scc1 FIN0
s_cmp_eq_u32 s49, 1
s_cbranch_scc1 FIN1
s_cmp_eq_u32 s49, 2
s_cbranch_scc1 FIN2
s_branch FIN3
SLOW00:
s_waitcnt vmcnt(0) lgkmcnt(0)
s_barrier
s_mov_b32 s54, 1
v_and_b32 v178, 15, v242
v_lshrrev_b32 v179, 4, v242
v_lshlrev_b32 v179, 4, v179
v_lshl_add_u32 v178, v178, 8, v179
v_mov_b32 v180, 0xff800000
v_mov_b32 v181, 0xff800000
v_mov_b32 v182, 0xff800000
s_mov_b32 s3, s41
s_mov_b32 s7, 0
SLOWL00:
s_add_u32 s6, s38, 0
s_and_b32 s6, s6, 3
s_lshl_b32 s6, s6, 6
s_add_u32 s6, s6, s3
buffer_load_dwordx4 v[0:3], v178, s[12:15], s6 offen
buffer_load_dwordx4 v[16:19], v178, s[12:15], s3 offen offset:0
s_add_u32 s6, s38, 1
s_and_b32 s6, s6, 3
s_lshl_b32 s6, s6, 6
s_add_u32 s6, s6, s3
buffer_load_dwordx4 v[4:7], v178, s[12:15], s6 offen
buffer_load_dwordx4 v[20:23], v178, s[12:15], s3 offen offset:64
s_add_u32 s6, s38, 2
s_and_b32 s6, s6, 3
s_lshl_b32 s6, s6, 6
s_add_u32 s6, s6, s3
buffer_load_dwordx4 v[8:11], v178, s[12:15], s6 offen
buffer_load_dwordx4 v[24:27], v178, s[12:15], s3 offen offset:128
s_add_u32 s6, s38, 3
s_and_b32 s6, s6, 3
s_lshl_b32 s6, s6, 6
s_add_u32 s6, s6, s3
buffer_load_dwordx4 v[12:15], v178, s[12:15], s6 offen
buffer_load_dwordx4 v[28:31], v178, s[12:15], s3 offen offset:192
s_waitcnt vmcnt(0)
v_mfma_f32_16x16x32_bf16 v[64:67], v[0:3], v[112:115], 0
v_mfma_f32_16x16x32_bf16 v[68:71], v[0:3], v[128:131], 0
v_mfma_f32_16x16x32_bf16 v[72:75], v[16:19], a[0:3], 0
v_mfma_f32_16x16x32_bf16 v[64:67], v[4:7], v[116:119], v[64:67]
v_mfma_f32_16x16x32_bf16 v[68:71], v[4:7], v[132:135], v[68:71]
v_mfma_f32_16x16x32_bf16 v[72:75], v[20:23], a[4:7], v[72:75]
v_mfma_f32_16x16x32_bf16 v[64:67], v[8:11], v[120:123], v[64:67]
v_mfma_f32_16x16x32_bf16 v[68:71], v[8:11], v[136:139], v[68:71]
v_mfma_f32_16x16x32_bf16 v[72:75], v[24:27], a[8:11], v[72:75]
v_mfma_f32_16x16x32_bf16 v[64:67], v[12:15], v[124:127], v[64:67]
v_mfma_f32_16x16x32_bf16 v[68:71], v[12:15], v[140:143], v[68:71]
v_mfma_f32_16x16x32_bf16 v[72:75], v[28:31], a[12:15], v[72:75]
s_nop 15
v_max3_f32 v180, v180, v64, v65
v_max3_f32 v180, v180, v66, v67
v_max3_f32 v181, v181, v68, v69
v_max3_f32 v181, v181, v70, v71
v_max3_f32 v182, v182, v72, v73
v_max3_f32 v182, v182, v74, v75
s_add_u32 s3, s3, 4096
s_add_u32 s7, s7, 1
s_cmp_lt_u32 s7, 32
s_cbranch_scc1 SLOWL00
v_mov_b32 v179, v180
s_nop 1
v_permlane16_swap_b32 v180, v179
v_max_f32 v180, v180, v179
v_mov_b32 v179, v180
s_nop 1
v_permlane32_swap_b32 v180, v179
v_max_f32 v180, v180, v179
v_sub_f32 v156, 0, v180
v_sub_f32 v157, 0, v180
v_sub_f32 v158, 0, v180
v_sub_f32 v159, 0, v180
v_mov_b32 v179, v181
s_nop 1
v_permlane16_swap_b32 v181, v179
v_max_f32 v181, v181, v179
v_mov_b32 v179, v181
s_nop 1
v_permlane32_swap_b32 v181, v179
v_max_f32 v181, v181, v179
v_sub_f32 v160, 0, v181
v_sub_f32 v161, 0, v181
v_sub_f32 v162, 0, v181
v_sub_f32 v163, 0, v181
v_mov_b32 v179, v182
s_nop 1
v_permlane16_swap_b32 v182, v179
v_max_f32 v182, v182, v179
v_mov_b32 v179, v182
s_nop 1
v_permlane32_swap_b32 v182, v179
v_max_f32 v182, v182, v179
v_sub_f32 v164, 0, v182
v_sub_f32 v165, 0, v182
v_sub_f32 v166, 0, v182
v_sub_f32 v167, 0, v182
s_add_u32 s42, s41, 4294950912
s_mov_b32 s43, s42
s_add_u32 m0, s39, 0
s_add_u32 s42, s42, 16384
buffer_load_dwordx4 v222, s[12:15], s42 offen nt lds
buffer_load_dwordx4 v223, s[12:15], s42 offen offset:1024 nt lds
buffer_load_dwordx4 v224, s[12:15], s42 offen offset:2048 nt lds
buffer_load_dwordx4 v225, s[12:15], s42 offen offset:3072 nt lds
s_add_u32 m0, s39, 16384
s_add_u32 s42, s42, 16384
buffer_load_dwordx4 v222, s[12:15], s42 offen nt lds
buffer_load_dwordx4 v223, s[12:15], s42 offen offset:1024 nt lds
buffer_load_dwordx4 v224, s[12:15], s42 offen offset:2048 nt lds
buffer_load_dwordx4 v225, s[12:15], s42 offen offset:3072 nt lds
s_add_u32 m0, s39, 65536
s_add_u32 s43, s43, 16384
buffer_load_dwordx4 v226, s[16:19], s43 offen nt lds
buffer_load_dwordx4 v227, s[16:19], s43 offen offset:1024 nt lds
buffer_load_dwordx4 v226, s[16:19], s43 offen offset:2048 nt lds
buffer_load_dwordx4 v227, s[16:19], s43 offen offset:3072 nt lds
s_waitcnt vmcnt(0)
s_barrier
ds_read_b128 a[180:183], v186 offset:0
ds_read_b128 a[184:187], v187 offset:0
ds_read_b128 a[188:191], v190 offset:0
ds_read_b128 a[192:195], v188 offset:0
ds_read_b128 a[196:199], v191 offset:0
ds_read_b128 a[200:203], v189 offset:0
ds_read_b128 a[204:207], v192 offset:0
s_branch ATT00
SLOW01:
s_waitcnt vmcnt(0) lgkmcnt(0)
s_barrier
s_mov_b32 s54, 1
v_and_b32 v178, 15, v242
v_lshrrev_b32 v179, 4, v242
v_lshlrev_b32 v179, 4, v179
v_lshl_add_u32 v178, v178, 8, v179
v_mov_b32 v180, 0xff800000
v_mov_b32 v181, 0xff800000
v_mov_b32 v182, 0xff800000
s_mov_b32 s3, s41
s_mov_b32 s7, 0
SLOWL01:
s_add_u32 s6, s38, 0
s_and_b32 s6, s6, 3
s_lshl_b32 s6, s6, 6
s_add_u32 s6, s6, s3
buffer_load_dwordx4 v[0:3], v178, s[12:15], s6 offen
buffer_load_dwordx4 v[16:19], v178, s[12:15], s3 offen offset:0
s_add_u32 s6, s38, 1
s_and_b32 s6, s6, 3
s_lshl_b32 s6, s6, 6
s_add_u32 s6, s6, s3
buffer_load_dwordx4 v[4:7], v178, s[12:15], s6 offen
buffer_load_dwordx4 v[20:23], v178, s[12:15], s3 offen offset:64
s_add_u32 s6, s38, 2
s_and_b32 s6, s6, 3
s_lshl_b32 s6, s6, 6
s_add_u32 s6, s6, s3
buffer_load_dwordx4 v[8:11], v178, s[12:15], s6 offen
buffer_load_dwordx4 v[24:27], v178, s[12:15], s3 offen offset:128
s_add_u32 s6, s38, 3
s_and_b32 s6, s6, 3
s_lshl_b32 s6, s6, 6
s_add_u32 s6, s6, s3
buffer_load_dwordx4 v[12:15], v178, s[12:15], s6 offen
buffer_load_dwordx4 v[28:31], v178, s[12:15], s3 offen offset:192
s_waitcnt vmcnt(0)
v_mfma_f32_16x16x32_bf16 v[64:67], v[0:3], v[112:115], 0
v_mfma_f32_16x16x32_bf16 v[68:71], v[0:3], v[128:131], 0
v_mfma_f32_16x16x32_bf16 v[72:75], v[16:19], a[0:3], 0
v_mfma_f32_16x16x32_bf16 v[64:67], v[4:7], v[116:119], v[64:67]
v_mfma_f32_16x16x32_bf16 v[68:71], v[4:7], v[132:135], v[68:71]
v_mfma_f32_16x16x32_bf16 v[72:75], v[20:23], a[4:7], v[72:75]
v_mfma_f32_16x16x32_bf16 v[64:67], v[8:11], v[120:123], v[64:67]
v_mfma_f32_16x16x32_bf16 v[68:71], v[8:11], v[136:139], v[68:71]
v_mfma_f32_16x16x32_bf16 v[72:75], v[24:27], a[8:11], v[72:75]
v_mfma_f32_16x16x32_bf16 v[64:67], v[12:15], v[124:127], v[64:67]
v_mfma_f32_16x16x32_bf16 v[68:71], v[12:15], v[140:143], v[68:71]
v_mfma_f32_16x16x32_bf16 v[72:75], v[28:31], a[12:15], v[72:75]
s_nop 15
v_max3_f32 v180, v180, v64, v65
v_max3_f32 v180, v180, v66, v67
v_max3_f32 v181, v181, v68, v69
v_max3_f32 v181, v181, v70, v71
v_max3_f32 v182, v182, v72, v73
v_max3_f32 v182, v182, v74, v75
s_add_u32 s3, s3, 4096
s_add_u32 s7, s7, 1
s_cmp_lt_u32 s7, 32
s_cbranch_scc1 SLOWL01
v_mov_b32 v179, v180
s_nop 1
v_permlane16_swap_b32 v180, v179
v_max_f32 v180, v180, v179
v_mov_b32 v179, v180
s_nop 1
v_permlane32_swap_b32 v180, v179
v_max_f32 v180, v180, v179
v_sub_f32 v156, 0, v180
v_sub_f32 v157, 0, v180
v_sub_f32 v158, 0, v180
v_sub_f32 v159, 0, v180
v_mov_b32 v179, v181
s_nop 1
v_permlane16_swap_b32 v181, v179
v_max_f32 v181, v181, v179
v_mov_b32 v179, v181
s_nop 1
v_permlane32_swap_b32 v181, v179
v_max_f32 v181, v181, v179
v_sub_f32 v160, 0, v181
v_sub_f32 v161, 0, v181
v_sub_f32 v162, 0, v181
v_sub_f32 v163, 0, v181
v_mov_b32 v179, v182
s_nop 1
v_permlane16_swap_b32 v182, v179
v_max_f32 v182, v182, v179
v_mov_b32 v179, v182
s_nop 1
v_permlane32_swap_b32 v182, v179
v_max_f32 v182, v182, v179
v_sub_f32 v164, 0, v182
v_sub_f32 v165, 0, v182
v_sub_f32 v166, 0, v182
v_sub_f32 v167, 0, v182
s_add_u32 s42, s41, 4294950912
s_mov_b32 s43, s42
s_add_u32 m0, s39, 0
s_add_u32 s42, s42, 16384
buffer_load_dwordx4 v222, s[12:15], s42 offen nt lds
buffer_load_dwordx4 v223, s[12:15], s42 offen offset:1024 nt lds
buffer_load_dwordx4 v224, s[12:15], s42 offen offset:2048 nt lds
buffer_load_dwordx4 v225, s[12:15], s42 offen offset:3072 nt lds
s_add_u32 m0, s39, 16384
s_add_u32 s42, s42, 16384
buffer_load_dwordx4 v222, s[12:15], s42 offen nt lds
buffer_load_dwordx4 v223, s[12:15], s42 offen offset:1024 nt lds
buffer_load_dwordx4 v224, s[12:15], s42 offen offset:2048 nt lds
buffer_load_dwordx4 v225, s[12:15], s42 offen offset:3072 nt lds
s_add_u32 m0, s39, 65536
s_add_u32 s43, s43, 16384
buffer_load_dwordx4 v226, s[16:19], s43 offen nt lds
buffer_load_dwordx4 v227, s[16:19], s43 offen offset:1024 nt lds
buffer_load_dwordx4 v226, s[16:19], s43 offen offset:2048 nt lds
buffer_load_dwordx4 v227, s[16:19], s43 offen offset:3072 nt lds
s_waitcnt vmcnt(0)
s_barrier
ds_read_b128 a[180:183], v186 offset:0
ds_read_b128 a[184:187], v187 offset:0
ds_read_b128 a[188:191], v190 offset:0
ds_read_b128 a[192:195], v188 offset:0
ds_read_b128 a[196:199], v191 offset:0
ds_read_b128 a[200:203], v189 offset:0
ds_read_b128 a[204:207], v192 offset:0
s_branch ATT01
SLOW10:
s_waitcnt vmcnt(0) lgkmcnt(0)
s_barrier
s_mov_b32 s54, 1
v_and_b32 v178, 15, v242
v_lshrrev_b32 v179, 4, v242
v_lshlrev_b32 v179, 4, v179
v_lshl_add_u32 v178, v178, 8, v179
v_mov_b32 v180, 0xff800000
v_mov_b32 v181, 0xff800000
v_mov_b32 v182, 0xff800000
s_mov_b32 s3, s41
s_mov_b32 s7, 0
SLOWL10:
s_add_u32 s6, s38, 0
s_and_b32 s6, s6, 3
s_lshl_b32 s6, s6, 6
s_add_u32 s6, s6, s3
buffer_load_dwordx4 v[0:3], v178, s[12:15], s6 offen
buffer_load_dwordx4 v[16:19], v178, s[12:15], s3 offen offset:0
s_add_u32 s6, s38, 1
s_and_b32 s6, s6, 3
s_lshl_b32 s6, s6, 6
s_add_u32 s6, s6, s3
buffer_load_dwordx4 v[4:7], v178, s[12:15], s6 offen
buffer_load_dwordx4 v[20:23], v178, s[12:15], s3 offen offset:64
s_add_u32 s6, s38, 2
s_and_b32 s6, s6, 3
s_lshl_b32 s6, s6, 6
s_add_u32 s6, s6, s3
buffer_load_dwordx4 v[8:11], v178, s[12:15], s6 offen
buffer_load_dwordx4 v[24:27], v178, s[12:15], s3 offen offset:128
s_add_u32 s6, s38, 3
s_and_b32 s6, s6, 3
s_lshl_b32 s6, s6, 6
s_add_u32 s6, s6, s3
buffer_load_dwordx4 v[12:15], v178, s[12:15], s6 offen
buffer_load_dwordx4 v[28:31], v178, s[12:15], s3 offen offset:192
s_waitcnt vmcnt(0)
v_mfma_f32_16x16x32_bf16 v[64:67], v[0:3], v[112:115], 0
v_mfma_f32_16x16x32_bf16 v[68:71], v[0:3], v[128:131], 0
v_mfma_f32_16x16x32_bf16 v[72:75], v[16:19], a[0:3], 0
v_mfma_f32_16x16x32_bf16 v[64:67], v[4:7], v[116:119], v[64:67]
v_mfma_f32_16x16x32_bf16 v[68:71], v[4:7], v[132:135], v[68:71]
v_mfma_f32_16x16x32_bf16 v[72:75], v[20:23], a[4:7], v[72:75]
v_mfma_f32_16x16x32_bf16 v[64:67], v[8:11], v[120:123], v[64:67]
v_mfma_f32_16x16x32_bf16 v[68:71], v[8:11], v[136:139], v[68:71]
v_mfma_f32_16x16x32_bf16 v[72:75], v[24:27], a[8:11], v[72:75]
v_mfma_f32_16x16x32_bf16 v[64:67], v[12:15], v[124:127], v[64:67]
v_mfma_f32_16x16x32_bf16 v[68:71], v[12:15], v[140:143], v[68:71]
v_mfma_f32_16x16x32_bf16 v[72:75], v[28:31], a[12:15], v[72:75]
s_nop 15
v_max3_f32 v180, v180, v64, v65
v_max3_f32 v180, v180, v66, v67
v_max3_f32 v181, v181, v68, v69
v_max3_f32 v181, v181, v70, v71
v_max3_f32 v182, v182, v72, v73
v_max3_f32 v182, v182, v74, v75
s_add_u32 s3, s3, 4096
s_add_u32 s7, s7, 1
s_cmp_lt_u32 s7, 32
s_cbranch_scc1 SLOWL10
v_mov_b32 v179, v180
s_nop 1
v_permlane16_swap_b32 v180, v179
v_max_f32 v180, v180, v179
v_mov_b32 v179, v180
s_nop 1
v_permlane32_swap_b32 v180, v179
v_max_f32 v180, v180, v179
v_sub_f32 v156, 0, v180
v_sub_f32 v157, 0, v180
v_sub_f32 v158, 0, v180
v_sub_f32 v159, 0, v180
v_mov_b32 v179, v181
s_nop 1
v_permlane16_swap_b32 v181, v179
v_max_f32 v181, v181, v179
v_mov_b32 v179, v181
s_nop 1
v_permlane32_swap_b32 v181, v179
v_max_f32 v181, v181, v179
v_sub_f32 v160, 0, v181
v_sub_f32 v161, 0, v181
v_sub_f32 v162, 0, v181
v_sub_f32 v163, 0, v181
v_mov_b32 v179, v182
s_nop 1
v_permlane16_swap_b32 v182, v179
v_max_f32 v182, v182, v179
v_mov_b32 v179, v182
s_nop 1
v_permlane32_swap_b32 v182, v179
v_max_f32 v182, v182, v179
v_sub_f32 v164, 0, v182
v_sub_f32 v165, 0, v182
v_sub_f32 v166, 0, v182
v_sub_f32 v167, 0, v182
s_add_u32 s42, s41, 4294950912
s_mov_b32 s43, s42
s_add_u32 m0, s39, 0
s_add_u32 s42, s42, 16384
buffer_load_dwordx4 v222, s[12:15], s42 offen nt lds
buffer_load_dwordx4 v223, s[12:15], s42 offen offset:1024 nt lds
buffer_load_dwordx4 v224, s[12:15], s42 offen offset:2048 nt lds
buffer_load_dwordx4 v225, s[12:15], s42 offen offset:3072 nt lds
s_add_u32 m0, s39, 16384
s_add_u32 s42, s42, 16384
buffer_load_dwordx4 v222, s[12:15], s42 offen nt lds
buffer_load_dwordx4 v223, s[12:15], s42 offen offset:1024 nt lds
buffer_load_dwordx4 v224, s[12:15], s42 offen offset:2048 nt lds
buffer_load_dwordx4 v225, s[12:15], s42 offen offset:3072 nt lds
s_add_u32 m0, s39, 65536
s_add_u32 s43, s43, 16384
buffer_load_dwordx4 v226, s[16:19], s43 offen nt lds
buffer_load_dwordx4 v227, s[16:19], s43 offen offset:1024 nt lds
buffer_load_dwordx4 v226, s[16:19], s43 offen offset:2048 nt lds
buffer_load_dwordx4 v227, s[16:19], s43 offen offset:3072 nt lds
s_waitcnt vmcnt(0)
s_barrier
ds_read_b128 a[180:183], v186 offset:0
ds_read_b128 a[184:187], v187 offset:0
ds_read_b128 a[188:191], v190 offset:0
ds_read_b128 a[192:195], v188 offset:0
ds_read_b128 a[196:199], v191 offset:0
ds_read_b128 a[200:203], v189 offset:0
ds_read_b128 a[204:207], v192 offset:0
s_branch ATT10
SLOW11:
s_waitcnt vmcnt(0) lgkmcnt(0)
s_barrier
s_mov_b32 s54, 1
v_and_b32 v178, 15, v242
v_lshrrev_b32 v179, 4, v242
v_lshlrev_b32 v179, 4, v179
v_lshl_add_u32 v178, v178, 8, v179
v_mov_b32 v180, 0xff800000
v_mov_b32 v181, 0xff800000
v_mov_b32 v182, 0xff800000
s_mov_b32 s3, s41
s_mov_b32 s7, 0
SLOWL11:
s_add_u32 s6, s38, 0
s_and_b32 s6, s6, 3
s_lshl_b32 s6, s6, 6
s_add_u32 s6, s6, s3
buffer_load_dwordx4 v[0:3], v178, s[12:15], s6 offen
buffer_load_dwordx4 v[16:19], v178, s[12:15], s3 offen offset:0
s_add_u32 s6, s38, 1
s_and_b32 s6, s6, 3
s_lshl_b32 s6, s6, 6
s_add_u32 s6, s6, s3
buffer_load_dwordx4 v[4:7], v178, s[12:15], s6 offen
buffer_load_dwordx4 v[20:23], v178, s[12:15], s3 offen offset:64
s_add_u32 s6, s38, 2
s_and_b32 s6, s6, 3
s_lshl_b32 s6, s6, 6
s_add_u32 s6, s6, s3
buffer_load_dwordx4 v[8:11], v178, s[12:15], s6 offen
buffer_load_dwordx4 v[24:27], v178, s[12:15], s3 offen offset:128
s_add_u32 s6, s38, 3
s_and_b32 s6, s6, 3
s_lshl_b32 s6, s6, 6
s_add_u32 s6, s6, s3
buffer_load_dwordx4 v[12:15], v178, s[12:15], s6 offen
buffer_load_dwordx4 v[28:31], v178, s[12:15], s3 offen offset:192
s_waitcnt vmcnt(0)
v_mfma_f32_16x16x32_bf16 v[64:67], v[0:3], v[112:115], 0
v_mfma_f32_16x16x32_bf16 v[68:71], v[0:3], v[128:131], 0
v_mfma_f32_16x16x32_bf16 v[72:75], v[16:19], a[0:3], 0
v_mfma_f32_16x16x32_bf16 v[64:67], v[4:7], v[116:119], v[64:67]
v_mfma_f32_16x16x32_bf16 v[68:71], v[4:7], v[132:135], v[68:71]
v_mfma_f32_16x16x32_bf16 v[72:75], v[20:23], a[4:7], v[72:75]
v_mfma_f32_16x16x32_bf16 v[64:67], v[8:11], v[120:123], v[64:67]
v_mfma_f32_16x16x32_bf16 v[68:71], v[8:11], v[136:139], v[68:71]
v_mfma_f32_16x16x32_bf16 v[72:75], v[24:27], a[8:11], v[72:75]
v_mfma_f32_16x16x32_bf16 v[64:67], v[12:15], v[124:127], v[64:67]
v_mfma_f32_16x16x32_bf16 v[68:71], v[12:15], v[140:143], v[68:71]
v_mfma_f32_16x16x32_bf16 v[72:75], v[28:31], a[12:15], v[72:75]
s_nop 15
v_max3_f32 v180, v180, v64, v65
v_max3_f32 v180, v180, v66, v67
v_max3_f32 v181, v181, v68, v69
v_max3_f32 v181, v181, v70, v71
v_max3_f32 v182, v182, v72, v73
v_max3_f32 v182, v182, v74, v75
s_add_u32 s3, s3, 4096
s_add_u32 s7, s7, 1
s_cmp_lt_u32 s7, 32
s_cbranch_scc1 SLOWL11
v_mov_b32 v179, v180
s_nop 1
v_permlane16_swap_b32 v180, v179
v_max_f32 v180, v180, v179
v_mov_b32 v179, v180
s_nop 1
v_permlane32_swap_b32 v180, v179
v_max_f32 v180, v180, v179
v_sub_f32 v156, 0, v180
v_sub_f32 v157, 0, v180
v_sub_f32 v158, 0, v180
v_sub_f32 v159, 0, v180
v_mov_b32 v179, v181
s_nop 1
v_permlane16_swap_b32 v181, v179
v_max_f32 v181, v181, v179
v_mov_b32 v179, v181
s_nop 1
v_permlane32_swap_b32 v181, v179
v_max_f32 v181, v181, v179
v_sub_f32 v160, 0, v181
v_sub_f32 v161, 0, v181
v_sub_f32 v162, 0, v181
v_sub_f32 v163, 0, v181
v_mov_b32 v179, v182
s_nop 1
v_permlane16_swap_b32 v182, v179
v_max_f32 v182, v182, v179
v_mov_b32 v179, v182
s_nop 1
v_permlane32_swap_b32 v182, v179
v_max_f32 v182, v182, v179
v_sub_f32 v164, 0, v182
v_sub_f32 v165, 0, v182
v_sub_f32 v166, 0, v182
v_sub_f32 v167, 0, v182
s_add_u32 s42, s41, 4294950912
s_mov_b32 s43, s42
s_add_u32 m0, s39, 0
s_add_u32 s42, s42, 16384
buffer_load_dwordx4 v222, s[12:15], s42 offen nt lds
buffer_load_dwordx4 v223, s[12:15], s42 offen offset:1024 nt lds
buffer_load_dwordx4 v224, s[12:15], s42 offen offset:2048 nt lds
buffer_load_dwordx4 v225, s[12:15], s42 offen offset:3072 nt lds
s_add_u32 m0, s39, 16384
s_add_u32 s42, s42, 16384
buffer_load_dwordx4 v222, s[12:15], s42 offen nt lds
buffer_load_dwordx4 v223, s[12:15], s42 offen offset:1024 nt lds
buffer_load_dwordx4 v224, s[12:15], s42 offen offset:2048 nt lds
buffer_load_dwordx4 v225, s[12:15], s42 offen offset:3072 nt lds
s_add_u32 m0, s39, 65536
s_add_u32 s43, s43, 16384
buffer_load_dwordx4 v226, s[16:19], s43 offen nt lds
buffer_load_dwordx4 v227, s[16:19], s43 offen offset:1024 nt lds
buffer_load_dwordx4 v226, s[16:19], s43 offen offset:2048 nt lds
buffer_load_dwordx4 v227, s[16:19], s43 offen offset:3072 nt lds
s_add_u32 m0, s39, 32768
s_add_u32 s42, s42, 16384
buffer_load_dwordx4 v222, s[12:15], s42 offen nt lds
buffer_load_dwordx4 v223, s[12:15], s42 offen offset:1024 nt lds
buffer_load_dwordx4 v224, s[12:15], s42 offen offset:2048 nt lds
buffer_load_dwordx4 v225, s[12:15], s42 offen offset:3072 nt lds
s_add_u32 m0, s39, 81920
s_add_u32 s43, s43, 16384
buffer_load_dwordx4 v226, s[16:19], s43 offen nt lds
buffer_load_dwordx4 v227, s[16:19], s43 offen offset:1024 nt lds
buffer_load_dwordx4 v226, s[16:19], s43 offen offset:2048 nt lds
buffer_load_dwordx4 v227, s[16:19], s43 offen offset:3072 nt lds
s_waitcnt vmcnt(0)
s_barrier
ds_read_b128 a[180:183], v186 offset:0
ds_read_b128 a[184:187], v187 offset:0
ds_read_b128 a[188:191], v190 offset:0
ds_read_b128 a[192:195], v188 offset:0
ds_read_b128 a[196:199], v191 offset:0
ds_read_b128 a[200:203], v189 offset:0
ds_read_b128 a[204:207], v192 offset:0
s_branch ATT11
FIN0:
s_lshl_b32 s6, s48, 3
s_add_u32 s6, s6, s47
ds_read_b64_tr_b16 v[0:1], v64 offset:0
ds_read_b64_tr_b16 v[2:3], v64 offset:4608
ds_read_b128 v[76:79], v73 offset:12288
ds_read_b64_tr_b16 v[4:5], v64 offset:9216
ds_read_b64_tr_b16 v[6:7], v64 offset:13824
ds_read_b128 v[80:83], v73 offset:13312
ds_read_b64_tr_b16 v[8:9], v64 offset:18432
ds_read_b64_tr_b16 v[10:11], v64 offset:23040
ds_read_b128 v[84:87], v73 offset:14336
ds_read_b64_tr_b16 v[12:13], v64 offset:27648
ds_read_b64_tr_b16 v[14:15], v64 offset:32256
ds_read_b128 v[88:91], v73 offset:15360
ds_read_b64_tr_b16 v[16:17], v65 offset:0
ds_read_b64_tr_b16 v[18:19], v65 offset:4608
ds_read_b64_tr_b16 v[20:21], v65 offset:9216
ds_read_b64_tr_b16 v[22:23], v65 offset:13824
s_lshl_b32 s6, s6, 2
s_add_u32 s6, s6, s50
s_lshl_b32 s6, s6, 6
s_add_u32 s6, s6, s38
s_mul_i32 s58, s6, 3072
s_add_u32 s58, s58, 18874368
s_add_u32 s42, s58, 49152
s_add_u32 s43, s58, 98304
s_add_u32 s44, s58, 147456
s_waitcnt lgkmcnt(10)
v_mfma_f32_16x16x32_bf16 v[168:171], v[0:3], v[76:79], v[168:171]
ds_read_b64_tr_b16 v[24:25], v65 offset:18432
v_mfma_f32_16x16x32_bf16 v[168:171], v[4:7], v[80:83], v[168:171]
ds_read_b64_tr_b16 v[26:27], v65 offset:23040
s_waitcnt lgkmcnt(6)
v_mfma_f32_16x16x32_bf16 v[168:171], v[8:11], v[84:87], v[168:171]
ds_read_b64_tr_b16 v[28:29], v65 offset:27648
v_mfma_f32_16x16x32_bf16 v[168:171], v[12:15], v[88:91], v[168:171]
ds_read_b64_tr_b16 v[30:31], v65 offset:32256
s_waitcnt lgkmcnt(4)
v_mfma_f32_16x16x32_bf16 v[172:175], v[16:19], v[76:79], v[172:175]
ds_read_b64_tr_b16 v[0:1], v66 offset:0
ds_read_b64_tr_b16 v[2:3], v66 offset:4608
v_mfma_f32_16x16x32_bf16 v[172:175], v[20:23], v[80:83], v[172:175]
ds_read_b64_tr_b16 v[4:5], v66 offset:9216
ds_read_b64_tr_b16 v[6:7], v66 offset:13824
s_waitcnt lgkmcnt(0)
v_mfma_f32_16x16x32_bf16 v[172:175], v[24:27], v[84:87], v[172:175]
ds_read_b64_tr_b16 v[8:9], v66 offset:18432
ds_read_b64_tr_b16 v[10:11], v66 offset:23040
v_mfma_f32_16x16x32_bf16 v[172:175], v[28:31], v[88:91], v[172:175]
ds_read_b64_tr_b16 v[12:13], v66 offset:27648
ds_read_b64_tr_b16 v[14:15], v66 offset:32256
v_mfma_f32_16x16x32_bf16 v[60:63], v[0:3], v[76:79], v[60:63]
ds_read_b64_tr_b16 v[16:17], v67 offset:0
ds_read_b64_tr_b16 v[18:19], v67 offset:4608
v_mfma_f32_16x16x32_bf16 v[60:63], v[4:7], v[80:83], v[60:63]
ds_read_b64_tr_b16 v[20:21], v67 offset:9216
ds_read_b64_tr_b16 v[22:23], v67 offset:13824
s_waitcnt lgkmcnt(2)
v_mfma_f32_16x16x32_bf16 v[60:63], v[8:11], v[84:87], v[60:63]
ds_read_b64_tr_b16 v[24:25], v67 offset:18432
ds_read_b64_tr_b16 v[26:27], v67 offset:23040
v_mfma_f32_16x16x32_bf16 v[60:63], v[12:15], v[88:91], v[60:63]
ds_read_b64_tr_b16 v[28:29], v67 offset:27648
ds_read_b64_tr_b16 v[30:31], v67 offset:32256
v_mfma_f32_16x16x32_bf16 v[120:123], v[16:19], a[16:19], v[120:123]
ds_read_b64_tr_b16 v[0:1], v68 offset:0
ds_read_b64_tr_b16 v[2:3], v68 offset:4608
v_mfma_f32_16x16x32_bf16 v[124:127], v[16:19], a[20:23], v[124:127]
ds_read_b64_tr_b16 v[4:5], v68 offset:9216
ds_read_b64_tr_b16 v[6:7], v68 offset:13824
s_waitcnt lgkmcnt(6)
v_mfma_f32_16x16x32_bf16 v[120:123], v[20:23], a[24:27], v[120:123]
ds_read_b64_tr_b16 v[8:9], v68 offset:18432
ds_read_b64_tr_b16 v[10:11], v68 offset:23040
v_mfma_f32_16x16x32_bf16 v[124:127], v[20:23], a[28:31], v[124:127]
ds_read_b64_tr_b16 v[12:13], v68 offset:27648
v_cvt_pk_bf16_f32 v32, v168, v169
v_mfma_f32_16x16x32_bf16 v[120:123], v[24:27], a[32:35], v[120:123]
ds_read_b64_tr_b16 v[14:15], v68 offset:32256
v_cvt_pk_bf16_f32 v33, v170, v171
v_mfma_f32_16x16x32_bf16 v[124:127], v[24:27], a[36:39], v[124:127]
ds_read_b64_tr_b16 v[16:17], v69 offset:0
s_waitcnt lgkmcnt(7)
v_mfma_f32_16x16x32_bf16 v[120:123], v[28:31], a[40:43], v[120:123]
ds_read_b64_tr_b16 v[18:19], v69 offset:4608
v_cvt_pk_bf16_f32 v34, v172, v173
v_mfma_f32_16x16x32_bf16 v[124:127], v[28:31], a[44:47], v[124:127]
ds_read_b64_tr_b16 v[20:21], v69 offset:9216
v_cvt_pk_bf16_f32 v35, v174, v175
v_mfma_f32_16x16x32_bf16 v[128:131], v[0:3], a[16:19], v[128:131]
ds_read_b64_tr_b16 v[22:23], v69 offset:13824
buffer_store_dwordx4 v[32:35], v237, s[24:27], s44 offen offset:0 sc1
v_mfma_f32_16x16x32_bf16 v[132:135], v[0:3], a[20:23], v[132:135]
ds_read_b64_tr_b16 v[24:25], v69 offset:18432
s_waitcnt lgkmcnt(7)
v_mfma_f32_16x16x32_bf16 v[128:131], v[4:7], a[24:27], v[128:131]
ds_read_b64_tr_b16 v[26:27], v69 offset:23040
v_cvt_pk_bf16_f32 v36, v60, v61
v_mfma_f32_16x16x32_bf16 v[132:135], v[4:7], a[28:31], v[132:135]
ds_read_b64_tr_b16 v[28:29], v69 offset:27648
v_cvt_pk_bf16_f32 v37, v62, v63
v_mfma_f32_16x16x32_bf16 v[128:131], v[8:11], a[32:35], v[128:131]
ds_read_b64_tr_b16 v[30:31], v69 offset:32256
buffer_store_dwordx4 v[36:39], v237, s[24:27], s44 offen offset:1024 sc1
v_mfma_f32_16x16x32_bf16 v[132:135], v[8:11], a[36:39], v[132:135]
ds_read_b64_tr_b16 v[0:1], v70 offset:0
s_waitcnt lgkmcnt(7)
v_mfma_f32_16x16x32_bf16 v[128:131], v[12:15], a[40:43], v[128:131]
ds_read_b64_tr_b16 v[2:3], v70 offset:4608
v_cvt_pk_bf16_f32 v40, v120, v121
v_mfma_f32_16x16x32_bf16 v[132:135], v[12:15], a[44:47], v[132:135]
ds_read_b64_tr_b16 v[4:5], v70 offset:9216
v_cvt_pk_bf16_f32 v41, v122, v123
v_mfma_f32_16x16x32_bf16 v[136:139], v[16:19], a[16:19], v[136:139]
ds_read_b64_tr_b16 v[6:7], v70 offset:13824
v_cvt_pk_bf16_f32 v42, v124, v125
v_mfma_f32_16x16x32_bf16 v[140:143], v[16:19], a[20:23], v[140:143]
ds_read_b64_tr_b16 v[8:9], v70 offset:18432
s_waitcnt lgkmcnt(7)
v_mfma_f32_16x16x32_bf16 v[136:139], v[20:23], a[24:27], v[136:139]
ds_read_b64_tr_b16 v[10:11], v70 offset:23040
v_cvt_pk_bf16_f32 v43, v126, v127
v_mfma_f32_16x16x32_bf16 v[140:143], v[20:23], a[28:31], v[140:143]
ds_read_b64_tr_b16 v[12:13], v70 offset:27648
buffer_store_dwordx4 v[40:43], v237, s[24:27], s42 offen offset:0 sc1
v_mfma_f32_16x16x32_bf16 v[136:139], v[24:27], a[32:35], v[136:139]
ds_read_b64_tr_b16 v[14:15], v70 offset:32256
v_cvt_pk_bf16_f32 v44, v128, v129
v_mfma_f32_16x16x32_bf16 v[140:143], v[24:27], a[36:39], v[140:143]
ds_read_b64_tr_b16 v[16:17], v71 offset:0
s_waitcnt lgkmcnt(7)
v_mfma_f32_16x16x32_bf16 v[136:139], v[28:31], a[40:43], v[136:139]
ds_read_b64_tr_b16 v[18:19], v71 offset:4608
v_cvt_pk_bf16_f32 v45, v130, v131
v_mfma_f32_16x16x32_bf16 v[140:143], v[28:31], a[44:47], v[140:143]
ds_read_b64_tr_b16 v[20:21], v71 offset:9216
v_cvt_pk_bf16_f32 v46, v132, v133
v_mfma_f32_16x16x32_bf16 v[144:147], v[0:3], a[16:19], v[144:147]
ds_read_b64_tr_b16 v[22:23], v71 offset:13824
v_cvt_pk_bf16_f32 v47, v134, v135
v_mfma_f32_16x16x32_bf16 v[148:151], v[0:3], a[20:23], v[148:151]
ds_read_b64_tr_b16 v[24:25], v71 offset:18432
s_waitcnt lgkmcnt(7)
v_mfma_f32_16x16x32_bf16 v[144:147], v[4:7], a[24:27], v[144:147]
ds_read_b64_tr_b16 v[26:27], v71 offset:23040
buffer_store_dwordx4 v[44:47], v237, s[24:27], s42 offen offset:1024 sc1
v_mfma_f32_16x16x32_bf16 v[148:151], v[4:7], a[28:31], v[148:151]
ds_read_b64_tr_b16 v[28:29], v71 offset:27648
v_mfma_f32_16x16x32_bf16 v[144:147], v[8:11], a[32:35], v[144:147]
ds_read_b64_tr_b16 v[30:31], v71 offset:32256
v_cvt_pk_bf16_f32 v32, v136, v137
v_mfma_f32_16x16x32_bf16 v[148:151], v[8:11], a[36:39], v[148:151]
ds_read_b64_tr_b16 v[0:1], v72 offset:0
s_waitcnt lgkmcnt(7)
v_mfma_f32_16x16x32_bf16 v[144:147], v[12:15], a[40:43], v[144:147]
ds_read_b64_tr_b16 v[2:3], v72 offset:4608
v_cvt_pk_bf16_f32 v33, v138, v139
v_mfma_f32_16x16x32_bf16 v[148:151], v[12:15], a[44:47], v[148:151]
ds_read_b64_tr_b16 v[4:5], v72 offset:9216
v_cvt_pk_bf16_f32 v34, v140, v141
v_mfma_f32_16x16x32_bf16 v[152:155], v[16:19], a[16:19], v[152:155]
ds_read_b64_tr_b16 v[6:7], v72 offset:13824
v_cvt_pk_bf16_f32 v35, v142, v143
v_mfma_f32_16x16x32_bf16 v[156:159], v[16:19], a[20:23], v[156:159]
ds_read_b64_tr_b16 v[8:9], v72 offset:18432
s_waitcnt lgkmcnt(7)
v_mfma_f32_16x16x32_bf16 v[152:155], v[20:23], a[24:27], v[152:155]
ds_read_b64_tr_b16 v[10:11], v72 offset:23040
buffer_store_dwordx4 v[32:35], v237, s[24:27], s42 offen offset:2048 sc1
v_mfma_f32_16x16x32_bf16 v[156:159], v[20:23], a[28:31], v[156:159]
ds_read_b64_tr_b16 v[12:13], v72 offset:27648
v_mfma_f32_16x16x32_bf16 v[152:155], v[24:27], a[32:35], v[152:155]
ds_read_b64_tr_b16 v[14:15], v72 offset:32256
v_cvt_pk_bf16_f32 v36, v144, v145
v_mfma_f32_16x16x32_bf16 v[156:159], v[24:27], a[36:39], v[156:159]
ds_read_b64_tr_b16 v[16:17], v64 offset:0
s_waitcnt lgkmcnt(7)
v_mfma_f32_16x16x32_bf16 v[152:155], v[28:31], a[40:43], v[152:155]
ds_read_b64_tr_b16 v[18:19], v64 offset:4608
v_cvt_pk_bf16_f32 v37, v146, v147
v_mfma_f32_16x16x32_bf16 v[156:159], v[28:31], a[44:47], v[156:159]
ds_read_b64_tr_b16 v[20:21], v64 offset:9216
v_cvt_pk_bf16_f32 v38, v148, v149
v_mfma_f32_16x16x32_bf16 v[160:163], v[0:3], a[16:19], v[160:163]
ds_read_b64_tr_b16 v[22:23], v64 offset:13824
v_cvt_pk_bf16_f32 v39, v150, v151
v_mfma_f32_16x16x32_bf16 v[164:167], v[0:3], a[20:23], v[164:167]
ds_read_b64_tr_b16 v[24:25], v64 offset:18432
s_waitcnt lgkmcnt(7)
v_mfma_f32_16x16x32_bf16 v[160:163], v[4:7], a[24:27], v[160:163]
ds_read_b64_tr_b16 v[26:27], v64 offset:23040
buffer_store_dwordx4 v[36:39], v237, s[24:27], s43 offen offset:0 sc1
v_mfma_f32_16x16x32_bf16 v[164:167], v[4:7], a[28:31], v[164:167]
ds_read_b64_tr_b16 v[28:29], v64 offset:27648
v_mfma_f32_16x16x32_bf16 v[160:163], v[8:11], a[32:35], v[160:163]
ds_read_b64_tr_b16 v[30:31], v64 offset:32256
v_cvt_pk_bf16_f32 v40, v152, v153
v_mfma_f32_16x16x32_bf16 v[164:167], v[8:11], a[36:39], v[164:167]
ds_read_b64_tr_b16 v[0:1], v65 offset:0
s_waitcnt lgkmcnt(7)
v_mfma_f32_16x16x32_bf16 v[160:163], v[12:15], a[40:43], v[160:163]
ds_read_b64_tr_b16 v[2:3], v65 offset:4608
v_cvt_pk_bf16_f32 v41, v154, v155
v_mfma_f32_16x16x32_bf16 v[164:167], v[12:15], a[44:47], v[164:167]
ds_read_b64_tr_b16 v[4:5], v65 offset:9216
v_cvt_pk_bf16_f32 v42, v156, v157
v_mfma_f32_16x16x32_bf16 v[96:99], v[16:19], a[16:19], v[96:99]
ds_read_b64_tr_b16 v[6:7], v65 offset:13824
v_cvt_pk_bf16_f32 v43, v158, v159
v_mfma_f32_16x16x32_bf16 v[100:103], v[16:19], a[20:23], v[100:103]
ds_read_b64_tr_b16 v[8:9], v65 offset:18432
s_waitcnt lgkmcnt(7)
v_mfma_f32_16x16x32_bf16 v[96:99], v[20:23], a[24:27], v[96:99]
ds_read_b64_tr_b16 v[10:11], v65 offset:23040
buffer_store_dwordx4 v[40:43], v237, s[24:27], s43 offen offset:1024 sc1
v_mfma_f32_16x16x32_bf16 v[100:103], v[20:23], a[28:31], v[100:103]
ds_read_b64_tr_b16 v[12:13], v65 offset:27648
v_mfma_f32_16x16x32_bf16 v[96:99], v[24:27], a[32:35], v[96:99]
ds_read_b64_tr_b16 v[14:15], v65 offset:32256
v_cvt_pk_bf16_f32 v44, v160, v161
v_mfma_f32_16x16x32_bf16 v[100:103], v[24:27], a[36:39], v[100:103]
ds_read_b64_tr_b16 v[16:17], v66 offset:0
s_waitcnt lgkmcnt(7)
v_mfma_f32_16x16x32_bf16 v[96:99], v[28:31], a[40:43], v[96:99]
ds_read_b64_tr_b16 v[18:19], v66 offset:4608
v_cvt_pk_bf16_f32 v45, v162, v163
v_mfma_f32_16x16x32_bf16 v[100:103], v[28:31], a[44:47], v[100:103]
ds_read_b64_tr_b16 v[20:21], v66 offset:9216
v_cvt_pk_bf16_f32 v46, v164, v165
v_mfma_f32_16x16x32_bf16 v[104:107], v[0:3], a[16:19], v[104:107]
ds_read_b64_tr_b16 v[22:23], v66 offset:13824
v_cvt_pk_bf16_f32 v47, v166, v167
v_mfma_f32_16x16x32_bf16 v[108:111], v[0:3], a[20:23], v[108:111]
ds_read_b64_tr_b16 v[24:25], v66 offset:18432
s_waitcnt lgkmcnt(7)
v_mfma_f32_16x16x32_bf16 v[104:107], v[4:7], a[24:27], v[104:107]
ds_read_b64_tr_b16 v[26:27], v66 offset:23040
buffer_store_dwordx4 v[44:47], v237, s[24:27], s43 offen offset:2048 sc1
v_mfma_f32_16x16x32_bf16 v[108:111], v[4:7], a[28:31], v[108:111]
ds_read_b64_tr_b16 v[28:29], v66 offset:27648
v_mfma_f32_16x16x32_bf16 v[104:107], v[8:11], a[32:35], v[104:107]
ds_read_b64_tr_b16 v[30:31], v66 offset:32256
v_mfma_f32_16x16x32_bf16 v[108:111], v[8:11], a[36:39], v[108:111]
s_waitcnt lgkmcnt(6)
v_mfma_f32_16x16x32_bf16 v[104:107], v[12:15], a[40:43], v[104:107]
v_mfma_f32_16x16x32_bf16 v[108:111], v[12:15], a[44:47], v[108:111]
v_mfma_f32_16x16x32_bf16 v[112:115], v[16:19], a[16:19], v[112:115]
v_mfma_f32_16x16x32_bf16 v[116:119], v[16:19], a[20:23], v[116:119]
s_waitcnt lgkmcnt(2)
v_mfma_f32_16x16x32_bf16 v[112:115], v[20:23], a[24:27], v[112:115]
v_mfma_f32_16x16x32_bf16 v[116:119], v[20:23], a[28:31], v[116:119]
v_mfma_f32_16x16x32_bf16 v[112:115], v[24:27], a[32:35], v[112:115]
v_mfma_f32_16x16x32_bf16 v[116:119], v[24:27], a[36:39], v[116:119]
s_waitcnt lgkmcnt(0)
v_mfma_f32_16x16x32_bf16 v[112:115], v[28:31], a[40:43], v[112:115]
v_mfma_f32_16x16x32_bf16 v[116:119], v[28:31], a[44:47], v[116:119]
s_nop 7
v_and_b32 v178, 31, v242
v_mul_u32_u24 v178, 2304, v178
v_lshrrev_b32 v179, 5, v242
v_lshl_add_u32 v64, v179, 4, v178
s_mul_i32 s7, s47, 331776
s_mul_i32 s6, s50, 288
s_add_u32 s7, s7, s6
s_mul_i32 s6, s48, 1152
s_add_u32 s7, s7, s6
s_lshl_b32 s6, s38, 6
s_add_u32 s7, s7, s6
s_mul_i32 s6, s38, 73728
s_add_u32 s7, s7, s6
s_add_u32 s45, s7, 0
s_add_u32 s46, s7, 32
s_add_u32 s51, s7, 64
s_add_u32 s58, s58, 0
s_waitcnt vmcnt(0)
s_lshl_b32 s3, s38, 4
s_add_u32 s63, s63, s3
s_add_u32 s66, s63, 0
v_mov_b32 v185, 1
buffer_load_dwordx4 v[180:183], v243, s[24:27], s63 offen sc1
s_mov_b64 exec, 1
buffer_store_dword v185, v243, s[24:27], s66 offen sc1
s_mov_b64 exec, -1
s_mov_b32 s5, 0x20000
s_waitcnt vmcnt(1)
CL16:
v_min3_u32 v184, v181, v182, v183
s_nop 0
v_readfirstlane_b32 s66, v184
s_nop 0
s_cmp_ge_u32 s66, 1
s_cbranch_scc1 CE16
buffer_load_dwordx4 v[180:183], v243, s[24:27], s63 offen sc1
s_waitcnt vmcnt(0)
s_sub_u32 s5, s5, 1
s_cbranch_scc0 CL16
CE16:
s_add_u32 s3, s58, 12288
buffer_load_dwordx4 v[0:3], v237, s[24:27], s3 offen offset:0 sc1
s_add_u32 s3, s58, 24576
buffer_load_dwordx4 v[4:7], v237, s[24:27], s3 offen offset:0 sc1
s_add_u32 s3, s58, 36864
buffer_load_dwordx4 v[8:11], v237, s[24:27], s3 offen offset:0 sc1
s_add_u32 s3, s58, 12288
buffer_load_dwordx4 v[12:15], v237, s[24:27], s3 offen offset:1024 sc1
s_add_u32 s3, s58, 24576
buffer_load_dwordx4 v[16:19], v237, s[24:27], s3 offen offset:1024 sc1
s_add_u32 s3, s58, 36864
buffer_load_dwordx4 v[20:23], v237, s[24:27], s3 offen offset:1024 sc1
s_add_u32 s3, s58, 12288
buffer_load_dwordx4 v[24:27], v237, s[24:27], s3 offen offset:2048 sc1
s_add_u32 s3, s58, 24576
buffer_load_dwordx4 v[28:31], v237, s[24:27], s3 offen offset:2048 sc1
s_add_u32 s3, s58, 36864
buffer_load_dwordx4 v[32:35], v237, s[24:27], s3 offen offset:2048 sc1
s_mov_b32 s3, 0xffff0000
s_waitcnt vmcnt(8)
v_lshlrev_b32 v178, 16, v0
v_and_b32 v179, s3, v0
v_pk_add_f32 v[96:97], v[96:97], v[178:179]
v_lshlrev_b32 v180, 16, v1
v_and_b32 v181, s3, v1
v_pk_add_f32 v[98:99], v[98:99], v[180:181]
v_lshlrev_b32 v182, 16, v2
v_and_b32 v183, s3, v2
v_pk_add_f32 v[100:101], v[100:101], v[182:183]
v_lshlrev_b32 v178, 16, v3
v_and_b32 v179, s3, v3
v_pk_add_f32 v[102:103], v[102:103], v[178:179]
s_waitcnt vmcnt(7)
v_lshlrev_b32 v180, 16, v4
v_and_b32 v181, s3, v4
v_pk_add_f32 v[96:97], v[96:97], v[180:181]
v_lshlrev_b32 v182, 16, v5
v_and_b32 v183, s3, v5
v_pk_add_f32 v[98:99], v[98:99], v[182:183]
v_lshlrev_b32 v178, 16, v6
v_and_b32 v179, s3, v6
v_pk_add_f32 v[100:101], v[100:101], v[178:179]
v_lshlrev_b32 v180, 16, v7
v_and_b32 v181, s3, v7
v_pk_add_f32 v[102:103], v[102:103], v[180:181]
s_waitcnt vmcnt(6)
v_lshlrev_b32 v182, 16, v8
v_and_b32 v183, s3, v8
v_pk_add_f32 v[96:97], v[96:97], v[182:183]
v_lshlrev_b32 v178, 16, v9
v_and_b32 v179, s3, v9
v_pk_add_f32 v[98:99], v[98:99], v[178:179]
v_lshlrev_b32 v180, 16, v10
v_and_b32 v181, s3, v10
v_pk_add_f32 v[100:101], v[100:101], v[180:181]
v_lshlrev_b32 v182, 16, v11
v_and_b32 v183, s3, v11
v_pk_add_f32 v[102:103], v[102:103], v[182:183]
v_cvt_pk_bf16_f32 v96, v96, v97
v_cvt_pk_bf16_f32 v97, v98, v99
v_cvt_pk_bf16_f32 v98, v100, v101
v_cvt_pk_bf16_f32 v99, v102, v103
s_nop 1
v_permlane16_swap_b32 v96, v98
v_permlane16_swap_b32 v97, v99
buffer_store_dwordx4 v[96:99], v64, s[32:35], s45 offen
s_waitcnt vmcnt(6)
v_lshlrev_b32 v178, 16, v12
v_and_b32 v179, s3, v12
v_pk_add_f32 v[104:105], v[104:105], v[178:179]
v_lshlrev_b32 v180, 16, v13
v_and_b32 v181, s3, v13
v_pk_add_f32 v[106:107], v[106:107], v[180:181]
v_lshlrev_b32 v182, 16, v14
v_and_b32 v183, s3, v14
v_pk_add_f32 v[108:109], v[108:109], v[182:183]
v_lshlrev_b32 v178, 16, v15
v_and_b32 v179, s3, v15
v_pk_add_f32 v[110:111], v[110:111], v[178:179]
s_waitcnt vmcnt(5)
v_lshlrev_b32 v180, 16, v16
v_and_b32 v181, s3, v16
v_pk_add_f32 v[104:105], v[104:105], v[180:181]
v_lshlrev_b32 v182, 16, v17
v_and_b32 v183, s3, v17
v_pk_add_f32 v[106:107], v[106:107], v[182:183]
v_lshlrev_b32 v178, 16, v18
v_and_b32 v179, s3, v18
v_pk_add_f32 v[108:109], v[108:109], v[178:179]
v_lshlrev_b32 v180, 16, v19
v_and_b32 v181, s3, v19
v_pk_add_f32 v[110:111], v[110:111], v[180:181]
s_waitcnt vmcnt(4)
v_lshlrev_b32 v182, 16, v20
v_and_b32 v183, s3, v20
v_pk_add_f32 v[104:105], v[104:105], v[182:183]
v_lshlrev_b32 v178, 16, v21
v_and_b32 v179, s3, v21
v_pk_add_f32 v[106:107], v[106:107], v[178:179]
v_lshlrev_b32 v180, 16, v22
v_and_b32 v181, s3, v22
v_pk_add_f32 v[108:109], v[108:109], v[180:181]
v_lshlrev_b32 v182, 16, v23
v_and_b32 v183, s3, v23
v_pk_add_f32 v[110:111], v[110:111], v[182:183]
v_cvt_pk_bf16_f32 v104, v104, v105
v_cvt_pk_bf16_f32 v105, v106, v107
v_cvt_pk_bf16_f32 v106, v108, v109
v_cvt_pk_bf16_f32 v107, v110, v111
s_nop 1
v_permlane16_swap_b32 v104, v106
v_permlane16_swap_b32 v105, v107
buffer_store_dwordx4 v[104:107], v64, s[32:35], s46 offen
s_waitcnt vmcnt(4)
v_lshlrev_b32 v178, 16, v24
v_and_b32 v179, s3, v24
v_pk_add_f32 v[112:113], v[112:113], v[178:179]
v_lshlrev_b32 v180, 16, v25
v_and_b32 v181, s3, v25
v_pk_add_f32 v[114:115], v[114:115], v[180:181]
v_lshlrev_b32 v182, 16, v26
v_and_b32 v183, s3, v26
v_pk_add_f32 v[116:117], v[116:117], v[182:183]
v_lshlrev_b32 v178, 16, v27
v_and_b32 v179, s3, v27
v_pk_add_f32 v[118:119], v[118:119], v[178:179]
s_waitcnt vmcnt(3)
v_lshlrev_b32 v180, 16, v28
v_and_b32 v181, s3, v28
v_pk_add_f32 v[112:113], v[112:113], v[180:181]
v_lshlrev_b32 v182, 16, v29
v_and_b32 v183, s3, v29
v_pk_add_f32 v[114:115], v[114:115], v[182:183]
v_lshlrev_b32 v178, 16, v30
v_and_b32 v179, s3, v30
v_pk_add_f32 v[116:117], v[116:117], v[178:179]
v_lshlrev_b32 v180, 16, v31
v_and_b32 v181, s3, v31
v_pk_add_f32 v[118:119], v[118:119], v[180:181]
s_waitcnt vmcnt(2)
v_lshlrev_b32 v182, 16, v32
v_and_b32 v183, s3, v32
v_pk_add_f32 v[112:113], v[112:113], v[182:183]
v_lshlrev_b32 v178, 16, v33
v_and_b32 v179, s3, v33
v_pk_add_f32 v[114:115], v[114:115], v[178:179]
v_lshlrev_b32 v180, 16, v34
v_and_b32 v181, s3, v34
v_pk_add_f32 v[116:117], v[116:117], v[180:181]
v_lshlrev_b32 v182, 16, v35
v_and_b32 v183, s3, v35
v_pk_add_f32 v[118:119], v[118:119], v[182:183]
v_cvt_pk_bf16_f32 v112, v112, v113
v_cvt_pk_bf16_f32 v113, v114, v115
v_cvt_pk_bf16_f32 v114, v116, v117
v_cvt_pk_bf16_f32 v115, v118, v119
s_nop 1
v_permlane16_swap_b32 v112, v114
v_permlane16_swap_b32 v113, v115
buffer_store_dwordx4 v[112:115], v64, s[32:35], s51 offen
s_endpgm
FIN1:
s_lshl_b32 s6, s48, 3
s_add_u32 s6, s6, s47
ds_read_b64_tr_b16 v[0:1], v64 offset:0
ds_read_b64_tr_b16 v[2:3], v64 offset:4608
ds_read_b128 v[76:79], v73 offset:12288
ds_read_b64_tr_b16 v[4:5], v64 offset:9216
ds_read_b64_tr_b16 v[6:7], v64 offset:13824
ds_read_b128 v[80:83], v73 offset:13312
ds_read_b64_tr_b16 v[8:9], v64 offset:18432
ds_read_b64_tr_b16 v[10:11], v64 offset:23040
ds_read_b128 v[84:87], v73 offset:14336
ds_read_b64_tr_b16 v[12:13], v64 offset:27648
ds_read_b64_tr_b16 v[14:15], v64 offset:32256
ds_read_b128 v[88:91], v73 offset:15360
ds_read_b64_tr_b16 v[16:17], v65 offset:0
ds_read_b64_tr_b16 v[18:19], v65 offset:4608
ds_read_b64_tr_b16 v[20:21], v65 offset:9216
ds_read_b64_tr_b16 v[22:23], v65 offset:13824
s_lshl_b32 s6, s6, 2
s_add_u32 s6, s6, s50
s_lshl_b32 s6, s6, 6
s_add_u32 s6, s6, s38
s_mul_i32 s58, s6, 3072
s_add_u32 s58, s58, 18874368
s_add_u32 s42, s58, 12288
s_add_u32 s43, s58, 110592
s_add_u32 s44, s58, 159744
s_waitcnt lgkmcnt(14)
v_mfma_f32_16x16x32_bf16 v[96:99], v[0:3], a[16:19], v[96:99]
ds_read_b64_tr_b16 v[24:25], v65 offset:18432
v_mfma_f32_16x16x32_bf16 v[100:103], v[0:3], a[20:23], v[100:103]
ds_read_b64_tr_b16 v[26:27], v65 offset:23040
s_waitcnt lgkmcnt(13)
v_mfma_f32_16x16x32_bf16 v[168:171], v[0:3], v[76:79], v[168:171]
v_mfma_f32_16x16x32_bf16 v[96:99], v[4:7], a[24:27], v[96:99]
ds_read_b64_tr_b16 v[28:29], v65 offset:27648
v_mfma_f32_16x16x32_bf16 v[100:103], v[4:7], a[28:31], v[100:103]
ds_read_b64_tr_b16 v[30:31], v65 offset:32256
s_waitcnt lgkmcnt(12)
v_mfma_f32_16x16x32_bf16 v[168:171], v[4:7], v[80:83], v[168:171]
v_mfma_f32_16x16x32_bf16 v[96:99], v[8:11], a[32:35], v[96:99]
ds_read_b64_tr_b16 v[0:1], v66 offset:0
v_mfma_f32_16x16x32_bf16 v[100:103], v[8:11], a[36:39], v[100:103]
ds_read_b64_tr_b16 v[2:3], v66 offset:4608
s_waitcnt lgkmcnt(11)
v_mfma_f32_16x16x32_bf16 v[168:171], v[8:11], v[84:87], v[168:171]
v_mfma_f32_16x16x32_bf16 v[96:99], v[12:15], a[40:43], v[96:99]
ds_read_b64_tr_b16 v[4:5], v66 offset:9216
v_mfma_f32_16x16x32_bf16 v[100:103], v[12:15], a[44:47], v[100:103]
ds_read_b64_tr_b16 v[6:7], v66 offset:13824
s_waitcnt lgkmcnt(10)
v_mfma_f32_16x16x32_bf16 v[168:171], v[12:15], v[88:91], v[168:171]
v_mfma_f32_16x16x32_bf16 v[104:107], v[16:19], a[16:19], v[104:107]
ds_read_b64_tr_b16 v[8:9], v66 offset:18432
v_mfma_f32_16x16x32_bf16 v[108:111], v[16:19], a[20:23], v[108:111]
ds_read_b64_tr_b16 v[10:11], v66 offset:23040
v_mfma_f32_16x16x32_bf16 v[172:175], v[16:19], v[76:79], v[172:175]
s_waitcnt lgkmcnt(10)
v_mfma_f32_16x16x32_bf16 v[104:107], v[20:23], a[24:27], v[104:107]
ds_read_b64_tr_b16 v[12:13], v66 offset:27648
v_cvt_pk_bf16_f32 v32, v96, v97
v_mfma_f32_16x16x32_bf16 v[108:111], v[20:23], a[28:31], v[108:111]
ds_read_b64_tr_b16 v[14:15], v66 offset:32256
v_cvt_pk_bf16_f32 v33, v98, v99
v_mfma_f32_16x16x32_bf16 v[172:175], v[20:23], v[80:83], v[172:175]
v_cvt_pk_bf16_f32 v34, v100, v101
s_waitcnt lgkmcnt(8)
v_mfma_f32_16x16x32_bf16 v[104:107], v[24:27], a[32:35], v[104:107]
ds_read_b64_tr_b16 v[16:17], v70 offset:0
v_cvt_pk_bf16_f32 v35, v102, v103
v_mfma_f32_16x16x32_bf16 v[108:111], v[24:27], a[36:39], v[108:111]
ds_read_b64_tr_b16 v[18:19], v70 offset:4608
buffer_store_dwordx4 v[32:35], v237, s[24:27], s42 offen offset:0 sc1
v_mfma_f32_16x16x32_bf16 v[172:175], v[24:27], v[84:87], v[172:175]
v_mfma_f32_16x16x32_bf16 v[104:107], v[28:31], a[40:43], v[104:107]
ds_read_b64_tr_b16 v[20:21], v70 offset:9216
v_mfma_f32_16x16x32_bf16 v[108:111], v[28:31], a[44:47], v[108:111]
ds_read_b64_tr_b16 v[22:23], v70 offset:13824
v_mfma_f32_16x16x32_bf16 v[172:175], v[28:31], v[88:91], v[172:175]
s_waitcnt lgkmcnt(8)
v_mfma_f32_16x16x32_bf16 v[112:115], v[0:3], a[16:19], v[112:115]
ds_read_b64_tr_b16 v[24:25], v70 offset:18432
v_mfma_f32_16x16x32_bf16 v[116:119], v[0:3], a[20:23], v[116:119]
ds_read_b64_tr_b16 v[26:27], v70 offset:23040
v_mfma_f32_16x16x32_bf16 v[60:63], v[0:3], v[76:79], v[60:63]
v_mfma_f32_16x16x32_bf16 v[112:115], v[4:7], a[24:27], v[112:115]
ds_read_b64_tr_b16 v[28:29], v70 offset:27648
v_cvt_pk_bf16_f32 v36, v104, v105
v_mfma_f32_16x16x32_bf16 v[116:119], v[4:7], a[28:31], v[116:119]
ds_read_b64_tr_b16 v[30:31], v70 offset:32256
v_cvt_pk_bf16_f32 v37, v106, v107
v_mfma_f32_16x16x32_bf16 v[60:63], v[4:7], v[80:83], v[60:63]
v_cvt_pk_bf16_f32 v38, v108, v109
s_waitcnt lgkmcnt(8)
v_mfma_f32_16x16x32_bf16 v[112:115], v[8:11], a[32:35], v[112:115]
ds_read_b64_tr_b16 v[0:1], v71 offset:0
v_cvt_pk_bf16_f32 v39, v110, v111
v_mfma_f32_16x16x32_bf16 v[116:119], v[8:11], a[36:39], v[116:119]
ds_read_b64_tr_b16 v[2:3], v71 offset:4608
buffer_store_dwordx4 v[36:39], v237, s[24:27], s42 offen offset:1024 sc1
v_mfma_f32_16x16x32_bf16 v[60:63], v[8:11], v[84:87], v[60:63]
v_cvt_pk_bf16_f32 v40, v168, v169
v_cvt_pk_bf16_f32 v41, v170, v171
v_mfma_f32_16x16x32_bf16 v[112:115], v[12:15], a[40:43], v[112:115]
ds_read_b64_tr_b16 v[4:5], v71 offset:9216
v_cvt_pk_bf16_f32 v42, v172, v173
v_mfma_f32_16x16x32_bf16 v[116:119], v[12:15], a[44:47], v[116:119]
ds_read_b64_tr_b16 v[6:7], v71 offset:13824
v_cvt_pk_bf16_f32 v43, v174, v175
v_mfma_f32_16x16x32_bf16 v[60:63], v[12:15], v[88:91], v[60:63]
buffer_store_dwordx4 v[40:43], v237, s[24:27], s44 offen offset:0 sc1
s_waitcnt lgkmcnt(8)
v_mfma_f32_16x16x32_bf16 v[144:147], v[16:19], a[16:19], v[144:147]
ds_read_b64_tr_b16 v[8:9], v71 offset:18432
v_mfma_f32_16x16x32_bf16 v[148:151], v[16:19], a[20:23], v[148:151]
ds_read_b64_tr_b16 v[10:11], v71 offset:23040
v_mfma_f32_16x16x32_bf16 v[144:147], v[20:23], a[24:27], v[144:147]
ds_read_b64_tr_b16 v[12:13], v71 offset:27648
v_mfma_f32_16x16x32_bf16 v[148:151], v[20:23], a[28:31], v[148:151]
ds_read_b64_tr_b16 v[14:15], v71 offset:32256
s_waitcnt lgkmcnt(8)
v_mfma_f32_16x16x32_bf16 v[144:147], v[24:27], a[32:35], v[144:147]
ds_read_b64_tr_b16 v[16:17], v72 offset:0
v_cvt_pk_bf16_f32 v44, v112, v113
v_mfma_f32_16x16x32_bf16 v[148:151], v[24:27], a[36:39], v[148:151]
ds_read_b64_tr_b16 v[18:19], v72 offset:4608
v_cvt_pk_bf16_f32 v45, v114, v115
v_mfma_f32_16x16x32_bf16 v[144:147], v[28:31], a[40:43], v[144:147]
ds_read_b64_tr_b16 v[20:21], v72 offset:9216
v_cvt_pk_bf16_f32 v46, v116, v117
v_mfma_f32_16x16x32_bf16 v[148:151], v[28:31], a[44:47], v[148:151]
ds_read_b64_tr_b16 v[22:23], v72 offset:13824
s_waitcnt lgkmcnt(8)
v_mfma_f32_16x16x32_bf16 v[152:155], v[0:3], a[16:19], v[152:155]
ds_read_b64_tr_b16 v[24:25], v72 offset:18432
v_cvt_pk_bf16_f32 v47, v118, v119
v_mfma_f32_16x16x32_bf16 v[156:159], v[0:3], a[20:23], v[156:159]
ds_read_b64_tr_b16 v[26:27], v72 offset:23040
buffer_store_dwordx4 v[44:47], v237, s[24:27], s42 offen offset:2048 sc1
v_mfma_f32_16x16x32_bf16 v[152:155], v[4:7], a[24:27], v[152:155]
ds_read_b64_tr_b16 v[28:29], v72 offset:27648
v_cvt_pk_bf16_f32 v32, v60, v61
v_mfma_f32_16x16x32_bf16 v[156:159], v[4:7], a[28:31], v[156:159]
ds_read_b64_tr_b16 v[30:31], v72 offset:32256
s_waitcnt lgkmcnt(8)
v_mfma_f32_16x16x32_bf16 v[152:155], v[8:11], a[32:35], v[152:155]
ds_read_b64_tr_b16 v[0:1], v67 offset:0
v_cvt_pk_bf16_f32 v33, v62, v63
v_mfma_f32_16x16x32_bf16 v[156:159], v[8:11], a[36:39], v[156:159]
ds_read_b64_tr_b16 v[2:3], v67 offset:4608
buffer_store_dwordx4 v[32:35], v237, s[24:27], s44 offen offset:1024 sc1
v_mfma_f32_16x16x32_bf16 v[152:155], v[12:15], a[40:43], v[152:155]
ds_read_b64_tr_b16 v[4:5], v67 offset:9216
v_cvt_pk_bf16_f32 v36, v144, v145
v_mfma_f32_16x16x32_bf16 v[156:159], v[12:15], a[44:47], v[156:159]
ds_read_b64_tr_b16 v[6:7], v67 offset:13824
s_waitcnt lgkmcnt(8)
v_mfma_f32_16x16x32_bf16 v[160:163], v[16:19], a[16:19], v[160:163]
ds_read_b64_tr_b16 v[8:9], v67 offset:18432
v_cvt_pk_bf16_f32 v37, v146, v147
v_mfma_f32_16x16x32_bf16 v[164:167], v[16:19], a[20:23], v[164:167]
ds_read_b64_tr_b16 v[10:11], v67 offset:23040
v_cvt_pk_bf16_f32 v38, v148, v149
v_mfma_f32_16x16x32_bf16 v[160:163], v[20:23], a[24:27], v[160:163]
ds_read_b64_tr_b16 v[12:13], v67 offset:27648
v_cvt_pk_bf16_f32 v39, v150, v151
v_mfma_f32_16x16x32_bf16 v[164:167], v[20:23], a[28:31], v[164:167]
ds_read_b64_tr_b16 v[14:15], v67 offset:32256
s_waitcnt lgkmcnt(8)
v_mfma_f32_16x16x32_bf16 v[160:163], v[24:27], a[32:35], v[160:163]
ds_read_b64_tr_b16 v[16:17], v68 offset:0
buffer_store_dwordx4 v[36:39], v237, s[24:27], s43 offen offset:0 sc1
v_mfma_f32_16x16x32_bf16 v[164:167], v[24:27], a[36:39], v[164:167]
ds_read_b64_tr_b16 v[18:19], v68 offset:4608
v_cvt_pk_bf16_f32 v40, v152, v153
v_mfma_f32_16x16x32_bf16 v[160:163], v[28:31], a[40:43], v[160:163]
ds_read_b64_tr_b16 v[20:21], v68 offset:9216
v_cvt_pk_bf16_f32 v41, v154, v155
v_mfma_f32_16x16x32_bf16 v[164:167], v[28:31], a[44:47], v[164:167]
ds_read_b64_tr_b16 v[22:23], v68 offset:13824
s_waitcnt lgkmcnt(8)
v_mfma_f32_16x16x32_bf16 v[120:123], v[0:3], a[16:19], v[120:123]
ds_read_b64_tr_b16 v[24:25], v68 offset:18432
v_cvt_pk_bf16_f32 v42, v156, v157
v_mfma_f32_16x16x32_bf16 v[124:127], v[0:3], a[20:23], v[124:127]
ds_read_b64_tr_b16 v[26:27], v68 offset:23040
v_cvt_pk_bf16_f32 v43, v158, v159
v_mfma_f32_16x16x32_bf16 v[120:123], v[4:7], a[24:27], v[120:123]
ds_read_b64_tr_b16 v[28:29], v68 offset:27648
buffer_store_dwordx4 v[40:43], v237, s[24:27], s43 offen offset:1024 sc1
v_mfma_f32_16x16x32_bf16 v[124:127], v[4:7], a[28:31], v[124:127]
ds_read_b64_tr_b16 v[30:31], v68 offset:32256
s_waitcnt lgkmcnt(8)
v_mfma_f32_16x16x32_bf16 v[120:123], v[8:11], a[32:35], v[120:123]
ds_read_b64_tr_b16 v[0:1], v69 offset:0
v_cvt_pk_bf16_f32 v44, v160, v161
v_mfma_f32_16x16x32_bf16 v[124:127], v[8:11], a[36:39], v[124:127]
ds_read_b64_tr_b16 v[2:3], v69 offset:4608
v_cvt_pk_bf16_f32 v45, v162, v163
v_mfma_f32_16x16x32_bf16 v[120:123], v[12:15], a[40:43], v[120:123]
ds_read_b64_tr_b16 v[4:5], v69 offset:9216
v_cvt_pk_bf16_f32 v46, v164, v165
v_mfma_f32_16x16x32_bf16 v[124:127], v[12:15], a[44:47], v[124:127]
ds_read_b64_tr_b16 v[6:7], v69 offset:13824
s_waitcnt lgkmcnt(8)
v_mfma_f32_16x16x32_bf16 v[128:131], v[16:19], a[16:19], v[128:131]
ds_read_b64_tr_b16 v[8:9], v69 offset:18432
v_cvt_pk_bf16_f32 v47, v166, v167
v_mfma_f32_16x16x32_bf16 v[132:135], v[16:19], a[20:23], v[132:135]
ds_read_b64_tr_b16 v[10:11], v69 offset:23040
buffer_store_dwordx4 v[44:47], v237, s[24:27], s43 offen offset:2048 sc1
v_mfma_f32_16x16x32_bf16 v[128:131], v[20:23], a[24:27], v[128:131]
ds_read_b64_tr_b16 v[12:13], v69 offset:27648
v_mfma_f32_16x16x32_bf16 v[132:135], v[20:23], a[28:31], v[132:135]
ds_read_b64_tr_b16 v[14:15], v69 offset:32256
s_waitcnt lgkmcnt(8)
v_mfma_f32_16x16x32_bf16 v[128:131], v[24:27], a[32:35], v[128:131]
v_mfma_f32_16x16x32_bf16 v[132:135], v[24:27], a[36:39], v[132:135]
v_mfma_f32_16x16x32_bf16 v[128:131], v[28:31], a[40:43], v[128:131]
v_mfma_f32_16x16x32_bf16 v[132:135], v[28:31], a[44:47], v[132:135]
s_waitcnt lgkmcnt(4)
v_mfma_f32_16x16x32_bf16 v[136:139], v[0:3], a[16:19], v[136:139]
v_mfma_f32_16x16x32_bf16 v[140:143], v[0:3], a[20:23], v[140:143]
v_mfma_f32_16x16x32_bf16 v[136:139], v[4:7], a[24:27], v[136:139]
v_mfma_f32_16x16x32_bf16 v[140:143], v[4:7], a[28:31], v[140:143]
s_waitcnt lgkmcnt(0)
v_mfma_f32_16x16x32_bf16 v[136:139], v[8:11], a[32:35], v[136:139]
v_mfma_f32_16x16x32_bf16 v[140:143], v[8:11], a[36:39], v[140:143]
v_mfma_f32_16x16x32_bf16 v[136:139], v[12:15], a[40:43], v[136:139]
v_mfma_f32_16x16x32_bf16 v[140:143], v[12:15], a[44:47], v[140:143]
s_nop 7
v_and_b32 v178, 31, v242
v_mul_u32_u24 v178, 2304, v178
v_lshrrev_b32 v179, 5, v242
v_lshl_add_u32 v64, v179, 4, v178
s_mul_i32 s7, s47, 331776
s_mul_i32 s6, s50, 288
s_add_u32 s7, s7, s6
s_mul_i32 s6, s48, 1152
s_add_u32 s7, s7, s6
s_lshl_b32 s6, s38, 6
s_add_u32 s7, s7, s6
s_mul_i32 s6, s38, 73728
s_add_u32 s7, s7, s6
s_cmp_ge_u32 s38, 3
s_cselect_b32 s3, 4294967008, 0
s_add_u32 s3, s3, 96
s_add_u32 s45, s7, s3
s_cmp_ge_u32 s38, 3
s_cselect_b32 s3, 4294967008, 0
s_add_u32 s3, s3, 128
s_add_u32 s46, s7, s3
s_cmp_ge_u32 s38, 2
s_cselect_b32 s3, 4294967008, 0
s_add_u32 s3, s3, 160
s_add_u32 s51, s7, s3
s_add_u32 s58, s58, 49152
s_waitcnt vmcnt(0)
s_lshl_b32 s3, s38, 4
s_add_u32 s63, s63, s3
s_add_u32 s66, s63, 4
v_mov_b32 v185, 1
buffer_load_dwordx4 v[180:183], v243, s[24:27], s63 offen sc1
s_mov_b64 exec, 1
buffer_store_dword v185, v243, s[24:27], s66 offen sc1
s_mov_b64 exec, -1
s_mov_b32 s5, 0x20000
s_waitcnt vmcnt(1)
CL17:
v_min3_u32 v184, v180, v182, v183
s_nop 0
v_readfirstlane_b32 s66, v184
s_nop 0
s_cmp_ge_u32 s66, 1
s_cbranch_scc1 CE17
buffer_load_dwordx4 v[180:183], v243, s[24:27], s63 offen sc1
s_waitcnt vmcnt(0)
s_sub_u32 s5, s5, 1
s_cbranch_scc0 CL17
CE17:
s_add_u32 s3, s58, 24576
buffer_load_dwordx4 v[0:3], v237, s[24:27], s3 offen offset:0 sc1
s_add_u32 s3, s58, 36864
buffer_load_dwordx4 v[4:7], v237, s[24:27], s3 offen offset:0 sc1
s_add_u32 s3, s58, 0
buffer_load_dwordx4 v[8:11], v237, s[24:27], s3 offen offset:0 sc1
s_add_u32 s3, s58, 24576
buffer_load_dwordx4 v[12:15], v237, s[24:27], s3 offen offset:1024 sc1
s_add_u32 s3, s58, 36864
buffer_load_dwordx4 v[16:19], v237, s[24:27], s3 offen offset:1024 sc1
s_add_u32 s3, s58, 0
buffer_load_dwordx4 v[20:23], v237, s[24:27], s3 offen offset:1024 sc1
s_add_u32 s3, s58, 24576
buffer_load_dwordx4 v[24:27], v237, s[24:27], s3 offen offset:2048 sc1
s_add_u32 s3, s58, 36864
buffer_load_dwordx4 v[28:31], v237, s[24:27], s3 offen offset:2048 sc1
s_add_u32 s3, s58, 0
buffer_load_dwordx4 v[32:35], v237, s[24:27], s3 offen offset:2048 sc1
s_mov_b32 s3, 0xffff0000
s_waitcnt vmcnt(8)
v_lshlrev_b32 v178, 16, v0
v_and_b32 v179, s3, v0
v_pk_add_f32 v[120:121], v[120:121], v[178:179]
v_lshlrev_b32 v180, 16, v1
v_and_b32 v181, s3, v1
v_pk_add_f32 v[122:123], v[122:123], v[180:181]
v_lshlrev_b32 v182, 16, v2
v_and_b32 v183, s3, v2
v_pk_add_f32 v[124:125], v[124:125], v[182:183]
v_lshlrev_b32 v178, 16, v3
v_and_b32 v179, s3, v3
v_pk_add_f32 v[126:127], v[126:127], v[178:179]
s_waitcnt vmcnt(7)
v_lshlrev_b32 v180, 16, v4
v_and_b32 v181, s3, v4
v_pk_add_f32 v[120:121], v[120:121], v[180:181]
v_lshlrev_b32 v182, 16, v5
v_and_b32 v183, s3, v5
v_pk_add_f32 v[122:123], v[122:123], v[182:183]
v_lshlrev_b32 v178, 16, v6
v_and_b32 v179, s3, v6
v_pk_add_f32 v[124:125], v[124:125], v[178:179]
v_lshlrev_b32 v180, 16, v7
v_and_b32 v181, s3, v7
v_pk_add_f32 v[126:127], v[126:127], v[180:181]
s_waitcnt vmcnt(6)
v_lshlrev_b32 v182, 16, v8
v_and_b32 v183, s3, v8
v_pk_add_f32 v[120:121], v[120:121], v[182:183]
v_lshlrev_b32 v178, 16, v9
v_and_b32 v179, s3, v9
v_pk_add_f32 v[122:123], v[122:123], v[178:179]
v_lshlrev_b32 v180, 16, v10
v_and_b32 v181, s3, v10
v_pk_add_f32 v[124:125], v[124:125], v[180:181]
v_lshlrev_b32 v182, 16, v11
v_and_b32 v183, s3, v11
v_pk_add_f32 v[126:127], v[126:127], v[182:183]
v_cvt_pk_bf16_f32 v120, v120, v121
v_cvt_pk_bf16_f32 v121, v122, v123
v_cvt_pk_bf16_f32 v122, v124, v125
v_cvt_pk_bf16_f32 v123, v126, v127
s_nop 1
v_permlane16_swap_b32 v120, v122
v_permlane16_swap_b32 v121, v123
buffer_store_dwordx4 v[120:123], v64, s[32:35], s45 offen
s_waitcnt vmcnt(6)
v_lshlrev_b32 v178, 16, v12
v_and_b32 v179, s3, v12
v_pk_add_f32 v[128:129], v[128:129], v[178:179]
v_lshlrev_b32 v180, 16, v13
v_and_b32 v181, s3, v13
v_pk_add_f32 v[130:131], v[130:131], v[180:181]
v_lshlrev_b32 v182, 16, v14
v_and_b32 v183, s3, v14
v_pk_add_f32 v[132:133], v[132:133], v[182:183]
v_lshlrev_b32 v178, 16, v15
v_and_b32 v179, s3, v15
v_pk_add_f32 v[134:135], v[134:135], v[178:179]
s_waitcnt vmcnt(5)
v_lshlrev_b32 v180, 16, v16
v_and_b32 v181, s3, v16
v_pk_add_f32 v[128:129], v[128:129], v[180:181]
v_lshlrev_b32 v182, 16, v17
v_and_b32 v183, s3, v17
v_pk_add_f32 v[130:131], v[130:131], v[182:183]
v_lshlrev_b32 v178, 16, v18
v_and_b32 v179, s3, v18
v_pk_add_f32 v[132:133], v[132:133], v[178:179]
v_lshlrev_b32 v180, 16, v19
v_and_b32 v181, s3, v19
v_pk_add_f32 v[134:135], v[134:135], v[180:181]
s_waitcnt vmcnt(4)
v_lshlrev_b32 v182, 16, v20
v_and_b32 v183, s3, v20
v_pk_add_f32 v[128:129], v[128:129], v[182:183]
v_lshlrev_b32 v178, 16, v21
v_and_b32 v179, s3, v21
v_pk_add_f32 v[130:131], v[130:131], v[178:179]
v_lshlrev_b32 v180, 16, v22
v_and_b32 v181, s3, v22
v_pk_add_f32 v[132:133], v[132:133], v[180:181]
v_lshlrev_b32 v182, 16, v23
v_and_b32 v183, s3, v23
v_pk_add_f32 v[134:135], v[134:135], v[182:183]
v_cvt_pk_bf16_f32 v128, v128, v129
v_cvt_pk_bf16_f32 v129, v130, v131
v_cvt_pk_bf16_f32 v130, v132, v133
v_cvt_pk_bf16_f32 v131, v134, v135
s_nop 1
v_permlane16_swap_b32 v128, v130
v_permlane16_swap_b32 v129, v131
buffer_store_dwordx4 v[128:131], v64, s[32:35], s46 offen
s_waitcnt vmcnt(4)
v_lshlrev_b32 v178, 16, v24
v_and_b32 v179, s3, v24
v_pk_add_f32 v[136:137], v[136:137], v[178:179]
v_lshlrev_b32 v180, 16, v25
v_and_b32 v181, s3, v25
v_pk_add_f32 v[138:139], v[138:139], v[180:181]
v_lshlrev_b32 v182, 16, v26
v_and_b32 v183, s3, v26
v_pk_add_f32 v[140:141], v[140:141], v[182:183]
v_lshlrev_b32 v178, 16, v27
v_and_b32 v179, s3, v27
v_pk_add_f32 v[142:143], v[142:143], v[178:179]
s_waitcnt vmcnt(3)
v_lshlrev_b32 v180, 16, v28
v_and_b32 v181, s3, v28
v_pk_add_f32 v[136:137], v[136:137], v[180:181]
v_lshlrev_b32 v182, 16, v29
v_and_b32 v183, s3, v29
v_pk_add_f32 v[138:139], v[138:139], v[182:183]
v_lshlrev_b32 v178, 16, v30
v_and_b32 v179, s3, v30
v_pk_add_f32 v[140:141], v[140:141], v[178:179]
v_lshlrev_b32 v180, 16, v31
v_and_b32 v181, s3, v31
v_pk_add_f32 v[142:143], v[142:143], v[180:181]
s_waitcnt vmcnt(2)
v_lshlrev_b32 v182, 16, v32
v_and_b32 v183, s3, v32
v_pk_add_f32 v[136:137], v[136:137], v[182:183]
v_lshlrev_b32 v178, 16, v33
v_and_b32 v179, s3, v33
v_pk_add_f32 v[138:139], v[138:139], v[178:179]
v_lshlrev_b32 v180, 16, v34
v_and_b32 v181, s3, v34
v_pk_add_f32 v[140:141], v[140:141], v[180:181]
v_lshlrev_b32 v182, 16, v35
v_and_b32 v183, s3, v35
v_pk_add_f32 v[142:143], v[142:143], v[182:183]
v_cvt_pk_bf16_f32 v136, v136, v137
v_cvt_pk_bf16_f32 v137, v138, v139
v_cvt_pk_bf16_f32 v138, v140, v141
v_cvt_pk_bf16_f32 v139, v142, v143
s_nop 1
v_permlane16_swap_b32 v136, v138
v_permlane16_swap_b32 v137, v139
buffer_store_dwordx4 v[136:139], v64, s[32:35], s51 offen
s_endpgm
FIN2:
s_lshl_b32 s6, s48, 3
s_add_u32 s6, s6, s47
ds_read_b64_tr_b16 v[0:1], v64 offset:0
ds_read_b64_tr_b16 v[2:3], v64 offset:4608
ds_read_b128 v[76:79], v73 offset:12288
ds_read_b64_tr_b16 v[4:5], v64 offset:9216
ds_read_b64_tr_b16 v[6:7], v64 offset:13824
ds_read_b128 v[80:83], v73 offset:13312
ds_read_b64_tr_b16 v[8:9], v64 offset:18432
ds_read_b64_tr_b16 v[10:11], v64 offset:23040
ds_read_b128 v[84:87], v73 offset:14336
ds_read_b64_tr_b16 v[12:13], v64 offset:27648
ds_read_b64_tr_b16 v[14:15], v64 offset:32256
ds_read_b128 v[88:91], v73 offset:15360
ds_read_b64_tr_b16 v[16:17], v65 offset:0
ds_read_b64_tr_b16 v[18:19], v65 offset:4608
ds_read_b64_tr_b16 v[20:21], v65 offset:9216
ds_read_b64_tr_b16 v[22:23], v65 offset:13824
s_lshl_b32 s6, s6, 2
s_add_u32 s6, s6, s50
s_lshl_b32 s6, s6, 6
s_add_u32 s6, s6, s38
s_mul_i32 s58, s6, 3072
s_add_u32 s58, s58, 18874368
s_add_u32 s42, s58, 24576
s_add_u32 s43, s58, 73728
s_add_u32 s44, s58, 172032
s_waitcnt lgkmcnt(14)
v_mfma_f32_16x16x32_bf16 v[96:99], v[0:3], a[16:19], v[96:99]
ds_read_b64_tr_b16 v[24:25], v65 offset:18432
v_mfma_f32_16x16x32_bf16 v[100:103], v[0:3], a[20:23], v[100:103]
ds_read_b64_tr_b16 v[26:27], v65 offset:23040
s_waitcnt lgkmcnt(13)
v_mfma_f32_16x16x32_bf16 v[168:171], v[0:3], v[76:79], v[168:171]
v_mfma_f32_16x16x32_bf16 v[96:99], v[4:7], a[24:27], v[96:99]
ds_read_b64_tr_b16 v[28:29], v65 offset:27648
v_mfma_f32_16x16x32_bf16 v[100:103], v[4:7], a[28:31], v[100:103]
ds_read_b64_tr_b16 v[30:31], v65 offset:32256
s_waitcnt lgkmcnt(12)
v_mfma_f32_16x16x32_bf16 v[168:171], v[4:7], v[80:83], v[168:171]
v_mfma_f32_16x16x32_bf16 v[96:99], v[8:11], a[32:35], v[96:99]
ds_read_b64_tr_b16 v[0:1], v66 offset:0
v_mfma_f32_16x16x32_bf16 v[100:103], v[8:11], a[36:39], v[100:103]
ds_read_b64_tr_b16 v[2:3], v66 offset:4608
s_waitcnt lgkmcnt(11)
v_mfma_f32_16x16x32_bf16 v[168:171], v[8:11], v[84:87], v[168:171]
v_mfma_f32_16x16x32_bf16 v[96:99], v[12:15], a[40:43], v[96:99]
ds_read_b64_tr_b16 v[4:5], v66 offset:9216
v_mfma_f32_16x16x32_bf16 v[100:103], v[12:15], a[44:47], v[100:103]
ds_read_b64_tr_b16 v[6:7], v66 offset:13824
s_waitcnt lgkmcnt(10)
v_mfma_f32_16x16x32_bf16 v[168:171], v[12:15], v[88:91], v[168:171]
v_mfma_f32_16x16x32_bf16 v[104:107], v[16:19], a[16:19], v[104:107]
ds_read_b64_tr_b16 v[8:9], v66 offset:18432
v_mfma_f32_16x16x32_bf16 v[108:111], v[16:19], a[20:23], v[108:111]
ds_read_b64_tr_b16 v[10:11], v66 offset:23040
v_mfma_f32_16x16x32_bf16 v[172:175], v[16:19], v[76:79], v[172:175]
s_waitcnt lgkmcnt(10)
v_mfma_f32_16x16x32_bf16 v[104:107], v[20:23], a[24:27], v[104:107]
ds_read_b64_tr_b16 v[12:13], v66 offset:27648
v_cvt_pk_bf16_f32 v32, v96, v97
v_mfma_f32_16x16x32_bf16 v[108:111], v[20:23], a[28:31], v[108:111]
ds_read_b64_tr_b16 v[14:15], v66 offset:32256
v_cvt_pk_bf16_f32 v33, v98, v99
v_mfma_f32_16x16x32_bf16 v[172:175], v[20:23], v[80:83], v[172:175]
v_cvt_pk_bf16_f32 v34, v100, v101
s_waitcnt lgkmcnt(8)
v_mfma_f32_16x16x32_bf16 v[104:107], v[24:27], a[32:35], v[104:107]
ds_read_b64_tr_b16 v[16:17], v67 offset:0
v_cvt_pk_bf16_f32 v35, v102, v103
v_mfma_f32_16x16x32_bf16 v[108:111], v[24:27], a[36:39], v[108:111]
ds_read_b64_tr_b16 v[18:19], v67 offset:4608
buffer_store_dwordx4 v[32:35], v237, s[24:27], s42 offen offset:0 sc1
v_mfma_f32_16x16x32_bf16 v[172:175], v[24:27], v[84:87], v[172:175]
v_mfma_f32_16x16x32_bf16 v[104:107], v[28:31], a[40:43], v[104:107]
ds_read_b64_tr_b16 v[20:21], v67 offset:9216
v_mfma_f32_16x16x32_bf16 v[108:111], v[28:31], a[44:47], v[108:111]
ds_read_b64_tr_b16 v[22:23], v67 offset:13824
v_mfma_f32_16x16x32_bf16 v[172:175], v[28:31], v[88:91], v[172:175]
s_waitcnt lgkmcnt(8)
v_mfma_f32_16x16x32_bf16 v[112:115], v[0:3], a[16:19], v[112:115]
ds_read_b64_tr_b16 v[24:25], v67 offset:18432
v_mfma_f32_16x16x32_bf16 v[116:119], v[0:3], a[20:23], v[116:119]
ds_read_b64_tr_b16 v[26:27], v67 offset:23040
v_mfma_f32_16x16x32_bf16 v[60:63], v[0:3], v[76:79], v[60:63]
v_mfma_f32_16x16x32_bf16 v[112:115], v[4:7], a[24:27], v[112:115]
ds_read_b64_tr_b16 v[28:29], v67 offset:27648
v_cvt_pk_bf16_f32 v36, v104, v105
v_mfma_f32_16x16x32_bf16 v[116:119], v[4:7], a[28:31], v[116:119]
ds_read_b64_tr_b16 v[30:31], v67 offset:32256
v_cvt_pk_bf16_f32 v37, v106, v107
v_mfma_f32_16x16x32_bf16 v[60:63], v[4:7], v[80:83], v[60:63]
v_cvt_pk_bf16_f32 v38, v108, v109
s_waitcnt lgkmcnt(8)
v_mfma_f32_16x16x32_bf16 v[112:115], v[8:11], a[32:35], v[112:115]
ds_read_b64_tr_b16 v[0:1], v68 offset:0
v_cvt_pk_bf16_f32 v39, v110, v111
v_mfma_f32_16x16x32_bf16 v[116:119], v[8:11], a[36:39], v[116:119]
ds_read_b64_tr_b16 v[2:3], v68 offset:4608
buffer_store_dwordx4 v[36:39], v237, s[24:27], s42 offen offset:1024 sc1
v_mfma_f32_16x16x32_bf16 v[60:63], v[8:11], v[84:87], v[60:63]
v_cvt_pk_bf16_f32 v40, v168, v169
v_cvt_pk_bf16_f32 v41, v170, v171
v_mfma_f32_16x16x32_bf16 v[112:115], v[12:15], a[40:43], v[112:115]
ds_read_b64_tr_b16 v[4:5], v68 offset:9216
v_cvt_pk_bf16_f32 v42, v172, v173
v_mfma_f32_16x16x32_bf16 v[116:119], v[12:15], a[44:47], v[116:119]
ds_read_b64_tr_b16 v[6:7], v68 offset:13824
v_cvt_pk_bf16_f32 v43, v174, v175
v_mfma_f32_16x16x32_bf16 v[60:63], v[12:15], v[88:91], v[60:63]
buffer_store_dwordx4 v[40:43], v237, s[24:27], s44 offen offset:0 sc1
s_waitcnt lgkmcnt(8)
v_mfma_f32_16x16x32_bf16 v[120:123], v[16:19], a[16:19], v[120:123]
ds_read_b64_tr_b16 v[8:9], v68 offset:18432
v_mfma_f32_16x16x32_bf16 v[124:127], v[16:19], a[20:23], v[124:127]
ds_read_b64_tr_b16 v[10:11], v68 offset:23040
v_mfma_f32_16x16x32_bf16 v[120:123], v[20:23], a[24:27], v[120:123]
ds_read_b64_tr_b16 v[12:13], v68 offset:27648
v_mfma_f32_16x16x32_bf16 v[124:127], v[20:23], a[28:31], v[124:127]
ds_read_b64_tr_b16 v[14:15], v68 offset:32256
s_waitcnt lgkmcnt(8)
v_mfma_f32_16x16x32_bf16 v[120:123], v[24:27], a[32:35], v[120:123]
ds_read_b64_tr_b16 v[16:17], v69 offset:0
v_cvt_pk_bf16_f32 v44, v112, v113
v_mfma_f32_16x16x32_bf16 v[124:127], v[24:27], a[36:39], v[124:127]
ds_read_b64_tr_b16 v[18:19], v69 offset:4608
v_cvt_pk_bf16_f32 v45, v114, v115
v_mfma_f32_16x16x32_bf16 v[120:123], v[28:31], a[40:43], v[120:123]
ds_read_b64_tr_b16 v[20:21], v69 offset:9216
v_cvt_pk_bf16_f32 v46, v116, v117
v_mfma_f32_16x16x32_bf16 v[124:127], v[28:31], a[44:47], v[124:127]
ds_read_b64_tr_b16 v[22:23], v69 offset:13824
s_waitcnt lgkmcnt(8)
v_mfma_f32_16x16x32_bf16 v[128:131], v[0:3], a[16:19], v[128:131]
ds_read_b64_tr_b16 v[24:25], v69 offset:18432
v_cvt_pk_bf16_f32 v47, v118, v119
v_mfma_f32_16x16x32_bf16 v[132:135], v[0:3], a[20:23], v[132:135]
ds_read_b64_tr_b16 v[26:27], v69 offset:23040
buffer_store_dwordx4 v[44:47], v237, s[24:27], s42 offen offset:2048 sc1
v_mfma_f32_16x16x32_bf16 v[128:131], v[4:7], a[24:27], v[128:131]
ds_read_b64_tr_b16 v[28:29], v69 offset:27648
v_cvt_pk_bf16_f32 v32, v60, v61
v_mfma_f32_16x16x32_bf16 v[132:135], v[4:7], a[28:31], v[132:135]
ds_read_b64_tr_b16 v[30:31], v69 offset:32256
s_waitcnt lgkmcnt(8)
v_mfma_f32_16x16x32_bf16 v[128:131], v[8:11], a[32:35], v[128:131]
ds_read_b64_tr_b16 v[0:1], v70 offset:0
v_cvt_pk_bf16_f32 v33, v62, v63
v_mfma_f32_16x16x32_bf16 v[132:135], v[8:11], a[36:39], v[132:135]
ds_read_b64_tr_b16 v[2:3], v70 offset:4608
buffer_store_dwordx4 v[32:35], v237, s[24:27], s44 offen offset:1024 sc1
v_mfma_f32_16x16x32_bf16 v[128:131], v[12:15], a[40:43], v[128:131]
ds_read_b64_tr_b16 v[4:5], v70 offset:9216
v_cvt_pk_bf16_f32 v36, v120, v121
v_mfma_f32_16x16x32_bf16 v[132:135], v[12:15], a[44:47], v[132:135]
ds_read_b64_tr_b16 v[6:7], v70 offset:13824
s_waitcnt lgkmcnt(8)
v_mfma_f32_16x16x32_bf16 v[136:139], v[16:19], a[16:19], v[136:139]
ds_read_b64_tr_b16 v[8:9], v70 offset:18432
v_cvt_pk_bf16_f32 v37, v122, v123
v_mfma_f32_16x16x32_bf16 v[140:143], v[16:19], a[20:23], v[140:143]
ds_read_b64_tr_b16 v[10:11], v70 offset:23040
v_cvt_pk_bf16_f32 v38, v124, v125
v_mfma_f32_16x16x32_bf16 v[136:139], v[20:23], a[24:27], v[136:139]
ds_read_b64_tr_b16 v[12:13], v70 offset:27648
v_cvt_pk_bf16_f32 v39, v126, v127
v_mfma_f32_16x16x32_bf16 v[140:143], v[20:23], a[28:31], v[140:143]
ds_read_b64_tr_b16 v[14:15], v70 offset:32256
s_waitcnt lgkmcnt(8)
v_mfma_f32_16x16x32_bf16 v[136:139], v[24:27], a[32:35], v[136:139]
ds_read_b64_tr_b16 v[16:17], v71 offset:0
buffer_store_dwordx4 v[36:39], v237, s[24:27], s43 offen offset:0 sc1
v_mfma_f32_16x16x32_bf16 v[140:143], v[24:27], a[36:39], v[140:143]
ds_read_b64_tr_b16 v[18:19], v71 offset:4608
v_cvt_pk_bf16_f32 v40, v128, v129
v_mfma_f32_16x16x32_bf16 v[136:139], v[28:31], a[40:43], v[136:139]
ds_read_b64_tr_b16 v[20:21], v71 offset:9216
v_cvt_pk_bf16_f32 v41, v130, v131
v_mfma_f32_16x16x32_bf16 v[140:143], v[28:31], a[44:47], v[140:143]
ds_read_b64_tr_b16 v[22:23], v71 offset:13824
s_waitcnt lgkmcnt(8)
v_mfma_f32_16x16x32_bf16 v[144:147], v[0:3], a[16:19], v[144:147]
ds_read_b64_tr_b16 v[24:25], v71 offset:18432
v_cvt_pk_bf16_f32 v42, v132, v133
v_mfma_f32_16x16x32_bf16 v[148:151], v[0:3], a[20:23], v[148:151]
ds_read_b64_tr_b16 v[26:27], v71 offset:23040
v_cvt_pk_bf16_f32 v43, v134, v135
v_mfma_f32_16x16x32_bf16 v[144:147], v[4:7], a[24:27], v[144:147]
ds_read_b64_tr_b16 v[28:29], v71 offset:27648
buffer_store_dwordx4 v[40:43], v237, s[24:27], s43 offen offset:1024 sc1
v_mfma_f32_16x16x32_bf16 v[148:151], v[4:7], a[28:31], v[148:151]
ds_read_b64_tr_b16 v[30:31], v71 offset:32256
s_waitcnt lgkmcnt(8)
v_mfma_f32_16x16x32_bf16 v[144:147], v[8:11], a[32:35], v[144:147]
ds_read_b64_tr_b16 v[0:1], v72 offset:0
v_cvt_pk_bf16_f32 v44, v136, v137
v_mfma_f32_16x16x32_bf16 v[148:151], v[8:11], a[36:39], v[148:151]
ds_read_b64_tr_b16 v[2:3], v72 offset:4608
v_cvt_pk_bf16_f32 v45, v138, v139
v_mfma_f32_16x16x32_bf16 v[144:147], v[12:15], a[40:43], v[144:147]
ds_read_b64_tr_b16 v[4:5], v72 offset:9216
v_cvt_pk_bf16_f32 v46, v140, v141
v_mfma_f32_16x16x32_bf16 v[148:151], v[12:15], a[44:47], v[148:151]
ds_read_b64_tr_b16 v[6:7], v72 offset:13824
s_waitcnt lgkmcnt(8)
v_mfma_f32_16x16x32_bf16 v[152:155], v[16:19], a[16:19], v[152:155]
ds_read_b64_tr_b16 v[8:9], v72 offset:18432
v_cvt_pk_bf16_f32 v47, v142, v143
v_mfma_f32_16x16x32_bf16 v[156:159], v[16:19], a[20:23], v[156:159]
ds_read_b64_tr_b16 v[10:11], v72 offset:23040
buffer_store_dwordx4 v[44:47], v237, s[24:27], s43 offen offset:2048 sc1
v_mfma_f32_16x16x32_bf16 v[152:155], v[20:23], a[24:27], v[152:155]
ds_read_b64_tr_b16 v[12:13], v72 offset:27648
v_mfma_f32_16x16x32_bf16 v[156:159], v[20:23], a[28:31], v[156:159]
ds_read_b64_tr_b16 v[14:15], v72 offset:32256
s_waitcnt lgkmcnt(8)
v_mfma_f32_16x16x32_bf16 v[152:155], v[24:27], a[32:35], v[152:155]
v_mfma_f32_16x16x32_bf16 v[156:159], v[24:27], a[36:39], v[156:159]
v_mfma_f32_16x16x32_bf16 v[152:155], v[28:31], a[40:43], v[152:155]
v_mfma_f32_16x16x32_bf16 v[156:159], v[28:31], a[44:47], v[156:159]
s_waitcnt lgkmcnt(4)
v_mfma_f32_16x16x32_bf16 v[160:163], v[0:3], a[16:19], v[160:163]
v_mfma_f32_16x16x32_bf16 v[164:167], v[0:3], a[20:23], v[164:167]
v_mfma_f32_16x16x32_bf16 v[160:163], v[4:7], a[24:27], v[160:163]
v_mfma_f32_16x16x32_bf16 v[164:167], v[4:7], a[28:31], v[164:167]
s_waitcnt lgkmcnt(0)
v_mfma_f32_16x16x32_bf16 v[160:163], v[8:11], a[32:35], v[160:163]
v_mfma_f32_16x16x32_bf16 v[164:167], v[8:11], a[36:39], v[164:167]
v_mfma_f32_16x16x32_bf16 v[160:163], v[12:15], a[40:43], v[160:163]
v_mfma_f32_16x16x32_bf16 v[164:167], v[12:15], a[44:47], v[164:167]
s_nop 7
v_and_b32 v178, 31, v242
v_mul_u32_u24 v178, 2304, v178
v_lshrrev_b32 v179, 5, v242
v_lshl_add_u32 v64, v179, 4, v178
s_mul_i32 s7, s47, 331776
s_mul_i32 s6, s50, 288
s_add_u32 s7, s7, s6
s_mul_i32 s6, s48, 1152
s_add_u32 s7, s7, s6
s_lshl_b32 s6, s38, 6
s_add_u32 s7, s7, s6
s_mul_i32 s6, s38, 73728
s_add_u32 s7, s7, s6
s_cmp_ge_u32 s38, 2
s_cselect_b32 s3, 4294967008, 0
s_add_u32 s3, s3, 192
s_add_u32 s45, s7, s3
s_cmp_ge_u32 s38, 1
s_cselect_b32 s3, 4294967008, 0
s_add_u32 s3, s3, 224
s_add_u32 s46, s7, s3
s_cmp_ge_u32 s38, 1
s_cselect_b32 s3, 4294967008, 0
s_add_u32 s3, s3, 256
s_add_u32 s51, s7, s3
s_add_u32 s58, s58, 98304
s_waitcnt vmcnt(0)
s_lshl_b32 s3, s38, 4
s_add_u32 s63, s63, s3
s_add_u32 s66, s63, 8
v_mov_b32 v185, 1
buffer_load_dwordx4 v[180:183], v243, s[24:27], s63 offen sc1
s_mov_b64 exec, 1
buffer_store_dword v185, v243, s[24:27], s66 offen sc1
s_mov_b64 exec, -1
s_mov_b32 s5, 0x20000
s_waitcnt vmcnt(1)
CL18:
v_min3_u32 v184, v180, v181, v183
s_nop 0
v_readfirstlane_b32 s66, v184
s_nop 0
s_cmp_ge_u32 s66, 1
s_cbranch_scc1 CE18
buffer_load_dwordx4 v[180:183], v243, s[24:27], s63 offen sc1
s_waitcnt vmcnt(0)
s_sub_u32 s5, s5, 1
s_cbranch_scc0 CL18
CE18:
s_add_u32 s3, s58, 36864
buffer_load_dwordx4 v[0:3], v237, s[24:27], s3 offen offset:0 sc1
s_add_u32 s3, s58, 0
buffer_load_dwordx4 v[4:7], v237, s[24:27], s3 offen offset:0 sc1
s_add_u32 s3, s58, 12288
buffer_load_dwordx4 v[8:11], v237, s[24:27], s3 offen offset:0 sc1
s_add_u32 s3, s58, 36864
buffer_load_dwordx4 v[12:15], v237, s[24:27], s3 offen offset:1024 sc1
s_add_u32 s3, s58, 0
buffer_load_dwordx4 v[16:19], v237, s[24:27], s3 offen offset:1024 sc1
s_add_u32 s3, s58, 12288
buffer_load_dwordx4 v[20:23], v237, s[24:27], s3 offen offset:1024 sc1
s_add_u32 s3, s58, 36864
buffer_load_dwordx4 v[24:27], v237, s[24:27], s3 offen offset:2048 sc1
s_add_u32 s3, s58, 0
buffer_load_dwordx4 v[28:31], v237, s[24:27], s3 offen offset:2048 sc1
s_add_u32 s3, s58, 12288
buffer_load_dwordx4 v[32:35], v237, s[24:27], s3 offen offset:2048 sc1
s_mov_b32 s3, 0xffff0000
s_waitcnt vmcnt(8)
v_lshlrev_b32 v178, 16, v0
v_and_b32 v179, s3, v0
v_pk_add_f32 v[144:145], v[144:145], v[178:179]
v_lshlrev_b32 v180, 16, v1
v_and_b32 v181, s3, v1
v_pk_add_f32 v[146:147], v[146:147], v[180:181]
v_lshlrev_b32 v182, 16, v2
v_and_b32 v183, s3, v2
v_pk_add_f32 v[148:149], v[148:149], v[182:183]
v_lshlrev_b32 v178, 16, v3
v_and_b32 v179, s3, v3
v_pk_add_f32 v[150:151], v[150:151], v[178:179]
s_waitcnt vmcnt(7)
v_lshlrev_b32 v180, 16, v4
v_and_b32 v181, s3, v4
v_pk_add_f32 v[144:145], v[144:145], v[180:181]
v_lshlrev_b32 v182, 16, v5
v_and_b32 v183, s3, v5
v_pk_add_f32 v[146:147], v[146:147], v[182:183]
v_lshlrev_b32 v178, 16, v6
v_and_b32 v179, s3, v6
v_pk_add_f32 v[148:149], v[148:149], v[178:179]
v_lshlrev_b32 v180, 16, v7
v_and_b32 v181, s3, v7
v_pk_add_f32 v[150:151], v[150:151], v[180:181]
s_waitcnt vmcnt(6)
v_lshlrev_b32 v182, 16, v8
v_and_b32 v183, s3, v8
v_pk_add_f32 v[144:145], v[144:145], v[182:183]
v_lshlrev_b32 v178, 16, v9
v_and_b32 v179, s3, v9
v_pk_add_f32 v[146:147], v[146:147], v[178:179]
v_lshlrev_b32 v180, 16, v10
v_and_b32 v181, s3, v10
v_pk_add_f32 v[148:149], v[148:149], v[180:181]
v_lshlrev_b32 v182, 16, v11
v_and_b32 v183, s3, v11
v_pk_add_f32 v[150:151], v[150:151], v[182:183]
v_cvt_pk_bf16_f32 v144, v144, v145
v_cvt_pk_bf16_f32 v145, v146, v147
v_cvt_pk_bf16_f32 v146, v148, v149
v_cvt_pk_bf16_f32 v147, v150, v151
s_nop 1
v_permlane16_swap_b32 v144, v146
v_permlane16_swap_b32 v145, v147
buffer_store_dwordx4 v[144:147], v64, s[32:35], s45 offen
s_waitcnt vmcnt(6)
v_lshlrev_b32 v178, 16, v12
v_and_b32 v179, s3, v12
v_pk_add_f32 v[152:153], v[152:153], v[178:179]
v_lshlrev_b32 v180, 16, v13
v_and_b32 v181, s3, v13
v_pk_add_f32 v[154:155], v[154:155], v[180:181]
v_lshlrev_b32 v182, 16, v14
v_and_b32 v183, s3, v14
v_pk_add_f32 v[156:157], v[156:157], v[182:183]
v_lshlrev_b32 v178, 16, v15
v_and_b32 v179, s3, v15
v_pk_add_f32 v[158:159], v[158:159], v[178:179]
s_waitcnt vmcnt(5)
v_lshlrev_b32 v180, 16, v16
v_and_b32 v181, s3, v16
v_pk_add_f32 v[152:153], v[152:153], v[180:181]
v_lshlrev_b32 v182, 16, v17
v_and_b32 v183, s3, v17
v_pk_add_f32 v[154:155], v[154:155], v[182:183]
v_lshlrev_b32 v178, 16, v18
v_and_b32 v179, s3, v18
v_pk_add_f32 v[156:157], v[156:157], v[178:179]
v_lshlrev_b32 v180, 16, v19
v_and_b32 v181, s3, v19
v_pk_add_f32 v[158:159], v[158:159], v[180:181]
s_waitcnt vmcnt(4)
v_lshlrev_b32 v182, 16, v20
v_and_b32 v183, s3, v20
v_pk_add_f32 v[152:153], v[152:153], v[182:183]
v_lshlrev_b32 v178, 16, v21
v_and_b32 v179, s3, v21
v_pk_add_f32 v[154:155], v[154:155], v[178:179]
v_lshlrev_b32 v180, 16, v22
v_and_b32 v181, s3, v22
v_pk_add_f32 v[156:157], v[156:157], v[180:181]
v_lshlrev_b32 v182, 16, v23
v_and_b32 v183, s3, v23
v_pk_add_f32 v[158:159], v[158:159], v[182:183]
v_cvt_pk_bf16_f32 v152, v152, v153
v_cvt_pk_bf16_f32 v153, v154, v155
v_cvt_pk_bf16_f32 v154, v156, v157
v_cvt_pk_bf16_f32 v155, v158, v159
s_nop 1
v_permlane16_swap_b32 v152, v154
v_permlane16_swap_b32 v153, v155
buffer_store_dwordx4 v[152:155], v64, s[32:35], s46 offen
s_waitcnt vmcnt(4)
v_lshlrev_b32 v178, 16, v24
v_and_b32 v179, s3, v24
v_pk_add_f32 v[160:161], v[160:161], v[178:179]
v_lshlrev_b32 v180, 16, v25
v_and_b32 v181, s3, v25
v_pk_add_f32 v[162:163], v[162:163], v[180:181]
v_lshlrev_b32 v182, 16, v26
v_and_b32 v183, s3, v26
v_pk_add_f32 v[164:165], v[164:165], v[182:183]
v_lshlrev_b32 v178, 16, v27
v_and_b32 v179, s3, v27
v_pk_add_f32 v[166:167], v[166:167], v[178:179]
s_waitcnt vmcnt(3)
v_lshlrev_b32 v180, 16, v28
v_and_b32 v181, s3, v28
v_pk_add_f32 v[160:161], v[160:161], v[180:181]
v_lshlrev_b32 v182, 16, v29
v_and_b32 v183, s3, v29
v_pk_add_f32 v[162:163], v[162:163], v[182:183]
v_lshlrev_b32 v178, 16, v30
v_and_b32 v179, s3, v30
v_pk_add_f32 v[164:165], v[164:165], v[178:179]
v_lshlrev_b32 v180, 16, v31
v_and_b32 v181, s3, v31
v_pk_add_f32 v[166:167], v[166:167], v[180:181]
s_waitcnt vmcnt(2)
v_lshlrev_b32 v182, 16, v32
v_and_b32 v183, s3, v32
v_pk_add_f32 v[160:161], v[160:161], v[182:183]
v_lshlrev_b32 v178, 16, v33
v_and_b32 v179, s3, v33
v_pk_add_f32 v[162:163], v[162:163], v[178:179]
v_lshlrev_b32 v180, 16, v34
v_and_b32 v181, s3, v34
v_pk_add_f32 v[164:165], v[164:165], v[180:181]
v_lshlrev_b32 v182, 16, v35
v_and_b32 v183, s3, v35
v_pk_add_f32 v[166:167], v[166:167], v[182:183]
v_cvt_pk_bf16_f32 v160, v160, v161
v_cvt_pk_bf16_f32 v161, v162, v163
v_cvt_pk_bf16_f32 v162, v164, v165
v_cvt_pk_bf16_f32 v163, v166, v167
s_nop 1
v_permlane16_swap_b32 v160, v162
v_permlane16_swap_b32 v161, v163
buffer_store_dwordx4 v[160:163], v64, s[32:35], s51 offen
s_endpgm
FIN3:
s_lshl_b32 s6, s48, 3
s_add_u32 s6, s6, s47
ds_read_b64_tr_b16 v[0:1], v64 offset:0
ds_read_b64_tr_b16 v[2:3], v64 offset:4608
ds_read_b128 v[76:79], v73 offset:12288
ds_read_b64_tr_b16 v[4:5], v64 offset:9216
ds_read_b64_tr_b16 v[6:7], v64 offset:13824
ds_read_b128 v[80:83], v73 offset:13312
ds_read_b64_tr_b16 v[8:9], v64 offset:18432
ds_read_b64_tr_b16 v[10:11], v64 offset:23040
ds_read_b128 v[84:87], v73 offset:14336
ds_read_b64_tr_b16 v[12:13], v64 offset:27648
ds_read_b64_tr_b16 v[14:15], v64 offset:32256
ds_read_b128 v[88:91], v73 offset:15360
ds_read_b64_tr_b16 v[16:17], v65 offset:0
ds_read_b64_tr_b16 v[18:19], v65 offset:4608
ds_read_b64_tr_b16 v[20:21], v65 offset:9216
ds_read_b64_tr_b16 v[22:23], v65 offset:13824
s_lshl_b32 s6, s6, 2
s_add_u32 s6, s6, s50
s_lshl_b32 s6, s6, 6
s_add_u32 s6, s6, s38
s_mul_i32 s58, s6, 3072
s_add_u32 s58, s58, 18874368
s_add_u32 s42, s58, 36864
s_add_u32 s43, s58, 86016
s_add_u32 s44, s58, 135168
s_waitcnt lgkmcnt(14)
v_mfma_f32_16x16x32_bf16 v[96:99], v[0:3], a[16:19], v[96:99]
ds_read_b64_tr_b16 v[24:25], v65 offset:18432
v_mfma_f32_16x16x32_bf16 v[100:103], v[0:3], a[20:23], v[100:103]
ds_read_b64_tr_b16 v[26:27], v65 offset:23040
s_waitcnt lgkmcnt(13)
v_mfma_f32_16x16x32_bf16 v[96:99], v[4:7], a[24:27], v[96:99]
ds_read_b64_tr_b16 v[28:29], v65 offset:27648
v_mfma_f32_16x16x32_bf16 v[100:103], v[4:7], a[28:31], v[100:103]
ds_read_b64_tr_b16 v[30:31], v65 offset:32256
s_waitcnt lgkmcnt(12)
v_mfma_f32_16x16x32_bf16 v[96:99], v[8:11], a[32:35], v[96:99]
ds_read_b64_tr_b16 v[0:1], v66 offset:0
v_mfma_f32_16x16x32_bf16 v[100:103], v[8:11], a[36:39], v[100:103]
ds_read_b64_tr_b16 v[2:3], v66 offset:4608
s_waitcnt lgkmcnt(11)
v_mfma_f32_16x16x32_bf16 v[96:99], v[12:15], a[40:43], v[96:99]
ds_read_b64_tr_b16 v[4:5], v66 offset:9216
v_mfma_f32_16x16x32_bf16 v[100:103], v[12:15], a[44:47], v[100:103]
ds_read_b64_tr_b16 v[6:7], v66 offset:13824
s_waitcnt lgkmcnt(10)
v_mfma_f32_16x16x32_bf16 v[104:107], v[16:19], a[16:19], v[104:107]
ds_read_b64_tr_b16 v[8:9], v66 offset:18432
v_mfma_f32_16x16x32_bf16 v[108:111], v[16:19], a[20:23], v[108:111]
ds_read_b64_tr_b16 v[10:11], v66 offset:23040
s_waitcnt lgkmcnt(10)
v_mfma_f32_16x16x32_bf16 v[104:107], v[20:23], a[24:27], v[104:107]
ds_read_b64_tr_b16 v[12:13], v66 offset:27648
v_mfma_f32_16x16x32_bf16 v[108:111], v[20:23], a[28:31], v[108:111]
ds_read_b64_tr_b16 v[14:15], v66 offset:32256
s_waitcnt lgkmcnt(8)
v_mfma_f32_16x16x32_bf16 v[104:107], v[24:27], a[32:35], v[104:107]
ds_read_b64_tr_b16 v[16:17], v67 offset:0
v_cvt_pk_bf16_f32 v32, v96, v97
v_mfma_f32_16x16x32_bf16 v[108:111], v[24:27], a[36:39], v[108:111]
ds_read_b64_tr_b16 v[18:19], v67 offset:4608
v_cvt_pk_bf16_f32 v33, v98, v99
v_mfma_f32_16x16x32_bf16 v[104:107], v[28:31], a[40:43], v[104:107]
ds_read_b64_tr_b16 v[20:21], v67 offset:9216
v_cvt_pk_bf16_f32 v34, v100, v101
v_mfma_f32_16x16x32_bf16 v[108:111], v[28:31], a[44:47], v[108:111]
ds_read_b64_tr_b16 v[22:23], v67 offset:13824
s_waitcnt lgkmcnt(8)
v_mfma_f32_16x16x32_bf16 v[112:115], v[0:3], a[16:19], v[112:115]
ds_read_b64_tr_b16 v[24:25], v67 offset:18432
v_cvt_pk_bf16_f32 v35, v102, v103
v_mfma_f32_16x16x32_bf16 v[116:119], v[0:3], a[20:23], v[116:119]
ds_read_b64_tr_b16 v[26:27], v67 offset:23040
buffer_store_dwordx4 v[32:35], v237, s[24:27], s42 offen offset:0 sc1
v_mfma_f32_16x16x32_bf16 v[112:115], v[4:7], a[24:27], v[112:115]
ds_read_b64_tr_b16 v[28:29], v67 offset:27648
v_mfma_f32_16x16x32_bf16 v[116:119], v[4:7], a[28:31], v[116:119]
ds_read_b64_tr_b16 v[30:31], v67 offset:32256
s_waitcnt lgkmcnt(8)
v_mfma_f32_16x16x32_bf16 v[112:115], v[8:11], a[32:35], v[112:115]
ds_read_b64_tr_b16 v[0:1], v68 offset:0
v_cvt_pk_bf16_f32 v36, v104, v105
v_mfma_f32_16x16x32_bf16 v[116:119], v[8:11], a[36:39], v[116:119]
ds_read_b64_tr_b16 v[2:3], v68 offset:4608
v_cvt_pk_bf16_f32 v37, v106, v107
v_mfma_f32_16x16x32_bf16 v[112:115], v[12:15], a[40:43], v[112:115]
ds_read_b64_tr_b16 v[4:5], v68 offset:9216
v_cvt_pk_bf16_f32 v38, v108, v109
v_mfma_f32_16x16x32_bf16 v[116:119], v[12:15], a[44:47], v[116:119]
ds_read_b64_tr_b16 v[6:7], v68 offset:13824
s_waitcnt lgkmcnt(8)
v_mfma_f32_16x16x32_bf16 v[120:123], v[16:19], a[16:19], v[120:123]
ds_read_b64_tr_b16 v[8:9], v68 offset:18432
v_cvt_pk_bf16_f32 v39, v110, v111
v_mfma_f32_16x16x32_bf16 v[124:127], v[16:19], a[20:23], v[124:127]
ds_read_b64_tr_b16 v[10:11], v68 offset:23040
buffer_store_dwordx4 v[36:39], v237, s[24:27], s42 offen offset:1024 sc1
v_mfma_f32_16x16x32_bf16 v[120:123], v[20:23], a[24:27], v[120:123]
ds_read_b64_tr_b16 v[12:13], v68 offset:27648
v_mfma_f32_16x16x32_bf16 v[124:127], v[20:23], a[28:31], v[124:127]
ds_read_b64_tr_b16 v[14:15], v68 offset:32256
s_waitcnt lgkmcnt(8)
v_mfma_f32_16x16x32_bf16 v[120:123], v[24:27], a[32:35], v[120:123]
ds_read_b64_tr_b16 v[16:17], v69 offset:0
v_cvt_pk_bf16_f32 v40, v112, v113
v_mfma_f32_16x16x32_bf16 v[124:127], v[24:27], a[36:39], v[124:127]
ds_read_b64_tr_b16 v[18:19], v69 offset:4608
v_cvt_pk_bf16_f32 v41, v114, v115
v_mfma_f32_16x16x32_bf16 v[120:123], v[28:31], a[40:43], v[120:123]
ds_read_b64_tr_b16 v[20:21], v69 offset:9216
v_cvt_pk_bf16_f32 v42, v116, v117
v_mfma_f32_16x16x32_bf16 v[124:127], v[28:31], a[44:47], v[124:127]
ds_read_b64_tr_b16 v[22:23], v69 offset:13824
s_waitcnt lgkmcnt(8)
v_mfma_f32_16x16x32_bf16 v[128:131], v[0:3], a[16:19], v[128:131]
ds_read_b64_tr_b16 v[24:25], v69 offset:18432
v_cvt_pk_bf16_f32 v43, v118, v119
v_mfma_f32_16x16x32_bf16 v[132:135], v[0:3], a[20:23], v[132:135]
ds_read_b64_tr_b16 v[26:27], v69 offset:23040
buffer_store_dwordx4 v[40:43], v237, s[24:27], s42 offen offset:2048 sc1
v_mfma_f32_16x16x32_bf16 v[128:131], v[4:7], a[24:27], v[128:131]
ds_read_b64_tr_b16 v[28:29], v69 offset:27648
v_mfma_f32_16x16x32_bf16 v[132:135], v[4:7], a[28:31], v[132:135]
ds_read_b64_tr_b16 v[30:31], v69 offset:32256
s_waitcnt lgkmcnt(8)
v_mfma_f32_16x16x32_bf16 v[128:131], v[8:11], a[32:35], v[128:131]
ds_read_b64_tr_b16 v[0:1], v70 offset:0
v_cvt_pk_bf16_f32 v44, v120, v121
v_mfma_f32_16x16x32_bf16 v[132:135], v[8:11], a[36:39], v[132:135]
ds_read_b64_tr_b16 v[2:3], v70 offset:4608
v_cvt_pk_bf16_f32 v45, v122, v123
v_mfma_f32_16x16x32_bf16 v[128:131], v[12:15], a[40:43], v[128:131]
ds_read_b64_tr_b16 v[4:5], v70 offset:9216
v_cvt_pk_bf16_f32 v46, v124, v125
v_mfma_f32_16x16x32_bf16 v[132:135], v[12:15], a[44:47], v[132:135]
ds_read_b64_tr_b16 v[6:7], v70 offset:13824
s_waitcnt lgkmcnt(8)
v_mfma_f32_16x16x32_bf16 v[136:139], v[16:19], a[16:19], v[136:139]
ds_read_b64_tr_b16 v[8:9], v70 offset:18432
v_cvt_pk_bf16_f32 v47, v126, v127
v_mfma_f32_16x16x32_bf16 v[140:143], v[16:19], a[20:23], v[140:143]
ds_read_b64_tr_b16 v[10:11], v70 offset:23040
buffer_store_dwordx4 v[44:47], v237, s[24:27], s43 offen offset:0 sc1
v_mfma_f32_16x16x32_bf16 v[136:139], v[20:23], a[24:27], v[136:139]
ds_read_b64_tr_b16 v[12:13], v70 offset:27648
v_mfma_f32_16x16x32_bf16 v[140:143], v[20:23], a[28:31], v[140:143]
ds_read_b64_tr_b16 v[14:15], v70 offset:32256
s_waitcnt lgkmcnt(8)
v_mfma_f32_16x16x32_bf16 v[136:139], v[24:27], a[32:35], v[136:139]
ds_read_b64_tr_b16 v[16:17], v71 offset:0
v_cvt_pk_bf16_f32 v32, v128, v129
v_mfma_f32_16x16x32_bf16 v[140:143], v[24:27], a[36:39], v[140:143]
ds_read_b64_tr_b16 v[18:19], v71 offset:4608
v_cvt_pk_bf16_f32 v33, v130, v131
v_mfma_f32_16x16x32_bf16 v[136:139], v[28:31], a[40:43], v[136:139]
ds_read_b64_tr_b16 v[20:21], v71 offset:9216
v_cvt_pk_bf16_f32 v34, v132, v133
v_mfma_f32_16x16x32_bf16 v[140:143], v[28:31], a[44:47], v[140:143]
ds_read_b64_tr_b16 v[22:23], v71 offset:13824
s_waitcnt lgkmcnt(8)
v_mfma_f32_16x16x32_bf16 v[144:147], v[0:3], a[16:19], v[144:147]
ds_read_b64_tr_b16 v[24:25], v71 offset:18432
v_cvt_pk_bf16_f32 v35, v134, v135
v_mfma_f32_16x16x32_bf16 v[148:151], v[0:3], a[20:23], v[148:151]
ds_read_b64_tr_b16 v[26:27], v71 offset:23040
buffer_store_dwordx4 v[32:35], v237, s[24:27], s43 offen offset:1024 sc1
v_mfma_f32_16x16x32_bf16 v[144:147], v[4:7], a[24:27], v[144:147]
ds_read_b64_tr_b16 v[28:29], v71 offset:27648
v_mfma_f32_16x16x32_bf16 v[148:151], v[4:7], a[28:31], v[148:151]
ds_read_b64_tr_b16 v[30:31], v71 offset:32256
s_waitcnt lgkmcnt(8)
v_mfma_f32_16x16x32_bf16 v[144:147], v[8:11], a[32:35], v[144:147]
ds_read_b64_tr_b16 v[0:1], v72 offset:0
v_cvt_pk_bf16_f32 v36, v136, v137
v_mfma_f32_16x16x32_bf16 v[148:151], v[8:11], a[36:39], v[148:151]
ds_read_b64_tr_b16 v[2:3], v72 offset:4608
v_cvt_pk_bf16_f32 v37, v138, v139
v_mfma_f32_16x16x32_bf16 v[144:147], v[12:15], a[40:43], v[144:147]
ds_read_b64_tr_b16 v[4:5], v72 offset:9216
v_cvt_pk_bf16_f32 v38, v140, v141
v_mfma_f32_16x16x32_bf16 v[148:151], v[12:15], a[44:47], v[148:151]
ds_read_b64_tr_b16 v[6:7], v72 offset:13824
s_waitcnt lgkmcnt(8)
v_mfma_f32_16x16x32_bf16 v[152:155], v[16:19], a[16:19], v[152:155]
ds_read_b64_tr_b16 v[8:9], v72 offset:18432
v_cvt_pk_bf16_f32 v39, v142, v143
v_mfma_f32_16x16x32_bf16 v[156:159], v[16:19], a[20:23], v[156:159]
ds_read_b64_tr_b16 v[10:11], v72 offset:23040
buffer_store_dwordx4 v[36:39], v237, s[24:27], s43 offen offset:2048 sc1
v_mfma_f32_16x16x32_bf16 v[152:155], v[20:23], a[24:27], v[152:155]
ds_read_b64_tr_b16 v[12:13], v72 offset:27648
v_mfma_f32_16x16x32_bf16 v[156:159], v[20:23], a[28:31], v[156:159]
ds_read_b64_tr_b16 v[14:15], v72 offset:32256
s_waitcnt lgkmcnt(8)
v_mfma_f32_16x16x32_bf16 v[152:155], v[24:27], a[32:35], v[152:155]
ds_read_b64_tr_b16 v[16:17], v64 offset:0
v_cvt_pk_bf16_f32 v40, v144, v145
v_mfma_f32_16x16x32_bf16 v[156:159], v[24:27], a[36:39], v[156:159]
ds_read_b64_tr_b16 v[18:19], v64 offset:4608
v_cvt_pk_bf16_f32 v41, v146, v147
v_mfma_f32_16x16x32_bf16 v[152:155], v[28:31], a[40:43], v[152:155]
ds_read_b64_tr_b16 v[20:21], v64 offset:9216
v_cvt_pk_bf16_f32 v42, v148, v149
v_mfma_f32_16x16x32_bf16 v[156:159], v[28:31], a[44:47], v[156:159]
ds_read_b64_tr_b16 v[22:23], v64 offset:13824
s_waitcnt lgkmcnt(8)
v_mfma_f32_16x16x32_bf16 v[160:163], v[0:3], a[16:19], v[160:163]
ds_read_b64_tr_b16 v[24:25], v64 offset:18432
v_cvt_pk_bf16_f32 v43, v150, v151
v_mfma_f32_16x16x32_bf16 v[164:167], v[0:3], a[20:23], v[164:167]
ds_read_b64_tr_b16 v[26:27], v64 offset:23040
buffer_store_dwordx4 v[40:43], v237, s[24:27], s44 offen offset:0 sc1
v_mfma_f32_16x16x32_bf16 v[160:163], v[4:7], a[24:27], v[160:163]
ds_read_b64_tr_b16 v[28:29], v64 offset:27648
v_mfma_f32_16x16x32_bf16 v[164:167], v[4:7], a[28:31], v[164:167]
ds_read_b64_tr_b16 v[30:31], v64 offset:32256
s_waitcnt lgkmcnt(8)
v_mfma_f32_16x16x32_bf16 v[160:163], v[8:11], a[32:35], v[160:163]
ds_read_b64_tr_b16 v[0:1], v65 offset:0
v_cvt_pk_bf16_f32 v44, v152, v153
v_mfma_f32_16x16x32_bf16 v[164:167], v[8:11], a[36:39], v[164:167]
ds_read_b64_tr_b16 v[2:3], v65 offset:4608
v_cvt_pk_bf16_f32 v45, v154, v155
v_mfma_f32_16x16x32_bf16 v[160:163], v[12:15], a[40:43], v[160:163]
ds_read_b64_tr_b16 v[4:5], v65 offset:9216
v_cvt_pk_bf16_f32 v46, v156, v157
v_mfma_f32_16x16x32_bf16 v[164:167], v[12:15], a[44:47], v[164:167]
ds_read_b64_tr_b16 v[6:7], v65 offset:13824
s_waitcnt lgkmcnt(4)
v_mfma_f32_16x16x32_bf16 v[168:171], v[16:19], v[76:79], v[168:171]
ds_read_b64_tr_b16 v[8:9], v65 offset:18432
v_cvt_pk_bf16_f32 v47, v158, v159
v_mfma_f32_16x16x32_bf16 v[168:171], v[20:23], v[80:83], v[168:171]
ds_read_b64_tr_b16 v[10:11], v65 offset:23040
buffer_store_dwordx4 v[44:47], v237, s[24:27], s44 offen offset:1024 sc1
v_mfma_f32_16x16x32_bf16 v[168:171], v[24:27], v[84:87], v[168:171]
ds_read_b64_tr_b16 v[12:13], v65 offset:27648
v_mfma_f32_16x16x32_bf16 v[168:171], v[28:31], v[88:91], v[168:171]
ds_read_b64_tr_b16 v[14:15], v65 offset:32256
s_waitcnt lgkmcnt(0)
v_mfma_f32_16x16x32_bf16 v[172:175], v[0:3], v[76:79], v[172:175]
ds_read_b64_tr_b16 v[16:17], v66 offset:0
ds_read_b64_tr_b16 v[18:19], v66 offset:4608
v_mfma_f32_16x16x32_bf16 v[172:175], v[4:7], v[80:83], v[172:175]
ds_read_b64_tr_b16 v[20:21], v66 offset:9216
ds_read_b64_tr_b16 v[22:23], v66 offset:13824
v_mfma_f32_16x16x32_bf16 v[172:175], v[8:11], v[84:87], v[172:175]
ds_read_b64_tr_b16 v[24:25], v66 offset:18432
ds_read_b64_tr_b16 v[26:27], v66 offset:23040
v_mfma_f32_16x16x32_bf16 v[172:175], v[12:15], v[88:91], v[172:175]
ds_read_b64_tr_b16 v[28:29], v66 offset:27648
ds_read_b64_tr_b16 v[30:31], v66 offset:32256
s_waitcnt lgkmcnt(0)
v_mfma_f32_16x16x32_bf16 v[60:63], v[16:19], v[76:79], v[60:63]
v_cvt_pk_bf16_f32 v32, v160, v161
v_cvt_pk_bf16_f32 v33, v162, v163
v_mfma_f32_16x16x32_bf16 v[60:63], v[20:23], v[80:83], v[60:63]
v_cvt_pk_bf16_f32 v34, v164, v165
v_cvt_pk_bf16_f32 v35, v166, v167
v_mfma_f32_16x16x32_bf16 v[60:63], v[24:27], v[84:87], v[60:63]
buffer_store_dwordx4 v[32:35], v237, s[24:27], s44 offen offset:2048 sc1
v_mfma_f32_16x16x32_bf16 v[60:63], v[28:31], v[88:91], v[60:63]
s_nop 7
v_and_b32 v178, 15, v242
v_mul_u32_u24 v178, 2304, v178
v_lshrrev_b32 v179, 5, v242
v_lshl_add_u32 v64, v179, 4, v178
s_mul_i32 s7, s47, 331776
s_mul_i32 s6, s50, 288
s_add_u32 s7, s7, s6
s_mul_i32 s6, s48, 1152
s_add_u32 s7, s7, s6
s_lshl_b32 s6, s38, 6
s_add_u32 s7, s7, s6
v_lshrrev_b32 v179, 4, v242
v_lshl_add_u32 v65, v179, 3, v178
v_and_b32 v179, 1, v179
v_lshl_add_u32 v64, v179, 5, v64
s_add_u32 s45, s7, 294912
s_add_u32 s46, s45, 64
s_cmp_eq_u32 s38, 3
s_cselect_b32 s46, s46, 0x40000000
s_add_u32 s58, s58, 147456
s_waitcnt vmcnt(0)
s_lshl_b32 s3, s38, 4
s_add_u32 s63, s63, s3
s_add_u32 s66, s63, 12
v_mov_b32 v185, 1
buffer_load_dwordx4 v[180:183], v243, s[24:27], s63 offen sc1
s_mov_b64 exec, 1
buffer_store_dword v185, v243, s[24:27], s66 offen sc1
s_mov_b64 exec, -1
s_mov_b32 s5, 0x20000
s_waitcnt vmcnt(1)
CL19:
v_min3_u32 v184, v180, v181, v182
s_nop 0
v_readfirstlane_b32 s66, v184
s_nop 0
s_cmp_ge_u32 s66, 1
s_cbranch_scc1 CE19
buffer_load_dwordx4 v[180:183], v243, s[24:27], s63 offen sc1
s_waitcnt vmcnt(0)
s_sub_u32 s5, s5, 1
s_cbranch_scc0 CL19
CE19:
s_add_u32 s3, s58, 0
buffer_load_dwordx4 v[0:3], v237, s[24:27], s3 offen offset:0 sc1
s_add_u32 s3, s58, 12288
buffer_load_dwordx4 v[4:7], v237, s[24:27], s3 offen offset:0 sc1
s_add_u32 s3, s58, 24576
buffer_load_dwordx4 v[8:11], v237, s[24:27], s3 offen offset:0 sc1
s_add_u32 s3, s58, 0
buffer_load_dwordx4 v[12:15], v237, s[24:27], s3 offen offset:1024 sc1
s_add_u32 s3, s58, 12288
buffer_load_dwordx4 v[16:19], v237, s[24:27], s3 offen offset:1024 sc1
s_add_u32 s3, s58, 24576
buffer_load_dwordx4 v[20:23], v237, s[24:27], s3 offen offset:1024 sc1
s_mov_b32 s3, 0xffff0000
s_waitcnt vmcnt(5)
v_lshlrev_b32 v178, 16, v0
v_and_b32 v179, s3, v0
v_pk_add_f32 v[168:169], v[168:169], v[178:179]
v_lshlrev_b32 v180, 16, v1
v_and_b32 v181, s3, v1
v_pk_add_f32 v[170:171], v[170:171], v[180:181]
v_lshlrev_b32 v182, 16, v2
v_and_b32 v183, s3, v2
v_pk_add_f32 v[172:173], v[172:173], v[182:183]
v_lshlrev_b32 v178, 16, v3
v_and_b32 v179, s3, v3
v_pk_add_f32 v[174:175], v[174:175], v[178:179]
s_waitcnt vmcnt(4)
v_lshlrev_b32 v180, 16, v4
v_and_b32 v181, s3, v4
v_pk_add_f32 v[168:169], v[168:169], v[180:181]
v_lshlrev_b32 v182, 16, v5
v_and_b32 v183, s3, v5
v_pk_add_f32 v[170:171], v[170:171], v[182:183]
v_lshlrev_b32 v178, 16, v6
v_and_b32 v179, s3, v6
v_pk_add_f32 v[172:173], v[172:173], v[178:179]
v_lshlrev_b32 v180, 16, v7
v_and_b32 v181, s3, v7
v_pk_add_f32 v[174:175], v[174:175], v[180:181]
s_waitcnt vmcnt(3)
v_lshlrev_b32 v182, 16, v8
v_and_b32 v183, s3, v8
v_pk_add_f32 v[168:169], v[168:169], v[182:183]
v_lshlrev_b32 v178, 16, v9
v_and_b32 v179, s3, v9
v_pk_add_f32 v[170:171], v[170:171], v[178:179]
v_lshlrev_b32 v180, 16, v10
v_and_b32 v181, s3, v10
v_pk_add_f32 v[172:173], v[172:173], v[180:181]
v_lshlrev_b32 v182, 16, v11
v_and_b32 v183, s3, v11
v_pk_add_f32 v[174:175], v[174:175], v[182:183]
v_cvt_pk_bf16_f32 v168, v168, v169
v_cvt_pk_bf16_f32 v169, v170, v171
v_cvt_pk_bf16_f32 v170, v172, v173
v_cvt_pk_bf16_f32 v171, v174, v175
s_nop 1
v_permlane16_swap_b32 v168, v170
v_permlane16_swap_b32 v169, v171
buffer_store_dwordx4 v[168:171], v64, s[32:35], s45 offen
s_waitcnt vmcnt(3)
v_lshlrev_b32 v178, 16, v12
v_and_b32 v179, s3, v12
v_pk_add_f32 v[60:61], v[60:61], v[178:179]
v_lshlrev_b32 v180, 16, v13
v_and_b32 v181, s3, v13
v_pk_add_f32 v[62:63], v[62:63], v[180:181]
s_waitcnt vmcnt(2)
v_lshlrev_b32 v182, 16, v16
v_and_b32 v183, s3, v16
v_pk_add_f32 v[60:61], v[60:61], v[182:183]
v_lshlrev_b32 v178, 16, v17
v_and_b32 v179, s3, v17
v_pk_add_f32 v[62:63], v[62:63], v[178:179]
s_waitcnt vmcnt(1)
v_lshlrev_b32 v180, 16, v20
v_and_b32 v181, s3, v20
v_pk_add_f32 v[60:61], v[60:61], v[180:181]
v_lshlrev_b32 v182, 16, v21
v_and_b32 v183, s3, v21
v_pk_add_f32 v[62:63], v[62:63], v[182:183]
v_cvt_pk_bf16_f32 v60, v60, v61
v_cvt_pk_bf16_f32 v61, v62, v63
buffer_store_dwordx2 v[60:61], v65, s[32:35], s46 offen
s_endpgm
PROG1:
s_mul_i32 s44, s46, 524288
s_add_u32 s44, s44, s52
s_lshl_b32 s45, s46, 7
s_add_u32 s45, s45, s51
s_add_u32 m0, s39, 65536
s_add_u32 s46, s46, 1
buffer_load_dwordx4 v228, s[20:23], s44 offen  lds
buffer_load_dwordx4 v229, s[20:23], s44 offen offset:1024  lds
buffer_load_dwordx4 v230, s[20:23], s44 offen offset:2048  lds
buffer_load_dwordx4 v231, s[20:23], s44 offen offset:3072  lds
s_add_u32 m0, s39, 114432
s_nop 0
buffer_load_dwordx4 v228, s[20:23], s44 offen offset:256  lds
buffer_load_dwordx4 v229, s[20:23], s44 offen offset:1280  lds
buffer_load_dwordx4 v230, s[20:23], s44 offen offset:2304  lds
buffer_load_dwordx4 v231, s[20:23], s44 offen offset:3328  lds
s_add_u32 m0, s40, 0
s_cmp_eq_u32 s46, 9
s_cselect_b32 s46, 0, s46
buffer_load_dwordx4 v232, s[8:11], s45 offen  lds
buffer_load_dwordx4 v233, s[8:11], s45 offen offset:1024  lds
buffer_load_dwordx4 v234, s[8:11], s45 offen offset:2048  lds
buffer_load_dwordx4 v235, s[8:11], s45 offen offset:3072  lds
s_add_u32 m0, s40, 4096
s_nop 0
buffer_load_dwordx4 v236, s[8:11], s45 offen  lds
s_mul_i32 s3, s49, 1179648
buffer_load_dword v255, v243, s[28:31], s3 offen
s_add_u32 s3, s3, 1179520
buffer_load_dword v255, v243, s[28:31], s3 offen
s_mul_i32 s3, s47, 331776
buffer_load_dword v255, v243, s[32:35], s3 offen
buffer_load_dword v255, v243, s[24:27], s53 offen
s_lshl_b32 s3, s48, 3
s_add_u32 s3, s3, s47
s_mul_i32 s3, s3, 786432
s_add_u32 s3, s3, 18874368
buffer_load_dword v255, v243, s[24:27], s3 offen
buffer_load_dword v255, v243, s[12:15], s41 offen nt
buffer_load_dword v255, v243, s[16:19], s41 offen nt
v_and_b32 v146, 31, v242
v_lshrrev_b32 v147, 5, v242
v_and_b32 v148, 3, v242
v_bfe_u32 v149, v242, 2, 2
v_and_b32 v150, 1, v145
v_lshl_add_u32 v178, v145, 3, v149
v_and_b32 v179, 1, v148
v_lshlrev_b32 v179, 3, v179
v_lshl_add_u32 v181, v178, 8, v179
v_add_u32 v181, 65536, v181
v_lshlrev_b32 v178, 2, v149
v_lshl_add_u32 v178, v150, 1, v178
v_lshrrev_b32 v179, 1, v148
v_xor_b32 v180, v178, v179
s_lshl_b32 s5, s38, 2
s_add_u32 s3, s5, 0
s_and_b32 s3, s3, 15
v_xor_b32 v178, s3, v180
v_lshl_add_u32 v210, v178, 4, v181
s_add_u32 s3, s5, 2
s_and_b32 s3, s3, 15
v_xor_b32 v178, s3, v180
v_lshl_add_u32 v211, v178, 4, v181
s_add_u32 s3, s5, 4
s_and_b32 s3, s3, 15
v_xor_b32 v178, s3, v180
v_lshl_add_u32 v212, v178, 4, v181
s_add_u32 s3, s5, 6
s_and_b32 s3, s3, 15
v_xor_b32 v178, s3, v180
v_lshl_add_u32 v213, v178, 4, v181
s_add_u32 s3, s5, 8
s_and_b32 s3, s3, 15
v_xor_b32 v178, s3, v180
v_lshl_add_u32 v214, v178, 4, v181
s_add_u32 s3, s5, 10
s_and_b32 s3, s3, 15
v_xor_b32 v178, s3, v180
v_lshl_add_u32 v215, v178, 4, v181
s_add_u32 s3, s5, 12
s_and_b32 s3, s3, 15
v_xor_b32 v178, s3, v180
v_lshl_add_u32 v216, v178, 4, v181
s_add_u32 s3, s5, 14
s_and_b32 s3, s3, 15
v_xor_b32 v178, s3, v180
v_lshl_add_u32 v217, v178, 4, v181
v_lshrrev_b32 v179, 1, v144
v_lshlrev_b32 v181, 7, v144
v_add_u32 v181, 0, v181
v_add_u32 v178, 0, v145
v_xor_b32 v178, v178, v179
v_lshl_add_u32 v178, v178, 4, v181
v_add_u32 v218, s39, v178
v_add_u32 v220, 16384, v178
v_add_u32 v178, 4, v145
v_xor_b32 v178, v178, v179
v_lshl_add_u32 v178, v178, 4, v181
v_add_u32 v219, s39, v178
v_add_u32 v221, 16384, v178
v_add_u32 v178, 0, v145
v_xor_b32 v178, v178, v144
v_lshlrev_b32 v178, 4, v178
v_lshl_add_u32 v178, v145, 8, v178
v_add_u32 v222, s39, v178
v_add_u32 v178, 4, v145
v_xor_b32 v178, v178, v144
v_lshlrev_b32 v178, 4, v178
v_lshl_add_u32 v178, v145, 8, v178
v_add_u32 v223, s39, v178
v_add_u32 v178, 8, v145
v_xor_b32 v178, v178, v144
v_lshlrev_b32 v178, 4, v178
v_lshl_add_u32 v178, v145, 8, v178
v_add_u32 v224, s39, v178
v_add_u32 v178, 12, v145
v_xor_b32 v178, v178, v144
v_lshlrev_b32 v178, 4, v178
v_lshl_add_u32 v178, v145, 8, v178
v_add_u32 v225, s39, v178
v_lshlrev_b32 v178, 2, v145
v_xor_b32 v178, v178, v144
v_lshlrev_b32 v178, 4, v178
v_lshl_add_u32 v178, v145, 8, v178
v_add_u32 v226, s39, v178
v_xor_b32 v227, 32, v226
v_lshlrev_b32 v181, 8, v144
s_add_u32 s3, s38, 0
s_and_b32 s3, s3, 3
s_lshl_b32 s3, s3, 2
v_add_u32 v178, s3, v145
v_xor_b32 v178, v178, v144
v_lshl_add_u32 v186, v178, 4, v181
v_add_u32 v178, 0, v145
v_xor_b32 v178, v178, v144
v_lshl_add_u32 v178, v178, 4, v181
v_add_u32 v190, s39, v178
s_add_u32 s3, s38, 1
s_and_b32 s3, s3, 3
s_lshl_b32 s3, s3, 2
v_add_u32 v178, s3, v145
v_xor_b32 v178, v178, v144
v_lshl_add_u32 v187, v178, 4, v181
v_add_u32 v178, 4, v145
v_xor_b32 v178, v178, v144
v_lshl_add_u32 v178, v178, 4, v181
v_add_u32 v191, s39, v178
s_add_u32 s3, s38, 2
s_and_b32 s3, s3, 3
s_lshl_b32 s3, s3, 2
v_add_u32 v178, s3, v145
v_xor_b32 v178, v178, v144
v_lshl_add_u32 v188, v178, 4, v181
v_add_u32 v178, 8, v145
v_xor_b32 v178, v178, v144
v_lshl_add_u32 v178, v178, 4, v181
v_add_u32 v192, s39, v178
s_add_u32 s3, s38, 3
s_and_b32 s3, s3, 3
s_lshl_b32 s3, s3, 2
v_add_u32 v178, s3, v145
v_xor_b32 v178, v178, v144
v_lshl_add_u32 v189, v178, 4, v181
v_add_u32 v178, 12, v145
v_xor_b32 v178, v178, v144
v_lshl_add_u32 v178, v178, 4, v181
v_add_u32 v193, s39, v178
v_lshl_add_u32 v178, v145, 2, v149
v_and_b32 v179, 1, v148
v_lshlrev_b32 v179, 3, v179
v_lshl_add_u32 v181, v178, 8, v179
v_add_u32 v181, 65536, v181
v_lshlrev_b32 v178, 2, v149
v_lshl_add_u32 v178, v150, 1, v178
v_lshrrev_b32 v179, 1, v148
v_xor_b32 v180, v178, v179
s_lshl_b32 s5, s38, 2
s_add_u32 s3, s5, 0
s_and_b32 s3, s3, 15
v_xor_b32 v178, s3, v180
v_lshl_add_u32 v194, v178, 4, v181
s_add_u32 s3, s5, 2
s_and_b32 s3, s3, 15
v_xor_b32 v178, s3, v180
v_lshl_add_u32 v195, v178, 4, v181
s_add_u32 s3, s5, 4
s_and_b32 s3, s3, 15
v_xor_b32 v178, s3, v180
v_lshl_add_u32 v196, v178, 4, v181
s_add_u32 s3, s5, 6
s_and_b32 s3, s3, 15
v_xor_b32 v178, s3, v180
v_lshl_add_u32 v197, v178, 4, v181
s_add_u32 s3, s5, 8
s_and_b32 s3, s3, 15
v_xor_b32 v178, s3, v180
v_lshl_add_u32 v198, v178, 4, v181
s_add_u32 s3, s5, 10
s_and_b32 s3, s3, 15
v_xor_b32 v178, s3, v180
v_lshl_add_u32 v199, v178, 4, v181
s_add_u32 s3, s5, 12
s_and_b32 s3, s3, 15
v_xor_b32 v178, s3, v180
v_lshl_add_u32 v200, v178, 4, v181
s_add_u32 s3, s5, 14
s_and_b32 s3, s3, 15
v_xor_b32 v178, s3, v180
v_lshl_add_u32 v201, v178, 4, v181
s_lshl_b32 s3, s38, 2
v_add_u32 v178, s3, v145
v_and_b32 v178, 7, v178
v_xor_b32 v178, v178, v151
v_lshlrev_b32 v178, 4, v178
v_mul_u32_u24 v179, 1152, v152
s_mul_i32 s3, s38, 9216
s_add_u32 s3, s3, 147456
s_cmp_ge_u32 s38, 2
s_cselect_b32 s3, 0x40000000, s3
v_add3_u32 v207, v178, v179, s3
v_lshlrev_b32 v206, 2, v144
v_add_u32 v203, 155648, v237
s_lshr_b32 s3, s38, 1
s_lshl_b32 s3, s3, 10
s_and_b32 s5, s38, 1
s_lshl_b32 s5, s5, 3
s_add_u32 s3, s3, s5
v_add_u32 v202, s3, v203
v_lshl_add_u32 v178, v147, 4, v144
s_lshl_b32 s3, s38, 10
s_add_u32 s3, s3, 55296
v_lshl_add_u32 v239, v178, 4, s3
v_lshl_add_u32 v239, v150, 3, v239
v_lshlrev_b32 v178, 4, v144
v_add_u32 v238, 4096, v237
v_add_u32 v241, 86016, v178
s_lshl_b32 s3, s38, 2
v_add_u32 v240, s3, v241
s_mul_i32 s3, s38, 36864
s_movk_i32 s7, 3641
v_add_u32 v178, 0, v242
v_mul_u32_u24 v179, s7, v178
v_lshrrev_b32 v179, 16, v179
v_mul_u32_u24 v180, 864, v179
v_lshl_add_u32 v178, v178, 4, v180
s_sub_u32 s5, s3, 0
v_add_u32 v244, s5, v178
v_add_u32 v178, 64, v242
v_mul_u32_u24 v179, s7, v178
v_lshrrev_b32 v179, 16, v179
v_mul_u32_u24 v180, 864, v179
v_lshl_add_u32 v178, v178, 4, v180
s_sub_u32 s5, s3, 1024
v_add_u32 v245, s5, v178
v_add_u32 v178, 128, v242
v_mul_u32_u24 v179, s7, v178
v_lshrrev_b32 v179, 16, v179
v_mul_u32_u24 v180, 864, v179
v_lshl_add_u32 v178, v178, 4, v180
s_sub_u32 s5, s3, 2048
v_add_u32 v246, s5, v178
v_add_u32 v178, 192, v242
v_mul_u32_u24 v179, s7, v178
v_lshrrev_b32 v179, 16, v179
v_mul_u32_u24 v180, 864, v179
v_lshl_add_u32 v178, v178, 4, v180
s_sub_u32 s5, s3, 3072
v_add_u32 v247, s5, v178
v_add_u32 v178, 256, v242
v_mul_u32_u24 v179, s7, v178
v_lshrrev_b32 v179, 16, v179
v_mul_u32_u24 v180, 864, v179
v_lshl_add_u32 v178, v178, 4, v180
s_sub_u32 s5, s3, 0
v_add_u32 v248, s5, v178
v_add_u32 v178, 320, v242
v_mul_u32_u24 v179, s7, v178
v_lshrrev_b32 v179, 16, v179
v_mul_u32_u24 v180, 864, v179
v_lshl_add_u32 v178, v178, 4, v180
s_sub_u32 s5, s3, 1024
v_add_u32 v249, s5, v178
v_add_u32 v178, 384, v242
v_mul_u32_u24 v179, s7, v178
v_lshrrev_b32 v179, 16, v179
v_mul_u32_u24 v180, 864, v179
v_lshl_add_u32 v178, v178, 4, v180
s_sub_u32 s5, s3, 2048
v_add_u32 v250, s5, v178
v_add_u32 v178, 448, v242
v_mul_u32_u24 v179, s7, v178
v_lshrrev_b32 v179, 16, v179
v_mul_u32_u24 v180, 864, v179
v_lshl_add_u32 v178, v178, 4, v180
s_sub_u32 s5, s3, 3072
v_add_u32 v251, s5, v178
v_add_u32 v178, 512, v242
v_mul_u32_u24 v179, s7, v178
v_lshrrev_b32 v179, 16, v179
v_mul_u32_u24 v180, 864, v179
v_lshl_add_u32 v178, v178, 4, v180
s_sub_u32 s5, s3, 0
v_add_u32 v252, s5, v178
v_mov_b32 v178, 0x3f803f80
v_accvgpr_write_b32 a228, v178
v_accvgpr_write_b32 a229, v178
v_accvgpr_write_b32 a230, v178
v_accvgpr_write_b32 a231, v178
s_mul_i32 s56, s38, 9216
s_mul_i32 s61, s49, 1179648
s_mul_i32 s3, s50, 288
s_add_u32 s61, s61, s3
s_and_b32 s64, s47, 1
s_lshr_b32 s65, s50, 1
s_lshl_b32 s3, s48, 3
s_add_u32 s3, s3, s47
s_lshl_b32 s3, s3, 2
s_add_u32 s3, s3, s49
s_mul_i32 s60, s3, 294912
s_mov_b32 s4, 0x3e0293ee
s_add_u32 s42, s41, 4294950912
s_mov_b32 s43, s42
v_add_u32 v168, 49152, v210
v_add_u32 v169, 49152, v211
v_add_u32 v170, 49152, v212
v_add_u32 v171, 49152, v213
v_add_u32 v172, 49152, v214
v_add_u32 v173, 49152, v215
v_add_u32 v174, 49152, v216
v_add_u32 v175, 49152, v217
s_getpc_b64 s[66:67]
CODE01:
s_sub_u32 s66, s66, CODE01-CODEB
s_subb_u32 s67, s67, 0
s_lshr_b32 s3, s2, 3
s_lshl_b32 s3, s3, 2
s_add_u32 s3, s3, s38
s_mul_i32 s3, s3, 9
v_add_u32 v178, s3, v242
v_lshlrev_b32 v178, 7, v178
v_min_u32 v178, CODE1-CODEB-4, v178
s_mov_b64 exec, 0x1ff
global_load_dword v255, v178, s[66:67]
s_mov_b64 exec, -1
s_waitcnt vmcnt(8)
s_lshl_b32 s3, s49, 2
s_add_u32 s3, s3, s50
s_lshl_b32 s3, s3, 2
s_add_u32 s3, s3, s38
s_cmp_lg_u32 s3, 3
s_cbranch_scc1 NOPUB8
s_mov_b64 exec, 1
v_mov_b32 v185, 1
global_store_dword v253, v185, s[36:37] sc1
s_mov_b64 exec, -1
NOPUB8:
s_barrier
ds_read_b128 a[96:99], v218 offset:0
ds_read_b64_tr_b16 a[180:181], v168 offset:0
ds_read_b64_tr_b16 a[182:183], v168 offset:1024
ds_read_b128 a[100:103], v218 offset:2048
ds_read_b128 a[104:107], v220 offset:0
ds_read_b64_tr_b16 a[184:185], v169 offset:0
ds_read_b64_tr_b16 a[186:187], v169 offset:1024
ds_read_b64_tr_b16 a[188:189], v170 offset:0
ds_read_b64_tr_b16 a[190:191], v170 offset:1024
ds_read_b64_tr_b16 a[192:193], v171 offset:0
ds_read_b64_tr_b16 a[194:195], v171 offset:1024
ds_read_b64_tr_b16 a[196:197], v172 offset:0
ds_read_b64_tr_b16 a[198:199], v172 offset:1024
ds_read_b64_tr_b16 a[200:201], v173 offset:0
ds_read_b64_tr_b16 a[202:203], v173 offset:1024
ds_read_b64_tr_b16 a[204:205], v174 offset:0
ds_read_b64_tr_b16 a[206:207], v174 offset:1024
s_waitcnt lgkmcnt(10)
v_mfma_f32_16x16x32_bf16 v[96:99], a[180:183], a[96:99], 0
ds_read_b64_tr_b16 a[208:209], v175 offset:0
s_mul_i32 s44, s46, 524288
v_mfma_f32_16x16x32_bf16 v[100:103], a[180:183], a[100:103], 0
ds_read_b64_tr_b16 a[210:211], v175 offset:1024
s_add_u32 s44, s44, s52
v_mfma_f32_16x16x32_bf16 v[160:163], a[180:183], a[104:107], 0
s_lshl_b32 s45, s46, 7
s_add_u32 s45, s45, s51
v_mfma_f32_16x16x32_bf16 v[104:107], a[184:187], a[96:99], 0
ds_read_b64_tr_b16 a[180:181], v210 offset:0
s_add_u32 m0, s39, 81920
v_mfma_f32_16x16x32_bf16 v[108:111], a[184:187], a[100:103], 0
ds_read_b64_tr_b16 a[182:183], v210 offset:1024
s_add_u32 s46, s46, 1
v_mfma_f32_16x16x32_bf16 v[164:167], a[184:187], a[104:107], 0
buffer_load_dwordx4 v228, s[20:23], s44 offen  lds
s_waitcnt lgkmcnt(10)
v_mfma_f32_16x16x32_bf16 v[112:115], a[188:191], a[96:99], 0
ds_read_b64_tr_b16 a[184:185], v211 offset:0
buffer_load_dwordx4 v229, s[20:23], s44 offen offset:1024  lds
v_mfma_f32_16x16x32_bf16 v[116:119], a[188:191], a[100:103], 0
ds_read_b64_tr_b16 a[186:187], v211 offset:1024
buffer_load_dwordx4 v230, s[20:23], s44 offen offset:2048  lds
v_mfma_f32_16x16x32_bf16 v[120:123], a[192:195], a[96:99], 0
ds_read_b64_tr_b16 a[188:189], v212 offset:0
buffer_load_dwordx4 v231, s[20:23], s44 offen offset:3072  lds
v_mfma_f32_16x16x32_bf16 v[124:127], a[192:195], a[100:103], 0
ds_read_b64_tr_b16 a[190:191], v212 offset:1024
s_waitcnt lgkmcnt(10)
v_mfma_f32_16x16x32_bf16 v[128:131], a[196:199], a[96:99], 0
ds_read_b64_tr_b16 a[192:193], v213 offset:0
s_add_u32 m0, s39, 130816
v_mfma_f32_16x16x32_bf16 v[132:135], a[196:199], a[100:103], 0
ds_read_b64_tr_b16 a[194:195], v213 offset:1024
buffer_load_dwordx4 v228, s[20:23], s44 offen offset:256  lds
v_mfma_f32_16x16x32_bf16 v[136:139], a[200:203], a[96:99], 0
ds_read_b64_tr_b16 a[196:197], v214 offset:0
buffer_load_dwordx4 v229, s[20:23], s44 offen offset:1280  lds
v_mfma_f32_16x16x32_bf16 v[140:143], a[200:203], a[100:103], 0
ds_read_b64_tr_b16 a[198:199], v214 offset:1024
s_waitcnt lgkmcnt(10)
v_mfma_f32_16x16x32_bf16 v[144:147], a[204:207], a[96:99], 0
ds_read_b64_tr_b16 a[200:201], v215 offset:0
buffer_load_dwordx4 v230, s[20:23], s44 offen offset:2304  lds
v_mfma_f32_16x16x32_bf16 v[148:151], a[204:207], a[100:103], 0
ds_read_b64_tr_b16 a[202:203], v215 offset:1024
buffer_load_dwordx4 v231, s[20:23], s44 offen offset:3328  lds
v_mfma_f32_16x16x32_bf16 v[152:155], a[208:211], a[96:99], 0
ds_read_b64_tr_b16 a[204:205], v216 offset:0
s_add_u32 m0, s40, 18432
v_mfma_f32_16x16x32_bf16 v[156:159], a[208:211], a[100:103], 0
ds_read_b64_tr_b16 a[206:207], v216 offset:1024
s_waitcnt lgkmcnt(10)
v_mfma_f32_16x16x32_bf16 v[0:3], a[180:183], a[96:99], 0
ds_read_b64_tr_b16 a[208:209], v217 offset:0
s_cmp_eq_u32 s46, 9
s_cselect_b32 s46, 0, s46
v_mfma_f32_16x16x32_bf16 v[4:7], a[180:183], a[100:103], 0
ds_read_b64_tr_b16 a[210:211], v217 offset:1024
buffer_load_dwordx4 v232, s[8:11], s45 offen  lds
v_mfma_f32_16x16x32_bf16 v[64:67], a[180:183], a[104:107], 0
ds_read_b128 a[108:111], v219 offset:0
buffer_load_dwordx4 v233, s[8:11], s45 offen offset:1024  lds
v_mfma_f32_16x16x32_bf16 v[8:11], a[184:187], a[96:99], 0
ds_read_b64_tr_b16 a[180:181], v168 offset:8192
buffer_load_dwordx4 v234, s[8:11], s45 offen offset:2048  lds
v_mfma_f32_16x16x32_bf16 v[12:15], a[184:187], a[100:103], 0
ds_read_b64_tr_b16 a[182:183], v168 offset:9216
buffer_load_dwordx4 v235, s[8:11], s45 offen offset:3072  lds
v_mfma_f32_16x16x32_bf16 v[68:71], a[184:187], a[104:107], 0
ds_read_b128 a[112:115], v219 offset:2048
s_add_u32 m0, s40, 22528
s_nop 0
buffer_load_dwordx4 v236, s[8:11], s45 offen  lds
s_waitcnt lgkmcnt(12)
v_mfma_f32_16x16x32_bf16 v[16:19], a[188:191], a[96:99], 0
ds_read_b128 a[116:119], v221 offset:0
s_mul_i32 s44, s46, 524288
v_mfma_f32_16x16x32_bf16 v[20:23], a[188:191], a[100:103], 0
ds_read_b64_tr_b16 a[184:185], v169 offset:8192
s_add_u32 s44, s44, s52
v_mfma_f32_16x16x32_bf16 v[24:27], a[192:195], a[96:99], 0
ds_read_b64_tr_b16 a[186:187], v169 offset:9216
s_lshl_b32 s45, s46, 7
v_mfma_f32_16x16x32_bf16 v[28:31], a[192:195], a[100:103], 0
ds_read_b64_tr_b16 a[188:189], v170 offset:8192
s_waitcnt lgkmcnt(12)
v_mfma_f32_16x16x32_bf16 v[32:35], a[196:199], a[96:99], 0
ds_read_b64_tr_b16 a[190:191], v170 offset:9216
s_add_u32 s45, s45, s51
v_mfma_f32_16x16x32_bf16 v[36:39], a[196:199], a[100:103], 0
ds_read_b64_tr_b16 a[192:193], v171 offset:8192
s_add_u32 m0, s39, 98304
v_mfma_f32_16x16x32_bf16 v[40:43], a[200:203], a[96:99], 0
ds_read_b64_tr_b16 a[194:195], v171 offset:9216
s_add_u32 s46, s46, 1
v_mfma_f32_16x16x32_bf16 v[44:47], a[200:203], a[100:103], 0
ds_read_b64_tr_b16 a[196:197], v172 offset:8192
s_waitcnt lgkmcnt(12)
v_mfma_f32_16x16x32_bf16 v[48:51], a[204:207], a[96:99], 0
ds_read_b64_tr_b16 a[198:199], v172 offset:9216
buffer_load_dwordx4 v228, s[20:23], s44 offen  lds
v_mfma_f32_16x16x32_bf16 v[52:55], a[204:207], a[100:103], 0
ds_read_b64_tr_b16 a[200:201], v173 offset:8192
buffer_load_dwordx4 v229, s[20:23], s44 offen offset:1024  lds
v_mfma_f32_16x16x32_bf16 v[56:59], a[208:211], a[96:99], 0
ds_read_b64_tr_b16 a[202:203], v173 offset:9216
v_mfma_f32_16x16x32_bf16 v[60:63], a[208:211], a[100:103], 0
ds_read_b64_tr_b16 a[204:205], v174 offset:8192
s_waitcnt lgkmcnt(9)
v_mfma_f32_16x16x32_bf16 v[96:99], a[180:183], a[108:111], v[96:99]
ds_read_b64_tr_b16 a[206:207], v174 offset:9216
buffer_load_dwordx4 v230, s[20:23], s44 offen offset:2048  lds
v_mfma_f32_16x16x32_bf16 v[100:103], a[180:183], a[112:115], v[100:103]
ds_read_b64_tr_b16 a[208:209], v175 offset:8192
v_mfma_f32_16x16x32_bf16 v[160:163], a[180:183], a[116:119], v[160:163]
ds_read_b64_tr_b16 a[210:211], v175 offset:9216
buffer_load_dwordx4 v231, s[20:23], s44 offen offset:3072  lds
v_mfma_f32_16x16x32_bf16 v[104:107], a[184:187], a[108:111], v[104:107]
ds_read_b64_tr_b16 a[180:181], v210 offset:8192
v_mfma_f32_16x16x32_bf16 v[108:111], a[184:187], a[112:115], v[108:111]
ds_read_b64_tr_b16 a[182:183], v210 offset:9216
v_mfma_f32_16x16x32_bf16 v[164:167], a[184:187], a[116:119], v[164:167]
s_add_u32 m0, s39, 147200
s_waitcnt lgkmcnt(10)
v_mfma_f32_16x16x32_bf16 v[112:115], a[188:191], a[108:111], v[112:115]
ds_read_b64_tr_b16 a[184:185], v211 offset:8192
buffer_load_dwordx4 v228, s[20:23], s44 offen offset:256  lds
v_mfma_f32_16x16x32_bf16 v[116:119], a[188:191], a[112:115], v[116:119]
ds_read_b64_tr_b16 a[186:187], v211 offset:9216
v_mfma_f32_16x16x32_bf16 v[120:123], a[192:195], a[108:111], v[120:123]
ds_read_b64_tr_b16 a[188:189], v212 offset:8192
buffer_load_dwordx4 v229, s[20:23], s44 offen offset:1280  lds
v_mfma_f32_16x16x32_bf16 v[124:127], a[192:195], a[112:115], v[124:127]
ds_read_b64_tr_b16 a[190:191], v212 offset:9216
s_waitcnt lgkmcnt(10)
v_mfma_f32_16x16x32_bf16 v[128:131], a[196:199], a[108:111], v[128:131]
ds_read_b64_tr_b16 a[192:193], v213 offset:8192
v_mfma_f32_16x16x32_bf16 v[132:135], a[196:199], a[112:115], v[132:135]
ds_read_b64_tr_b16 a[194:195], v213 offset:9216
buffer_load_dwordx4 v230, s[20:23], s44 offen offset:2304  lds
v_mfma_f32_16x16x32_bf16 v[136:139], a[200:203], a[108:111], v[136:139]
ds_read_b64_tr_b16 a[196:197], v214 offset:8192
v_mfma_f32_16x16x32_bf16 v[140:143], a[200:203], a[112:115], v[140:143]
ds_read_b64_tr_b16 a[198:199], v214 offset:9216
s_waitcnt lgkmcnt(10)
v_mfma_f32_16x16x32_bf16 v[144:147], a[204:207], a[108:111], v[144:147]
ds_read_b64_tr_b16 a[200:201], v215 offset:8192
buffer_load_dwordx4 v231, s[20:23], s44 offen offset:3328  lds
v_mfma_f32_16x16x32_bf16 v[148:151], a[204:207], a[112:115], v[148:151]
ds_read_b64_tr_b16 a[202:203], v215 offset:9216
v_mfma_f32_16x16x32_bf16 v[152:155], a[208:211], a[108:111], v[152:155]
ds_read_b64_tr_b16 a[204:205], v216 offset:8192
v_mfma_f32_16x16x32_bf16 v[156:159], a[208:211], a[112:115], v[156:159]
ds_read_b64_tr_b16 a[206:207], v216 offset:9216
s_waitcnt lgkmcnt(10)
v_mfma_f32_16x16x32_bf16 v[0:3], a[180:183], a[108:111], v[0:3]
ds_read_b64_tr_b16 a[208:209], v217 offset:8192
s_add_u32 m0, s40, 36864
v_mfma_f32_16x16x32_bf16 v[4:7], a[180:183], a[112:115], v[4:7]
ds_read_b64_tr_b16 a[210:211], v217 offset:9216
s_cmp_eq_u32 s46, 9
s_cselect_b32 s46, 0, s46
v_mfma_f32_16x16x32_bf16 v[64:67], a[180:183], a[116:119], v[64:67]
buffer_load_dwordx4 v232, s[8:11], s45 offen  lds
v_mfma_f32_16x16x32_bf16 v[8:11], a[184:187], a[108:111], v[8:11]
buffer_load_dwordx4 v233, s[8:11], s45 offen offset:1024  lds
v_mfma_f32_16x16x32_bf16 v[12:15], a[184:187], a[112:115], v[12:15]
v_mfma_f32_16x16x32_bf16 v[68:71], a[184:187], a[116:119], v[68:71]
s_waitcnt vmcnt(10) lgkmcnt(0)
s_barrier
v_mfma_f32_16x16x32_bf16 v[16:19], a[188:191], a[108:111], v[16:19]
ds_read_b128 a[120:123], v218 offset:18432
buffer_load_dwordx4 v234, s[8:11], s45 offen offset:2048  lds
v_mfma_f32_16x16x32_bf16 v[20:23], a[188:191], a[112:115], v[20:23]
ds_read_b64_tr_b16 a[180:181], v168 offset:16384
v_mfma_f32_16x16x32_bf16 v[24:27], a[192:195], a[108:111], v[24:27]
ds_read_b64_tr_b16 a[182:183], v168 offset:17408
ds_read_b128 a[124:127], v218 offset:20480
ds_read_b128 a[128:131], v220 offset:18432
ds_read_b64_tr_b16 a[184:185], v169 offset:16384
v_mfma_f32_16x16x32_bf16 v[28:31], a[192:195], a[112:115], v[28:31]
ds_read_b64_tr_b16 a[186:187], v169 offset:17408
buffer_load_dwordx4 v235, s[8:11], s45 offen offset:3072  lds
v_mfma_f32_16x16x32_bf16 v[32:35], a[196:199], a[108:111], v[32:35]
ds_read_b64_tr_b16 a[188:189], v170 offset:16384
v_mfma_f32_16x16x32_bf16 v[36:39], a[196:199], a[112:115], v[36:39]
ds_read_b64_tr_b16 a[190:191], v170 offset:17408
s_add_u32 m0, s40, 40960
v_mfma_f32_16x16x32_bf16 v[40:43], a[200:203], a[108:111], v[40:43]
ds_read_b64_tr_b16 a[192:193], v171 offset:16384
buffer_load_dwordx4 v236, s[8:11], s45 offen  lds
v_mfma_f32_16x16x32_bf16 v[44:47], a[200:203], a[112:115], v[44:47]
ds_read_b64_tr_b16 a[194:195], v171 offset:17408
s_mul_i32 s44, s46, 524288
v_mfma_f32_16x16x32_bf16 v[48:51], a[204:207], a[108:111], v[48:51]
ds_read_b64_tr_b16 a[196:197], v172 offset:16384
s_add_u32 s44, s44, s52
v_mfma_f32_16x16x32_bf16 v[52:55], a[204:207], a[112:115], v[52:55]
ds_read_b64_tr_b16 a[198:199], v172 offset:17408
s_lshl_b32 s45, s46, 7
v_mfma_f32_16x16x32_bf16 v[56:59], a[208:211], a[108:111], v[56:59]
ds_read_b64_tr_b16 a[200:201], v173 offset:16384
s_add_u32 s45, s45, s51
v_mfma_f32_16x16x32_bf16 v[60:63], a[208:211], a[112:115], v[60:63]
ds_read_b64_tr_b16 a[202:203], v173 offset:17408
s_waitcnt lgkmcnt(8)
v_mfma_f32_16x16x32_bf16 v[96:99], a[180:183], a[120:123], v[96:99]
ds_read_b64_tr_b16 a[204:205], v174 offset:16384
s_add_u32 m0, s39, 65536
v_mfma_f32_16x16x32_bf16 v[100:103], a[180:183], a[124:127], v[100:103]
ds_read_b64_tr_b16 a[206:207], v174 offset:17408
s_add_u32 s46, s46, 1
v_mfma_f32_16x16x32_bf16 v[160:163], a[180:183], a[128:131], v[160:163]
ds_read_b64_tr_b16 a[208:209], v175 offset:16384
buffer_load_dwordx4 v228, s[20:23], s44 offen  lds
v_mfma_f32_16x16x32_bf16 v[104:107], a[184:187], a[120:123], v[104:107]
ds_read_b64_tr_b16 a[210:211], v175 offset:17408
buffer_load_dwordx4 v229, s[20:23], s44 offen offset:1024  lds
v_mfma_f32_16x16x32_bf16 v[108:111], a[184:187], a[124:127], v[108:111]
ds_read_b64_tr_b16 a[180:181], v210 offset:16384
v_mfma_f32_16x16x32_bf16 v[164:167], a[184:187], a[128:131], v[164:167]
ds_read_b64_tr_b16 a[182:183], v210 offset:17408
s_waitcnt lgkmcnt(10)
v_mfma_f32_16x16x32_bf16 v[112:115], a[188:191], a[120:123], v[112:115]
ds_read_b64_tr_b16 a[184:185], v211 offset:16384
buffer_load_dwordx4 v230, s[20:23], s44 offen offset:2048  lds
v_mfma_f32_16x16x32_bf16 v[116:119], a[188:191], a[124:127], v[116:119]
ds_read_b64_tr_b16 a[186:187], v211 offset:17408
v_mfma_f32_16x16x32_bf16 v[120:123], a[192:195], a[120:123], v[120:123]
ds_read_b64_tr_b16 a[188:189], v212 offset:16384
v_mfma_f32_16x16x32_bf16 v[124:127], a[192:195], a[124:127], v[124:127]
ds_read_b64_tr_b16 a[190:191], v212 offset:17408
s_waitcnt lgkmcnt(10)
v_mfma_f32_16x16x32_bf16 v[128:131], a[196:199], a[120:123], v[128:131]
ds_read_b64_tr_b16 a[192:193], v213 offset:16384
v_mfma_f32_16x16x32_bf16 v[132:135], a[196:199], a[124:127], v[132:135]
ds_read_b64_tr_b16 a[194:195], v213 offset:17408
buffer_load_dwordx4 v231, s[20:23], s44 offen offset:3072  lds
v_mfma_f32_16x16x32_bf16 v[136:139], a[200:203], a[120:123], v[136:139]
ds_read_b64_tr_b16 a[196:197], v214 offset:16384
v_mfma_f32_16x16x32_bf16 v[140:143], a[200:203], a[124:127], v[140:143]
ds_read_b64_tr_b16 a[198:199], v214 offset:17408
s_waitcnt lgkmcnt(10)
v_mfma_f32_16x16x32_bf16 v[144:147], a[204:207], a[120:123], v[144:147]
ds_read_b64_tr_b16 a[200:201], v215 offset:16384
v_mfma_f32_16x16x32_bf16 v[148:151], a[204:207], a[124:127], v[148:151]
ds_read_b64_tr_b16 a[202:203], v215 offset:17408
v_mfma_f32_16x16x32_bf16 v[152:155], a[208:211], a[120:123], v[152:155]
ds_read_b64_tr_b16 a[204:205], v216 offset:16384
s_add_u32 m0, s39, 114432
v_mfma_f32_16x16x32_bf16 v[156:159], a[208:211], a[124:127], v[156:159]
ds_read_b64_tr_b16 a[206:207], v216 offset:17408
s_waitcnt lgkmcnt(10)
v_mfma_f32_16x16x32_bf16 v[0:3], a[180:183], a[120:123], v[0:3]
ds_read_b64_tr_b16 a[208:209], v217 offset:16384
buffer_load_dwordx4 v228, s[20:23], s44 offen offset:256  lds
v_mfma_f32_16x16x32_bf16 v[4:7], a[180:183], a[124:127], v[4:7]
ds_read_b64_tr_b16 a[210:211], v217 offset:17408
v_mfma_f32_16x16x32_bf16 v[64:67], a[180:183], a[128:131], v[64:67]
ds_read_b128 a[132:135], v219 offset:18432
v_mfma_f32_16x16x32_bf16 v[8:11], a[184:187], a[120:123], v[8:11]
ds_read_b64_tr_b16 a[180:181], v168 offset:24576
buffer_load_dwordx4 v229, s[20:23], s44 offen offset:1280  lds
v_mfma_f32_16x16x32_bf16 v[12:15], a[184:187], a[124:127], v[12:15]
ds_read_b64_tr_b16 a[182:183], v168 offset:25600
v_mfma_f32_16x16x32_bf16 v[68:71], a[184:187], a[128:131], v[68:71]
ds_read_b128 a[136:139], v219 offset:20480
s_waitcnt lgkmcnt(12)
v_mfma_f32_16x16x32_bf16 v[16:19], a[188:191], a[120:123], v[16:19]
ds_read_b128 a[140:143], v221 offset:18432
v_mfma_f32_16x16x32_bf16 v[20:23], a[188:191], a[124:127], v[20:23]
ds_read_b64_tr_b16 a[184:185], v169 offset:24576
buffer_load_dwordx4 v230, s[20:23], s44 offen offset:2304  lds
v_mfma_f32_16x16x32_bf16 v[24:27], a[192:195], a[120:123], v[24:27]
ds_read_b64_tr_b16 a[186:187], v169 offset:25600
v_mfma_f32_16x16x32_bf16 v[28:31], a[192:195], a[124:127], v[28:31]
ds_read_b64_tr_b16 a[188:189], v170 offset:24576
s_waitcnt lgkmcnt(12)
v_mfma_f32_16x16x32_bf16 v[32:35], a[196:199], a[120:123], v[32:35]
ds_read_b64_tr_b16 a[190:191], v170 offset:25600
v_mfma_f32_16x16x32_bf16 v[36:39], a[196:199], a[124:127], v[36:39]
ds_read_b64_tr_b16 a[192:193], v171 offset:24576
v_mfma_f32_16x16x32_bf16 v[40:43], a[200:203], a[120:123], v[40:43]
ds_read_b64_tr_b16 a[194:195], v171 offset:25600
buffer_load_dwordx4 v231, s[20:23], s44 offen offset:3328  lds
v_mfma_f32_16x16x32_bf16 v[44:47], a[200:203], a[124:127], v[44:47]
ds_read_b64_tr_b16 a[196:197], v172 offset:24576
s_waitcnt lgkmcnt(12)
v_mfma_f32_16x16x32_bf16 v[48:51], a[204:207], a[120:123], v[48:51]
ds_read_b64_tr_b16 a[198:199], v172 offset:25600
v_mfma_f32_16x16x32_bf16 v[52:55], a[204:207], a[124:127], v[52:55]
ds_read_b64_tr_b16 a[200:201], v173 offset:24576
v_mfma_f32_16x16x32_bf16 v[56:59], a[208:211], a[120:123], v[56:59]
ds_read_b64_tr_b16 a[202:203], v173 offset:25600
v_mfma_f32_16x16x32_bf16 v[60:63], a[208:211], a[124:127], v[60:63]
ds_read_b64_tr_b16 a[204:205], v174 offset:24576
s_waitcnt lgkmcnt(9)
v_mfma_f32_16x16x32_bf16 v[96:99], a[180:183], a[132:135], v[96:99]
ds_read_b64_tr_b16 a[206:207], v174 offset:25600
s_add_u32 m0, s40, 0
v_mfma_f32_16x16x32_bf16 v[100:103], a[180:183], a[136:139], v[100:103]
ds_read_b64_tr_b16 a[208:209], v175 offset:24576
s_cmp_eq_u32 s46, 9
s_cselect_b32 s46, 0, s46
v_mfma_f32_16x16x32_bf16 v[160:163], a[180:183], a[140:143], v[160:163]
ds_read_b64_tr_b16 a[210:211], v175 offset:25600
buffer_load_dwordx4 v232, s[8:11], s45 offen  lds
v_mfma_f32_16x16x32_bf16 v[104:107], a[184:187], a[132:135], v[104:107]
ds_read_b64_tr_b16 a[180:181], v210 offset:24576
v_mfma_f32_16x16x32_bf16 v[108:111], a[184:187], a[136:139], v[108:111]
ds_read_b64_tr_b16 a[182:183], v210 offset:25600
buffer_load_dwordx4 v233, s[8:11], s45 offen offset:1024  lds
v_mfma_f32_16x16x32_bf16 v[164:167], a[184:187], a[140:143], v[164:167]
s_waitcnt lgkmcnt(10)
v_mfma_f32_16x16x32_bf16 v[112:115], a[188:191], a[132:135], v[112:115]
ds_read_b64_tr_b16 a[184:185], v211 offset:24576
v_mfma_f32_16x16x32_bf16 v[116:119], a[188:191], a[136:139], v[116:119]
ds_read_b64_tr_b16 a[186:187], v211 offset:25600
v_mfma_f32_16x16x32_bf16 v[120:123], a[192:195], a[132:135], v[120:123]
ds_read_b64_tr_b16 a[188:189], v212 offset:24576
buffer_load_dwordx4 v234, s[8:11], s45 offen offset:2048  lds
v_mfma_f32_16x16x32_bf16 v[124:127], a[192:195], a[136:139], v[124:127]
ds_read_b64_tr_b16 a[190:191], v212 offset:25600
s_waitcnt lgkmcnt(10)
v_mfma_f32_16x16x32_bf16 v[128:131], a[196:199], a[132:135], v[128:131]
ds_read_b64_tr_b16 a[192:193], v213 offset:24576
v_mfma_f32_16x16x32_bf16 v[132:135], a[196:199], a[136:139], v[132:135]
ds_read_b64_tr_b16 a[194:195], v213 offset:25600
v_mfma_f32_16x16x32_bf16 v[136:139], a[200:203], a[132:135], v[136:139]
ds_read_b64_tr_b16 a[196:197], v214 offset:24576
v_mfma_f32_16x16x32_bf16 v[140:143], a[200:203], a[136:139], v[140:143]
ds_read_b64_tr_b16 a[198:199], v214 offset:25600
s_waitcnt lgkmcnt(10)
v_mfma_f32_16x16x32_bf16 v[144:147], a[204:207], a[132:135], v[144:147]
ds_read_b64_tr_b16 a[200:201], v215 offset:24576
buffer_load_dwordx4 v235, s[8:11], s45 offen offset:3072  lds
v_mfma_f32_16x16x32_bf16 v[148:151], a[204:207], a[136:139], v[148:151]
ds_read_b64_tr_b16 a[202:203], v215 offset:25600
v_mfma_f32_16x16x32_bf16 v[152:155], a[208:211], a[132:135], v[152:155]
ds_read_b64_tr_b16 a[204:205], v216 offset:24576
v_mfma_f32_16x16x32_bf16 v[156:159], a[208:211], a[136:139], v[156:159]
ds_read_b64_tr_b16 a[206:207], v216 offset:25600
s_waitcnt lgkmcnt(10)
v_mfma_f32_16x16x32_bf16 v[0:3], a[180:183], a[132:135], v[0:3]
ds_read_b64_tr_b16 a[208:209], v217 offset:24576
s_add_u32 m0, s40, 4096
v_mfma_f32_16x16x32_bf16 v[4:7], a[180:183], a[136:139], v[4:7]
ds_read_b64_tr_b16 a[210:211], v217 offset:25600
buffer_load_dwordx4 v236, s[8:11], s45 offen  lds
v_mfma_f32_16x16x32_bf16 v[64:67], a[180:183], a[140:143], v[64:67]
v_mfma_f32_16x16x32_bf16 v[8:11], a[184:187], a[132:135], v[8:11]
v_mfma_f32_16x16x32_bf16 v[12:15], a[184:187], a[136:139], v[12:15]
v_mfma_f32_16x16x32_bf16 v[68:71], a[184:187], a[140:143], v[68:71]
s_waitcnt vmcnt(13) lgkmcnt(0)
s_barrier
v_mfma_f32_16x16x32_bf16 v[16:19], a[188:191], a[132:135], v[16:19]
ds_read_b128 a[96:99], v218 offset:36864
s_mul_i32 s44, s46, 524288
v_mfma_f32_16x16x32_bf16 v[20:23], a[188:191], a[136:139], v[20:23]
ds_read_b64_tr_b16 a[180:181], v168 offset:32768
s_add_u32 s44, s44, s52
v_mfma_f32_16x16x32_bf16 v[24:27], a[192:195], a[132:135], v[24:27]
ds_read_b64_tr_b16 a[182:183], v168 offset:33792
ds_read_b128 a[100:103], v218 offset:38912
ds_read_b128 a[104:107], v220 offset:36864
ds_read_b64_tr_b16 a[184:185], v169 offset:32768
v_mfma_f32_16x16x32_bf16 v[28:31], a[192:195], a[136:139], v[28:31]
ds_read_b64_tr_b16 a[186:187], v169 offset:33792
v_mfma_f32_16x16x32_bf16 v[32:35], a[196:199], a[132:135], v[32:35]
ds_read_b64_tr_b16 a[188:189], v170 offset:32768
s_lshl_b32 s45, s46, 7
v_mfma_f32_16x16x32_bf16 v[36:39], a[196:199], a[136:139], v[36:39]
ds_read_b64_tr_b16 a[190:191], v170 offset:33792
s_add_u32 s45, s45, s51
v_mfma_f32_16x16x32_bf16 v[40:43], a[200:203], a[132:135], v[40:43]
ds_read_b64_tr_b16 a[192:193], v171 offset:32768
v_mfma_f32_16x16x32_bf16 v[44:47], a[200:203], a[136:139], v[44:47]
ds_read_b64_tr_b16 a[194:195], v171 offset:33792
v_mfma_f32_16x16x32_bf16 v[48:51], a[204:207], a[132:135], v[48:51]
ds_read_b64_tr_b16 a[196:197], v172 offset:32768
v_mfma_f32_16x16x32_bf16 v[52:55], a[204:207], a[136:139], v[52:55]
ds_read_b64_tr_b16 a[198:199], v172 offset:33792
s_add_u32 m0, s39, 81920
v_mfma_f32_16x16x32_bf16 v[56:59], a[208:211], a[132:135], v[56:59]
ds_read_b64_tr_b16 a[200:201], v173 offset:32768
s_add_u32 s46, s46, 1
v_mfma_f32_16x16x32_bf16 v[60:63], a[208:211], a[136:139], v[60:63]
ds_read_b64_tr_b16 a[202:203], v173 offset:33792
s_waitcnt lgkmcnt(8)
v_mfma_f32_16x16x32_bf16 v[96:99], a[180:183], a[96:99], v[96:99]
ds_read_b64_tr_b16 a[204:205], v174 offset:32768
buffer_load_dwordx4 v228, s[20:23], s44 offen  lds
v_mfma_f32_16x16x32_bf16 v[100:103], a[180:183], a[100:103], v[100:103]
ds_read_b64_tr_b16 a[206:207], v174 offset:33792
v_mfma_f32_16x16x32_bf16 v[160:163], a[180:183], a[104:107], v[160:163]
ds_read_b64_tr_b16 a[208:209], v175 offset:32768
buffer_load_dwordx4 v229, s[20:23], s44 offen offset:1024  lds
v_mfma_f32_16x16x32_bf16 v[104:107], a[184:187], a[96:99], v[104:107]
ds_read_b64_tr_b16 a[210:211], v175 offset:33792
v_mfma_f32_16x16x32_bf16 v[108:111], a[184:187], a[100:103], v[108:111]
ds_read_b64_tr_b16 a[180:181], v210 offset:32768
v_mfma_f32_16x16x32_bf16 v[164:167], a[184:187], a[104:107], v[164:167]
ds_read_b64_tr_b16 a[182:183], v210 offset:33792
s_waitcnt lgkmcnt(10)
v_mfma_f32_16x16x32_bf16 v[112:115], a[188:191], a[96:99], v[112:115]
ds_read_b64_tr_b16 a[184:185], v211 offset:32768
buffer_load_dwordx4 v230, s[20:23], s44 offen offset:2048  lds
v_mfma_f32_16x16x32_bf16 v[116:119], a[188:191], a[100:103], v[116:119]
ds_read_b64_tr_b16 a[186:187], v211 offset:33792
v_mfma_f32_16x16x32_bf16 v[120:123], a[192:195], a[96:99], v[120:123]
ds_read_b64_tr_b16 a[188:189], v212 offset:32768
v_mfma_f32_16x16x32_bf16 v[124:127], a[192:195], a[100:103], v[124:127]
ds_read_b64_tr_b16 a[190:191], v212 offset:33792
s_waitcnt lgkmcnt(10)
v_mfma_f32_16x16x32_bf16 v[128:131], a[196:199], a[96:99], v[128:131]
ds_read_b64_tr_b16 a[192:193], v213 offset:32768
v_mfma_f32_16x16x32_bf16 v[132:135], a[196:199], a[100:103], v[132:135]
ds_read_b64_tr_b16 a[194:195], v213 offset:33792
buffer_load_dwordx4 v231, s[20:23], s44 offen offset:3072  lds
v_mfma_f32_16x16x32_bf16 v[136:139], a[200:203], a[96:99], v[136:139]
ds_read_b64_tr_b16 a[196:197], v214 offset:32768
v_mfma_f32_16x16x32_bf16 v[140:143], a[200:203], a[100:103], v[140:143]
ds_read_b64_tr_b16 a[198:199], v214 offset:33792
s_waitcnt lgkmcnt(10)
v_mfma_f32_16x16x32_bf16 v[144:147], a[204:207], a[96:99], v[144:147]
ds_read_b64_tr_b16 a[200:201], v215 offset:32768
v_mfma_f32_16x16x32_bf16 v[148:151], a[204:207], a[100:103], v[148:151]
ds_read_b64_tr_b16 a[202:203], v215 offset:33792
v_mfma_f32_16x16x32_bf16 v[152:155], a[208:211], a[96:99], v[152:155]
ds_read_b64_tr_b16 a[204:205], v216 offset:32768
s_add_u32 m0, s39, 130816
v_mfma_f32_16x16x32_bf16 v[156:159], a[208:211], a[100:103], v[156:159]
ds_read_b64_tr_b16 a[206:207], v216 offset:33792
s_waitcnt lgkmcnt(10)
v_mfma_f32_16x16x32_bf16 v[0:3], a[180:183], a[96:99], v[0:3]
ds_read_b64_tr_b16 a[208:209], v217 offset:32768
buffer_load_dwordx4 v228, s[20:23], s44 offen offset:256  lds
v_mfma_f32_16x16x32_bf16 v[4:7], a[180:183], a[100:103], v[4:7]
ds_read_b64_tr_b16 a[210:211], v217 offset:33792
v_mfma_f32_16x16x32_bf16 v[64:67], a[180:183], a[104:107], v[64:67]
ds_read_b128 a[108:111], v219 offset:36864
v_mfma_f32_16x16x32_bf16 v[8:11], a[184:187], a[96:99], v[8:11]
ds_read_b64_tr_b16 a[180:181], v168 offset:40960
buffer_load_dwordx4 v229, s[20:23], s44 offen offset:1280  lds
v_mfma_f32_16x16x32_bf16 v[12:15], a[184:187], a[100:103], v[12:15]
ds_read_b64_tr_b16 a[182:183], v168 offset:41984
v_mfma_f32_16x16x32_bf16 v[68:71], a[184:187], a[104:107], v[68:71]
ds_read_b128 a[112:115], v219 offset:38912
s_waitcnt lgkmcnt(12)
v_mfma_f32_16x16x32_bf16 v[16:19], a[188:191], a[96:99], v[16:19]
ds_read_b128 a[116:119], v221 offset:36864
v_mfma_f32_16x16x32_bf16 v[20:23], a[188:191], a[100:103], v[20:23]
ds_read_b64_tr_b16 a[184:185], v169 offset:40960
buffer_load_dwordx4 v230, s[20:23], s44 offen offset:2304  lds
v_mfma_f32_16x16x32_bf16 v[24:27], a[192:195], a[96:99], v[24:27]
ds_read_b64_tr_b16 a[186:187], v169 offset:41984
v_mfma_f32_16x16x32_bf16 v[28:31], a[192:195], a[100:103], v[28:31]
ds_read_b64_tr_b16 a[188:189], v170 offset:40960
s_waitcnt lgkmcnt(12)
v_mfma_f32_16x16x32_bf16 v[32:35], a[196:199], a[96:99], v[32:35]
ds_read_b64_tr_b16 a[190:191], v170 offset:41984
v_mfma_f32_16x16x32_bf16 v[36:39], a[196:199], a[100:103], v[36:39]
ds_read_b64_tr_b16 a[192:193], v171 offset:40960
v_mfma_f32_16x16x32_bf16 v[40:43], a[200:203], a[96:99], v[40:43]
ds_read_b64_tr_b16 a[194:195], v171 offset:41984
buffer_load_dwordx4 v231, s[20:23], s44 offen offset:3328  lds
v_mfma_f32_16x16x32_bf16 v[44:47], a[200:203], a[100:103], v[44:47]
ds_read_b64_tr_b16 a[196:197], v172 offset:40960
s_waitcnt lgkmcnt(12)
v_mfma_f32_16x16x32_bf16 v[48:51], a[204:207], a[96:99], v[48:51]
ds_read_b64_tr_b16 a[198:199], v172 offset:41984
v_mfma_f32_16x16x32_bf16 v[52:55], a[204:207], a[100:103], v[52:55]
ds_read_b64_tr_b16 a[200:201], v173 offset:40960
v_mfma_f32_16x16x32_bf16 v[56:59], a[208:211], a[96:99], v[56:59]
ds_read_b64_tr_b16 a[202:203], v173 offset:41984
v_mfma_f32_16x16x32_bf16 v[60:63], a[208:211], a[100:103], v[60:63]
ds_read_b64_tr_b16 a[204:205], v174 offset:40960
s_waitcnt lgkmcnt(9)
v_mfma_f32_16x16x32_bf16 v[96:99], a[180:183], a[108:111], v[96:99]
ds_read_b64_tr_b16 a[206:207], v174 offset:41984
s_add_u32 m0, s40, 18432
v_mfma_f32_16x16x32_bf16 v[100:103], a[180:183], a[112:115], v[100:103]
ds_read_b64_tr_b16 a[208:209], v175 offset:40960
s_cmp_eq_u32 s46, 9
s_cselect_b32 s46, 0, s46
v_mfma_f32_16x16x32_bf16 v[160:163], a[180:183], a[116:119], v[160:163]
ds_read_b64_tr_b16 a[210:211], v175 offset:41984
buffer_load_dwordx4 v232, s[8:11], s45 offen  lds
v_mfma_f32_16x16x32_bf16 v[104:107], a[184:187], a[108:111], v[104:107]
ds_read_b64_tr_b16 a[180:181], v210 offset:40960
v_mfma_f32_16x16x32_bf16 v[108:111], a[184:187], a[112:115], v[108:111]
ds_read_b64_tr_b16 a[182:183], v210 offset:41984
buffer_load_dwordx4 v233, s[8:11], s45 offen offset:1024  lds
v_mfma_f32_16x16x32_bf16 v[164:167], a[184:187], a[116:119], v[164:167]
s_waitcnt lgkmcnt(10)
v_mfma_f32_16x16x32_bf16 v[112:115], a[188:191], a[108:111], v[112:115]
ds_read_b64_tr_b16 a[184:185], v211 offset:40960
v_mfma_f32_16x16x32_bf16 v[116:119], a[188:191], a[112:115], v[116:119]
ds_read_b64_tr_b16 a[186:187], v211 offset:41984
v_mfma_f32_16x16x32_bf16 v[120:123], a[192:195], a[108:111], v[120:123]
ds_read_b64_tr_b16 a[188:189], v212 offset:40960
buffer_load_dwordx4 v234, s[8:11], s45 offen offset:2048  lds
v_mfma_f32_16x16x32_bf16 v[124:127], a[192:195], a[112:115], v[124:127]
ds_read_b64_tr_b16 a[190:191], v212 offset:41984
s_waitcnt lgkmcnt(10)
v_mfma_f32_16x16x32_bf16 v[128:131], a[196:199], a[108:111], v[128:131]
ds_read_b64_tr_b16 a[192:193], v213 offset:40960
v_mfma_f32_16x16x32_bf16 v[132:135], a[196:199], a[112:115], v[132:135]
ds_read_b64_tr_b16 a[194:195], v213 offset:41984
v_mfma_f32_16x16x32_bf16 v[136:139], a[200:203], a[108:111], v[136:139]
ds_read_b64_tr_b16 a[196:197], v214 offset:40960
v_mfma_f32_16x16x32_bf16 v[140:143], a[200:203], a[112:115], v[140:143]
ds_read_b64_tr_b16 a[198:199], v214 offset:41984
s_waitcnt lgkmcnt(10)
v_mfma_f32_16x16x32_bf16 v[144:147], a[204:207], a[108:111], v[144:147]
ds_read_b64_tr_b16 a[200:201], v215 offset:40960
buffer_load_dwordx4 v235, s[8:11], s45 offen offset:3072  lds
v_mfma_f32_16x16x32_bf16 v[148:151], a[204:207], a[112:115], v[148:151]
ds_read_b64_tr_b16 a[202:203], v215 offset:41984
v_mfma_f32_16x16x32_bf16 v[152:155], a[208:211], a[108:111], v[152:155]
ds_read_b64_tr_b16 a[204:205], v216 offset:40960
v_mfma_f32_16x16x32_bf16 v[156:159], a[208:211], a[112:115], v[156:159]
ds_read_b64_tr_b16 a[206:207], v216 offset:41984
s_waitcnt lgkmcnt(10)
v_mfma_f32_16x16x32_bf16 v[0:3], a[180:183], a[108:111], v[0:3]
ds_read_b64_tr_b16 a[208:209], v217 offset:40960
s_add_u32 m0, s40, 22528
v_mfma_f32_16x16x32_bf16 v[4:7], a[180:183], a[112:115], v[4:7]
ds_read_b64_tr_b16 a[210:211], v217 offset:41984
buffer_load_dwordx4 v236, s[8:11], s45 offen  lds
v_mfma_f32_16x16x32_bf16 v[64:67], a[180:183], a[116:119], v[64:67]
v_mfma_f32_16x16x32_bf16 v[8:11], a[184:187], a[108:111], v[8:11]
v_mfma_f32_16x16x32_bf16 v[12:15], a[184:187], a[112:115], v[12:15]
v_mfma_f32_16x16x32_bf16 v[68:71], a[184:187], a[116:119], v[68:71]
s_waitcnt vmcnt(13) lgkmcnt(0)
s_barrier
v_mfma_f32_16x16x32_bf16 v[16:19], a[188:191], a[108:111], v[16:19]
ds_read_b128 a[120:123], v218 offset:0
s_mul_i32 s44, s46, 524288
v_mfma_f32_16x16x32_bf16 v[20:23], a[188:191], a[112:115], v[20:23]
ds_read_b64_tr_b16 a[180:181], v168 offset:0
s_add_u32 s44, s44, s52
v_mfma_f32_16x16x32_bf16 v[24:27], a[192:195], a[108:111], v[24:27]
ds_read_b64_tr_b16 a[182:183], v168 offset:1024
ds_read_b128 a[124:127], v218 offset:2048
ds_read_b128 a[128:131], v220 offset:0
ds_read_b64_tr_b16 a[184:185], v169 offset:0
v_mfma_f32_16x16x32_bf16 v[28:31], a[192:195], a[112:115], v[28:31]
ds_read_b64_tr_b16 a[186:187], v169 offset:1024
v_mfma_f32_16x16x32_bf16 v[32:35], a[196:199], a[108:111], v[32:35]
ds_read_b64_tr_b16 a[188:189], v170 offset:0
s_lshl_b32 s45, s46, 7
v_mfma_f32_16x16x32_bf16 v[36:39], a[196:199], a[112:115], v[36:39]
ds_read_b64_tr_b16 a[190:191], v170 offset:1024
s_add_u32 s45, s45, s51
v_mfma_f32_16x16x32_bf16 v[40:43], a[200:203], a[108:111], v[40:43]
ds_read_b64_tr_b16 a[192:193], v171 offset:0
v_mfma_f32_16x16x32_bf16 v[44:47], a[200:203], a[112:115], v[44:47]
ds_read_b64_tr_b16 a[194:195], v171 offset:1024
v_mfma_f32_16x16x32_bf16 v[48:51], a[204:207], a[108:111], v[48:51]
ds_read_b64_tr_b16 a[196:197], v172 offset:0
v_mfma_f32_16x16x32_bf16 v[52:55], a[204:207], a[112:115], v[52:55]
ds_read_b64_tr_b16 a[198:199], v172 offset:1024
s_add_u32 m0, s39, 98304
v_mfma_f32_16x16x32_bf16 v[56:59], a[208:211], a[108:111], v[56:59]
ds_read_b64_tr_b16 a[200:201], v173 offset:0
s_add_u32 s46, s46, 1
v_mfma_f32_16x16x32_bf16 v[60:63], a[208:211], a[112:115], v[60:63]
ds_read_b64_tr_b16 a[202:203], v173 offset:1024
s_waitcnt lgkmcnt(8)
v_mfma_f32_16x16x32_bf16 v[96:99], a[180:183], a[120:123], v[96:99]
ds_read_b64_tr_b16 a[204:205], v174 offset:0
buffer_load_dwordx4 v228, s[20:23], s44 offen  lds
v_mfma_f32_16x16x32_bf16 v[100:103], a[180:183], a[124:127], v[100:103]
ds_read_b64_tr_b16 a[206:207], v174 offset:1024
v_mfma_f32_16x16x32_bf16 v[160:163], a[180:183], a[128:131], v[160:163]
ds_read_b64_tr_b16 a[208:209], v175 offset:0
buffer_load_dwordx4 v229, s[20:23], s44 offen offset:1024  lds
v_mfma_f32_16x16x32_bf16 v[104:107], a[184:187], a[120:123], v[104:107]
ds_read_b64_tr_b16 a[210:211], v175 offset:1024
v_mfma_f32_16x16x32_bf16 v[108:111], a[184:187], a[124:127], v[108:111]
ds_read_b64_tr_b16 a[180:181], v210 offset:0
v_mfma_f32_16x16x32_bf16 v[164:167], a[184:187], a[128:131], v[164:167]
ds_read_b64_tr_b16 a[182:183], v210 offset:1024
s_waitcnt lgkmcnt(10)
v_mfma_f32_16x16x32_bf16 v[112:115], a[188:191], a[120:123], v[112:115]
ds_read_b64_tr_b16 a[184:185], v211 offset:0
buffer_load_dwordx4 v230, s[20:23], s44 offen offset:2048  lds
v_mfma_f32_16x16x32_bf16 v[116:119], a[188:191], a[124:127], v[116:119]
ds_read_b64_tr_b16 a[186:187], v211 offset:1024
v_mfma_f32_16x16x32_bf16 v[120:123], a[192:195], a[120:123], v[120:123]
ds_read_b64_tr_b16 a[188:189], v212 offset:0
v_mfma_f32_16x16x32_bf16 v[124:127], a[192:195], a[124:127], v[124:127]
ds_read_b64_tr_b16 a[190:191], v212 offset:1024
s_waitcnt lgkmcnt(10)
v_mfma_f32_16x16x32_bf16 v[128:131], a[196:199], a[120:123], v[128:131]
ds_read_b64_tr_b16 a[192:193], v213 offset:0
v_mfma_f32_16x16x32_bf16 v[132:135], a[196:199], a[124:127], v[132:135]
ds_read_b64_tr_b16 a[194:195], v213 offset:1024
buffer_load_dwordx4 v231, s[20:23], s44 offen offset:3072  lds
v_mfma_f32_16x16x32_bf16 v[136:139], a[200:203], a[120:123], v[136:139]
ds_read_b64_tr_b16 a[196:197], v214 offset:0
v_mfma_f32_16x16x32_bf16 v[140:143], a[200:203], a[124:127], v[140:143]
ds_read_b64_tr_b16 a[198:199], v214 offset:1024
s_waitcnt lgkmcnt(10)
v_mfma_f32_16x16x32_bf16 v[144:147], a[204:207], a[120:123], v[144:147]
ds_read_b64_tr_b16 a[200:201], v215 offset:0
v_mfma_f32_16x16x32_bf16 v[148:151], a[204:207], a[124:127], v[148:151]
ds_read_b64_tr_b16 a[202:203], v215 offset:1024
v_mfma_f32_16x16x32_bf16 v[152:155], a[208:211], a[120:123], v[152:155]
ds_read_b64_tr_b16 a[204:205], v216 offset:0
s_add_u32 m0, s39, 147200
v_mfma_f32_16x16x32_bf16 v[156:159], a[208:211], a[124:127], v[156:159]
ds_read_b64_tr_b16 a[206:207], v216 offset:1024
s_waitcnt lgkmcnt(10)
v_mfma_f32_16x16x32_bf16 v[0:3], a[180:183], a[120:123], v[0:3]
ds_read_b64_tr_b16 a[208:209], v217 offset:0
buffer_load_dwordx4 v228, s[20:23], s44 offen offset:256  lds
v_mfma_f32_16x16x32_bf16 v[4:7], a[180:183], a[124:127], v[4:7]
ds_read_b64_tr_b16 a[210:211], v217 offset:1024
v_mfma_f32_16x16x32_bf16 v[64:67], a[180:183], a[128:131], v[64:67]
ds_read_b128 a[132:135], v219 offset:0
v_mfma_f32_16x16x32_bf16 v[8:11], a[184:187], a[120:123], v[8:11]
ds_read_b64_tr_b16 a[180:181], v168 offset:8192
buffer_load_dwordx4 v229, s[20:23], s44 offen offset:1280  lds
v_mfma_f32_16x16x32_bf16 v[12:15], a[184:187], a[124:127], v[12:15]
ds_read_b64_tr_b16 a[182:183], v168 offset:9216
v_mfma_f32_16x16x32_bf16 v[68:71], a[184:187], a[128:131], v[68:71]
ds_read_b128 a[136:139], v219 offset:2048
s_waitcnt lgkmcnt(12)
v_mfma_f32_16x16x32_bf16 v[16:19], a[188:191], a[120:123], v[16:19]
ds_read_b128 a[140:143], v221 offset:0
v_mfma_f32_16x16x32_bf16 v[20:23], a[188:191], a[124:127], v[20:23]
ds_read_b64_tr_b16 a[184:185], v169 offset:8192
buffer_load_dwordx4 v230, s[20:23], s44 offen offset:2304  lds
v_mfma_f32_16x16x32_bf16 v[24:27], a[192:195], a[120:123], v[24:27]
ds_read_b64_tr_b16 a[186:187], v169 offset:9216
v_mfma_f32_16x16x32_bf16 v[28:31], a[192:195], a[124:127], v[28:31]
ds_read_b64_tr_b16 a[188:189], v170 offset:8192
s_waitcnt lgkmcnt(12)
v_mfma_f32_16x16x32_bf16 v[32:35], a[196:199], a[120:123], v[32:35]
ds_read_b64_tr_b16 a[190:191], v170 offset:9216
v_mfma_f32_16x16x32_bf16 v[36:39], a[196:199], a[124:127], v[36:39]
ds_read_b64_tr_b16 a[192:193], v171 offset:8192
v_mfma_f32_16x16x32_bf16 v[40:43], a[200:203], a[120:123], v[40:43]
ds_read_b64_tr_b16 a[194:195], v171 offset:9216
buffer_load_dwordx4 v231, s[20:23], s44 offen offset:3328  lds
v_mfma_f32_16x16x32_bf16 v[44:47], a[200:203], a[124:127], v[44:47]
ds_read_b64_tr_b16 a[196:197], v172 offset:8192
s_waitcnt lgkmcnt(12)
v_mfma_f32_16x16x32_bf16 v[48:51], a[204:207], a[120:123], v[48:51]
ds_read_b64_tr_b16 a[198:199], v172 offset:9216
v_mfma_f32_16x16x32_bf16 v[52:55], a[204:207], a[124:127], v[52:55]
ds_read_b64_tr_b16 a[200:201], v173 offset:8192
v_mfma_f32_16x16x32_bf16 v[56:59], a[208:211], a[120:123], v[56:59]
ds_read_b64_tr_b16 a[202:203], v173 offset:9216
v_mfma_f32_16x16x32_bf16 v[60:63], a[208:211], a[124:127], v[60:63]
ds_read_b64_tr_b16 a[204:205], v174 offset:8192
s_waitcnt lgkmcnt(9)
v_mfma_f32_16x16x32_bf16 v[96:99], a[180:183], a[132:135], v[96:99]
ds_read_b64_tr_b16 a[206:207], v174 offset:9216
s_add_u32 m0, s40, 36864
v_mfma_f32_16x16x32_bf16 v[100:103], a[180:183], a[136:139], v[100:103]
ds_read_b64_tr_b16 a[208:209], v175 offset:8192
s_cmp_eq_u32 s46, 9
s_cselect_b32 s46, 0, s46
v_mfma_f32_16x16x32_bf16 v[160:163], a[180:183], a[140:143], v[160:163]
ds_read_b64_tr_b16 a[210:211], v175 offset:9216
buffer_load_dwordx4 v232, s[8:11], s45 offen  lds
v_mfma_f32_16x16x32_bf16 v[104:107], a[184:187], a[132:135], v[104:107]
ds_read_b64_tr_b16 a[180:181], v210 offset:8192
v_mfma_f32_16x16x32_bf16 v[108:111], a[184:187], a[136:139], v[108:111]
ds_read_b64_tr_b16 a[182:183], v210 offset:9216
buffer_load_dwordx4 v233, s[8:11], s45 offen offset:1024  lds
v_mfma_f32_16x16x32_bf16 v[164:167], a[184:187], a[140:143], v[164:167]
s_waitcnt lgkmcnt(10)
v_mfma_f32_16x16x32_bf16 v[112:115], a[188:191], a[132:135], v[112:115]
ds_read_b64_tr_b16 a[184:185], v211 offset:8192
v_mfma_f32_16x16x32_bf16 v[116:119], a[188:191], a[136:139], v[116:119]
ds_read_b64_tr_b16 a[186:187], v211 offset:9216
v_mfma_f32_16x16x32_bf16 v[120:123], a[192:195], a[132:135], v[120:123]
ds_read_b64_tr_b16 a[188:189], v212 offset:8192
buffer_load_dwordx4 v234, s[8:11], s45 offen offset:2048  lds
v_mfma_f32_16x16x32_bf16 v[124:127], a[192:195], a[136:139], v[124:127]
ds_read_b64_tr_b16 a[190:191], v212 offset:9216
s_waitcnt lgkmcnt(10)
v_mfma_f32_16x16x32_bf16 v[128:131], a[196:199], a[132:135], v[128:131]
ds_read_b64_tr_b16 a[192:193], v213 offset:8192
v_mfma_f32_16x16x32_bf16 v[132:135], a[196:199], a[136:139], v[132:135]
ds_read_b64_tr_b16 a[194:195], v213 offset:9216
v_mfma_f32_16x16x32_bf16 v[136:139], a[200:203], a[132:135], v[136:139]
ds_read_b64_tr_b16 a[196:197], v214 offset:8192
v_mfma_f32_16x16x32_bf16 v[140:143], a[200:203], a[136:139], v[140:143]
ds_read_b64_tr_b16 a[198:199], v214 offset:9216
s_waitcnt lgkmcnt(10)
v_mfma_f32_16x16x32_bf16 v[144:147], a[204:207], a[132:135], v[144:147]
ds_read_b64_tr_b16 a[200:201], v215 offset:8192
buffer_load_dwordx4 v235, s[8:11], s45 offen offset:3072  lds
v_mfma_f32_16x16x32_bf16 v[148:151], a[204:207], a[136:139], v[148:151]
ds_read_b64_tr_b16 a[202:203], v215 offset:9216
v_mfma_f32_16x16x32_bf16 v[152:155], a[208:211], a[132:135], v[152:155]
ds_read_b64_tr_b16 a[204:205], v216 offset:8192
v_mfma_f32_16x16x32_bf16 v[156:159], a[208:211], a[136:139], v[156:159]
ds_read_b64_tr_b16 a[206:207], v216 offset:9216
s_waitcnt lgkmcnt(10)
v_mfma_f32_16x16x32_bf16 v[0:3], a[180:183], a[132:135], v[0:3]
ds_read_b64_tr_b16 a[208:209], v217 offset:8192
s_add_u32 m0, s40, 40960
v_mfma_f32_16x16x32_bf16 v[4:7], a[180:183], a[136:139], v[4:7]
ds_read_b64_tr_b16 a[210:211], v217 offset:9216
buffer_load_dwordx4 v236, s[8:11], s45 offen  lds
v_mfma_f32_16x16x32_bf16 v[64:67], a[180:183], a[140:143], v[64:67]
v_mfma_f32_16x16x32_bf16 v[8:11], a[184:187], a[132:135], v[8:11]
v_mfma_f32_16x16x32_bf16 v[12:15], a[184:187], a[136:139], v[12:15]
v_mfma_f32_16x16x32_bf16 v[68:71], a[184:187], a[140:143], v[68:71]
s_waitcnt vmcnt(13) lgkmcnt(0)
s_barrier
v_mfma_f32_16x16x32_bf16 v[16:19], a[188:191], a[132:135], v[16:19]
ds_read_b128 a[96:99], v218 offset:18432
s_mul_i32 s44, s46, 524288
v_mfma_f32_16x16x32_bf16 v[20:23], a[188:191], a[136:139], v[20:23]
ds_read_b64_tr_b16 a[180:181], v168 offset:16384
s_add_u32 s44, s44, s52
v_mfma_f32_16x16x32_bf16 v[24:27], a[192:195], a[132:135], v[24:27]
ds_read_b64_tr_b16 a[182:183], v168 offset:17408
ds_read_b128 a[100:103], v218 offset:20480
ds_read_b128 a[104:107], v220 offset:18432
ds_read_b64_tr_b16 a[184:185], v169 offset:16384
v_mfma_f32_16x16x32_bf16 v[28:31], a[192:195], a[136:139], v[28:31]
ds_read_b64_tr_b16 a[186:187], v169 offset:17408
v_mfma_f32_16x16x32_bf16 v[32:35], a[196:199], a[132:135], v[32:35]
ds_read_b64_tr_b16 a[188:189], v170 offset:16384
s_lshl_b32 s45, s46, 7
v_mfma_f32_16x16x32_bf16 v[36:39], a[196:199], a[136:139], v[36:39]
ds_read_b64_tr_b16 a[190:191], v170 offset:17408
s_add_u32 s45, s45, s51
v_mfma_f32_16x16x32_bf16 v[40:43], a[200:203], a[132:135], v[40:43]
ds_read_b64_tr_b16 a[192:193], v171 offset:16384
v_mfma_f32_16x16x32_bf16 v[44:47], a[200:203], a[136:139], v[44:47]
ds_read_b64_tr_b16 a[194:195], v171 offset:17408
v_mfma_f32_16x16x32_bf16 v[48:51], a[204:207], a[132:135], v[48:51]
ds_read_b64_tr_b16 a[196:197], v172 offset:16384
v_mfma_f32_16x16x32_bf16 v[52:55], a[204:207], a[136:139], v[52:55]
ds_read_b64_tr_b16 a[198:199], v172 offset:17408
s_add_u32 m0, s39, 65536
v_mfma_f32_16x16x32_bf16 v[56:59], a[208:211], a[132:135], v[56:59]
ds_read_b64_tr_b16 a[200:201], v173 offset:16384
s_add_u32 s46, s46, 1
v_mfma_f32_16x16x32_bf16 v[60:63], a[208:211], a[136:139], v[60:63]
ds_read_b64_tr_b16 a[202:203], v173 offset:17408
s_waitcnt lgkmcnt(8)
v_mfma_f32_16x16x32_bf16 v[96:99], a[180:183], a[96:99], v[96:99]
ds_read_b64_tr_b16 a[204:205], v174 offset:16384
buffer_load_dwordx4 v228, s[20:23], s44 offen  lds
v_mfma_f32_16x16x32_bf16 v[100:103], a[180:183], a[100:103], v[100:103]
ds_read_b64_tr_b16 a[206:207], v174 offset:17408
v_mfma_f32_16x16x32_bf16 v[160:163], a[180:183], a[104:107], v[160:163]
ds_read_b64_tr_b16 a[208:209], v175 offset:16384
buffer_load_dwordx4 v229, s[20:23], s44 offen offset:1024  lds
v_mfma_f32_16x16x32_bf16 v[104:107], a[184:187], a[96:99], v[104:107]
ds_read_b64_tr_b16 a[210:211], v175 offset:17408
v_mfma_f32_16x16x32_bf16 v[108:111], a[184:187], a[100:103], v[108:111]
ds_read_b64_tr_b16 a[180:181], v210 offset:16384
v_mfma_f32_16x16x32_bf16 v[164:167], a[184:187], a[104:107], v[164:167]
ds_read_b64_tr_b16 a[182:183], v210 offset:17408
s_waitcnt lgkmcnt(10)
v_mfma_f32_16x16x32_bf16 v[112:115], a[188:191], a[96:99], v[112:115]
ds_read_b64_tr_b16 a[184:185], v211 offset:16384
buffer_load_dwordx4 v230, s[20:23], s44 offen offset:2048  lds
v_mfma_f32_16x16x32_bf16 v[116:119], a[188:191], a[100:103], v[116:119]
ds_read_b64_tr_b16 a[186:187], v211 offset:17408
v_mfma_f32_16x16x32_bf16 v[120:123], a[192:195], a[96:99], v[120:123]
ds_read_b64_tr_b16 a[188:189], v212 offset:16384
v_mfma_f32_16x16x32_bf16 v[124:127], a[192:195], a[100:103], v[124:127]
ds_read_b64_tr_b16 a[190:191], v212 offset:17408
s_waitcnt lgkmcnt(10)
v_mfma_f32_16x16x32_bf16 v[128:131], a[196:199], a[96:99], v[128:131]
ds_read_b64_tr_b16 a[192:193], v213 offset:16384
v_mfma_f32_16x16x32_bf16 v[132:135], a[196:199], a[100:103], v[132:135]
ds_read_b64_tr_b16 a[194:195], v213 offset:17408
buffer_load_dwordx4 v231, s[20:23], s44 offen offset:3072  lds
v_mfma_f32_16x16x32_bf16 v[136:139], a[200:203], a[96:99], v[136:139]
ds_read_b64_tr_b16 a[196:197], v214 offset:16384
v_mfma_f32_16x16x32_bf16 v[140:143], a[200:203], a[100:103], v[140:143]
ds_read_b64_tr_b16 a[198:199], v214 offset:17408
s_waitcnt lgkmcnt(10)
v_mfma_f32_16x16x32_bf16 v[144:147], a[204:207], a[96:99], v[144:147]
ds_read_b64_tr_b16 a[200:201], v215 offset:16384
v_mfma_f32_16x16x32_bf16 v[148:151], a[204:207], a[100:103], v[148:151]
ds_read_b64_tr_b16 a[202:203], v215 offset:17408
v_mfma_f32_16x16x32_bf16 v[152:155], a[208:211], a[96:99], v[152:155]
ds_read_b64_tr_b16 a[204:205], v216 offset:16384
s_add_u32 m0, s39, 114432
v_mfma_f32_16x16x32_bf16 v[156:159], a[208:211], a[100:103], v[156:159]
ds_read_b64_tr_b16 a[206:207], v216 offset:17408
s_waitcnt lgkmcnt(10)
v_mfma_f32_16x16x32_bf16 v[0:3], a[180:183], a[96:99], v[0:3]
ds_read_b64_tr_b16 a[208:209], v217 offset:16384
buffer_load_dwordx4 v228, s[20:23], s44 offen offset:256  lds
v_mfma_f32_16x16x32_bf16 v[4:7], a[180:183], a[100:103], v[4:7]
ds_read_b64_tr_b16 a[210:211], v217 offset:17408
v_mfma_f32_16x16x32_bf16 v[64:67], a[180:183], a[104:107], v[64:67]
ds_read_b128 a[108:111], v219 offset:18432
v_mfma_f32_16x16x32_bf16 v[8:11], a[184:187], a[96:99], v[8:11]
ds_read_b64_tr_b16 a[180:181], v168 offset:24576
buffer_load_dwordx4 v229, s[20:23], s44 offen offset:1280  lds
v_mfma_f32_16x16x32_bf16 v[12:15], a[184:187], a[100:103], v[12:15]
ds_read_b64_tr_b16 a[182:183], v168 offset:25600
v_mfma_f32_16x16x32_bf16 v[68:71], a[184:187], a[104:107], v[68:71]
ds_read_b128 a[112:115], v219 offset:20480
s_waitcnt lgkmcnt(12)
v_mfma_f32_16x16x32_bf16 v[16:19], a[188:191], a[96:99], v[16:19]
ds_read_b128 a[116:119], v221 offset:18432
v_mfma_f32_16x16x32_bf16 v[20:23], a[188:191], a[100:103], v[20:23]
ds_read_b64_tr_b16 a[184:185], v169 offset:24576
buffer_load_dwordx4 v230, s[20:23], s44 offen offset:2304  lds
v_mfma_f32_16x16x32_bf16 v[24:27], a[192:195], a[96:99], v[24:27]
ds_read_b64_tr_b16 a[186:187], v169 offset:25600
v_mfma_f32_16x16x32_bf16 v[28:31], a[192:195], a[100:103], v[28:31]
ds_read_b64_tr_b16 a[188:189], v170 offset:24576
s_waitcnt lgkmcnt(12)
v_mfma_f32_16x16x32_bf16 v[32:35], a[196:199], a[96:99], v[32:35]
ds_read_b64_tr_b16 a[190:191], v170 offset:25600
v_mfma_f32_16x16x32_bf16 v[36:39], a[196:199], a[100:103], v[36:39]
ds_read_b64_tr_b16 a[192:193], v171 offset:24576
v_mfma_f32_16x16x32_bf16 v[40:43], a[200:203], a[96:99], v[40:43]
ds_read_b64_tr_b16 a[194:195], v171 offset:25600
buffer_load_dwordx4 v231, s[20:23], s44 offen offset:3328  lds
v_mfma_f32_16x16x32_bf16 v[44:47], a[200:203], a[100:103], v[44:47]
ds_read_b64_tr_b16 a[196:197], v172 offset:24576
s_waitcnt lgkmcnt(12)
v_mfma_f32_16x16x32_bf16 v[48:51], a[204:207], a[96:99], v[48:51]
ds_read_b64_tr_b16 a[198:199], v172 offset:25600
v_mfma_f32_16x16x32_bf16 v[52:55], a[204:207], a[100:103], v[52:55]
ds_read_b64_tr_b16 a[200:201], v173 offset:24576
v_mfma_f32_16x16x32_bf16 v[56:59], a[208:211], a[96:99], v[56:59]
ds_read_b64_tr_b16 a[202:203], v173 offset:25600
v_mfma_f32_16x16x32_bf16 v[60:63], a[208:211], a[100:103], v[60:63]
ds_read_b64_tr_b16 a[204:205], v174 offset:24576
s_waitcnt lgkmcnt(9)
v_mfma_f32_16x16x32_bf16 v[96:99], a[180:183], a[108:111], v[96:99]
ds_read_b64_tr_b16 a[206:207], v174 offset:25600
s_add_u32 m0, s40, 0
v_mfma_f32_16x16x32_bf16 v[100:103], a[180:183], a[112:115], v[100:103]
ds_read_b64_tr_b16 a[208:209], v175 offset:24576
s_cmp_eq_u32 s46, 9
s_cselect_b32 s46, 0, s46
v_mfma_f32_16x16x32_bf16 v[160:163], a[180:183], a[116:119], v[160:163]
ds_read_b64_tr_b16 a[210:211], v175 offset:25600
buffer_load_dwordx4 v232, s[8:11], s45 offen  lds
v_mfma_f32_16x16x32_bf16 v[104:107], a[184:187], a[108:111], v[104:107]
ds_read_b64_tr_b16 a[180:181], v210 offset:24576
v_mfma_f32_16x16x32_bf16 v[108:111], a[184:187], a[112:115], v[108:111]
ds_read_b64_tr_b16 a[182:183], v210 offset:25600
buffer_load_dwordx4 v233, s[8:11], s45 offen offset:1024  lds
v_mfma_f32_16x16x32_bf16 v[164:167], a[184:187], a[116:119], v[164:167]
s_waitcnt lgkmcnt(10)
v_mfma_f32_16x16x32_bf16 v[112:115], a[188:191], a[108:111], v[112:115]
ds_read_b64_tr_b16 a[184:185], v211 offset:24576
v_mfma_f32_16x16x32_bf16 v[116:119], a[188:191], a[112:115], v[116:119]
ds_read_b64_tr_b16 a[186:187], v211 offset:25600
v_mfma_f32_16x16x32_bf16 v[120:123], a[192:195], a[108:111], v[120:123]
ds_read_b64_tr_b16 a[188:189], v212 offset:24576
buffer_load_dwordx4 v234, s[8:11], s45 offen offset:2048  lds
v_mfma_f32_16x16x32_bf16 v[124:127], a[192:195], a[112:115], v[124:127]
ds_read_b64_tr_b16 a[190:191], v212 offset:25600
s_waitcnt lgkmcnt(10)
v_mfma_f32_16x16x32_bf16 v[128:131], a[196:199], a[108:111], v[128:131]
ds_read_b64_tr_b16 a[192:193], v213 offset:24576
v_mfma_f32_16x16x32_bf16 v[132:135], a[196:199], a[112:115], v[132:135]
ds_read_b64_tr_b16 a[194:195], v213 offset:25600
v_mfma_f32_16x16x32_bf16 v[136:139], a[200:203], a[108:111], v[136:139]
ds_read_b64_tr_b16 a[196:197], v214 offset:24576
v_mfma_f32_16x16x32_bf16 v[140:143], a[200:203], a[112:115], v[140:143]
ds_read_b64_tr_b16 a[198:199], v214 offset:25600
s_waitcnt lgkmcnt(10)
v_mfma_f32_16x16x32_bf16 v[144:147], a[204:207], a[108:111], v[144:147]
ds_read_b64_tr_b16 a[200:201], v215 offset:24576
buffer_load_dwordx4 v235, s[8:11], s45 offen offset:3072  lds
v_mfma_f32_16x16x32_bf16 v[148:151], a[204:207], a[112:115], v[148:151]
ds_read_b64_tr_b16 a[202:203], v215 offset:25600
v_mfma_f32_16x16x32_bf16 v[152:155], a[208:211], a[108:111], v[152:155]
ds_read_b64_tr_b16 a[204:205], v216 offset:24576
v_mfma_f32_16x16x32_bf16 v[156:159], a[208:211], a[112:115], v[156:159]
ds_read_b64_tr_b16 a[206:207], v216 offset:25600
s_waitcnt lgkmcnt(10)
v_mfma_f32_16x16x32_bf16 v[0:3], a[180:183], a[108:111], v[0:3]
ds_read_b64_tr_b16 a[208:209], v217 offset:24576
s_add_u32 m0, s40, 4096
v_mfma_f32_16x16x32_bf16 v[4:7], a[180:183], a[112:115], v[4:7]
ds_read_b64_tr_b16 a[210:211], v217 offset:25600
buffer_load_dwordx4 v236, s[8:11], s45 offen  lds
v_mfma_f32_16x16x32_bf16 v[64:67], a[180:183], a[116:119], v[64:67]
v_mfma_f32_16x16x32_bf16 v[8:11], a[184:187], a[108:111], v[8:11]
v_mfma_f32_16x16x32_bf16 v[12:15], a[184:187], a[112:115], v[12:15]
v_mfma_f32_16x16x32_bf16 v[68:71], a[184:187], a[116:119], v[68:71]
s_waitcnt vmcnt(13) lgkmcnt(0)
s_barrier
v_mfma_f32_16x16x32_bf16 v[16:19], a[188:191], a[108:111], v[16:19]
ds_read_b128 a[120:123], v218 offset:36864
s_mul_i32 s44, s46, 524288
v_mfma_f32_16x16x32_bf16 v[20:23], a[188:191], a[112:115], v[20:23]
ds_read_b64_tr_b16 a[180:181], v168 offset:32768
s_add_u32 s44, s44, s52
v_mfma_f32_16x16x32_bf16 v[24:27], a[192:195], a[108:111], v[24:27]
ds_read_b64_tr_b16 a[182:183], v168 offset:33792
ds_read_b128 a[124:127], v218 offset:38912
ds_read_b128 a[128:131], v220 offset:36864
ds_read_b64_tr_b16 a[184:185], v169 offset:32768
v_mfma_f32_16x16x32_bf16 v[28:31], a[192:195], a[112:115], v[28:31]
ds_read_b64_tr_b16 a[186:187], v169 offset:33792
v_mfma_f32_16x16x32_bf16 v[32:35], a[196:199], a[108:111], v[32:35]
ds_read_b64_tr_b16 a[188:189], v170 offset:32768
s_lshl_b32 s45, s46, 7
v_mfma_f32_16x16x32_bf16 v[36:39], a[196:199], a[112:115], v[36:39]
ds_read_b64_tr_b16 a[190:191], v170 offset:33792
s_add_u32 s45, s45, s51
v_mfma_f32_16x16x32_bf16 v[40:43], a[200:203], a[108:111], v[40:43]
ds_read_b64_tr_b16 a[192:193], v171 offset:32768
v_mfma_f32_16x16x32_bf16 v[44:47], a[200:203], a[112:115], v[44:47]
ds_read_b64_tr_b16 a[194:195], v171 offset:33792
v_mfma_f32_16x16x32_bf16 v[48:51], a[204:207], a[108:111], v[48:51]
ds_read_b64_tr_b16 a[196:197], v172 offset:32768
v_mfma_f32_16x16x32_bf16 v[52:55], a[204:207], a[112:115], v[52:55]
ds_read_b64_tr_b16 a[198:199], v172 offset:33792
s_add_u32 m0, s39, 81920
v_mfma_f32_16x16x32_bf16 v[56:59], a[208:211], a[108:111], v[56:59]
ds_read_b64_tr_b16 a[200:201], v173 offset:32768
s_add_u32 s46, s46, 1
v_mfma_f32_16x16x32_bf16 v[60:63], a[208:211], a[112:115], v[60:63]
ds_read_b64_tr_b16 a[202:203], v173 offset:33792
s_waitcnt lgkmcnt(8)
v_mfma_f32_16x16x32_bf16 v[96:99], a[180:183], a[120:123], v[96:99]
ds_read_b64_tr_b16 a[204:205], v174 offset:32768
buffer_load_dwordx4 v228, s[20:23], s44 offen  lds
v_mfma_f32_16x16x32_bf16 v[100:103], a[180:183], a[124:127], v[100:103]
ds_read_b64_tr_b16 a[206:207], v174 offset:33792
v_mfma_f32_16x16x32_bf16 v[160:163], a[180:183], a[128:131], v[160:163]
ds_read_b64_tr_b16 a[208:209], v175 offset:32768
buffer_load_dwordx4 v229, s[20:23], s44 offen offset:1024  lds
v_mfma_f32_16x16x32_bf16 v[104:107], a[184:187], a[120:123], v[104:107]
ds_read_b64_tr_b16 a[210:211], v175 offset:33792
v_mfma_f32_16x16x32_bf16 v[108:111], a[184:187], a[124:127], v[108:111]
ds_read_b64_tr_b16 a[180:181], v210 offset:32768
v_mfma_f32_16x16x32_bf16 v[164:167], a[184:187], a[128:131], v[164:167]
ds_read_b64_tr_b16 a[182:183], v210 offset:33792
s_waitcnt lgkmcnt(10)
v_mfma_f32_16x16x32_bf16 v[112:115], a[188:191], a[120:123], v[112:115]
ds_read_b64_tr_b16 a[184:185], v211 offset:32768
buffer_load_dwordx4 v230, s[20:23], s44 offen offset:2048  lds
v_mfma_f32_16x16x32_bf16 v[116:119], a[188:191], a[124:127], v[116:119]
ds_read_b64_tr_b16 a[186:187], v211 offset:33792
v_mfma_f32_16x16x32_bf16 v[120:123], a[192:195], a[120:123], v[120:123]
ds_read_b64_tr_b16 a[188:189], v212 offset:32768
v_mfma_f32_16x16x32_bf16 v[124:127], a[192:195], a[124:127], v[124:127]
ds_read_b64_tr_b16 a[190:191], v212 offset:33792
s_waitcnt lgkmcnt(10)
v_mfma_f32_16x16x32_bf16 v[128:131], a[196:199], a[120:123], v[128:131]
ds_read_b64_tr_b16 a[192:193], v213 offset:32768
v_mfma_f32_16x16x32_bf16 v[132:135], a[196:199], a[124:127], v[132:135]
ds_read_b64_tr_b16 a[194:195], v213 offset:33792
buffer_load_dwordx4 v231, s[20:23], s44 offen offset:3072  lds
v_mfma_f32_16x16x32_bf16 v[136:139], a[200:203], a[120:123], v[136:139]
ds_read_b64_tr_b16 a[196:197], v214 offset:32768
v_mfma_f32_16x16x32_bf16 v[140:143], a[200:203], a[124:127], v[140:143]
ds_read_b64_tr_b16 a[198:199], v214 offset:33792
s_waitcnt lgkmcnt(10)
v_mfma_f32_16x16x32_bf16 v[144:147], a[204:207], a[120:123], v[144:147]
ds_read_b64_tr_b16 a[200:201], v215 offset:32768
v_mfma_f32_16x16x32_bf16 v[148:151], a[204:207], a[124:127], v[148:151]
ds_read_b64_tr_b16 a[202:203], v215 offset:33792
v_mfma_f32_16x16x32_bf16 v[152:155], a[208:211], a[120:123], v[152:155]
ds_read_b64_tr_b16 a[204:205], v216 offset:32768
s_add_u32 m0, s39, 130816
v_mfma_f32_16x16x32_bf16 v[156:159], a[208:211], a[124:127], v[156:159]
ds_read_b64_tr_b16 a[206:207], v216 offset:33792
s_waitcnt lgkmcnt(10)
v_mfma_f32_16x16x32_bf16 v[0:3], a[180:183], a[120:123], v[0:3]
ds_read_b64_tr_b16 a[208:209], v217 offset:32768
buffer_load_dwordx4 v228, s[20:23], s44 offen offset:256  lds
v_mfma_f32_16x16x32_bf16 v[4:7], a[180:183], a[124:127], v[4:7]
ds_read_b64_tr_b16 a[210:211], v217 offset:33792
v_mfma_f32_16x16x32_bf16 v[64:67], a[180:183], a[128:131], v[64:67]
ds_read_b128 a[132:135], v219 offset:36864
v_mfma_f32_16x16x32_bf16 v[8:11], a[184:187], a[120:123], v[8:11]
ds_read_b64_tr_b16 a[180:181], v168 offset:40960
buffer_load_dwordx4 v229, s[20:23], s44 offen offset:1280  lds
v_mfma_f32_16x16x32_bf16 v[12:15], a[184:187], a[124:127], v[12:15]
ds_read_b64_tr_b16 a[182:183], v168 offset:41984
v_mfma_f32_16x16x32_bf16 v[68:71], a[184:187], a[128:131], v[68:71]
ds_read_b128 a[136:139], v219 offset:38912
s_waitcnt lgkmcnt(12)
v_mfma_f32_16x16x32_bf16 v[16:19], a[188:191], a[120:123], v[16:19]
ds_read_b128 a[140:143], v221 offset:36864
v_mfma_f32_16x16x32_bf16 v[20:23], a[188:191], a[124:127], v[20:23]
ds_read_b64_tr_b16 a[184:185], v169 offset:40960
buffer_load_dwordx4 v230, s[20:23], s44 offen offset:2304  lds
v_mfma_f32_16x16x32_bf16 v[24:27], a[192:195], a[120:123], v[24:27]
ds_read_b64_tr_b16 a[186:187], v169 offset:41984
v_mfma_f32_16x16x32_bf16 v[28:31], a[192:195], a[124:127], v[28:31]
ds_read_b64_tr_b16 a[188:189], v170 offset:40960
s_waitcnt lgkmcnt(12)
v_mfma_f32_16x16x32_bf16 v[32:35], a[196:199], a[120:123], v[32:35]
ds_read_b64_tr_b16 a[190:191], v170 offset:41984
v_mfma_f32_16x16x32_bf16 v[36:39], a[196:199], a[124:127], v[36:39]
ds_read_b64_tr_b16 a[192:193], v171 offset:40960
v_mfma_f32_16x16x32_bf16 v[40:43], a[200:203], a[120:123], v[40:43]
ds_read_b64_tr_b16 a[194:195], v171 offset:41984
buffer_load_dwordx4 v231, s[20:23], s44 offen offset:3328  lds
v_mfma_f32_16x16x32_bf16 v[44:47], a[200:203], a[124:127], v[44:47]
ds_read_b64_tr_b16 a[196:197], v172 offset:40960
s_waitcnt lgkmcnt(12)
v_mfma_f32_16x16x32_bf16 v[48:51], a[204:207], a[120:123], v[48:51]
ds_read_b64_tr_b16 a[198:199], v172 offset:41984
v_mfma_f32_16x16x32_bf16 v[52:55], a[204:207], a[124:127], v[52:55]
ds_read_b64_tr_b16 a[200:201], v173 offset:40960
v_mfma_f32_16x16x32_bf16 v[56:59], a[208:211], a[120:123], v[56:59]
ds_read_b64_tr_b16 a[202:203], v173 offset:41984
v_mfma_f32_16x16x32_bf16 v[60:63], a[208:211], a[124:127], v[60:63]
ds_read_b64_tr_b16 a[204:205], v174 offset:40960
s_waitcnt lgkmcnt(9)
v_mfma_f32_16x16x32_bf16 v[96:99], a[180:183], a[132:135], v[96:99]
ds_read_b64_tr_b16 a[206:207], v174 offset:41984
s_add_u32 m0, s40, 18432
v_mfma_f32_16x16x32_bf16 v[100:103], a[180:183], a[136:139], v[100:103]
ds_read_b64_tr_b16 a[208:209], v175 offset:40960
s_cmp_eq_u32 s46, 9
s_cselect_b32 s46, 0, s46
v_mfma_f32_16x16x32_bf16 v[160:163], a[180:183], a[140:143], v[160:163]
ds_read_b64_tr_b16 a[210:211], v175 offset:41984
buffer_load_dwordx4 v232, s[8:11], s45 offen  lds
v_mfma_f32_16x16x32_bf16 v[104:107], a[184:187], a[132:135], v[104:107]
ds_read_b64_tr_b16 a[180:181], v210 offset:40960
v_mfma_f32_16x16x32_bf16 v[108:111], a[184:187], a[136:139], v[108:111]
ds_read_b64_tr_b16 a[182:183], v210 offset:41984
buffer_load_dwordx4 v233, s[8:11], s45 offen offset:1024  lds
v_mfma_f32_16x16x32_bf16 v[164:167], a[184:187], a[140:143], v[164:167]
s_waitcnt lgkmcnt(10)
v_mfma_f32_16x16x32_bf16 v[112:115], a[188:191], a[132:135], v[112:115]
ds_read_b64_tr_b16 a[184:185], v211 offset:40960
v_mfma_f32_16x16x32_bf16 v[116:119], a[188:191], a[136:139], v[116:119]
ds_read_b64_tr_b16 a[186:187], v211 offset:41984
v_mfma_f32_16x16x32_bf16 v[120:123], a[192:195], a[132:135], v[120:123]
ds_read_b64_tr_b16 a[188:189], v212 offset:40960
buffer_load_dwordx4 v234, s[8:11], s45 offen offset:2048  lds
v_mfma_f32_16x16x32_bf16 v[124:127], a[192:195], a[136:139], v[124:127]
ds_read_b64_tr_b16 a[190:191], v212 offset:41984
s_waitcnt lgkmcnt(10)
v_mfma_f32_16x16x32_bf16 v[128:131], a[196:199], a[132:135], v[128:131]
ds_read_b64_tr_b16 a[192:193], v213 offset:40960
v_mfma_f32_16x16x32_bf16 v[132:135], a[196:199], a[136:139], v[132:135]
ds_read_b64_tr_b16 a[194:195], v213 offset:41984
v_mfma_f32_16x16x32_bf16 v[136:139], a[200:203], a[132:135], v[136:139]
ds_read_b64_tr_b16 a[196:197], v214 offset:40960
v_mfma_f32_16x16x32_bf16 v[140:143], a[200:203], a[136:139], v[140:143]
ds_read_b64_tr_b16 a[198:199], v214 offset:41984
s_waitcnt lgkmcnt(10)
v_mfma_f32_16x16x32_bf16 v[144:147], a[204:207], a[132:135], v[144:147]
ds_read_b64_tr_b16 a[200:201], v215 offset:40960
buffer_load_dwordx4 v235, s[8:11], s45 offen offset:3072  lds
v_mfma_f32_16x16x32_bf16 v[148:151], a[204:207], a[136:139], v[148:151]
ds_read_b64_tr_b16 a[202:203], v215 offset:41984
v_mfma_f32_16x16x32_bf16 v[152:155], a[208:211], a[132:135], v[152:155]
ds_read_b64_tr_b16 a[204:205], v216 offset:40960
v_mfma_f32_16x16x32_bf16 v[156:159], a[208:211], a[136:139], v[156:159]
ds_read_b64_tr_b16 a[206:207], v216 offset:41984
s_waitcnt lgkmcnt(10)
v_mfma_f32_16x16x32_bf16 v[0:3], a[180:183], a[132:135], v[0:3]
ds_read_b64_tr_b16 a[208:209], v217 offset:40960
s_add_u32 m0, s40, 22528
v_mfma_f32_16x16x32_bf16 v[4:7], a[180:183], a[136:139], v[4:7]
ds_read_b64_tr_b16 a[210:211], v217 offset:41984
buffer_load_dwordx4 v236, s[8:11], s45 offen  lds
v_mfma_f32_16x16x32_bf16 v[64:67], a[180:183], a[140:143], v[64:67]
v_mfma_f32_16x16x32_bf16 v[8:11], a[184:187], a[132:135], v[8:11]
v_mfma_f32_16x16x32_bf16 v[12:15], a[184:187], a[136:139], v[12:15]
v_mfma_f32_16x16x32_bf16 v[68:71], a[184:187], a[140:143], v[68:71]
s_waitcnt vmcnt(13) lgkmcnt(0)
s_barrier
v_mfma_f32_16x16x32_bf16 v[16:19], a[188:191], a[132:135], v[16:19]
ds_read_b128 a[96:99], v218 offset:0
s_mul_i32 s44, s46, 524288
v_mfma_f32_16x16x32_bf16 v[20:23], a[188:191], a[136:139], v[20:23]
ds_read_b64_tr_b16 a[180:181], v168 offset:0
s_add_u32 s44, s44, s52
v_mfma_f32_16x16x32_bf16 v[24:27], a[192:195], a[132:135], v[24:27]
ds_read_b64_tr_b16 a[182:183], v168 offset:1024
ds_read_b128 a[100:103], v218 offset:2048
ds_read_b128 a[104:107], v220 offset:0
ds_read_b64_tr_b16 a[184:185], v169 offset:0
v_mfma_f32_16x16x32_bf16 v[28:31], a[192:195], a[136:139], v[28:31]
ds_read_b64_tr_b16 a[186:187], v169 offset:1024
v_mfma_f32_16x16x32_bf16 v[32:35], a[196:199], a[132:135], v[32:35]
ds_read_b64_tr_b16 a[188:189], v170 offset:0
s_lshl_b32 s45, s46, 7
v_mfma_f32_16x16x32_bf16 v[36:39], a[196:199], a[136:139], v[36:39]
ds_read_b64_tr_b16 a[190:191], v170 offset:1024
s_add_u32 s45, s45, s51
v_mfma_f32_16x16x32_bf16 v[40:43], a[200:203], a[132:135], v[40:43]
ds_read_b64_tr_b16 a[192:193], v171 offset:0
v_mfma_f32_16x16x32_bf16 v[44:47], a[200:203], a[136:139], v[44:47]
ds_read_b64_tr_b16 a[194:195], v171 offset:1024
v_mfma_f32_16x16x32_bf16 v[48:51], a[204:207], a[132:135], v[48:51]
ds_read_b64_tr_b16 a[196:197], v172 offset:0
v_mfma_f32_16x16x32_bf16 v[52:55], a[204:207], a[136:139], v[52:55]
ds_read_b64_tr_b16 a[198:199], v172 offset:1024
s_add_u32 m0, s39, 98304
v_mfma_f32_16x16x32_bf16 v[56:59], a[208:211], a[132:135], v[56:59]
ds_read_b64_tr_b16 a[200:201], v173 offset:0
s_add_u32 s46, s46, 1
v_mfma_f32_16x16x32_bf16 v[60:63], a[208:211], a[136:139], v[60:63]
ds_read_b64_tr_b16 a[202:203], v173 offset:1024
s_waitcnt lgkmcnt(8)
v_mfma_f32_16x16x32_bf16 v[96:99], a[180:183], a[96:99], v[96:99]
ds_read_b64_tr_b16 a[204:205], v174 offset:0
buffer_load_dwordx4 v228, s[20:23], s44 offen  lds
v_mfma_f32_16x16x32_bf16 v[100:103], a[180:183], a[100:103], v[100:103]
ds_read_b64_tr_b16 a[206:207], v174 offset:1024
v_mfma_f32_16x16x32_bf16 v[160:163], a[180:183], a[104:107], v[160:163]
ds_read_b64_tr_b16 a[208:209], v175 offset:0
buffer_load_dwordx4 v229, s[20:23], s44 offen offset:1024  lds
v_mfma_f32_16x16x32_bf16 v[104:107], a[184:187], a[96:99], v[104:107]
ds_read_b64_tr_b16 a[210:211], v175 offset:1024
v_mfma_f32_16x16x32_bf16 v[108:111], a[184:187], a[100:103], v[108:111]
ds_read_b64_tr_b16 a[180:181], v210 offset:0
v_mfma_f32_16x16x32_bf16 v[164:167], a[184:187], a[104:107], v[164:167]
ds_read_b64_tr_b16 a[182:183], v210 offset:1024
s_waitcnt lgkmcnt(10)
v_mfma_f32_16x16x32_bf16 v[112:115], a[188:191], a[96:99], v[112:115]
ds_read_b64_tr_b16 a[184:185], v211 offset:0
buffer_load_dwordx4 v230, s[20:23], s44 offen offset:2048  lds
v_mfma_f32_16x16x32_bf16 v[116:119], a[188:191], a[100:103], v[116:119]
ds_read_b64_tr_b16 a[186:187], v211 offset:1024
v_mfma_f32_16x16x32_bf16 v[120:123], a[192:195], a[96:99], v[120:123]
ds_read_b64_tr_b16 a[188:189], v212 offset:0
v_mfma_f32_16x16x32_bf16 v[124:127], a[192:195], a[100:103], v[124:127]
ds_read_b64_tr_b16 a[190:191], v212 offset:1024
s_waitcnt lgkmcnt(10)
v_mfma_f32_16x16x32_bf16 v[128:131], a[196:199], a[96:99], v[128:131]
ds_read_b64_tr_b16 a[192:193], v213 offset:0
v_mfma_f32_16x16x32_bf16 v[132:135], a[196:199], a[100:103], v[132:135]
ds_read_b64_tr_b16 a[194:195], v213 offset:1024
buffer_load_dwordx4 v231, s[20:23], s44 offen offset:3072  lds
v_mfma_f32_16x16x32_bf16 v[136:139], a[200:203], a[96:99], v[136:139]
ds_read_b64_tr_b16 a[196:197], v214 offset:0
v_mfma_f32_16x16x32_bf16 v[140:143], a[200:203], a[100:103], v[140:143]
ds_read_b64_tr_b16 a[198:199], v214 offset:1024
s_waitcnt lgkmcnt(10)
v_mfma_f32_16x16x32_bf16 v[144:147], a[204:207], a[96:99], v[144:147]
ds_read_b64_tr_b16 a[200:201], v215 offset:0
v_mfma_f32_16x16x32_bf16 v[148:151], a[204:207], a[100:103], v[148:151]
ds_read_b64_tr_b16 a[202:203], v215 offset:1024
v_mfma_f32_16x16x32_bf16 v[152:155], a[208:211], a[96:99], v[152:155]
ds_read_b64_tr_b16 a[204:205], v216 offset:0
s_add_u32 m0, s39, 147200
v_mfma_f32_16x16x32_bf16 v[156:159], a[208:211], a[100:103], v[156:159]
ds_read_b64_tr_b16 a[206:207], v216 offset:1024
s_waitcnt lgkmcnt(10)
v_mfma_f32_16x16x32_bf16 v[0:3], a[180:183], a[96:99], v[0:3]
ds_read_b64_tr_b16 a[208:209], v217 offset:0
buffer_load_dwordx4 v228, s[20:23], s44 offen offset:256  lds
v_mfma_f32_16x16x32_bf16 v[4:7], a[180:183], a[100:103], v[4:7]
ds_read_b64_tr_b16 a[210:211], v217 offset:1024
v_mfma_f32_16x16x32_bf16 v[64:67], a[180:183], a[104:107], v[64:67]
ds_read_b128 a[108:111], v219 offset:0
v_mfma_f32_16x16x32_bf16 v[8:11], a[184:187], a[96:99], v[8:11]
ds_read_b64_tr_b16 a[180:181], v168 offset:8192
buffer_load_dwordx4 v229, s[20:23], s44 offen offset:1280  lds
v_mfma_f32_16x16x32_bf16 v[12:15], a[184:187], a[100:103], v[12:15]
ds_read_b64_tr_b16 a[182:183], v168 offset:9216
v_mfma_f32_16x16x32_bf16 v[68:71], a[184:187], a[104:107], v[68:71]
ds_read_b128 a[112:115], v219 offset:2048
s_waitcnt lgkmcnt(12)
v_mfma_f32_16x16x32_bf16 v[16:19], a[188:191], a[96:99], v[16:19]
ds_read_b128 a[116:119], v221 offset:0
v_mfma_f32_16x16x32_bf16 v[20:23], a[188:191], a[100:103], v[20:23]
ds_read_b64_tr_b16 a[184:185], v169 offset:8192
buffer_load_dwordx4 v230, s[20:23], s44 offen offset:2304  lds
v_mfma_f32_16x16x32_bf16 v[24:27], a[192:195], a[96:99], v[24:27]
ds_read_b64_tr_b16 a[186:187], v169 offset:9216
v_mfma_f32_16x16x32_bf16 v[28:31], a[192:195], a[100:103], v[28:31]
ds_read_b64_tr_b16 a[188:189], v170 offset:8192
s_waitcnt lgkmcnt(12)
v_mfma_f32_16x16x32_bf16 v[32:35], a[196:199], a[96:99], v[32:35]
ds_read_b64_tr_b16 a[190:191], v170 offset:9216
v_mfma_f32_16x16x32_bf16 v[36:39], a[196:199], a[100:103], v[36:39]
ds_read_b64_tr_b16 a[192:193], v171 offset:8192
v_mfma_f32_16x16x32_bf16 v[40:43], a[200:203], a[96:99], v[40:43]
ds_read_b64_tr_b16 a[194:195], v171 offset:9216
buffer_load_dwordx4 v231, s[20:23], s44 offen offset:3328  lds
v_mfma_f32_16x16x32_bf16 v[44:47], a[200:203], a[100:103], v[44:47]
ds_read_b64_tr_b16 a[196:197], v172 offset:8192
s_waitcnt lgkmcnt(12)
v_mfma_f32_16x16x32_bf16 v[48:51], a[204:207], a[96:99], v[48:51]
ds_read_b64_tr_b16 a[198:199], v172 offset:9216
v_mfma_f32_16x16x32_bf16 v[52:55], a[204:207], a[100:103], v[52:55]
ds_read_b64_tr_b16 a[200:201], v173 offset:8192
v_mfma_f32_16x16x32_bf16 v[56:59], a[208:211], a[96:99], v[56:59]
ds_read_b64_tr_b16 a[202:203], v173 offset:9216
v_mfma_f32_16x16x32_bf16 v[60:63], a[208:211], a[100:103], v[60:63]
ds_read_b64_tr_b16 a[204:205], v174 offset:8192
s_waitcnt lgkmcnt(9)
v_mfma_f32_16x16x32_bf16 v[96:99], a[180:183], a[108:111], v[96:99]
ds_read_b64_tr_b16 a[206:207], v174 offset:9216
s_add_u32 m0, s40, 36864
v_mfma_f32_16x16x32_bf16 v[100:103], a[180:183], a[112:115], v[100:103]
ds_read_b64_tr_b16 a[208:209], v175 offset:8192
s_cmp_eq_u32 s46, 9
s_cselect_b32 s46, 0, s46
v_mfma_f32_16x16x32_bf16 v[160:163], a[180:183], a[116:119], v[160:163]
ds_read_b64_tr_b16 a[210:211], v175 offset:9216
buffer_load_dwordx4 v232, s[8:11], s45 offen  lds
v_mfma_f32_16x16x32_bf16 v[104:107], a[184:187], a[108:111], v[104:107]
ds_read_b64_tr_b16 a[180:181], v210 offset:8192
v_mfma_f32_16x16x32_bf16 v[108:111], a[184:187], a[112:115], v[108:111]
ds_read_b64_tr_b16 a[182:183], v210 offset:9216
buffer_load_dwordx4 v233, s[8:11], s45 offen offset:1024  lds
v_mfma_f32_16x16x32_bf16 v[164:167], a[184:187], a[116:119], v[164:167]
s_waitcnt lgkmcnt(10)
v_mfma_f32_16x16x32_bf16 v[112:115], a[188:191], a[108:111], v[112:115]
ds_read_b64_tr_b16 a[184:185], v211 offset:8192
v_mfma_f32_16x16x32_bf16 v[116:119], a[188:191], a[112:115], v[116:119]
ds_read_b64_tr_b16 a[186:187], v211 offset:9216
v_mfma_f32_16x16x32_bf16 v[120:123], a[192:195], a[108:111], v[120:123]
ds_read_b64_tr_b16 a[188:189], v212 offset:8192
buffer_load_dwordx4 v234, s[8:11], s45 offen offset:2048  lds
v_mfma_f32_16x16x32_bf16 v[124:127], a[192:195], a[112:115], v[124:127]
ds_read_b64_tr_b16 a[190:191], v212 offset:9216
s_waitcnt lgkmcnt(10)
v_mfma_f32_16x16x32_bf16 v[128:131], a[196:199], a[108:111], v[128:131]
ds_read_b64_tr_b16 a[192:193], v213 offset:8192
v_mfma_f32_16x16x32_bf16 v[132:135], a[196:199], a[112:115], v[132:135]
ds_read_b64_tr_b16 a[194:195], v213 offset:9216
v_mfma_f32_16x16x32_bf16 v[136:139], a[200:203], a[108:111], v[136:139]
ds_read_b64_tr_b16 a[196:197], v214 offset:8192
v_mfma_f32_16x16x32_bf16 v[140:143], a[200:203], a[112:115], v[140:143]
ds_read_b64_tr_b16 a[198:199], v214 offset:9216
s_waitcnt lgkmcnt(10)
v_mfma_f32_16x16x32_bf16 v[144:147], a[204:207], a[108:111], v[144:147]
ds_read_b64_tr_b16 a[200:201], v215 offset:8192
buffer_load_dwordx4 v235, s[8:11], s45 offen offset:3072  lds
v_mfma_f32_16x16x32_bf16 v[148:151], a[204:207], a[112:115], v[148:151]
ds_read_b64_tr_b16 a[202:203], v215 offset:9216
v_mfma_f32_16x16x32_bf16 v[152:155], a[208:211], a[108:111], v[152:155]
ds_read_b64_tr_b16 a[204:205], v216 offset:8192
v_mfma_f32_16x16x32_bf16 v[156:159], a[208:211], a[112:115], v[156:159]
ds_read_b64_tr_b16 a[206:207], v216 offset:9216
s_waitcnt lgkmcnt(10)
v_mfma_f32_16x16x32_bf16 v[0:3], a[180:183], a[108:111], v[0:3]
ds_read_b64_tr_b16 a[208:209], v217 offset:8192
s_add_u32 m0, s40, 40960
v_mfma_f32_16x16x32_bf16 v[4:7], a[180:183], a[112:115], v[4:7]
ds_read_b64_tr_b16 a[210:211], v217 offset:9216
buffer_load_dwordx4 v236, s[8:11], s45 offen  lds
v_mfma_f32_16x16x32_bf16 v[64:67], a[180:183], a[116:119], v[64:67]
v_mfma_f32_16x16x32_bf16 v[8:11], a[184:187], a[108:111], v[8:11]
v_mfma_f32_16x16x32_bf16 v[12:15], a[184:187], a[112:115], v[12:15]
v_mfma_f32_16x16x32_bf16 v[68:71], a[184:187], a[116:119], v[68:71]
s_waitcnt vmcnt(13) lgkmcnt(0)
s_barrier
v_mfma_f32_16x16x32_bf16 v[16:19], a[188:191], a[108:111], v[16:19]
ds_read_b128 a[120:123], v218 offset:18432
s_add_u32 s52, s52, 0
v_mfma_f32_16x16x32_bf16 v[20:23], a[188:191], a[112:115], v[20:23]
ds_read_b64_tr_b16 a[180:181], v168 offset:16384
v_mfma_f32_16x16x32_bf16 v[24:27], a[192:195], a[108:111], v[24:27]
ds_read_b64_tr_b16 a[182:183], v168 offset:17408
ds_read_b128 a[124:127], v218 offset:20480
ds_read_b128 a[128:131], v220 offset:18432
ds_read_b64_tr_b16 a[184:185], v169 offset:16384
v_mfma_f32_16x16x32_bf16 v[28:31], a[192:195], a[112:115], v[28:31]
ds_read_b64_tr_b16 a[186:187], v169 offset:17408
v_mfma_f32_16x16x32_bf16 v[32:35], a[196:199], a[108:111], v[32:35]
ds_read_b64_tr_b16 a[188:189], v170 offset:16384
v_mfma_f32_16x16x32_bf16 v[36:39], a[196:199], a[112:115], v[36:39]
ds_read_b64_tr_b16 a[190:191], v170 offset:17408
v_mfma_f32_16x16x32_bf16 v[40:43], a[200:203], a[108:111], v[40:43]
ds_read_b64_tr_b16 a[192:193], v171 offset:16384
v_mfma_f32_16x16x32_bf16 v[44:47], a[200:203], a[112:115], v[44:47]
ds_read_b64_tr_b16 a[194:195], v171 offset:17408
v_mfma_f32_16x16x32_bf16 v[48:51], a[204:207], a[108:111], v[48:51]
ds_read_b64_tr_b16 a[196:197], v172 offset:16384
v_mfma_f32_16x16x32_bf16 v[52:55], a[204:207], a[112:115], v[52:55]
ds_read_b64_tr_b16 a[198:199], v172 offset:17408
v_mfma_f32_16x16x32_bf16 v[56:59], a[208:211], a[108:111], v[56:59]
ds_read_b64_tr_b16 a[200:201], v173 offset:16384
v_mfma_f32_16x16x32_bf16 v[60:63], a[208:211], a[112:115], v[60:63]
ds_read_b64_tr_b16 a[202:203], v173 offset:17408
s_waitcnt lgkmcnt(8)
v_mfma_f32_16x16x32_bf16 v[96:99], a[180:183], a[120:123], v[96:99]
ds_read_b64_tr_b16 a[204:205], v174 offset:16384
v_mfma_f32_16x16x32_bf16 v[100:103], a[180:183], a[124:127], v[100:103]
ds_read_b64_tr_b16 a[206:207], v174 offset:17408
v_mfma_f32_16x16x32_bf16 v[160:163], a[180:183], a[128:131], v[160:163]
ds_read_b64_tr_b16 a[208:209], v175 offset:16384
s_add_u32 m0, s39, 0
v_mfma_f32_16x16x32_bf16 v[104:107], a[184:187], a[120:123], v[104:107]
ds_read_b64_tr_b16 a[210:211], v175 offset:17408
s_add_u32 s42, s42, 16384
v_mfma_f32_16x16x32_bf16 v[108:111], a[184:187], a[124:127], v[108:111]
ds_read_b64_tr_b16 a[180:181], v210 offset:16384
buffer_load_dwordx4 v222, s[12:15], s42 offen nt lds
v_mfma_f32_16x16x32_bf16 v[164:167], a[184:187], a[128:131], v[164:167]
ds_read_b64_tr_b16 a[182:183], v210 offset:17408
s_waitcnt lgkmcnt(10)
v_mfma_f32_16x16x32_bf16 v[112:115], a[188:191], a[120:123], v[112:115]
ds_read_b64_tr_b16 a[184:185], v211 offset:16384
v_mfma_f32_16x16x32_bf16 v[116:119], a[188:191], a[124:127], v[116:119]
ds_read_b64_tr_b16 a[186:187], v211 offset:17408
v_mfma_f32_16x16x32_bf16 v[120:123], a[192:195], a[120:123], v[120:123]
ds_read_b64_tr_b16 a[188:189], v212 offset:16384
v_mfma_f32_16x16x32_bf16 v[124:127], a[192:195], a[124:127], v[124:127]
ds_read_b64_tr_b16 a[190:191], v212 offset:17408
s_waitcnt lgkmcnt(10)
v_mfma_f32_16x16x32_bf16 v[128:131], a[196:199], a[120:123], v[128:131]
ds_read_b64_tr_b16 a[192:193], v213 offset:16384
v_mfma_f32_16x16x32_bf16 v[132:135], a[196:199], a[124:127], v[132:135]
ds_read_b64_tr_b16 a[194:195], v213 offset:17408
v_mfma_f32_16x16x32_bf16 v[136:139], a[200:203], a[120:123], v[136:139]
ds_read_b64_tr_b16 a[196:197], v214 offset:16384
v_mfma_f32_16x16x32_bf16 v[140:143], a[200:203], a[124:127], v[140:143]
ds_read_b64_tr_b16 a[198:199], v214 offset:17408
s_waitcnt lgkmcnt(10)
v_mfma_f32_16x16x32_bf16 v[144:147], a[204:207], a[120:123], v[144:147]
ds_read_b64_tr_b16 a[200:201], v215 offset:16384
v_mfma_f32_16x16x32_bf16 v[148:151], a[204:207], a[124:127], v[148:151]
ds_read_b64_tr_b16 a[202:203], v215 offset:17408
v_mfma_f32_16x16x32_bf16 v[152:155], a[208:211], a[120:123], v[152:155]
ds_read_b64_tr_b16 a[204:205], v216 offset:16384
buffer_load_dwordx4 v223, s[12:15], s42 offen offset:1024 nt lds
v_mfma_f32_16x16x32_bf16 v[156:159], a[208:211], a[124:127], v[156:159]
ds_read_b64_tr_b16 a[206:207], v216 offset:17408
s_waitcnt lgkmcnt(10)
v_mfma_f32_16x16x32_bf16 v[0:3], a[180:183], a[120:123], v[0:3]
ds_read_b64_tr_b16 a[208:209], v217 offset:16384
v_mfma_f32_16x16x32_bf16 v[4:7], a[180:183], a[124:127], v[4:7]
ds_read_b64_tr_b16 a[210:211], v217 offset:17408
v_mfma_f32_16x16x32_bf16 v[64:67], a[180:183], a[128:131], v[64:67]
ds_read_b128 a[132:135], v219 offset:18432
v_mfma_f32_16x16x32_bf16 v[8:11], a[184:187], a[120:123], v[8:11]
ds_read_b64_tr_b16 a[180:181], v168 offset:24576
v_mfma_f32_16x16x32_bf16 v[12:15], a[184:187], a[124:127], v[12:15]
ds_read_b64_tr_b16 a[182:183], v168 offset:25600
v_mfma_f32_16x16x32_bf16 v[68:71], a[184:187], a[128:131], v[68:71]
ds_read_b128 a[136:139], v219 offset:20480
s_waitcnt lgkmcnt(12)
v_mfma_f32_16x16x32_bf16 v[16:19], a[188:191], a[120:123], v[16:19]
ds_read_b128 a[140:143], v221 offset:18432
v_mfma_f32_16x16x32_bf16 v[20:23], a[188:191], a[124:127], v[20:23]
ds_read_b64_tr_b16 a[184:185], v169 offset:24576
v_mfma_f32_16x16x32_bf16 v[24:27], a[192:195], a[120:123], v[24:27]
ds_read_b64_tr_b16 a[186:187], v169 offset:25600
v_mfma_f32_16x16x32_bf16 v[28:31], a[192:195], a[124:127], v[28:31]
ds_read_b64_tr_b16 a[188:189], v170 offset:24576
s_waitcnt lgkmcnt(12)
v_mfma_f32_16x16x32_bf16 v[32:35], a[196:199], a[120:123], v[32:35]
ds_read_b64_tr_b16 a[190:191], v170 offset:25600
v_mfma_f32_16x16x32_bf16 v[36:39], a[196:199], a[124:127], v[36:39]
ds_read_b64_tr_b16 a[192:193], v171 offset:24576
v_mfma_f32_16x16x32_bf16 v[40:43], a[200:203], a[120:123], v[40:43]
ds_read_b64_tr_b16 a[194:195], v171 offset:25600
buffer_load_dwordx4 v224, s[12:15], s42 offen offset:2048 nt lds
v_mfma_f32_16x16x32_bf16 v[44:47], a[200:203], a[124:127], v[44:47]
ds_read_b64_tr_b16 a[196:197], v172 offset:24576
s_waitcnt lgkmcnt(12)
v_mfma_f32_16x16x32_bf16 v[48:51], a[204:207], a[120:123], v[48:51]
ds_read_b64_tr_b16 a[198:199], v172 offset:25600
v_mfma_f32_16x16x32_bf16 v[52:55], a[204:207], a[124:127], v[52:55]
ds_read_b64_tr_b16 a[200:201], v173 offset:24576
v_mfma_f32_16x16x32_bf16 v[56:59], a[208:211], a[120:123], v[56:59]
ds_read_b64_tr_b16 a[202:203], v173 offset:25600
v_mfma_f32_16x16x32_bf16 v[60:63], a[208:211], a[124:127], v[60:63]
ds_read_b64_tr_b16 a[204:205], v174 offset:24576
s_waitcnt lgkmcnt(9)
v_mfma_f32_16x16x32_bf16 v[96:99], a[180:183], a[132:135], v[96:99]
ds_read_b64_tr_b16 a[206:207], v174 offset:25600
v_mfma_f32_16x16x32_bf16 v[100:103], a[180:183], a[136:139], v[100:103]
ds_read_b64_tr_b16 a[208:209], v175 offset:24576
v_mfma_f32_16x16x32_bf16 v[160:163], a[180:183], a[140:143], v[160:163]
ds_read_b64_tr_b16 a[210:211], v175 offset:25600
v_mfma_f32_16x16x32_bf16 v[104:107], a[184:187], a[132:135], v[104:107]
ds_read_b64_tr_b16 a[180:181], v210 offset:24576
v_mfma_f32_16x16x32_bf16 v[108:111], a[184:187], a[136:139], v[108:111]
ds_read_b64_tr_b16 a[182:183], v210 offset:25600
v_mfma_f32_16x16x32_bf16 v[164:167], a[184:187], a[140:143], v[164:167]
s_waitcnt lgkmcnt(10)
v_mfma_f32_16x16x32_bf16 v[112:115], a[188:191], a[132:135], v[112:115]
ds_read_b64_tr_b16 a[184:185], v211 offset:24576
v_mfma_f32_16x16x32_bf16 v[116:119], a[188:191], a[136:139], v[116:119]
ds_read_b64_tr_b16 a[186:187], v211 offset:25600
v_mfma_f32_16x16x32_bf16 v[120:123], a[192:195], a[132:135], v[120:123]
ds_read_b64_tr_b16 a[188:189], v212 offset:24576
buffer_load_dwordx4 v225, s[12:15], s42 offen offset:3072 nt lds
v_mfma_f32_16x16x32_bf16 v[124:127], a[192:195], a[136:139], v[124:127]
ds_read_b64_tr_b16 a[190:191], v212 offset:25600
s_waitcnt lgkmcnt(10)
v_mfma_f32_16x16x32_bf16 v[128:131], a[196:199], a[132:135], v[128:131]
ds_read_b64_tr_b16 a[192:193], v213 offset:24576
v_mfma_f32_16x16x32_bf16 v[132:135], a[196:199], a[136:139], v[132:135]
ds_read_b64_tr_b16 a[194:195], v213 offset:25600
v_mfma_f32_16x16x32_bf16 v[136:139], a[200:203], a[132:135], v[136:139]
ds_read_b64_tr_b16 a[196:197], v214 offset:24576
v_mfma_f32_16x16x32_bf16 v[140:143], a[200:203], a[136:139], v[140:143]
ds_read_b64_tr_b16 a[198:199], v214 offset:25600
s_waitcnt lgkmcnt(10)
v_mfma_f32_16x16x32_bf16 v[144:147], a[204:207], a[132:135], v[144:147]
ds_read_b64_tr_b16 a[200:201], v215 offset:24576
v_mfma_f32_16x16x32_bf16 v[148:151], a[204:207], a[136:139], v[148:151]
ds_read_b64_tr_b16 a[202:203], v215 offset:25600
v_mfma_f32_16x16x32_bf16 v[152:155], a[208:211], a[132:135], v[152:155]
ds_read_b64_tr_b16 a[204:205], v216 offset:24576
v_mfma_f32_16x16x32_bf16 v[156:159], a[208:211], a[136:139], v[156:159]
ds_read_b64_tr_b16 a[206:207], v216 offset:25600
s_waitcnt lgkmcnt(10)
v_mfma_f32_16x16x32_bf16 v[0:3], a[180:183], a[132:135], v[0:3]
ds_read_b64_tr_b16 a[208:209], v217 offset:24576
v_mfma_f32_16x16x32_bf16 v[4:7], a[180:183], a[136:139], v[4:7]
ds_read_b64_tr_b16 a[210:211], v217 offset:25600
v_mfma_f32_16x16x32_bf16 v[64:67], a[180:183], a[140:143], v[64:67]
v_mfma_f32_16x16x32_bf16 v[8:11], a[184:187], a[132:135], v[8:11]
v_mfma_f32_16x16x32_bf16 v[12:15], a[184:187], a[136:139], v[12:15]
v_mfma_f32_16x16x32_bf16 v[68:71], a[184:187], a[140:143], v[68:71]
s_waitcnt vmcnt(4) lgkmcnt(0)
s_barrier
v_mfma_f32_16x16x32_bf16 v[16:19], a[188:191], a[132:135], v[16:19]
ds_read_b128 a[96:99], v218 offset:36864
s_add_u32 m0, s39, 16384
v_mfma_f32_16x16x32_bf16 v[20:23], a[188:191], a[136:139], v[20:23]
ds_read_b64_tr_b16 a[180:181], v168 offset:32768
s_add_u32 s42, s42, 16384
v_mfma_f32_16x16x32_bf16 v[24:27], a[192:195], a[132:135], v[24:27]
ds_read_b64_tr_b16 a[182:183], v168 offset:33792
ds_read_b128 a[100:103], v218 offset:38912
ds_read_b128 a[104:107], v220 offset:36864
ds_read_b128 a[108:111], v219 offset:36864
ds_read_b64_tr_b16 a[184:185], v168 offset:40960
v_mfma_f32_16x16x32_bf16 v[28:31], a[192:195], a[136:139], v[28:31]
ds_read_b64_tr_b16 a[186:187], v168 offset:41984
buffer_load_dwordx4 v222, s[12:15], s42 offen nt lds
v_mfma_f32_16x16x32_bf16 v[32:35], a[196:199], a[132:135], v[32:35]
ds_read_b128 a[112:115], v219 offset:38912
v_mfma_f32_16x16x32_bf16 v[36:39], a[196:199], a[136:139], v[36:39]
ds_read_b128 a[116:119], v221 offset:36864
ds_read_b64_tr_b16 a[188:189], v169 offset:32768
ds_read_b64_tr_b16 a[190:191], v169 offset:33792
v_mfma_f32_16x16x32_bf16 v[40:43], a[200:203], a[132:135], v[40:43]
ds_read_b64_tr_b16 a[192:193], v169 offset:40960
v_mfma_f32_16x16x32_bf16 v[44:47], a[200:203], a[136:139], v[44:47]
ds_read_b64_tr_b16 a[194:195], v169 offset:41984
v_mfma_f32_16x16x32_bf16 v[48:51], a[204:207], a[132:135], v[48:51]
ds_read_b64_tr_b16 a[196:197], v170 offset:32768
v_mfma_f32_16x16x32_bf16 v[52:55], a[204:207], a[136:139], v[52:55]
ds_read_b64_tr_b16 a[198:199], v170 offset:33792
v_mfma_f32_16x16x32_bf16 v[56:59], a[208:211], a[132:135], v[56:59]
ds_read_b64_tr_b16 a[200:201], v170 offset:40960
buffer_load_dwordx4 v223, s[12:15], s42 offen offset:1024 nt lds
v_mfma_f32_16x16x32_bf16 v[60:63], a[208:211], a[136:139], v[60:63]
ds_read_b64_tr_b16 a[202:203], v170 offset:41984
s_waitcnt lgkmcnt(10)
v_mfma_f32_16x16x32_bf16 v[96:99], a[180:183], a[96:99], v[96:99]
ds_read_b64_tr_b16 a[204:205], v171 offset:32768
v_mfma_f32_16x16x32_bf16 v[100:103], a[180:183], a[100:103], v[100:103]
ds_read_b64_tr_b16 a[206:207], v171 offset:33792
v_mfma_f32_16x16x32_bf16 v[160:163], a[180:183], a[104:107], v[160:163]
ds_read_b64_tr_b16 a[208:209], v171 offset:40960
v_mfma_f32_16x16x32_bf16 v[96:99], a[184:187], a[108:111], v[96:99]
ds_read_b64_tr_b16 a[210:211], v171 offset:41984
s_waitcnt lgkmcnt(10)
v_mfma_f32_16x16x32_bf16 v[100:103], a[184:187], a[112:115], v[100:103]
ds_read_b64_tr_b16 a[180:181], v172 offset:32768
v_mfma_f32_16x16x32_bf16 v[160:163], a[184:187], a[116:119], v[160:163]
ds_read_b64_tr_b16 a[182:183], v172 offset:33792
v_mfma_f32_16x16x32_bf16 v[104:107], a[188:191], a[96:99], v[104:107]
ds_read_b64_tr_b16 a[184:185], v172 offset:40960
v_mfma_f32_16x16x32_bf16 v[108:111], a[188:191], a[100:103], v[108:111]
ds_read_b64_tr_b16 a[186:187], v172 offset:41984
v_mfma_f32_16x16x32_bf16 v[164:167], a[188:191], a[104:107], v[164:167]
s_waitcnt lgkmcnt(10)
v_mfma_f32_16x16x32_bf16 v[104:107], a[192:195], a[108:111], v[104:107]
ds_read_b64_tr_b16 a[188:189], v173 offset:32768
buffer_load_dwordx4 v224, s[12:15], s42 offen offset:2048 nt lds
v_mfma_f32_16x16x32_bf16 v[108:111], a[192:195], a[112:115], v[108:111]
ds_read_b64_tr_b16 a[190:191], v173 offset:33792
v_mfma_f32_16x16x32_bf16 v[164:167], a[192:195], a[116:119], v[164:167]
v_mfma_f32_16x16x32_bf16 v[112:115], a[196:199], a[96:99], v[112:115]
ds_read_b64_tr_b16 a[192:193], v173 offset:40960
v_mfma_f32_16x16x32_bf16 v[116:119], a[196:199], a[100:103], v[116:119]
ds_read_b64_tr_b16 a[194:195], v173 offset:41984
s_waitcnt lgkmcnt(10)
v_mfma_f32_16x16x32_bf16 v[112:115], a[200:203], a[108:111], v[112:115]
ds_read_b64_tr_b16 a[196:197], v174 offset:32768
v_mfma_f32_16x16x32_bf16 v[116:119], a[200:203], a[112:115], v[116:119]
ds_read_b64_tr_b16 a[198:199], v174 offset:33792
v_mfma_f32_16x16x32_bf16 v[120:123], a[204:207], a[96:99], v[120:123]
ds_read_b64_tr_b16 a[200:201], v174 offset:40960
v_mul_f32 v160, s4, v160
v_mfma_f32_16x16x32_bf16 v[124:127], a[204:207], a[100:103], v[124:127]
ds_read_b64_tr_b16 a[202:203], v174 offset:41984
s_waitcnt lgkmcnt(10)
v_mfma_f32_16x16x32_bf16 v[120:123], a[208:211], a[108:111], v[120:123]
ds_read_b64_tr_b16 a[204:205], v175 offset:32768
v_mul_f32 v161, s4, v161
v_mfma_f32_16x16x32_bf16 v[124:127], a[208:211], a[112:115], v[124:127]
ds_read_b64_tr_b16 a[206:207], v175 offset:33792
buffer_load_dwordx4 v225, s[12:15], s42 offen offset:3072 nt lds
v_mfma_f32_16x16x32_bf16 v[128:131], a[180:183], a[96:99], v[128:131]
ds_read_b64_tr_b16 a[208:209], v175 offset:40960
v_cvt_pk_bf16_f32 v84, v160, v161
v_mfma_f32_16x16x32_bf16 v[132:135], a[180:183], a[100:103], v[132:135]
ds_read_b64_tr_b16 a[210:211], v175 offset:41984
s_waitcnt lgkmcnt(10)
v_mfma_f32_16x16x32_bf16 v[128:131], a[184:187], a[108:111], v[128:131]
ds_read_b64_tr_b16 a[180:181], v210 offset:32768
v_mul_f32 v162, s4, v162
v_mfma_f32_16x16x32_bf16 v[132:135], a[184:187], a[112:115], v[132:135]
ds_read_b64_tr_b16 a[182:183], v210 offset:33792
v_mul_f32 v163, s4, v163
v_mfma_f32_16x16x32_bf16 v[136:139], a[188:191], a[96:99], v[136:139]
ds_read_b64_tr_b16 a[184:185], v210 offset:40960
v_cvt_pk_bf16_f32 v85, v162, v163
v_mfma_f32_16x16x32_bf16 v[140:143], a[188:191], a[100:103], v[140:143]
ds_read_b64_tr_b16 a[186:187], v210 offset:41984
s_waitcnt lgkmcnt(10)
v_mfma_f32_16x16x32_bf16 v[136:139], a[192:195], a[108:111], v[136:139]
ds_read_b64_tr_b16 a[188:189], v211 offset:32768
v_mul_f32 v164, s4, v164
v_mfma_f32_16x16x32_bf16 v[140:143], a[192:195], a[112:115], v[140:143]
ds_read_b64_tr_b16 a[190:191], v211 offset:33792
v_mul_f32 v165, s4, v165
v_mfma_f32_16x16x32_bf16 v[144:147], a[196:199], a[96:99], v[144:147]
ds_read_b64_tr_b16 a[192:193], v211 offset:40960
v_cvt_pk_bf16_f32 v86, v164, v165
v_mfma_f32_16x16x32_bf16 v[148:151], a[196:199], a[100:103], v[148:151]
ds_read_b64_tr_b16 a[194:195], v211 offset:41984
s_waitcnt lgkmcnt(10)
v_mfma_f32_16x16x32_bf16 v[144:147], a[200:203], a[108:111], v[144:147]
ds_read_b64_tr_b16 a[196:197], v212 offset:32768
s_add_u32 m0, s39, 65536
v_mfma_f32_16x16x32_bf16 v[148:151], a[200:203], a[112:115], v[148:151]
ds_read_b64_tr_b16 a[198:199], v212 offset:33792
s_add_u32 s43, s43, 16384
v_mfma_f32_16x16x32_bf16 v[152:155], a[204:207], a[96:99], v[152:155]
ds_read_b64_tr_b16 a[200:201], v212 offset:40960
buffer_load_dwordx4 v226, s[16:19], s43 offen nt lds
v_mfma_f32_16x16x32_bf16 v[156:159], a[204:207], a[100:103], v[156:159]
ds_read_b64_tr_b16 a[202:203], v212 offset:41984
s_waitcnt lgkmcnt(10)
v_mfma_f32_16x16x32_bf16 v[152:155], a[208:211], a[108:111], v[152:155]
ds_read_b64_tr_b16 a[204:205], v213 offset:32768
v_mul_f32 v166, s4, v166
v_mfma_f32_16x16x32_bf16 v[156:159], a[208:211], a[112:115], v[156:159]
ds_read_b64_tr_b16 a[206:207], v213 offset:33792
v_mul_f32 v167, s4, v167
v_mfma_f32_16x16x32_bf16 v[0:3], a[180:183], a[96:99], v[0:3]
ds_read_b64_tr_b16 a[208:209], v213 offset:40960
v_cvt_pk_bf16_f32 v87, v166, v167
v_mfma_f32_16x16x32_bf16 v[4:7], a[180:183], a[100:103], v[4:7]
ds_read_b64_tr_b16 a[210:211], v213 offset:41984
v_mul_f32 v96, s4, v96
v_mfma_f32_16x16x32_bf16 v[64:67], a[180:183], a[104:107], v[64:67]
v_mul_f32 v97, s4, v97
s_waitcnt lgkmcnt(10)
v_mfma_f32_16x16x32_bf16 v[0:3], a[184:187], a[108:111], v[0:3]
ds_read_b64_tr_b16 a[180:181], v214 offset:32768
v_cvt_pk_bf16_f32 v96, v96, v97
v_mfma_f32_16x16x32_bf16 v[4:7], a[184:187], a[112:115], v[4:7]
ds_read_b64_tr_b16 a[182:183], v214 offset:33792
buffer_load_dwordx4 v227, s[16:19], s43 offen offset:1024 nt lds
v_mfma_f32_16x16x32_bf16 v[64:67], a[184:187], a[116:119], v[64:67]
v_mul_f32 v98, s4, v98
v_mul_f32 v99, s4, v99
v_mfma_f32_16x16x32_bf16 v[8:11], a[188:191], a[96:99], v[8:11]
ds_read_b64_tr_b16 a[184:185], v214 offset:40960
v_cvt_pk_bf16_f32 v97, v98, v99
v_mfma_f32_16x16x32_bf16 v[12:15], a[188:191], a[100:103], v[12:15]
ds_read_b64_tr_b16 a[186:187], v214 offset:41984
v_mul_f32 v100, s4, v100
v_mfma_f32_16x16x32_bf16 v[68:71], a[188:191], a[104:107], v[68:71]
v_mul_f32 v101, s4, v101
s_waitcnt lgkmcnt(10)
v_mfma_f32_16x16x32_bf16 v[8:11], a[192:195], a[108:111], v[8:11]
ds_read_b64_tr_b16 a[188:189], v215 offset:32768
v_cvt_pk_bf16_f32 v98, v100, v101
v_mfma_f32_16x16x32_bf16 v[12:15], a[192:195], a[112:115], v[12:15]
ds_read_b64_tr_b16 a[190:191], v215 offset:33792
v_mul_f32 v102, s4, v102
v_mfma_f32_16x16x32_bf16 v[68:71], a[192:195], a[116:119], v[68:71]
v_mul_f32 v103, s4, v103
v_cvt_pk_bf16_f32 v99, v102, v103
v_mfma_f32_16x16x32_bf16 v[16:19], a[196:199], a[96:99], v[16:19]
ds_read_b64_tr_b16 a[192:193], v215 offset:40960
v_mul_f32 v104, s4, v104
v_mfma_f32_16x16x32_bf16 v[20:23], a[196:199], a[100:103], v[20:23]
ds_read_b64_tr_b16 a[194:195], v215 offset:41984
s_waitcnt lgkmcnt(10)
v_mfma_f32_16x16x32_bf16 v[16:19], a[200:203], a[108:111], v[16:19]
ds_read_b64_tr_b16 a[196:197], v216 offset:32768
v_mul_f32 v105, s4, v105
v_mfma_f32_16x16x32_bf16 v[20:23], a[200:203], a[112:115], v[20:23]
ds_read_b64_tr_b16 a[198:199], v216 offset:33792
buffer_load_dwordx4 v226, s[16:19], s43 offen offset:2048 nt lds
v_mfma_f32_16x16x32_bf16 v[24:27], a[204:207], a[96:99], v[24:27]
ds_read_b64_tr_b16 a[200:201], v216 offset:40960
v_mul_f32 v64, s4, v64
v_mfma_f32_16x16x32_bf16 v[28:31], a[204:207], a[100:103], v[28:31]
ds_read_b64_tr_b16 a[202:203], v216 offset:41984
s_waitcnt lgkmcnt(10)
v_mfma_f32_16x16x32_bf16 v[24:27], a[208:211], a[108:111], v[24:27]
ds_read_b64_tr_b16 a[204:205], v217 offset:32768
v_mul_f32 v65, s4, v65
v_mfma_f32_16x16x32_bf16 v[28:31], a[208:211], a[112:115], v[28:31]
ds_read_b64_tr_b16 a[206:207], v217 offset:33792
v_cvt_pk_bf16_f32 v80, v64, v65
v_mfma_f32_16x16x32_bf16 v[32:35], a[180:183], a[96:99], v[32:35]
ds_read_b64_tr_b16 a[208:209], v217 offset:40960
v_mul_f32 v66, s4, v66
v_mfma_f32_16x16x32_bf16 v[36:39], a[180:183], a[100:103], v[36:39]
ds_read_b64_tr_b16 a[210:211], v217 offset:41984
s_waitcnt lgkmcnt(10)
v_mfma_f32_16x16x32_bf16 v[32:35], a[184:187], a[108:111], v[32:35]
v_mul_f32 v67, s4, v67
v_cvt_pk_bf16_f32 v81, v66, v67
v_mfma_f32_16x16x32_bf16 v[36:39], a[184:187], a[112:115], v[36:39]
v_mul_f32 v68, s4, v68
v_mul_f32 v69, s4, v69
v_mfma_f32_16x16x32_bf16 v[40:43], a[188:191], a[96:99], v[40:43]
v_cvt_pk_bf16_f32 v82, v68, v69
v_mul_f32 v70, s4, v70
v_mfma_f32_16x16x32_bf16 v[44:47], a[188:191], a[100:103], v[44:47]
buffer_load_dwordx4 v227, s[16:19], s43 offen offset:3072 nt lds
s_waitcnt lgkmcnt(6)
v_mfma_f32_16x16x32_bf16 v[40:43], a[192:195], a[108:111], v[40:43]
v_mul_f32 v71, s4, v71
v_cvt_pk_bf16_f32 v83, v70, v71
v_mfma_f32_16x16x32_bf16 v[44:47], a[192:195], a[112:115], v[44:47]
v_cvt_pk_bf16_f32 v104, v104, v105
v_mul_f32 v106, s4, v106
v_mfma_f32_16x16x32_bf16 v[48:51], a[196:199], a[96:99], v[48:51]
v_mul_f32 v107, s4, v107
v_cvt_pk_bf16_f32 v105, v106, v107
v_mfma_f32_16x16x32_bf16 v[52:55], a[196:199], a[100:103], v[52:55]
v_mul_f32 v108, s4, v108
s_waitcnt lgkmcnt(2)
v_mfma_f32_16x16x32_bf16 v[48:51], a[200:203], a[108:111], v[48:51]
v_mul_f32 v109, s4, v109
v_cvt_pk_bf16_f32 v106, v108, v109
v_mfma_f32_16x16x32_bf16 v[52:55], a[200:203], a[112:115], v[52:55]
v_mul_f32 v110, s4, v110
v_mul_f32 v111, s4, v111
v_mfma_f32_16x16x32_bf16 v[56:59], a[204:207], a[96:99], v[56:59]
v_cvt_pk_bf16_f32 v107, v110, v111
v_mul_f32 v112, s4, v112
v_mfma_f32_16x16x32_bf16 v[60:63], a[204:207], a[100:103], v[60:63]
v_mul_f32 v113, s4, v113
s_waitcnt lgkmcnt(0)
v_mfma_f32_16x16x32_bf16 v[56:59], a[208:211], a[108:111], v[56:59]
v_cvt_pk_bf16_f32 v112, v112, v113
v_mul_f32 v114, s4, v114
v_mfma_f32_16x16x32_bf16 v[60:63], a[208:211], a[112:115], v[60:63]
v_mul_f32 v115, s4, v115
v_cvt_pk_bf16_f32 v113, v114, v115
s_nop 3
ds_write_b64 v239, v[80:81]
ds_write_b64 v239, v[82:83] offset:512
ds_write_b64 v239, v[84:85] offset:4096
ds_write_b64 v239, v[86:87] offset:4608
s_cmp_lg_u32 s38, 0
s_cbranch_scc1 NORD9
global_load_dword v254, v253, s[36:37] sc1
NORD9:
v_add_u32 v178, 55296, v237
v_pk_mul_f32 v[116:117], v[116:117], s[4:5] op_sel_hi:[1,0]
v_cvt_pk_bf16_f32 v114, v116, v117
v_pk_mul_f32 v[118:119], v[118:119], s[4:5] op_sel_hi:[1,0]
v_cvt_pk_bf16_f32 v115, v118, v119
v_pk_mul_f32 v[120:121], v[120:121], s[4:5] op_sel_hi:[1,0]
v_cvt_pk_bf16_f32 v120, v120, v121
v_pk_mul_f32 v[122:123], v[122:123], s[4:5] op_sel_hi:[1,0]
v_cvt_pk_bf16_f32 v121, v122, v123
v_pk_mul_f32 v[124:125], v[124:125], s[4:5] op_sel_hi:[1,0]
v_cvt_pk_bf16_f32 v122, v124, v125
v_pk_mul_f32 v[126:127], v[126:127], s[4:5] op_sel_hi:[1,0]
v_cvt_pk_bf16_f32 v123, v126, v127
v_pk_mul_f32 v[128:129], v[128:129], s[4:5] op_sel_hi:[1,0]
v_cvt_pk_bf16_f32 v128, v128, v129
v_pk_mul_f32 v[130:131], v[130:131], s[4:5] op_sel_hi:[1,0]
v_cvt_pk_bf16_f32 v129, v130, v131
s_waitcnt vmcnt(8) lgkmcnt(0)
s_barrier
ds_read_b128 a[0:3], v178 offset:0
ds_read_b128 a[4:7], v178 offset:1024
ds_read_b128 a[8:11], v178 offset:2048
ds_read_b128 a[12:15], v178 offset:3072
ds_read_b128 a[80:83], v178 offset:4096
ds_read_b128 a[84:87], v178 offset:5120
ds_read_b128 a[88:91], v178 offset:6144
ds_read_b128 a[92:95], v178 offset:7168
ds_read_b128 a[180:183], v186 offset:0
ds_read_b128 a[184:187], v187 offset:0
ds_read_b128 a[188:191], v190 offset:0
ds_read_b128 a[192:195], v188 offset:0
ds_read_b128 a[196:199], v191 offset:0
ds_read_b128 a[200:203], v189 offset:0
ds_read_b128 a[204:207], v192 offset:0
v_pk_mul_f32 v[132:133], v[132:133], s[4:5] op_sel_hi:[1,0]
v_cvt_pk_bf16_f32 v130, v132, v133
v_pk_mul_f32 v[134:135], v[134:135], s[4:5] op_sel_hi:[1,0]
v_cvt_pk_bf16_f32 v131, v134, v135
v_pk_mul_f32 v[136:137], v[136:137], s[4:5] op_sel_hi:[1,0]
v_cvt_pk_bf16_f32 v136, v136, v137
v_pk_mul_f32 v[138:139], v[138:139], s[4:5] op_sel_hi:[1,0]
v_cvt_pk_bf16_f32 v137, v138, v139
v_pk_mul_f32 v[140:141], v[140:141], s[4:5] op_sel_hi:[1,0]
v_cvt_pk_bf16_f32 v138, v140, v141
v_pk_mul_f32 v[142:143], v[142:143], s[4:5] op_sel_hi:[1,0]
v_cvt_pk_bf16_f32 v139, v142, v143
v_pk_mul_f32 v[144:145], v[144:145], s[4:5] op_sel_hi:[1,0]
v_cvt_pk_bf16_f32 v144, v144, v145
v_pk_mul_f32 v[146:147], v[146:147], s[4:5] op_sel_hi:[1,0]
v_cvt_pk_bf16_f32 v145, v146, v147
v_pk_mul_f32 v[148:149], v[148:149], s[4:5] op_sel_hi:[1,0]
v_cvt_pk_bf16_f32 v146, v148, v149
v_pk_mul_f32 v[150:151], v[150:151], s[4:5] op_sel_hi:[1,0]
v_cvt_pk_bf16_f32 v147, v150, v151
v_pk_mul_f32 v[152:153], v[152:153], s[4:5] op_sel_hi:[1,0]
v_cvt_pk_bf16_f32 v152, v152, v153
v_pk_mul_f32 v[154:155], v[154:155], s[4:5] op_sel_hi:[1,0]
v_cvt_pk_bf16_f32 v153, v154, v155
v_pk_mul_f32 v[156:157], v[156:157], s[4:5] op_sel_hi:[1,0]
v_cvt_pk_bf16_f32 v154, v156, v157
v_pk_mul_f32 v[158:159], v[158:159], s[4:5] op_sel_hi:[1,0]
v_cvt_pk_bf16_f32 v155, v158, v159
v_permlane32_swap_b32 v96, v104
v_permlane32_swap_b32 v97, v105
v_permlane32_swap_b32 v98, v106
v_permlane32_swap_b32 v99, v107
v_permlane32_swap_b32 v112, v120
v_permlane32_swap_b32 v113, v121
v_permlane32_swap_b32 v114, v122
v_permlane32_swap_b32 v115, v123
v_permlane32_swap_b32 v128, v136
v_permlane32_swap_b32 v129, v137
v_permlane32_swap_b32 v130, v138
v_permlane32_swap_b32 v131, v139
v_permlane32_swap_b32 v144, v152
v_permlane32_swap_b32 v145, v153
v_permlane32_swap_b32 v146, v154
v_permlane32_swap_b32 v147, v155
v_permlane16_swap_b32 v96, v104
v_permlane16_swap_b32 v97, v105
v_permlane16_swap_b32 v98, v106
v_permlane16_swap_b32 v99, v107
v_permlane16_swap_b32 v112, v120
v_permlane16_swap_b32 v113, v121
v_permlane16_swap_b32 v114, v122
v_permlane16_swap_b32 v115, v123
v_permlane16_swap_b32 v128, v136
v_permlane16_swap_b32 v129, v137
v_permlane16_swap_b32 v130, v138
v_permlane16_swap_b32 v131, v139
v_permlane16_swap_b32 v144, v152
v_permlane16_swap_b32 v145, v153
v_permlane16_swap_b32 v146, v154
v_permlane16_swap_b32 v147, v155
v_accvgpr_write_b32 a48, v96
v_accvgpr_write_b32 a49, v97
v_accvgpr_write_b32 a64, v98
v_accvgpr_write_b32 a65, v99
v_accvgpr_write_b32 a50, v104
v_accvgpr_write_b32 a51, v105
v_accvgpr_write_b32 a66, v106
v_accvgpr_write_b32 a67, v107
v_accvgpr_write_b32 a52, v112
v_accvgpr_write_b32 a53, v113
v_accvgpr_write_b32 a68, v114
v_accvgpr_write_b32 a69, v115
v_accvgpr_write_b32 a54, v120
v_accvgpr_write_b32 a55, v121
v_accvgpr_write_b32 a70, v122
v_accvgpr_write_b32 a71, v123
v_accvgpr_write_b32 a56, v128
v_accvgpr_write_b32 a57, v129
v_accvgpr_write_b32 a72, v130
v_accvgpr_write_b32 a73, v131
v_accvgpr_write_b32 a58, v136
v_accvgpr_write_b32 a59, v137
v_accvgpr_write_b32 a74, v138
v_accvgpr_write_b32 a75, v139
v_accvgpr_write_b32 a60, v144
v_accvgpr_write_b32 a61, v145
v_accvgpr_write_b32 a76, v146
v_accvgpr_write_b32 a77, v147
v_accvgpr_write_b32 a62, v152
v_accvgpr_write_b32 a63, v153
v_accvgpr_write_b32 a78, v154
v_accvgpr_write_b32 a79, v155
v_pk_mul_f32 v[0:1], v[0:1], s[4:5] op_sel_hi:[1,0]
v_pk_mul_f32 v[2:3], v[2:3], s[4:5] op_sel_hi:[1,0]
v_pk_mul_f32 v[4:5], v[4:5], s[4:5] op_sel_hi:[1,0]
v_pk_mul_f32 v[6:7], v[6:7], s[4:5] op_sel_hi:[1,0]
v_pk_mul_f32 v[8:9], v[8:9], s[4:5] op_sel_hi:[1,0]
v_pk_mul_f32 v[10:11], v[10:11], s[4:5] op_sel_hi:[1,0]
v_pk_mul_f32 v[12:13], v[12:13], s[4:5] op_sel_hi:[1,0]
v_pk_mul_f32 v[14:15], v[14:15], s[4:5] op_sel_hi:[1,0]
v_pk_mul_f32 v[16:17], v[16:17], s[4:5] op_sel_hi:[1,0]
v_pk_mul_f32 v[18:19], v[18:19], s[4:5] op_sel_hi:[1,0]
v_pk_mul_f32 v[20:21], v[20:21], s[4:5] op_sel_hi:[1,0]
v_pk_mul_f32 v[22:23], v[22:23], s[4:5] op_sel_hi:[1,0]
v_pk_mul_f32 v[24:25], v[24:25], s[4:5] op_sel_hi:[1,0]
v_pk_mul_f32 v[26:27], v[26:27], s[4:5] op_sel_hi:[1,0]
v_pk_mul_f32 v[28:29], v[28:29], s[4:5] op_sel_hi:[1,0]
v_pk_mul_f32 v[30:31], v[30:31], s[4:5] op_sel_hi:[1,0]
v_pk_mul_f32 v[32:33], v[32:33], s[4:5] op_sel_hi:[1,0]
v_pk_mul_f32 v[34:35], v[34:35], s[4:5] op_sel_hi:[1,0]
v_pk_mul_f32 v[36:37], v[36:37], s[4:5] op_sel_hi:[1,0]
v_pk_mul_f32 v[38:39], v[38:39], s[4:5] op_sel_hi:[1,0]
v_pk_mul_f32 v[40:41], v[40:41], s[4:5] op_sel_hi:[1,0]
v_pk_mul_f32 v[42:43], v[42:43], s[4:5] op_sel_hi:[1,0]
v_pk_mul_f32 v[44:45], v[44:45], s[4:5] op_sel_hi:[1,0]
v_pk_mul_f32 v[46:47], v[46:47], s[4:5] op_sel_hi:[1,0]
v_pk_mul_f32 v[48:49], v[48:49], s[4:5] op_sel_hi:[1,0]
v_pk_mul_f32 v[50:51], v[50:51], s[4:5] op_sel_hi:[1,0]
v_pk_mul_f32 v[52:53], v[52:53], s[4:5] op_sel_hi:[1,0]
v_pk_mul_f32 v[54:55], v[54:55], s[4:5] op_sel_hi:[1,0]
v_pk_mul_f32 v[56:57], v[56:57], s[4:5] op_sel_hi:[1,0]
v_pk_mul_f32 v[58:59], v[58:59], s[4:5] op_sel_hi:[1,0]
v_pk_mul_f32 v[60:61], v[60:61], s[4:5] op_sel_hi:[1,0]
v_pk_mul_f32 v[62:63], v[62:63], s[4:5] op_sel_hi:[1,0]
v_cvt_pk_bf16_f32 v112, v0, v1
v_cvt_pk_bf16_f32 v113, v2, v3
v_cvt_pk_bf16_f32 v128, v4, v5
v_cvt_pk_bf16_f32 v129, v6, v7
v_cvt_pk_bf16_f32 v114, v8, v9
v_cvt_pk_bf16_f32 v115, v10, v11
v_cvt_pk_bf16_f32 v130, v12, v13
v_cvt_pk_bf16_f32 v131, v14, v15
v_cvt_pk_bf16_f32 v116, v16, v17
v_cvt_pk_bf16_f32 v117, v18, v19
v_cvt_pk_bf16_f32 v132, v20, v21
v_cvt_pk_bf16_f32 v133, v22, v23
v_cvt_pk_bf16_f32 v118, v24, v25
v_cvt_pk_bf16_f32 v119, v26, v27
v_cvt_pk_bf16_f32 v134, v28, v29
v_cvt_pk_bf16_f32 v135, v30, v31
v_cvt_pk_bf16_f32 v120, v32, v33
v_cvt_pk_bf16_f32 v121, v34, v35
v_cvt_pk_bf16_f32 v136, v36, v37
v_cvt_pk_bf16_f32 v137, v38, v39
v_cvt_pk_bf16_f32 v122, v40, v41
v_cvt_pk_bf16_f32 v123, v42, v43
v_cvt_pk_bf16_f32 v138, v44, v45
v_cvt_pk_bf16_f32 v139, v46, v47
v_cvt_pk_bf16_f32 v124, v48, v49
v_cvt_pk_bf16_f32 v125, v50, v51
v_cvt_pk_bf16_f32 v140, v52, v53
v_cvt_pk_bf16_f32 v141, v54, v55
v_cvt_pk_bf16_f32 v126, v56, v57
v_cvt_pk_bf16_f32 v127, v58, v59
v_cvt_pk_bf16_f32 v142, v60, v61
v_cvt_pk_bf16_f32 v143, v62, v63
v_mov_b32 v156, 0
v_mov_b32 v157, 0
v_mov_b32 v158, 0
v_mov_b32 v159, 0
v_mov_b32 v160, 0
v_mov_b32 v161, 0
v_mov_b32 v162, 0
v_mov_b32 v163, 0
v_mov_b32 v164, 0
v_mov_b32 v165, 0
v_mov_b32 v166, 0
v_mov_b32 v167, 0
v_permlane32_swap_b32 v112, v114
v_permlane32_swap_b32 v113, v115
v_permlane32_swap_b32 v116, v118
v_permlane32_swap_b32 v117, v119
v_permlane32_swap_b32 v120, v122
v_permlane32_swap_b32 v121, v123
v_permlane32_swap_b32 v124, v126
v_permlane32_swap_b32 v125, v127
v_permlane32_swap_b32 v128, v130
v_permlane32_swap_b32 v129, v131
v_permlane32_swap_b32 v132, v134
v_permlane32_swap_b32 v133, v135
v_permlane32_swap_b32 v136, v138
v_permlane32_swap_b32 v137, v139
v_permlane32_swap_b32 v140, v142
v_permlane32_swap_b32 v141, v143
v_permlane16_swap_b32 v112, v114
v_permlane16_swap_b32 v113, v115
v_permlane16_swap_b32 v116, v118
v_permlane16_swap_b32 v117, v119
v_permlane16_swap_b32 v120, v122
v_permlane16_swap_b32 v121, v123
v_permlane16_swap_b32 v124, v126
v_permlane16_swap_b32 v125, v127
v_permlane16_swap_b32 v128, v130
v_permlane16_swap_b32 v129, v131
v_permlane16_swap_b32 v132, v134
v_permlane16_swap_b32 v133, v135
v_permlane16_swap_b32 v136, v138
v_permlane16_swap_b32 v137, v139
v_permlane16_swap_b32 v140, v142
v_permlane16_swap_b32 v141, v143
s_mov_b32 s54, 0
ATT10:
s_mov_b32 s46, s55
v_mov_b32 v177, 0
s_waitcnt lgkmcnt(3)
v_mfma_f32_16x16x32_bf16 v[64:67], a[180:183], v[112:115], v[156:159]
ds_read_b128 a[208:211], v186 offset:4096
s_add_u32 m0, s39, 32768
v_mfma_f32_16x16x32_bf16 v[72:75], a[180:183], v[128:131], v[160:163]
s_add_u32 s42, s42, 16384
buffer_load_dwordx4 v222, s[12:15], s42 offen nt lds
v_mfma_f32_16x16x32_bf16 v[64:67], a[184:187], v[116:119], v[64:67]
ds_read_b128 a[212:215], v193 offset:0
v_mfma_f32_16x16x32_bf16 v[72:75], a[184:187], v[132:135], v[72:75]
buffer_load_dwordx4 v223, s[12:15], s42 offen offset:1024 nt lds
v_mfma_f32_16x16x32_bf16 v[144:147], a[188:191], a[0:3], v[164:167]
ds_read_b128 a[216:219], v187 offset:4096
v_mfma_f32_16x16x32_bf16 v[64:67], a[192:195], v[120:123], v[64:67]
ds_read_b128 a[220:223], v188 offset:4096
v_mfma_f32_16x16x32_bf16 v[72:75], a[192:195], v[136:139], v[72:75]
buffer_load_dwordx4 v224, s[12:15], s42 offen offset:2048 nt lds
s_waitcnt lgkmcnt(3)
v_mfma_f32_16x16x32_bf16 v[144:147], a[196:199], a[4:7], v[144:147]
ds_read_b128 a[224:227], v189 offset:4096
v_mfma_f32_16x16x32_bf16 v[64:67], a[200:203], v[124:127], v[64:67]
ds_read_b128 a[180:183], v186 offset:8192
v_mfma_f32_16x16x32_bf16 v[72:75], a[200:203], v[140:143], v[72:75]
buffer_load_dwordx4 v225, s[12:15], s42 offen offset:3072 nt lds
v_mfma_f32_16x16x32_bf16 v[144:147], a[204:207], a[8:11], v[144:147]
ds_read_b128 a[184:187], v187 offset:8192
v_mfma_f32_16x16x32_bf16 v[68:71], a[208:211], v[112:115], v[156:159]
ds_read_b128 a[188:191], v188 offset:8192
v_mfma_f32_16x16x32_bf16 v[76:79], a[208:211], v[128:131], v[160:163]
s_add_u32 m0, s39, 81920
s_waitcnt lgkmcnt(3)
v_mfma_f32_16x16x32_bf16 v[144:147], a[212:215], a[12:15], v[144:147]
ds_read_b128 a[192:195], v189 offset:8192
s_add_u32 s43, s43, 16384
v_mfma_f32_16x16x32_bf16 v[68:71], a[216:219], v[116:119], v[68:71]
ds_read_b128 a[196:199], v186 offset:12288
buffer_load_dwordx4 v226, s[16:19], s43 offen nt lds
v_mfma_f32_16x16x32_bf16 v[76:79], a[216:219], v[132:135], v[76:79]
buffer_load_dwordx4 v227, s[16:19], s43 offen offset:1024 nt lds
v_mfma_f32_16x16x32_bf16 v[68:71], a[220:223], v[120:123], v[68:71]
ds_read_b128 a[200:203], v187 offset:12288
v_mfma_f32_16x16x32_bf16 v[76:79], a[220:223], v[136:139], v[76:79]
v_mfma_f32_16x16x32_bf16 v[68:71], a[224:227], v[124:127], v[68:71]
ds_read_b128 a[204:207], v188 offset:12288
buffer_load_dwordx4 v226, s[16:19], s43 offen offset:2048 nt lds
v_mfma_f32_16x16x32_bf16 v[76:79], a[224:227], v[140:143], v[76:79]
v_exp_f32 v144, v144
s_waitcnt lgkmcnt(4)
v_mfma_f32_16x16x32_bf16 v[80:83], a[180:183], v[112:115], v[156:159]
ds_read_b128 a[208:211], v189 offset:12288
v_add_f32 v177, v177, v144
v_exp_f32 v145, v145
v_exp_f32 v146, v146
v_cvt_pk_bf16_f32 v152, v144, v145
v_exp_f32 v147, v147
v_add_f32 v177, v177, v145
v_cvt_pk_bf16_f32 v153, v146, v147
v_mfma_f32_16x16x32_bf16 v[88:91], a[180:183], v[128:131], v[160:163]
buffer_load_dwordx4 v227, s[16:19], s43 offen offset:3072 nt lds
ds_write_b64 v202, v[152:153] offset:0
v_mfma_f32_16x16x32_bf16 v[80:83], a[184:187], v[116:119], v[80:83]
v_add_f32 v177, v177, v146
v_add_f32 v177, v177, v147
v_mfma_f32_16x16x32_bf16 v[88:91], a[184:187], v[132:135], v[88:91]
v_mfma_f32_16x16x32_bf16 v[80:83], a[188:191], v[120:123], v[80:83]
s_waitcnt vmcnt(8) lgkmcnt(0)
s_barrier
v_mfma_f32_16x16x32_bf16 v[88:91], a[188:191], v[136:139], v[88:91]
ds_read_b128 a[212:215], v186 offset:16384
s_waitcnt lgkmcnt(3)
v_mfma_f32_16x16x32_bf16 v[80:83], a[192:195], v[124:127], v[80:83]
ds_read_b128 a[216:219], v187 offset:16384
s_add_u32 m0, s39, 49152
v_mfma_f32_16x16x32_bf16 v[88:91], a[192:195], v[140:143], v[88:91]
ds_read_b128 a[220:223], v190 offset:16384
s_add_u32 s42, s42, 16384
v_mfma_f32_16x16x32_bf16 v[84:87], a[196:199], v[112:115], v[156:159]
ds_read_b64_tr_b16 a[224:225], v196 offset:0
buffer_load_dwordx4 v222, s[12:15], s42 offen nt lds
v_mfma_f32_16x16x32_bf16 v[92:95], a[196:199], v[128:131], v[160:163]
ds_read_b64_tr_b16 a[226:227], v196 offset:4096
v_exp_f32 v64, v64
v_mfma_f32_16x16x32_bf16 v[84:87], a[200:203], v[116:119], v[84:87]
ds_read_b128 a[180:183], v191 offset:16384
v_exp_f32 v65, v65
v_mfma_f32_16x16x32_bf16 v[92:95], a[200:203], v[132:135], v[92:95]
v_cvt_pk_bf16_f32 v96, v64, v65
s_waitcnt lgkmcnt(5)
v_mfma_f32_16x16x32_bf16 v[84:87], a[204:207], v[120:123], v[84:87]
ds_read_b128 a[184:187], v188 offset:16384
v_exp_f32 v66, v66
v_mfma_f32_16x16x32_bf16 v[92:95], a[204:207], v[136:139], v[92:95]
buffer_load_dwordx4 v223, s[12:15], s42 offen offset:1024 nt lds
v_mfma_f32_16x16x32_bf16 v[84:87], a[208:211], v[124:127], v[84:87]
ds_read_b128 a[188:191], v192 offset:16384
v_exp_f32 v67, v67
v_mfma_f32_16x16x32_bf16 v[92:95], a[208:211], v[140:143], v[92:95]
v_exp_f32 v68, v68
v_cvt_pk_bf16_f32 v97, v66, v67
v_exp_f32 v69, v69
v_exp_f32 v70, v70
v_cvt_pk_bf16_f32 v98, v68, v69
v_exp_f32 v71, v71
v_exp_f32 v72, v72
v_cvt_pk_bf16_f32 v99, v70, v71
v_exp_f32 v73, v73
v_exp_f32 v74, v74
v_cvt_pk_bf16_f32 v100, v72, v73
v_exp_f32 v75, v75
v_exp_f32 v76, v76
v_cvt_pk_bf16_f32 v101, v74, v75
v_exp_f32 v77, v77
v_exp_f32 v78, v78
v_cvt_pk_bf16_f32 v102, v76, v77
v_exp_f32 v79, v79
s_nop 0
v_cvt_pk_bf16_f32 v103, v78, v79
v_mfma_f32_16x16x32_bf16 v[64:67], a[212:215], v[112:115], v[156:159]
ds_read_b64_tr_b16 a[192:193], v197 offset:0
v_exp_f32 v80, v80
v_mfma_f32_16x16x32_bf16 v[72:75], a[212:215], v[128:131], v[160:163]
ds_read_b64_tr_b16 a[194:195], v197 offset:4096
s_waitcnt lgkmcnt(4)
v_mfma_f32_16x16x32_bf16 v[64:67], a[216:219], v[116:119], v[64:67]
ds_read_b128 a[196:199], v193 offset:16384
v_exp_f32 v81, v81
v_mfma_f32_16x16x32_bf16 v[72:75], a[216:219], v[132:135], v[72:75]
ds_read_b128 a[24:27], v203 offset:0
v_cvt_pk_bf16_f32 v104, v80, v81
v_mfma_f32_16x16x32_bf16 v[144:147], a[220:223], a[0:3], v[164:167]
ds_read_b128 a[200:203], v189 offset:16384
v_exp_f32 v82, v82
v_mfma_f32_16x16x32_bf16 v[16:19], a[224:227], v[96:99], 0
ds_read_b64_tr_b16 a[204:205], v198 offset:0
v_exp_f32 v83, v83
v_mfma_f32_16x16x32_bf16 v[20:23], a[224:227], v[100:103], 0
ds_read_b64_tr_b16 a[206:207], v198 offset:4096
buffer_load_dwordx4 v224, s[12:15], s42 offen offset:2048 nt lds
v_mfma_f32_16x16x32_bf16 v[144:147], a[180:183], a[4:7], v[144:147]
ds_read_b128 a[208:211], v186 offset:20480
s_waitcnt lgkmcnt(5)
v_mfma_f32_16x16x32_bf16 v[64:67], a[184:187], v[120:123], v[64:67]
ds_read_b64_tr_b16 a[212:213], v199 offset:0
v_cvt_pk_bf16_f32 v105, v82, v83
v_mfma_f32_16x16x32_bf16 v[72:75], a[184:187], v[136:139], v[72:75]
ds_read_b64_tr_b16 a[214:215], v199 offset:4096
v_exp_f32 v84, v84
v_mfma_f32_16x16x32_bf16 v[144:147], a[188:191], a[8:11], v[144:147]
ds_read_b128 a[216:219], v187 offset:20480
v_exp_f32 v85, v85
v_mfma_f32_16x16x32_bf16 v[24:27], a[192:195], v[96:99], 0
ds_read_b64_tr_b16 a[220:221], v200 offset:0
v_cvt_pk_bf16_f32 v106, v84, v85
v_mfma_f32_16x16x32_bf16 v[28:31], a[192:195], v[100:103], 0
ds_read_b64_tr_b16 a[222:223], v200 offset:4096
v_exp_f32 v86, v86
v_mfma_f32_16x16x32_bf16 v[144:147], a[196:199], a[12:15], v[144:147]
ds_read_b128 a[224:227], v188 offset:20480
s_waitcnt lgkmcnt(6)
v_mfma_f32_16x16x32_bf16 v[64:67], a[200:203], v[124:127], v[64:67]
ds_read_b64_tr_b16 a[180:181], v201 offset:0
v_exp_f32 v87, v87
v_mfma_f32_16x16x32_bf16 v[72:75], a[200:203], v[140:143], v[72:75]
ds_read_b64_tr_b16 a[182:183], v201 offset:4096
buffer_load_dwordx4 v225, s[12:15], s42 offen offset:3072 nt lds
v_mfma_f32_16x16x32_bf16 v[32:35], a[204:207], v[96:99], 0
ds_read_b128 a[28:31], v203 offset:1024
v_cvt_pk_bf16_f32 v107, v86, v87
v_mfma_f32_16x16x32_bf16 v[36:39], a[204:207], v[100:103], 0
ds_read_b128 a[184:187], v189 offset:20480
v_exp_f32 v88, v88
v_mfma_f32_16x16x32_bf16 v[68:71], a[208:211], v[112:115], v[156:159]
ds_read_b64_tr_b16 a[188:189], v194 offset:0
v_exp_f32 v89, v89
v_mfma_f32_16x16x32_bf16 v[76:79], a[208:211], v[128:131], v[160:163]
ds_read_b64_tr_b16 a[190:191], v194 offset:4096
s_waitcnt lgkmcnt(7)
v_mfma_f32_16x16x32_bf16 v[40:43], a[212:215], v[96:99], 0
ds_read_b64_tr_b16 a[192:193], v195 offset:0
v_cvt_pk_bf16_f32 v108, v88, v89
v_mfma_f32_16x16x32_bf16 v[44:47], a[212:215], v[100:103], 0
ds_read_b64_tr_b16 a[194:195], v195 offset:4096
v_exp_f32 v90, v90
v_mfma_f32_16x16x32_bf16 v[68:71], a[216:219], v[116:119], v[68:71]
ds_read_b128 a[196:199], v186 offset:24576
v_exp_f32 v91, v91
v_mfma_f32_16x16x32_bf16 v[76:79], a[216:219], v[132:135], v[76:79]
v_exp_f32 v92, v92
v_mfma_f32_16x16x32_bf16 v[48:51], a[220:223], v[96:99], 0
ds_read_b128 a[200:203], v187 offset:24576
s_add_u32 m0, s39, 98304
v_mfma_f32_16x16x32_bf16 v[52:55], a[220:223], v[100:103], 0
s_add_u32 s43, s43, 16384
s_waitcnt lgkmcnt(6)
v_mfma_f32_16x16x32_bf16 v[68:71], a[224:227], v[120:123], v[68:71]
ds_read_b64_tr_b16 a[204:205], v196 offset:8192
buffer_load_dwordx4 v226, s[16:19], s43 offen nt lds
v_mfma_f32_16x16x32_bf16 v[76:79], a[224:227], v[136:139], v[76:79]
ds_read_b64_tr_b16 a[206:207], v196 offset:12288
v_cvt_pk_bf16_f32 v109, v90, v91
v_mfma_f32_16x16x32_bf16 v[56:59], a[180:183], v[96:99], 0
ds_read_b128 a[208:211], v188 offset:24576
v_exp_f32 v93, v93
v_mfma_f32_16x16x32_bf16 v[60:63], a[180:183], v[100:103], 0
v_exp_f32 v94, v94
v_mfma_f32_16x16x32_bf16 a[232:235], a[228:231], v[96:99], 0
v_cvt_pk_bf16_f32 v110, v92, v93
v_exp_f32 v95, v95
v_mfma_f32_16x16x32_bf16 v[68:71], a[184:187], v[124:127], v[68:71]
ds_read_b64_tr_b16 a[212:213], v197 offset:8192
v_cvt_pk_bf16_f32 v111, v94, v95
v_mfma_f32_16x16x32_bf16 v[76:79], a[184:187], v[140:143], v[76:79]
ds_read_b64_tr_b16 a[214:215], v197 offset:12288
s_waitcnt lgkmcnt(7)
v_mfma_f32_16x16x32_bf16 v[0:3], a[188:191], v[96:99], 0
ds_read_b128 a[216:219], v189 offset:24576
buffer_load_dwordx4 v227, s[16:19], s43 offen offset:1024 nt lds
v_mfma_f32_16x16x32_bf16 v[4:7], a[188:191], v[100:103], 0
v_exp_f32 v144, v144
v_mfma_f32_16x16x32_bf16 a[16:19], a[188:191], a[24:27], 0
v_exp_f32 v145, v145
v_mfma_f32_16x16x32_bf16 a[236:239], a[228:231], v[100:103], 0
v_exp_f32 v146, v146
v_mfma_f32_16x16x32_bf16 v[8:11], a[192:195], v[96:99], 0
ds_read_b64_tr_b16 a[220:221], v198 offset:8192
v_cvt_pk_bf16_f32 v152, v144, v145
v_mfma_f32_16x16x32_bf16 v[12:15], a[192:195], v[100:103], 0
ds_read_b64_tr_b16 a[222:223], v198 offset:12288
v_add_f32 v177, v177, v144
v_mfma_f32_16x16x32_bf16 a[20:23], a[192:195], a[24:27], 0
v_add_f32 v177, v177, v145
s_waitcnt lgkmcnt(6)
v_mfma_f32_16x16x32_bf16 v[80:83], a[196:199], v[112:115], v[156:159]
ds_read_b128 a[224:227], v186 offset:28672
v_add_f32 v177, v177, v146
v_mfma_f32_16x16x32_bf16 v[88:91], a[196:199], v[128:131], v[160:163]
v_exp_f32 v147, v147
v_mfma_f32_16x16x32_bf16 v[80:83], a[200:203], v[116:119], v[80:83]
ds_read_b64_tr_b16 a[180:181], v199 offset:8192
buffer_load_dwordx4 v226, s[16:19], s43 offen offset:2048 nt lds
v_mfma_f32_16x16x32_bf16 v[88:91], a[200:203], v[132:135], v[88:91]
ds_read_b64_tr_b16 a[182:183], v199 offset:12288
v_cvt_pk_bf16_f32 v153, v146, v147
v_mfma_f32_16x16x32_bf16 v[16:19], a[204:207], v[104:107], v[16:19]
ds_read_b128 a[184:187], v187 offset:28672
ds_write_b64 v202, v[152:153] offset:2048
v_mfma_f32_16x16x32_bf16 v[20:23], a[204:207], v[108:111], v[20:23]
v_add_f32 v177, v177, v147
s_waitcnt lgkmcnt(6)
v_mfma_f32_16x16x32_bf16 v[80:83], a[208:211], v[120:123], v[80:83]
ds_read_b64_tr_b16 a[188:189], v200 offset:8192
v_exp_f32 v64, v64
v_mfma_f32_16x16x32_bf16 v[88:91], a[208:211], v[136:139], v[88:91]
ds_read_b64_tr_b16 a[190:191], v200 offset:12288
v_exp_f32 v65, v65
v_mfma_f32_16x16x32_bf16 v[24:27], a[212:215], v[104:107], v[24:27]
ds_read_b128 a[192:195], v188 offset:28672
v_cvt_pk_bf16_f32 v96, v64, v65
v_mfma_f32_16x16x32_bf16 v[28:31], a[212:215], v[108:111], v[28:31]
v_exp_f32 v66, v66
v_mfma_f32_16x16x32_bf16 v[80:83], a[216:219], v[124:127], v[80:83]
ds_read_b64_tr_b16 a[196:197], v201 offset:8192
v_exp_f32 v67, v67
v_mfma_f32_16x16x32_bf16 v[88:91], a[216:219], v[140:143], v[88:91]
ds_read_b64_tr_b16 a[198:199], v201 offset:12288
s_waitcnt lgkmcnt(6)
v_mfma_f32_16x16x32_bf16 v[32:35], a[220:223], v[104:107], v[32:35]
ds_read_b128 a[200:203], v189 offset:28672
buffer_load_dwordx4 v227, s[16:19], s43 offen offset:3072 nt lds
v_mfma_f32_16x16x32_bf16 v[36:39], a[220:223], v[108:111], v[36:39]
v_exp_f32 v68, v68
v_mfma_f32_16x16x32_bf16 v[84:87], a[224:227], v[112:115], v[156:159]
ds_read_b64_tr_b16 a[204:205], v194 offset:8192
v_cvt_pk_bf16_f32 v97, v66, v67
v_mfma_f32_16x16x32_bf16 v[92:95], a[224:227], v[128:131], v[160:163]
ds_read_b64_tr_b16 a[206:207], v194 offset:12288
v_exp_f32 v69, v69
v_mfma_f32_16x16x32_bf16 v[40:43], a[180:183], v[104:107], v[40:43]
ds_read_b64_tr_b16 a[208:209], v195 offset:8192
v_cvt_pk_bf16_f32 v98, v68, v69
v_mfma_f32_16x16x32_bf16 v[44:47], a[180:183], v[108:111], v[44:47]
ds_read_b64_tr_b16 a[210:211], v195 offset:12288
s_waitcnt lgkmcnt(8)
v_mfma_f32_16x16x32_bf16 v[84:87], a[184:187], v[116:119], v[84:87]
v_exp_f32 v70, v70
v_mfma_f32_16x16x32_bf16 v[92:95], a[184:187], v[132:135], v[92:95]
v_exp_f32 v71, v71
v_mfma_f32_16x16x32_bf16 v[48:51], a[188:191], v[104:107], v[48:51]
s_waitcnt vmcnt(8)
s_barrier
v_mfma_f32_16x16x32_bf16 v[52:55], a[188:191], v[108:111], v[52:55]
ds_read_b128 a[212:215], v186 offset:32768
s_waitcnt lgkmcnt(5)
v_mfma_f32_16x16x32_bf16 v[84:87], a[192:195], v[120:123], v[84:87]
ds_read_b128 a[216:219], v187 offset:32768
s_add_u32 m0, s39, 0
v_mfma_f32_16x16x32_bf16 v[92:95], a[192:195], v[136:139], v[92:95]
ds_read_b128 a[220:223], v190 offset:32768
s_add_u32 s42, s42, 16384
v_mfma_f32_16x16x32_bf16 v[56:59], a[196:199], v[104:107], v[56:59]
ds_read_b64_tr_b16 a[224:225], v196 offset:16384
buffer_load_dwordx4 v222, s[12:15], s42 offen nt lds
v_mfma_f32_16x16x32_bf16 v[60:63], a[196:199], v[108:111], v[60:63]
ds_read_b64_tr_b16 a[226:227], v196 offset:20480
v_cvt_pk_bf16_f32 v99, v70, v71
v_mfma_f32_16x16x32_bf16 a[232:235], a[228:231], v[104:107], a[232:235]
v_exp_f32 v72, v72
v_mfma_f32_16x16x32_bf16 v[84:87], a[200:203], v[124:127], v[84:87]
ds_read_b128 a[180:183], v191 offset:32768
v_exp_f32 v73, v73
v_mfma_f32_16x16x32_bf16 v[92:95], a[200:203], v[140:143], v[92:95]
v_cvt_pk_bf16_f32 v100, v72, v73
s_waitcnt lgkmcnt(6)
v_mfma_f32_16x16x32_bf16 v[0:3], a[204:207], v[104:107], v[0:3]
ds_read_b128 a[184:187], v188 offset:32768
v_exp_f32 v74, v74
v_mfma_f32_16x16x32_bf16 v[4:7], a[204:207], v[108:111], v[4:7]
buffer_load_dwordx4 v223, s[12:15], s42 offen offset:1024 nt lds
v_mfma_f32_16x16x32_bf16 a[16:19], a[204:207], a[28:31], a[16:19]
v_exp_f32 v75, v75
v_mfma_f32_16x16x32_bf16 a[236:239], a[228:231], v[108:111], a[236:239]
v_exp_f32 v76, v76
v_mfma_f32_16x16x32_bf16 v[8:11], a[208:211], v[104:107], v[8:11]
ds_read_b128 a[188:191], v192 offset:32768
v_cvt_pk_bf16_f32 v101, v74, v75
v_mfma_f32_16x16x32_bf16 v[12:15], a[208:211], v[108:111], v[12:15]
v_exp_f32 v77, v77
v_mfma_f32_16x16x32_bf16 a[20:23], a[208:211], a[28:31], a[20:23]
v_cvt_pk_bf16_f32 v102, v76, v77
v_exp_f32 v78, v78
v_exp_f32 v79, v79
s_nop 0
v_cvt_pk_bf16_f32 v103, v78, v79
s_waitcnt lgkmcnt(3)
v_mfma_f32_16x16x32_bf16 v[64:67], a[212:215], v[112:115], v[156:159]
ds_read_b64_tr_b16 a[192:193], v197 offset:16384
v_exp_f32 v80, v80
v_mfma_f32_16x16x32_bf16 v[72:75], a[212:215], v[128:131], v[160:163]
ds_read_b64_tr_b16 a[194:195], v197 offset:20480
v_exp_f32 v81, v81
v_mfma_f32_16x16x32_bf16 v[64:67], a[216:219], v[116:119], v[64:67]
ds_read_b128 a[196:199], v193 offset:32768
v_cvt_pk_bf16_f32 v104, v80, v81
v_mfma_f32_16x16x32_bf16 v[72:75], a[216:219], v[132:135], v[72:75]
ds_read_b128 a[24:27], v203 offset:2048
buffer_load_dwordx4 v224, s[12:15], s42 offen offset:2048 nt lds
v_mfma_f32_16x16x32_bf16 v[144:147], a[220:223], a[0:3], v[164:167]
ds_read_b128 a[200:203], v189 offset:32768
v_exp_f32 v82, v82
v_mfma_f32_16x16x32_bf16 v[16:19], a[224:227], v[96:99], v[16:19]
ds_read_b64_tr_b16 a[204:205], v198 offset:16384
v_exp_f32 v83, v83
v_mfma_f32_16x16x32_bf16 v[20:23], a[224:227], v[100:103], v[20:23]
ds_read_b64_tr_b16 a[206:207], v198 offset:20480
s_waitcnt lgkmcnt(5)
v_mfma_f32_16x16x32_bf16 v[144:147], a[180:183], a[4:7], v[144:147]
ds_read_b128 a[208:211], v186 offset:36864
v_cvt_pk_bf16_f32 v105, v82, v83
v_mfma_f32_16x16x32_bf16 v[64:67], a[184:187], v[120:123], v[64:67]
ds_read_b64_tr_b16 a[212:213], v199 offset:16384
v_exp_f32 v84, v84
v_mfma_f32_16x16x32_bf16 v[72:75], a[184:187], v[136:139], v[72:75]
ds_read_b64_tr_b16 a[214:215], v199 offset:20480
v_exp_f32 v85, v85
v_mfma_f32_16x16x32_bf16 v[144:147], a[188:191], a[8:11], v[144:147]
ds_read_b128 a[216:219], v187 offset:36864
v_cvt_pk_bf16_f32 v106, v84, v85
v_mfma_f32_16x16x32_bf16 v[24:27], a[192:195], v[96:99], v[24:27]
ds_read_b64_tr_b16 a[220:221], v200 offset:16384
v_exp_f32 v86, v86
v_mfma_f32_16x16x32_bf16 v[28:31], a[192:195], v[100:103], v[28:31]
ds_read_b64_tr_b16 a[222:223], v200 offset:20480
s_waitcnt lgkmcnt(5)
v_mfma_f32_16x16x32_bf16 v[144:147], a[196:199], a[12:15], v[144:147]
ds_read_b128 a[224:227], v188 offset:36864
buffer_load_dwordx4 v225, s[12:15], s42 offen offset:3072 nt lds
v_mfma_f32_16x16x32_bf16 v[64:67], a[200:203], v[124:127], v[64:67]
ds_read_b64_tr_b16 a[180:181], v201 offset:16384
v_exp_f32 v87, v87
v_mfma_f32_16x16x32_bf16 v[72:75], a[200:203], v[140:143], v[72:75]
ds_read_b64_tr_b16 a[182:183], v201 offset:20480
v_cvt_pk_bf16_f32 v107, v86, v87
v_mfma_f32_16x16x32_bf16 v[32:35], a[204:207], v[96:99], v[32:35]
ds_read_b128 a[28:31], v203 offset:3072
v_exp_f32 v88, v88
v_mfma_f32_16x16x32_bf16 v[36:39], a[204:207], v[100:103], v[36:39]
ds_read_b128 a[184:187], v189 offset:36864
v_exp_f32 v89, v89
v_mfma_f32_16x16x32_bf16 v[68:71], a[208:211], v[112:115], v[156:159]
ds_read_b64_tr_b16 a[188:189], v194 offset:16384
v_cvt_pk_bf16_f32 v108, v88, v89
v_mfma_f32_16x16x32_bf16 v[76:79], a[208:211], v[128:131], v[160:163]
ds_read_b64_tr_b16 a[190:191], v194 offset:20480
s_waitcnt lgkmcnt(7)
v_mfma_f32_16x16x32_bf16 v[40:43], a[212:215], v[96:99], v[40:43]
ds_read_b64_tr_b16 a[192:193], v195 offset:16384
v_exp_f32 v90, v90
v_mfma_f32_16x16x32_bf16 v[44:47], a[212:215], v[100:103], v[44:47]
ds_read_b64_tr_b16 a[194:195], v195 offset:20480
v_exp_f32 v91, v91
v_mfma_f32_16x16x32_bf16 v[68:71], a[216:219], v[116:119], v[68:71]
ds_read_b128 a[196:199], v186 offset:40960
s_add_u32 m0, s39, 114688
v_mfma_f32_16x16x32_bf16 v[76:79], a[216:219], v[132:135], v[76:79]
s_add_u32 s43, s43, 16384
buffer_load_dwordx4 v226, s[16:19], s43 offen nt lds
v_mfma_f32_16x16x32_bf16 v[48:51], a[220:223], v[96:99], v[48:51]
ds_read_b128 a[200:203], v187 offset:40960
v_cvt_pk_bf16_f32 v109, v90, v91
v_mfma_f32_16x16x32_bf16 v[52:55], a[220:223], v[100:103], v[52:55]
v_exp_f32 v92, v92
s_waitcnt lgkmcnt(6)
v_mfma_f32_16x16x32_bf16 v[68:71], a[224:227], v[120:123], v[68:71]
ds_read_b64_tr_b16 a[204:205], v196 offset:24576
v_exp_f32 v93, v93
v_mfma_f32_16x16x32_bf16 v[76:79], a[224:227], v[136:139], v[76:79]
ds_read_b64_tr_b16 a[206:207], v196 offset:28672
v_cvt_pk_bf16_f32 v110, v92, v93
v_mfma_f32_16x16x32_bf16 v[56:59], a[180:183], v[96:99], v[56:59]
ds_read_b128 a[208:211], v188 offset:40960
v_exp_f32 v94, v94
v_mfma_f32_16x16x32_bf16 v[60:63], a[180:183], v[100:103], v[60:63]
v_exp_f32 v95, v95
v_mfma_f32_16x16x32_bf16 a[232:235], a[228:231], v[96:99], a[232:235]
v_cvt_pk_bf16_f32 v111, v94, v95
v_exp_f32 v144, v144
v_mfma_f32_16x16x32_bf16 v[68:71], a[184:187], v[124:127], v[68:71]
ds_read_b64_tr_b16 a[212:213], v197 offset:24576
buffer_load_dwordx4 v227, s[16:19], s43 offen offset:1024 nt lds
v_mfma_f32_16x16x32_bf16 v[76:79], a[184:187], v[140:143], v[76:79]
ds_read_b64_tr_b16 a[214:215], v197 offset:28672
s_waitcnt lgkmcnt(7)
v_mfma_f32_16x16x32_bf16 v[0:3], a[188:191], v[96:99], v[0:3]
ds_read_b128 a[216:219], v189 offset:40960
v_add_f32 v177, v177, v144
v_mfma_f32_16x16x32_bf16 v[4:7], a[188:191], v[100:103], v[4:7]
v_exp_f32 v145, v145
v_mfma_f32_16x16x32_bf16 a[16:19], a[188:191], a[24:27], a[16:19]
v_exp_f32 v146, v146
v_mfma_f32_16x16x32_bf16 a[236:239], a[228:231], v[100:103], a[236:239]
v_cvt_pk_bf16_f32 v152, v144, v145
v_add_f32 v177, v177, v145
v_mfma_f32_16x16x32_bf16 v[8:11], a[192:195], v[96:99], v[8:11]
ds_read_b64_tr_b16 a[220:221], v198 offset:24576
v_add_f32 v177, v177, v146
v_mfma_f32_16x16x32_bf16 v[12:15], a[192:195], v[100:103], v[12:15]
ds_read_b64_tr_b16 a[222:223], v198 offset:28672
v_exp_f32 v147, v147
v_mfma_f32_16x16x32_bf16 a[20:23], a[192:195], a[24:27], a[20:23]
v_cvt_pk_bf16_f32 v153, v146, v147
s_waitcnt lgkmcnt(6)
v_mfma_f32_16x16x32_bf16 v[80:83], a[196:199], v[112:115], v[156:159]
ds_read_b128 a[224:227], v186 offset:45056
ds_write_b64 v202, v[152:153] offset:0
v_mfma_f32_16x16x32_bf16 v[88:91], a[196:199], v[128:131], v[160:163]
buffer_load_dwordx4 v226, s[16:19], s43 offen offset:2048 nt lds
v_mfma_f32_16x16x32_bf16 v[80:83], a[200:203], v[116:119], v[80:83]
ds_read_b64_tr_b16 a[180:181], v199 offset:24576
v_add_f32 v177, v177, v147
v_mfma_f32_16x16x32_bf16 v[88:91], a[200:203], v[132:135], v[88:91]
ds_read_b64_tr_b16 a[182:183], v199 offset:28672
v_exp_f32 v64, v64
v_mfma_f32_16x16x32_bf16 v[16:19], a[204:207], v[104:107], v[16:19]
ds_read_b128 a[184:187], v187 offset:45056
v_exp_f32 v65, v65
v_mfma_f32_16x16x32_bf16 v[20:23], a[204:207], v[108:111], v[20:23]
v_cvt_pk_bf16_f32 v96, v64, v65
s_waitcnt lgkmcnt(6)
v_mfma_f32_16x16x32_bf16 v[80:83], a[208:211], v[120:123], v[80:83]
ds_read_b64_tr_b16 a[188:189], v200 offset:24576
v_exp_f32 v66, v66
v_mfma_f32_16x16x32_bf16 v[88:91], a[208:211], v[136:139], v[88:91]
ds_read_b64_tr_b16 a[190:191], v200 offset:28672
v_exp_f32 v67, v67
v_mfma_f32_16x16x32_bf16 v[24:27], a[212:215], v[104:107], v[24:27]
ds_read_b128 a[192:195], v188 offset:45056
v_cvt_pk_bf16_f32 v97, v66, v67
v_mfma_f32_16x16x32_bf16 v[28:31], a[212:215], v[108:111], v[28:31]
v_exp_f32 v68, v68
v_mfma_f32_16x16x32_bf16 v[80:83], a[216:219], v[124:127], v[80:83]
ds_read_b64_tr_b16 a[196:197], v201 offset:24576
buffer_load_dwordx4 v227, s[16:19], s43 offen offset:3072 nt lds
v_mfma_f32_16x16x32_bf16 v[88:91], a[216:219], v[140:143], v[88:91]
ds_read_b64_tr_b16 a[198:199], v201 offset:28672
s_waitcnt lgkmcnt(6)
v_mfma_f32_16x16x32_bf16 v[32:35], a[220:223], v[104:107], v[32:35]
ds_read_b128 a[200:203], v189 offset:45056
v_exp_f32 v69, v69
v_mfma_f32_16x16x32_bf16 v[36:39], a[220:223], v[108:111], v[36:39]
v_exp_f32 v70, v70
v_mfma_f32_16x16x32_bf16 v[84:87], a[224:227], v[112:115], v[156:159]
ds_read_b64_tr_b16 a[204:205], v194 offset:24576
v_cvt_pk_bf16_f32 v98, v68, v69
v_mfma_f32_16x16x32_bf16 v[92:95], a[224:227], v[128:131], v[160:163]
ds_read_b64_tr_b16 a[206:207], v194 offset:28672
v_exp_f32 v71, v71
v_mfma_f32_16x16x32_bf16 v[40:43], a[180:183], v[104:107], v[40:43]
ds_read_b64_tr_b16 a[208:209], v195 offset:24576
v_cvt_pk_bf16_f32 v99, v70, v71
v_mfma_f32_16x16x32_bf16 v[44:47], a[180:183], v[108:111], v[44:47]
ds_read_b64_tr_b16 a[210:211], v195 offset:28672
s_waitcnt lgkmcnt(8)
v_mfma_f32_16x16x32_bf16 v[84:87], a[184:187], v[116:119], v[84:87]
v_exp_f32 v72, v72
v_mfma_f32_16x16x32_bf16 v[92:95], a[184:187], v[132:135], v[92:95]
v_exp_f32 v73, v73
v_mfma_f32_16x16x32_bf16 v[48:51], a[188:191], v[104:107], v[48:51]
s_waitcnt vmcnt(8)
s_barrier
v_mfma_f32_16x16x32_bf16 v[52:55], a[188:191], v[108:111], v[52:55]
ds_read_b128 a[212:215], v186 offset:49152
s_waitcnt lgkmcnt(5)
v_mfma_f32_16x16x32_bf16 v[84:87], a[192:195], v[120:123], v[84:87]
ds_read_b128 a[216:219], v187 offset:49152
s_add_u32 m0, s39, 16384
v_mfma_f32_16x16x32_bf16 v[92:95], a[192:195], v[136:139], v[92:95]
ds_read_b128 a[220:223], v190 offset:49152
s_add_u32 s42, s42, 16384
v_mfma_f32_16x16x32_bf16 v[56:59], a[196:199], v[104:107], v[56:59]
ds_read_b64_tr_b16 a[224:225], v196 offset:32768
buffer_load_dwordx4 v222, s[12:15], s42 offen nt lds
v_mfma_f32_16x16x32_bf16 v[60:63], a[196:199], v[108:111], v[60:63]
ds_read_b64_tr_b16 a[226:227], v196 offset:36864
v_cvt_pk_bf16_f32 v100, v72, v73
v_mfma_f32_16x16x32_bf16 a[232:235], a[228:231], v[104:107], a[232:235]
v_exp_f32 v74, v74
v_mfma_f32_16x16x32_bf16 v[84:87], a[200:203], v[124:127], v[84:87]
ds_read_b128 a[180:183], v191 offset:49152
v_exp_f32 v75, v75
v_mfma_f32_16x16x32_bf16 v[92:95], a[200:203], v[140:143], v[92:95]
v_cvt_pk_bf16_f32 v101, v74, v75
s_waitcnt lgkmcnt(6)
v_mfma_f32_16x16x32_bf16 v[0:3], a[204:207], v[104:107], v[0:3]
ds_read_b128 a[184:187], v188 offset:49152
v_exp_f32 v76, v76
v_mfma_f32_16x16x32_bf16 v[4:7], a[204:207], v[108:111], v[4:7]
buffer_load_dwordx4 v223, s[12:15], s42 offen offset:1024 nt lds
v_mfma_f32_16x16x32_bf16 a[16:19], a[204:207], a[28:31], a[16:19]
v_exp_f32 v77, v77
v_mfma_f32_16x16x32_bf16 a[236:239], a[228:231], v[108:111], a[236:239]
v_exp_f32 v78, v78
v_mfma_f32_16x16x32_bf16 v[8:11], a[208:211], v[104:107], v[8:11]
ds_read_b128 a[188:191], v192 offset:49152
v_cvt_pk_bf16_f32 v102, v76, v77
v_mfma_f32_16x16x32_bf16 v[12:15], a[208:211], v[108:111], v[12:15]
v_exp_f32 v79, v79
v_mfma_f32_16x16x32_bf16 a[20:23], a[208:211], a[28:31], a[20:23]
v_cvt_pk_bf16_f32 v103, v78, v79
s_waitcnt lgkmcnt(3)
v_mfma_f32_16x16x32_bf16 v[64:67], a[212:215], v[112:115], v[156:159]
ds_read_b64_tr_b16 a[192:193], v197 offset:32768
v_exp_f32 v80, v80
v_mfma_f32_16x16x32_bf16 v[72:75], a[212:215], v[128:131], v[160:163]
ds_read_b64_tr_b16 a[194:195], v197 offset:36864
v_exp_f32 v81, v81
v_mfma_f32_16x16x32_bf16 v[64:67], a[216:219], v[116:119], v[64:67]
ds_read_b128 a[196:199], v193 offset:49152
v_cvt_pk_bf16_f32 v104, v80, v81
v_mfma_f32_16x16x32_bf16 v[72:75], a[216:219], v[132:135], v[72:75]
ds_read_b128 a[24:27], v203 offset:0
buffer_load_dwordx4 v224, s[12:15], s42 offen offset:2048 nt lds
v_mfma_f32_16x16x32_bf16 v[144:147], a[220:223], a[0:3], v[164:167]
ds_read_b128 a[200:203], v189 offset:49152
v_exp_f32 v82, v82
v_mfma_f32_16x16x32_bf16 v[16:19], a[224:227], v[96:99], v[16:19]
ds_read_b64_tr_b16 a[204:205], v198 offset:32768
v_exp_f32 v83, v83
v_mfma_f32_16x16x32_bf16 v[20:23], a[224:227], v[100:103], v[20:23]
ds_read_b64_tr_b16 a[206:207], v198 offset:36864
s_waitcnt lgkmcnt(5)
v_mfma_f32_16x16x32_bf16 v[144:147], a[180:183], a[4:7], v[144:147]
ds_read_b128 a[208:211], v186 offset:53248
v_cvt_pk_bf16_f32 v105, v82, v83
v_mfma_f32_16x16x32_bf16 v[64:67], a[184:187], v[120:123], v[64:67]
ds_read_b64_tr_b16 a[212:213], v199 offset:32768
v_exp_f32 v84, v84
v_mfma_f32_16x16x32_bf16 v[72:75], a[184:187], v[136:139], v[72:75]
ds_read_b64_tr_b16 a[214:215], v199 offset:36864
v_exp_f32 v85, v85
v_mfma_f32_16x16x32_bf16 v[144:147], a[188:191], a[8:11], v[144:147]
ds_read_b128 a[216:219], v187 offset:53248
v_cvt_pk_bf16_f32 v106, v84, v85
v_mfma_f32_16x16x32_bf16 v[24:27], a[192:195], v[96:99], v[24:27]
ds_read_b64_tr_b16 a[220:221], v200 offset:32768
v_exp_f32 v86, v86
v_mfma_f32_16x16x32_bf16 v[28:31], a[192:195], v[100:103], v[28:31]
ds_read_b64_tr_b16 a[222:223], v200 offset:36864
s_waitcnt lgkmcnt(5)
v_mfma_f32_16x16x32_bf16 v[144:147], a[196:199], a[12:15], v[144:147]
ds_read_b128 a[224:227], v188 offset:53248
buffer_load_dwordx4 v225, s[12:15], s42 offen offset:3072 nt lds
v_mfma_f32_16x16x32_bf16 v[64:67], a[200:203], v[124:127], v[64:67]
ds_read_b64_tr_b16 a[180:181], v201 offset:32768
v_exp_f32 v87, v87
v_mfma_f32_16x16x32_bf16 v[72:75], a[200:203], v[140:143], v[72:75]
ds_read_b64_tr_b16 a[182:183], v201 offset:36864
v_cvt_pk_bf16_f32 v107, v86, v87
v_mfma_f32_16x16x32_bf16 v[32:35], a[204:207], v[96:99], v[32:35]
ds_read_b128 a[28:31], v203 offset:1024
v_exp_f32 v88, v88
v_mfma_f32_16x16x32_bf16 v[36:39], a[204:207], v[100:103], v[36:39]
ds_read_b128 a[184:187], v189 offset:53248
v_exp_f32 v89, v89
v_mfma_f32_16x16x32_bf16 v[68:71], a[208:211], v[112:115], v[156:159]
ds_read_b64_tr_b16 a[188:189], v194 offset:32768
v_cvt_pk_bf16_f32 v108, v88, v89
v_mfma_f32_16x16x32_bf16 v[76:79], a[208:211], v[128:131], v[160:163]
ds_read_b64_tr_b16 a[190:191], v194 offset:36864
s_waitcnt lgkmcnt(7)
v_mfma_f32_16x16x32_bf16 v[40:43], a[212:215], v[96:99], v[40:43]
ds_read_b64_tr_b16 a[192:193], v195 offset:32768
v_exp_f32 v90, v90
v_mfma_f32_16x16x32_bf16 v[44:47], a[212:215], v[100:103], v[44:47]
ds_read_b64_tr_b16 a[194:195], v195 offset:36864
v_exp_f32 v91, v91
v_mfma_f32_16x16x32_bf16 v[68:71], a[216:219], v[116:119], v[68:71]
ds_read_b128 a[196:199], v186 offset:57344
s_add_u32 m0, s39, 65536
v_mfma_f32_16x16x32_bf16 v[76:79], a[216:219], v[132:135], v[76:79]
s_add_u32 s43, s43, 16384
buffer_load_dwordx4 v226, s[16:19], s43 offen nt lds
v_mfma_f32_16x16x32_bf16 v[48:51], a[220:223], v[96:99], v[48:51]
ds_read_b128 a[200:203], v187 offset:57344
v_cvt_pk_bf16_f32 v109, v90, v91
v_mfma_f32_16x16x32_bf16 v[52:55], a[220:223], v[100:103], v[52:55]
v_exp_f32 v92, v92
s_waitcnt lgkmcnt(6)
v_mfma_f32_16x16x32_bf16 v[68:71], a[224:227], v[120:123], v[68:71]
ds_read_b64_tr_b16 a[204:205], v196 offset:40960
v_exp_f32 v93, v93
v_mfma_f32_16x16x32_bf16 v[76:79], a[224:227], v[136:139], v[76:79]
ds_read_b64_tr_b16 a[206:207], v196 offset:45056
v_cvt_pk_bf16_f32 v110, v92, v93
v_mfma_f32_16x16x32_bf16 v[56:59], a[180:183], v[96:99], v[56:59]
ds_read_b128 a[208:211], v188 offset:57344
v_exp_f32 v94, v94
v_mfma_f32_16x16x32_bf16 v[60:63], a[180:183], v[100:103], v[60:63]
v_exp_f32 v95, v95
v_mfma_f32_16x16x32_bf16 a[232:235], a[228:231], v[96:99], a[232:235]
v_cvt_pk_bf16_f32 v111, v94, v95
v_exp_f32 v144, v144
v_mfma_f32_16x16x32_bf16 v[68:71], a[184:187], v[124:127], v[68:71]
ds_read_b64_tr_b16 a[212:213], v197 offset:40960
buffer_load_dwordx4 v227, s[16:19], s43 offen offset:1024 nt lds
v_mfma_f32_16x16x32_bf16 v[76:79], a[184:187], v[140:143], v[76:79]
ds_read_b64_tr_b16 a[214:215], v197 offset:45056
s_waitcnt lgkmcnt(7)
v_mfma_f32_16x16x32_bf16 v[0:3], a[188:191], v[96:99], v[0:3]
ds_read_b128 a[216:219], v189 offset:57344
v_add_f32 v177, v177, v144
v_mfma_f32_16x16x32_bf16 v[4:7], a[188:191], v[100:103], v[4:7]
v_exp_f32 v145, v145
v_mfma_f32_16x16x32_bf16 a[16:19], a[188:191], a[24:27], a[16:19]
v_exp_f32 v146, v146
v_mfma_f32_16x16x32_bf16 a[236:239], a[228:231], v[100:103], a[236:239]
v_cvt_pk_bf16_f32 v152, v144, v145
v_add_f32 v177, v177, v145
v_mfma_f32_16x16x32_bf16 v[8:11], a[192:195], v[96:99], v[8:11]
ds_read_b64_tr_b16 a[220:221], v198 offset:40960
v_add_f32 v177, v177, v146
v_mfma_f32_16x16x32_bf16 v[12:15], a[192:195], v[100:103], v[12:15]
ds_read_b64_tr_b16 a[222:223], v198 offset:45056
v_exp_f32 v147, v147
v_mfma_f32_16x16x32_bf16 a[20:23], a[192:195], a[24:27], a[20:23]
v_cvt_pk_bf16_f32 v153, v146, v147
s_waitcnt lgkmcnt(6)
v_mfma_f32_16x16x32_bf16 v[80:83], a[196:199], v[112:115], v[156:159]
ds_read_b128 a[224:227], v186 offset:61440
ds_write_b64 v202, v[152:153] offset:2048
v_mfma_f32_16x16x32_bf16 v[88:91], a[196:199], v[128:131], v[160:163]
buffer_load_dwordx4 v226, s[16:19], s43 offen offset:2048 nt lds
v_mfma_f32_16x16x32_bf16 v[80:83], a[200:203], v[116:119], v[80:83]
ds_read_b64_tr_b16 a[180:181], v199 offset:40960
v_add_f32 v177, v177, v147
v_mfma_f32_16x16x32_bf16 v[88:91], a[200:203], v[132:135], v[88:91]
ds_read_b64_tr_b16 a[182:183], v199 offset:45056
v_exp_f32 v64, v64
v_mfma_f32_16x16x32_bf16 v[16:19], a[204:207], v[104:107], v[16:19]
ds_read_b128 a[184:187], v187 offset:61440
v_exp_f32 v65, v65
v_mfma_f32_16x16x32_bf16 v[20:23], a[204:207], v[108:111], v[20:23]
v_cvt_pk_bf16_f32 v96, v64, v65
s_waitcnt lgkmcnt(6)
v_mfma_f32_16x16x32_bf16 v[80:83], a[208:211], v[120:123], v[80:83]
ds_read_b64_tr_b16 a[188:189], v200 offset:40960
v_exp_f32 v66, v66
v_mfma_f32_16x16x32_bf16 v[88:91], a[208:211], v[136:139], v[88:91]
ds_read_b64_tr_b16 a[190:191], v200 offset:45056
v_exp_f32 v67, v67
v_mfma_f32_16x16x32_bf16 v[24:27], a[212:215], v[104:107], v[24:27]
ds_read_b128 a[192:195], v188 offset:61440
v_cvt_pk_bf16_f32 v97, v66, v67
v_mfma_f32_16x16x32_bf16 v[28:31], a[212:215], v[108:111], v[28:31]
v_exp_f32 v68, v68
v_mfma_f32_16x16x32_bf16 v[80:83], a[216:219], v[124:127], v[80:83]
ds_read_b64_tr_b16 a[196:197], v201 offset:40960
buffer_load_dwordx4 v227, s[16:19], s43 offen offset:3072 nt lds
v_mfma_f32_16x16x32_bf16 v[88:91], a[216:219], v[140:143], v[88:91]
ds_read_b64_tr_b16 a[198:199], v201 offset:45056
s_waitcnt lgkmcnt(6)
v_mfma_f32_16x16x32_bf16 v[32:35], a[220:223], v[104:107], v[32:35]
ds_read_b128 a[200:203], v189 offset:61440
v_exp_f32 v69, v69
v_mfma_f32_16x16x32_bf16 v[36:39], a[220:223], v[108:111], v[36:39]
v_exp_f32 v70, v70
v_mfma_f32_16x16x32_bf16 v[84:87], a[224:227], v[112:115], v[156:159]
ds_read_b64_tr_b16 a[204:205], v194 offset:40960
v_cvt_pk_bf16_f32 v98, v68, v69
v_mfma_f32_16x16x32_bf16 v[92:95], a[224:227], v[128:131], v[160:163]
ds_read_b64_tr_b16 a[206:207], v194 offset:45056
v_exp_f32 v71, v71
v_mfma_f32_16x16x32_bf16 v[40:43], a[180:183], v[104:107], v[40:43]
ds_read_b64_tr_b16 a[208:209], v195 offset:40960
v_cvt_pk_bf16_f32 v99, v70, v71
v_mfma_f32_16x16x32_bf16 v[44:47], a[180:183], v[108:111], v[44:47]
ds_read_b64_tr_b16 a[210:211], v195 offset:45056
s_waitcnt lgkmcnt(8)
v_mfma_f32_16x16x32_bf16 v[84:87], a[184:187], v[116:119], v[84:87]
v_exp_f32 v72, v72
v_mfma_f32_16x16x32_bf16 v[92:95], a[184:187], v[132:135], v[92:95]
v_exp_f32 v73, v73
v_mfma_f32_16x16x32_bf16 v[48:51], a[188:191], v[104:107], v[48:51]
s_waitcnt vmcnt(8)
s_barrier
v_mfma_f32_16x16x32_bf16 v[52:55], a[188:191], v[108:111], v[52:55]
ds_read_b128 a[212:215], v186 offset:0
s_waitcnt lgkmcnt(5)
v_mfma_f32_16x16x32_bf16 v[84:87], a[192:195], v[120:123], v[84:87]
ds_read_b128 a[216:219], v187 offset:0
s_add_u32 m0, s39, 32768
v_mfma_f32_16x16x32_bf16 v[92:95], a[192:195], v[136:139], v[92:95]
ds_read_b128 a[220:223], v190 offset:0
s_add_u32 s42, s42, 16384
v_mfma_f32_16x16x32_bf16 v[56:59], a[196:199], v[104:107], v[56:59]
ds_read_b64_tr_b16 a[224:225], v196 offset:49152
buffer_load_dwordx4 v222, s[12:15], s42 offen nt lds
v_mfma_f32_16x16x32_bf16 v[60:63], a[196:199], v[108:111], v[60:63]
ds_read_b64_tr_b16 a[226:227], v196 offset:53248
v_cvt_pk_bf16_f32 v100, v72, v73
v_mfma_f32_16x16x32_bf16 a[232:235], a[228:231], v[104:107], a[232:235]
v_exp_f32 v74, v74
v_mfma_f32_16x16x32_bf16 v[84:87], a[200:203], v[124:127], v[84:87]
ds_read_b128 a[180:183], v191 offset:0
v_exp_f32 v75, v75
v_mfma_f32_16x16x32_bf16 v[92:95], a[200:203], v[140:143], v[92:95]
v_cvt_pk_bf16_f32 v101, v74, v75
s_waitcnt lgkmcnt(6)
v_mfma_f32_16x16x32_bf16 v[0:3], a[204:207], v[104:107], v[0:3]
ds_read_b128 a[184:187], v188 offset:0
v_exp_f32 v76, v76
v_mfma_f32_16x16x32_bf16 v[4:7], a[204:207], v[108:111], v[4:7]
buffer_load_dwordx4 v223, s[12:15], s42 offen offset:1024 nt lds
v_mfma_f32_16x16x32_bf16 a[16:19], a[204:207], a[28:31], a[16:19]
v_exp_f32 v77, v77
v_mfma_f32_16x16x32_bf16 a[236:239], a[228:231], v[108:111], a[236:239]
v_exp_f32 v78, v78
v_mfma_f32_16x16x32_bf16 v[8:11], a[208:211], v[104:107], v[8:11]
ds_read_b128 a[188:191], v192 offset:0
v_cvt_pk_bf16_f32 v102, v76, v77
v_mfma_f32_16x16x32_bf16 v[12:15], a[208:211], v[108:111], v[12:15]
v_exp_f32 v79, v79
v_mfma_f32_16x16x32_bf16 a[20:23], a[208:211], a[28:31], a[20:23]
v_cvt_pk_bf16_f32 v103, v78, v79
s_waitcnt lgkmcnt(3)
v_mfma_f32_16x16x32_bf16 v[64:67], a[212:215], v[112:115], v[156:159]
ds_read_b64_tr_b16 a[192:193], v197 offset:49152
v_exp_f32 v80, v80
v_mfma_f32_16x16x32_bf16 v[72:75], a[212:215], v[128:131], v[160:163]
ds_read_b64_tr_b16 a[194:195], v197 offset:53248
v_exp_f32 v81, v81
v_mfma_f32_16x16x32_bf16 v[64:67], a[216:219], v[116:119], v[64:67]
ds_read_b128 a[196:199], v193 offset:0
v_cvt_pk_bf16_f32 v104, v80, v81
v_mfma_f32_16x16x32_bf16 v[72:75], a[216:219], v[132:135], v[72:75]
ds_read_b128 a[24:27], v203 offset:2048
buffer_load_dwordx4 v224, s[12:15], s42 offen offset:2048 nt lds
v_mfma_f32_16x16x32_bf16 v[144:147], a[220:223], a[0:3], v[164:167]
ds_read_b128 a[200:203], v189 offset:0
v_exp_f32 v82, v82
v_mfma_f32_16x16x32_bf16 v[16:19], a[224:227], v[96:99], v[16:19]
ds_read_b64_tr_b16 a[204:205], v198 offset:49152
v_exp_f32 v83, v83
v_mfma_f32_16x16x32_bf16 v[20:23], a[224:227], v[100:103], v[20:23]
ds_read_b64_tr_b16 a[206:207], v198 offset:53248
s_waitcnt lgkmcnt(5)
v_mfma_f32_16x16x32_bf16 v[144:147], a[180:183], a[4:7], v[144:147]
ds_read_b128 a[208:211], v186 offset:4096
v_cvt_pk_bf16_f32 v105, v82, v83
v_mfma_f32_16x16x32_bf16 v[64:67], a[184:187], v[120:123], v[64:67]
ds_read_b64_tr_b16 a[212:213], v199 offset:49152
v_exp_f32 v84, v84
v_mfma_f32_16x16x32_bf16 v[72:75], a[184:187], v[136:139], v[72:75]
ds_read_b64_tr_b16 a[214:215], v199 offset:53248
v_exp_f32 v85, v85
v_mfma_f32_16x16x32_bf16 v[144:147], a[188:191], a[8:11], v[144:147]
ds_read_b128 a[216:219], v187 offset:4096
v_cvt_pk_bf16_f32 v106, v84, v85
v_mfma_f32_16x16x32_bf16 v[24:27], a[192:195], v[96:99], v[24:27]
ds_read_b64_tr_b16 a[220:221], v200 offset:49152
v_exp_f32 v86, v86
v_mfma_f32_16x16x32_bf16 v[28:31], a[192:195], v[100:103], v[28:31]
ds_read_b64_tr_b16 a[222:223], v200 offset:53248
s_waitcnt lgkmcnt(5)
v_mfma_f32_16x16x32_bf16 v[144:147], a[196:199], a[12:15], v[144:147]
ds_read_b128 a[224:227], v188 offset:4096
buffer_load_dwordx4 v225, s[12:15], s42 offen offset:3072 nt lds
v_mfma_f32_16x16x32_bf16 v[64:67], a[200:203], v[124:127], v[64:67]
ds_read_b64_tr_b16 a[180:181], v201 offset:49152
v_exp_f32 v87, v87
v_mfma_f32_16x16x32_bf16 v[72:75], a[200:203], v[140:143], v[72:75]
ds_read_b64_tr_b16 a[182:183], v201 offset:53248
v_cvt_pk_bf16_f32 v107, v86, v87
v_mfma_f32_16x16x32_bf16 v[32:35], a[204:207], v[96:99], v[32:35]
ds_read_b128 a[28:31], v203 offset:3072
v_exp_f32 v88, v88
v_mfma_f32_16x16x32_bf16 v[36:39], a[204:207], v[100:103], v[36:39]
ds_read_b128 a[184:187], v189 offset:4096
v_exp_f32 v89, v89
v_mfma_f32_16x16x32_bf16 v[68:71], a[208:211], v[112:115], v[156:159]
ds_read_b64_tr_b16 a[188:189], v194 offset:49152
v_cvt_pk_bf16_f32 v108, v88, v89
v_mfma_f32_16x16x32_bf16 v[76:79], a[208:211], v[128:131], v[160:163]
ds_read_b64_tr_b16 a[190:191], v194 offset:53248
s_waitcnt lgkmcnt(7)
v_mfma_f32_16x16x32_bf16 v[40:43], a[212:215], v[96:99], v[40:43]
ds_read_b64_tr_b16 a[192:193], v195 offset:49152
v_exp_f32 v90, v90
v_mfma_f32_16x16x32_bf16 v[44:47], a[212:215], v[100:103], v[44:47]
ds_read_b64_tr_b16 a[194:195], v195 offset:53248
v_exp_f32 v91, v91
v_mfma_f32_16x16x32_bf16 v[68:71], a[216:219], v[116:119], v[68:71]
ds_read_b128 a[196:199], v186 offset:8192
s_add_u32 m0, s39, 81920
v_mfma_f32_16x16x32_bf16 v[76:79], a[216:219], v[132:135], v[76:79]
s_add_u32 s43, s43, 16384
buffer_load_dwordx4 v226, s[16:19], s43 offen nt lds
v_mfma_f32_16x16x32_bf16 v[48:51], a[220:223], v[96:99], v[48:51]
ds_read_b128 a[200:203], v187 offset:8192
v_cvt_pk_bf16_f32 v109, v90, v91
v_mfma_f32_16x16x32_bf16 v[52:55], a[220:223], v[100:103], v[52:55]
v_exp_f32 v92, v92
s_waitcnt lgkmcnt(6)
v_mfma_f32_16x16x32_bf16 v[68:71], a[224:227], v[120:123], v[68:71]
ds_read_b64_tr_b16 a[204:205], v196 offset:57344
v_exp_f32 v93, v93
v_mfma_f32_16x16x32_bf16 v[76:79], a[224:227], v[136:139], v[76:79]
ds_read_b64_tr_b16 a[206:207], v196 offset:61440
v_cvt_pk_bf16_f32 v110, v92, v93
v_mfma_f32_16x16x32_bf16 v[56:59], a[180:183], v[96:99], v[56:59]
ds_read_b128 a[208:211], v188 offset:8192
v_exp_f32 v94, v94
v_mfma_f32_16x16x32_bf16 v[60:63], a[180:183], v[100:103], v[60:63]
v_exp_f32 v95, v95
v_mfma_f32_16x16x32_bf16 a[232:235], a[228:231], v[96:99], a[232:235]
v_cvt_pk_bf16_f32 v111, v94, v95
v_exp_f32 v144, v144
v_mfma_f32_16x16x32_bf16 v[68:71], a[184:187], v[124:127], v[68:71]
ds_read_b64_tr_b16 a[212:213], v197 offset:57344
buffer_load_dwordx4 v227, s[16:19], s43 offen offset:1024 nt lds
v_mfma_f32_16x16x32_bf16 v[76:79], a[184:187], v[140:143], v[76:79]
ds_read_b64_tr_b16 a[214:215], v197 offset:61440
s_waitcnt lgkmcnt(7)
v_mfma_f32_16x16x32_bf16 v[0:3], a[188:191], v[96:99], v[0:3]
ds_read_b128 a[216:219], v189 offset:8192
v_add_f32 v177, v177, v144
v_mfma_f32_16x16x32_bf16 v[4:7], a[188:191], v[100:103], v[4:7]
v_exp_f32 v145, v145
v_mfma_f32_16x16x32_bf16 a[16:19], a[188:191], a[24:27], a[16:19]
v_exp_f32 v146, v146
v_mfma_f32_16x16x32_bf16 a[236:239], a[228:231], v[100:103], a[236:239]
v_cvt_pk_bf16_f32 v152, v144, v145
v_add_f32 v177, v177, v145
v_mfma_f32_16x16x32_bf16 v[8:11], a[192:195], v[96:99], v[8:11]
ds_read_b64_tr_b16 a[220:221], v198 offset:57344
v_add_f32 v177, v177, v146
v_mfma_f32_16x16x32_bf16 v[12:15], a[192:195], v[100:103], v[12:15]
ds_read_b64_tr_b16 a[222:223], v198 offset:61440
v_exp_f32 v147, v147
v_mfma_f32_16x16x32_bf16 a[20:23], a[192:195], a[24:27], a[20:23]
v_cvt_pk_bf16_f32 v153, v146, v147
s_waitcnt lgkmcnt(6)
v_mfma_f32_16x16x32_bf16 v[80:83], a[196:199], v[112:115], v[156:159]
ds_read_b128 a[224:227], v186 offset:12288
ds_write_b64 v202, v[152:153] offset:0
v_mfma_f32_16x16x32_bf16 v[88:91], a[196:199], v[128:131], v[160:163]
buffer_load_dwordx4 v226, s[16:19], s43 offen offset:2048 nt lds
v_mfma_f32_16x16x32_bf16 v[80:83], a[200:203], v[116:119], v[80:83]
ds_read_b64_tr_b16 a[180:181], v199 offset:57344
v_add_f32 v177, v177, v147
v_mfma_f32_16x16x32_bf16 v[88:91], a[200:203], v[132:135], v[88:91]
ds_read_b64_tr_b16 a[182:183], v199 offset:61440
v_exp_f32 v64, v64
v_mfma_f32_16x16x32_bf16 v[16:19], a[204:207], v[104:107], v[16:19]
ds_read_b128 a[184:187], v187 offset:12288
v_exp_f32 v65, v65
v_mfma_f32_16x16x32_bf16 v[20:23], a[204:207], v[108:111], v[20:23]
v_cvt_pk_bf16_f32 v96, v64, v65
s_waitcnt lgkmcnt(6)
v_mfma_f32_16x16x32_bf16 v[80:83], a[208:211], v[120:123], v[80:83]
ds_read_b64_tr_b16 a[188:189], v200 offset:57344
v_exp_f32 v66, v66
v_mfma_f32_16x16x32_bf16 v[88:91], a[208:211], v[136:139], v[88:91]
ds_read_b64_tr_b16 a[190:191], v200 offset:61440
v_exp_f32 v67, v67
v_mfma_f32_16x16x32_bf16 v[24:27], a[212:215], v[104:107], v[24:27]
ds_read_b128 a[192:195], v188 offset:12288
v_cvt_pk_bf16_f32 v97, v66, v67
v_mfma_f32_16x16x32_bf16 v[28:31], a[212:215], v[108:111], v[28:31]
v_exp_f32 v68, v68
v_mfma_f32_16x16x32_bf16 v[80:83], a[216:219], v[124:127], v[80:83]
ds_read_b64_tr_b16 a[196:197], v201 offset:57344
buffer_load_dwordx4 v227, s[16:19], s43 offen offset:3072 nt lds
v_mfma_f32_16x16x32_bf16 v[88:91], a[216:219], v[140:143], v[88:91]
ds_read_b64_tr_b16 a[198:199], v201 offset:61440
s_waitcnt lgkmcnt(6)
v_mfma_f32_16x16x32_bf16 v[32:35], a[220:223], v[104:107], v[32:35]
ds_read_b128 a[200:203], v189 offset:12288
v_exp_f32 v69, v69
v_mfma_f32_16x16x32_bf16 v[36:39], a[220:223], v[108:111], v[36:39]
v_exp_f32 v70, v70
v_mfma_f32_16x16x32_bf16 v[84:87], a[224:227], v[112:115], v[156:159]
ds_read_b64_tr_b16 a[204:205], v194 offset:57344
v_cvt_pk_bf16_f32 v98, v68, v69
v_mfma_f32_16x16x32_bf16 v[92:95], a[224:227], v[128:131], v[160:163]
ds_read_b64_tr_b16 a[206:207], v194 offset:61440
v_exp_f32 v71, v71
v_mfma_f32_16x16x32_bf16 v[40:43], a[180:183], v[104:107], v[40:43]
ds_read_b64_tr_b16 a[208:209], v195 offset:57344
v_cvt_pk_bf16_f32 v99, v70, v71
v_mfma_f32_16x16x32_bf16 v[44:47], a[180:183], v[108:111], v[44:47]
ds_read_b64_tr_b16 a[210:211], v195 offset:61440
s_waitcnt lgkmcnt(8)
v_mfma_f32_16x16x32_bf16 v[84:87], a[184:187], v[116:119], v[84:87]
v_exp_f32 v72, v72
v_mfma_f32_16x16x32_bf16 v[92:95], a[184:187], v[132:135], v[92:95]
v_exp_f32 v73, v73
v_mfma_f32_16x16x32_bf16 v[48:51], a[188:191], v[104:107], v[48:51]
s_waitcnt vmcnt(8)
s_barrier
v_mfma_f32_16x16x32_bf16 v[52:55], a[188:191], v[108:111], v[52:55]
ds_read_b128 a[212:215], v186 offset:16384
s_waitcnt lgkmcnt(5)
v_mfma_f32_16x16x32_bf16 v[84:87], a[192:195], v[120:123], v[84:87]
ds_read_b128 a[216:219], v187 offset:16384
s_add_u32 m0, s39, 49152
v_mfma_f32_16x16x32_bf16 v[92:95], a[192:195], v[136:139], v[92:95]
ds_read_b128 a[220:223], v190 offset:16384
s_add_u32 s42, s42, 16384
v_mfma_f32_16x16x32_bf16 v[56:59], a[196:199], v[104:107], v[56:59]
ds_read_b64_tr_b16 a[224:225], v196 offset:0
buffer_load_dwordx4 v222, s[12:15], s42 offen nt lds
v_mfma_f32_16x16x32_bf16 v[60:63], a[196:199], v[108:111], v[60:63]
ds_read_b64_tr_b16 a[226:227], v196 offset:4096
v_cvt_pk_bf16_f32 v100, v72, v73
v_mfma_f32_16x16x32_bf16 a[232:235], a[228:231], v[104:107], a[232:235]
v_exp_f32 v74, v74
v_mfma_f32_16x16x32_bf16 v[84:87], a[200:203], v[124:127], v[84:87]
ds_read_b128 a[180:183], v191 offset:16384
v_exp_f32 v75, v75
v_mfma_f32_16x16x32_bf16 v[92:95], a[200:203], v[140:143], v[92:95]
v_cvt_pk_bf16_f32 v101, v74, v75
s_waitcnt lgkmcnt(6)
v_mfma_f32_16x16x32_bf16 v[0:3], a[204:207], v[104:107], v[0:3]
ds_read_b128 a[184:187], v188 offset:16384
v_exp_f32 v76, v76
v_mfma_f32_16x16x32_bf16 v[4:7], a[204:207], v[108:111], v[4:7]
buffer_load_dwordx4 v223, s[12:15], s42 offen offset:1024 nt lds
v_mfma_f32_16x16x32_bf16 a[16:19], a[204:207], a[28:31], a[16:19]
v_exp_f32 v77, v77
v_mfma_f32_16x16x32_bf16 a[236:239], a[228:231], v[108:111], a[236:239]
v_exp_f32 v78, v78
v_mfma_f32_16x16x32_bf16 v[8:11], a[208:211], v[104:107], v[8:11]
ds_read_b128 a[188:191], v192 offset:16384
v_cvt_pk_bf16_f32 v102, v76, v77
v_mfma_f32_16x16x32_bf16 v[12:15], a[208:211], v[108:111], v[12:15]
v_exp_f32 v79, v79
v_mfma_f32_16x16x32_bf16 a[20:23], a[208:211], a[28:31], a[20:23]
v_cvt_pk_bf16_f32 v103, v78, v79
s_waitcnt lgkmcnt(3)
v_mfma_f32_16x16x32_bf16 v[64:67], a[212:215], v[112:115], v[156:159]
ds_read_b64_tr_b16 a[192:193], v197 offset:0
v_exp_f32 v80, v80
v_mfma_f32_16x16x32_bf16 v[72:75], a[212:215], v[128:131], v[160:163]
ds_read_b64_tr_b16 a[194:195], v197 offset:4096
v_exp_f32 v81, v81
v_mfma_f32_16x16x32_bf16 v[64:67], a[216:219], v[116:119], v[64:67]
ds_read_b128 a[196:199], v193 offset:16384
v_cvt_pk_bf16_f32 v104, v80, v81
v_mfma_f32_16x16x32_bf16 v[72:75], a[216:219], v[132:135], v[72:75]
ds_read_b128 a[24:27], v203 offset:0
buffer_load_dwordx4 v224, s[12:15], s42 offen offset:2048 nt lds
v_mfma_f32_16x16x32_bf16 v[144:147], a[220:223], a[0:3], v[164:167]
ds_read_b128 a[200:203], v189 offset:16384
v_exp_f32 v82, v82
v_mfma_f32_16x16x32_bf16 v[16:19], a[224:227], v[96:99], v[16:19]
ds_read_b64_tr_b16 a[204:205], v198 offset:0
v_exp_f32 v83, v83
v_mfma_f32_16x16x32_bf16 v[20:23], a[224:227], v[100:103], v[20:23]
ds_read_b64_tr_b16 a[206:207], v198 offset:4096
s_waitcnt lgkmcnt(5)
v_mfma_f32_16x16x32_bf16 v[144:147], a[180:183], a[4:7], v[144:147]
ds_read_b128 a[208:211], v186 offset:20480
v_cvt_pk_bf16_f32 v105, v82, v83
v_mfma_f32_16x16x32_bf16 v[64:67], a[184:187], v[120:123], v[64:67]
ds_read_b64_tr_b16 a[212:213], v199 offset:0
v_exp_f32 v84, v84
v_mfma_f32_16x16x32_bf16 v[72:75], a[184:187], v[136:139], v[72:75]
ds_read_b64_tr_b16 a[214:215], v199 offset:4096
v_exp_f32 v85, v85
v_mfma_f32_16x16x32_bf16 v[144:147], a[188:191], a[8:11], v[144:147]
ds_read_b128 a[216:219], v187 offset:20480
v_cvt_pk_bf16_f32 v106, v84, v85
v_mfma_f32_16x16x32_bf16 v[24:27], a[192:195], v[96:99], v[24:27]
ds_read_b64_tr_b16 a[220:221], v200 offset:0
v_exp_f32 v86, v86
v_mfma_f32_16x16x32_bf16 v[28:31], a[192:195], v[100:103], v[28:31]
ds_read_b64_tr_b16 a[222:223], v200 offset:4096
s_waitcnt lgkmcnt(5)
v_mfma_f32_16x16x32_bf16 v[144:147], a[196:199], a[12:15], v[144:147]
ds_read_b128 a[224:227], v188 offset:20480
buffer_load_dwordx4 v225, s[12:15], s42 offen offset:3072 nt lds
v_mfma_f32_16x16x32_bf16 v[64:67], a[200:203], v[124:127], v[64:67]
ds_read_b64_tr_b16 a[180:181], v201 offset:0
v_exp_f32 v87, v87
v_mfma_f32_16x16x32_bf16 v[72:75], a[200:203], v[140:143], v[72:75]
ds_read_b64_tr_b16 a[182:183], v201 offset:4096
v_cvt_pk_bf16_f32 v107, v86, v87
v_mfma_f32_16x16x32_bf16 v[32:35], a[204:207], v[96:99], v[32:35]
ds_read_b128 a[28:31], v203 offset:1024
v_exp_f32 v88, v88
v_mfma_f32_16x16x32_bf16 v[36:39], a[204:207], v[100:103], v[36:39]
ds_read_b128 a[184:187], v189 offset:20480
v_exp_f32 v89, v89
v_mfma_f32_16x16x32_bf16 v[68:71], a[208:211], v[112:115], v[156:159]
ds_read_b64_tr_b16 a[188:189], v194 offset:0
v_cvt_pk_bf16_f32 v108, v88, v89
v_mfma_f32_16x16x32_bf16 v[76:79], a[208:211], v[128:131], v[160:163]
ds_read_b64_tr_b16 a[190:191], v194 offset:4096
s_waitcnt lgkmcnt(7)
v_mfma_f32_16x16x32_bf16 v[40:43], a[212:215], v[96:99], v[40:43]
ds_read_b64_tr_b16 a[192:193], v195 offset:0
v_exp_f32 v90, v90
v_mfma_f32_16x16x32_bf16 v[44:47], a[212:215], v[100:103], v[44:47]
ds_read_b64_tr_b16 a[194:195], v195 offset:4096
v_exp_f32 v91, v91
v_mfma_f32_16x16x32_bf16 v[68:71], a[216:219], v[116:119], v[68:71]
ds_read_b128 a[196:199], v186 offset:24576
s_add_u32 m0, s39, 98304
v_mfma_f32_16x16x32_bf16 v[76:79], a[216:219], v[132:135], v[76:79]
s_add_u32 s43, s43, 16384
buffer_load_dwordx4 v226, s[16:19], s43 offen nt lds
v_mfma_f32_16x16x32_bf16 v[48:51], a[220:223], v[96:99], v[48:51]
ds_read_b128 a[200:203], v187 offset:24576
v_cvt_pk_bf16_f32 v109, v90, v91
v_mfma_f32_16x16x32_bf16 v[52:55], a[220:223], v[100:103], v[52:55]
v_exp_f32 v92, v92
s_waitcnt lgkmcnt(6)
v_mfma_f32_16x16x32_bf16 v[68:71], a[224:227], v[120:123], v[68:71]
ds_read_b64_tr_b16 a[204:205], v196 offset:8192
v_exp_f32 v93, v93
v_mfma_f32_16x16x32_bf16 v[76:79], a[224:227], v[136:139], v[76:79]
ds_read_b64_tr_b16 a[206:207], v196 offset:12288
v_cvt_pk_bf16_f32 v110, v92, v93
v_mfma_f32_16x16x32_bf16 v[56:59], a[180:183], v[96:99], v[56:59]
ds_read_b128 a[208:211], v188 offset:24576
v_exp_f32 v94, v94
v_mfma_f32_16x16x32_bf16 v[60:63], a[180:183], v[100:103], v[60:63]
v_exp_f32 v95, v95
v_mfma_f32_16x16x32_bf16 a[232:235], a[228:231], v[96:99], a[232:235]
v_cvt_pk_bf16_f32 v111, v94, v95
v_exp_f32 v144, v144
v_mfma_f32_16x16x32_bf16 v[68:71], a[184:187], v[124:127], v[68:71]
ds_read_b64_tr_b16 a[212:213], v197 offset:8192
buffer_load_dwordx4 v227, s[16:19], s43 offen offset:1024 nt lds
v_mfma_f32_16x16x32_bf16 v[76:79], a[184:187], v[140:143], v[76:79]
ds_read_b64_tr_b16 a[214:215], v197 offset:12288
s_waitcnt lgkmcnt(7)
v_mfma_f32_16x16x32_bf16 v[0:3], a[188:191], v[96:99], v[0:3]
ds_read_b128 a[216:219], v189 offset:24576
v_add_f32 v177, v177, v144
v_mfma_f32_16x16x32_bf16 v[4:7], a[188:191], v[100:103], v[4:7]
v_exp_f32 v145, v145
v_mfma_f32_16x16x32_bf16 a[16:19], a[188:191], a[24:27], a[16:19]
v_exp_f32 v146, v146
v_mfma_f32_16x16x32_bf16 a[236:239], a[228:231], v[100:103], a[236:239]
v_cvt_pk_bf16_f32 v152, v144, v145
v_add_f32 v177, v177, v145
v_mfma_f32_16x16x32_bf16 v[8:11], a[192:195], v[96:99], v[8:11]
ds_read_b64_tr_b16 a[220:221], v198 offset:8192
v_add_f32 v177, v177, v146
v_mfma_f32_16x16x32_bf16 v[12:15], a[192:195], v[100:103], v[12:15]
ds_read_b64_tr_b16 a[222:223], v198 offset:12288
v_exp_f32 v147, v147
v_mfma_f32_16x16x32_bf16 a[20:23], a[192:195], a[24:27], a[20:23]
v_cvt_pk_bf16_f32 v153, v146, v147
s_waitcnt lgkmcnt(6)
v_mfma_f32_16x16x32_bf16 v[80:83], a[196:199], v[112:115], v[156:159]
ds_read_b128 a[224:227], v186 offset:28672
ds_write_b64 v202, v[152:153] offset:2048
v_mfma_f32_16x16x32_bf16 v[88:91], a[196:199], v[128:131], v[160:163]
buffer_load_dwordx4 v226, s[16:19], s43 offen offset:2048 nt lds
v_mfma_f32_16x16x32_bf16 v[80:83], a[200:203], v[116:119], v[80:83]
ds_read_b64_tr_b16 a[180:181], v199 offset:8192
v_add_f32 v177, v177, v147
v_mfma_f32_16x16x32_bf16 v[88:91], a[200:203], v[132:135], v[88:91]
ds_read_b64_tr_b16 a[182:183], v199 offset:12288
v_exp_f32 v64, v64
v_mfma_f32_16x16x32_bf16 v[16:19], a[204:207], v[104:107], v[16:19]
ds_read_b128 a[184:187], v187 offset:28672
v_exp_f32 v65, v65
v_mfma_f32_16x16x32_bf16 v[20:23], a[204:207], v[108:111], v[20:23]
v_cvt_pk_bf16_f32 v96, v64, v65
s_waitcnt lgkmcnt(6)
v_mfma_f32_16x16x32_bf16 v[80:83], a[208:211], v[120:123], v[80:83]
ds_read_b64_tr_b16 a[188:189], v200 offset:8192
v_exp_f32 v66, v66
v_mfma_f32_16x16x32_bf16 v[88:91], a[208:211], v[136:139], v[88:91]
ds_read_b64_tr_b16 a[190:191], v200 offset:12288
v_exp_f32 v67, v67
v_mfma_f32_16x16x32_bf16 v[24:27], a[212:215], v[104:107], v[24:27]
ds_read_b128 a[192:195], v188 offset:28672
v_cvt_pk_bf16_f32 v97, v66, v67
v_mfma_f32_16x16x32_bf16 v[28:31], a[212:215], v[108:111], v[28:31]
v_exp_f32 v68, v68
v_mfma_f32_16x16x32_bf16 v[80:83], a[216:219], v[124:127], v[80:83]
ds_read_b64_tr_b16 a[196:197], v201 offset:8192
buffer_load_dwordx4 v227, s[16:19], s43 offen offset:3072 nt lds
v_mfma_f32_16x16x32_bf16 v[88:91], a[216:219], v[140:143], v[88:91]
ds_read_b64_tr_b16 a[198:199], v201 offset:12288
s_waitcnt lgkmcnt(6)
v_mfma_f32_16x16x32_bf16 v[32:35], a[220:223], v[104:107], v[32:35]
ds_read_b128 a[200:203], v189 offset:28672
v_exp_f32 v69, v69
v_mfma_f32_16x16x32_bf16 v[36:39], a[220:223], v[108:111], v[36:39]
v_exp_f32 v70, v70
v_mfma_f32_16x16x32_bf16 v[84:87], a[224:227], v[112:115], v[156:159]
ds_read_b64_tr_b16 a[204:205], v194 offset:8192
v_cvt_pk_bf16_f32 v98, v68, v69
v_mfma_f32_16x16x32_bf16 v[92:95], a[224:227], v[128:131], v[160:163]
ds_read_b64_tr_b16 a[206:207], v194 offset:12288
v_exp_f32 v71, v71
v_mfma_f32_16x16x32_bf16 v[40:43], a[180:183], v[104:107], v[40:43]
ds_read_b64_tr_b16 a[208:209], v195 offset:8192
v_cvt_pk_bf16_f32 v99, v70, v71
v_mfma_f32_16x16x32_bf16 v[44:47], a[180:183], v[108:111], v[44:47]
ds_read_b64_tr_b16 a[210:211], v195 offset:12288
s_waitcnt lgkmcnt(8)
v_mfma_f32_16x16x32_bf16 v[84:87], a[184:187], v[116:119], v[84:87]
v_exp_f32 v72, v72
v_mfma_f32_16x16x32_bf16 v[92:95], a[184:187], v[132:135], v[92:95]
v_exp_f32 v73, v73
v_mfma_f32_16x16x32_bf16 v[48:51], a[188:191], v[104:107], v[48:51]
s_waitcnt vmcnt(8)
s_barrier
v_mfma_f32_16x16x32_bf16 v[52:55], a[188:191], v[108:111], v[52:55]
ds_read_b128 a[212:215], v186 offset:32768
s_waitcnt lgkmcnt(5)
v_mfma_f32_16x16x32_bf16 v[84:87], a[192:195], v[120:123], v[84:87]
ds_read_b128 a[216:219], v187 offset:32768
s_add_u32 m0, s39, 114688
v_mfma_f32_16x16x32_bf16 v[92:95], a[192:195], v[136:139], v[92:95]
ds_read_b128 a[220:223], v190 offset:32768
s_add_u32 s43, s43, 16384
v_mfma_f32_16x16x32_bf16 v[56:59], a[196:199], v[104:107], v[56:59]
ds_read_b64_tr_b16 a[224:225], v196 offset:16384
buffer_load_dwordx4 v226, s[16:19], s43 offen nt lds
v_mfma_f32_16x16x32_bf16 v[60:63], a[196:199], v[108:111], v[60:63]
ds_read_b64_tr_b16 a[226:227], v196 offset:20480
v_cvt_pk_bf16_f32 v100, v72, v73
v_mfma_f32_16x16x32_bf16 a[232:235], a[228:231], v[104:107], a[232:235]
v_exp_f32 v74, v74
v_mfma_f32_16x16x32_bf16 v[84:87], a[200:203], v[124:127], v[84:87]
ds_read_b128 a[180:183], v191 offset:32768
v_exp_f32 v75, v75
v_mfma_f32_16x16x32_bf16 v[92:95], a[200:203], v[140:143], v[92:95]
v_cvt_pk_bf16_f32 v101, v74, v75
s_waitcnt lgkmcnt(6)
v_mfma_f32_16x16x32_bf16 v[0:3], a[204:207], v[104:107], v[0:3]
ds_read_b128 a[184:187], v188 offset:32768
v_exp_f32 v76, v76
v_mfma_f32_16x16x32_bf16 v[4:7], a[204:207], v[108:111], v[4:7]
v_exp_f32 v77, v77
v_mfma_f32_16x16x32_bf16 a[16:19], a[204:207], a[28:31], a[16:19]
v_exp_f32 v78, v78
v_mfma_f32_16x16x32_bf16 a[236:239], a[228:231], v[108:111], a[236:239]
v_cvt_pk_bf16_f32 v102, v76, v77
v_exp_f32 v79, v79
v_mfma_f32_16x16x32_bf16 v[8:11], a[208:211], v[104:107], v[8:11]
ds_read_b128 a[188:191], v192 offset:32768
v_cvt_pk_bf16_f32 v103, v78, v79
v_mfma_f32_16x16x32_bf16 v[12:15], a[208:211], v[108:111], v[12:15]
v_mfma_f32_16x16x32_bf16 a[20:23], a[208:211], a[28:31], a[20:23]
s_waitcnt lgkmcnt(3)
v_mfma_f32_16x16x32_bf16 v[64:67], a[212:215], v[112:115], v[156:159]
ds_read_b64_tr_b16 a[192:193], v197 offset:16384
v_exp_f32 v80, v80
v_mfma_f32_16x16x32_bf16 v[72:75], a[212:215], v[128:131], v[160:163]
ds_read_b64_tr_b16 a[194:195], v197 offset:20480
v_exp_f32 v81, v81
v_mfma_f32_16x16x32_bf16 v[64:67], a[216:219], v[116:119], v[64:67]
ds_read_b128 a[196:199], v193 offset:32768
v_cvt_pk_bf16_f32 v104, v80, v81
v_mfma_f32_16x16x32_bf16 v[72:75], a[216:219], v[132:135], v[72:75]
ds_read_b128 a[24:27], v203 offset:2048
buffer_load_dwordx4 v227, s[16:19], s43 offen offset:1024 nt lds
v_mfma_f32_16x16x32_bf16 v[144:147], a[220:223], a[0:3], v[164:167]
ds_read_b128 a[200:203], v189 offset:32768
v_exp_f32 v82, v82
v_mfma_f32_16x16x32_bf16 v[16:19], a[224:227], v[96:99], v[16:19]
ds_read_b64_tr_b16 a[204:205], v198 offset:16384
v_exp_f32 v83, v83
v_mfma_f32_16x16x32_bf16 v[20:23], a[224:227], v[100:103], v[20:23]
ds_read_b64_tr_b16 a[206:207], v198 offset:20480
s_waitcnt lgkmcnt(5)
v_mfma_f32_16x16x32_bf16 v[144:147], a[180:183], a[4:7], v[144:147]
ds_read_b128 a[208:211], v186 offset:36864
v_cvt_pk_bf16_f32 v105, v82, v83
v_mfma_f32_16x16x32_bf16 v[64:67], a[184:187], v[120:123], v[64:67]
ds_read_b64_tr_b16 a[212:213], v199 offset:16384
v_exp_f32 v84, v84
v_mfma_f32_16x16x32_bf16 v[72:75], a[184:187], v[136:139], v[72:75]
ds_read_b64_tr_b16 a[214:215], v199 offset:20480
v_exp_f32 v85, v85
v_mfma_f32_16x16x32_bf16 v[144:147], a[188:191], a[8:11], v[144:147]
ds_read_b128 a[216:219], v187 offset:36864
v_cvt_pk_bf16_f32 v106, v84, v85
v_mfma_f32_16x16x32_bf16 v[24:27], a[192:195], v[96:99], v[24:27]
ds_read_b64_tr_b16 a[220:221], v200 offset:16384
v_exp_f32 v86, v86
v_mfma_f32_16x16x32_bf16 v[28:31], a[192:195], v[100:103], v[28:31]
ds_read_b64_tr_b16 a[222:223], v200 offset:20480
s_waitcnt lgkmcnt(5)
v_mfma_f32_16x16x32_bf16 v[144:147], a[196:199], a[12:15], v[144:147]
ds_read_b128 a[224:227], v188 offset:36864
v_exp_f32 v87, v87
v_mfma_f32_16x16x32_bf16 v[64:67], a[200:203], v[124:127], v[64:67]
ds_read_b64_tr_b16 a[180:181], v201 offset:16384
v_cvt_pk_bf16_f32 v107, v86, v87
v_mfma_f32_16x16x32_bf16 v[72:75], a[200:203], v[140:143], v[72:75]
ds_read_b64_tr_b16 a[182:183], v201 offset:20480
v_exp_f32 v88, v88
v_mfma_f32_16x16x32_bf16 v[32:35], a[204:207], v[96:99], v[32:35]
ds_read_b128 a[28:31], v203 offset:3072
v_exp_f32 v89, v89
v_mfma_f32_16x16x32_bf16 v[36:39], a[204:207], v[100:103], v[36:39]
ds_read_b128 a[184:187], v189 offset:36864
v_cvt_pk_bf16_f32 v108, v88, v89
v_mfma_f32_16x16x32_bf16 v[68:71], a[208:211], v[112:115], v[156:159]
ds_read_b64_tr_b16 a[188:189], v194 offset:16384
v_exp_f32 v90, v90
v_mfma_f32_16x16x32_bf16 v[76:79], a[208:211], v[128:131], v[160:163]
ds_read_b64_tr_b16 a[190:191], v194 offset:20480
s_waitcnt lgkmcnt(7)
v_mfma_f32_16x16x32_bf16 v[40:43], a[212:215], v[96:99], v[40:43]
ds_read_b64_tr_b16 a[192:193], v195 offset:16384
v_exp_f32 v91, v91
v_mfma_f32_16x16x32_bf16 v[44:47], a[212:215], v[100:103], v[44:47]
ds_read_b64_tr_b16 a[194:195], v195 offset:20480
v_cvt_pk_bf16_f32 v109, v90, v91
v_mfma_f32_16x16x32_bf16 v[68:71], a[216:219], v[116:119], v[68:71]
ds_read_b128 a[196:199], v186 offset:40960
buffer_load_dwordx4 v226, s[16:19], s43 offen offset:2048 nt lds
v_mfma_f32_16x16x32_bf16 v[76:79], a[216:219], v[132:135], v[76:79]
v_exp_f32 v92, v92
v_mfma_f32_16x16x32_bf16 v[48:51], a[220:223], v[96:99], v[48:51]
ds_read_b128 a[200:203], v187 offset:40960
v_exp_f32 v93, v93
v_mfma_f32_16x16x32_bf16 v[52:55], a[220:223], v[100:103], v[52:55]
v_cvt_pk_bf16_f32 v110, v92, v93
s_waitcnt lgkmcnt(6)
v_mfma_f32_16x16x32_bf16 v[68:71], a[224:227], v[120:123], v[68:71]
ds_read_b64_tr_b16 a[204:205], v196 offset:24576
v_exp_f32 v94, v94
v_mfma_f32_16x16x32_bf16 v[76:79], a[224:227], v[136:139], v[76:79]
ds_read_b64_tr_b16 a[206:207], v196 offset:28672
v_exp_f32 v95, v95
v_mfma_f32_16x16x32_bf16 v[56:59], a[180:183], v[96:99], v[56:59]
ds_read_b128 a[208:211], v188 offset:40960
v_cvt_pk_bf16_f32 v111, v94, v95
v_mfma_f32_16x16x32_bf16 v[60:63], a[180:183], v[100:103], v[60:63]
v_exp_f32 v144, v144
v_mfma_f32_16x16x32_bf16 a[232:235], a[228:231], v[96:99], a[232:235]
v_exp_f32 v145, v145
v_mfma_f32_16x16x32_bf16 v[68:71], a[184:187], v[124:127], v[68:71]
ds_read_b64_tr_b16 a[212:213], v197 offset:24576
v_cvt_pk_bf16_f32 v152, v144, v145
v_mfma_f32_16x16x32_bf16 v[76:79], a[184:187], v[140:143], v[76:79]
ds_read_b64_tr_b16 a[214:215], v197 offset:28672
s_waitcnt lgkmcnt(7)
v_mfma_f32_16x16x32_bf16 v[0:3], a[188:191], v[96:99], v[0:3]
ds_read_b128 a[216:219], v189 offset:40960
v_add_f32 v177, v177, v144
v_mfma_f32_16x16x32_bf16 v[4:7], a[188:191], v[100:103], v[4:7]
v_exp_f32 v146, v146
v_mfma_f32_16x16x32_bf16 a[16:19], a[188:191], a[24:27], a[16:19]
v_exp_f32 v147, v147
v_mfma_f32_16x16x32_bf16 a[236:239], a[228:231], v[100:103], a[236:239]
v_cvt_pk_bf16_f32 v153, v146, v147
ds_write_b64 v202, v[152:153] offset:0
v_mfma_f32_16x16x32_bf16 v[8:11], a[192:195], v[96:99], v[8:11]
ds_read_b64_tr_b16 a[220:221], v198 offset:24576
v_add_f32 v177, v177, v145
v_mfma_f32_16x16x32_bf16 v[12:15], a[192:195], v[100:103], v[12:15]
ds_read_b64_tr_b16 a[222:223], v198 offset:28672
v_add_f32 v177, v177, v146
v_mfma_f32_16x16x32_bf16 a[20:23], a[192:195], a[24:27], a[20:23]
v_add_f32 v177, v177, v147
s_waitcnt lgkmcnt(6)
v_mfma_f32_16x16x32_bf16 v[80:83], a[196:199], v[112:115], v[156:159]
ds_read_b128 a[224:227], v186 offset:45056
v_exp_f32 v64, v64
v_mfma_f32_16x16x32_bf16 v[88:91], a[196:199], v[128:131], v[160:163]
buffer_load_dwordx4 v227, s[16:19], s43 offen offset:3072 nt lds
v_mfma_f32_16x16x32_bf16 v[80:83], a[200:203], v[116:119], v[80:83]
ds_read_b64_tr_b16 a[180:181], v199 offset:24576
v_exp_f32 v65, v65
v_mfma_f32_16x16x32_bf16 v[88:91], a[200:203], v[132:135], v[88:91]
ds_read_b64_tr_b16 a[182:183], v199 offset:28672
v_cvt_pk_bf16_f32 v96, v64, v65
v_mfma_f32_16x16x32_bf16 v[16:19], a[204:207], v[104:107], v[16:19]
ds_read_b128 a[184:187], v187 offset:45056
v_exp_f32 v66, v66
v_mfma_f32_16x16x32_bf16 v[20:23], a[204:207], v[108:111], v[20:23]
v_exp_f32 v67, v67
s_waitcnt lgkmcnt(6)
v_mfma_f32_16x16x32_bf16 v[80:83], a[208:211], v[120:123], v[80:83]
ds_read_b64_tr_b16 a[188:189], v200 offset:24576
v_cvt_pk_bf16_f32 v97, v66, v67
v_mfma_f32_16x16x32_bf16 v[88:91], a[208:211], v[136:139], v[88:91]
ds_read_b64_tr_b16 a[190:191], v200 offset:28672
v_exp_f32 v68, v68
v_mfma_f32_16x16x32_bf16 v[24:27], a[212:215], v[104:107], v[24:27]
ds_read_b128 a[192:195], v188 offset:45056
v_exp_f32 v69, v69
v_mfma_f32_16x16x32_bf16 v[28:31], a[212:215], v[108:111], v[28:31]
v_exp_f32 v70, v70
v_mfma_f32_16x16x32_bf16 v[80:83], a[216:219], v[124:127], v[80:83]
ds_read_b64_tr_b16 a[196:197], v201 offset:24576
v_cvt_pk_bf16_f32 v98, v68, v69
v_mfma_f32_16x16x32_bf16 v[88:91], a[216:219], v[140:143], v[88:91]
ds_read_b64_tr_b16 a[198:199], v201 offset:28672
s_waitcnt lgkmcnt(6)
v_mfma_f32_16x16x32_bf16 v[32:35], a[220:223], v[104:107], v[32:35]
ds_read_b128 a[200:203], v189 offset:45056
v_exp_f32 v71, v71
v_mfma_f32_16x16x32_bf16 v[36:39], a[220:223], v[108:111], v[36:39]
v_exp_f32 v72, v72
v_mfma_f32_16x16x32_bf16 v[84:87], a[224:227], v[112:115], v[156:159]
ds_read_b64_tr_b16 a[204:205], v194 offset:24576
v_cvt_pk_bf16_f32 v99, v70, v71
v_mfma_f32_16x16x32_bf16 v[92:95], a[224:227], v[128:131], v[160:163]
ds_read_b64_tr_b16 a[206:207], v194 offset:28672
v_exp_f32 v73, v73
v_mfma_f32_16x16x32_bf16 v[40:43], a[180:183], v[104:107], v[40:43]
ds_read_b64_tr_b16 a[208:209], v195 offset:24576
v_cvt_pk_bf16_f32 v100, v72, v73
v_mfma_f32_16x16x32_bf16 v[44:47], a[180:183], v[108:111], v[44:47]
ds_read_b64_tr_b16 a[210:211], v195 offset:28672
s_waitcnt lgkmcnt(8)
v_mfma_f32_16x16x32_bf16 v[84:87], a[184:187], v[116:119], v[84:87]
v_exp_f32 v74, v74
v_mfma_f32_16x16x32_bf16 v[92:95], a[184:187], v[132:135], v[92:95]
v_exp_f32 v75, v75
v_mfma_f32_16x16x32_bf16 v[48:51], a[188:191], v[104:107], v[48:51]
s_waitcnt vmcnt(4)
s_barrier
v_mfma_f32_16x16x32_bf16 v[52:55], a[188:191], v[108:111], v[52:55]
ds_read_b128 a[212:215], v186 offset:49152
s_waitcnt lgkmcnt(5)
v_mfma_f32_16x16x32_bf16 v[84:87], a[192:195], v[120:123], v[84:87]
ds_read_b128 a[216:219], v187 offset:49152
s_add_u32 s42, s41, 114688
v_mfma_f32_16x16x32_bf16 v[92:95], a[192:195], v[136:139], v[92:95]
ds_read_b128 a[220:223], v190 offset:49152
s_mov_b32 s43, s42
v_mfma_f32_16x16x32_bf16 v[56:59], a[196:199], v[104:107], v[56:59]
ds_read_b64_tr_b16 a[224:225], v196 offset:32768
v_cvt_pk_bf16_f32 v101, v74, v75
v_mfma_f32_16x16x32_bf16 v[60:63], a[196:199], v[108:111], v[60:63]
ds_read_b64_tr_b16 a[226:227], v196 offset:36864
v_exp_f32 v76, v76
v_mfma_f32_16x16x32_bf16 a[232:235], a[228:231], v[104:107], a[232:235]
v_exp_f32 v77, v77
v_mfma_f32_16x16x32_bf16 v[84:87], a[200:203], v[124:127], v[84:87]
ds_read_b128 a[180:183], v191 offset:49152
v_cvt_pk_bf16_f32 v102, v76, v77
v_mfma_f32_16x16x32_bf16 v[92:95], a[200:203], v[140:143], v[92:95]
v_exp_f32 v78, v78
s_waitcnt lgkmcnt(6)
v_mfma_f32_16x16x32_bf16 v[0:3], a[204:207], v[104:107], v[0:3]
ds_read_b128 a[184:187], v188 offset:49152
v_exp_f32 v79, v79
v_mfma_f32_16x16x32_bf16 v[4:7], a[204:207], v[108:111], v[4:7]
v_cvt_pk_bf16_f32 v103, v78, v79
v_mfma_f32_16x16x32_bf16 a[16:19], a[204:207], a[28:31], a[16:19]
v_mfma_f32_16x16x32_bf16 a[236:239], a[228:231], v[108:111], a[236:239]
v_mfma_f32_16x16x32_bf16 v[8:11], a[208:211], v[104:107], v[8:11]
ds_read_b128 a[188:191], v192 offset:49152
s_add_u32 m0, s39, 0
v_mfma_f32_16x16x32_bf16 v[12:15], a[208:211], v[108:111], v[12:15]
s_add_u32 s42, s42, 16384
buffer_load_dwordx4 v222, s[12:15], s42 offen nt lds
v_mfma_f32_16x16x32_bf16 a[20:23], a[208:211], a[28:31], a[20:23]
s_waitcnt lgkmcnt(3)
v_mfma_f32_16x16x32_bf16 v[64:67], a[212:215], v[112:115], v[156:159]
ds_read_b64_tr_b16 a[192:193], v197 offset:32768
v_exp_f32 v80, v80
v_mfma_f32_16x16x32_bf16 v[72:75], a[212:215], v[128:131], v[160:163]
ds_read_b64_tr_b16 a[194:195], v197 offset:36864
v_exp_f32 v81, v81
v_mfma_f32_16x16x32_bf16 v[64:67], a[216:219], v[116:119], v[64:67]
ds_read_b128 a[196:199], v193 offset:49152
v_cvt_pk_bf16_f32 v104, v80, v81
v_mfma_f32_16x16x32_bf16 v[72:75], a[216:219], v[132:135], v[72:75]
ds_read_b128 a[24:27], v203 offset:0
v_exp_f32 v82, v82
v_mfma_f32_16x16x32_bf16 v[144:147], a[220:223], a[0:3], v[164:167]
ds_read_b128 a[200:203], v189 offset:49152
v_exp_f32 v83, v83
v_mfma_f32_16x16x32_bf16 v[16:19], a[224:227], v[96:99], v[16:19]
ds_read_b64_tr_b16 a[204:205], v198 offset:32768
v_cvt_pk_bf16_f32 v105, v82, v83
v_mfma_f32_16x16x32_bf16 v[20:23], a[224:227], v[100:103], v[20:23]
ds_read_b64_tr_b16 a[206:207], v198 offset:36864
s_waitcnt lgkmcnt(5)
v_mfma_f32_16x16x32_bf16 v[144:147], a[180:183], a[4:7], v[144:147]
ds_read_b128 a[208:211], v186 offset:53248
v_exp_f32 v84, v84
v_mfma_f32_16x16x32_bf16 v[64:67], a[184:187], v[120:123], v[64:67]
ds_read_b64_tr_b16 a[212:213], v199 offset:32768
v_exp_f32 v85, v85
v_mfma_f32_16x16x32_bf16 v[72:75], a[184:187], v[136:139], v[72:75]
ds_read_b64_tr_b16 a[214:215], v199 offset:36864
v_cvt_pk_bf16_f32 v106, v84, v85
v_mfma_f32_16x16x32_bf16 v[144:147], a[188:191], a[8:11], v[144:147]
ds_read_b128 a[216:219], v187 offset:53248
buffer_load_dwordx4 v223, s[12:15], s42 offen offset:1024 nt lds
v_mfma_f32_16x16x32_bf16 v[24:27], a[192:195], v[96:99], v[24:27]
ds_read_b64_tr_b16 a[220:221], v200 offset:32768
v_exp_f32 v86, v86
v_mfma_f32_16x16x32_bf16 v[28:31], a[192:195], v[100:103], v[28:31]
ds_read_b64_tr_b16 a[222:223], v200 offset:36864
s_waitcnt lgkmcnt(5)
v_mfma_f32_16x16x32_bf16 v[144:147], a[196:199], a[12:15], v[144:147]
ds_read_b128 a[224:227], v188 offset:53248
v_exp_f32 v87, v87
v_mfma_f32_16x16x32_bf16 v[64:67], a[200:203], v[124:127], v[64:67]
ds_read_b64_tr_b16 a[180:181], v201 offset:32768
v_cvt_pk_bf16_f32 v107, v86, v87
v_mfma_f32_16x16x32_bf16 v[72:75], a[200:203], v[140:143], v[72:75]
ds_read_b64_tr_b16 a[182:183], v201 offset:36864
v_exp_f32 v88, v88
v_mfma_f32_16x16x32_bf16 v[32:35], a[204:207], v[96:99], v[32:35]
ds_read_b128 a[28:31], v203 offset:1024
v_exp_f32 v89, v89
v_mfma_f32_16x16x32_bf16 v[36:39], a[204:207], v[100:103], v[36:39]
ds_read_b128 a[184:187], v189 offset:53248
v_cvt_pk_bf16_f32 v108, v88, v89
v_mfma_f32_16x16x32_bf16 v[68:71], a[208:211], v[112:115], v[156:159]
ds_read_b64_tr_b16 a[188:189], v194 offset:32768
v_exp_f32 v90, v90
v_mfma_f32_16x16x32_bf16 v[76:79], a[208:211], v[128:131], v[160:163]
ds_read_b64_tr_b16 a[190:191], v194 offset:36864
s_waitcnt lgkmcnt(7)
v_mfma_f32_16x16x32_bf16 v[40:43], a[212:215], v[96:99], v[40:43]
ds_read_b64_tr_b16 a[192:193], v195 offset:32768
v_exp_f32 v91, v91
v_mfma_f32_16x16x32_bf16 v[44:47], a[212:215], v[100:103], v[44:47]
ds_read_b64_tr_b16 a[194:195], v195 offset:36864
v_cvt_pk_bf16_f32 v109, v90, v91
v_mfma_f32_16x16x32_bf16 v[68:71], a[216:219], v[116:119], v[68:71]
ds_read_b128 a[196:199], v186 offset:57344
buffer_load_dwordx4 v224, s[12:15], s42 offen offset:2048 nt lds
v_mfma_f32_16x16x32_bf16 v[76:79], a[216:219], v[132:135], v[76:79]
v_exp_f32 v92, v92
v_mfma_f32_16x16x32_bf16 v[48:51], a[220:223], v[96:99], v[48:51]
ds_read_b128 a[200:203], v187 offset:57344
v_exp_f32 v93, v93
v_mfma_f32_16x16x32_bf16 v[52:55], a[220:223], v[100:103], v[52:55]
v_cvt_pk_bf16_f32 v110, v92, v93
s_waitcnt lgkmcnt(6)
v_mfma_f32_16x16x32_bf16 v[68:71], a[224:227], v[120:123], v[68:71]
ds_read_b64_tr_b16 a[204:205], v196 offset:40960
v_exp_f32 v94, v94
v_mfma_f32_16x16x32_bf16 v[76:79], a[224:227], v[136:139], v[76:79]
ds_read_b64_tr_b16 a[206:207], v196 offset:45056
v_exp_f32 v95, v95
v_mfma_f32_16x16x32_bf16 v[56:59], a[180:183], v[96:99], v[56:59]
ds_read_b128 a[208:211], v188 offset:57344
v_cvt_pk_bf16_f32 v111, v94, v95
v_mfma_f32_16x16x32_bf16 v[60:63], a[180:183], v[100:103], v[60:63]
v_exp_f32 v144, v144
v_mfma_f32_16x16x32_bf16 a[232:235], a[228:231], v[96:99], a[232:235]
v_exp_f32 v145, v145
v_mfma_f32_16x16x32_bf16 v[68:71], a[184:187], v[124:127], v[68:71]
ds_read_b64_tr_b16 a[212:213], v197 offset:40960
v_cvt_pk_bf16_f32 v152, v144, v145
v_mfma_f32_16x16x32_bf16 v[76:79], a[184:187], v[140:143], v[76:79]
ds_read_b64_tr_b16 a[214:215], v197 offset:45056
s_waitcnt lgkmcnt(7)
v_mfma_f32_16x16x32_bf16 v[0:3], a[188:191], v[96:99], v[0:3]
ds_read_b128 a[216:219], v189 offset:57344
v_add_f32 v177, v177, v144
v_mfma_f32_16x16x32_bf16 v[4:7], a[188:191], v[100:103], v[4:7]
v_exp_f32 v146, v146
v_mfma_f32_16x16x32_bf16 a[16:19], a[188:191], a[24:27], a[16:19]
buffer_load_dwordx4 v225, s[12:15], s42 offen offset:3072 nt lds
v_mfma_f32_16x16x32_bf16 a[236:239], a[228:231], v[100:103], a[236:239]
v_exp_f32 v147, v147
v_mfma_f32_16x16x32_bf16 v[8:11], a[192:195], v[96:99], v[8:11]
ds_read_b64_tr_b16 a[220:221], v198 offset:40960
v_cvt_pk_bf16_f32 v153, v146, v147
v_mfma_f32_16x16x32_bf16 v[12:15], a[192:195], v[100:103], v[12:15]
ds_read_b64_tr_b16 a[222:223], v198 offset:45056
ds_write_b64 v202, v[152:153] offset:2048
v_mfma_f32_16x16x32_bf16 a[20:23], a[192:195], a[24:27], a[20:23]
v_add_f32 v177, v177, v145
s_waitcnt lgkmcnt(6)
v_mfma_f32_16x16x32_bf16 v[80:83], a[196:199], v[112:115], v[156:159]
ds_read_b128 a[224:227], v186 offset:61440
v_add_f32 v177, v177, v146
v_mfma_f32_16x16x32_bf16 v[88:91], a[196:199], v[128:131], v[160:163]
v_add_f32 v177, v177, v147
v_exp_f32 v64, v64
v_mfma_f32_16x16x32_bf16 v[80:83], a[200:203], v[116:119], v[80:83]
ds_read_b64_tr_b16 a[180:181], v199 offset:40960
v_exp_f32 v65, v65
v_mfma_f32_16x16x32_bf16 v[88:91], a[200:203], v[132:135], v[88:91]
ds_read_b64_tr_b16 a[182:183], v199 offset:45056
v_cvt_pk_bf16_f32 v96, v64, v65
v_mfma_f32_16x16x32_bf16 v[16:19], a[204:207], v[104:107], v[16:19]
ds_read_b128 a[184:187], v187 offset:61440
v_exp_f32 v66, v66
v_mfma_f32_16x16x32_bf16 v[20:23], a[204:207], v[108:111], v[20:23]
v_exp_f32 v67, v67
s_waitcnt lgkmcnt(6)
v_mfma_f32_16x16x32_bf16 v[80:83], a[208:211], v[120:123], v[80:83]
ds_read_b64_tr_b16 a[188:189], v200 offset:40960
v_cvt_pk_bf16_f32 v97, v66, v67
v_mfma_f32_16x16x32_bf16 v[88:91], a[208:211], v[136:139], v[88:91]
ds_read_b64_tr_b16 a[190:191], v200 offset:45056
s_lshl_b32 s57, s39, 1
v_mfma_f32_16x16x32_bf16 v[24:27], a[212:215], v[104:107], v[24:27]
ds_read_b128 a[192:195], v188 offset:61440
s_add_u32 s57, s57, s53
v_mfma_f32_16x16x32_bf16 v[28:31], a[212:215], v[108:111], v[28:31]
v_exp_f32 v68, v68
v_mfma_f32_16x16x32_bf16 v[80:83], a[216:219], v[124:127], v[80:83]
ds_read_b64_tr_b16 a[196:197], v201 offset:40960
v_exp_f32 v69, v69
v_mfma_f32_16x16x32_bf16 v[88:91], a[216:219], v[140:143], v[88:91]
ds_read_b64_tr_b16 a[198:199], v201 offset:45056
s_waitcnt lgkmcnt(6)
v_mfma_f32_16x16x32_bf16 v[32:35], a[220:223], v[104:107], v[32:35]
ds_read_b128 a[200:203], v189 offset:61440
v_cvt_pk_bf16_f32 v98, v68, v69
v_mfma_f32_16x16x32_bf16 v[36:39], a[220:223], v[108:111], v[36:39]
v_exp_f32 v70, v70
v_mfma_f32_16x16x32_bf16 v[84:87], a[224:227], v[112:115], v[156:159]
ds_read_b64_tr_b16 a[204:205], v194 offset:40960
v_exp_f32 v71, v71
v_mfma_f32_16x16x32_bf16 v[92:95], a[224:227], v[128:131], v[160:163]
ds_read_b64_tr_b16 a[206:207], v194 offset:45056
v_cvt_pk_bf16_f32 v99, v70, v71
v_mfma_f32_16x16x32_bf16 v[40:43], a[180:183], v[104:107], v[40:43]
ds_read_b64_tr_b16 a[208:209], v195 offset:40960
v_exp_f32 v72, v72
v_mfma_f32_16x16x32_bf16 v[44:47], a[180:183], v[108:111], v[44:47]
ds_read_b64_tr_b16 a[210:211], v195 offset:45056
s_waitcnt lgkmcnt(8)
v_mfma_f32_16x16x32_bf16 v[84:87], a[184:187], v[116:119], v[84:87]
v_exp_f32 v73, v73
v_mfma_f32_16x16x32_bf16 v[92:95], a[184:187], v[132:135], v[92:95]
v_exp_f32 v74, v74
v_mfma_f32_16x16x32_bf16 v[48:51], a[188:191], v[104:107], v[48:51]
s_waitcnt vmcnt(4) lgkmcnt(0)
s_barrier
v_mfma_f32_16x16x32_bf16 v[52:55], a[188:191], v[108:111], v[52:55]
ds_read_b64_tr_b16 a[212:213], v196 offset:49152
s_add_u32 m0, s39, 16384
v_mfma_f32_16x16x32_bf16 v[84:87], a[192:195], v[120:123], v[84:87]
ds_read_b64_tr_b16 a[216:217], v197 offset:49152
s_add_u32 s42, s42, 16384
v_mfma_f32_16x16x32_bf16 v[92:95], a[192:195], v[136:139], v[92:95]
ds_read_b64_tr_b16 a[214:215], v196 offset:53248
buffer_load_dwordx4 v222, s[12:15], s42 offen nt lds
v_mfma_f32_16x16x32_bf16 v[56:59], a[196:199], v[104:107], v[56:59]
ds_read_b64_tr_b16 a[218:219], v197 offset:53248
ds_read_b64_tr_b16 a[220:221], v198 offset:49152
v_mfma_f32_16x16x32_bf16 v[60:63], a[196:199], v[108:111], v[60:63]
ds_read_b64_tr_b16 a[222:223], v198 offset:53248
buffer_load_dwordx4 v223, s[12:15], s42 offen offset:1024 nt lds
v_mfma_f32_16x16x32_bf16 a[232:235], a[228:231], v[104:107], a[232:235]
ds_read_b64_tr_b16 a[224:225], v199 offset:49152
v_cvt_pk_bf16_f32 v100, v72, v73
v_mfma_f32_16x16x32_bf16 v[84:87], a[200:203], v[124:127], v[84:87]
ds_read_b64_tr_b16 a[226:227], v199 offset:53248
buffer_load_dwordx4 v224, s[12:15], s42 offen offset:2048 nt lds
v_mfma_f32_16x16x32_bf16 v[92:95], a[200:203], v[140:143], v[92:95]
ds_read_b64_tr_b16 a[180:181], v200 offset:49152
v_exp_f32 v75, v75
v_mfma_f32_16x16x32_bf16 v[0:3], a[204:207], v[104:107], v[0:3]
ds_read_b64_tr_b16 a[182:183], v200 offset:53248
v_cvt_pk_bf16_f32 v101, v74, v75
v_mfma_f32_16x16x32_bf16 v[4:7], a[204:207], v[108:111], v[4:7]
ds_read_b64_tr_b16 a[184:185], v201 offset:49152
v_exp_f32 v76, v76
v_mfma_f32_16x16x32_bf16 a[16:19], a[204:207], a[28:31], a[16:19]
ds_read_b64_tr_b16 a[186:187], v201 offset:53248
buffer_load_dwordx4 v225, s[12:15], s42 offen offset:3072 nt lds
v_mfma_f32_16x16x32_bf16 a[236:239], a[228:231], v[108:111], a[236:239]
v_exp_f32 v77, v77
v_mfma_f32_16x16x32_bf16 v[8:11], a[208:211], v[104:107], v[8:11]
ds_read_b64_tr_b16 a[188:189], v194 offset:49152
v_cvt_pk_bf16_f32 v102, v76, v77
v_mfma_f32_16x16x32_bf16 v[12:15], a[208:211], v[108:111], v[12:15]
ds_read_b64_tr_b16 a[190:191], v194 offset:53248
s_add_u32 m0, s39, 65536
v_mfma_f32_16x16x32_bf16 a[20:23], a[208:211], a[28:31], a[20:23]
s_add_u32 s43, s43, 16384
v_exp_f32 v78, v78
v_exp_f32 v79, v79
s_nop 0
v_cvt_pk_bf16_f32 v103, v78, v79
s_waitcnt lgkmcnt(8)
v_mfma_f32_16x16x32_bf16 v[16:19], a[212:215], v[96:99], v[16:19]
ds_read_b64_tr_b16 a[192:193], v195 offset:49152
buffer_load_dwordx4 v226, s[16:19], s43 offen nt lds
v_mfma_f32_16x16x32_bf16 v[20:23], a[212:215], v[100:103], v[20:23]
ds_read_b64_tr_b16 a[194:195], v195 offset:53248
buffer_load_dwordx4 v227, s[16:19], s43 offen offset:1024 nt lds
v_mfma_f32_16x16x32_bf16 v[24:27], a[216:219], v[96:99], v[24:27]
ds_read_b64_tr_b16 a[196:197], v196 offset:57344
v_exp_f32 v80, v80
v_mfma_f32_16x16x32_bf16 v[28:31], a[216:219], v[100:103], v[28:31]
ds_read_b64_tr_b16 a[198:199], v196 offset:61440
v_exp_f32 v81, v81
v_mfma_f32_16x16x32_bf16 v[32:35], a[220:223], v[96:99], v[32:35]
ds_read_b128 a[24:27], v203 offset:2048
v_cvt_pk_bf16_f32 v104, v80, v81
v_mfma_f32_16x16x32_bf16 v[36:39], a[220:223], v[100:103], v[36:39]
ds_read_b64_tr_b16 a[200:201], v197 offset:57344
s_waitcnt lgkmcnt(8)
v_mfma_f32_16x16x32_bf16 v[40:43], a[224:227], v[96:99], v[40:43]
ds_read_b64_tr_b16 a[202:203], v197 offset:61440
buffer_load_dwordx4 v226, s[16:19], s43 offen offset:2048 nt lds
v_mfma_f32_16x16x32_bf16 v[44:47], a[224:227], v[100:103], v[44:47]
ds_read_b64_tr_b16 a[204:205], v198 offset:57344
v_exp_f32 v82, v82
v_mfma_f32_16x16x32_bf16 v[48:51], a[180:183], v[96:99], v[48:51]
ds_read_b64_tr_b16 a[206:207], v198 offset:61440
buffer_load_dwordx4 v227, s[16:19], s43 offen offset:3072 nt lds
v_mfma_f32_16x16x32_bf16 v[52:55], a[180:183], v[100:103], v[52:55]
ds_read_b64_tr_b16 a[208:209], v199 offset:57344
v_exp_f32 v83, v83
v_mfma_f32_16x16x32_bf16 a[232:235], a[228:231], v[96:99], a[232:235]
ds_read_b64_tr_b16 a[210:211], v199 offset:61440
v_cvt_pk_bf16_f32 v105, v82, v83
v_mfma_f32_16x16x32_bf16 v[56:59], a[184:187], v[96:99], v[56:59]
ds_read_b64_tr_b16 a[212:213], v200 offset:57344
v_exp_f32 v84, v84
v_mfma_f32_16x16x32_bf16 v[60:63], a[184:187], v[100:103], v[60:63]
ds_read_b64_tr_b16 a[214:215], v200 offset:61440
s_waitcnt lgkmcnt(8)
v_mfma_f32_16x16x32_bf16 v[0:3], a[188:191], v[96:99], v[0:3]
ds_read_b64_tr_b16 a[216:217], v201 offset:57344
s_add_u32 m0, s39, 32768
v_mfma_f32_16x16x32_bf16 v[4:7], a[188:191], v[100:103], v[4:7]
ds_read_b64_tr_b16 a[218:219], v201 offset:61440
s_add_u32 s42, s42, 16384
v_mfma_f32_16x16x32_bf16 a[16:19], a[188:191], a[24:27], a[16:19]
ds_read_b128 a[28:31], v203 offset:3072
buffer_load_dwordx4 v222, s[12:15], s42 offen nt lds
v_mfma_f32_16x16x32_bf16 a[236:239], a[228:231], v[100:103], a[236:239]
buffer_load_dwordx4 v223, s[12:15], s42 offen offset:1024 nt lds
v_mfma_f32_16x16x32_bf16 v[8:11], a[192:195], v[96:99], v[8:11]
ds_read_b64_tr_b16 a[220:221], v194 offset:57344
v_exp_f32 v85, v85
v_mfma_f32_16x16x32_bf16 v[12:15], a[192:195], v[100:103], v[12:15]
ds_read_b64_tr_b16 a[222:223], v194 offset:61440
buffer_load_dwordx4 v224, s[12:15], s42 offen offset:2048 nt lds
v_exp_f32 v86, v86
v_cvt_pk_bf16_f32 v106, v84, v85
v_exp_f32 v87, v87
v_exp_f32 v88, v88
v_cvt_pk_bf16_f32 v107, v86, v87
v_exp_f32 v89, v89
v_exp_f32 v90, v90
v_cvt_pk_bf16_f32 v108, v88, v89
v_exp_f32 v91, v91
v_exp_f32 v92, v92
v_cvt_pk_bf16_f32 v109, v90, v91
v_exp_f32 v93, v93
v_exp_f32 v94, v94
v_cvt_pk_bf16_f32 v110, v92, v93
v_exp_f32 v95, v95
s_nop 0
v_cvt_pk_bf16_f32 v111, v94, v95
v_mfma_f32_16x16x32_bf16 a[20:23], a[192:195], a[24:27], a[20:23]
v_mfma_f32_16x16x32_bf16 v[16:19], a[196:199], v[104:107], v[16:19]
ds_read_b64_tr_b16 a[224:225], v195 offset:57344
v_mfma_f32_16x16x32_bf16 v[20:23], a[196:199], v[108:111], v[20:23]
ds_read_b64_tr_b16 a[226:227], v195 offset:61440
v_mfma_f32_16x16x32_bf16 a[232:235], a[228:231], v[104:107], a[232:235]
buffer_load_dwordx4 v225, s[12:15], s42 offen offset:3072 nt lds
v_mfma_f32_16x16x32_bf16 a[236:239], a[228:231], v[108:111], a[236:239]
s_waitcnt lgkmcnt(9)
v_mfma_f32_16x16x32_bf16 v[24:27], a[200:203], v[104:107], v[24:27]
v_mfma_f32_16x16x32_bf16 v[28:31], a[200:203], v[108:111], v[28:31]
s_add_u32 m0, s39, 81920
s_add_u32 s43, s43, 16384
v_mfma_f32_16x16x32_bf16 v[32:35], a[204:207], v[104:107], v[32:35]
buffer_load_dwordx4 v226, s[16:19], s43 offen nt lds
v_mfma_f32_16x16x32_bf16 v[36:39], a[204:207], v[108:111], v[36:39]
v_mfma_f32_16x16x32_bf16 v[40:43], a[208:211], v[104:107], v[40:43]
buffer_load_dwordx4 v227, s[16:19], s43 offen offset:1024 nt lds
v_mfma_f32_16x16x32_bf16 v[44:47], a[208:211], v[108:111], v[44:47]
v_accvgpr_read_b32 v176, a232
s_waitcnt lgkmcnt(2)
v_mfma_f32_16x16x32_bf16 v[48:51], a[212:215], v[104:107], v[48:51]
v_accvgpr_read_b32 v144, a236
v_rcp_f32 v180, v176
v_mfma_f32_16x16x32_bf16 v[52:55], a[212:215], v[108:111], v[52:55]
v_rcp_f32 v182, v144
v_mfma_f32_16x16x32_bf16 v[56:59], a[216:219], v[104:107], v[56:59]
buffer_load_dwordx4 v226, s[16:19], s43 offen offset:2048 nt lds
v_mfma_f32_16x16x32_bf16 v[60:63], a[216:219], v[108:111], v[60:63]
v_mfma_f32_16x16x32_bf16 v[0:3], a[220:223], v[104:107], v[0:3]
v_mfma_f32_16x16x32_bf16 v[4:7], a[220:223], v[108:111], v[4:7]
buffer_load_dwordx4 v227, s[16:19], s43 offen offset:3072 nt lds
v_mfma_f32_16x16x32_bf16 a[16:19], a[220:223], a[28:31], a[16:19]
s_waitcnt lgkmcnt(0)
v_mfma_f32_16x16x32_bf16 v[8:11], a[224:227], v[104:107], v[8:11]
v_mfma_f32_16x16x32_bf16 v[12:15], a[224:227], v[108:111], v[12:15]
v_mfma_f32_16x16x32_bf16 a[20:23], a[224:227], a[28:31], a[20:23]
v_mov_b32 v184, v177
s_mov_b32 s3, 0x4e800000
s_mov_b32 s7, 0x30800000
v_permlane16_swap_b32 v177, v184
v_add_f32 v177, v177, v184
v_max_f32 v145, v176, v144
v_mov_b32 v184, v177
v_cmp_nle_f32 s[66:67], s7, v176
v_cmp_nle_f32 vcc, s7, v144
v_permlane32_swap_b32 v177, v184
v_add_f32 v177, v177, v184
s_or_b64 s[66:67], vcc, s[66:67]
v_max_f32 v145, v145, v177
v_cmp_nge_f32 vcc, s3, v145
ds_write_b32 v240, v177 offset:45056
s_or_b64 vcc, vcc, s[66:67]
s_cselect_b32 s3, 1, 0
v_mov_b32 v184, s3
ds_write_b32 v240, v184 offset:45312
s_add_u32 s6, s38, 1
s_and_b32 s6, s6, 3
s_lshl_b32 s6, s6, 10
s_add_u32 s6, s6, s57
v_pk_mul_f32 v[16:17], v[16:17], v[180:181] op_sel_hi:[1,0]
v_pk_mul_f32 v[18:19], v[18:19], v[180:181] op_sel_hi:[1,0]
v_pk_mul_f32 v[24:25], v[24:25], v[180:181] op_sel_hi:[1,0]
v_pk_mul_f32 v[26:27], v[26:27], v[180:181] op_sel_hi:[1,0]
v_cvt_pk_bf16_f32 v72, v16, v17
v_cvt_pk_bf16_f32 v73, v18, v19
v_cvt_pk_bf16_f32 v74, v24, v25
v_cvt_pk_bf16_f32 v75, v26, v27
buffer_store_dwordx4 v[72:75], v237, s[24:27], s6 offen sc1
v_pk_mul_f32 v[20:21], v[20:21], v[182:183] op_sel_hi:[1,0]
v_pk_mul_f32 v[22:23], v[22:23], v[182:183] op_sel_hi:[1,0]
v_pk_mul_f32 v[28:29], v[28:29], v[182:183] op_sel_hi:[1,0]
v_pk_mul_f32 v[30:31], v[30:31], v[182:183] op_sel_hi:[1,0]
v_cvt_pk_bf16_f32 v76, v20, v21
v_cvt_pk_bf16_f32 v77, v22, v23
v_cvt_pk_bf16_f32 v78, v28, v29
v_cvt_pk_bf16_f32 v79, v30, v31
buffer_store_dwordx4 v[76:79], v238, s[24:27], s6 offen sc1
s_add_u32 s6, s38, 2
s_and_b32 s6, s6, 3
s_lshl_b32 s6, s6, 10
s_add_u32 s6, s6, s57
v_pk_mul_f32 v[32:33], v[32:33], v[180:181] op_sel_hi:[1,0]
v_pk_mul_f32 v[34:35], v[34:35], v[180:181] op_sel_hi:[1,0]
v_pk_mul_f32 v[40:41], v[40:41], v[180:181] op_sel_hi:[1,0]
v_pk_mul_f32 v[42:43], v[42:43], v[180:181] op_sel_hi:[1,0]
v_cvt_pk_bf16_f32 v80, v32, v33
v_cvt_pk_bf16_f32 v81, v34, v35
v_cvt_pk_bf16_f32 v82, v40, v41
v_cvt_pk_bf16_f32 v83, v42, v43
buffer_store_dwordx4 v[80:83], v237, s[24:27], s6 offen sc1
v_pk_mul_f32 v[36:37], v[36:37], v[182:183] op_sel_hi:[1,0]
v_pk_mul_f32 v[38:39], v[38:39], v[182:183] op_sel_hi:[1,0]
v_pk_mul_f32 v[44:45], v[44:45], v[182:183] op_sel_hi:[1,0]
v_pk_mul_f32 v[46:47], v[46:47], v[182:183] op_sel_hi:[1,0]
v_cvt_pk_bf16_f32 v84, v36, v37
v_cvt_pk_bf16_f32 v85, v38, v39
v_cvt_pk_bf16_f32 v86, v44, v45
v_cvt_pk_bf16_f32 v87, v46, v47
buffer_store_dwordx4 v[84:87], v238, s[24:27], s6 offen sc1
s_cmp_lg_u32 s38, 0
s_cbranch_scc1 INITE10
s_mov_b32 s6, 0x20000
INITL10:
v_readfirstlane_b32 s3, v254
s_nop 0
s_cmp_lg_u32 s3, 0
s_cbranch_scc1 INITE10
global_load_dword v254, v253, s[36:37] sc1
s_waitcnt vmcnt(0)
s_sub_u32 s6, s6, 1
s_cbranch_scc0 INITL10
INITE10:
s_waitcnt lgkmcnt(0)
s_barrier
ds_read_b128 v[96:99], v241 offset:45056
ds_read_b128 v[100:103], v241 offset:45312
s_add_u32 s6, s38, 3
s_and_b32 s6, s6, 3
s_lshl_b32 s6, s6, 10
s_add_u32 s6, s6, s57
v_pk_mul_f32 v[48:49], v[48:49], v[180:181] op_sel_hi:[1,0]
v_pk_mul_f32 v[50:51], v[50:51], v[180:181] op_sel_hi:[1,0]
v_pk_mul_f32 v[56:57], v[56:57], v[180:181] op_sel_hi:[1,0]
v_pk_mul_f32 v[58:59], v[58:59], v[180:181] op_sel_hi:[1,0]
v_cvt_pk_bf16_f32 v88, v48, v49
v_cvt_pk_bf16_f32 v89, v50, v51
v_cvt_pk_bf16_f32 v90, v56, v57
v_cvt_pk_bf16_f32 v91, v58, v59
buffer_store_dwordx4 v[88:91], v237, s[24:27], s6 offen sc1
v_pk_mul_f32 v[52:53], v[52:53], v[182:183] op_sel_hi:[1,0]
v_pk_mul_f32 v[54:55], v[54:55], v[182:183] op_sel_hi:[1,0]
v_pk_mul_f32 v[60:61], v[60:61], v[182:183] op_sel_hi:[1,0]
v_pk_mul_f32 v[62:63], v[62:63], v[182:183] op_sel_hi:[1,0]
v_cvt_pk_bf16_f32 v92, v52, v53
v_cvt_pk_bf16_f32 v93, v54, v55
v_cvt_pk_bf16_f32 v94, v60, v61
v_cvt_pk_bf16_f32 v95, v62, v63
buffer_store_dwordx4 v[92:95], v238, s[24:27], s6 offen sc1
s_add_u32 s6, s38, 0
s_and_b32 s6, s6, 3
s_lshl_b32 s6, s6, 10
s_add_u32 s6, s6, s57
v_pk_mul_f32 v[0:1], v[0:1], v[180:181] op_sel_hi:[1,0]
v_pk_mul_f32 v[2:3], v[2:3], v[180:181] op_sel_hi:[1,0]
v_pk_mul_f32 v[8:9], v[8:9], v[180:181] op_sel_hi:[1,0]
v_pk_mul_f32 v[10:11], v[10:11], v[180:181] op_sel_hi:[1,0]
v_cvt_pk_bf16_f32 v64, v0, v1
v_cvt_pk_bf16_f32 v65, v2, v3
v_cvt_pk_bf16_f32 v66, v8, v9
v_cvt_pk_bf16_f32 v67, v10, v11
buffer_store_dwordx4 v[64:67], v237, s[24:27], s6 offen sc1
v_pk_mul_f32 v[4:5], v[4:5], v[182:183] op_sel_hi:[1,0]
v_pk_mul_f32 v[6:7], v[6:7], v[182:183] op_sel_hi:[1,0]
v_pk_mul_f32 v[12:13], v[12:13], v[182:183] op_sel_hi:[1,0]
v_pk_mul_f32 v[14:15], v[14:15], v[182:183] op_sel_hi:[1,0]
v_cvt_pk_bf16_f32 v68, v4, v5
v_cvt_pk_bf16_f32 v69, v6, v7
v_cvt_pk_bf16_f32 v70, v12, v13
v_cvt_pk_bf16_f32 v71, v14, v15
buffer_store_dwordx4 v[68:71], v238, s[24:27], s6 offen sc1
v_accvgpr_read_b32 v16, a16
v_accvgpr_read_b32 v17, a17
v_accvgpr_read_b32 v18, a18
v_accvgpr_read_b32 v19, a19
v_accvgpr_read_b32 v20, a20
v_accvgpr_read_b32 v21, a21
v_accvgpr_read_b32 v22, a22
v_accvgpr_read_b32 v23, a23
s_waitcnt lgkmcnt(1)
v_add_f32 v96, v96, v97
v_add_f32 v98, v98, v99
s_waitcnt lgkmcnt(0)
v_or_b32 v100, v100, v101
v_add_f32 v96, v96, v98
v_or3_b32 v100, v100, v102, v103
v_cmp_nle_f32 vcc, s7, v96
v_cmp_ne_u32 s[66:67], 0, v100
v_rcp_f32 v98, v96
s_lshr_b32 s6, s39, 2
s_add_u32 s6, s6, s53
s_or_b64 vcc, vcc, s[66:67]
s_cselect_b32 s3, 1, 0
s_cmp_gt_u32 s3, s54
s_cbranch_scc1 SLOW10
v_mul_f32 v16, v16, v98
v_mul_f32 v17, v17, v98
v_mul_f32 v18, v18, v98
v_mul_f32 v19, v19, v98
v_mul_f32 v20, v20, v98
v_mul_f32 v21, v21, v98
v_mul_f32 v22, v22, v98
v_mul_f32 v23, v23, v98
v_cvt_pk_bf16_f32 v16, v16, v17
v_cvt_pk_bf16_f32 v17, v18, v19
v_cvt_pk_bf16_f32 v18, v20, v21
v_cvt_pk_bf16_f32 v19, v22, v23
s_add_u32 s6, s6, 32768
buffer_store_dwordx4 v[16:19], v237, s[24:27], s6 offen sc1
s_add_u32 s41, s41, 131072
s_add_u32 s53, s53, 36864
s_waitcnt vmcnt(25)
s_barrier
ds_read_b128 a[180:183], v186 offset:0
ds_read_b128 a[184:187], v187 offset:0
ds_read_b128 a[188:191], v190 offset:0
ds_read_b128 a[192:195], v188 offset:0
ds_read_b128 a[196:199], v191 offset:0
ds_read_b128 a[200:203], v189 offset:0
ds_read_b128 a[204:207], v192 offset:0
v_accvgpr_read_b32 v112, a48
v_accvgpr_read_b32 v113, a49
v_accvgpr_read_b32 v114, a50
v_accvgpr_read_b32 v115, a51
v_accvgpr_read_b32 v116, a52
v_accvgpr_read_b32 v117, a53
v_accvgpr_read_b32 v118, a54
v_accvgpr_read_b32 v119, a55
v_accvgpr_read_b32 v120, a56
v_accvgpr_read_b32 v121, a57
v_accvgpr_read_b32 v122, a58
v_accvgpr_read_b32 v123, a59
v_accvgpr_read_b32 v124, a60
v_accvgpr_read_b32 v125, a61
v_accvgpr_read_b32 v126, a62
v_accvgpr_read_b32 v127, a63
v_accvgpr_read_b32 v128, a64
v_accvgpr_read_b32 v129, a65
v_accvgpr_read_b32 v130, a66
v_accvgpr_read_b32 v131, a67
v_accvgpr_read_b32 v132, a68
v_accvgpr_read_b32 v133, a69
v_accvgpr_read_b32 v134, a70
v_accvgpr_read_b32 v135, a71
v_accvgpr_read_b32 v136, a72
v_accvgpr_read_b32 v137, a73
v_accvgpr_read_b32 v138, a74
v_accvgpr_read_b32 v139, a75
v_accvgpr_read_b32 v140, a76
v_accvgpr_read_b32 v141, a77
v_accvgpr_read_b32 v142, a78
v_accvgpr_read_b32 v143, a79
v_accvgpr_mov_b32 a0, a80
v_accvgpr_mov_b32 a1, a81
v_accvgpr_mov_b32 a2, a82
v_accvgpr_mov_b32 a3, a83
v_accvgpr_mov_b32 a4, a84
v_accvgpr_mov_b32 a5, a85
v_accvgpr_mov_b32 a6, a86
v_accvgpr_mov_b32 a7, a87
v_accvgpr_mov_b32 a8, a88
v_accvgpr_mov_b32 a9, a89
v_accvgpr_mov_b32 a10, a90
v_accvgpr_mov_b32 a11, a91
v_accvgpr_mov_b32 a12, a92
v_accvgpr_mov_b32 a13, a93
v_accvgpr_mov_b32 a14, a94
v_accvgpr_mov_b32 a15, a95
v_mov_b32 v156, 0
v_mov_b32 v157, 0
v_mov_b32 v158, 0
v_mov_b32 v159, 0
v_mov_b32 v160, 0
v_mov_b32 v161, 0
v_mov_b32 v162, 0
v_mov_b32 v163, 0
v_mov_b32 v164, 0
v_mov_b32 v165, 0
v_mov_b32 v166, 0
v_mov_b32 v167, 0
s_mov_b32 s54, 0
ATT11:
s_add_u32 s55, s47, s50
v_mov_b32 v177, 0
s_waitcnt lgkmcnt(3)
v_mfma_f32_16x16x32_bf16 v[64:67], a[180:183], v[112:115], v[156:159]
ds_read_b128 a[208:211], v186 offset:4096
v_mfma_f32_16x16x32_bf16 v[72:75], a[180:183], v[128:131], v[160:163]
v_mfma_f32_16x16x32_bf16 v[64:67], a[184:187], v[116:119], v[64:67]
ds_read_b128 a[212:215], v193 offset:0
v_mfma_f32_16x16x32_bf16 v[72:75], a[184:187], v[132:135], v[72:75]
v_mfma_f32_16x16x32_bf16 v[144:147], a[188:191], a[0:3], v[164:167]
ds_read_b128 a[216:219], v187 offset:4096
v_mfma_f32_16x16x32_bf16 v[64:67], a[192:195], v[120:123], v[64:67]
ds_read_b128 a[220:223], v188 offset:4096
v_mfma_f32_16x16x32_bf16 v[72:75], a[192:195], v[136:139], v[72:75]
s_waitcnt lgkmcnt(3)
v_mfma_f32_16x16x32_bf16 v[144:147], a[196:199], a[4:7], v[144:147]
ds_read_b128 a[224:227], v189 offset:4096
v_mfma_f32_16x16x32_bf16 v[64:67], a[200:203], v[124:127], v[64:67]
ds_read_b128 a[180:183], v186 offset:8192
v_mfma_f32_16x16x32_bf16 v[72:75], a[200:203], v[140:143], v[72:75]
v_mfma_f32_16x16x32_bf16 v[144:147], a[204:207], a[8:11], v[144:147]
ds_read_b128 a[184:187], v187 offset:8192
v_mfma_f32_16x16x32_bf16 v[68:71], a[208:211], v[112:115], v[156:159]
ds_read_b128 a[188:191], v188 offset:8192
v_mfma_f32_16x16x32_bf16 v[76:79], a[208:211], v[128:131], v[160:163]
s_waitcnt lgkmcnt(3)
v_mfma_f32_16x16x32_bf16 v[144:147], a[212:215], a[12:15], v[144:147]
ds_read_b128 a[192:195], v189 offset:8192
v_mfma_f32_16x16x32_bf16 v[68:71], a[216:219], v[116:119], v[68:71]
ds_read_b128 a[196:199], v186 offset:12288
v_mfma_f32_16x16x32_bf16 v[76:79], a[216:219], v[132:135], v[76:79]
v_mfma_f32_16x16x32_bf16 v[68:71], a[220:223], v[120:123], v[68:71]
ds_read_b128 a[200:203], v187 offset:12288
v_mfma_f32_16x16x32_bf16 v[76:79], a[220:223], v[136:139], v[76:79]
v_mfma_f32_16x16x32_bf16 v[68:71], a[224:227], v[124:127], v[68:71]
ds_read_b128 a[204:207], v188 offset:12288
v_exp_f32 v144, v144
v_mfma_f32_16x16x32_bf16 v[76:79], a[224:227], v[140:143], v[76:79]
v_add_f32 v177, v177, v144
s_waitcnt lgkmcnt(4)
v_mfma_f32_16x16x32_bf16 v[80:83], a[180:183], v[112:115], v[156:159]
ds_read_b128 a[208:211], v189 offset:12288
v_exp_f32 v145, v145
v_exp_f32 v146, v146
v_cvt_pk_bf16_f32 v152, v144, v145
v_exp_f32 v147, v147
v_add_f32 v177, v177, v145
v_cvt_pk_bf16_f32 v153, v146, v147
v_mfma_f32_16x16x32_bf16 v[88:91], a[180:183], v[128:131], v[160:163]
ds_write_b64 v202, v[152:153] offset:0
v_add_f32 v177, v177, v146
v_mfma_f32_16x16x32_bf16 v[80:83], a[184:187], v[116:119], v[80:83]
v_add_f32 v177, v177, v147
v_mfma_f32_16x16x32_bf16 v[88:91], a[184:187], v[132:135], v[88:91]
v_mfma_f32_16x16x32_bf16 v[80:83], a[188:191], v[120:123], v[80:83]
s_waitcnt vmcnt(0) lgkmcnt(0)
s_barrier
v_mfma_f32_16x16x32_bf16 v[88:91], a[188:191], v[136:139], v[88:91]
ds_read_b128 a[212:215], v186 offset:16384
s_waitcnt lgkmcnt(3)
v_mfma_f32_16x16x32_bf16 v[80:83], a[192:195], v[124:127], v[80:83]
ds_read_b128 a[216:219], v187 offset:16384
s_cmp_lg_u32 s54, 0
s_cbranch_scc1 SKP13
s_lshl_b32 s66, s50, 2
s_add_u32 s66, s66, s38
s_lshl_b32 s66, s66, 2
s_add_u32 s66, s66, s62
v_mov_b32 v185, 1
s_mov_b64 exec, 1
buffer_store_dword v185, v243, s[24:27], s66 offen sc1
s_mov_b64 exec, -1
SKP13:
v_mfma_f32_16x16x32_bf16 v[88:91], a[192:195], v[140:143], v[88:91]
ds_read_b128 a[220:223], v190 offset:16384
s_add_u32 m0, s39, 49152
v_mfma_f32_16x16x32_bf16 v[84:87], a[196:199], v[112:115], v[156:159]
ds_read_b64_tr_b16 a[224:225], v196 offset:0
s_add_u32 s42, s42, 16384
v_mfma_f32_16x16x32_bf16 v[92:95], a[196:199], v[128:131], v[160:163]
ds_read_b64_tr_b16 a[226:227], v196 offset:4096
buffer_load_dwordx4 v222, s[12:15], s42 offen nt lds
v_mfma_f32_16x16x32_bf16 v[84:87], a[200:203], v[116:119], v[84:87]
ds_read_b128 a[180:183], v191 offset:16384
v_exp_f32 v64, v64
v_mfma_f32_16x16x32_bf16 v[92:95], a[200:203], v[132:135], v[92:95]
v_exp_f32 v65, v65
s_waitcnt lgkmcnt(5)
v_mfma_f32_16x16x32_bf16 v[84:87], a[204:207], v[120:123], v[84:87]
ds_read_b128 a[184:187], v188 offset:16384
v_cvt_pk_bf16_f32 v96, v64, v65
v_mfma_f32_16x16x32_bf16 v[92:95], a[204:207], v[136:139], v[92:95]
buffer_load_dwordx4 v223, s[12:15], s42 offen offset:1024 nt lds
v_mfma_f32_16x16x32_bf16 v[84:87], a[208:211], v[124:127], v[84:87]
ds_read_b128 a[188:191], v192 offset:16384
v_exp_f32 v66, v66
v_mfma_f32_16x16x32_bf16 v[92:95], a[208:211], v[140:143], v[92:95]
v_exp_f32 v67, v67
v_exp_f32 v68, v68
v_cvt_pk_bf16_f32 v97, v66, v67
v_exp_f32 v69, v69
v_exp_f32 v70, v70
v_cvt_pk_bf16_f32 v98, v68, v69
v_exp_f32 v71, v71
v_exp_f32 v72, v72
v_cvt_pk_bf16_f32 v99, v70, v71
v_exp_f32 v73, v73
v_exp_f32 v74, v74
v_cvt_pk_bf16_f32 v100, v72, v73
v_exp_f32 v75, v75
v_exp_f32 v76, v76
v_cvt_pk_bf16_f32 v101, v74, v75
v_exp_f32 v77, v77
v_exp_f32 v78, v78
v_cvt_pk_bf16_f32 v102, v76, v77
v_exp_f32 v79, v79
s_nop 0
v_cvt_pk_bf16_f32 v103, v78, v79
v_mfma_f32_16x16x32_bf16 v[64:67], a[212:215], v[112:115], v[156:159]
ds_read_b64_tr_b16 a[192:193], v197 offset:0
v_exp_f32 v80, v80
v_mfma_f32_16x16x32_bf16 v[72:75], a[212:215], v[128:131], v[160:163]
ds_read_b64_tr_b16 a[194:195], v197 offset:4096
s_waitcnt lgkmcnt(4)
v_mfma_f32_16x16x32_bf16 v[64:67], a[216:219], v[116:119], v[64:67]
ds_read_b128 a[196:199], v193 offset:16384
v_exp_f32 v81, v81
v_mfma_f32_16x16x32_bf16 v[72:75], a[216:219], v[132:135], v[72:75]
ds_read_b128 a[24:27], v203 offset:0
v_cvt_pk_bf16_f32 v104, v80, v81
v_mfma_f32_16x16x32_bf16 v[144:147], a[220:223], a[0:3], v[164:167]
ds_read_b128 a[200:203], v189 offset:16384
v_exp_f32 v82, v82
v_mfma_f32_16x16x32_bf16 v[16:19], a[224:227], v[96:99], 0
ds_read_b64_tr_b16 a[204:205], v198 offset:0
v_exp_f32 v83, v83
v_mfma_f32_16x16x32_bf16 v[20:23], a[224:227], v[100:103], 0
ds_read_b64_tr_b16 a[206:207], v198 offset:4096
buffer_load_dwordx4 v224, s[12:15], s42 offen offset:2048 nt lds
v_mfma_f32_16x16x32_bf16 v[144:147], a[180:183], a[4:7], v[144:147]
ds_read_b128 a[208:211], v186 offset:20480
s_waitcnt lgkmcnt(5)
v_mfma_f32_16x16x32_bf16 v[64:67], a[184:187], v[120:123], v[64:67]
ds_read_b64_tr_b16 a[212:213], v199 offset:0
v_cvt_pk_bf16_f32 v105, v82, v83
v_mfma_f32_16x16x32_bf16 v[72:75], a[184:187], v[136:139], v[72:75]
ds_read_b64_tr_b16 a[214:215], v199 offset:4096
v_exp_f32 v84, v84
v_mfma_f32_16x16x32_bf16 v[144:147], a[188:191], a[8:11], v[144:147]
ds_read_b128 a[216:219], v187 offset:20480
v_exp_f32 v85, v85
v_mfma_f32_16x16x32_bf16 v[24:27], a[192:195], v[96:99], 0
ds_read_b64_tr_b16 a[220:221], v200 offset:0
v_cvt_pk_bf16_f32 v106, v84, v85
v_mfma_f32_16x16x32_bf16 v[28:31], a[192:195], v[100:103], 0
ds_read_b64_tr_b16 a[222:223], v200 offset:4096
v_exp_f32 v86, v86
v_mfma_f32_16x16x32_bf16 v[144:147], a[196:199], a[12:15], v[144:147]
ds_read_b128 a[224:227], v188 offset:20480
s_waitcnt lgkmcnt(6)
v_mfma_f32_16x16x32_bf16 v[64:67], a[200:203], v[124:127], v[64:67]
ds_read_b64_tr_b16 a[180:181], v201 offset:0
v_exp_f32 v87, v87
v_mfma_f32_16x16x32_bf16 v[72:75], a[200:203], v[140:143], v[72:75]
ds_read_b64_tr_b16 a[182:183], v201 offset:4096
buffer_load_dwordx4 v225, s[12:15], s42 offen offset:3072 nt lds
v_mfma_f32_16x16x32_bf16 v[32:35], a[204:207], v[96:99], 0
ds_read_b128 a[28:31], v203 offset:1024
v_cvt_pk_bf16_f32 v107, v86, v87
v_mfma_f32_16x16x32_bf16 v[36:39], a[204:207], v[100:103], 0
ds_read_b128 a[184:187], v189 offset:20480
v_exp_f32 v88, v88
v_mfma_f32_16x16x32_bf16 v[68:71], a[208:211], v[112:115], v[156:159]
ds_read_b64_tr_b16 a[188:189], v194 offset:0
v_exp_f32 v89, v89
v_mfma_f32_16x16x32_bf16 v[76:79], a[208:211], v[128:131], v[160:163]
ds_read_b64_tr_b16 a[190:191], v194 offset:4096
s_waitcnt lgkmcnt(7)
v_mfma_f32_16x16x32_bf16 v[40:43], a[212:215], v[96:99], 0
ds_read_b64_tr_b16 a[192:193], v195 offset:0
v_cvt_pk_bf16_f32 v108, v88, v89
v_mfma_f32_16x16x32_bf16 v[44:47], a[212:215], v[100:103], 0
ds_read_b64_tr_b16 a[194:195], v195 offset:4096
v_exp_f32 v90, v90
v_mfma_f32_16x16x32_bf16 v[68:71], a[216:219], v[116:119], v[68:71]
ds_read_b128 a[196:199], v186 offset:24576
v_exp_f32 v91, v91
v_mfma_f32_16x16x32_bf16 v[76:79], a[216:219], v[132:135], v[76:79]
v_exp_f32 v92, v92
v_mfma_f32_16x16x32_bf16 v[48:51], a[220:223], v[96:99], 0
ds_read_b128 a[200:203], v187 offset:24576
s_add_u32 m0, s39, 98304
v_mfma_f32_16x16x32_bf16 v[52:55], a[220:223], v[100:103], 0
s_add_u32 s43, s43, 16384
s_waitcnt lgkmcnt(6)
v_mfma_f32_16x16x32_bf16 v[68:71], a[224:227], v[120:123], v[68:71]
ds_read_b64_tr_b16 a[204:205], v196 offset:8192
buffer_load_dwordx4 v226, s[16:19], s43 offen nt lds
v_mfma_f32_16x16x32_bf16 v[76:79], a[224:227], v[136:139], v[76:79]
ds_read_b64_tr_b16 a[206:207], v196 offset:12288
v_cvt_pk_bf16_f32 v109, v90, v91
v_mfma_f32_16x16x32_bf16 v[56:59], a[180:183], v[96:99], 0
ds_read_b128 a[208:211], v188 offset:24576
v_exp_f32 v93, v93
v_mfma_f32_16x16x32_bf16 v[60:63], a[180:183], v[100:103], 0
v_exp_f32 v94, v94
v_mfma_f32_16x16x32_bf16 a[232:235], a[228:231], v[96:99], 0
v_cvt_pk_bf16_f32 v110, v92, v93
v_exp_f32 v95, v95
v_mfma_f32_16x16x32_bf16 v[68:71], a[184:187], v[124:127], v[68:71]
ds_read_b64_tr_b16 a[212:213], v197 offset:8192
v_cvt_pk_bf16_f32 v111, v94, v95
v_mfma_f32_16x16x32_bf16 v[76:79], a[184:187], v[140:143], v[76:79]
ds_read_b64_tr_b16 a[214:215], v197 offset:12288
s_waitcnt lgkmcnt(7)
v_mfma_f32_16x16x32_bf16 v[0:3], a[188:191], v[96:99], 0
ds_read_b128 a[216:219], v189 offset:24576
buffer_load_dwordx4 v227, s[16:19], s43 offen offset:1024 nt lds
v_mfma_f32_16x16x32_bf16 v[4:7], a[188:191], v[100:103], 0
v_exp_f32 v144, v144
v_mfma_f32_16x16x32_bf16 a[16:19], a[188:191], a[24:27], 0
v_exp_f32 v145, v145
v_mfma_f32_16x16x32_bf16 a[236:239], a[228:231], v[100:103], 0
v_exp_f32 v146, v146
v_mfma_f32_16x16x32_bf16 v[8:11], a[192:195], v[96:99], 0
ds_read_b64_tr_b16 a[220:221], v198 offset:8192
v_cvt_pk_bf16_f32 v152, v144, v145
v_mfma_f32_16x16x32_bf16 v[12:15], a[192:195], v[100:103], 0
ds_read_b64_tr_b16 a[222:223], v198 offset:12288
v_add_f32 v177, v177, v144
v_mfma_f32_16x16x32_bf16 a[20:23], a[192:195], a[24:27], 0
v_add_f32 v177, v177, v145
s_waitcnt lgkmcnt(6)
v_mfma_f32_16x16x32_bf16 v[80:83], a[196:199], v[112:115], v[156:159]
ds_read_b128 a[224:227], v186 offset:28672
v_add_f32 v177, v177, v146
v_mfma_f32_16x16x32_bf16 v[88:91], a[196:199], v[128:131], v[160:163]
v_exp_f32 v147, v147
v_mfma_f32_16x16x32_bf16 v[80:83], a[200:203], v[116:119], v[80:83]
ds_read_b64_tr_b16 a[180:181], v199 offset:8192
buffer_load_dwordx4 v226, s[16:19], s43 offen offset:2048 nt lds
v_mfma_f32_16x16x32_bf16 v[88:91], a[200:203], v[132:135], v[88:91]
ds_read_b64_tr_b16 a[182:183], v199 offset:12288
v_cvt_pk_bf16_f32 v153, v146, v147
v_mfma_f32_16x16x32_bf16 v[16:19], a[204:207], v[104:107], v[16:19]
ds_read_b128 a[184:187], v187 offset:28672
ds_write_b64 v202, v[152:153] offset:2048
v_mfma_f32_16x16x32_bf16 v[20:23], a[204:207], v[108:111], v[20:23]
v_add_f32 v177, v177, v147
s_waitcnt lgkmcnt(6)
v_mfma_f32_16x16x32_bf16 v[80:83], a[208:211], v[120:123], v[80:83]
ds_read_b64_tr_b16 a[188:189], v200 offset:8192
v_exp_f32 v64, v64
v_mfma_f32_16x16x32_bf16 v[88:91], a[208:211], v[136:139], v[88:91]
ds_read_b64_tr_b16 a[190:191], v200 offset:12288
v_exp_f32 v65, v65
v_mfma_f32_16x16x32_bf16 v[24:27], a[212:215], v[104:107], v[24:27]
ds_read_b128 a[192:195], v188 offset:28672
v_cvt_pk_bf16_f32 v96, v64, v65
v_mfma_f32_16x16x32_bf16 v[28:31], a[212:215], v[108:111], v[28:31]
v_exp_f32 v66, v66
v_mfma_f32_16x16x32_bf16 v[80:83], a[216:219], v[124:127], v[80:83]
ds_read_b64_tr_b16 a[196:197], v201 offset:8192
v_exp_f32 v67, v67
v_mfma_f32_16x16x32_bf16 v[88:91], a[216:219], v[140:143], v[88:91]
ds_read_b64_tr_b16 a[198:199], v201 offset:12288
s_waitcnt lgkmcnt(6)
v_mfma_f32_16x16x32_bf16 v[32:35], a[220:223], v[104:107], v[32:35]
ds_read_b128 a[200:203], v189 offset:28672
buffer_load_dwordx4 v227, s[16:19], s43 offen offset:3072 nt lds
v_mfma_f32_16x16x32_bf16 v[36:39], a[220:223], v[108:111], v[36:39]
v_exp_f32 v68, v68
v_mfma_f32_16x16x32_bf16 v[84:87], a[224:227], v[112:115], v[156:159]
ds_read_b64_tr_b16 a[204:205], v194 offset:8192
v_cvt_pk_bf16_f32 v97, v66, v67
v_mfma_f32_16x16x32_bf16 v[92:95], a[224:227], v[128:131], v[160:163]
ds_read_b64_tr_b16 a[206:207], v194 offset:12288
v_exp_f32 v69, v69
v_mfma_f32_16x16x32_bf16 v[40:43], a[180:183], v[104:107], v[40:43]
ds_read_b64_tr_b16 a[208:209], v195 offset:8192
v_cvt_pk_bf16_f32 v98, v68, v69
v_mfma_f32_16x16x32_bf16 v[44:47], a[180:183], v[108:111], v[44:47]
ds_read_b64_tr_b16 a[210:211], v195 offset:12288
s_waitcnt lgkmcnt(8)
v_mfma_f32_16x16x32_bf16 v[84:87], a[184:187], v[116:119], v[84:87]
v_exp_f32 v70, v70
v_mfma_f32_16x16x32_bf16 v[92:95], a[184:187], v[132:135], v[92:95]
v_exp_f32 v71, v71
v_mfma_f32_16x16x32_bf16 v[48:51], a[188:191], v[104:107], v[48:51]
s_barrier
v_mfma_f32_16x16x32_bf16 v[52:55], a[188:191], v[108:111], v[52:55]
ds_read_b128 a[212:215], v186 offset:32768
s_waitcnt lgkmcnt(5)
v_mfma_f32_16x16x32_bf16 v[84:87], a[192:195], v[120:123], v[84:87]
ds_read_b128 a[216:219], v187 offset:32768
s_add_u32 m0, s39, 0
v_mfma_f32_16x16x32_bf16 v[92:95], a[192:195], v[136:139], v[92:95]
ds_read_b128 a[220:223], v190 offset:32768
s_add_u32 s42, s42, 16384
v_mfma_f32_16x16x32_bf16 v[56:59], a[196:199], v[104:107], v[56:59]
ds_read_b64_tr_b16 a[224:225], v196 offset:16384
buffer_load_dwordx4 v222, s[12:15], s42 offen nt lds
v_mfma_f32_16x16x32_bf16 v[60:63], a[196:199], v[108:111], v[60:63]
ds_read_b64_tr_b16 a[226:227], v196 offset:20480
v_cvt_pk_bf16_f32 v99, v70, v71
v_mfma_f32_16x16x32_bf16 a[232:235], a[228:231], v[104:107], a[232:235]
v_exp_f32 v72, v72
v_mfma_f32_16x16x32_bf16 v[84:87], a[200:203], v[124:127], v[84:87]
ds_read_b128 a[180:183], v191 offset:32768
v_exp_f32 v73, v73
v_mfma_f32_16x16x32_bf16 v[92:95], a[200:203], v[140:143], v[92:95]
v_cvt_pk_bf16_f32 v100, v72, v73
s_waitcnt lgkmcnt(6)
v_mfma_f32_16x16x32_bf16 v[0:3], a[204:207], v[104:107], v[0:3]
ds_read_b128 a[184:187], v188 offset:32768
v_exp_f32 v74, v74
v_mfma_f32_16x16x32_bf16 v[4:7], a[204:207], v[108:111], v[4:7]
buffer_load_dwordx4 v223, s[12:15], s42 offen offset:1024 nt lds
v_mfma_f32_16x16x32_bf16 a[16:19], a[204:207], a[28:31], a[16:19]
v_exp_f32 v75, v75
v_mfma_f32_16x16x32_bf16 a[236:239], a[228:231], v[108:111], a[236:239]
v_exp_f32 v76, v76
v_mfma_f32_16x16x32_bf16 v[8:11], a[208:211], v[104:107], v[8:11]
ds_read_b128 a[188:191], v192 offset:32768
v_cvt_pk_bf16_f32 v101, v74, v75
v_mfma_f32_16x16x32_bf16 v[12:15], a[208:211], v[108:111], v[12:15]
v_exp_f32 v77, v77
v_mfma_f32_16x16x32_bf16 a[20:23], a[208:211], a[28:31], a[20:23]
v_cvt_pk_bf16_f32 v102, v76, v77
v_exp_f32 v78, v78
v_exp_f32 v79, v79
s_nop 0
v_cvt_pk_bf16_f32 v103, v78, v79
s_waitcnt lgkmcnt(3)
v_mfma_f32_16x16x32_bf16 v[64:67], a[212:215], v[112:115], v[156:159]
ds_read_b64_tr_b16 a[192:193], v197 offset:16384
v_exp_f32 v80, v80
v_mfma_f32_16x16x32_bf16 v[72:75], a[212:215], v[128:131], v[160:163]
ds_read_b64_tr_b16 a[194:195], v197 offset:20480
v_exp_f32 v81, v81
v_mfma_f32_16x16x32_bf16 v[64:67], a[216:219], v[116:119], v[64:67]
ds_read_b128 a[196:199], v193 offset:32768
v_cvt_pk_bf16_f32 v104, v80, v81
v_mfma_f32_16x16x32_bf16 v[72:75], a[216:219], v[132:135], v[72:75]
ds_read_b128 a[24:27], v203 offset:2048
buffer_load_dwordx4 v224, s[12:15], s42 offen offset:2048 nt lds
v_mfma_f32_16x16x32_bf16 v[144:147], a[220:223], a[0:3], v[164:167]
ds_read_b128 a[200:203], v189 offset:32768
v_exp_f32 v82, v82
v_mfma_f32_16x16x32_bf16 v[16:19], a[224:227], v[96:99], v[16:19]
ds_read_b64_tr_b16 a[204:205], v198 offset:16384
v_exp_f32 v83, v83
v_mfma_f32_16x16x32_bf16 v[20:23], a[224:227], v[100:103], v[20:23]
ds_read_b64_tr_b16 a[206:207], v198 offset:20480
s_waitcnt lgkmcnt(5)
v_mfma_f32_16x16x32_bf16 v[144:147], a[180:183], a[4:7], v[144:147]
ds_read_b128 a[208:211], v186 offset:36864
v_cvt_pk_bf16_f32 v105, v82, v83
v_mfma_f32_16x16x32_bf16 v[64:67], a[184:187], v[120:123], v[64:67]
ds_read_b64_tr_b16 a[212:213], v199 offset:16384
v_exp_f32 v84, v84
v_mfma_f32_16x16x32_bf16 v[72:75], a[184:187], v[136:139], v[72:75]
ds_read_b64_tr_b16 a[214:215], v199 offset:20480
v_exp_f32 v85, v85
v_mfma_f32_16x16x32_bf16 v[144:147], a[188:191], a[8:11], v[144:147]
ds_read_b128 a[216:219], v187 offset:36864
v_cvt_pk_bf16_f32 v106, v84, v85
v_mfma_f32_16x16x32_bf16 v[24:27], a[192:195], v[96:99], v[24:27]
ds_read_b64_tr_b16 a[220:221], v200 offset:16384
v_exp_f32 v86, v86
v_mfma_f32_16x16x32_bf16 v[28:31], a[192:195], v[100:103], v[28:31]
ds_read_b64_tr_b16 a[222:223], v200 offset:20480
s_waitcnt lgkmcnt(5)
v_mfma_f32_16x16x32_bf16 v[144:147], a[196:199], a[12:15], v[144:147]
ds_read_b128 a[224:227], v188 offset:36864
buffer_load_dwordx4 v225, s[12:15], s42 offen offset:3072 nt lds
v_mfma_f32_16x16x32_bf16 v[64:67], a[200:203], v[124:127], v[64:67]
ds_read_b64_tr_b16 a[180:181], v201 offset:16384
v_exp_f32 v87, v87
v_mfma_f32_16x16x32_bf16 v[72:75], a[200:203], v[140:143], v[72:75]
ds_read_b64_tr_b16 a[182:183], v201 offset:20480
v_cvt_pk_bf16_f32 v107, v86, v87
v_mfma_f32_16x16x32_bf16 v[32:35], a[204:207], v[96:99], v[32:35]
ds_read_b128 a[28:31], v203 offset:3072
v_exp_f32 v88, v88
v_mfma_f32_16x16x32_bf16 v[36:39], a[204:207], v[100:103], v[36:39]
ds_read_b128 a[184:187], v189 offset:36864
v_exp_f32 v89, v89
v_mfma_f32_16x16x32_bf16 v[68:71], a[208:211], v[112:115], v[156:159]
ds_read_b64_tr_b16 a[188:189], v194 offset:16384
v_cvt_pk_bf16_f32 v108, v88, v89
v_mfma_f32_16x16x32_bf16 v[76:79], a[208:211], v[128:131], v[160:163]
ds_read_b64_tr_b16 a[190:191], v194 offset:20480
s_waitcnt lgkmcnt(7)
v_mfma_f32_16x16x32_bf16 v[40:43], a[212:215], v[96:99], v[40:43]
ds_read_b64_tr_b16 a[192:193], v195 offset:16384
v_exp_f32 v90, v90
v_mfma_f32_16x16x32_bf16 v[44:47], a[212:215], v[100:103], v[44:47]
ds_read_b64_tr_b16 a[194:195], v195 offset:20480
v_exp_f32 v91, v91
v_mfma_f32_16x16x32_bf16 v[68:71], a[216:219], v[116:119], v[68:71]
ds_read_b128 a[196:199], v186 offset:40960
s_add_u32 m0, s39, 114688
v_mfma_f32_16x16x32_bf16 v[76:79], a[216:219], v[132:135], v[76:79]
s_add_u32 s43, s43, 16384
buffer_load_dwordx4 v226, s[16:19], s43 offen nt lds
v_mfma_f32_16x16x32_bf16 v[48:51], a[220:223], v[96:99], v[48:51]
ds_read_b128 a[200:203], v187 offset:40960
v_cvt_pk_bf16_f32 v109, v90, v91
v_mfma_f32_16x16x32_bf16 v[52:55], a[220:223], v[100:103], v[52:55]
v_exp_f32 v92, v92
s_waitcnt lgkmcnt(6)
v_mfma_f32_16x16x32_bf16 v[68:71], a[224:227], v[120:123], v[68:71]
ds_read_b64_tr_b16 a[204:205], v196 offset:24576
v_exp_f32 v93, v93
v_mfma_f32_16x16x32_bf16 v[76:79], a[224:227], v[136:139], v[76:79]
ds_read_b64_tr_b16 a[206:207], v196 offset:28672
v_cvt_pk_bf16_f32 v110, v92, v93
v_mfma_f32_16x16x32_bf16 v[56:59], a[180:183], v[96:99], v[56:59]
ds_read_b128 a[208:211], v188 offset:40960
v_exp_f32 v94, v94
v_mfma_f32_16x16x32_bf16 v[60:63], a[180:183], v[100:103], v[60:63]
v_exp_f32 v95, v95
v_mfma_f32_16x16x32_bf16 a[232:235], a[228:231], v[96:99], a[232:235]
v_cvt_pk_bf16_f32 v111, v94, v95
v_exp_f32 v144, v144
v_mfma_f32_16x16x32_bf16 v[68:71], a[184:187], v[124:127], v[68:71]
ds_read_b64_tr_b16 a[212:213], v197 offset:24576
buffer_load_dwordx4 v227, s[16:19], s43 offen offset:1024 nt lds
v_mfma_f32_16x16x32_bf16 v[76:79], a[184:187], v[140:143], v[76:79]
ds_read_b64_tr_b16 a[214:215], v197 offset:28672
s_waitcnt lgkmcnt(7)
v_mfma_f32_16x16x32_bf16 v[0:3], a[188:191], v[96:99], v[0:3]
ds_read_b128 a[216:219], v189 offset:40960
v_add_f32 v177, v177, v144
v_mfma_f32_16x16x32_bf16 v[4:7], a[188:191], v[100:103], v[4:7]
v_exp_f32 v145, v145
v_mfma_f32_16x16x32_bf16 a[16:19], a[188:191], a[24:27], a[16:19]
v_exp_f32 v146, v146
v_mfma_f32_16x16x32_bf16 a[236:239], a[228:231], v[100:103], a[236:239]
v_cvt_pk_bf16_f32 v152, v144, v145
v_add_f32 v177, v177, v145
v_mfma_f32_16x16x32_bf16 v[8:11], a[192:195], v[96:99], v[8:11]
ds_read_b64_tr_b16 a[220:221], v198 offset:24576
v_add_f32 v177, v177, v146
v_mfma_f32_16x16x32_bf16 v[12:15], a[192:195], v[100:103], v[12:15]
ds_read_b64_tr_b16 a[222:223], v198 offset:28672
v_exp_f32 v147, v147
v_mfma_f32_16x16x32_bf16 a[20:23], a[192:195], a[24:27], a[20:23]
v_cvt_pk_bf16_f32 v153, v146, v147
s_waitcnt lgkmcnt(6)
v_mfma_f32_16x16x32_bf16 v[80:83], a[196:199], v[112:115], v[156:159]
ds_read_b128 a[224:227], v186 offset:45056
ds_write_b64 v202, v[152:153] offset:0
v_mfma_f32_16x16x32_bf16 v[88:91], a[196:199], v[128:131], v[160:163]
buffer_load_dwordx4 v226, s[16:19], s43 offen offset:2048 nt lds
v_mfma_f32_16x16x32_bf16 v[80:83], a[200:203], v[116:119], v[80:83]
ds_read_b64_tr_b16 a[180:181], v199 offset:24576
v_add_f32 v177, v177, v147
v_mfma_f32_16x16x32_bf16 v[88:91], a[200:203], v[132:135], v[88:91]
ds_read_b64_tr_b16 a[182:183], v199 offset:28672
v_exp_f32 v64, v64
v_mfma_f32_16x16x32_bf16 v[16:19], a[204:207], v[104:107], v[16:19]
ds_read_b128 a[184:187], v187 offset:45056
v_exp_f32 v65, v65
v_mfma_f32_16x16x32_bf16 v[20:23], a[204:207], v[108:111], v[20:23]
v_cvt_pk_bf16_f32 v96, v64, v65
s_waitcnt lgkmcnt(6)
v_mfma_f32_16x16x32_bf16 v[80:83], a[208:211], v[120:123], v[80:83]
ds_read_b64_tr_b16 a[188:189], v200 offset:24576
v_exp_f32 v66, v66
v_mfma_f32_16x16x32_bf16 v[88:91], a[208:211], v[136:139], v[88:91]
ds_read_b64_tr_b16 a[190:191], v200 offset:28672
v_exp_f32 v67, v67
v_mfma_f32_16x16x32_bf16 v[24:27], a[212:215], v[104:107], v[24:27]
ds_read_b128 a[192:195], v188 offset:45056
v_cvt_pk_bf16_f32 v97, v66, v67
v_mfma_f32_16x16x32_bf16 v[28:31], a[212:215], v[108:111], v[28:31]
v_exp_f32 v68, v68
v_mfma_f32_16x16x32_bf16 v[80:83], a[216:219], v[124:127], v[80:83]
ds_read_b64_tr_b16 a[196:197], v201 offset:24576
buffer_load_dwordx4 v227, s[16:19], s43 offen offset:3072 nt lds
v_mfma_f32_16x16x32_bf16 v[88:91], a[216:219], v[140:143], v[88:91]
ds_read_b64_tr_b16 a[198:199], v201 offset:28672
s_waitcnt lgkmcnt(6)
v_mfma_f32_16x16x32_bf16 v[32:35], a[220:223], v[104:107], v[32:35]
ds_read_b128 a[200:203], v189 offset:45056
v_exp_f32 v69, v69
v_mfma_f32_16x16x32_bf16 v[36:39], a[220:223], v[108:111], v[36:39]
v_exp_f32 v70, v70
v_mfma_f32_16x16x32_bf16 v[84:87], a[224:227], v[112:115], v[156:159]
ds_read_b64_tr_b16 a[204:205], v194 offset:24576
v_cvt_pk_bf16_f32 v98, v68, v69
v_mfma_f32_16x16x32_bf16 v[92:95], a[224:227], v[128:131], v[160:163]
ds_read_b64_tr_b16 a[206:207], v194 offset:28672
v_exp_f32 v71, v71
v_mfma_f32_16x16x32_bf16 v[40:43], a[180:183], v[104:107], v[40:43]
ds_read_b64_tr_b16 a[208:209], v195 offset:24576
v_cvt_pk_bf16_f32 v99, v70, v71
v_mfma_f32_16x16x32_bf16 v[44:47], a[180:183], v[108:111], v[44:47]
ds_read_b64_tr_b16 a[210:211], v195 offset:28672
s_waitcnt lgkmcnt(8)
v_mfma_f32_16x16x32_bf16 v[84:87], a[184:187], v[116:119], v[84:87]
v_exp_f32 v72, v72
v_mfma_f32_16x16x32_bf16 v[92:95], a[184:187], v[132:135], v[92:95]
v_exp_f32 v73, v73
v_mfma_f32_16x16x32_bf16 v[48:51], a[188:191], v[104:107], v[48:51]
s_waitcnt vmcnt(8)
s_barrier
v_mfma_f32_16x16x32_bf16 v[52:55], a[188:191], v[108:111], v[52:55]
ds_read_b128 a[212:215], v186 offset:49152
s_waitcnt lgkmcnt(5)
v_mfma_f32_16x16x32_bf16 v[84:87], a[192:195], v[120:123], v[84:87]
ds_read_b128 a[216:219], v187 offset:49152
s_add_u32 m0, s39, 16384
v_mfma_f32_16x16x32_bf16 v[92:95], a[192:195], v[136:139], v[92:95]
ds_read_b128 a[220:223], v190 offset:49152
s_add_u32 s42, s42, 16384
v_mfma_f32_16x16x32_bf16 v[56:59], a[196:199], v[104:107], v[56:59]
ds_read_b64_tr_b16 a[224:225], v196 offset:32768
buffer_load_dwordx4 v222, s[12:15], s42 offen nt lds
v_mfma_f32_16x16x32_bf16 v[60:63], a[196:199], v[108:111], v[60:63]
ds_read_b64_tr_b16 a[226:227], v196 offset:36864
v_cvt_pk_bf16_f32 v100, v72, v73
v_mfma_f32_16x16x32_bf16 a[232:235], a[228:231], v[104:107], a[232:235]
v_exp_f32 v74, v74
v_mfma_f32_16x16x32_bf16 v[84:87], a[200:203], v[124:127], v[84:87]
ds_read_b128 a[180:183], v191 offset:49152
v_exp_f32 v75, v75
v_mfma_f32_16x16x32_bf16 v[92:95], a[200:203], v[140:143], v[92:95]
v_cvt_pk_bf16_f32 v101, v74, v75
s_waitcnt lgkmcnt(6)
v_mfma_f32_16x16x32_bf16 v[0:3], a[204:207], v[104:107], v[0:3]
ds_read_b128 a[184:187], v188 offset:49152
v_exp_f32 v76, v76
v_mfma_f32_16x16x32_bf16 v[4:7], a[204:207], v[108:111], v[4:7]
buffer_load_dwordx4 v223, s[12:15], s42 offen offset:1024 nt lds
v_mfma_f32_16x16x32_bf16 a[16:19], a[204:207], a[28:31], a[16:19]
v_exp_f32 v77, v77
v_mfma_f32_16x16x32_bf16 a[236:239], a[228:231], v[108:111], a[236:239]
v_exp_f32 v78, v78
v_mfma_f32_16x16x32_bf16 v[8:11], a[208:211], v[104:107], v[8:11]
ds_read_b128 a[188:191], v192 offset:49152
v_cvt_pk_bf16_f32 v102, v76, v77
v_mfma_f32_16x16x32_bf16 v[12:15], a[208:211], v[108:111], v[12:15]
v_exp_f32 v79, v79
v_mfma_f32_16x16x32_bf16 a[20:23], a[208:211], a[28:31], a[20:23]
v_cvt_pk_bf16_f32 v103, v78, v79
s_waitcnt lgkmcnt(3)
v_mfma_f32_16x16x32_bf16 v[64:67], a[212:215], v[112:115], v[156:159]
ds_read_b64_tr_b16 a[192:193], v197 offset:32768
v_exp_f32 v80, v80
v_mfma_f32_16x16x32_bf16 v[72:75], a[212:215], v[128:131], v[160:163]
ds_read_b64_tr_b16 a[194:195], v197 offset:36864
v_exp_f32 v81, v81
v_mfma_f32_16x16x32_bf16 v[64:67], a[216:219], v[116:119], v[64:67]
ds_read_b128 a[196:199], v193 offset:49152
v_cvt_pk_bf16_f32 v104, v80, v81
v_mfma_f32_16x16x32_bf16 v[72:75], a[216:219], v[132:135], v[72:75]
ds_read_b128 a[24:27], v203 offset:0
buffer_load_dwordx4 v224, s[12:15], s42 offen offset:2048 nt lds
v_mfma_f32_16x16x32_bf16 v[144:147], a[220:223], a[0:3], v[164:167]
ds_read_b128 a[200:203], v189 offset:49152
v_exp_f32 v82, v82
v_mfma_f32_16x16x32_bf16 v[16:19], a[224:227], v[96:99], v[16:19]
ds_read_b64_tr_b16 a[204:205], v198 offset:32768
v_exp_f32 v83, v83
v_mfma_f32_16x16x32_bf16 v[20:23], a[224:227], v[100:103], v[20:23]
ds_read_b64_tr_b16 a[206:207], v198 offset:36864
s_waitcnt lgkmcnt(5)
v_mfma_f32_16x16x32_bf16 v[144:147], a[180:183], a[4:7], v[144:147]
ds_read_b128 a[208:211], v186 offset:53248
v_cvt_pk_bf16_f32 v105, v82, v83
v_mfma_f32_16x16x32_bf16 v[64:67], a[184:187], v[120:123], v[64:67]
ds_read_b64_tr_b16 a[212:213], v199 offset:32768
v_exp_f32 v84, v84
v_mfma_f32_16x16x32_bf16 v[72:75], a[184:187], v[136:139], v[72:75]
ds_read_b64_tr_b16 a[214:215], v199 offset:36864
v_exp_f32 v85, v85
v_mfma_f32_16x16x32_bf16 v[144:147], a[188:191], a[8:11], v[144:147]
ds_read_b128 a[216:219], v187 offset:53248
v_cvt_pk_bf16_f32 v106, v84, v85
v_mfma_f32_16x16x32_bf16 v[24:27], a[192:195], v[96:99], v[24:27]
ds_read_b64_tr_b16 a[220:221], v200 offset:32768
v_exp_f32 v86, v86
v_mfma_f32_16x16x32_bf16 v[28:31], a[192:195], v[100:103], v[28:31]
ds_read_b64_tr_b16 a[222:223], v200 offset:36864
s_waitcnt lgkmcnt(5)
v_mfma_f32_16x16x32_bf16 v[144:147], a[196:199], a[12:15], v[144:147]
ds_read_b128 a[224:227], v188 offset:53248
buffer_load_dwordx4 v225, s[12:15], s42 offen offset:3072 nt lds
v_mfma_f32_16x16x32_bf16 v[64:67], a[200:203], v[124:127], v[64:67]
ds_read_b64_tr_b16 a[180:181], v201 offset:32768
v_exp_f32 v87, v87
v_mfma_f32_16x16x32_bf16 v[72:75], a[200:203], v[140:143], v[72:75]
ds_read_b64_tr_b16 a[182:183], v201 offset:36864
v_cvt_pk_bf16_f32 v107, v86, v87
v_mfma_f32_16x16x32_bf16 v[32:35], a[204:207], v[96:99], v[32:35]
ds_read_b128 a[28:31], v203 offset:1024
v_exp_f32 v88, v88
v_mfma_f32_16x16x32_bf16 v[36:39], a[204:207], v[100:103], v[36:39]
ds_read_b128 a[184:187], v189 offset:53248
v_exp_f32 v89, v89
v_mfma_f32_16x16x32_bf16 v[68:71], a[208:211], v[112:115], v[156:159]
ds_read_b64_tr_b16 a[188:189], v194 offset:32768
v_cvt_pk_bf16_f32 v108, v88, v89
v_mfma_f32_16x16x32_bf16 v[76:79], a[208:211], v[128:131], v[160:163]
ds_read_b64_tr_b16 a[190:191], v194 offset:36864
s_waitcnt lgkmcnt(7)
v_mfma_f32_16x16x32_bf16 v[40:43], a[212:215], v[96:99], v[40:43]
ds_read_b64_tr_b16 a[192:193], v195 offset:32768
v_exp_f32 v90, v90
v_mfma_f32_16x16x32_bf16 v[44:47], a[212:215], v[100:103], v[44:47]
ds_read_b64_tr_b16 a[194:195], v195 offset:36864
v_exp_f32 v91, v91
v_mfma_f32_16x16x32_bf16 v[68:71], a[216:219], v[116:119], v[68:71]
ds_read_b128 a[196:199], v186 offset:57344
s_add_u32 m0, s39, 65536
v_mfma_f32_16x16x32_bf16 v[76:79], a[216:219], v[132:135], v[76:79]
s_add_u32 s43, s43, 16384
buffer_load_dwordx4 v226, s[16:19], s43 offen nt lds
v_mfma_f32_16x16x32_bf16 v[48:51], a[220:223], v[96:99], v[48:51]
ds_read_b128 a[200:203], v187 offset:57344
v_cvt_pk_bf16_f32 v109, v90, v91
v_mfma_f32_16x16x32_bf16 v[52:55], a[220:223], v[100:103], v[52:55]
v_exp_f32 v92, v92
s_waitcnt lgkmcnt(6)
v_mfma_f32_16x16x32_bf16 v[68:71], a[224:227], v[120:123], v[68:71]
ds_read_b64_tr_b16 a[204:205], v196 offset:40960
v_exp_f32 v93, v93
v_mfma_f32_16x16x32_bf16 v[76:79], a[224:227], v[136:139], v[76:79]
ds_read_b64_tr_b16 a[206:207], v196 offset:45056
v_cvt_pk_bf16_f32 v110, v92, v93
v_mfma_f32_16x16x32_bf16 v[56:59], a[180:183], v[96:99], v[56:59]
ds_read_b128 a[208:211], v188 offset:57344
v_exp_f32 v94, v94
v_mfma_f32_16x16x32_bf16 v[60:63], a[180:183], v[100:103], v[60:63]
v_exp_f32 v95, v95
v_mfma_f32_16x16x32_bf16 a[232:235], a[228:231], v[96:99], a[232:235]
v_cvt_pk_bf16_f32 v111, v94, v95
v_exp_f32 v144, v144
v_mfma_f32_16x16x32_bf16 v[68:71], a[184:187], v[124:127], v[68:71]
ds_read_b64_tr_b16 a[212:213], v197 offset:40960
buffer_load_dwordx4 v227, s[16:19], s43 offen offset:1024 nt lds
v_mfma_f32_16x16x32_bf16 v[76:79], a[184:187], v[140:143], v[76:79]
ds_read_b64_tr_b16 a[214:215], v197 offset:45056
s_waitcnt lgkmcnt(7)
v_mfma_f32_16x16x32_bf16 v[0:3], a[188:191], v[96:99], v[0:3]
ds_read_b128 a[216:219], v189 offset:57344
v_add_f32 v177, v177, v144
v_mfma_f32_16x16x32_bf16 v[4:7], a[188:191], v[100:103], v[4:7]
v_exp_f32 v145, v145
v_mfma_f32_16x16x32_bf16 a[16:19], a[188:191], a[24:27], a[16:19]
v_exp_f32 v146, v146
v_mfma_f32_16x16x32_bf16 a[236:239], a[228:231], v[100:103], a[236:239]
v_cvt_pk_bf16_f32 v152, v144, v145
v_add_f32 v177, v177, v145
v_mfma_f32_16x16x32_bf16 v[8:11], a[192:195], v[96:99], v[8:11]
ds_read_b64_tr_b16 a[220:221], v198 offset:40960
v_add_f32 v177, v177, v146
v_mfma_f32_16x16x32_bf16 v[12:15], a[192:195], v[100:103], v[12:15]
ds_read_b64_tr_b16 a[222:223], v198 offset:45056
v_exp_f32 v147, v147
v_mfma_f32_16x16x32_bf16 a[20:23], a[192:195], a[24:27], a[20:23]
v_cvt_pk_bf16_f32 v153, v146, v147
s_waitcnt lgkmcnt(6)
v_mfma_f32_16x16x32_bf16 v[80:83], a[196:199], v[112:115], v[156:159]
ds_read_b128 a[224:227], v186 offset:61440
ds_write_b64 v202, v[152:153] offset:2048
v_mfma_f32_16x16x32_bf16 v[88:91], a[196:199], v[128:131], v[160:163]
buffer_load_dwordx4 v226, s[16:19], s43 offen offset:2048 nt lds
v_mfma_f32_16x16x32_bf16 v[80:83], a[200:203], v[116:119], v[80:83]
ds_read_b64_tr_b16 a[180:181], v199 offset:40960
v_add_f32 v177, v177, v147
v_mfma_f32_16x16x32_bf16 v[88:91], a[200:203], v[132:135], v[88:91]
ds_read_b64_tr_b16 a[182:183], v199 offset:45056
v_exp_f32 v64, v64
v_mfma_f32_16x16x32_bf16 v[16:19], a[204:207], v[104:107], v[16:19]
ds_read_b128 a[184:187], v187 offset:61440
v_exp_f32 v65, v65
v_mfma_f32_16x16x32_bf16 v[20:23], a[204:207], v[108:111], v[20:23]
v_cvt_pk_bf16_f32 v96, v64, v65
s_waitcnt lgkmcnt(6)
v_mfma_f32_16x16x32_bf16 v[80:83], a[208:211], v[120:123], v[80:83]
ds_read_b64_tr_b16 a[188:189], v200 offset:40960
v_exp_f32 v66, v66
v_mfma_f32_16x16x32_bf16 v[88:91], a[208:211], v[136:139], v[88:91]
ds_read_b64_tr_b16 a[190:191], v200 offset:45056
v_exp_f32 v67, v67
v_mfma_f32_16x16x32_bf16 v[24:27], a[212:215], v[104:107], v[24:27]
ds_read_b128 a[192:195], v188 offset:61440
v_cvt_pk_bf16_f32 v97, v66, v67
v_mfma_f32_16x16x32_bf16 v[28:31], a[212:215], v[108:111], v[28:31]
v_exp_f32 v68, v68
v_mfma_f32_16x16x32_bf16 v[80:83], a[216:219], v[124:127], v[80:83]
ds_read_b64_tr_b16 a[196:197], v201 offset:40960
buffer_load_dwordx4 v227, s[16:19], s43 offen offset:3072 nt lds
v_mfma_f32_16x16x32_bf16 v[88:91], a[216:219], v[140:143], v[88:91]
ds_read_b64_tr_b16 a[198:199], v201 offset:45056
s_waitcnt lgkmcnt(6)
v_mfma_f32_16x16x32_bf16 v[32:35], a[220:223], v[104:107], v[32:35]
ds_read_b128 a[200:203], v189 offset:61440
v_exp_f32 v69, v69
v_mfma_f32_16x16x32_bf16 v[36:39], a[220:223], v[108:111], v[36:39]
v_exp_f32 v70, v70
v_mfma_f32_16x16x32_bf16 v[84:87], a[224:227], v[112:115], v[156:159]
ds_read_b64_tr_b16 a[204:205], v194 offset:40960
v_cvt_pk_bf16_f32 v98, v68, v69
v_mfma_f32_16x16x32_bf16 v[92:95], a[224:227], v[128:131], v[160:163]
ds_read_b64_tr_b16 a[206:207], v194 offset:45056
v_exp_f32 v71, v71
v_mfma_f32_16x16x32_bf16 v[40:43], a[180:183], v[104:107], v[40:43]
ds_read_b64_tr_b16 a[208:209], v195 offset:40960
v_cvt_pk_bf16_f32 v99, v70, v71
v_mfma_f32_16x16x32_bf16 v[44:47], a[180:183], v[108:111], v[44:47]
ds_read_b64_tr_b16 a[210:211], v195 offset:45056
s_waitcnt lgkmcnt(8)
v_mfma_f32_16x16x32_bf16 v[84:87], a[184:187], v[116:119], v[84:87]
v_exp_f32 v72, v72
v_mfma_f32_16x16x32_bf16 v[92:95], a[184:187], v[132:135], v[92:95]
v_exp_f32 v73, v73
v_mfma_f32_16x16x32_bf16 v[48:51], a[188:191], v[104:107], v[48:51]
s_waitcnt vmcnt(8)
s_barrier
v_mfma_f32_16x16x32_bf16 v[52:55], a[188:191], v[108:111], v[52:55]
ds_read_b128 a[212:215], v186 offset:0
s_waitcnt lgkmcnt(5)
v_mfma_f32_16x16x32_bf16 v[84:87], a[192:195], v[120:123], v[84:87]
ds_read_b128 a[216:219], v187 offset:0
s_add_u32 m0, s39, 32768
v_mfma_f32_16x16x32_bf16 v[92:95], a[192:195], v[136:139], v[92:95]
ds_read_b128 a[220:223], v190 offset:0
s_add_u32 s42, s42, 16384
v_mfma_f32_16x16x32_bf16 v[56:59], a[196:199], v[104:107], v[56:59]
ds_read_b64_tr_b16 a[224:225], v196 offset:49152
buffer_load_dwordx4 v222, s[12:15], s42 offen nt lds
v_mfma_f32_16x16x32_bf16 v[60:63], a[196:199], v[108:111], v[60:63]
ds_read_b64_tr_b16 a[226:227], v196 offset:53248
v_cvt_pk_bf16_f32 v100, v72, v73
v_mfma_f32_16x16x32_bf16 a[232:235], a[228:231], v[104:107], a[232:235]
v_exp_f32 v74, v74
v_mfma_f32_16x16x32_bf16 v[84:87], a[200:203], v[124:127], v[84:87]
ds_read_b128 a[180:183], v191 offset:0
v_exp_f32 v75, v75
v_mfma_f32_16x16x32_bf16 v[92:95], a[200:203], v[140:143], v[92:95]
v_cvt_pk_bf16_f32 v101, v74, v75
s_waitcnt lgkmcnt(6)
v_mfma_f32_16x16x32_bf16 v[0:3], a[204:207], v[104:107], v[0:3]
ds_read_b128 a[184:187], v188 offset:0
v_exp_f32 v76, v76
v_mfma_f32_16x16x32_bf16 v[4:7], a[204:207], v[108:111], v[4:7]
buffer_load_dwordx4 v223, s[12:15], s42 offen offset:1024 nt lds
v_mfma_f32_16x16x32_bf16 a[16:19], a[204:207], a[28:31], a[16:19]
v_exp_f32 v77, v77
v_mfma_f32_16x16x32_bf16 a[236:239], a[228:231], v[108:111], a[236:239]
v_exp_f32 v78, v78
v_mfma_f32_16x16x32_bf16 v[8:11], a[208:211], v[104:107], v[8:11]
ds_read_b128 a[188:191], v192 offset:0
v_cvt_pk_bf16_f32 v102, v76, v77
v_mfma_f32_16x16x32_bf16 v[12:15], a[208:211], v[108:111], v[12:15]
v_exp_f32 v79, v79
v_mfma_f32_16x16x32_bf16 a[20:23], a[208:211], a[28:31], a[20:23]
v_cvt_pk_bf16_f32 v103, v78, v79
s_waitcnt lgkmcnt(3)
v_mfma_f32_16x16x32_bf16 v[64:67], a[212:215], v[112:115], v[156:159]
ds_read_b64_tr_b16 a[192:193], v197 offset:49152
v_exp_f32 v80, v80
v_mfma_f32_16x16x32_bf16 v[72:75], a[212:215], v[128:131], v[160:163]
ds_read_b64_tr_b16 a[194:195], v197 offset:53248
v_exp_f32 v81, v81
v_mfma_f32_16x16x32_bf16 v[64:67], a[216:219], v[116:119], v[64:67]
ds_read_b128 a[196:199], v193 offset:0
v_cvt_pk_bf16_f32 v104, v80, v81
v_mfma_f32_16x16x32_bf16 v[72:75], a[216:219], v[132:135], v[72:75]
ds_read_b128 a[24:27], v203 offset:2048
buffer_load_dwordx4 v224, s[12:15], s42 offen offset:2048 nt lds
v_mfma_f32_16x16x32_bf16 v[144:147], a[220:223], a[0:3], v[164:167]
ds_read_b128 a[200:203], v189 offset:0
v_exp_f32 v82, v82
v_mfma_f32_16x16x32_bf16 v[16:19], a[224:227], v[96:99], v[16:19]
ds_read_b64_tr_b16 a[204:205], v198 offset:49152
v_exp_f32 v83, v83
v_mfma_f32_16x16x32_bf16 v[20:23], a[224:227], v[100:103], v[20:23]
ds_read_b64_tr_b16 a[206:207], v198 offset:53248
s_waitcnt lgkmcnt(5)
v_mfma_f32_16x16x32_bf16 v[144:147], a[180:183], a[4:7], v[144:147]
ds_read_b128 a[208:211], v186 offset:4096
v_cvt_pk_bf16_f32 v105, v82, v83
v_mfma_f32_16x16x32_bf16 v[64:67], a[184:187], v[120:123], v[64:67]
ds_read_b64_tr_b16 a[212:213], v199 offset:49152
v_exp_f32 v84, v84
v_mfma_f32_16x16x32_bf16 v[72:75], a[184:187], v[136:139], v[72:75]
ds_read_b64_tr_b16 a[214:215], v199 offset:53248
v_exp_f32 v85, v85
v_mfma_f32_16x16x32_bf16 v[144:147], a[188:191], a[8:11], v[144:147]
ds_read_b128 a[216:219], v187 offset:4096
v_cvt_pk_bf16_f32 v106, v84, v85
v_mfma_f32_16x16x32_bf16 v[24:27], a[192:195], v[96:99], v[24:27]
ds_read_b64_tr_b16 a[220:221], v200 offset:49152
v_exp_f32 v86, v86
v_mfma_f32_16x16x32_bf16 v[28:31], a[192:195], v[100:103], v[28:31]
ds_read_b64_tr_b16 a[222:223], v200 offset:53248
s_waitcnt lgkmcnt(5)
v_mfma_f32_16x16x32_bf16 v[144:147], a[196:199], a[12:15], v[144:147]
ds_read_b128 a[224:227], v188 offset:4096
buffer_load_dwordx4 v225, s[12:15], s42 offen offset:3072 nt lds
v_mfma_f32_16x16x32_bf16 v[64:67], a[200:203], v[124:127], v[64:67]
ds_read_b64_tr_b16 a[180:181], v201 offset:49152
v_exp_f32 v87, v87
v_mfma_f32_16x16x32_bf16 v[72:75], a[200:203], v[140:143], v[72:75]
ds_read_b64_tr_b16 a[182:183], v201 offset:53248
v_cvt_pk_bf16_f32 v107, v86, v87
v_mfma_f32_16x16x32_bf16 v[32:35], a[204:207], v[96:99], v[32:35]
ds_read_b128 a[28:31], v203 offset:3072
v_exp_f32 v88, v88
v_mfma_f32_16x16x32_bf16 v[36:39], a[204:207], v[100:103], v[36:39]
ds_read_b128 a[184:187], v189 offset:4096
v_exp_f32 v89, v89
v_mfma_f32_16x16x32_bf16 v[68:71], a[208:211], v[112:115], v[156:159]
ds_read_b64_tr_b16 a[188:189], v194 offset:49152
v_cvt_pk_bf16_f32 v108, v88, v89
v_mfma_f32_16x16x32_bf16 v[76:79], a[208:211], v[128:131], v[160:163]
ds_read_b64_tr_b16 a[190:191], v194 offset:53248
s_waitcnt lgkmcnt(7)
v_mfma_f32_16x16x32_bf16 v[40:43], a[212:215], v[96:99], v[40:43]
ds_read_b64_tr_b16 a[192:193], v195 offset:49152
v_exp_f32 v90, v90
v_mfma_f32_16x16x32_bf16 v[44:47], a[212:215], v[100:103], v[44:47]
ds_read_b64_tr_b16 a[194:195], v195 offset:53248
v_exp_f32 v91, v91
v_mfma_f32_16x16x32_bf16 v[68:71], a[216:219], v[116:119], v[68:71]
ds_read_b128 a[196:199], v186 offset:8192
s_add_u32 m0, s39, 81920
v_mfma_f32_16x16x32_bf16 v[76:79], a[216:219], v[132:135], v[76:79]
s_add_u32 s43, s43, 16384
buffer_load_dwordx4 v226, s[16:19], s43 offen nt lds
v_mfma_f32_16x16x32_bf16 v[48:51], a[220:223], v[96:99], v[48:51]
ds_read_b128 a[200:203], v187 offset:8192
v_cvt_pk_bf16_f32 v109, v90, v91
v_mfma_f32_16x16x32_bf16 v[52:55], a[220:223], v[100:103], v[52:55]
v_exp_f32 v92, v92
s_waitcnt lgkmcnt(6)
v_mfma_f32_16x16x32_bf16 v[68:71], a[224:227], v[120:123], v[68:71]
ds_read_b64_tr_b16 a[204:205], v196 offset:57344
v_exp_f32 v93, v93
v_mfma_f32_16x16x32_bf16 v[76:79], a[224:227], v[136:139], v[76:79]
ds_read_b64_tr_b16 a[206:207], v196 offset:61440
v_cvt_pk_bf16_f32 v110, v92, v93
v_mfma_f32_16x16x32_bf16 v[56:59], a[180:183], v[96:99], v[56:59]
ds_read_b128 a[208:211], v188 offset:8192
v_exp_f32 v94, v94
v_mfma_f32_16x16x32_bf16 v[60:63], a[180:183], v[100:103], v[60:63]
v_exp_f32 v95, v95
v_mfma_f32_16x16x32_bf16 a[232:235], a[228:231], v[96:99], a[232:235]
v_cvt_pk_bf16_f32 v111, v94, v95
v_exp_f32 v144, v144
v_mfma_f32_16x16x32_bf16 v[68:71], a[184:187], v[124:127], v[68:71]
ds_read_b64_tr_b16 a[212:213], v197 offset:57344
buffer_load_dwordx4 v227, s[16:19], s43 offen offset:1024 nt lds
v_mfma_f32_16x16x32_bf16 v[76:79], a[184:187], v[140:143], v[76:79]
ds_read_b64_tr_b16 a[214:215], v197 offset:61440
s_waitcnt lgkmcnt(7)
v_mfma_f32_16x16x32_bf16 v[0:3], a[188:191], v[96:99], v[0:3]
ds_read_b128 a[216:219], v189 offset:8192
v_add_f32 v177, v177, v144
v_mfma_f32_16x16x32_bf16 v[4:7], a[188:191], v[100:103], v[4:7]
v_exp_f32 v145, v145
v_mfma_f32_16x16x32_bf16 a[16:19], a[188:191], a[24:27], a[16:19]
v_exp_f32 v146, v146
v_mfma_f32_16x16x32_bf16 a[236:239], a[228:231], v[100:103], a[236:239]
v_cvt_pk_bf16_f32 v152, v144, v145
v_add_f32 v177, v177, v145
v_mfma_f32_16x16x32_bf16 v[8:11], a[192:195], v[96:99], v[8:11]
ds_read_b64_tr_b16 a[220:221], v198 offset:57344
v_add_f32 v177, v177, v146
v_mfma_f32_16x16x32_bf16 v[12:15], a[192:195], v[100:103], v[12:15]
ds_read_b64_tr_b16 a[222:223], v198 offset:61440
v_exp_f32 v147, v147
v_mfma_f32_16x16x32_bf16 a[20:23], a[192:195], a[24:27], a[20:23]
v_cvt_pk_bf16_f32 v153, v146, v147
s_waitcnt lgkmcnt(6)
v_mfma_f32_16x16x32_bf16 v[80:83], a[196:199], v[112:115], v[156:159]
ds_read_b128 a[224:227], v186 offset:12288
ds_write_b64 v202, v[152:153] offset:0
v_mfma_f32_16x16x32_bf16 v[88:91], a[196:199], v[128:131], v[160:163]
buffer_load_dwordx4 v226, s[16:19], s43 offen offset:2048 nt lds
v_mfma_f32_16x16x32_bf16 v[80:83], a[200:203], v[116:119], v[80:83]
ds_read_b64_tr_b16 a[180:181], v199 offset:57344
v_add_f32 v177, v177, v147
v_mfma_f32_16x16x32_bf16 v[88:91], a[200:203], v[132:135], v[88:91]
ds_read_b64_tr_b16 a[182:183], v199 offset:61440
v_exp_f32 v64, v64
v_mfma_f32_16x16x32_bf16 v[16:19], a[204:207], v[104:107], v[16:19]
ds_read_b128 a[184:187], v187 offset:12288
v_exp_f32 v65, v65
v_mfma_f32_16x16x32_bf16 v[20:23], a[204:207], v[108:111], v[20:23]
v_cvt_pk_bf16_f32 v96, v64, v65
s_waitcnt lgkmcnt(6)
v_mfma_f32_16x16x32_bf16 v[80:83], a[208:211], v[120:123], v[80:83]
ds_read_b64_tr_b16 a[188:189], v200 offset:57344
v_exp_f32 v66, v66
v_mfma_f32_16x16x32_bf16 v[88:91], a[208:211], v[136:139], v[88:91]
ds_read_b64_tr_b16 a[190:191], v200 offset:61440
v_exp_f32 v67, v67
v_mfma_f32_16x16x32_bf16 v[24:27], a[212:215], v[104:107], v[24:27]
ds_read_b128 a[192:195], v188 offset:12288
v_cvt_pk_bf16_f32 v97, v66, v67
v_mfma_f32_16x16x32_bf16 v[28:31], a[212:215], v[108:111], v[28:31]
v_exp_f32 v68, v68
v_mfma_f32_16x16x32_bf16 v[80:83], a[216:219], v[124:127], v[80:83]
ds_read_b64_tr_b16 a[196:197], v201 offset:57344
buffer_load_dwordx4 v227, s[16:19], s43 offen offset:3072 nt lds
v_mfma_f32_16x16x32_bf16 v[88:91], a[216:219], v[140:143], v[88:91]
ds_read_b64_tr_b16 a[198:199], v201 offset:61440
s_waitcnt lgkmcnt(6)
v_mfma_f32_16x16x32_bf16 v[32:35], a[220:223], v[104:107], v[32:35]
ds_read_b128 a[200:203], v189 offset:12288
v_exp_f32 v69, v69
v_mfma_f32_16x16x32_bf16 v[36:39], a[220:223], v[108:111], v[36:39]
v_exp_f32 v70, v70
v_mfma_f32_16x16x32_bf16 v[84:87], a[224:227], v[112:115], v[156:159]
ds_read_b64_tr_b16 a[204:205], v194 offset:57344
v_cvt_pk_bf16_f32 v98, v68, v69
v_mfma_f32_16x16x32_bf16 v[92:95], a[224:227], v[128:131], v[160:163]
ds_read_b64_tr_b16 a[206:207], v194 offset:61440
v_exp_f32 v71, v71
v_mfma_f32_16x16x32_bf16 v[40:43], a[180:183], v[104:107], v[40:43]
ds_read_b64_tr_b16 a[208:209], v195 offset:57344
v_cvt_pk_bf16_f32 v99, v70, v71
v_mfma_f32_16x16x32_bf16 v[44:47], a[180:183], v[108:111], v[44:47]
ds_read_b64_tr_b16 a[210:211], v195 offset:61440
s_waitcnt lgkmcnt(8)
v_mfma_f32_16x16x32_bf16 v[84:87], a[184:187], v[116:119], v[84:87]
v_exp_f32 v72, v72
v_mfma_f32_16x16x32_bf16 v[92:95], a[184:187], v[132:135], v[92:95]
v_exp_f32 v73, v73
v_mfma_f32_16x16x32_bf16 v[48:51], a[188:191], v[104:107], v[48:51]
s_waitcnt vmcnt(8)
s_barrier
v_mfma_f32_16x16x32_bf16 v[52:55], a[188:191], v[108:111], v[52:55]
ds_read_b128 a[212:215], v186 offset:16384
s_waitcnt lgkmcnt(5)
v_mfma_f32_16x16x32_bf16 v[84:87], a[192:195], v[120:123], v[84:87]
ds_read_b128 a[216:219], v187 offset:16384
s_add_u32 m0, s39, 49152
v_mfma_f32_16x16x32_bf16 v[92:95], a[192:195], v[136:139], v[92:95]
ds_read_b128 a[220:223], v190 offset:16384
s_add_u32 s42, s42, 16384
v_mfma_f32_16x16x32_bf16 v[56:59], a[196:199], v[104:107], v[56:59]
ds_read_b64_tr_b16 a[224:225], v196 offset:0
buffer_load_dwordx4 v222, s[12:15], s42 offen nt lds
v_mfma_f32_16x16x32_bf16 v[60:63], a[196:199], v[108:111], v[60:63]
ds_read_b64_tr_b16 a[226:227], v196 offset:4096
v_cvt_pk_bf16_f32 v100, v72, v73
v_mfma_f32_16x16x32_bf16 a[232:235], a[228:231], v[104:107], a[232:235]
buffer_load_dwordx4 v223, s[12:15], s42 offen offset:1024 nt lds
v_mfma_f32_16x16x32_bf16 v[84:87], a[200:203], v[124:127], v[84:87]
ds_read_b128 a[180:183], v191 offset:16384
v_exp_f32 v74, v74
v_mfma_f32_16x16x32_bf16 v[92:95], a[200:203], v[140:143], v[92:95]
v_exp_f32 v75, v75
s_waitcnt lgkmcnt(6)
v_mfma_f32_16x16x32_bf16 v[0:3], a[204:207], v[104:107], v[0:3]
ds_read_b128 a[184:187], v188 offset:16384
v_cvt_pk_bf16_f32 v101, v74, v75
v_mfma_f32_16x16x32_bf16 v[4:7], a[204:207], v[108:111], v[4:7]
v_exp_f32 v76, v76
v_mfma_f32_16x16x32_bf16 a[16:19], a[204:207], a[28:31], a[16:19]
buffer_load_dwordx4 v224, s[12:15], s42 offen offset:2048 nt lds
v_mfma_f32_16x16x32_bf16 a[236:239], a[228:231], v[108:111], a[236:239]
v_exp_f32 v77, v77
v_mfma_f32_16x16x32_bf16 v[8:11], a[208:211], v[104:107], v[8:11]
ds_read_b128 a[188:191], v192 offset:16384
v_cvt_pk_bf16_f32 v102, v76, v77
v_mfma_f32_16x16x32_bf16 v[12:15], a[208:211], v[108:111], v[12:15]
v_exp_f32 v78, v78
v_mfma_f32_16x16x32_bf16 a[20:23], a[208:211], a[28:31], a[20:23]
v_exp_f32 v79, v79
s_nop 0
v_cvt_pk_bf16_f32 v103, v78, v79
s_waitcnt lgkmcnt(3)
v_mfma_f32_16x16x32_bf16 v[64:67], a[212:215], v[112:115], v[156:159]
ds_read_b64_tr_b16 a[192:193], v197 offset:0
buffer_load_dwordx4 v225, s[12:15], s42 offen offset:3072 nt lds
v_mfma_f32_16x16x32_bf16 v[72:75], a[212:215], v[128:131], v[160:163]
ds_read_b64_tr_b16 a[194:195], v197 offset:4096
v_exp_f32 v80, v80
v_mfma_f32_16x16x32_bf16 v[64:67], a[216:219], v[116:119], v[64:67]
ds_read_b128 a[196:199], v193 offset:16384
v_exp_f32 v81, v81
v_mfma_f32_16x16x32_bf16 v[72:75], a[216:219], v[132:135], v[72:75]
ds_read_b128 a[24:27], v203 offset:0
v_cvt_pk_bf16_f32 v104, v80, v81
v_mfma_f32_16x16x32_bf16 v[144:147], a[220:223], a[0:3], v[164:167]
ds_read_b128 a[200:203], v189 offset:16384
v_exp_f32 v82, v82
v_mfma_f32_16x16x32_bf16 v[16:19], a[224:227], v[96:99], v[16:19]
ds_read_b64_tr_b16 a[204:205], v198 offset:0
s_add_u32 m0, s39, 98304
v_mfma_f32_16x16x32_bf16 v[20:23], a[224:227], v[100:103], v[20:23]
ds_read_b64_tr_b16 a[206:207], v198 offset:4096
s_waitcnt lgkmcnt(5)
v_mfma_f32_16x16x32_bf16 v[144:147], a[180:183], a[4:7], v[144:147]
ds_read_b128 a[208:211], v186 offset:20480
s_add_u32 s43, s43, 16384
v_mfma_f32_16x16x32_bf16 v[64:67], a[184:187], v[120:123], v[64:67]
ds_read_b64_tr_b16 a[212:213], v199 offset:0
buffer_load_dwordx4 v226, s[16:19], s43 offen nt lds
v_mfma_f32_16x16x32_bf16 v[72:75], a[184:187], v[136:139], v[72:75]
ds_read_b64_tr_b16 a[214:215], v199 offset:4096
v_exp_f32 v83, v83
v_mfma_f32_16x16x32_bf16 v[144:147], a[188:191], a[8:11], v[144:147]
ds_read_b128 a[216:219], v187 offset:20480
buffer_load_dwordx4 v227, s[16:19], s43 offen offset:1024 nt lds
v_mfma_f32_16x16x32_bf16 v[24:27], a[192:195], v[96:99], v[24:27]
ds_read_b64_tr_b16 a[220:221], v200 offset:0
v_cvt_pk_bf16_f32 v105, v82, v83
v_mfma_f32_16x16x32_bf16 v[28:31], a[192:195], v[100:103], v[28:31]
ds_read_b64_tr_b16 a[222:223], v200 offset:4096
s_waitcnt lgkmcnt(5)
v_mfma_f32_16x16x32_bf16 v[144:147], a[196:199], a[12:15], v[144:147]
ds_read_b128 a[224:227], v188 offset:20480
v_exp_f32 v84, v84
v_mfma_f32_16x16x32_bf16 v[64:67], a[200:203], v[124:127], v[64:67]
ds_read_b64_tr_b16 a[180:181], v201 offset:0
v_exp_f32 v85, v85
v_mfma_f32_16x16x32_bf16 v[72:75], a[200:203], v[140:143], v[72:75]
ds_read_b64_tr_b16 a[182:183], v201 offset:4096
buffer_load_dwordx4 v226, s[16:19], s43 offen offset:2048 nt lds
v_mfma_f32_16x16x32_bf16 v[32:35], a[204:207], v[96:99], v[32:35]
ds_read_b128 a[28:31], v203 offset:1024
v_cvt_pk_bf16_f32 v106, v84, v85
v_mfma_f32_16x16x32_bf16 v[36:39], a[204:207], v[100:103], v[36:39]
ds_read_b128 a[184:187], v189 offset:20480
v_exp_f32 v86, v86
v_mfma_f32_16x16x32_bf16 v[68:71], a[208:211], v[112:115], v[156:159]
ds_read_b64_tr_b16 a[188:189], v194 offset:0
v_exp_f32 v87, v87
v_mfma_f32_16x16x32_bf16 v[76:79], a[208:211], v[128:131], v[160:163]
ds_read_b64_tr_b16 a[190:191], v194 offset:4096
s_waitcnt lgkmcnt(7)
v_mfma_f32_16x16x32_bf16 v[40:43], a[212:215], v[96:99], v[40:43]
ds_read_b64_tr_b16 a[192:193], v195 offset:0
buffer_load_dwordx4 v227, s[16:19], s43 offen offset:3072 nt lds
v_mfma_f32_16x16x32_bf16 v[44:47], a[212:215], v[100:103], v[44:47]
ds_read_b64_tr_b16 a[194:195], v195 offset:4096
v_cvt_pk_bf16_f32 v107, v86, v87
v_mfma_f32_16x16x32_bf16 v[68:71], a[216:219], v[116:119], v[68:71]
ds_read_b128 a[196:199], v186 offset:24576
v_exp_f32 v88, v88
v_mfma_f32_16x16x32_bf16 v[76:79], a[216:219], v[132:135], v[76:79]
v_exp_f32 v89, v89
v_mfma_f32_16x16x32_bf16 v[48:51], a[220:223], v[96:99], v[48:51]
ds_read_b128 a[200:203], v187 offset:24576
v_cvt_pk_bf16_f32 v108, v88, v89
v_mfma_f32_16x16x32_bf16 v[52:55], a[220:223], v[100:103], v[52:55]
s_lshl_b32 s3, s49, 3
s_waitcnt lgkmcnt(6)
v_mfma_f32_16x16x32_bf16 v[68:71], a[224:227], v[120:123], v[68:71]
ds_read_b64_tr_b16 a[204:205], v196 offset:8192
s_add_u32 s3, s3, s47
v_mfma_f32_16x16x32_bf16 v[76:79], a[224:227], v[136:139], v[76:79]
ds_read_b64_tr_b16 a[206:207], v196 offset:12288
v_exp_f32 v90, v90
v_mfma_f32_16x16x32_bf16 v[56:59], a[180:183], v[96:99], v[56:59]
ds_read_b128 a[208:211], v188 offset:24576
v_exp_f32 v91, v91
v_mfma_f32_16x16x32_bf16 v[60:63], a[180:183], v[100:103], v[60:63]
v_exp_f32 v92, v92
v_mfma_f32_16x16x32_bf16 a[232:235], a[228:231], v[96:99], a[232:235]
s_lshl_b32 s3, s3, 2
s_add_u32 s3, s3, s50
v_mfma_f32_16x16x32_bf16 v[68:71], a[184:187], v[124:127], v[68:71]
ds_read_b64_tr_b16 a[212:213], v197 offset:8192
v_cvt_pk_bf16_f32 v109, v90, v91
v_mfma_f32_16x16x32_bf16 v[76:79], a[184:187], v[140:143], v[76:79]
ds_read_b64_tr_b16 a[214:215], v197 offset:12288
s_waitcnt lgkmcnt(7)
v_mfma_f32_16x16x32_bf16 v[0:3], a[188:191], v[96:99], v[0:3]
ds_read_b128 a[216:219], v189 offset:24576
v_exp_f32 v93, v93
v_mfma_f32_16x16x32_bf16 v[4:7], a[188:191], v[100:103], v[4:7]
v_exp_f32 v94, v94
v_mfma_f32_16x16x32_bf16 a[16:19], a[188:191], a[24:27], a[16:19]
s_lshl_b32 s3, s3, 2
s_add_u32 s3, s3, s38
v_mfma_f32_16x16x32_bf16 a[236:239], a[228:231], v[100:103], a[236:239]
v_cvt_pk_bf16_f32 v110, v92, v93
v_exp_f32 v95, v95
v_mfma_f32_16x16x32_bf16 v[8:11], a[192:195], v[96:99], v[8:11]
ds_read_b64_tr_b16 a[220:221], v198 offset:8192
v_cvt_pk_bf16_f32 v111, v94, v95
v_mfma_f32_16x16x32_bf16 v[12:15], a[192:195], v[100:103], v[12:15]
ds_read_b64_tr_b16 a[222:223], v198 offset:12288
v_exp_f32 v144, v144
v_mfma_f32_16x16x32_bf16 a[20:23], a[192:195], a[24:27], a[20:23]
v_add_f32 v177, v177, v144
s_waitcnt lgkmcnt(6)
v_mfma_f32_16x16x32_bf16 v[80:83], a[196:199], v[112:115], v[156:159]
ds_read_b128 a[224:227], v186 offset:28672
s_mul_i32 s3, s3, 9216
v_mfma_f32_16x16x32_bf16 v[88:91], a[196:199], v[128:131], v[160:163]
v_lshlrev_b32 v178, 7, v242
v_exp_f32 v145, v145
v_mfma_f32_16x16x32_bf16 v[80:83], a[200:203], v[116:119], v[80:83]
ds_read_b64_tr_b16 a[180:181], v199 offset:8192
v_cvt_pk_bf16_f32 v152, v144, v145
v_mfma_f32_16x16x32_bf16 v[88:91], a[200:203], v[132:135], v[88:91]
ds_read_b64_tr_b16 a[182:183], v199 offset:12288
v_add_f32 v177, v177, v145
v_mfma_f32_16x16x32_bf16 v[16:19], a[204:207], v[104:107], v[16:19]
ds_read_b128 a[184:187], v187 offset:28672
v_exp_f32 v146, v146
v_mfma_f32_16x16x32_bf16 v[20:23], a[204:207], v[108:111], v[20:23]
v_and_b32 v179, 0x3ff, v178
s_waitcnt lgkmcnt(6)
v_mfma_f32_16x16x32_bf16 v[80:83], a[208:211], v[120:123], v[80:83]
ds_read_b64_tr_b16 a[188:189], v200 offset:8192
v_add_f32 v177, v177, v146
v_mfma_f32_16x16x32_bf16 v[88:91], a[208:211], v[136:139], v[88:91]
ds_read_b64_tr_b16 a[190:191], v200 offset:12288
v_exp_f32 v147, v147
v_mfma_f32_16x16x32_bf16 v[24:27], a[212:215], v[104:107], v[24:27]
ds_read_b128 a[192:195], v188 offset:28672
v_cvt_pk_bf16_f32 v153, v146, v147
v_mfma_f32_16x16x32_bf16 v[28:31], a[212:215], v[108:111], v[28:31]
ds_write_b64 v202, v[152:153] offset:2048
v_add_f32 v177, v177, v147
v_mfma_f32_16x16x32_bf16 v[80:83], a[216:219], v[124:127], v[80:83]
ds_read_b64_tr_b16 a[196:197], v201 offset:8192
buffer_load_dword v255, v178, s[28:31], s3 offen
v_mfma_f32_16x16x32_bf16 v[88:91], a[216:219], v[140:143], v[88:91]
ds_read_b64_tr_b16 a[198:199], v201 offset:12288
s_waitcnt lgkmcnt(6)
v_mfma_f32_16x16x32_bf16 v[32:35], a[220:223], v[104:107], v[32:35]
ds_read_b128 a[200:203], v189 offset:28672
s_add_u32 s3, s3, 8192
v_mfma_f32_16x16x32_bf16 v[36:39], a[220:223], v[108:111], v[36:39]
v_exp_f32 v64, v64
v_mfma_f32_16x16x32_bf16 v[84:87], a[224:227], v[112:115], v[156:159]
ds_read_b64_tr_b16 a[204:205], v194 offset:8192
v_exp_f32 v65, v65
v_mfma_f32_16x16x32_bf16 v[92:95], a[224:227], v[128:131], v[160:163]
ds_read_b64_tr_b16 a[206:207], v194 offset:12288
buffer_load_dword v255, v179, s[28:31], s3 offen
v_mfma_f32_16x16x32_bf16 v[40:43], a[180:183], v[104:107], v[40:43]
ds_read_b64_tr_b16 a[208:209], v195 offset:8192
v_cvt_pk_bf16_f32 v96, v64, v65
v_mfma_f32_16x16x32_bf16 v[44:47], a[180:183], v[108:111], v[44:47]
ds_read_b64_tr_b16 a[210:211], v195 offset:12288
s_waitcnt lgkmcnt(8)
v_mfma_f32_16x16x32_bf16 v[84:87], a[184:187], v[116:119], v[84:87]
v_exp_f32 v66, v66
v_mfma_f32_16x16x32_bf16 v[92:95], a[184:187], v[132:135], v[92:95]
v_exp_f32 v67, v67
v_mfma_f32_16x16x32_bf16 v[48:51], a[188:191], v[104:107], v[48:51]
s_waitcnt vmcnt(10) lgkmcnt(7)
s_barrier
v_mfma_f32_16x16x32_bf16 v[52:55], a[188:191], v[108:111], v[52:55]
ds_read_b128 a[212:215], v186 offset:32768
s_waitcnt lgkmcnt(5)
v_mfma_f32_16x16x32_bf16 v[84:87], a[192:195], v[120:123], v[84:87]
ds_read_b128 a[216:219], v187 offset:32768
s_add_u32 m0, s39, 114688
v_mfma_f32_16x16x32_bf16 v[92:95], a[192:195], v[136:139], v[92:95]
ds_read_b128 a[220:223], v190 offset:32768
s_add_u32 s43, s43, 16384
v_mfma_f32_16x16x32_bf16 v[56:59], a[196:199], v[104:107], v[56:59]
ds_read_b64_tr_b16 a[224:225], v196 offset:16384
buffer_load_dwordx4 v226, s[16:19], s43 offen nt lds
v_mfma_f32_16x16x32_bf16 v[60:63], a[196:199], v[108:111], v[60:63]
ds_read_b64_tr_b16 a[226:227], v196 offset:20480
v_cvt_pk_bf16_f32 v97, v66, v67
v_mfma_f32_16x16x32_bf16 a[232:235], a[228:231], v[104:107], a[232:235]
v_exp_f32 v68, v68
v_mfma_f32_16x16x32_bf16 v[84:87], a[200:203], v[124:127], v[84:87]
ds_read_b128 a[180:183], v191 offset:32768
v_exp_f32 v69, v69
v_mfma_f32_16x16x32_bf16 v[92:95], a[200:203], v[140:143], v[92:95]
v_cvt_pk_bf16_f32 v98, v68, v69
s_waitcnt lgkmcnt(6)
v_mfma_f32_16x16x32_bf16 v[0:3], a[204:207], v[104:107], v[0:3]
ds_read_b128 a[184:187], v188 offset:32768
v_exp_f32 v70, v70
v_mfma_f32_16x16x32_bf16 v[4:7], a[204:207], v[108:111], v[4:7]
v_exp_f32 v71, v71
v_mfma_f32_16x16x32_bf16 a[16:19], a[204:207], a[28:31], a[16:19]
v_exp_f32 v72, v72
v_mfma_f32_16x16x32_bf16 a[236:239], a[228:231], v[108:111], a[236:239]
v_cvt_pk_bf16_f32 v99, v70, v71
v_exp_f32 v73, v73
v_mfma_f32_16x16x32_bf16 v[8:11], a[208:211], v[104:107], v[8:11]
ds_read_b128 a[188:191], v192 offset:32768
v_cvt_pk_bf16_f32 v100, v72, v73
v_mfma_f32_16x16x32_bf16 v[12:15], a[208:211], v[108:111], v[12:15]
v_exp_f32 v74, v74
v_mfma_f32_16x16x32_bf16 a[20:23], a[208:211], a[28:31], a[20:23]
v_exp_f32 v75, v75
v_exp_f32 v76, v76
v_cvt_pk_bf16_f32 v101, v74, v75
v_exp_f32 v77, v77
v_exp_f32 v78, v78
v_cvt_pk_bf16_f32 v102, v76, v77
v_exp_f32 v79, v79
s_nop 0
v_cvt_pk_bf16_f32 v103, v78, v79
s_waitcnt lgkmcnt(3)
v_mfma_f32_16x16x32_bf16 v[64:67], a[212:215], v[112:115], v[156:159]
ds_read_b64_tr_b16 a[192:193], v197 offset:16384
v_exp_f32 v80, v80
v_mfma_f32_16x16x32_bf16 v[72:75], a[212:215], v[128:131], v[160:163]
ds_read_b64_tr_b16 a[194:195], v197 offset:20480
v_exp_f32 v81, v81
v_mfma_f32_16x16x32_bf16 v[64:67], a[216:219], v[116:119], v[64:67]
ds_read_b128 a[196:199], v193 offset:32768
v_cvt_pk_bf16_f32 v104, v80, v81
v_mfma_f32_16x16x32_bf16 v[72:75], a[216:219], v[132:135], v[72:75]
ds_read_b128 a[24:27], v203 offset:2048
buffer_load_dwordx4 v227, s[16:19], s43 offen offset:1024 nt lds
v_mfma_f32_16x16x32_bf16 v[144:147], a[220:223], a[0:3], v[164:167]
ds_read_b128 a[200:203], v189 offset:32768
v_exp_f32 v82, v82
v_mfma_f32_16x16x32_bf16 v[16:19], a[224:227], v[96:99], v[16:19]
ds_read_b64_tr_b16 a[204:205], v198 offset:16384
v_exp_f32 v83, v83
v_mfma_f32_16x16x32_bf16 v[20:23], a[224:227], v[100:103], v[20:23]
ds_read_b64_tr_b16 a[206:207], v198 offset:20480
s_waitcnt lgkmcnt(5)
v_mfma_f32_16x16x32_bf16 v[144:147], a[180:183], a[4:7], v[144:147]
ds_read_b128 a[208:211], v186 offset:36864
v_cvt_pk_bf16_f32 v105, v82, v83
v_mfma_f32_16x16x32_bf16 v[64:67], a[184:187], v[120:123], v[64:67]
ds_read_b64_tr_b16 a[212:213], v199 offset:16384
v_exp_f32 v84, v84
v_mfma_f32_16x16x32_bf16 v[72:75], a[184:187], v[136:139], v[72:75]
ds_read_b64_tr_b16 a[214:215], v199 offset:20480
v_exp_f32 v85, v85
v_mfma_f32_16x16x32_bf16 v[144:147], a[188:191], a[8:11], v[144:147]
ds_read_b128 a[216:219], v187 offset:36864
v_cvt_pk_bf16_f32 v106, v84, v85
v_mfma_f32_16x16x32_bf16 v[24:27], a[192:195], v[96:99], v[24:27]
ds_read_b64_tr_b16 a[220:221], v200 offset:16384
v_exp_f32 v86, v86
v_mfma_f32_16x16x32_bf16 v[28:31], a[192:195], v[100:103], v[28:31]
ds_read_b64_tr_b16 a[222:223], v200 offset:20480
s_waitcnt lgkmcnt(5)
v_mfma_f32_16x16x32_bf16 v[144:147], a[196:199], a[12:15], v[144:147]
ds_read_b128 a[224:227], v188 offset:36864
v_exp_f32 v87, v87
v_mfma_f32_16x16x32_bf16 v[64:67], a[200:203], v[124:127], v[64:67]
ds_read_b64_tr_b16 a[180:181], v201 offset:16384
v_cvt_pk_bf16_f32 v107, v86, v87
v_mfma_f32_16x16x32_bf16 v[72:75], a[200:203], v[140:143], v[72:75]
ds_read_b64_tr_b16 a[182:183], v201 offset:20480
v_exp_f32 v88, v88
v_mfma_f32_16x16x32_bf16 v[32:35], a[204:207], v[96:99], v[32:35]
ds_read_b128 a[28:31], v203 offset:3072
v_exp_f32 v89, v89
v_mfma_f32_16x16x32_bf16 v[36:39], a[204:207], v[100:103], v[36:39]
ds_read_b128 a[184:187], v189 offset:36864
v_cvt_pk_bf16_f32 v108, v88, v89
v_mfma_f32_16x16x32_bf16 v[68:71], a[208:211], v[112:115], v[156:159]
ds_read_b64_tr_b16 a[188:189], v194 offset:16384
v_exp_f32 v90, v90
v_mfma_f32_16x16x32_bf16 v[76:79], a[208:211], v[128:131], v[160:163]
ds_read_b64_tr_b16 a[190:191], v194 offset:20480
s_waitcnt lgkmcnt(7)
v_mfma_f32_16x16x32_bf16 v[40:43], a[212:215], v[96:99], v[40:43]
ds_read_b64_tr_b16 a[192:193], v195 offset:16384
v_exp_f32 v91, v91
v_mfma_f32_16x16x32_bf16 v[44:47], a[212:215], v[100:103], v[44:47]
ds_read_b64_tr_b16 a[194:195], v195 offset:20480
v_cvt_pk_bf16_f32 v109, v90, v91
v_mfma_f32_16x16x32_bf16 v[68:71], a[216:219], v[116:119], v[68:71]
ds_read_b128 a[196:199], v186 offset:40960
buffer_load_dwordx4 v226, s[16:19], s43 offen offset:2048 nt lds
v_mfma_f32_16x16x32_bf16 v[76:79], a[216:219], v[132:135], v[76:79]
v_exp_f32 v92, v92
v_mfma_f32_16x16x32_bf16 v[48:51], a[220:223], v[96:99], v[48:51]
ds_read_b128 a[200:203], v187 offset:40960
v_exp_f32 v93, v93
v_mfma_f32_16x16x32_bf16 v[52:55], a[220:223], v[100:103], v[52:55]
v_cvt_pk_bf16_f32 v110, v92, v93
s_waitcnt lgkmcnt(6)
v_mfma_f32_16x16x32_bf16 v[68:71], a[224:227], v[120:123], v[68:71]
ds_read_b64_tr_b16 a[204:205], v196 offset:24576
v_exp_f32 v94, v94
v_mfma_f32_16x16x32_bf16 v[76:79], a[224:227], v[136:139], v[76:79]
ds_read_b64_tr_b16 a[206:207], v196 offset:28672
v_exp_f32 v95, v95
v_mfma_f32_16x16x32_bf16 v[56:59], a[180:183], v[96:99], v[56:59]
ds_read_b128 a[208:211], v188 offset:40960
v_cvt_pk_bf16_f32 v111, v94, v95
v_mfma_f32_16x16x32_bf16 v[60:63], a[180:183], v[100:103], v[60:63]
v_exp_f32 v144, v144
v_mfma_f32_16x16x32_bf16 a[232:235], a[228:231], v[96:99], a[232:235]
v_exp_f32 v145, v145
v_mfma_f32_16x16x32_bf16 v[68:71], a[184:187], v[124:127], v[68:71]
ds_read_b64_tr_b16 a[212:213], v197 offset:24576
v_cvt_pk_bf16_f32 v152, v144, v145
v_mfma_f32_16x16x32_bf16 v[76:79], a[184:187], v[140:143], v[76:79]
ds_read_b64_tr_b16 a[214:215], v197 offset:28672
s_waitcnt lgkmcnt(7)
v_mfma_f32_16x16x32_bf16 v[0:3], a[188:191], v[96:99], v[0:3]
ds_read_b128 a[216:219], v189 offset:40960
v_add_f32 v177, v177, v144
v_mfma_f32_16x16x32_bf16 v[4:7], a[188:191], v[100:103], v[4:7]
v_exp_f32 v146, v146
v_mfma_f32_16x16x32_bf16 a[16:19], a[188:191], a[24:27], a[16:19]
v_exp_f32 v147, v147
v_mfma_f32_16x16x32_bf16 a[236:239], a[228:231], v[100:103], a[236:239]
v_cvt_pk_bf16_f32 v153, v146, v147
ds_write_b64 v202, v[152:153] offset:0
v_mfma_f32_16x16x32_bf16 v[8:11], a[192:195], v[96:99], v[8:11]
ds_read_b64_tr_b16 a[220:221], v198 offset:24576
v_add_f32 v177, v177, v145
v_mfma_f32_16x16x32_bf16 v[12:15], a[192:195], v[100:103], v[12:15]
ds_read_b64_tr_b16 a[222:223], v198 offset:28672
v_add_f32 v177, v177, v146
v_mfma_f32_16x16x32_bf16 a[20:23], a[192:195], a[24:27], a[20:23]
v_add_f32 v177, v177, v147
s_waitcnt lgkmcnt(6)
v_mfma_f32_16x16x32_bf16 v[80:83], a[196:199], v[112:115], v[156:159]
ds_read_b128 a[224:227], v186 offset:45056
v_exp_f32 v64, v64
v_mfma_f32_16x16x32_bf16 v[88:91], a[196:199], v[128:131], v[160:163]
buffer_load_dwordx4 v227, s[16:19], s43 offen offset:3072 nt lds
v_mfma_f32_16x16x32_bf16 v[80:83], a[200:203], v[116:119], v[80:83]
ds_read_b64_tr_b16 a[180:181], v199 offset:24576
v_exp_f32 v65, v65
v_mfma_f32_16x16x32_bf16 v[88:91], a[200:203], v[132:135], v[88:91]
ds_read_b64_tr_b16 a[182:183], v199 offset:28672
v_cvt_pk_bf16_f32 v96, v64, v65
v_mfma_f32_16x16x32_bf16 v[16:19], a[204:207], v[104:107], v[16:19]
ds_read_b128 a[184:187], v187 offset:45056
v_exp_f32 v66, v66
v_mfma_f32_16x16x32_bf16 v[20:23], a[204:207], v[108:111], v[20:23]
v_exp_f32 v67, v67
s_waitcnt lgkmcnt(6)
v_mfma_f32_16x16x32_bf16 v[80:83], a[208:211], v[120:123], v[80:83]
ds_read_b64_tr_b16 a[188:189], v200 offset:24576
v_cvt_pk_bf16_f32 v97, v66, v67
v_mfma_f32_16x16x32_bf16 v[88:91], a[208:211], v[136:139], v[88:91]
ds_read_b64_tr_b16 a[190:191], v200 offset:28672
v_exp_f32 v68, v68
v_mfma_f32_16x16x32_bf16 v[24:27], a[212:215], v[104:107], v[24:27]
ds_read_b128 a[192:195], v188 offset:45056
v_exp_f32 v69, v69
v_mfma_f32_16x16x32_bf16 v[28:31], a[212:215], v[108:111], v[28:31]
v_exp_f32 v70, v70
v_mfma_f32_16x16x32_bf16 v[80:83], a[216:219], v[124:127], v[80:83]
ds_read_b64_tr_b16 a[196:197], v201 offset:24576
v_cvt_pk_bf16_f32 v98, v68, v69
v_mfma_f32_16x16x32_bf16 v[88:91], a[216:219], v[140:143], v[88:91]
ds_read_b64_tr_b16 a[198:199], v201 offset:28672
s_waitcnt lgkmcnt(6)
v_mfma_f32_16x16x32_bf16 v[32:35], a[220:223], v[104:107], v[32:35]
ds_read_b128 a[200:203], v189 offset:45056
v_exp_f32 v71, v71
v_mfma_f32_16x16x32_bf16 v[36:39], a[220:223], v[108:111], v[36:39]
v_exp_f32 v72, v72
v_mfma_f32_16x16x32_bf16 v[84:87], a[224:227], v[112:115], v[156:159]
ds_read_b64_tr_b16 a[204:205], v194 offset:24576
v_cvt_pk_bf16_f32 v99, v70, v71
v_mfma_f32_16x16x32_bf16 v[92:95], a[224:227], v[128:131], v[160:163]
ds_read_b64_tr_b16 a[206:207], v194 offset:28672
v_exp_f32 v73, v73
v_mfma_f32_16x16x32_bf16 v[40:43], a[180:183], v[104:107], v[40:43]
ds_read_b64_tr_b16 a[208:209], v195 offset:24576
v_cvt_pk_bf16_f32 v100, v72, v73
v_mfma_f32_16x16x32_bf16 v[44:47], a[180:183], v[108:111], v[44:47]
ds_read_b64_tr_b16 a[210:211], v195 offset:28672
s_waitcnt lgkmcnt(8)
v_mfma_f32_16x16x32_bf16 v[84:87], a[184:187], v[116:119], v[84:87]
v_exp_f32 v74, v74
v_mfma_f32_16x16x32_bf16 v[92:95], a[184:187], v[132:135], v[92:95]
v_exp_f32 v75, v75
v_mfma_f32_16x16x32_bf16 v[48:51], a[188:191], v[104:107], v[48:51]
s_waitcnt vmcnt(6)
s_barrier
v_mfma_f32_16x16x32_bf16 v[52:55], a[188:191], v[108:111], v[52:55]
ds_read_b128 a[212:215], v186 offset:49152
s_waitcnt lgkmcnt(5)
v_mfma_f32_16x16x32_bf16 v[84:87], a[192:195], v[120:123], v[84:87]
ds_read_b128 a[216:219], v187 offset:49152
s_cmp_lg_u32 s38, 0
s_cbranch_scc1 FL11
buffer_load_dword v180, v206, s[24:27], s62 offen sc1
FL11:
v_mfma_f32_16x16x32_bf16 v[92:95], a[192:195], v[136:139], v[92:95]
ds_read_b128 a[220:223], v190 offset:49152
v_cvt_pk_bf16_f32 v101, v74, v75
v_mfma_f32_16x16x32_bf16 v[56:59], a[196:199], v[104:107], v[56:59]
ds_read_b64_tr_b16 a[224:225], v196 offset:32768
v_exp_f32 v76, v76
v_mfma_f32_16x16x32_bf16 v[60:63], a[196:199], v[108:111], v[60:63]
ds_read_b64_tr_b16 a[226:227], v196 offset:36864
v_exp_f32 v77, v77
v_mfma_f32_16x16x32_bf16 a[232:235], a[228:231], v[104:107], a[232:235]
v_exp_f32 v78, v78
v_mfma_f32_16x16x32_bf16 v[84:87], a[200:203], v[124:127], v[84:87]
ds_read_b128 a[180:183], v191 offset:49152
v_cvt_pk_bf16_f32 v102, v76, v77
v_mfma_f32_16x16x32_bf16 v[92:95], a[200:203], v[140:143], v[92:95]
v_exp_f32 v79, v79
s_waitcnt lgkmcnt(6)
v_mfma_f32_16x16x32_bf16 v[0:3], a[204:207], v[104:107], v[0:3]
ds_read_b128 a[184:187], v188 offset:49152
s_add_u32 s57, s55, 0
v_mfma_f32_16x16x32_bf16 v[4:7], a[204:207], v[108:111], v[4:7]
s_and_b32 s57, s57, 3
v_cvt_pk_bf16_f32 v103, v78, v79
v_mfma_f32_16x16x32_bf16 a[16:19], a[204:207], a[28:31], a[16:19]
v_mfma_f32_16x16x32_bf16 a[236:239], a[228:231], v[108:111], a[236:239]
v_mfma_f32_16x16x32_bf16 v[8:11], a[208:211], v[104:107], v[8:11]
ds_read_b128 a[188:191], v192 offset:49152
v_mfma_f32_16x16x32_bf16 v[12:15], a[208:211], v[108:111], v[12:15]
v_mfma_f32_16x16x32_bf16 a[20:23], a[208:211], a[28:31], a[20:23]
s_waitcnt lgkmcnt(3)
v_mfma_f32_16x16x32_bf16 v[64:67], a[212:215], v[112:115], v[156:159]
ds_read_b64_tr_b16 a[192:193], v197 offset:32768
v_exp_f32 v80, v80
v_mfma_f32_16x16x32_bf16 v[72:75], a[212:215], v[128:131], v[160:163]
ds_read_b64_tr_b16 a[194:195], v197 offset:36864
s_mul_i32 s57, s57, 294912
v_mfma_f32_16x16x32_bf16 v[64:67], a[216:219], v[116:119], v[64:67]
ds_read_b128 a[196:199], v193 offset:49152
s_add_u32 s57, s57, s61
v_mfma_f32_16x16x32_bf16 v[72:75], a[216:219], v[132:135], v[72:75]
ds_read_b128 a[24:27], v203 offset:0
v_exp_f32 v81, v81
v_mfma_f32_16x16x32_bf16 v[144:147], a[220:223], a[0:3], v[164:167]
ds_read_b128 a[200:203], v189 offset:49152
v_cvt_pk_bf16_f32 v104, v80, v81
v_mfma_f32_16x16x32_bf16 v[16:19], a[224:227], v[96:99], v[16:19]
ds_read_b64_tr_b16 a[204:205], v198 offset:32768
v_exp_f32 v82, v82
v_mfma_f32_16x16x32_bf16 v[20:23], a[224:227], v[100:103], v[20:23]
ds_read_b64_tr_b16 a[206:207], v198 offset:36864
s_waitcnt lgkmcnt(5)
v_mfma_f32_16x16x32_bf16 v[144:147], a[180:183], a[4:7], v[144:147]
ds_read_b128 a[208:211], v186 offset:53248
v_exp_f32 v83, v83
v_mfma_f32_16x16x32_bf16 v[64:67], a[184:187], v[120:123], v[64:67]
ds_read_b64_tr_b16 a[212:213], v199 offset:32768
v_cvt_pk_bf16_f32 v105, v82, v83
v_mfma_f32_16x16x32_bf16 v[72:75], a[184:187], v[136:139], v[72:75]
ds_read_b64_tr_b16 a[214:215], v199 offset:36864
v_exp_f32 v84, v84
v_mfma_f32_16x16x32_bf16 v[144:147], a[188:191], a[8:11], v[144:147]
ds_read_b128 a[216:219], v187 offset:53248
s_add_u32 m0, s56, 0
v_mfma_f32_16x16x32_bf16 v[24:27], a[192:195], v[96:99], v[24:27]
ds_read_b64_tr_b16 a[220:221], v200 offset:32768
buffer_load_dwordx4 v244, s[28:31], s57 offen  lds
v_mfma_f32_16x16x32_bf16 v[28:31], a[192:195], v[100:103], v[28:31]
ds_read_b64_tr_b16 a[222:223], v200 offset:36864
s_waitcnt lgkmcnt(5)
v_mfma_f32_16x16x32_bf16 v[144:147], a[196:199], a[12:15], v[144:147]
ds_read_b128 a[224:227], v188 offset:53248
v_exp_f32 v85, v85
v_mfma_f32_16x16x32_bf16 v[64:67], a[200:203], v[124:127], v[64:67]
ds_read_b64_tr_b16 a[180:181], v201 offset:32768
v_cvt_pk_bf16_f32 v106, v84, v85
v_mfma_f32_16x16x32_bf16 v[72:75], a[200:203], v[140:143], v[72:75]
ds_read_b64_tr_b16 a[182:183], v201 offset:36864
v_exp_f32 v86, v86
v_mfma_f32_16x16x32_bf16 v[32:35], a[204:207], v[96:99], v[32:35]
ds_read_b128 a[28:31], v203 offset:1024
v_exp_f32 v87, v87
v_mfma_f32_16x16x32_bf16 v[36:39], a[204:207], v[100:103], v[36:39]
ds_read_b128 a[184:187], v189 offset:53248
v_cvt_pk_bf16_f32 v107, v86, v87
v_mfma_f32_16x16x32_bf16 v[68:71], a[208:211], v[112:115], v[156:159]
ds_read_b64_tr_b16 a[188:189], v194 offset:32768
buffer_load_dwordx4 v245, s[28:31], s57 offen offset:1024  lds
v_mfma_f32_16x16x32_bf16 v[76:79], a[208:211], v[128:131], v[160:163]
ds_read_b64_tr_b16 a[190:191], v194 offset:36864
s_waitcnt lgkmcnt(7)
v_mfma_f32_16x16x32_bf16 v[40:43], a[212:215], v[96:99], v[40:43]
ds_read_b64_tr_b16 a[192:193], v195 offset:32768
v_exp_f32 v88, v88
v_mfma_f32_16x16x32_bf16 v[44:47], a[212:215], v[100:103], v[44:47]
ds_read_b64_tr_b16 a[194:195], v195 offset:36864
v_exp_f32 v89, v89
v_mfma_f32_16x16x32_bf16 v[68:71], a[216:219], v[116:119], v[68:71]
ds_read_b128 a[196:199], v186 offset:57344
v_cvt_pk_bf16_f32 v108, v88, v89
v_mfma_f32_16x16x32_bf16 v[76:79], a[216:219], v[132:135], v[76:79]
v_exp_f32 v90, v90
v_mfma_f32_16x16x32_bf16 v[48:51], a[220:223], v[96:99], v[48:51]
ds_read_b128 a[200:203], v187 offset:57344
v_exp_f32 v91, v91
v_mfma_f32_16x16x32_bf16 v[52:55], a[220:223], v[100:103], v[52:55]
v_cvt_pk_bf16_f32 v109, v90, v91
s_waitcnt lgkmcnt(6)
v_mfma_f32_16x16x32_bf16 v[68:71], a[224:227], v[120:123], v[68:71]
ds_read_b64_tr_b16 a[204:205], v196 offset:40960
buffer_load_dwordx4 v246, s[28:31], s57 offen offset:2048  lds
v_mfma_f32_16x16x32_bf16 v[76:79], a[224:227], v[136:139], v[76:79]
ds_read_b64_tr_b16 a[206:207], v196 offset:45056
v_exp_f32 v92, v92
v_mfma_f32_16x16x32_bf16 v[56:59], a[180:183], v[96:99], v[56:59]
ds_read_b128 a[208:211], v188 offset:57344
v_exp_f32 v93, v93
v_mfma_f32_16x16x32_bf16 v[60:63], a[180:183], v[100:103], v[60:63]
v_exp_f32 v94, v94
v_mfma_f32_16x16x32_bf16 a[232:235], a[228:231], v[96:99], a[232:235]
v_cvt_pk_bf16_f32 v110, v92, v93
v_exp_f32 v95, v95
v_mfma_f32_16x16x32_bf16 v[68:71], a[184:187], v[124:127], v[68:71]
ds_read_b64_tr_b16 a[212:213], v197 offset:40960
v_cvt_pk_bf16_f32 v111, v94, v95
v_mfma_f32_16x16x32_bf16 v[76:79], a[184:187], v[140:143], v[76:79]
ds_read_b64_tr_b16 a[214:215], v197 offset:45056
s_waitcnt lgkmcnt(7)
v_mfma_f32_16x16x32_bf16 v[0:3], a[188:191], v[96:99], v[0:3]
ds_read_b128 a[216:219], v189 offset:57344
v_exp_f32 v144, v144
v_mfma_f32_16x16x32_bf16 v[4:7], a[188:191], v[100:103], v[4:7]
v_exp_f32 v145, v145
v_mfma_f32_16x16x32_bf16 a[16:19], a[188:191], a[24:27], a[16:19]
buffer_load_dwordx4 v247, s[28:31], s57 offen offset:3072  lds
v_mfma_f32_16x16x32_bf16 a[236:239], a[228:231], v[100:103], a[236:239]
v_exp_f32 v146, v146
v_mfma_f32_16x16x32_bf16 v[8:11], a[192:195], v[96:99], v[8:11]
ds_read_b64_tr_b16 a[220:221], v198 offset:40960
v_cvt_pk_bf16_f32 v152, v144, v145
v_mfma_f32_16x16x32_bf16 v[12:15], a[192:195], v[100:103], v[12:15]
ds_read_b64_tr_b16 a[222:223], v198 offset:45056
v_add_f32 v177, v177, v144
v_mfma_f32_16x16x32_bf16 a[20:23], a[192:195], a[24:27], a[20:23]
v_add_f32 v177, v177, v145
s_waitcnt lgkmcnt(6)
v_mfma_f32_16x16x32_bf16 v[80:83], a[196:199], v[112:115], v[156:159]
ds_read_b128 a[224:227], v186 offset:61440
v_add_f32 v177, v177, v146
v_mfma_f32_16x16x32_bf16 v[88:91], a[196:199], v[128:131], v[160:163]
v_exp_f32 v147, v147
v_mfma_f32_16x16x32_bf16 v[80:83], a[200:203], v[116:119], v[80:83]
ds_read_b64_tr_b16 a[180:181], v199 offset:40960
v_cvt_pk_bf16_f32 v153, v146, v147
v_mfma_f32_16x16x32_bf16 v[88:91], a[200:203], v[132:135], v[88:91]
ds_read_b64_tr_b16 a[182:183], v199 offset:45056
s_add_u32 m0, s56, 4096
v_mfma_f32_16x16x32_bf16 v[16:19], a[204:207], v[104:107], v[16:19]
ds_read_b128 a[184:187], v187 offset:61440
buffer_load_dwordx4 v248, s[28:31], s57 offen  lds
v_mfma_f32_16x16x32_bf16 v[20:23], a[204:207], v[108:111], v[20:23]
ds_write_b64 v202, v[152:153] offset:2048
s_waitcnt lgkmcnt(6)
v_mfma_f32_16x16x32_bf16 v[80:83], a[208:211], v[120:123], v[80:83]
ds_read_b64_tr_b16 a[188:189], v200 offset:40960
v_add_f32 v177, v177, v147
v_mfma_f32_16x16x32_bf16 v[88:91], a[208:211], v[136:139], v[88:91]
ds_read_b64_tr_b16 a[190:191], v200 offset:45056
v_exp_f32 v64, v64
v_mfma_f32_16x16x32_bf16 v[24:27], a[212:215], v[104:107], v[24:27]
ds_read_b128 a[192:195], v188 offset:61440
v_exp_f32 v65, v65
v_mfma_f32_16x16x32_bf16 v[28:31], a[212:215], v[108:111], v[28:31]
v_exp_f32 v66, v66
v_mfma_f32_16x16x32_bf16 v[80:83], a[216:219], v[124:127], v[80:83]
ds_read_b64_tr_b16 a[196:197], v201 offset:40960
v_cvt_pk_bf16_f32 v96, v64, v65
v_mfma_f32_16x16x32_bf16 v[88:91], a[216:219], v[140:143], v[88:91]
ds_read_b64_tr_b16 a[198:199], v201 offset:45056
s_waitcnt lgkmcnt(6)
v_mfma_f32_16x16x32_bf16 v[32:35], a[220:223], v[104:107], v[32:35]
ds_read_b128 a[200:203], v189 offset:61440
s_lshl_b32 s44, s39, 1
v_mfma_f32_16x16x32_bf16 v[36:39], a[220:223], v[108:111], v[36:39]
s_add_u32 s44, s44, s53
v_exp_f32 v67, v67
v_mfma_f32_16x16x32_bf16 v[84:87], a[224:227], v[112:115], v[156:159]
ds_read_b64_tr_b16 a[204:205], v194 offset:40960
v_cvt_pk_bf16_f32 v97, v66, v67
v_mfma_f32_16x16x32_bf16 v[92:95], a[224:227], v[128:131], v[160:163]
ds_read_b64_tr_b16 a[206:207], v194 offset:45056
v_exp_f32 v68, v68
v_mfma_f32_16x16x32_bf16 v[40:43], a[180:183], v[104:107], v[40:43]
ds_read_b64_tr_b16 a[208:209], v195 offset:40960
v_exp_f32 v69, v69
v_mfma_f32_16x16x32_bf16 v[44:47], a[180:183], v[108:111], v[44:47]
ds_read_b64_tr_b16 a[210:211], v195 offset:45056
s_waitcnt lgkmcnt(8)
v_mfma_f32_16x16x32_bf16 v[84:87], a[184:187], v[116:119], v[84:87]
v_exp_f32 v70, v70
v_mfma_f32_16x16x32_bf16 v[92:95], a[184:187], v[132:135], v[92:95]
v_cvt_pk_bf16_f32 v98, v68, v69
v_exp_f32 v71, v71
v_mfma_f32_16x16x32_bf16 v[48:51], a[188:191], v[104:107], v[48:51]
s_cmp_lg_u32 s38, 0
s_cbranch_scc1 CE12
s_mov_b32 s5, 0x20000
s_waitcnt vmcnt(5)
CL12:
v_cmp_le_u32 s[66:67], 1, v180
s_nop 1
s_and_b32 s66, s66, 65535
s_cmp_eq_u32 s66, 65535
s_cbranch_scc1 CE12
s_sleep 4
buffer_load_dword v180, v206, s[24:27], s62 offen sc1
s_waitcnt vmcnt(0)
s_sub_u32 s5, s5, 1
s_cbranch_scc0 CL12
CE12:
s_waitcnt vmcnt(5) lgkmcnt(0)
s_barrier
v_mfma_f32_16x16x32_bf16 v[52:55], a[188:191], v[108:111], v[52:55]
ds_read_b64_tr_b16 a[212:213], v196 offset:49152
buffer_load_dwordx4 v249, s[28:31], s57 offen offset:1024  lds
v_mfma_f32_16x16x32_bf16 v[84:87], a[192:195], v[120:123], v[84:87]
ds_read_b64_tr_b16 a[216:217], v197 offset:49152
buffer_load_dwordx4 v250, s[28:31], s57 offen offset:2048  lds
v_mfma_f32_16x16x32_bf16 v[92:95], a[192:195], v[136:139], v[92:95]
ds_read_b64_tr_b16 a[214:215], v196 offset:53248
v_cvt_pk_bf16_f32 v99, v70, v71
v_mfma_f32_16x16x32_bf16 v[56:59], a[196:199], v[104:107], v[56:59]
ds_read_b64_tr_b16 a[218:219], v197 offset:53248
ds_read_b64_tr_b16 a[220:221], v198 offset:49152
v_mfma_f32_16x16x32_bf16 v[60:63], a[196:199], v[108:111], v[60:63]
ds_read_b64_tr_b16 a[222:223], v198 offset:53248
buffer_load_dwordx4 v251, s[28:31], s57 offen offset:3072  lds
v_mfma_f32_16x16x32_bf16 a[232:235], a[228:231], v[104:107], a[232:235]
ds_read_b64_tr_b16 a[224:225], v199 offset:49152
s_add_u32 m0, s56, 8192
v_mfma_f32_16x16x32_bf16 v[84:87], a[200:203], v[124:127], v[84:87]
ds_read_b64_tr_b16 a[226:227], v199 offset:53248
buffer_load_dwordx4 v252, s[28:31], s57 offen  lds
v_mfma_f32_16x16x32_bf16 v[92:95], a[200:203], v[140:143], v[92:95]
ds_read_b64_tr_b16 a[180:181], v200 offset:49152
s_add_u32 s57, s55, 0
v_mfma_f32_16x16x32_bf16 v[0:3], a[204:207], v[104:107], v[0:3]
ds_read_b64_tr_b16 a[182:183], v200 offset:53248
s_and_b32 s57, s57, 3
v_mfma_f32_16x16x32_bf16 v[4:7], a[204:207], v[108:111], v[4:7]
ds_read_b64_tr_b16 a[184:185], v201 offset:49152
s_mul_i32 s57, s57, 73728
v_mfma_f32_16x16x32_bf16 a[16:19], a[204:207], a[28:31], a[16:19]
ds_read_b64_tr_b16 a[186:187], v201 offset:53248
s_add_u32 s57, s57, s60
v_mfma_f32_16x16x32_bf16 a[236:239], a[228:231], v[108:111], a[236:239]
s_lshr_b32 s6, s39, 2
s_add_u32 s57, s57, s6
v_mfma_f32_16x16x32_bf16 v[8:11], a[208:211], v[104:107], v[8:11]
ds_read_b64_tr_b16 a[188:189], v194 offset:49152
s_add_u32 m0, s6, 147456
v_mfma_f32_16x16x32_bf16 v[12:15], a[208:211], v[108:111], v[12:15]
ds_read_b64_tr_b16 a[190:191], v194 offset:53248
s_add_u32 s57, s57, 32768
v_mfma_f32_16x16x32_bf16 a[20:23], a[208:211], a[28:31], a[20:23]
buffer_load_dwordx4 v237, s[24:27], s57 offen sc1 lds
v_exp_f32 v72, v72
v_exp_f32 v73, v73
v_exp_f32 v74, v74
v_cvt_pk_bf16_f32 v100, v72, v73
v_exp_f32 v75, v75
v_exp_f32 v76, v76
v_cvt_pk_bf16_f32 v101, v74, v75
v_exp_f32 v77, v77
v_exp_f32 v78, v78
v_cvt_pk_bf16_f32 v102, v76, v77
v_exp_f32 v79, v79
s_nop 0
v_cvt_pk_bf16_f32 v103, v78, v79
s_waitcnt lgkmcnt(8)
v_mfma_f32_16x16x32_bf16 v[16:19], a[212:215], v[96:99], v[16:19]
ds_read_b64_tr_b16 a[192:193], v195 offset:49152
s_add_u32 s58, s55, 0
v_mfma_f32_16x16x32_bf16 v[20:23], a[212:215], v[100:103], v[20:23]
ds_read_b64_tr_b16 a[194:195], v195 offset:53248
s_and_b32 s58, s58, 3
v_mfma_f32_16x16x32_bf16 v[24:27], a[216:219], v[96:99], v[24:27]
ds_read_b64_tr_b16 a[196:197], v196 offset:57344
s_mul_i32 s58, s58, 73728
v_mfma_f32_16x16x32_bf16 v[28:31], a[216:219], v[100:103], v[28:31]
ds_read_b64_tr_b16 a[198:199], v196 offset:61440
s_add_u32 s58, s58, s60
v_mfma_f32_16x16x32_bf16 v[32:35], a[220:223], v[96:99], v[32:35]
ds_read_b128 a[24:27], v203 offset:2048
s_lshl_b32 s59, s39, 1
v_mfma_f32_16x16x32_bf16 v[36:39], a[220:223], v[100:103], v[36:39]
ds_read_b64_tr_b16 a[200:201], v197 offset:57344
s_waitcnt lgkmcnt(8)
v_mfma_f32_16x16x32_bf16 v[40:43], a[224:227], v[96:99], v[40:43]
ds_read_b64_tr_b16 a[202:203], v197 offset:61440
s_add_u32 s58, s58, s59
v_mfma_f32_16x16x32_bf16 v[44:47], a[224:227], v[100:103], v[44:47]
ds_read_b64_tr_b16 a[204:205], v198 offset:57344
s_add_u32 s59, s58, 4096
v_mfma_f32_16x16x32_bf16 v[48:51], a[180:183], v[96:99], v[48:51]
ds_read_b64_tr_b16 a[206:207], v198 offset:61440
buffer_load_dwordx4 a[48:51], v237, s[24:27], s58 offen offset:0 sc1
v_mfma_f32_16x16x32_bf16 v[52:55], a[180:183], v[100:103], v[52:55]
ds_read_b64_tr_b16 a[208:209], v199 offset:57344
buffer_load_dwordx4 a[52:55], v237, s[24:27], s59 offen offset:0 sc1
v_mfma_f32_16x16x32_bf16 a[232:235], a[228:231], v[96:99], a[232:235]
ds_read_b64_tr_b16 a[210:211], v199 offset:61440
buffer_load_dwordx4 a[56:59], v237, s[24:27], s58 offen offset:1024 sc1
v_mfma_f32_16x16x32_bf16 v[56:59], a[184:187], v[96:99], v[56:59]
ds_read_b64_tr_b16 a[212:213], v200 offset:57344
buffer_load_dwordx4 a[60:63], v237, s[24:27], s59 offen offset:1024 sc1
v_mfma_f32_16x16x32_bf16 v[60:63], a[184:187], v[100:103], v[60:63]
ds_read_b64_tr_b16 a[214:215], v200 offset:61440
s_waitcnt lgkmcnt(8)
v_mfma_f32_16x16x32_bf16 v[0:3], a[188:191], v[96:99], v[0:3]
ds_read_b64_tr_b16 a[216:217], v201 offset:57344
buffer_load_dwordx4 a[64:67], v237, s[24:27], s58 offen offset:2048 sc1
v_mfma_f32_16x16x32_bf16 v[4:7], a[188:191], v[100:103], v[4:7]
ds_read_b64_tr_b16 a[218:219], v201 offset:61440
buffer_load_dwordx4 a[68:71], v237, s[24:27], s59 offen offset:2048 sc1
v_mfma_f32_16x16x32_bf16 a[16:19], a[188:191], a[24:27], a[16:19]
ds_read_b128 a[28:31], v203 offset:3072
buffer_load_dwordx4 a[72:75], v237, s[24:27], s58 offen offset:3072 sc1
v_mfma_f32_16x16x32_bf16 a[236:239], a[228:231], v[100:103], a[236:239]
v_exp_f32 v80, v80
v_mfma_f32_16x16x32_bf16 v[8:11], a[192:195], v[96:99], v[8:11]
ds_read_b64_tr_b16 a[220:221], v194 offset:57344
buffer_load_dwordx4 a[76:79], v237, s[24:27], s59 offen offset:3072 sc1
v_mfma_f32_16x16x32_bf16 v[12:15], a[192:195], v[100:103], v[12:15]
ds_read_b64_tr_b16 a[222:223], v194 offset:61440
v_exp_f32 v81, v81
v_exp_f32 v82, v82
v_cvt_pk_bf16_f32 v104, v80, v81
v_exp_f32 v83, v83
v_exp_f32 v84, v84
v_cvt_pk_bf16_f32 v105, v82, v83
v_exp_f32 v85, v85
v_exp_f32 v86, v86
v_cvt_pk_bf16_f32 v106, v84, v85
v_exp_f32 v87, v87
v_exp_f32 v88, v88
v_cvt_pk_bf16_f32 v107, v86, v87
v_exp_f32 v89, v89
v_exp_f32 v90, v90
v_cvt_pk_bf16_f32 v108, v88, v89
v_exp_f32 v91, v91
v_exp_f32 v92, v92
v_cvt_pk_bf16_f32 v109, v90, v91
v_exp_f32 v93, v93
v_exp_f32 v94, v94
v_cvt_pk_bf16_f32 v110, v92, v93
v_exp_f32 v95, v95
s_nop 0
v_cvt_pk_bf16_f32 v111, v94, v95
v_mfma_f32_16x16x32_bf16 a[20:23], a[192:195], a[24:27], a[20:23]
s_add_u32 s57, s55, 1
s_and_b32 s57, s57, 3
v_mfma_f32_16x16x32_bf16 v[16:19], a[196:199], v[104:107], v[16:19]
ds_read_b64_tr_b16 a[224:225], v195 offset:57344
v_mfma_f32_16x16x32_bf16 v[20:23], a[196:199], v[108:111], v[20:23]
ds_read_b64_tr_b16 a[226:227], v195 offset:61440
s_mul_i32 s57, s57, 294912
v_mfma_f32_16x16x32_bf16 a[232:235], a[228:231], v[104:107], a[232:235]
s_add_u32 s57, s57, s61
s_add_u32 m0, s56, 36864
v_mfma_f32_16x16x32_bf16 a[236:239], a[228:231], v[108:111], a[236:239]
buffer_load_dwordx4 v244, s[28:31], s57 offen  lds
s_waitcnt lgkmcnt(9)
v_mfma_f32_16x16x32_bf16 v[24:27], a[200:203], v[104:107], v[24:27]
buffer_load_dwordx4 v245, s[28:31], s57 offen offset:1024  lds
v_mfma_f32_16x16x32_bf16 v[28:31], a[200:203], v[108:111], v[28:31]
v_mfma_f32_16x16x32_bf16 v[32:35], a[204:207], v[104:107], v[32:35]
buffer_load_dwordx4 v246, s[28:31], s57 offen offset:2048  lds
v_mfma_f32_16x16x32_bf16 v[36:39], a[204:207], v[108:111], v[36:39]
v_mfma_f32_16x16x32_bf16 v[40:43], a[208:211], v[104:107], v[40:43]
buffer_load_dwordx4 v247, s[28:31], s57 offen offset:3072  lds
v_mfma_f32_16x16x32_bf16 v[44:47], a[208:211], v[108:111], v[44:47]
v_accvgpr_read_b32 v176, a232
s_waitcnt lgkmcnt(2)
v_mfma_f32_16x16x32_bf16 v[48:51], a[212:215], v[104:107], v[48:51]
s_add_u32 m0, s56, 40960
s_nop 0
buffer_load_dwordx4 v248, s[28:31], s57 offen  lds
v_mfma_f32_16x16x32_bf16 v[52:55], a[212:215], v[108:111], v[52:55]
buffer_load_dwordx4 v249, s[28:31], s57 offen offset:1024  lds
v_mfma_f32_16x16x32_bf16 v[56:59], a[216:219], v[104:107], v[56:59]
v_accvgpr_read_b32 v144, a236
v_rcp_f32 v180, v176
v_mfma_f32_16x16x32_bf16 v[60:63], a[216:219], v[108:111], v[60:63]
buffer_load_dwordx4 v250, s[28:31], s57 offen offset:2048  lds
v_mfma_f32_16x16x32_bf16 v[0:3], a[220:223], v[104:107], v[0:3]
v_rcp_f32 v182, v144
v_mfma_f32_16x16x32_bf16 v[4:7], a[220:223], v[108:111], v[4:7]
buffer_load_dwordx4 v251, s[28:31], s57 offen offset:3072  lds
v_mfma_f32_16x16x32_bf16 a[16:19], a[220:223], a[28:31], a[16:19]
s_waitcnt lgkmcnt(0)
v_mfma_f32_16x16x32_bf16 v[8:11], a[224:227], v[104:107], v[8:11]
s_add_u32 m0, s56, 45056
s_nop 0
buffer_load_dwordx4 v252, s[28:31], s57 offen  lds
v_mfma_f32_16x16x32_bf16 v[12:15], a[224:227], v[108:111], v[12:15]
v_mfma_f32_16x16x32_bf16 a[20:23], a[224:227], a[28:31], a[20:23]
v_mov_b32 v184, v177
s_mov_b32 s3, 0x4e800000
s_mov_b32 s7, 0x30800000
v_permlane16_swap_b32 v177, v184
v_add_f32 v177, v177, v184
v_max_f32 v145, v176, v144
v_mov_b32 v184, v177
v_cmp_nle_f32 s[66:67], s7, v176
v_cmp_nle_f32 vcc, s7, v144
v_permlane32_swap_b32 v177, v184
v_add_f32 v177, v177, v184
s_or_b64 s[66:67], vcc, s[66:67]
v_max_f32 v145, v145, v177
v_cmp_nge_f32 vcc, s3, v145
ds_write_b32 v240, v177 offset:0
s_or_b64 vcc, vcc, s[66:67]
s_cselect_b32 s3, 1, 0
v_mov_b32 v184, s3
ds_write_b32 v240, v184 offset:256
s_add_u32 s6, s38, 1
s_and_b32 s6, s6, 3
s_lshl_b32 s6, s6, 10
s_add_u32 s6, s6, s44
v_pk_mul_f32 v[16:17], v[16:17], v[180:181] op_sel_hi:[1,0]
v_pk_mul_f32 v[18:19], v[18:19], v[180:181] op_sel_hi:[1,0]
v_pk_mul_f32 v[24:25], v[24:25], v[180:181] op_sel_hi:[1,0]
v_pk_mul_f32 v[26:27], v[26:27], v[180:181] op_sel_hi:[1,0]
v_cvt_pk_bf16_f32 v72, v16, v17
v_cvt_pk_bf16_f32 v73, v18, v19
v_cvt_pk_bf16_f32 v74, v24, v25
v_cvt_pk_bf16_f32 v75, v26, v27
v_accvgpr_write_b32 a188, v72
v_accvgpr_write_b32 a189, v73
v_accvgpr_write_b32 a190, v74
v_accvgpr_write_b32 a191, v75
v_pk_mul_f32 v[20:21], v[20:21], v[182:183] op_sel_hi:[1,0]
v_pk_mul_f32 v[22:23], v[22:23], v[182:183] op_sel_hi:[1,0]
v_pk_mul_f32 v[28:29], v[28:29], v[182:183] op_sel_hi:[1,0]
v_pk_mul_f32 v[30:31], v[30:31], v[182:183] op_sel_hi:[1,0]
v_cvt_pk_bf16_f32 v76, v20, v21
v_cvt_pk_bf16_f32 v77, v22, v23
v_cvt_pk_bf16_f32 v78, v28, v29
v_cvt_pk_bf16_f32 v79, v30, v31
v_accvgpr_write_b32 a192, v76
v_accvgpr_write_b32 a193, v77
v_accvgpr_write_b32 a194, v78
v_accvgpr_write_b32 a195, v79
s_add_u32 s6, s38, 2
s_and_b32 s6, s6, 3
s_lshl_b32 s6, s6, 10
s_add_u32 s6, s6, s44
v_pk_mul_f32 v[32:33], v[32:33], v[180:181] op_sel_hi:[1,0]
v_pk_mul_f32 v[34:35], v[34:35], v[180:181] op_sel_hi:[1,0]
v_pk_mul_f32 v[40:41], v[40:41], v[180:181] op_sel_hi:[1,0]
v_pk_mul_f32 v[42:43], v[42:43], v[180:181] op_sel_hi:[1,0]
v_cvt_pk_bf16_f32 v80, v32, v33
v_cvt_pk_bf16_f32 v81, v34, v35
v_cvt_pk_bf16_f32 v82, v40, v41
v_cvt_pk_bf16_f32 v83, v42, v43
v_accvgpr_write_b32 a196, v80
v_accvgpr_write_b32 a197, v81
v_accvgpr_write_b32 a198, v82
v_accvgpr_write_b32 a199, v83
v_pk_mul_f32 v[36:37], v[36:37], v[182:183] op_sel_hi:[1,0]
v_pk_mul_f32 v[38:39], v[38:39], v[182:183] op_sel_hi:[1,0]
v_pk_mul_f32 v[44:45], v[44:45], v[182:183] op_sel_hi:[1,0]
v_pk_mul_f32 v[46:47], v[46:47], v[182:183] op_sel_hi:[1,0]
v_cvt_pk_bf16_f32 v84, v36, v37
v_cvt_pk_bf16_f32 v85, v38, v39
v_cvt_pk_bf16_f32 v86, v44, v45
v_cvt_pk_bf16_f32 v87, v46, v47
v_accvgpr_write_b32 a200, v84
v_accvgpr_write_b32 a201, v85
v_accvgpr_write_b32 a202, v86
v_accvgpr_write_b32 a203, v87
s_waitcnt lgkmcnt(0)
s_barrier
ds_read_b128 v[96:99], v241 offset:0
ds_read_b128 v[100:103], v241 offset:256
s_add_u32 s6, s38, 3
s_and_b32 s6, s6, 3
s_lshl_b32 s6, s6, 10
s_add_u32 s6, s6, s44
v_pk_mul_f32 v[48:49], v[48:49], v[180:181] op_sel_hi:[1,0]
v_pk_mul_f32 v[50:51], v[50:51], v[180:181] op_sel_hi:[1,0]
v_pk_mul_f32 v[56:57], v[56:57], v[180:181] op_sel_hi:[1,0]
v_pk_mul_f32 v[58:59], v[58:59], v[180:181] op_sel_hi:[1,0]
v_cvt_pk_bf16_f32 v88, v48, v49
v_cvt_pk_bf16_f32 v89, v50, v51
v_cvt_pk_bf16_f32 v90, v56, v57
v_cvt_pk_bf16_f32 v91, v58, v59
v_accvgpr_write_b32 a204, v88
v_accvgpr_write_b32 a205, v89
v_accvgpr_write_b32 a206, v90
v_accvgpr_write_b32 a207, v91
v_pk_mul_f32 v[52:53], v[52:53], v[182:183] op_sel_hi:[1,0]
v_pk_mul_f32 v[54:55], v[54:55], v[182:183] op_sel_hi:[1,0]
v_pk_mul_f32 v[60:61], v[60:61], v[182:183] op_sel_hi:[1,0]
v_pk_mul_f32 v[62:63], v[62:63], v[182:183] op_sel_hi:[1,0]
v_cvt_pk_bf16_f32 v92, v52, v53
v_cvt_pk_bf16_f32 v93, v54, v55
v_cvt_pk_bf16_f32 v94, v60, v61
v_cvt_pk_bf16_f32 v95, v62, v63
v_accvgpr_write_b32 a208, v92
v_accvgpr_write_b32 a209, v93
v_accvgpr_write_b32 a210, v94
v_accvgpr_write_b32 a211, v95
s_add_u32 s6, s38, 0
s_and_b32 s6, s6, 3
s_lshl_b32 s6, s6, 10
s_add_u32 s6, s6, s44
v_pk_mul_f32 v[0:1], v[0:1], v[180:181] op_sel_hi:[1,0]
v_pk_mul_f32 v[2:3], v[2:3], v[180:181] op_sel_hi:[1,0]
v_pk_mul_f32 v[8:9], v[8:9], v[180:181] op_sel_hi:[1,0]
v_pk_mul_f32 v[10:11], v[10:11], v[180:181] op_sel_hi:[1,0]
v_cvt_pk_bf16_f32 v64, v0, v1
v_cvt_pk_bf16_f32 v65, v2, v3
v_cvt_pk_bf16_f32 v66, v8, v9
v_cvt_pk_bf16_f32 v67, v10, v11
v_accvgpr_write_b32 a180, v64
v_accvgpr_write_b32 a181, v65
v_accvgpr_write_b32 a182, v66
v_accvgpr_write_b32 a183, v67
v_pk_mul_f32 v[4:5], v[4:5], v[182:183] op_sel_hi:[1,0]
v_pk_mul_f32 v[6:7], v[6:7], v[182:183] op_sel_hi:[1,0]
v_pk_mul_f32 v[12:13], v[12:13], v[182:183] op_sel_hi:[1,0]
v_pk_mul_f32 v[14:15], v[14:15], v[182:183] op_sel_hi:[1,0]
v_cvt_pk_bf16_f32 v68, v4, v5
v_cvt_pk_bf16_f32 v69, v6, v7
v_cvt_pk_bf16_f32 v70, v12, v13
v_cvt_pk_bf16_f32 v71, v14, v15
v_accvgpr_write_b32 a184, v68
v_accvgpr_write_b32 a185, v69
v_accvgpr_write_b32 a186, v70
v_accvgpr_write_b32 a187, v71
v_accvgpr_read_b32 v16, a16
v_accvgpr_read_b32 v17, a17
v_accvgpr_read_b32 v18, a18
v_accvgpr_read_b32 v19, a19
v_accvgpr_read_b32 v20, a20
v_accvgpr_read_b32 v21, a21
v_accvgpr_read_b32 v22, a22
v_accvgpr_read_b32 v23, a23
s_waitcnt lgkmcnt(1)
v_add_f32 v96, v96, v97
v_add_f32 v98, v98, v99
s_waitcnt lgkmcnt(0)
v_or_b32 v100, v100, v101
v_add_f32 v96, v96, v98
v_or3_b32 v100, v100, v102, v103
v_cmp_nle_f32 vcc, s7, v96
v_cmp_ne_u32 s[66:67], 0, v100
v_rcp_f32 v98, v96
s_lshr_b32 s6, s39, 2
s_add_u32 s6, s6, s53
s_or_b64 vcc, vcc, s[66:67]
s_cselect_b32 s3, 1, 0
s_cmp_gt_u32 s3, s54
s_cbranch_scc1 SLOW11
v_mul_f32 v16, v16, v98
v_mul_f32 v17, v17, v98
v_mul_f32 v18, v18, v98
v_mul_f32 v19, v19, v98
v_mul_f32 v20, v20, v98
v_mul_f32 v21, v21, v98
v_mul_f32 v22, v22, v98
v_mul_f32 v23, v23, v98
v_cvt_pk_bf16_f32 v16, v16, v17
v_cvt_pk_bf16_f32 v17, v18, v19
v_cvt_pk_bf16_f32 v18, v20, v21
v_cvt_pk_bf16_f32 v19, v22, v23
v_accvgpr_write_b32 a212, v16
v_accvgpr_write_b32 a213, v17
v_accvgpr_write_b32 a214, v18
v_accvgpr_write_b32 a215, v19
s_add_u32 s45, s6, 32768
s_add_u32 s41, s41, 131072
s_add_u32 s53, s53, 36864
s_add_u32 s42, s41, 4294950912
s_mov_b32 s43, s42
v_lshrrev_b32 v178, 2, v242
v_mul_u32_u24 v178, 288, v178
v_and_b32 v179, 3, v242
v_lshl_add_u32 v178, v179, 3, v178
s_lshl_b32 s6, s38, 6
v_add_u32 v178, s6, v178
v_add_u32 v73, 147456, v237
v_add_u32 v64, 0, v178
v_add_u32 v65, 32, v178
v_add_u32 v66, 64, v178
s_cmp_ge_u32 s38, 3
s_cselect_b32 s3, 4294967008, 0
s_add_u32 s3, s3, 96
v_add_u32 v67, s3, v178
s_cmp_ge_u32 s38, 3
s_cselect_b32 s3, 4294967008, 0
s_add_u32 s3, s3, 128
v_add_u32 v68, s3, v178
s_cmp_ge_u32 s38, 2
s_cselect_b32 s3, 4294967008, 0
s_add_u32 s3, s3, 160
v_add_u32 v69, s3, v178
s_cmp_ge_u32 s38, 2
s_cselect_b32 s3, 4294967008, 0
s_add_u32 s3, s3, 192
v_add_u32 v70, s3, v178
s_cmp_ge_u32 s38, 1
s_cselect_b32 s3, 4294967008, 0
s_add_u32 s3, s3, 224
v_add_u32 v71, s3, v178
s_cmp_ge_u32 s38, 1
s_cselect_b32 s3, 4294967008, 0
s_add_u32 s3, s3, 256
v_add_u32 v72, s3, v178
s_cmp_eq_u32 s38, 3
s_cselect_b64 vcc, -1, 0
s_waitcnt vmcnt(17) lgkmcnt(0)
s_barrier
s_waitcnt vmcnt(15)
ds_read_b64_tr_b16 v[0:1], v64 offset:0
ds_read_b64_tr_b16 v[2:3], v64 offset:4608
ds_read_b128 v[76:79], v73 offset:0
ds_read_b64_tr_b16 v[4:5], v65 offset:0
ds_read_b64_tr_b16 v[6:7], v65 offset:4608
ds_read_b64_tr_b16 v[8:9], v66 offset:0
ds_read_b64_tr_b16 v[10:11], v66 offset:4608
ds_read_b64_tr_b16 v[12:13], v67 offset:0
ds_read_b64_tr_b16 v[14:15], v67 offset:4608
ds_read_b64_tr_b16 v[16:17], v68 offset:0
ds_read_b64_tr_b16 v[18:19], v68 offset:4608
ds_read_b64_tr_b16 v[20:21], v69 offset:0
ds_read_b64_tr_b16 v[22:23], v69 offset:4608
ds_read_b64_tr_b16 v[24:25], v70 offset:0
ds_read_b64_tr_b16 v[26:27], v70 offset:4608
s_waitcnt lgkmcnt(10)
v_mfma_f32_16x16x32_bf16 v[96:99], v[0:3], a[48:51], 0
ds_read_b64_tr_b16 v[28:29], v71 offset:0
s_add_u32 s57, s55, 1
v_mfma_f32_16x16x32_bf16 v[100:103], v[0:3], a[52:55], 0
ds_read_b64_tr_b16 v[30:31], v71 offset:4608
s_and_b32 s57, s57, 3
v_mfma_f32_16x16x32_bf16 v[168:171], v[0:3], v[76:79], 0
s_mul_i32 s57, s57, 73728
s_add_u32 s57, s57, s60
v_mfma_f32_16x16x32_bf16 v[104:107], v[4:7], a[48:51], 0
ds_read_b64_tr_b16 v[0:1], v72 offset:0
s_lshr_b32 s6, s39, 2
v_mfma_f32_16x16x32_bf16 v[108:111], v[4:7], a[52:55], 0
ds_read_b64_tr_b16 v[2:3], v72 offset:4608
s_add_u32 s57, s57, s6
s_add_u32 m0, s6, 151552
s_add_u32 s57, s57, 32768
buffer_load_dwordx4 v237, s[24:27], s57 offen sc1 lds
v_mfma_f32_16x16x32_bf16 v[172:175], v[4:7], v[76:79], 0
s_add_u32 s58, s55, 1
s_waitcnt lgkmcnt(10)
v_mfma_f32_16x16x32_bf16 v[112:115], v[8:11], a[48:51], 0
ds_read_b64_tr_b16 v[4:5], v64 offset:9216
s_and_b32 s58, s58, 3
v_mfma_f32_16x16x32_bf16 v[116:119], v[8:11], a[52:55], 0
ds_read_b64_tr_b16 v[6:7], v64 offset:13824
s_mul_i32 s58, s58, 73728
s_add_u32 s58, s58, s60
s_lshl_b32 s59, s39, 1
s_add_u32 s58, s58, s59
s_add_u32 s59, s58, 4096
buffer_load_dwordx4 a[80:83], v237, s[24:27], s58 offen offset:0 sc1
v_mfma_f32_16x16x32_bf16 v[60:63], v[8:11], v[76:79], 0
ds_read_b128 v[80:83], v73 offset:1024
v_mfma_f32_16x16x32_bf16 v[120:123], v[12:15], a[48:51], 0
ds_read_b64_tr_b16 v[8:9], v65 offset:9216
buffer_load_dwordx4 a[84:87], v237, s[24:27], s59 offen offset:0 sc1
v_mfma_f32_16x16x32_bf16 v[124:127], v[12:15], a[52:55], 0
ds_read_b64_tr_b16 v[10:11], v65 offset:13824
s_waitcnt lgkmcnt(9)
v_mfma_f32_16x16x32_bf16 v[128:131], v[16:19], a[48:51], 0
ds_read_b64_tr_b16 v[12:13], v66 offset:9216
v_mfma_f32_16x16x32_bf16 v[132:135], v[16:19], a[52:55], 0
ds_read_b64_tr_b16 v[14:15], v66 offset:13824
buffer_load_dwordx4 a[88:91], v237, s[24:27], s58 offen offset:1024 sc1
v_mfma_f32_16x16x32_bf16 v[136:139], v[20:23], a[48:51], 0
ds_read_b64_tr_b16 v[16:17], v67 offset:9216
v_mfma_f32_16x16x32_bf16 v[140:143], v[20:23], a[52:55], 0
ds_read_b64_tr_b16 v[18:19], v67 offset:13824
v_mfma_f32_16x16x32_bf16 v[144:147], v[24:27], a[48:51], 0
ds_read_b64_tr_b16 v[20:21], v68 offset:9216
v_mfma_f32_16x16x32_bf16 v[148:151], v[24:27], a[52:55], 0
ds_read_b64_tr_b16 v[22:23], v68 offset:13824
s_waitcnt lgkmcnt(9)
v_mfma_f32_16x16x32_bf16 v[152:155], v[28:31], a[48:51], 0
ds_read_b64_tr_b16 v[24:25], v69 offset:9216
buffer_load_dwordx4 a[92:95], v237, s[24:27], s59 offen offset:1024 sc1
v_mfma_f32_16x16x32_bf16 v[156:159], v[28:31], a[52:55], 0
ds_read_b64_tr_b16 v[26:27], v69 offset:13824
v_mfma_f32_16x16x32_bf16 v[160:163], v[0:3], a[48:51], 0
ds_read_b64_tr_b16 v[28:29], v70 offset:9216
v_mfma_f32_16x16x32_bf16 v[164:167], v[0:3], a[52:55], 0
ds_read_b64_tr_b16 v[30:31], v70 offset:13824
s_waitcnt vmcnt(18)
v_mfma_f32_16x16x32_bf16 v[96:99], v[4:7], a[56:59], v[96:99]
ds_read_b64_tr_b16 v[0:1], v71 offset:9216
buffer_load_dwordx4 a[96:99], v237, s[24:27], s58 offen offset:2048 sc1
v_mfma_f32_16x16x32_bf16 v[100:103], v[4:7], a[60:63], v[100:103]
ds_read_b64_tr_b16 v[2:3], v71 offset:13824
s_waitcnt lgkmcnt(10)
v_mfma_f32_16x16x32_bf16 v[168:171], v[4:7], v[80:83], v[168:171]
buffer_load_dwordx4 a[100:103], v237, s[24:27], s59 offen offset:2048 sc1
v_mfma_f32_16x16x32_bf16 v[104:107], v[8:11], a[56:59], v[104:107]
ds_read_b64_tr_b16 v[4:5], v72 offset:9216
v_mfma_f32_16x16x32_bf16 v[108:111], v[8:11], a[60:63], v[108:111]
ds_read_b64_tr_b16 v[6:7], v72 offset:13824
v_mfma_f32_16x16x32_bf16 v[172:175], v[8:11], v[80:83], v[172:175]
v_mfma_f32_16x16x32_bf16 v[112:115], v[12:15], a[56:59], v[112:115]
ds_read_b64_tr_b16 v[8:9], v64 offset:18432
buffer_load_dwordx4 a[104:107], v237, s[24:27], s58 offen offset:3072 sc1
v_mfma_f32_16x16x32_bf16 v[116:119], v[12:15], a[60:63], v[116:119]
ds_read_b64_tr_b16 v[10:11], v64 offset:23040
v_mfma_f32_16x16x32_bf16 v[60:63], v[12:15], v[80:83], v[60:63]
ds_read_b128 v[76:79], v73 offset:2048
s_waitcnt lgkmcnt(9)
v_mfma_f32_16x16x32_bf16 v[120:123], v[16:19], a[56:59], v[120:123]
ds_read_b64_tr_b16 v[12:13], v65 offset:18432
v_mfma_f32_16x16x32_bf16 v[124:127], v[16:19], a[60:63], v[124:127]
ds_read_b64_tr_b16 v[14:15], v65 offset:23040
buffer_load_dwordx4 a[108:111], v237, s[24:27], s59 offen offset:3072 sc1
v_mfma_f32_16x16x32_bf16 v[128:131], v[20:23], a[56:59], v[128:131]
ds_read_b64_tr_b16 v[16:17], v66 offset:18432
s_add_u32 s57, s55, 2
v_mfma_f32_16x16x32_bf16 v[132:135], v[20:23], a[60:63], v[132:135]
ds_read_b64_tr_b16 v[18:19], v66 offset:23040
s_and_b32 s57, s57, 3
v_mfma_f32_16x16x32_bf16 v[136:139], v[24:27], a[56:59], v[136:139]
ds_read_b64_tr_b16 v[20:21], v67 offset:18432
s_mul_i32 s57, s57, 294912
v_mfma_f32_16x16x32_bf16 v[140:143], v[24:27], a[60:63], v[140:143]
ds_read_b64_tr_b16 v[22:23], v67 offset:23040
s_waitcnt lgkmcnt(9)
v_mfma_f32_16x16x32_bf16 v[144:147], v[28:31], a[56:59], v[144:147]
ds_read_b64_tr_b16 v[24:25], v68 offset:18432
s_add_u32 s57, s57, s61
s_add_u32 m0, s56, 73728
s_nop 0
buffer_load_dwordx4 v244, s[28:31], s57 offen  lds
v_mfma_f32_16x16x32_bf16 v[148:151], v[28:31], a[60:63], v[148:151]
ds_read_b64_tr_b16 v[26:27], v68 offset:23040
v_mfma_f32_16x16x32_bf16 v[152:155], v[0:3], a[56:59], v[152:155]
ds_read_b64_tr_b16 v[28:29], v69 offset:18432
buffer_load_dwordx4 v245, s[28:31], s57 offen offset:1024  lds
v_mfma_f32_16x16x32_bf16 v[156:159], v[0:3], a[60:63], v[156:159]
ds_read_b64_tr_b16 v[30:31], v69 offset:23040
v_mfma_f32_16x16x32_bf16 v[160:163], v[4:7], a[56:59], v[160:163]
ds_read_b64_tr_b16 v[0:1], v70 offset:18432
v_mfma_f32_16x16x32_bf16 v[164:167], v[4:7], a[60:63], v[164:167]
ds_read_b64_tr_b16 v[2:3], v70 offset:23040
s_waitcnt vmcnt(22) lgkmcnt(10)
v_mfma_f32_16x16x32_bf16 v[96:99], v[8:11], a[64:67], v[96:99]
ds_read_b64_tr_b16 v[4:5], v71 offset:18432
buffer_load_dwordx4 v246, s[28:31], s57 offen offset:2048  lds
v_mfma_f32_16x16x32_bf16 v[100:103], v[8:11], a[68:71], v[100:103]
ds_read_b64_tr_b16 v[6:7], v71 offset:23040
v_mfma_f32_16x16x32_bf16 v[168:171], v[8:11], v[76:79], v[168:171]
v_mfma_f32_16x16x32_bf16 v[104:107], v[12:15], a[64:67], v[104:107]
ds_read_b64_tr_b16 v[8:9], v72 offset:18432
buffer_load_dwordx4 v247, s[28:31], s57 offen offset:3072  lds
v_mfma_f32_16x16x32_bf16 v[108:111], v[12:15], a[68:71], v[108:111]
ds_read_b64_tr_b16 v[10:11], v72 offset:23040
v_mfma_f32_16x16x32_bf16 v[172:175], v[12:15], v[76:79], v[172:175]
s_waitcnt lgkmcnt(10)
v_mfma_f32_16x16x32_bf16 v[112:115], v[16:19], a[64:67], v[112:115]
ds_read_b64_tr_b16 v[12:13], v64 offset:27648
s_add_u32 m0, s56, 77824
v_mfma_f32_16x16x32_bf16 v[116:119], v[16:19], a[68:71], v[116:119]
ds_read_b64_tr_b16 v[14:15], v64 offset:32256
buffer_load_dwordx4 v248, s[28:31], s57 offen  lds
v_mfma_f32_16x16x32_bf16 v[60:63], v[16:19], v[76:79], v[60:63]
ds_read_b128 v[80:83], v73 offset:3072
v_mfma_f32_16x16x32_bf16 v[120:123], v[20:23], a[64:67], v[120:123]
ds_read_b64_tr_b16 v[16:17], v65 offset:27648
v_mfma_f32_16x16x32_bf16 v[124:127], v[20:23], a[68:71], v[124:127]
ds_read_b64_tr_b16 v[18:19], v65 offset:32256
s_waitcnt lgkmcnt(9)
v_mfma_f32_16x16x32_bf16 v[128:131], v[24:27], a[64:67], v[128:131]
ds_read_b64_tr_b16 v[20:21], v66 offset:27648
buffer_load_dwordx4 v249, s[28:31], s57 offen offset:1024  lds
v_mfma_f32_16x16x32_bf16 v[132:135], v[24:27], a[68:71], v[132:135]
ds_read_b64_tr_b16 v[22:23], v66 offset:32256
v_mfma_f32_16x16x32_bf16 v[136:139], v[28:31], a[64:67], v[136:139]
ds_read_b64_tr_b16 v[24:25], v67 offset:27648
v_mfma_f32_16x16x32_bf16 v[140:143], v[28:31], a[68:71], v[140:143]
ds_read_b64_tr_b16 v[26:27], v67 offset:32256
buffer_load_dwordx4 v250, s[28:31], s57 offen offset:2048  lds
v_mfma_f32_16x16x32_bf16 v[144:147], v[0:3], a[64:67], v[144:147]
ds_read_b64_tr_b16 v[28:29], v68 offset:27648
v_mfma_f32_16x16x32_bf16 v[148:151], v[0:3], a[68:71], v[148:151]
ds_read_b64_tr_b16 v[30:31], v68 offset:32256
s_waitcnt lgkmcnt(9)
v_mfma_f32_16x16x32_bf16 v[152:155], v[4:7], a[64:67], v[152:155]
ds_read_b64_tr_b16 v[0:1], v69 offset:27648
v_mfma_f32_16x16x32_bf16 v[156:159], v[4:7], a[68:71], v[156:159]
ds_read_b64_tr_b16 v[2:3], v69 offset:32256
buffer_load_dwordx4 v251, s[28:31], s57 offen offset:3072  lds
v_mfma_f32_16x16x32_bf16 v[160:163], v[8:11], a[64:67], v[160:163]
ds_read_b64_tr_b16 v[4:5], v70 offset:27648
v_mfma_f32_16x16x32_bf16 v[164:167], v[8:11], a[68:71], v[164:167]
ds_read_b64_tr_b16 v[6:7], v70 offset:32256
s_waitcnt vmcnt(26)
v_mfma_f32_16x16x32_bf16 v[96:99], v[12:15], a[72:75], v[96:99]
ds_read_b64_tr_b16 v[8:9], v71 offset:27648
s_add_u32 m0, s56, 81920
v_mfma_f32_16x16x32_bf16 v[100:103], v[12:15], a[76:79], v[100:103]
ds_read_b64_tr_b16 v[10:11], v71 offset:32256
s_waitcnt lgkmcnt(10)
v_mfma_f32_16x16x32_bf16 v[168:171], v[12:15], v[80:83], v[168:171]
buffer_load_dwordx4 v252, s[28:31], s57 offen  lds
v_mfma_f32_16x16x32_bf16 v[104:107], v[16:19], a[72:75], v[104:107]
ds_read_b64_tr_b16 v[12:13], v72 offset:27648
s_add_u32 s57, s55, 2
v_mfma_f32_16x16x32_bf16 v[108:111], v[16:19], a[76:79], v[108:111]
ds_read_b64_tr_b16 v[14:15], v72 offset:32256
s_and_b32 s57, s57, 3
v_mfma_f32_16x16x32_bf16 v[172:175], v[16:19], v[80:83], v[172:175]
s_mul_i32 s57, s57, 73728
s_add_u32 s57, s57, s60
s_lshr_b32 s6, s39, 2
s_add_u32 s57, s57, s6
s_add_u32 m0, s6, 155648
s_add_u32 s57, s57, 32768
buffer_load_dwordx4 v237, s[24:27], s57 offen sc1 lds
v_mfma_f32_16x16x32_bf16 v[112:115], v[20:23], a[72:75], v[112:115]
s_waitcnt vmcnt(18)
s_barrier
v_mfma_f32_16x16x32_bf16 v[116:119], v[20:23], a[76:79], v[116:119]
ds_read_b64_tr_b16 v[16:17], v64 offset:36864
s_add_u32 s58, s55, 2
v_mfma_f32_16x16x32_bf16 v[60:63], v[20:23], v[80:83], v[60:63]
ds_read_b64_tr_b16 v[18:19], v64 offset:41472
ds_read_b128 v[76:79], v73 offset:4096
s_waitcnt lgkmcnt(9)
v_mfma_f32_16x16x32_bf16 v[120:123], v[24:27], a[72:75], v[120:123]
ds_read_b64_tr_b16 v[20:21], v65 offset:36864
s_and_b32 s58, s58, 3
v_mfma_f32_16x16x32_bf16 v[124:127], v[24:27], a[76:79], v[124:127]
ds_read_b64_tr_b16 v[22:23], v65 offset:41472
s_mul_i32 s58, s58, 73728
s_add_u32 s58, s58, s60
s_lshl_b32 s59, s39, 1
s_add_u32 s58, s58, s59
s_add_u32 s59, s58, 4096
buffer_load_dwordx4 a[112:115], v237, s[24:27], s58 offen offset:0 sc1
v_mfma_f32_16x16x32_bf16 v[128:131], v[28:31], a[72:75], v[128:131]
ds_read_b64_tr_b16 v[24:25], v66 offset:36864
buffer_load_dwordx4 a[116:119], v237, s[24:27], s59 offen offset:0 sc1
v_mfma_f32_16x16x32_bf16 v[132:135], v[28:31], a[76:79], v[132:135]
ds_read_b64_tr_b16 v[26:27], v66 offset:41472
v_mfma_f32_16x16x32_bf16 v[136:139], v[0:3], a[72:75], v[136:139]
ds_read_b64_tr_b16 v[28:29], v67 offset:36864
v_mfma_f32_16x16x32_bf16 v[140:143], v[0:3], a[76:79], v[140:143]
ds_read_b64_tr_b16 v[30:31], v67 offset:41472
s_waitcnt lgkmcnt(9)
v_mfma_f32_16x16x32_bf16 v[144:147], v[4:7], a[72:75], v[144:147]
ds_read_b64_tr_b16 v[0:1], v68 offset:36864
buffer_load_dwordx4 a[120:123], v237, s[24:27], s58 offen offset:1024 sc1
v_mfma_f32_16x16x32_bf16 v[148:151], v[4:7], a[76:79], v[148:151]
ds_read_b64_tr_b16 v[2:3], v68 offset:41472
v_mfma_f32_16x16x32_bf16 v[152:155], v[8:11], a[72:75], v[152:155]
ds_read_b64_tr_b16 v[4:5], v69 offset:36864
v_mfma_f32_16x16x32_bf16 v[156:159], v[8:11], a[76:79], v[156:159]
ds_read_b64_tr_b16 v[6:7], v69 offset:41472
v_mfma_f32_16x16x32_bf16 v[160:163], v[12:15], a[72:75], v[160:163]
ds_read_b64_tr_b16 v[8:9], v70 offset:36864
buffer_load_dwordx4 a[124:127], v237, s[24:27], s59 offen offset:1024 sc1
v_mfma_f32_16x16x32_bf16 v[164:167], v[12:15], a[76:79], v[164:167]
ds_read_b64_tr_b16 v[10:11], v70 offset:41472
s_waitcnt vmcnt(20) lgkmcnt(10)
v_mfma_f32_16x16x32_bf16 v[96:99], v[16:19], a[80:83], v[96:99]
ds_read_b64_tr_b16 v[12:13], v71 offset:36864
v_mfma_f32_16x16x32_bf16 v[100:103], v[16:19], a[84:87], v[100:103]
ds_read_b64_tr_b16 v[14:15], v71 offset:41472
buffer_load_dwordx4 a[128:131], v237, s[24:27], s58 offen offset:2048 sc1
v_mfma_f32_16x16x32_bf16 v[168:171], v[16:19], v[76:79], v[168:171]
v_mfma_f32_16x16x32_bf16 v[104:107], v[20:23], a[80:83], v[104:107]
ds_read_b64_tr_b16 v[16:17], v72 offset:36864
v_mfma_f32_16x16x32_bf16 v[108:111], v[20:23], a[84:87], v[108:111]
ds_read_b64_tr_b16 v[18:19], v72 offset:41472
v_mfma_f32_16x16x32_bf16 v[172:175], v[20:23], v[76:79], v[172:175]
buffer_load_dwordx4 a[132:135], v237, s[24:27], s59 offen offset:2048 sc1
s_waitcnt lgkmcnt(10)
v_mfma_f32_16x16x32_bf16 v[112:115], v[24:27], a[80:83], v[112:115]
ds_read_b64_tr_b16 v[20:21], v64 offset:46080
v_mfma_f32_16x16x32_bf16 v[116:119], v[24:27], a[84:87], v[116:119]
ds_read_b64_tr_b16 v[22:23], v64 offset:50688
v_mfma_f32_16x16x32_bf16 v[60:63], v[24:27], v[76:79], v[60:63]
ds_read_b128 v[80:83], v73 offset:5120
v_mfma_f32_16x16x32_bf16 v[120:123], v[28:31], a[80:83], v[120:123]
ds_read_b64_tr_b16 v[24:25], v65 offset:46080
buffer_load_dwordx4 a[136:139], v237, s[24:27], s58 offen offset:3072 sc1
v_mfma_f32_16x16x32_bf16 v[124:127], v[28:31], a[84:87], v[124:127]
ds_read_b64_tr_b16 v[26:27], v65 offset:50688
s_waitcnt lgkmcnt(9)
v_mfma_f32_16x16x32_bf16 v[128:131], v[0:3], a[80:83], v[128:131]
ds_read_b64_tr_b16 v[28:29], v66 offset:46080
v_mfma_f32_16x16x32_bf16 v[132:135], v[0:3], a[84:87], v[132:135]
ds_read_b64_tr_b16 v[30:31], v66 offset:50688
buffer_load_dwordx4 a[140:143], v237, s[24:27], s59 offen offset:3072 sc1
v_mfma_f32_16x16x32_bf16 v[136:139], v[4:7], a[80:83], v[136:139]
ds_read_b64_tr_b16 v[0:1], v67 offset:46080
s_add_u32 s46, s38, 0
v_mfma_f32_16x16x32_bf16 v[140:143], v[4:7], a[84:87], v[140:143]
ds_read_b64_tr_b16 v[2:3], v67 offset:50688
s_and_b32 s46, s46, 3
v_mfma_f32_16x16x32_bf16 v[144:147], v[8:11], a[80:83], v[144:147]
ds_read_b64_tr_b16 v[4:5], v68 offset:46080
s_lshl_b32 s46, s46, 10
v_mfma_f32_16x16x32_bf16 v[148:151], v[8:11], a[84:87], v[148:151]
ds_read_b64_tr_b16 v[6:7], v68 offset:50688
s_waitcnt lgkmcnt(9)
v_mfma_f32_16x16x32_bf16 v[152:155], v[12:15], a[80:83], v[152:155]
ds_read_b64_tr_b16 v[8:9], v69 offset:46080
s_add_u32 s46, s46, s44
v_mfma_f32_16x16x32_bf16 v[156:159], v[12:15], a[84:87], v[156:159]
ds_read_b64_tr_b16 v[10:11], v69 offset:50688
buffer_store_dwordx4 a[180:183], v237, s[24:27], s46 offen sc1
v_mfma_f32_16x16x32_bf16 v[160:163], v[16:19], a[80:83], v[160:163]
ds_read_b64_tr_b16 v[12:13], v70 offset:46080
v_mfma_f32_16x16x32_bf16 v[164:167], v[16:19], a[84:87], v[164:167]
ds_read_b64_tr_b16 v[14:15], v70 offset:50688
s_waitcnt vmcnt(23)
v_mfma_f32_16x16x32_bf16 v[96:99], v[20:23], a[88:91], v[96:99]
ds_read_b64_tr_b16 v[16:17], v71 offset:46080
buffer_store_dwordx4 a[184:187], v238, s[24:27], s46 offen sc1
v_mfma_f32_16x16x32_bf16 v[100:103], v[20:23], a[92:95], v[100:103]
ds_read_b64_tr_b16 v[18:19], v71 offset:50688
s_waitcnt lgkmcnt(10)
v_mfma_f32_16x16x32_bf16 v[168:171], v[20:23], v[80:83], v[168:171]
s_add_u32 s46, s38, 1
s_and_b32 s46, s46, 3
v_mfma_f32_16x16x32_bf16 v[104:107], v[24:27], a[88:91], v[104:107]
ds_read_b64_tr_b16 v[20:21], v72 offset:46080
s_lshl_b32 s46, s46, 10
v_mfma_f32_16x16x32_bf16 v[108:111], v[24:27], a[92:95], v[108:111]
ds_read_b64_tr_b16 v[22:23], v72 offset:50688
s_add_u32 s46, s46, s44
buffer_store_dwordx4 a[188:191], v237, s[24:27], s46 offen sc1
v_mfma_f32_16x16x32_bf16 v[172:175], v[24:27], v[80:83], v[172:175]
v_mfma_f32_16x16x32_bf16 v[112:115], v[28:31], a[88:91], v[112:115]
ds_read_b64_tr_b16 v[24:25], v64 offset:55296
buffer_store_dwordx4 a[192:195], v238, s[24:27], s46 offen sc1
v_mfma_f32_16x16x32_bf16 v[116:119], v[28:31], a[92:95], v[116:119]
ds_read_b64_tr_b16 v[26:27], v64 offset:59904
s_add_u32 s46, s38, 2
v_mfma_f32_16x16x32_bf16 v[60:63], v[28:31], v[80:83], v[60:63]
ds_read_b128 v[76:79], v73 offset:6144
s_waitcnt lgkmcnt(9)
v_mfma_f32_16x16x32_bf16 v[120:123], v[0:3], a[88:91], v[120:123]
ds_read_b64_tr_b16 v[28:29], v65 offset:55296
s_and_b32 s46, s46, 3
v_mfma_f32_16x16x32_bf16 v[124:127], v[0:3], a[92:95], v[124:127]
ds_read_b64_tr_b16 v[30:31], v65 offset:59904
s_lshl_b32 s46, s46, 10
v_mfma_f32_16x16x32_bf16 v[128:131], v[4:7], a[88:91], v[128:131]
ds_read_b64_tr_b16 v[0:1], v66 offset:55296
s_add_u32 s46, s46, s44
buffer_store_dwordx4 a[196:199], v237, s[24:27], s46 offen sc1
v_mfma_f32_16x16x32_bf16 v[132:135], v[4:7], a[92:95], v[132:135]
ds_read_b64_tr_b16 v[2:3], v66 offset:59904
v_add_u32 v64, 64512, v64
v_mfma_f32_16x16x32_bf16 v[136:139], v[8:11], a[88:91], v[136:139]
ds_read_b64_tr_b16 v[4:5], v67 offset:55296
buffer_store_dwordx4 a[200:203], v238, s[24:27], s46 offen sc1
v_mfma_f32_16x16x32_bf16 v[140:143], v[8:11], a[92:95], v[140:143]
ds_read_b64_tr_b16 v[6:7], v67 offset:59904
s_waitcnt lgkmcnt(9)
v_mfma_f32_16x16x32_bf16 v[144:147], v[12:15], a[88:91], v[144:147]
ds_read_b64_tr_b16 v[8:9], v68 offset:55296
s_add_u32 s46, s38, 3
v_mfma_f32_16x16x32_bf16 v[148:151], v[12:15], a[92:95], v[148:151]
ds_read_b64_tr_b16 v[10:11], v68 offset:59904
s_and_b32 s46, s46, 3
v_mfma_f32_16x16x32_bf16 v[152:155], v[16:19], a[88:91], v[152:155]
ds_read_b64_tr_b16 v[12:13], v69 offset:55296
s_lshl_b32 s46, s46, 10
v_mfma_f32_16x16x32_bf16 v[156:159], v[16:19], a[92:95], v[156:159]
ds_read_b64_tr_b16 v[14:15], v69 offset:59904
s_add_u32 s46, s46, s44
v_mfma_f32_16x16x32_bf16 v[160:163], v[20:23], a[88:91], v[160:163]
ds_read_b64_tr_b16 v[16:17], v70 offset:55296
buffer_store_dwordx4 a[204:207], v237, s[24:27], s46 offen sc1
v_add_u32 v65, 64512, v65
v_mfma_f32_16x16x32_bf16 v[164:167], v[20:23], a[92:95], v[164:167]
ds_read_b64_tr_b16 v[18:19], v70 offset:59904
s_waitcnt vmcnt(27) lgkmcnt(10)
v_mfma_f32_16x16x32_bf16 v[96:99], v[24:27], a[96:99], v[96:99]
ds_read_b64_tr_b16 v[20:21], v71 offset:55296
buffer_store_dwordx4 a[208:211], v238, s[24:27], s46 offen sc1
v_add_u32 v66, 64512, v66
v_mfma_f32_16x16x32_bf16 v[100:103], v[24:27], a[100:103], v[100:103]
ds_read_b64_tr_b16 v[22:23], v71 offset:59904
v_add_u32 v67, 64512, v67
v_mfma_f32_16x16x32_bf16 v[168:171], v[24:27], v[76:79], v[168:171]
v_add_u32 v68, 64512, v68
v_add_u32 v69, 64512, v69
v_mfma_f32_16x16x32_bf16 v[104:107], v[28:31], a[96:99], v[104:107]
ds_read_b64_tr_b16 v[24:25], v72 offset:55296
buffer_store_dwordx4 a[212:215], v237, s[24:27], s45 offen sc1
v_mfma_f32_16x16x32_bf16 v[108:111], v[28:31], a[100:103], v[108:111]
ds_read_b64_tr_b16 v[26:27], v72 offset:59904
s_add_u32 s57, s55, 3
v_mfma_f32_16x16x32_bf16 v[172:175], v[28:31], v[76:79], v[172:175]
s_and_b32 s57, s57, 3
s_waitcnt lgkmcnt(10)
v_mfma_f32_16x16x32_bf16 v[112:115], v[0:3], a[96:99], v[112:115]
ds_read_b64_tr_b16 v[28:29], v64 offset:0
s_mul_i32 s57, s57, 294912
v_mfma_f32_16x16x32_bf16 v[116:119], v[0:3], a[100:103], v[116:119]
ds_read_b64_tr_b16 v[30:31], v64 offset:4608
s_add_u32 s57, s57, s61
v_mfma_f32_16x16x32_bf16 v[60:63], v[0:3], v[76:79], v[60:63]
ds_read_b128 v[80:83], v73 offset:7168
s_add_u32 m0, s56, 110592
v_add_u32 v70, 64512, v70
v_mfma_f32_16x16x32_bf16 v[120:123], v[4:7], a[96:99], v[120:123]
ds_read_b64_tr_b16 v[0:1], v65 offset:0
buffer_load_dwordx4 v244, s[28:31], s57 offen  lds
v_mfma_f32_16x16x32_bf16 v[124:127], v[4:7], a[100:103], v[124:127]
ds_read_b64_tr_b16 v[2:3], v65 offset:4608
v_add_u32 v71, 64512, v71
s_waitcnt lgkmcnt(9)
v_mfma_f32_16x16x32_bf16 v[128:131], v[8:11], a[96:99], v[128:131]
ds_read_b64_tr_b16 v[4:5], v66 offset:0
buffer_load_dwordx4 v245, s[28:31], s57 offen offset:1024  lds
v_mfma_f32_16x16x32_bf16 v[132:135], v[8:11], a[100:103], v[132:135]
ds_read_b64_tr_b16 v[6:7], v66 offset:4608
v_add_u32 v72, 64512, v72
v_mfma_f32_16x16x32_bf16 v[136:139], v[12:15], a[96:99], v[136:139]
ds_read_b64_tr_b16 v[8:9], v67 offset:0
v_mfma_f32_16x16x32_bf16 v[140:143], v[12:15], a[100:103], v[140:143]
ds_read_b64_tr_b16 v[10:11], v67 offset:4608
buffer_load_dwordx4 v246, s[28:31], s57 offen offset:2048  lds
v_mfma_f32_16x16x32_bf16 v[144:147], v[16:19], a[96:99], v[144:147]
ds_read_b64_tr_b16 v[12:13], v68 offset:0
v_mfma_f32_16x16x32_bf16 v[148:151], v[16:19], a[100:103], v[148:151]
ds_read_b64_tr_b16 v[14:15], v68 offset:4608
s_waitcnt lgkmcnt(9)
v_mfma_f32_16x16x32_bf16 v[152:155], v[20:23], a[96:99], v[152:155]
ds_read_b64_tr_b16 v[16:17], v69 offset:0
v_mfma_f32_16x16x32_bf16 v[156:159], v[20:23], a[100:103], v[156:159]
ds_read_b64_tr_b16 v[18:19], v69 offset:4608
buffer_load_dwordx4 v247, s[28:31], s57 offen offset:3072  lds
v_mfma_f32_16x16x32_bf16 v[160:163], v[24:27], a[96:99], v[160:163]
ds_read_b64_tr_b16 v[20:21], v70 offset:0
v_mfma_f32_16x16x32_bf16 v[164:167], v[24:27], a[100:103], v[164:167]
ds_read_b64_tr_b16 v[22:23], v70 offset:4608
s_waitcnt vmcnt(31)
v_mfma_f32_16x16x32_bf16 v[96:99], v[28:31], a[104:107], v[96:99]
ds_read_b64_tr_b16 v[24:25], v71 offset:0
s_add_u32 m0, s56, 114688
v_mfma_f32_16x16x32_bf16 v[100:103], v[28:31], a[108:111], v[100:103]
ds_read_b64_tr_b16 v[26:27], v71 offset:4608
s_waitcnt lgkmcnt(10)
v_mfma_f32_16x16x32_bf16 v[168:171], v[28:31], v[80:83], v[168:171]
buffer_load_dwordx4 v248, s[28:31], s57 offen  lds
v_mfma_f32_16x16x32_bf16 v[104:107], v[0:3], a[104:107], v[104:107]
ds_read_b64_tr_b16 v[28:29], v72 offset:0
v_mfma_f32_16x16x32_bf16 v[108:111], v[0:3], a[108:111], v[108:111]
ds_read_b64_tr_b16 v[30:31], v72 offset:4608
buffer_load_dwordx4 v249, s[28:31], s57 offen offset:1024  lds
v_mfma_f32_16x16x32_bf16 v[172:175], v[0:3], v[80:83], v[172:175]
v_mfma_f32_16x16x32_bf16 v[112:115], v[4:7], a[104:107], v[112:115]
s_waitcnt vmcnt(23)
s_barrier
v_mfma_f32_16x16x32_bf16 v[116:119], v[4:7], a[108:111], v[116:119]
ds_read_b64_tr_b16 v[0:1], v64 offset:9216
v_mfma_f32_16x16x32_bf16 v[60:63], v[4:7], v[80:83], v[60:63]
ds_read_b64_tr_b16 v[2:3], v64 offset:13824
ds_read_b128 v[76:79], v73 offset:8192
s_waitcnt lgkmcnt(9)
v_mfma_f32_16x16x32_bf16 v[120:123], v[8:11], a[104:107], v[120:123]
ds_read_b64_tr_b16 v[4:5], v65 offset:9216
buffer_load_dwordx4 v250, s[28:31], s57 offen offset:2048  lds
v_mfma_f32_16x16x32_bf16 v[124:127], v[8:11], a[108:111], v[124:127]
ds_read_b64_tr_b16 v[6:7], v65 offset:13824
v_mfma_f32_16x16x32_bf16 v[128:131], v[12:15], a[104:107], v[128:131]
ds_read_b64_tr_b16 v[8:9], v66 offset:9216
buffer_load_dwordx4 v251, s[28:31], s57 offen offset:3072  lds
v_mfma_f32_16x16x32_bf16 v[132:135], v[12:15], a[108:111], v[132:135]
ds_read_b64_tr_b16 v[10:11], v66 offset:13824
v_mfma_f32_16x16x32_bf16 v[136:139], v[16:19], a[104:107], v[136:139]
ds_read_b64_tr_b16 v[12:13], v67 offset:9216
v_mfma_f32_16x16x32_bf16 v[140:143], v[16:19], a[108:111], v[140:143]
ds_read_b64_tr_b16 v[14:15], v67 offset:13824
s_waitcnt lgkmcnt(9)
v_mfma_f32_16x16x32_bf16 v[144:147], v[20:23], a[104:107], v[144:147]
ds_read_b64_tr_b16 v[16:17], v68 offset:9216
s_add_u32 m0, s56, 118784
v_mfma_f32_16x16x32_bf16 v[148:151], v[20:23], a[108:111], v[148:151]
ds_read_b64_tr_b16 v[18:19], v68 offset:13824
buffer_load_dwordx4 v252, s[28:31], s57 offen  lds
v_mfma_f32_16x16x32_bf16 v[152:155], v[24:27], a[104:107], v[152:155]
ds_read_b64_tr_b16 v[20:21], v69 offset:9216
v_mfma_f32_16x16x32_bf16 v[156:159], v[24:27], a[108:111], v[156:159]
ds_read_b64_tr_b16 v[22:23], v69 offset:13824
v_mfma_f32_16x16x32_bf16 v[160:163], v[28:31], a[104:107], v[160:163]
ds_read_b64_tr_b16 v[24:25], v70 offset:9216
v_mfma_f32_16x16x32_bf16 v[164:167], v[28:31], a[108:111], v[164:167]
ds_read_b64_tr_b16 v[26:27], v70 offset:13824
s_waitcnt vmcnt(24) lgkmcnt(10)
v_mfma_f32_16x16x32_bf16 v[96:99], v[0:3], a[112:115], v[96:99]
ds_read_b64_tr_b16 v[28:29], v71 offset:9216
s_add_u32 s58, s55, 3
v_mfma_f32_16x16x32_bf16 v[100:103], v[0:3], a[116:119], v[100:103]
ds_read_b64_tr_b16 v[30:31], v71 offset:13824
s_and_b32 s58, s58, 3
v_mfma_f32_16x16x32_bf16 v[168:171], v[0:3], v[76:79], v[168:171]
s_mul_i32 s58, s58, 73728
s_add_u32 s58, s58, s60
v_mfma_f32_16x16x32_bf16 v[104:107], v[4:7], a[112:115], v[104:107]
ds_read_b64_tr_b16 v[0:1], v72 offset:9216
s_lshl_b32 s59, s39, 1
v_mfma_f32_16x16x32_bf16 v[108:111], v[4:7], a[116:119], v[108:111]
ds_read_b64_tr_b16 v[2:3], v72 offset:13824
s_add_u32 s58, s58, s59
v_mfma_f32_16x16x32_bf16 v[172:175], v[4:7], v[76:79], v[172:175]
s_add_u32 s57, s55, 3
s_waitcnt lgkmcnt(10)
v_mfma_f32_16x16x32_bf16 v[112:115], v[8:11], a[112:115], v[112:115]
ds_read_b64_tr_b16 v[4:5], v64 offset:18432
s_and_b32 s57, s57, 3
v_mfma_f32_16x16x32_bf16 v[116:119], v[8:11], a[116:119], v[116:119]
ds_read_b64_tr_b16 v[6:7], v64 offset:23040
s_mul_i32 s57, s57, 73728
s_waitcnt vmcnt(9)
s_lshl_b32 s66, s50, 2
s_add_u32 s66, s66, s38
s_lshl_b32 s66, s66, 2
s_add_u32 s66, s66, s62
v_mov_b32 v185, 2
s_mov_b64 exec, 1
buffer_store_dword v185, v243, s[24:27], s66 offen sc1
s_mov_b64 exec, -1
s_add_u32 s59, s58, 4096
v_mfma_f32_16x16x32_bf16 v[60:63], v[8:11], v[76:79], v[60:63]
ds_read_b128 v[80:83], v73 offset:9216
s_add_u32 s57, s57, s60
buffer_load_dwordx4 a[48:51], v237, s[24:27], s58 offen offset:0 sc1
s_lshr_b32 s6, s39, 2
s_add_u32 s57, s57, s6
s_add_u32 m0, s6, 159744
s_add_u32 s57, s57, 32768
buffer_load_dwordx4 v237, s[24:27], s57 offen sc1 lds
v_mfma_f32_16x16x32_bf16 v[120:123], v[12:15], a[112:115], v[120:123]
ds_read_b64_tr_b16 v[8:9], v65 offset:18432
v_mfma_f32_16x16x32_bf16 v[124:127], v[12:15], a[116:119], v[124:127]
ds_read_b64_tr_b16 v[10:11], v65 offset:23040
s_waitcnt lgkmcnt(9)
v_mfma_f32_16x16x32_bf16 v[128:131], v[16:19], a[112:115], v[128:131]
ds_read_b64_tr_b16 v[12:13], v66 offset:18432
s_add_u32 s57, s50, 0
v_mfma_f32_16x16x32_bf16 v[132:135], v[16:19], a[116:119], v[132:135]
ds_read_b64_tr_b16 v[14:15], v66 offset:23040
buffer_load_dwordx4 a[52:55], v237, s[24:27], s59 offen offset:0 sc1
v_mfma_f32_16x16x32_bf16 v[136:139], v[20:23], a[112:115], v[136:139]
ds_read_b64_tr_b16 v[16:17], v67 offset:18432
s_and_b32 s57, s57, 3
v_mfma_f32_16x16x32_bf16 v[140:143], v[20:23], a[116:119], v[140:143]
ds_read_b64_tr_b16 v[18:19], v67 offset:23040
s_mul_i32 s57, s57, 294912
v_mfma_f32_16x16x32_bf16 v[144:147], v[24:27], a[112:115], v[144:147]
ds_read_b64_tr_b16 v[20:21], v68 offset:18432
s_add_u32 s57, s57, s61
v_mfma_f32_16x16x32_bf16 v[148:151], v[24:27], a[116:119], v[148:151]
ds_read_b64_tr_b16 v[22:23], v68 offset:23040
s_waitcnt lgkmcnt(9)
v_mfma_f32_16x16x32_bf16 v[152:155], v[28:31], a[112:115], v[152:155]
ds_read_b64_tr_b16 v[24:25], v69 offset:18432
s_add_u32 s57, s57, 147456
v_mfma_f32_16x16x32_bf16 v[156:159], v[28:31], a[116:119], v[156:159]
ds_read_b64_tr_b16 v[26:27], v69 offset:23040
s_add_u32 m0, s56, 0
s_nop 0
buffer_load_dwordx4 v244, s[28:31], s57 offen  lds
v_mfma_f32_16x16x32_bf16 v[160:163], v[0:3], a[112:115], v[160:163]
ds_read_b64_tr_b16 v[28:29], v70 offset:18432
v_mfma_f32_16x16x32_bf16 v[164:167], v[0:3], a[116:119], v[164:167]
ds_read_b64_tr_b16 v[30:31], v70 offset:23040
v_mfma_f32_16x16x32_bf16 v[96:99], v[4:7], a[120:123], v[96:99]
ds_read_b64_tr_b16 v[0:1], v71 offset:18432
v_mfma_f32_16x16x32_bf16 v[100:103], v[4:7], a[124:127], v[100:103]
ds_read_b64_tr_b16 v[2:3], v71 offset:23040
s_waitcnt lgkmcnt(10)
v_mfma_f32_16x16x32_bf16 v[168:171], v[4:7], v[80:83], v[168:171]
buffer_load_dwordx4 a[56:59], v237, s[24:27], s58 offen offset:1024 sc1
v_mfma_f32_16x16x32_bf16 v[104:107], v[8:11], a[120:123], v[104:107]
ds_read_b64_tr_b16 v[4:5], v72 offset:18432
v_mfma_f32_16x16x32_bf16 v[108:111], v[8:11], a[124:127], v[108:111]
ds_read_b64_tr_b16 v[6:7], v72 offset:23040
buffer_load_dwordx4 v245, s[28:31], s57 offen offset:1024  lds
v_mfma_f32_16x16x32_bf16 v[172:175], v[8:11], v[80:83], v[172:175]
v_mfma_f32_16x16x32_bf16 v[112:115], v[12:15], a[120:123], v[112:115]
ds_read_b64_tr_b16 v[8:9], v64 offset:27648
v_mfma_f32_16x16x32_bf16 v[116:119], v[12:15], a[124:127], v[116:119]
ds_read_b64_tr_b16 v[10:11], v64 offset:32256
v_mfma_f32_16x16x32_bf16 v[60:63], v[12:15], v[80:83], v[60:63]
ds_read_b128 v[76:79], v73 offset:10240
s_waitcnt lgkmcnt(9)
v_mfma_f32_16x16x32_bf16 v[120:123], v[16:19], a[120:123], v[120:123]
ds_read_b64_tr_b16 v[12:13], v65 offset:27648
buffer_load_dwordx4 a[60:63], v237, s[24:27], s59 offen offset:1024 sc1
v_mfma_f32_16x16x32_bf16 v[124:127], v[16:19], a[124:127], v[124:127]
ds_read_b64_tr_b16 v[14:15], v65 offset:32256
v_mfma_f32_16x16x32_bf16 v[128:131], v[20:23], a[120:123], v[128:131]
ds_read_b64_tr_b16 v[16:17], v66 offset:27648
v_mfma_f32_16x16x32_bf16 v[132:135], v[20:23], a[124:127], v[132:135]
ds_read_b64_tr_b16 v[18:19], v66 offset:32256
v_mfma_f32_16x16x32_bf16 v[136:139], v[24:27], a[120:123], v[136:139]
ds_read_b64_tr_b16 v[20:21], v67 offset:27648
buffer_load_dwordx4 v246, s[28:31], s57 offen offset:2048  lds
v_mfma_f32_16x16x32_bf16 v[140:143], v[24:27], a[124:127], v[140:143]
ds_read_b64_tr_b16 v[22:23], v67 offset:32256
s_waitcnt lgkmcnt(9)
v_mfma_f32_16x16x32_bf16 v[144:147], v[28:31], a[120:123], v[144:147]
ds_read_b64_tr_b16 v[24:25], v68 offset:27648
v_mfma_f32_16x16x32_bf16 v[148:151], v[28:31], a[124:127], v[148:151]
ds_read_b64_tr_b16 v[26:27], v68 offset:32256
v_mfma_f32_16x16x32_bf16 v[152:155], v[0:3], a[120:123], v[152:155]
ds_read_b64_tr_b16 v[28:29], v69 offset:27648
v_mfma_f32_16x16x32_bf16 v[156:159], v[0:3], a[124:127], v[156:159]
ds_read_b64_tr_b16 v[30:31], v69 offset:32256
buffer_load_dwordx4 v247, s[28:31], s57 offen offset:3072  lds
v_mfma_f32_16x16x32_bf16 v[160:163], v[4:7], a[120:123], v[160:163]
ds_read_b64_tr_b16 v[0:1], v70 offset:27648
v_mfma_f32_16x16x32_bf16 v[164:167], v[4:7], a[124:127], v[164:167]
ds_read_b64_tr_b16 v[2:3], v70 offset:32256
s_waitcnt lgkmcnt(10)
v_mfma_f32_16x16x32_bf16 v[96:99], v[8:11], a[128:131], v[96:99]
ds_read_b64_tr_b16 v[4:5], v71 offset:27648
v_mfma_f32_16x16x32_bf16 v[100:103], v[8:11], a[132:135], v[100:103]
ds_read_b64_tr_b16 v[6:7], v71 offset:32256
v_mfma_f32_16x16x32_bf16 v[168:171], v[8:11], v[76:79], v[168:171]
buffer_load_dwordx4 a[64:67], v237, s[24:27], s58 offen offset:2048 sc1
v_mfma_f32_16x16x32_bf16 v[104:107], v[12:15], a[128:131], v[104:107]
ds_read_b64_tr_b16 v[8:9], v72 offset:27648
v_mfma_f32_16x16x32_bf16 v[108:111], v[12:15], a[132:135], v[108:111]
ds_read_b64_tr_b16 v[10:11], v72 offset:32256
v_mfma_f32_16x16x32_bf16 v[172:175], v[12:15], v[76:79], v[172:175]
s_add_u32 m0, s56, 4096
s_waitcnt lgkmcnt(10)
v_mfma_f32_16x16x32_bf16 v[112:115], v[16:19], a[128:131], v[112:115]
ds_read_b64_tr_b16 v[12:13], v64 offset:36864
buffer_load_dwordx4 v248, s[28:31], s57 offen  lds
v_mfma_f32_16x16x32_bf16 v[116:119], v[16:19], a[132:135], v[116:119]
ds_read_b64_tr_b16 v[14:15], v64 offset:41472
v_mfma_f32_16x16x32_bf16 v[60:63], v[16:19], v[76:79], v[60:63]
ds_read_b128 v[80:83], v73 offset:11264
v_mfma_f32_16x16x32_bf16 v[120:123], v[20:23], a[128:131], v[120:123]
ds_read_b64_tr_b16 v[16:17], v65 offset:36864
v_mfma_f32_16x16x32_bf16 v[124:127], v[20:23], a[132:135], v[124:127]
ds_read_b64_tr_b16 v[18:19], v65 offset:41472
s_waitcnt lgkmcnt(9)
v_mfma_f32_16x16x32_bf16 v[128:131], v[24:27], a[128:131], v[128:131]
ds_read_b64_tr_b16 v[20:21], v66 offset:36864
buffer_load_dwordx4 a[68:71], v237, s[24:27], s59 offen offset:2048 sc1
v_mfma_f32_16x16x32_bf16 v[132:135], v[24:27], a[132:135], v[132:135]
ds_read_b64_tr_b16 v[22:23], v66 offset:41472
v_mfma_f32_16x16x32_bf16 v[136:139], v[28:31], a[128:131], v[136:139]
ds_read_b64_tr_b16 v[24:25], v67 offset:36864
v_mfma_f32_16x16x32_bf16 v[140:143], v[28:31], a[132:135], v[140:143]
ds_read_b64_tr_b16 v[26:27], v67 offset:41472
v_mfma_f32_16x16x32_bf16 v[144:147], v[0:3], a[128:131], v[144:147]
ds_read_b64_tr_b16 v[28:29], v68 offset:36864
v_mfma_f32_16x16x32_bf16 v[148:151], v[0:3], a[132:135], v[148:151]
ds_read_b64_tr_b16 v[30:31], v68 offset:41472
s_waitcnt lgkmcnt(9)
v_mfma_f32_16x16x32_bf16 v[152:155], v[4:7], a[128:131], v[152:155]
ds_read_b64_tr_b16 v[0:1], v69 offset:36864
buffer_load_dwordx4 v249, s[28:31], s57 offen offset:1024  lds
v_mfma_f32_16x16x32_bf16 v[156:159], v[4:7], a[132:135], v[156:159]
ds_read_b64_tr_b16 v[2:3], v69 offset:41472
v_mfma_f32_16x16x32_bf16 v[160:163], v[8:11], a[128:131], v[160:163]
ds_read_b64_tr_b16 v[4:5], v70 offset:36864
v_mfma_f32_16x16x32_bf16 v[164:167], v[8:11], a[132:135], v[164:167]
ds_read_b64_tr_b16 v[6:7], v70 offset:41472
v_mfma_f32_16x16x32_bf16 v[96:99], v[12:15], a[136:139], v[96:99]
ds_read_b64_tr_b16 v[8:9], v71 offset:36864
v_mfma_f32_16x16x32_bf16 v[100:103], v[12:15], a[140:143], v[100:103]
ds_read_b64_tr_b16 v[10:11], v71 offset:41472
s_waitcnt lgkmcnt(10)
v_mfma_f32_16x16x32_bf16 v[168:171], v[12:15], v[80:83], v[168:171]
buffer_load_dwordx4 a[72:75], v237, s[24:27], s58 offen offset:3072 sc1
v_mfma_f32_16x16x32_bf16 v[104:107], v[16:19], a[136:139], v[104:107]
ds_read_b64_tr_b16 v[12:13], v72 offset:36864
v_mfma_f32_16x16x32_bf16 v[108:111], v[16:19], a[140:143], v[108:111]
ds_read_b64_tr_b16 v[14:15], v72 offset:41472
buffer_load_dwordx4 v250, s[28:31], s57 offen offset:2048  lds
v_mfma_f32_16x16x32_bf16 v[172:175], v[16:19], v[80:83], v[172:175]
v_mfma_f32_16x16x32_bf16 v[112:115], v[20:23], a[136:139], v[112:115]
s_waitcnt vmcnt(13)
s_barrier
v_mfma_f32_16x16x32_bf16 v[116:119], v[20:23], a[140:143], v[116:119]
ds_read_b64_tr_b16 v[16:17], v64 offset:46080
v_mfma_f32_16x16x32_bf16 v[60:63], v[20:23], v[80:83], v[60:63]
ds_read_b64_tr_b16 v[18:19], v64 offset:50688
ds_read_b128 v[76:79], v73 offset:12288
s_waitcnt lgkmcnt(9)
v_mfma_f32_16x16x32_bf16 v[120:123], v[24:27], a[136:139], v[120:123]
ds_read_b64_tr_b16 v[20:21], v65 offset:46080
buffer_load_dwordx4 a[76:79], v237, s[24:27], s59 offen offset:3072 sc1
v_mfma_f32_16x16x32_bf16 v[124:127], v[24:27], a[140:143], v[124:127]
ds_read_b64_tr_b16 v[22:23], v65 offset:50688
v_mfma_f32_16x16x32_bf16 v[128:131], v[28:31], a[136:139], v[128:131]
ds_read_b64_tr_b16 v[24:25], v66 offset:46080
v_mfma_f32_16x16x32_bf16 v[132:135], v[28:31], a[140:143], v[132:135]
ds_read_b64_tr_b16 v[26:27], v66 offset:50688
v_mfma_f32_16x16x32_bf16 v[136:139], v[0:3], a[136:139], v[136:139]
ds_read_b64_tr_b16 v[28:29], v67 offset:46080
buffer_load_dwordx4 v251, s[28:31], s57 offen offset:3072  lds
v_mfma_f32_16x16x32_bf16 v[140:143], v[0:3], a[140:143], v[140:143]
ds_read_b64_tr_b16 v[30:31], v67 offset:50688
s_waitcnt lgkmcnt(9)
v_mfma_f32_16x16x32_bf16 v[144:147], v[4:7], a[136:139], v[144:147]
ds_read_b64_tr_b16 v[0:1], v68 offset:46080
v_mfma_f32_16x16x32_bf16 v[148:151], v[4:7], a[140:143], v[148:151]
ds_read_b64_tr_b16 v[2:3], v68 offset:50688
v_mfma_f32_16x16x32_bf16 v[152:155], v[8:11], a[136:139], v[152:155]
ds_read_b64_tr_b16 v[4:5], v69 offset:46080
s_add_u32 m0, s56, 8192
v_mfma_f32_16x16x32_bf16 v[156:159], v[8:11], a[140:143], v[156:159]
ds_read_b64_tr_b16 v[6:7], v69 offset:50688
buffer_load_dwordx4 v252, s[28:31], s57 offen  lds
v_mfma_f32_16x16x32_bf16 v[160:163], v[12:15], a[136:139], v[160:163]
ds_read_b64_tr_b16 v[8:9], v70 offset:46080
v_mfma_f32_16x16x32_bf16 v[164:167], v[12:15], a[140:143], v[164:167]
ds_read_b64_tr_b16 v[10:11], v70 offset:50688
s_waitcnt vmcnt(15) lgkmcnt(10)
v_mfma_f32_16x16x32_bf16 v[96:99], v[16:19], a[48:51], v[96:99]
ds_read_b64_tr_b16 v[12:13], v71 offset:46080
s_add_u32 s58, s50, 0
v_mfma_f32_16x16x32_bf16 v[100:103], v[16:19], a[52:55], v[100:103]
ds_read_b64_tr_b16 v[14:15], v71 offset:50688
s_and_b32 s58, s58, 3
v_mfma_f32_16x16x32_bf16 v[168:171], v[16:19], v[76:79], v[168:171]
s_mul_i32 s58, s58, 73728
s_add_u32 s58, s58, s60
v_mfma_f32_16x16x32_bf16 v[104:107], v[20:23], a[48:51], v[104:107]
ds_read_b64_tr_b16 v[16:17], v72 offset:46080
s_add_u32 s58, s58, 36864
v_mfma_f32_16x16x32_bf16 v[108:111], v[20:23], a[52:55], v[108:111]
ds_read_b64_tr_b16 v[18:19], v72 offset:50688
s_lshl_b32 s59, s39, 1
s_add_u32 s58, s58, s59
s_add_u32 s59, s58, 4096
buffer_load_dwordx4 a[80:83], v237, s[24:27], s58 offen offset:0 sc1
v_mfma_f32_16x16x32_bf16 v[172:175], v[20:23], v[76:79], v[172:175]
s_add_u32 s57, s50, 0
s_waitcnt lgkmcnt(10)
v_mfma_f32_16x16x32_bf16 v[112:115], v[24:27], a[48:51], v[112:115]
ds_read_b64_tr_b16 v[20:21], v64 offset:55296
s_and_b32 s57, s57, 3
v_mfma_f32_16x16x32_bf16 v[116:119], v[24:27], a[52:55], v[116:119]
ds_read_b64_tr_b16 v[22:23], v64 offset:59904
s_mul_i32 s57, s57, 73728
v_mfma_f32_16x16x32_bf16 v[60:63], v[24:27], v[76:79], v[60:63]
ds_read_b128 v[80:83], v73 offset:13312
s_add_u32 s57, s57, s60
s_add_u32 s57, s57, 36864
s_lshr_b32 s6, s39, 2
s_add_u32 s57, s57, s6
s_add_u32 m0, s6, 147456
s_add_u32 s57, s57, 32768
buffer_load_dwordx4 v237, s[24:27], s57 offen sc1 lds
v_mfma_f32_16x16x32_bf16 v[120:123], v[28:31], a[48:51], v[120:123]
ds_read_b64_tr_b16 v[24:25], v65 offset:55296
v_add_u32 v64, 64512, v64
v_mfma_f32_16x16x32_bf16 v[124:127], v[28:31], a[52:55], v[124:127]
ds_read_b64_tr_b16 v[26:27], v65 offset:59904
s_waitcnt lgkmcnt(9)
v_mfma_f32_16x16x32_bf16 v[128:131], v[0:3], a[48:51], v[128:131]
ds_read_b64_tr_b16 v[28:29], v66 offset:55296
buffer_load_dwordx4 a[84:87], v237, s[24:27], s59 offen offset:0 sc1
v_mfma_f32_16x16x32_bf16 v[132:135], v[0:3], a[52:55], v[132:135]
ds_read_b64_tr_b16 v[30:31], v66 offset:59904
s_add_u32 s57, s50, 1
v_mfma_f32_16x16x32_bf16 v[136:139], v[4:7], a[48:51], v[136:139]
ds_read_b64_tr_b16 v[0:1], v67 offset:55296
s_and_b32 s57, s57, 3
v_mfma_f32_16x16x32_bf16 v[140:143], v[4:7], a[52:55], v[140:143]
ds_read_b64_tr_b16 v[2:3], v67 offset:59904
s_mul_i32 s57, s57, 294912
v_mfma_f32_16x16x32_bf16 v[144:147], v[8:11], a[48:51], v[144:147]
ds_read_b64_tr_b16 v[4:5], v68 offset:55296
s_add_u32 s57, s57, s61
v_mfma_f32_16x16x32_bf16 v[148:151], v[8:11], a[52:55], v[148:151]
ds_read_b64_tr_b16 v[6:7], v68 offset:59904
s_waitcnt lgkmcnt(9)
v_mfma_f32_16x16x32_bf16 v[152:155], v[12:15], a[48:51], v[152:155]
ds_read_b64_tr_b16 v[8:9], v69 offset:55296
s_add_u32 s57, s57, 147456
s_add_u32 m0, s56, 36864
s_nop 0
buffer_load_dwordx4 v244, s[28:31], s57 offen  lds
v_mfma_f32_16x16x32_bf16 v[156:159], v[12:15], a[52:55], v[156:159]
ds_read_b64_tr_b16 v[10:11], v69 offset:59904
v_add_u32 v65, 64512, v65
v_mfma_f32_16x16x32_bf16 v[160:163], v[16:19], a[48:51], v[160:163]
ds_read_b64_tr_b16 v[12:13], v70 offset:55296
v_add_u32 v66, 64512, v66
v_mfma_f32_16x16x32_bf16 v[164:167], v[16:19], a[52:55], v[164:167]
ds_read_b64_tr_b16 v[14:15], v70 offset:59904
s_waitcnt vmcnt(15)
v_mfma_f32_16x16x32_bf16 v[96:99], v[20:23], a[56:59], v[96:99]
ds_read_b64_tr_b16 v[16:17], v71 offset:55296
v_add_u32 v67, 64512, v67
v_mfma_f32_16x16x32_bf16 v[100:103], v[20:23], a[60:63], v[100:103]
ds_read_b64_tr_b16 v[18:19], v71 offset:59904
s_waitcnt lgkmcnt(10)
v_mfma_f32_16x16x32_bf16 v[168:171], v[20:23], v[80:83], v[168:171]
s_cmp_lg_u32 s38, 0
s_cbranch_scc1 FL14
buffer_load_dword v180, v206, s[24:27], s62 offen sc1
FL14:
v_mfma_f32_16x16x32_bf16 v[104:107], v[24:27], a[56:59], v[104:107]
ds_read_b64_tr_b16 v[20:21], v72 offset:55296
buffer_load_dwordx4 v245, s[28:31], s57 offen offset:1024  lds
v_mfma_f32_16x16x32_bf16 v[108:111], v[24:27], a[60:63], v[108:111]
ds_read_b64_tr_b16 v[22:23], v72 offset:59904
v_add_u32 v68, 64512, v68
v_mfma_f32_16x16x32_bf16 v[172:175], v[24:27], v[80:83], v[172:175]
v_add_u32 v69, 64512, v69
v_add_u32 v70, 64512, v70
v_mfma_f32_16x16x32_bf16 v[112:115], v[28:31], a[56:59], v[112:115]
ds_read_b64_tr_b16 v[24:25], v64 offset:0
v_add_u32 v71, 64512, v71
v_mfma_f32_16x16x32_bf16 v[116:119], v[28:31], a[60:63], v[116:119]
ds_read_b64_tr_b16 v[26:27], v64 offset:4608
buffer_load_dwordx4 a[88:91], v237, s[24:27], s58 offen offset:1024 sc1
v_mfma_f32_16x16x32_bf16 v[60:63], v[28:31], v[80:83], v[60:63]
ds_read_b128 v[76:79], v73 offset:14336
s_waitcnt lgkmcnt(9)
v_mfma_f32_16x16x32_bf16 v[120:123], v[0:3], a[56:59], v[120:123]
ds_read_b64_tr_b16 v[28:29], v65 offset:0
v_add_u32 v72, 64512, v72
v_mfma_f32_16x16x32_bf16 v[124:127], v[0:3], a[60:63], v[124:127]
ds_read_b64_tr_b16 v[30:31], v65 offset:4608
v_mfma_f32_16x16x32_bf16 v[128:131], v[4:7], a[56:59], v[128:131]
ds_read_b64_tr_b16 v[0:1], v66 offset:0
buffer_load_dwordx4 v246, s[28:31], s57 offen offset:2048  lds
v_mfma_f32_16x16x32_bf16 v[132:135], v[4:7], a[60:63], v[132:135]
ds_read_b64_tr_b16 v[2:3], v66 offset:4608
v_mfma_f32_16x16x32_bf16 v[136:139], v[8:11], a[56:59], v[136:139]
ds_read_b64_tr_b16 v[4:5], v67 offset:0
v_mfma_f32_16x16x32_bf16 v[140:143], v[8:11], a[60:63], v[140:143]
ds_read_b64_tr_b16 v[6:7], v67 offset:4608
s_waitcnt lgkmcnt(9)
v_mfma_f32_16x16x32_bf16 v[144:147], v[12:15], a[56:59], v[144:147]
ds_read_b64_tr_b16 v[8:9], v68 offset:0
v_mfma_f32_16x16x32_bf16 v[148:151], v[12:15], a[60:63], v[148:151]
ds_read_b64_tr_b16 v[10:11], v68 offset:4608
buffer_load_dwordx4 a[92:95], v237, s[24:27], s59 offen offset:1024 sc1
v_mfma_f32_16x16x32_bf16 v[152:155], v[16:19], a[56:59], v[152:155]
ds_read_b64_tr_b16 v[12:13], v69 offset:0
v_mfma_f32_16x16x32_bf16 v[156:159], v[16:19], a[60:63], v[156:159]
ds_read_b64_tr_b16 v[14:15], v69 offset:4608
v_mfma_f32_16x16x32_bf16 v[160:163], v[20:23], a[56:59], v[160:163]
ds_read_b64_tr_b16 v[16:17], v70 offset:0
v_mfma_f32_16x16x32_bf16 v[164:167], v[20:23], a[60:63], v[164:167]
ds_read_b64_tr_b16 v[18:19], v70 offset:4608
s_waitcnt vmcnt(14) lgkmcnt(10)
v_mfma_f32_16x16x32_bf16 v[96:99], v[24:27], a[64:67], v[96:99]
ds_read_b64_tr_b16 v[20:21], v71 offset:0
buffer_load_dwordx4 v247, s[28:31], s57 offen offset:3072  lds
v_mfma_f32_16x16x32_bf16 v[100:103], v[24:27], a[68:71], v[100:103]
ds_read_b64_tr_b16 v[22:23], v71 offset:4608
v_mfma_f32_16x16x32_bf16 v[168:171], v[24:27], v[76:79], v[168:171]
v_mfma_f32_16x16x32_bf16 v[104:107], v[28:31], a[64:67], v[104:107]
ds_read_b64_tr_b16 v[24:25], v72 offset:0
v_mfma_f32_16x16x32_bf16 v[108:111], v[28:31], a[68:71], v[108:111]
ds_read_b64_tr_b16 v[26:27], v72 offset:4608
buffer_load_dwordx4 a[96:99], v237, s[24:27], s58 offen offset:2048 sc1
v_mfma_f32_16x16x32_bf16 v[172:175], v[28:31], v[76:79], v[172:175]
s_waitcnt lgkmcnt(10)
v_mfma_f32_16x16x32_bf16 v[112:115], v[0:3], a[64:67], v[112:115]
ds_read_b64_tr_b16 v[28:29], v64 offset:9216
v_mfma_f32_16x16x32_bf16 v[116:119], v[0:3], a[68:71], v[116:119]
ds_read_b64_tr_b16 v[30:31], v64 offset:13824
s_add_u32 m0, s56, 40960
v_mfma_f32_16x16x32_bf16 v[60:63], v[0:3], v[76:79], v[60:63]
ds_read_b128 v[80:83], v73 offset:15360
buffer_load_dwordx4 v248, s[28:31], s57 offen  lds
v_mfma_f32_16x16x32_bf16 v[120:123], v[4:7], a[64:67], v[120:123]
ds_read_b64_tr_b16 v[0:1], v65 offset:9216
v_subrev_u32 v64, 129024, v64
v_mfma_f32_16x16x32_bf16 v[124:127], v[4:7], a[68:71], v[124:127]
ds_read_b64_tr_b16 v[2:3], v65 offset:13824
s_waitcnt lgkmcnt(9)
v_mfma_f32_16x16x32_bf16 v[128:131], v[8:11], a[64:67], v[128:131]
ds_read_b64_tr_b16 v[4:5], v66 offset:9216
v_mfma_f32_16x16x32_bf16 v[132:135], v[8:11], a[68:71], v[132:135]
ds_read_b64_tr_b16 v[6:7], v66 offset:13824
v_subrev_u32 v65, 129024, v65
v_mfma_f32_16x16x32_bf16 v[136:139], v[12:15], a[64:67], v[136:139]
ds_read_b64_tr_b16 v[8:9], v67 offset:9216
buffer_load_dwordx4 a[100:103], v237, s[24:27], s59 offen offset:2048 sc1
v_mfma_f32_16x16x32_bf16 v[140:143], v[12:15], a[68:71], v[140:143]
ds_read_b64_tr_b16 v[10:11], v67 offset:13824
v_subrev_u32 v66, 129024, v66
v_mfma_f32_16x16x32_bf16 v[144:147], v[16:19], a[64:67], v[144:147]
ds_read_b64_tr_b16 v[12:13], v68 offset:9216
v_mfma_f32_16x16x32_bf16 v[148:151], v[16:19], a[68:71], v[148:151]
ds_read_b64_tr_b16 v[14:15], v68 offset:13824
s_waitcnt lgkmcnt(9)
v_mfma_f32_16x16x32_bf16 v[152:155], v[20:23], a[64:67], v[152:155]
ds_read_b64_tr_b16 v[16:17], v69 offset:9216
buffer_load_dwordx4 v249, s[28:31], s57 offen offset:1024  lds
v_mfma_f32_16x16x32_bf16 v[156:159], v[20:23], a[68:71], v[156:159]
ds_read_b64_tr_b16 v[18:19], v69 offset:13824
v_subrev_u32 v67, 129024, v67
v_mfma_f32_16x16x32_bf16 v[160:163], v[24:27], a[64:67], v[160:163]
ds_read_b64_tr_b16 v[20:21], v70 offset:9216
v_subrev_u32 v68, 129024, v68
v_mfma_f32_16x16x32_bf16 v[164:167], v[24:27], a[68:71], v[164:167]
ds_read_b64_tr_b16 v[22:23], v70 offset:13824
s_waitcnt vmcnt(15)
v_mfma_f32_16x16x32_bf16 v[96:99], v[28:31], a[72:75], v[96:99]
ds_read_b64_tr_b16 v[24:25], v71 offset:9216
v_subrev_u32 v69, 129024, v69
v_mfma_f32_16x16x32_bf16 v[100:103], v[28:31], a[76:79], v[100:103]
ds_read_b64_tr_b16 v[26:27], v71 offset:13824
s_waitcnt lgkmcnt(10)
v_mfma_f32_16x16x32_bf16 v[168:171], v[28:31], v[80:83], v[168:171]
buffer_load_dwordx4 a[104:107], v237, s[24:27], s58 offen offset:3072 sc1
v_mfma_f32_16x16x32_bf16 v[104:107], v[0:3], a[72:75], v[104:107]
ds_read_b64_tr_b16 v[28:29], v72 offset:9216
v_subrev_u32 v70, 129024, v70
v_mfma_f32_16x16x32_bf16 v[108:111], v[0:3], a[76:79], v[108:111]
ds_read_b64_tr_b16 v[30:31], v72 offset:13824
v_subrev_u32 v71, 129024, v71
v_mfma_f32_16x16x32_bf16 v[172:175], v[0:3], v[80:83], v[172:175]
buffer_load_dwordx4 v250, s[28:31], s57 offen offset:2048  lds
v_mfma_f32_16x16x32_bf16 v[112:115], v[4:7], a[72:75], v[112:115]
s_cmp_lg_u32 s38, 0
s_cbranch_scc1 CE15
s_mov_b32 s5, 0x20000
s_waitcnt vmcnt(11)
CL15:
v_cmp_le_u32 s[66:67], 2, v180
s_nop 1
s_and_b32 s66, s66, 65535
s_cmp_eq_u32 s66, 65535
s_cbranch_scc1 CE15
s_sleep 4
buffer_load_dword v180, v206, s[24:27], s62 offen sc1
s_waitcnt vmcnt(0)
s_sub_u32 s5, s5, 1
s_cbranch_scc0 CL15
CE15:
s_waitcnt vmcnt(13)
s_barrier
v_mfma_f32_16x16x32_bf16 v[116:119], v[4:7], a[76:79], v[116:119]
ds_read_b64_tr_b16 v[0:1], v64 offset:0
v_subrev_u32 v72, 129024, v72
v_mfma_f32_16x16x32_bf16 v[60:63], v[4:7], v[80:83], v[60:63]
ds_read_b64_tr_b16 v[2:3], v64 offset:4608
ds_read_b128 v[76:79], v73 offset:0
s_waitcnt lgkmcnt(9)
v_mfma_f32_16x16x32_bf16 v[120:123], v[8:11], a[72:75], v[120:123]
ds_read_b64_tr_b16 v[4:5], v65 offset:0
buffer_load_dwordx4 a[108:111], v237, s[24:27], s59 offen offset:3072 sc1
v_mfma_f32_16x16x32_bf16 v[124:127], v[8:11], a[76:79], v[124:127]
ds_read_b64_tr_b16 v[6:7], v65 offset:4608
v_mfma_f32_16x16x32_bf16 v[128:131], v[12:15], a[72:75], v[128:131]
ds_read_b64_tr_b16 v[8:9], v66 offset:0
v_mfma_f32_16x16x32_bf16 v[132:135], v[12:15], a[76:79], v[132:135]
ds_read_b64_tr_b16 v[10:11], v66 offset:4608
v_mfma_f32_16x16x32_bf16 v[136:139], v[16:19], a[72:75], v[136:139]
ds_read_b64_tr_b16 v[12:13], v67 offset:0
v_mfma_f32_16x16x32_bf16 v[140:143], v[16:19], a[76:79], v[140:143]
ds_read_b64_tr_b16 v[14:15], v67 offset:4608
s_waitcnt lgkmcnt(9)
v_mfma_f32_16x16x32_bf16 v[144:147], v[20:23], a[72:75], v[144:147]
ds_read_b64_tr_b16 v[16:17], v68 offset:0
buffer_load_dwordx4 v251, s[28:31], s57 offen offset:3072  lds
v_mfma_f32_16x16x32_bf16 v[148:151], v[20:23], a[76:79], v[148:151]
ds_read_b64_tr_b16 v[18:19], v68 offset:4608
v_mfma_f32_16x16x32_bf16 v[152:155], v[24:27], a[72:75], v[152:155]
ds_read_b64_tr_b16 v[20:21], v69 offset:0
s_add_u32 m0, s56, 45056
v_mfma_f32_16x16x32_bf16 v[156:159], v[24:27], a[76:79], v[156:159]
ds_read_b64_tr_b16 v[22:23], v69 offset:4608
buffer_load_dwordx4 v252, s[28:31], s57 offen  lds
v_mfma_f32_16x16x32_bf16 v[160:163], v[28:31], a[72:75], v[160:163]
ds_read_b64_tr_b16 v[24:25], v70 offset:0
v_mfma_f32_16x16x32_bf16 v[164:167], v[28:31], a[76:79], v[164:167]
ds_read_b64_tr_b16 v[26:27], v70 offset:4608
s_waitcnt vmcnt(15) lgkmcnt(10)
v_mfma_f32_16x16x32_bf16 v[96:99], v[0:3], a[80:83], v[96:99]
ds_read_b64_tr_b16 v[28:29], v71 offset:0
s_add_u32 s58, s50, 1
v_mfma_f32_16x16x32_bf16 v[100:103], v[0:3], a[84:87], v[100:103]
ds_read_b64_tr_b16 v[30:31], v71 offset:4608
s_and_b32 s58, s58, 3
v_mfma_f32_16x16x32_bf16 v[168:171], v[0:3], v[76:79], v[168:171]
s_mul_i32 s58, s58, 73728
s_add_u32 s58, s58, s60
v_mfma_f32_16x16x32_bf16 v[104:107], v[4:7], a[80:83], v[104:107]
ds_read_b64_tr_b16 v[0:1], v72 offset:0
s_add_u32 s58, s58, 36864
v_mfma_f32_16x16x32_bf16 v[108:111], v[4:7], a[84:87], v[108:111]
ds_read_b64_tr_b16 v[2:3], v72 offset:4608
s_lshl_b32 s59, s39, 1
s_add_u32 s58, s58, s59
s_add_u32 s59, s58, 4096
buffer_load_dwordx4 a[112:115], v237, s[24:27], s58 offen offset:0 sc1
v_mfma_f32_16x16x32_bf16 v[172:175], v[4:7], v[76:79], v[172:175]
s_add_u32 s57, s50, 1
s_waitcnt lgkmcnt(10)
v_mfma_f32_16x16x32_bf16 v[112:115], v[8:11], a[80:83], v[112:115]
ds_read_b64_tr_b16 v[4:5], v64 offset:9216
s_and_b32 s57, s57, 3
v_mfma_f32_16x16x32_bf16 v[116:119], v[8:11], a[84:87], v[116:119]
ds_read_b64_tr_b16 v[6:7], v64 offset:13824
s_mul_i32 s57, s57, 73728
v_mfma_f32_16x16x32_bf16 v[60:63], v[8:11], v[76:79], v[60:63]
ds_read_b128 v[80:83], v73 offset:1024
s_add_u32 s57, s57, s60
s_add_u32 s57, s57, 36864
s_lshr_b32 s6, s39, 2
s_add_u32 s57, s57, s6
s_add_u32 m0, s6, 151552
s_add_u32 s57, s57, 32768
buffer_load_dwordx4 v237, s[24:27], s57 offen sc1 lds
v_mfma_f32_16x16x32_bf16 v[120:123], v[12:15], a[80:83], v[120:123]
ds_read_b64_tr_b16 v[8:9], v65 offset:9216
v_mfma_f32_16x16x32_bf16 v[124:127], v[12:15], a[84:87], v[124:127]
ds_read_b64_tr_b16 v[10:11], v65 offset:13824
s_waitcnt lgkmcnt(9)
v_mfma_f32_16x16x32_bf16 v[128:131], v[16:19], a[80:83], v[128:131]
ds_read_b64_tr_b16 v[12:13], v66 offset:9216
buffer_load_dwordx4 a[116:119], v237, s[24:27], s59 offen offset:0 sc1
v_mfma_f32_16x16x32_bf16 v[132:135], v[16:19], a[84:87], v[132:135]
ds_read_b64_tr_b16 v[14:15], v66 offset:13824
s_add_u32 s57, s50, 2
v_mfma_f32_16x16x32_bf16 v[136:139], v[20:23], a[80:83], v[136:139]
ds_read_b64_tr_b16 v[16:17], v67 offset:9216
s_and_b32 s57, s57, 3
v_mfma_f32_16x16x32_bf16 v[140:143], v[20:23], a[84:87], v[140:143]
ds_read_b64_tr_b16 v[18:19], v67 offset:13824
s_mul_i32 s57, s57, 294912
v_mfma_f32_16x16x32_bf16 v[144:147], v[24:27], a[80:83], v[144:147]
ds_read_b64_tr_b16 v[20:21], v68 offset:9216
s_add_u32 s57, s57, s61
v_mfma_f32_16x16x32_bf16 v[148:151], v[24:27], a[84:87], v[148:151]
ds_read_b64_tr_b16 v[22:23], v68 offset:13824
s_waitcnt lgkmcnt(9)
v_mfma_f32_16x16x32_bf16 v[152:155], v[28:31], a[80:83], v[152:155]
ds_read_b64_tr_b16 v[24:25], v69 offset:9216
s_add_u32 s57, s57, 147456
v_mfma_f32_16x16x32_bf16 v[156:159], v[28:31], a[84:87], v[156:159]
ds_read_b64_tr_b16 v[26:27], v69 offset:13824
s_add_u32 m0, s56, 73728
s_nop 0
buffer_load_dwordx4 v244, s[28:31], s57 offen  lds
v_mfma_f32_16x16x32_bf16 v[160:163], v[0:3], a[80:83], v[160:163]
ds_read_b64_tr_b16 v[28:29], v70 offset:9216
v_mfma_f32_16x16x32_bf16 v[164:167], v[0:3], a[84:87], v[164:167]
ds_read_b64_tr_b16 v[30:31], v70 offset:13824
s_waitcnt vmcnt(14)
v_mfma_f32_16x16x32_bf16 v[96:99], v[4:7], a[88:91], v[96:99]
ds_read_b64_tr_b16 v[0:1], v71 offset:9216
v_mfma_f32_16x16x32_bf16 v[100:103], v[4:7], a[92:95], v[100:103]
ds_read_b64_tr_b16 v[2:3], v71 offset:13824
s_waitcnt lgkmcnt(10)
v_mfma_f32_16x16x32_bf16 v[168:171], v[4:7], v[80:83], v[168:171]
buffer_load_dwordx4 a[120:123], v237, s[24:27], s58 offen offset:1024 sc1
v_mfma_f32_16x16x32_bf16 v[104:107], v[8:11], a[88:91], v[104:107]
ds_read_b64_tr_b16 v[4:5], v72 offset:9216
v_mfma_f32_16x16x32_bf16 v[108:111], v[8:11], a[92:95], v[108:111]
ds_read_b64_tr_b16 v[6:7], v72 offset:13824
buffer_load_dwordx4 v245, s[28:31], s57 offen offset:1024  lds
v_mfma_f32_16x16x32_bf16 v[172:175], v[8:11], v[80:83], v[172:175]
v_mfma_f32_16x16x32_bf16 v[112:115], v[12:15], a[88:91], v[112:115]
ds_read_b64_tr_b16 v[8:9], v64 offset:18432
v_mfma_f32_16x16x32_bf16 v[116:119], v[12:15], a[92:95], v[116:119]
ds_read_b64_tr_b16 v[10:11], v64 offset:23040
v_mfma_f32_16x16x32_bf16 v[60:63], v[12:15], v[80:83], v[60:63]
ds_read_b128 v[76:79], v73 offset:2048
s_waitcnt lgkmcnt(9)
v_mfma_f32_16x16x32_bf16 v[120:123], v[16:19], a[88:91], v[120:123]
ds_read_b64_tr_b16 v[12:13], v65 offset:18432
buffer_load_dwordx4 a[124:127], v237, s[24:27], s59 offen offset:1024 sc1
v_mfma_f32_16x16x32_bf16 v[124:127], v[16:19], a[92:95], v[124:127]
ds_read_b64_tr_b16 v[14:15], v65 offset:23040
v_mfma_f32_16x16x32_bf16 v[128:131], v[20:23], a[88:91], v[128:131]
ds_read_b64_tr_b16 v[16:17], v66 offset:18432
v_mfma_f32_16x16x32_bf16 v[132:135], v[20:23], a[92:95], v[132:135]
ds_read_b64_tr_b16 v[18:19], v66 offset:23040
v_mfma_f32_16x16x32_bf16 v[136:139], v[24:27], a[88:91], v[136:139]
ds_read_b64_tr_b16 v[20:21], v67 offset:18432
buffer_load_dwordx4 v246, s[28:31], s57 offen offset:2048  lds
v_mfma_f32_16x16x32_bf16 v[140:143], v[24:27], a[92:95], v[140:143]
ds_read_b64_tr_b16 v[22:23], v67 offset:23040
s_waitcnt lgkmcnt(9)
v_mfma_f32_16x16x32_bf16 v[144:147], v[28:31], a[88:91], v[144:147]
ds_read_b64_tr_b16 v[24:25], v68 offset:18432
v_mfma_f32_16x16x32_bf16 v[148:151], v[28:31], a[92:95], v[148:151]
ds_read_b64_tr_b16 v[26:27], v68 offset:23040
v_mfma_f32_16x16x32_bf16 v[152:155], v[0:3], a[88:91], v[152:155]
ds_read_b64_tr_b16 v[28:29], v69 offset:18432
v_mfma_f32_16x16x32_bf16 v[156:159], v[0:3], a[92:95], v[156:159]
ds_read_b64_tr_b16 v[30:31], v69 offset:23040
buffer_load_dwordx4 v247, s[28:31], s57 offen offset:3072  lds
v_mfma_f32_16x16x32_bf16 v[160:163], v[4:7], a[88:91], v[160:163]
ds_read_b64_tr_b16 v[0:1], v70 offset:18432
v_mfma_f32_16x16x32_bf16 v[164:167], v[4:7], a[92:95], v[164:167]
ds_read_b64_tr_b16 v[2:3], v70 offset:23040
s_waitcnt vmcnt(15) lgkmcnt(10)
v_mfma_f32_16x16x32_bf16 v[96:99], v[8:11], a[96:99], v[96:99]
ds_read_b64_tr_b16 v[4:5], v71 offset:18432
v_mfma_f32_16x16x32_bf16 v[100:103], v[8:11], a[100:103], v[100:103]
ds_read_b64_tr_b16 v[6:7], v71 offset:23040
v_mfma_f32_16x16x32_bf16 v[168:171], v[8:11], v[76:79], v[168:171]
buffer_load_dwordx4 a[128:131], v237, s[24:27], s58 offen offset:2048 sc1
v_mfma_f32_16x16x32_bf16 v[104:107], v[12:15], a[96:99], v[104:107]
ds_read_b64_tr_b16 v[8:9], v72 offset:18432
v_mfma_f32_16x16x32_bf16 v[108:111], v[12:15], a[100:103], v[108:111]
ds_read_b64_tr_b16 v[10:11], v72 offset:23040
v_mfma_f32_16x16x32_bf16 v[172:175], v[12:15], v[76:79], v[172:175]
s_add_u32 m0, s56, 77824
s_waitcnt lgkmcnt(10)
v_mfma_f32_16x16x32_bf16 v[112:115], v[16:19], a[96:99], v[112:115]
ds_read_b64_tr_b16 v[12:13], v64 offset:27648
buffer_load_dwordx4 v248, s[28:31], s57 offen  lds
v_mfma_f32_16x16x32_bf16 v[116:119], v[16:19], a[100:103], v[116:119]
ds_read_b64_tr_b16 v[14:15], v64 offset:32256
v_mfma_f32_16x16x32_bf16 v[60:63], v[16:19], v[76:79], v[60:63]
ds_read_b128 v[80:83], v73 offset:3072
v_mfma_f32_16x16x32_bf16 v[120:123], v[20:23], a[96:99], v[120:123]
ds_read_b64_tr_b16 v[16:17], v65 offset:27648
v_mfma_f32_16x16x32_bf16 v[124:127], v[20:23], a[100:103], v[124:127]
ds_read_b64_tr_b16 v[18:19], v65 offset:32256
s_waitcnt lgkmcnt(9)
v_mfma_f32_16x16x32_bf16 v[128:131], v[24:27], a[96:99], v[128:131]
ds_read_b64_tr_b16 v[20:21], v66 offset:27648
buffer_load_dwordx4 a[132:135], v237, s[24:27], s59 offen offset:2048 sc1
v_mfma_f32_16x16x32_bf16 v[132:135], v[24:27], a[100:103], v[132:135]
ds_read_b64_tr_b16 v[22:23], v66 offset:32256
v_mfma_f32_16x16x32_bf16 v[136:139], v[28:31], a[96:99], v[136:139]
ds_read_b64_tr_b16 v[24:25], v67 offset:27648
v_mfma_f32_16x16x32_bf16 v[140:143], v[28:31], a[100:103], v[140:143]
ds_read_b64_tr_b16 v[26:27], v67 offset:32256
v_mfma_f32_16x16x32_bf16 v[144:147], v[0:3], a[96:99], v[144:147]
ds_read_b64_tr_b16 v[28:29], v68 offset:27648
v_mfma_f32_16x16x32_bf16 v[148:151], v[0:3], a[100:103], v[148:151]
ds_read_b64_tr_b16 v[30:31], v68 offset:32256
s_waitcnt lgkmcnt(9)
v_mfma_f32_16x16x32_bf16 v[152:155], v[4:7], a[96:99], v[152:155]
ds_read_b64_tr_b16 v[0:1], v69 offset:27648
buffer_load_dwordx4 v249, s[28:31], s57 offen offset:1024  lds
v_mfma_f32_16x16x32_bf16 v[156:159], v[4:7], a[100:103], v[156:159]
ds_read_b64_tr_b16 v[2:3], v69 offset:32256
v_mfma_f32_16x16x32_bf16 v[160:163], v[8:11], a[96:99], v[160:163]
ds_read_b64_tr_b16 v[4:5], v70 offset:27648
v_mfma_f32_16x16x32_bf16 v[164:167], v[8:11], a[100:103], v[164:167]
ds_read_b64_tr_b16 v[6:7], v70 offset:32256
s_waitcnt vmcnt(15)
v_mfma_f32_16x16x32_bf16 v[96:99], v[12:15], a[104:107], v[96:99]
ds_read_b64_tr_b16 v[8:9], v71 offset:27648
v_mfma_f32_16x16x32_bf16 v[100:103], v[12:15], a[108:111], v[100:103]
ds_read_b64_tr_b16 v[10:11], v71 offset:32256
s_waitcnt lgkmcnt(10)
v_mfma_f32_16x16x32_bf16 v[168:171], v[12:15], v[80:83], v[168:171]
buffer_load_dwordx4 a[136:139], v237, s[24:27], s58 offen offset:3072 sc1
v_mfma_f32_16x16x32_bf16 v[104:107], v[16:19], a[104:107], v[104:107]
ds_read_b64_tr_b16 v[12:13], v72 offset:27648
v_mfma_f32_16x16x32_bf16 v[108:111], v[16:19], a[108:111], v[108:111]
ds_read_b64_tr_b16 v[14:15], v72 offset:32256
buffer_load_dwordx4 v250, s[28:31], s57 offen offset:2048  lds
v_mfma_f32_16x16x32_bf16 v[172:175], v[16:19], v[80:83], v[172:175]
v_mfma_f32_16x16x32_bf16 v[112:115], v[20:23], a[104:107], v[112:115]
s_waitcnt vmcnt(13)
s_barrier
v_mfma_f32_16x16x32_bf16 v[116:119], v[20:23], a[108:111], v[116:119]
ds_read_b64_tr_b16 v[16:17], v64 offset:36864
v_mfma_f32_16x16x32_bf16 v[60:63], v[20:23], v[80:83], v[60:63]
ds_read_b64_tr_b16 v[18:19], v64 offset:41472
ds_read_b128 v[76:79], v73 offset:4096
s_waitcnt lgkmcnt(9)
v_mfma_f32_16x16x32_bf16 v[120:123], v[24:27], a[104:107], v[120:123]
ds_read_b64_tr_b16 v[20:21], v65 offset:36864
buffer_load_dwordx4 a[140:143], v237, s[24:27], s59 offen offset:3072 sc1
v_mfma_f32_16x16x32_bf16 v[124:127], v[24:27], a[108:111], v[124:127]
ds_read_b64_tr_b16 v[22:23], v65 offset:41472
v_mfma_f32_16x16x32_bf16 v[128:131], v[28:31], a[104:107], v[128:131]
ds_read_b64_tr_b16 v[24:25], v66 offset:36864
v_mfma_f32_16x16x32_bf16 v[132:135], v[28:31], a[108:111], v[132:135]
ds_read_b64_tr_b16 v[26:27], v66 offset:41472
v_mfma_f32_16x16x32_bf16 v[136:139], v[0:3], a[104:107], v[136:139]
ds_read_b64_tr_b16 v[28:29], v67 offset:36864
buffer_load_dwordx4 v251, s[28:31], s57 offen offset:3072  lds
v_mfma_f32_16x16x32_bf16 v[140:143], v[0:3], a[108:111], v[140:143]
ds_read_b64_tr_b16 v[30:31], v67 offset:41472
s_waitcnt lgkmcnt(9)
v_mfma_f32_16x16x32_bf16 v[144:147], v[4:7], a[104:107], v[144:147]
ds_read_b64_tr_b16 v[0:1], v68 offset:36864
v_mfma_f32_16x16x32_bf16 v[148:151], v[4:7], a[108:111], v[148:151]
ds_read_b64_tr_b16 v[2:3], v68 offset:41472
v_mfma_f32_16x16x32_bf16 v[152:155], v[8:11], a[104:107], v[152:155]
ds_read_b64_tr_b16 v[4:5], v69 offset:36864
s_add_u32 m0, s56, 81920
v_mfma_f32_16x16x32_bf16 v[156:159], v[8:11], a[108:111], v[156:159]
ds_read_b64_tr_b16 v[6:7], v69 offset:41472
buffer_load_dwordx4 v252, s[28:31], s57 offen  lds
v_mfma_f32_16x16x32_bf16 v[160:163], v[12:15], a[104:107], v[160:163]
ds_read_b64_tr_b16 v[8:9], v70 offset:36864
v_mfma_f32_16x16x32_bf16 v[164:167], v[12:15], a[108:111], v[164:167]
ds_read_b64_tr_b16 v[10:11], v70 offset:41472
s_waitcnt vmcnt(15) lgkmcnt(10)
v_mfma_f32_16x16x32_bf16 v[96:99], v[16:19], a[112:115], v[96:99]
ds_read_b64_tr_b16 v[12:13], v71 offset:36864
s_add_u32 s58, s50, 2
v_mfma_f32_16x16x32_bf16 v[100:103], v[16:19], a[116:119], v[100:103]
ds_read_b64_tr_b16 v[14:15], v71 offset:41472
s_and_b32 s58, s58, 3
v_mfma_f32_16x16x32_bf16 v[168:171], v[16:19], v[76:79], v[168:171]
s_mul_i32 s58, s58, 73728
s_add_u32 s58, s58, s60
v_mfma_f32_16x16x32_bf16 v[104:107], v[20:23], a[112:115], v[104:107]
ds_read_b64_tr_b16 v[16:17], v72 offset:36864
s_add_u32 s58, s58, 36864
v_mfma_f32_16x16x32_bf16 v[108:111], v[20:23], a[116:119], v[108:111]
ds_read_b64_tr_b16 v[18:19], v72 offset:41472
s_lshl_b32 s59, s39, 1
s_add_u32 s58, s58, s59
s_add_u32 s59, s58, 4096
buffer_load_dwordx4 a[48:51], v237, s[24:27], s58 offen offset:0 sc1
v_mfma_f32_16x16x32_bf16 v[172:175], v[20:23], v[76:79], v[172:175]
s_add_u32 s57, s50, 2
s_waitcnt lgkmcnt(10)
v_mfma_f32_16x16x32_bf16 v[112:115], v[24:27], a[112:115], v[112:115]
ds_read_b64_tr_b16 v[20:21], v64 offset:46080
s_and_b32 s57, s57, 3
v_mfma_f32_16x16x32_bf16 v[116:119], v[24:27], a[116:119], v[116:119]
ds_read_b64_tr_b16 v[22:23], v64 offset:50688
s_mul_i32 s57, s57, 73728
v_mfma_f32_16x16x32_bf16 v[60:63], v[24:27], v[76:79], v[60:63]
ds_read_b128 v[80:83], v73 offset:5120
s_add_u32 s57, s57, s60
s_add_u32 s57, s57, 36864
s_lshr_b32 s6, s39, 2
s_add_u32 s57, s57, s6
s_add_u32 m0, s6, 155648
s_add_u32 s57, s57, 32768
buffer_load_dwordx4 v237, s[24:27], s57 offen sc1 lds
v_mfma_f32_16x16x32_bf16 v[120:123], v[28:31], a[112:115], v[120:123]
ds_read_b64_tr_b16 v[24:25], v65 offset:46080
v_mfma_f32_16x16x32_bf16 v[124:127], v[28:31], a[116:119], v[124:127]
ds_read_b64_tr_b16 v[26:27], v65 offset:50688
s_waitcnt lgkmcnt(9)
v_mfma_f32_16x16x32_bf16 v[128:131], v[0:3], a[112:115], v[128:131]
ds_read_b64_tr_b16 v[28:29], v66 offset:46080
buffer_load_dwordx4 a[52:55], v237, s[24:27], s59 offen offset:0 sc1
v_mfma_f32_16x16x32_bf16 v[132:135], v[0:3], a[116:119], v[132:135]
ds_read_b64_tr_b16 v[30:31], v66 offset:50688
s_add_u32 s57, s50, 3
v_mfma_f32_16x16x32_bf16 v[136:139], v[4:7], a[112:115], v[136:139]
ds_read_b64_tr_b16 v[0:1], v67 offset:46080
s_and_b32 s57, s57, 3
v_mfma_f32_16x16x32_bf16 v[140:143], v[4:7], a[116:119], v[140:143]
ds_read_b64_tr_b16 v[2:3], v67 offset:50688
s_mul_i32 s57, s57, 294912
v_mfma_f32_16x16x32_bf16 v[144:147], v[8:11], a[112:115], v[144:147]
ds_read_b64_tr_b16 v[4:5], v68 offset:46080
s_add_u32 s57, s57, s61
v_mfma_f32_16x16x32_bf16 v[148:151], v[8:11], a[116:119], v[148:151]
ds_read_b64_tr_b16 v[6:7], v68 offset:50688
s_waitcnt lgkmcnt(9)
v_mfma_f32_16x16x32_bf16 v[152:155], v[12:15], a[112:115], v[152:155]
ds_read_b64_tr_b16 v[8:9], v69 offset:46080
s_add_u32 s57, s57, 147456
v_mfma_f32_16x16x32_bf16 v[156:159], v[12:15], a[116:119], v[156:159]
ds_read_b64_tr_b16 v[10:11], v69 offset:50688
s_add_u32 m0, s56, 110592
s_nop 0
buffer_load_dwordx4 v244, s[28:31], s57 offen  lds
v_mfma_f32_16x16x32_bf16 v[160:163], v[16:19], a[112:115], v[160:163]
ds_read_b64_tr_b16 v[12:13], v70 offset:46080
v_mfma_f32_16x16x32_bf16 v[164:167], v[16:19], a[116:119], v[164:167]
ds_read_b64_tr_b16 v[14:15], v70 offset:50688
s_waitcnt vmcnt(15)
v_mfma_f32_16x16x32_bf16 v[96:99], v[20:23], a[120:123], v[96:99]
ds_read_b64_tr_b16 v[16:17], v71 offset:46080
v_mfma_f32_16x16x32_bf16 v[100:103], v[20:23], a[124:127], v[100:103]
ds_read_b64_tr_b16 v[18:19], v71 offset:50688
s_waitcnt lgkmcnt(10)
v_mfma_f32_16x16x32_bf16 v[168:171], v[20:23], v[80:83], v[168:171]
buffer_load_dwordx4 a[56:59], v237, s[24:27], s58 offen offset:1024 sc1
v_mfma_f32_16x16x32_bf16 v[104:107], v[24:27], a[120:123], v[104:107]
ds_read_b64_tr_b16 v[20:21], v72 offset:46080
v_mfma_f32_16x16x32_bf16 v[108:111], v[24:27], a[124:127], v[108:111]
ds_read_b64_tr_b16 v[22:23], v72 offset:50688
buffer_load_dwordx4 v245, s[28:31], s57 offen offset:1024  lds
v_mfma_f32_16x16x32_bf16 v[172:175], v[24:27], v[80:83], v[172:175]
v_mfma_f32_16x16x32_bf16 v[112:115], v[28:31], a[120:123], v[112:115]
ds_read_b64_tr_b16 v[24:25], v64 offset:55296
v_mfma_f32_16x16x32_bf16 v[116:119], v[28:31], a[124:127], v[116:119]
ds_read_b64_tr_b16 v[26:27], v64 offset:59904
v_mfma_f32_16x16x32_bf16 v[60:63], v[28:31], v[80:83], v[60:63]
ds_read_b128 v[76:79], v73 offset:6144
s_waitcnt lgkmcnt(9)
v_mfma_f32_16x16x32_bf16 v[120:123], v[0:3], a[120:123], v[120:123]
ds_read_b64_tr_b16 v[28:29], v65 offset:55296
buffer_load_dwordx4 a[60:63], v237, s[24:27], s59 offen offset:1024 sc1
v_mfma_f32_16x16x32_bf16 v[124:127], v[0:3], a[124:127], v[124:127]
ds_read_b64_tr_b16 v[30:31], v65 offset:59904
v_add_u32 v64, 64512, v64
v_mfma_f32_16x16x32_bf16 v[128:131], v[4:7], a[120:123], v[128:131]
ds_read_b64_tr_b16 v[0:1], v66 offset:55296
v_mfma_f32_16x16x32_bf16 v[132:135], v[4:7], a[124:127], v[132:135]
ds_read_b64_tr_b16 v[2:3], v66 offset:59904
v_add_u32 v65, 64512, v65
v_mfma_f32_16x16x32_bf16 v[136:139], v[8:11], a[120:123], v[136:139]
ds_read_b64_tr_b16 v[4:5], v67 offset:55296
buffer_load_dwordx4 v246, s[28:31], s57 offen offset:2048  lds
v_mfma_f32_16x16x32_bf16 v[140:143], v[8:11], a[124:127], v[140:143]
ds_read_b64_tr_b16 v[6:7], v67 offset:59904
s_waitcnt lgkmcnt(9)
v_mfma_f32_16x16x32_bf16 v[144:147], v[12:15], a[120:123], v[144:147]
ds_read_b64_tr_b16 v[8:9], v68 offset:55296
v_add_u32 v66, 64512, v66
v_mfma_f32_16x16x32_bf16 v[148:151], v[12:15], a[124:127], v[148:151]
ds_read_b64_tr_b16 v[10:11], v68 offset:59904
v_add_u32 v67, 64512, v67
v_mfma_f32_16x16x32_bf16 v[152:155], v[16:19], a[120:123], v[152:155]
ds_read_b64_tr_b16 v[12:13], v69 offset:55296
v_mfma_f32_16x16x32_bf16 v[156:159], v[16:19], a[124:127], v[156:159]
ds_read_b64_tr_b16 v[14:15], v69 offset:59904
buffer_load_dwordx4 v247, s[28:31], s57 offen offset:3072  lds
v_mfma_f32_16x16x32_bf16 v[160:163], v[20:23], a[120:123], v[160:163]
ds_read_b64_tr_b16 v[16:17], v70 offset:55296
v_add_u32 v68, 64512, v68
v_mfma_f32_16x16x32_bf16 v[164:167], v[20:23], a[124:127], v[164:167]
ds_read_b64_tr_b16 v[18:19], v70 offset:59904
s_waitcnt vmcnt(15) lgkmcnt(10)
v_mfma_f32_16x16x32_bf16 v[96:99], v[24:27], a[128:131], v[96:99]
ds_read_b64_tr_b16 v[20:21], v71 offset:55296
v_add_u32 v69, 64512, v69
v_mfma_f32_16x16x32_bf16 v[100:103], v[24:27], a[132:135], v[100:103]
ds_read_b64_tr_b16 v[22:23], v71 offset:59904
v_add_u32 v70, 64512, v70
v_mfma_f32_16x16x32_bf16 v[168:171], v[24:27], v[76:79], v[168:171]
buffer_load_dwordx4 a[64:67], v237, s[24:27], s58 offen offset:2048 sc1
v_mfma_f32_16x16x32_bf16 v[104:107], v[28:31], a[128:131], v[104:107]
ds_read_b64_tr_b16 v[24:25], v72 offset:55296
v_add_u32 v71, 64512, v71
v_mfma_f32_16x16x32_bf16 v[108:111], v[28:31], a[132:135], v[108:111]
ds_read_b64_tr_b16 v[26:27], v72 offset:59904
v_mfma_f32_16x16x32_bf16 v[172:175], v[28:31], v[76:79], v[172:175]
s_add_u32 m0, s56, 114688
s_waitcnt lgkmcnt(10)
v_mfma_f32_16x16x32_bf16 v[112:115], v[0:3], a[128:131], v[112:115]
ds_read_b64_tr_b16 v[28:29], v64 offset:0
buffer_load_dwordx4 v248, s[28:31], s57 offen  lds
v_mfma_f32_16x16x32_bf16 v[116:119], v[0:3], a[132:135], v[116:119]
ds_read_b64_tr_b16 v[30:31], v64 offset:4608
v_add_u32 v72, 64512, v72
v_mfma_f32_16x16x32_bf16 v[60:63], v[0:3], v[76:79], v[60:63]
ds_read_b128 v[80:83], v73 offset:7168
v_mfma_f32_16x16x32_bf16 v[120:123], v[4:7], a[128:131], v[120:123]
ds_read_b64_tr_b16 v[0:1], v65 offset:0
v_mfma_f32_16x16x32_bf16 v[124:127], v[4:7], a[132:135], v[124:127]
ds_read_b64_tr_b16 v[2:3], v65 offset:4608
s_waitcnt lgkmcnt(9)
v_mfma_f32_16x16x32_bf16 v[128:131], v[8:11], a[128:131], v[128:131]
ds_read_b64_tr_b16 v[4:5], v66 offset:0
buffer_load_dwordx4 a[68:71], v237, s[24:27], s59 offen offset:2048 sc1
v_mfma_f32_16x16x32_bf16 v[132:135], v[8:11], a[132:135], v[132:135]
ds_read_b64_tr_b16 v[6:7], v66 offset:4608
v_mfma_f32_16x16x32_bf16 v[136:139], v[12:15], a[128:131], v[136:139]
ds_read_b64_tr_b16 v[8:9], v67 offset:0
v_mfma_f32_16x16x32_bf16 v[140:143], v[12:15], a[132:135], v[140:143]
ds_read_b64_tr_b16 v[10:11], v67 offset:4608
v_mfma_f32_16x16x32_bf16 v[144:147], v[16:19], a[128:131], v[144:147]
ds_read_b64_tr_b16 v[12:13], v68 offset:0
v_mfma_f32_16x16x32_bf16 v[148:151], v[16:19], a[132:135], v[148:151]
ds_read_b64_tr_b16 v[14:15], v68 offset:4608
s_waitcnt lgkmcnt(9)
v_mfma_f32_16x16x32_bf16 v[152:155], v[20:23], a[128:131], v[152:155]
ds_read_b64_tr_b16 v[16:17], v69 offset:0
buffer_load_dwordx4 v249, s[28:31], s57 offen offset:1024  lds
v_mfma_f32_16x16x32_bf16 v[156:159], v[20:23], a[132:135], v[156:159]
ds_read_b64_tr_b16 v[18:19], v69 offset:4608
v_mfma_f32_16x16x32_bf16 v[160:163], v[24:27], a[128:131], v[160:163]
ds_read_b64_tr_b16 v[20:21], v70 offset:0
v_mfma_f32_16x16x32_bf16 v[164:167], v[24:27], a[132:135], v[164:167]
ds_read_b64_tr_b16 v[22:23], v70 offset:4608
s_waitcnt vmcnt(15)
v_mfma_f32_16x16x32_bf16 v[96:99], v[28:31], a[136:139], v[96:99]
ds_read_b64_tr_b16 v[24:25], v71 offset:0
v_mfma_f32_16x16x32_bf16 v[100:103], v[28:31], a[140:143], v[100:103]
ds_read_b64_tr_b16 v[26:27], v71 offset:4608
s_waitcnt lgkmcnt(10)
v_mfma_f32_16x16x32_bf16 v[168:171], v[28:31], v[80:83], v[168:171]
buffer_load_dwordx4 a[72:75], v237, s[24:27], s58 offen offset:3072 sc1
v_mfma_f32_16x16x32_bf16 v[104:107], v[0:3], a[136:139], v[104:107]
ds_read_b64_tr_b16 v[28:29], v72 offset:0
v_mfma_f32_16x16x32_bf16 v[108:111], v[0:3], a[140:143], v[108:111]
ds_read_b64_tr_b16 v[30:31], v72 offset:4608
buffer_load_dwordx4 v250, s[28:31], s57 offen offset:2048  lds
v_mfma_f32_16x16x32_bf16 v[172:175], v[0:3], v[80:83], v[172:175]
v_mfma_f32_16x16x32_bf16 v[112:115], v[4:7], a[136:139], v[112:115]
s_waitcnt vmcnt(13)
s_barrier
v_mfma_f32_16x16x32_bf16 v[116:119], v[4:7], a[140:143], v[116:119]
ds_read_b64_tr_b16 v[0:1], v64 offset:9216
v_mfma_f32_16x16x32_bf16 v[60:63], v[4:7], v[80:83], v[60:63]
ds_read_b64_tr_b16 v[2:3], v64 offset:13824
ds_read_b128 v[76:79], v73 offset:8192
s_waitcnt lgkmcnt(9)
v_mfma_f32_16x16x32_bf16 v[120:123], v[8:11], a[136:139], v[120:123]
ds_read_b64_tr_b16 v[4:5], v65 offset:9216
buffer_load_dwordx4 a[76:79], v237, s[24:27], s59 offen offset:3072 sc1
v_mfma_f32_16x16x32_bf16 v[124:127], v[8:11], a[140:143], v[124:127]
ds_read_b64_tr_b16 v[6:7], v65 offset:13824
v_mfma_f32_16x16x32_bf16 v[128:131], v[12:15], a[136:139], v[128:131]
ds_read_b64_tr_b16 v[8:9], v66 offset:9216
v_mfma_f32_16x16x32_bf16 v[132:135], v[12:15], a[140:143], v[132:135]
ds_read_b64_tr_b16 v[10:11], v66 offset:13824
v_mfma_f32_16x16x32_bf16 v[136:139], v[16:19], a[136:139], v[136:139]
ds_read_b64_tr_b16 v[12:13], v67 offset:9216
buffer_load_dwordx4 v251, s[28:31], s57 offen offset:3072  lds
v_mfma_f32_16x16x32_bf16 v[140:143], v[16:19], a[140:143], v[140:143]
ds_read_b64_tr_b16 v[14:15], v67 offset:13824
s_waitcnt lgkmcnt(9)
v_mfma_f32_16x16x32_bf16 v[144:147], v[20:23], a[136:139], v[144:147]
ds_read_b64_tr_b16 v[16:17], v68 offset:9216
v_mfma_f32_16x16x32_bf16 v[148:151], v[20:23], a[140:143], v[148:151]
ds_read_b64_tr_b16 v[18:19], v68 offset:13824
v_mfma_f32_16x16x32_bf16 v[152:155], v[24:27], a[136:139], v[152:155]
ds_read_b64_tr_b16 v[20:21], v69 offset:9216
s_add_u32 m0, s56, 118784
v_mfma_f32_16x16x32_bf16 v[156:159], v[24:27], a[140:143], v[156:159]
ds_read_b64_tr_b16 v[22:23], v69 offset:13824
buffer_load_dwordx4 v252, s[28:31], s57 offen  lds
v_mfma_f32_16x16x32_bf16 v[160:163], v[28:31], a[136:139], v[160:163]
ds_read_b64_tr_b16 v[24:25], v70 offset:9216
v_mfma_f32_16x16x32_bf16 v[164:167], v[28:31], a[140:143], v[164:167]
ds_read_b64_tr_b16 v[26:27], v70 offset:13824
s_waitcnt vmcnt(15) lgkmcnt(10)
v_mfma_f32_16x16x32_bf16 v[96:99], v[0:3], a[48:51], v[96:99]
ds_read_b64_tr_b16 v[28:29], v71 offset:9216
s_add_u32 s58, s50, 3
v_mfma_f32_16x16x32_bf16 v[100:103], v[0:3], a[52:55], v[100:103]
ds_read_b64_tr_b16 v[30:31], v71 offset:13824
s_and_b32 s58, s58, 3
v_mfma_f32_16x16x32_bf16 v[168:171], v[0:3], v[76:79], v[168:171]
s_mul_i32 s58, s58, 73728
s_add_u32 s58, s58, s60
v_mfma_f32_16x16x32_bf16 v[104:107], v[4:7], a[48:51], v[104:107]
ds_read_b64_tr_b16 v[0:1], v72 offset:9216
s_add_u32 s58, s58, 36864
v_mfma_f32_16x16x32_bf16 v[108:111], v[4:7], a[52:55], v[108:111]
ds_read_b64_tr_b16 v[2:3], v72 offset:13824
s_lshl_b32 s59, s39, 1
s_add_u32 s58, s58, s59
s_add_u32 s59, s58, 4096
buffer_load_dwordx4 a[16:19], v237, s[24:27], s58 offen offset:0 sc1
v_mfma_f32_16x16x32_bf16 v[172:175], v[4:7], v[76:79], v[172:175]
s_waitcnt lgkmcnt(10)
v_mfma_f32_16x16x32_bf16 v[112:115], v[8:11], a[48:51], v[112:115]
ds_read_b64_tr_b16 v[4:5], v64 offset:18432
v_mfma_f32_16x16x32_bf16 v[116:119], v[8:11], a[52:55], v[116:119]
ds_read_b64_tr_b16 v[6:7], v64 offset:23040
v_mfma_f32_16x16x32_bf16 v[60:63], v[8:11], v[76:79], v[60:63]
ds_read_b128 v[80:83], v73 offset:9216
v_mfma_f32_16x16x32_bf16 v[120:123], v[12:15], a[48:51], v[120:123]
ds_read_b64_tr_b16 v[8:9], v65 offset:18432
v_mfma_f32_16x16x32_bf16 v[124:127], v[12:15], a[52:55], v[124:127]
ds_read_b64_tr_b16 v[10:11], v65 offset:23040
s_waitcnt lgkmcnt(9)
v_mfma_f32_16x16x32_bf16 v[128:131], v[16:19], a[48:51], v[128:131]
ds_read_b64_tr_b16 v[12:13], v66 offset:18432
buffer_load_dwordx4 a[20:23], v237, s[24:27], s59 offen offset:0 sc1
v_mfma_f32_16x16x32_bf16 v[132:135], v[16:19], a[52:55], v[132:135]
ds_read_b64_tr_b16 v[14:15], v66 offset:23040
v_mfma_f32_16x16x32_bf16 v[136:139], v[20:23], a[48:51], v[136:139]
ds_read_b64_tr_b16 v[16:17], v67 offset:18432
v_mfma_f32_16x16x32_bf16 v[140:143], v[20:23], a[52:55], v[140:143]
ds_read_b64_tr_b16 v[18:19], v67 offset:23040
v_mfma_f32_16x16x32_bf16 v[144:147], v[24:27], a[48:51], v[144:147]
ds_read_b64_tr_b16 v[20:21], v68 offset:18432
v_mfma_f32_16x16x32_bf16 v[148:151], v[24:27], a[52:55], v[148:151]
ds_read_b64_tr_b16 v[22:23], v68 offset:23040
s_waitcnt lgkmcnt(9)
v_mfma_f32_16x16x32_bf16 v[152:155], v[28:31], a[48:51], v[152:155]
ds_read_b64_tr_b16 v[24:25], v69 offset:18432
v_mfma_f32_16x16x32_bf16 v[156:159], v[28:31], a[52:55], v[156:159]
ds_read_b64_tr_b16 v[26:27], v69 offset:23040
v_mfma_f32_16x16x32_bf16 v[160:163], v[0:3], a[48:51], v[160:163]
ds_read_b64_tr_b16 v[28:29], v70 offset:18432
v_mfma_f32_16x16x32_bf16 v[164:167], v[0:3], a[52:55], v[164:167]
ds_read_b64_tr_b16 v[30:31], v70 offset:23040
s_waitcnt vmcnt(13)
v_mfma_f32_16x16x32_bf16 v[96:99], v[4:7], a[56:59], v[96:99]
ds_read_b64_tr_b16 v[0:1], v71 offset:18432
v_mfma_f32_16x16x32_bf16 v[100:103], v[4:7], a[60:63], v[100:103]
ds_read_b64_tr_b16 v[2:3], v71 offset:23040
s_waitcnt lgkmcnt(10)
v_mfma_f32_16x16x32_bf16 v[168:171], v[4:7], v[80:83], v[168:171]
buffer_load_dwordx4 a[24:27], v237, s[24:27], s58 offen offset:1024 sc1
v_mfma_f32_16x16x32_bf16 v[104:107], v[8:11], a[56:59], v[104:107]
ds_read_b64_tr_b16 v[4:5], v72 offset:18432
v_mfma_f32_16x16x32_bf16 v[108:111], v[8:11], a[60:63], v[108:111]
ds_read_b64_tr_b16 v[6:7], v72 offset:23040
v_mfma_f32_16x16x32_bf16 v[172:175], v[8:11], v[80:83], v[172:175]
v_mfma_f32_16x16x32_bf16 v[112:115], v[12:15], a[56:59], v[112:115]
ds_read_b64_tr_b16 v[8:9], v64 offset:27648
v_mfma_f32_16x16x32_bf16 v[116:119], v[12:15], a[60:63], v[116:119]
ds_read_b64_tr_b16 v[10:11], v64 offset:32256
v_mfma_f32_16x16x32_bf16 v[60:63], v[12:15], v[80:83], v[60:63]
ds_read_b128 v[76:79], v73 offset:10240
s_waitcnt lgkmcnt(9)
v_mfma_f32_16x16x32_bf16 v[120:123], v[16:19], a[56:59], v[120:123]
ds_read_b64_tr_b16 v[12:13], v65 offset:27648
buffer_load_dwordx4 a[28:31], v237, s[24:27], s59 offen offset:1024 sc1
v_mfma_f32_16x16x32_bf16 v[124:127], v[16:19], a[60:63], v[124:127]
ds_read_b64_tr_b16 v[14:15], v65 offset:32256
v_mfma_f32_16x16x32_bf16 v[128:131], v[20:23], a[56:59], v[128:131]
ds_read_b64_tr_b16 v[16:17], v66 offset:27648
v_mfma_f32_16x16x32_bf16 v[132:135], v[20:23], a[60:63], v[132:135]
ds_read_b64_tr_b16 v[18:19], v66 offset:32256
v_mfma_f32_16x16x32_bf16 v[136:139], v[24:27], a[56:59], v[136:139]
ds_read_b64_tr_b16 v[20:21], v67 offset:27648
v_mfma_f32_16x16x32_bf16 v[140:143], v[24:27], a[60:63], v[140:143]
ds_read_b64_tr_b16 v[22:23], v67 offset:32256
s_waitcnt lgkmcnt(9)
v_mfma_f32_16x16x32_bf16 v[144:147], v[28:31], a[56:59], v[144:147]
ds_read_b64_tr_b16 v[24:25], v68 offset:27648
v_mfma_f32_16x16x32_bf16 v[148:151], v[28:31], a[60:63], v[148:151]
ds_read_b64_tr_b16 v[26:27], v68 offset:32256
v_mfma_f32_16x16x32_bf16 v[152:155], v[0:3], a[56:59], v[152:155]
ds_read_b64_tr_b16 v[28:29], v69 offset:27648
v_mfma_f32_16x16x32_bf16 v[156:159], v[0:3], a[60:63], v[156:159]
ds_read_b64_tr_b16 v[30:31], v69 offset:32256
buffer_load_dwordx4 a[32:35], v237, s[24:27], s58 offen offset:2048 sc1
v_mfma_f32_16x16x32_bf16 v[160:163], v[4:7], a[56:59], v[160:163]
ds_read_b64_tr_b16 v[0:1], v70 offset:27648
v_mfma_f32_16x16x32_bf16 v[164:167], v[4:7], a[60:63], v[164:167]
ds_read_b64_tr_b16 v[2:3], v70 offset:32256
s_waitcnt vmcnt(11) lgkmcnt(10)
v_mfma_f32_16x16x32_bf16 v[96:99], v[8:11], a[64:67], v[96:99]
ds_read_b64_tr_b16 v[4:5], v71 offset:27648
v_mfma_f32_16x16x32_bf16 v[100:103], v[8:11], a[68:71], v[100:103]
ds_read_b64_tr_b16 v[6:7], v71 offset:32256
v_mfma_f32_16x16x32_bf16 v[168:171], v[8:11], v[76:79], v[168:171]
buffer_load_dwordx4 a[36:39], v237, s[24:27], s59 offen offset:2048 sc1
v_mfma_f32_16x16x32_bf16 v[104:107], v[12:15], a[64:67], v[104:107]
ds_read_b64_tr_b16 v[8:9], v72 offset:27648
v_mfma_f32_16x16x32_bf16 v[108:111], v[12:15], a[68:71], v[108:111]
ds_read_b64_tr_b16 v[10:11], v72 offset:32256
v_mfma_f32_16x16x32_bf16 v[172:175], v[12:15], v[76:79], v[172:175]
s_waitcnt lgkmcnt(10)
v_mfma_f32_16x16x32_bf16 v[112:115], v[16:19], a[64:67], v[112:115]
ds_read_b64_tr_b16 v[12:13], v64 offset:36864
v_mfma_f32_16x16x32_bf16 v[116:119], v[16:19], a[68:71], v[116:119]
ds_read_b64_tr_b16 v[14:15], v64 offset:41472
v_mfma_f32_16x16x32_bf16 v[60:63], v[16:19], v[76:79], v[60:63]
ds_read_b128 v[80:83], v73 offset:11264
v_mfma_f32_16x16x32_bf16 v[120:123], v[20:23], a[64:67], v[120:123]
ds_read_b64_tr_b16 v[16:17], v65 offset:36864
v_add_u32 v64, 46080, v64
v_mfma_f32_16x16x32_bf16 v[124:127], v[20:23], a[68:71], v[124:127]
ds_read_b64_tr_b16 v[18:19], v65 offset:41472
s_waitcnt lgkmcnt(9)
v_mfma_f32_16x16x32_bf16 v[128:131], v[24:27], a[64:67], v[128:131]
ds_read_b64_tr_b16 v[20:21], v66 offset:36864
v_mfma_f32_16x16x32_bf16 v[132:135], v[24:27], a[68:71], v[132:135]
ds_read_b64_tr_b16 v[22:23], v66 offset:41472
v_add_u32 v65, 46080, v65
v_mfma_f32_16x16x32_bf16 v[136:139], v[28:31], a[64:67], v[136:139]
ds_read_b64_tr_b16 v[24:25], v67 offset:36864
v_mfma_f32_16x16x32_bf16 v[140:143], v[28:31], a[68:71], v[140:143]
ds_read_b64_tr_b16 v[26:27], v67 offset:41472
v_add_u32 v66, 46080, v66
v_mfma_f32_16x16x32_bf16 v[144:147], v[0:3], a[64:67], v[144:147]
ds_read_b64_tr_b16 v[28:29], v68 offset:36864
v_mfma_f32_16x16x32_bf16 v[148:151], v[0:3], a[68:71], v[148:151]
ds_read_b64_tr_b16 v[30:31], v68 offset:41472
s_waitcnt lgkmcnt(9)
v_mfma_f32_16x16x32_bf16 v[152:155], v[4:7], a[64:67], v[152:155]
ds_read_b64_tr_b16 v[0:1], v69 offset:36864
buffer_load_dwordx4 a[40:43], v237, s[24:27], s58 offen offset:3072 sc1
v_mfma_f32_16x16x32_bf16 v[156:159], v[4:7], a[68:71], v[156:159]
ds_read_b64_tr_b16 v[2:3], v69 offset:41472
v_add_u32 v67, 46080, v67
v_mfma_f32_16x16x32_bf16 v[160:163], v[8:11], a[64:67], v[160:163]
ds_read_b64_tr_b16 v[4:5], v70 offset:36864
v_add_u32 v68, 46080, v68
v_mfma_f32_16x16x32_bf16 v[164:167], v[8:11], a[68:71], v[164:167]
ds_read_b64_tr_b16 v[6:7], v70 offset:41472
s_waitcnt vmcnt(9)
v_mfma_f32_16x16x32_bf16 v[96:99], v[12:15], a[72:75], v[96:99]
ds_read_b64_tr_b16 v[8:9], v71 offset:36864
v_add_u32 v69, 46080, v69
v_mfma_f32_16x16x32_bf16 v[100:103], v[12:15], a[76:79], v[100:103]
ds_read_b64_tr_b16 v[10:11], v71 offset:41472
s_waitcnt lgkmcnt(10)
v_mfma_f32_16x16x32_bf16 v[168:171], v[12:15], v[80:83], v[168:171]
buffer_load_dwordx4 a[44:47], v237, s[24:27], s59 offen offset:3072 sc1
v_mfma_f32_16x16x32_bf16 v[104:107], v[16:19], a[72:75], v[104:107]
ds_read_b64_tr_b16 v[12:13], v72 offset:36864
v_add_u32 v70, 46080, v70
v_mfma_f32_16x16x32_bf16 v[108:111], v[16:19], a[76:79], v[108:111]
ds_read_b64_tr_b16 v[14:15], v72 offset:41472
s_add_u32 s57, s50, 3
v_mfma_f32_16x16x32_bf16 v[172:175], v[16:19], v[80:83], v[172:175]
s_and_b32 s57, s57, 3
v_add_u32 v71, 46080, v71
v_mfma_f32_16x16x32_bf16 v[112:115], v[20:23], a[72:75], v[112:115]
s_mul_i32 s57, s57, 73728
v_add_u32 v72, 46080, v72
v_mfma_f32_16x16x32_bf16 v[116:119], v[20:23], a[76:79], v[116:119]
s_add_u32 s57, s57, s60
v_mfma_f32_16x16x32_bf16 v[60:63], v[20:23], v[80:83], v[60:63]
s_add_u32 s57, s57, 36864
s_waitcnt lgkmcnt(6)
v_mfma_f32_16x16x32_bf16 v[120:123], v[24:27], a[72:75], v[120:123]
s_lshr_b32 s6, s39, 2
v_mfma_f32_16x16x32_bf16 v[124:127], v[24:27], a[76:79], v[124:127]
s_add_u32 s57, s57, s6
v_mfma_f32_16x16x32_bf16 v[128:131], v[28:31], a[72:75], v[128:131]
s_add_u32 m0, s6, 159744
v_mfma_f32_16x16x32_bf16 v[132:135], v[28:31], a[76:79], v[132:135]
s_add_u32 s57, s57, 32768
v_mfma_f32_16x16x32_bf16 v[136:139], v[0:3], a[72:75], v[136:139]
buffer_load_dwordx4 v237, s[24:27], s57 offen sc1 lds
v_mfma_f32_16x16x32_bf16 v[140:143], v[0:3], a[76:79], v[140:143]
s_waitcnt lgkmcnt(0)
v_mfma_f32_16x16x32_bf16 v[144:147], v[4:7], a[72:75], v[144:147]
v_mfma_f32_16x16x32_bf16 v[148:151], v[4:7], a[76:79], v[148:151]
v_mfma_f32_16x16x32_bf16 v[152:155], v[8:11], a[72:75], v[152:155]
v_mfma_f32_16x16x32_bf16 v[156:159], v[8:11], a[76:79], v[156:159]
v_mfma_f32_16x16x32_bf16 v[160:163], v[12:15], a[72:75], v[160:163]
v_mfma_f32_16x16x32_bf16 v[164:167], v[12:15], a[76:79], v[164:167]
s_waitcnt vmcnt(0)
s_barrier
s_cmp_eq_u32 s49, 0
s_cbranch_scc1 FIN0
s_cmp_eq_u32 s49, 1
s_cbranch_scc1 FIN1
s_cmp_eq_u32 s49, 2
s_cbranch_scc1 FIN2
s_branch FIN3
CODE1:
.section .rodata,"a"
.p2align 6
.amdhsa_kernel concat_heads__mha_block_cached__mha_block_cached__near_ridge_kernel
  .amdhsa_next_free_vgpr 512
  .amdhsa_next_free_sgpr 102
  .amdhsa_accum_offset 256
  .amdhsa_group_segment_fixed_size 0
  .amdhsa_kernarg_size 104
  .amdhsa_user_sgpr_count 2
  .amdhsa_user_sgpr_kernarg_segment_ptr 1
  .amdhsa_system_sgpr_workgroup_id_x 1
.end_amdhsa_kernel
```
